```python
import torch

def _softmax(x, axis=-1):
    return torch.softmax(x, dim=axis)
def _gelu(x):
    return torch.nn.functional.gelu(x, approximate="tanh")
def _silu(x):
    return torch.nn.functional.silu(x)
def _sigmoid(x):
    return torch.sigmoid(x)
def _layernorm(x, axis=-1, eps=1e-5):
    m = x.mean(dim=axis, keepdim=True)
    v = x.var(dim=axis, keepdim=True, unbiased=False)
    return (x - m) / torch.sqrt(v + eps)
def _scatter_add(tgt, idx, src, axis=0):
    return tgt.clone().index_add_(axis, idx, src)
def _segment_sum(src, seg, n):
    out = torch.zeros((n,) + src.shape[1:], dtype=src.dtype)
    return out.index_add_(0, seg, src)
def _pad(x, pw):
    flat = tuple(v for pair in reversed(pw) for v in pair)
    return torch.nn.functional.pad(x, flat)

kernel_name = 'concat_heads__ssm_conv_h3__sliding_local_dilated__prompt'

def setup_inputs():

    _w = (lambda a: (lambda t: t.to(torch.bfloat16) if t.is_floating_point() else t)(torch.as_tensor(a)))
    def _A_setup():
        B, S, D = 1, 2048, 1024
        ks = 4
        return {
            "q": _w((lambda *s: torch.randn(*s, dtype=torch.bfloat16) * 0.05)(B, S, D)),
            "k": _w((lambda *s: torch.randn(*s, dtype=torch.bfloat16) * 1.6)(B, S, D)),
            "v": _w((lambda *s: torch.randn(*s, dtype=torch.bfloat16) * 0.8)(B, S, D)),
            "shift_k": _w((lambda *s: torch.randn(*s, dtype=torch.bfloat16) * 1.6)(D, ks) * 0.5),
            "ssm_k": _w((lambda *s: torch.randn(*s, dtype=torch.bfloat16) * 1.6)(D, S) * (1.0 / S ** 0.5)),
            "ssm_D": _w((lambda *s: torch.randn(*s, dtype=torch.bfloat16) * 0.8)(D)),
        }
    _A_in = _A_setup()

    def _B_setup():
        B, S, D = 1, 2048, 1024
        return {
            "x": _w((lambda *s: torch.randn(*s, dtype=torch.bfloat16) * 0.2)(B, S, D)),
            "wqkv": _w((lambda *s: torch.randn(*s, dtype=torch.bfloat16) * 0.2)(D, 3 * D)),
            "wo": _w((lambda *s: torch.randn(*s, dtype=torch.bfloat16) * 0.05)(D, D)),
        }
    _B_in = _B_setup()

    return {
        "A_q": _A_in["q"],
        "A_k": _A_in["k"],
        "A_v": _A_in["v"],
        "A_shift_k": _A_in["shift_k"],
        "A_ssm_k": _A_in["ssm_k"],
        "A_ssm_D": _A_in["ssm_D"],
        "B_x": _B_in["x"],
        "B_wqkv": _B_in["wqkv"],
        "B_wo": _B_in["wo"],
    }

def reference(A_q, A_k, A_v, A_shift_k, A_ssm_k, A_ssm_D, B_x, B_wqkv, B_wo):
    def _A_ref(q, k, v, shift_k, ssm_k, ssm_D):
        B, S, D = q.shape
        ks = shift_k.shape[-1]
        k_pad = _pad(k, ((0, 0), (ks - 1, 0), (0, 0)))
        k_shift = torch.zeros_like(k)
        for t in range(ks):
            k_shift = k_shift + k_pad[:, t:t + S, :] * shift_k[:, ks - 1 - t][None, None, :]
        kv = k_shift * v
        L = 2 * S
        kv_pad = _pad(kv, ((0, 0), (0, S), (0, 0)))
        kf_pad = _pad(ssm_k, ((0, 0), (0, S)))
        kv_f = (lambda x, axes=(-2,-1): torch.fft.rfft2(x.float(), dim=axes))(kv_pad[:, None, :, :], axes=(1, 2))
        kf_f = (lambda x, axes=(-2,-1): torch.fft.rfft2(x.float(), dim=axes))(kf_pad[:, None, :], axes=(1, 2))
        kf_f = (lambda x, *d: x.permute(*d))(kf_f, 1, 2, 0)
        y_f = kv_f * kf_f[None, :, :, :]
        y = (lambda x, s, axes=(-2,-1): torch.fft.irfft2(x, s=s, dim=axes).to(torch.bfloat16))(y_f, (1, L), axes=(1, 2))[:, 0, :S, :]
        y = y + kv * ssm_D[None, None, :]
        return q * y

    def _B_ref(x, wqkv, wo):
        B, S, D = x.shape
        H = 32; Dh = D // H
        W, dil = 8, 2
        qkv = (lambda x, *d: x.permute(*d))((x @ wqkv).reshape(B, S, 3, H, Dh), 2, 0, 3, 1, 4)
        q, k, v = qkv[0], qkv[1], qkv[2]
        scale = Dh ** -0.5
        pos = torch.arange(S)
        off = torch.arange(W) * dil
        idx = pos[:, None] - off[None, :]
        mask = idx >= 0
        idx_c = torch.where(mask, idx, 0).reshape(-1)
        kg = k[:, :, idx_c, :].reshape(B, H, S, W, Dh)
        vg = v[:, :, idx_c, :].reshape(B, H, S, W, Dh)
        logits = torch.einsum("bhsd,bhswd->bhsw", q, kg) * scale
        logits = torch.where(mask[None, None, :, :], logits, -1e9)
        attn = _softmax(logits, axis=-1)
        o = torch.einsum("bhsw,bhswd->bhsd", attn, vg)
        return (lambda x, *d: x.permute(*d))(o, 0, 2, 1, 3).reshape(B, S, D) @ wo

    a = _A_ref(A_q, A_k, A_v, A_shift_k, A_ssm_k, A_ssm_D)
    b = _B_ref(B_x, B_wqkv, B_wo)
    return torch.concatenate([a, b], axis=-1)
```

```asm
; @launch grid=(256,1,1) block=(512,1,1) lds=163840
.amdgcn_target "amdgcn-amd-amdhsa--gfx950"
.text
.globl concat_heads__ssm_conv_h3__sliding_local_dilated__prompt_kernel
.p2align 8
.type concat_heads__ssm_conv_h3__sliding_local_dilated__prompt_kernel,@function
concat_heads__ssm_conv_h3__sliding_local_dilated__prompt_kernel:
    s_cmp_ge_u32 s2, 256
    s_cbranch_scc1 L_end
    s_load_dwordx16 s[8:23], s[0:1], 0
    s_load_dwordx8 s[24:31], s[0:1], 64
    v_lshrrev_b32 v1, 6, v0
    s_nop 0
    v_readfirstlane_b32 s3, v1
    v_and_b32 v0, 63, v0
    s_and_b32 s4, s2, 1
    s_bfe_u32 s5, s2, 0x30003
    s_bfe_u32 s6, s2, 0x20001
    s_lshl_b32 s6, s6, 2
    s_lshr_b32 s7, s2, 6
    s_add_u32 s6, s6, s7
    s_waitcnt lgkmcnt(0)
    s_cmp_lt_u32 s3, 4
    s_cbranch_scc1 L_grole
    s_sub_u32 s48, s3, 4
    s_mov_b32 s32, s20
    s_mov_b32 s33, s21
    s_mov_b32 s34, 0x400000
    s_mov_b32 s35, 0x20000
    s_mov_b32 s36, s22
    s_mov_b32 s37, s23
    s_mov_b32 s38, 0x600000
    s_mov_b32 s39, 0x20000
    s_lshl_b32 s43, s48, 12
    s_lshl_b32 s44, s48, 11
    s_add_u32 s44, s44, 17408
    s_lshl_b32 s49, s48, 4
    s_lshl_b64 s[46:47], 0xffff, s49
    v_lshrrev_b32 v13, 3, v0
    v_and_b32 v14, 7, v0
    v_lshrrev_b32 v15, 4, v0
    s_lshl_b32 s49, s5, 7
    s_lshl_b32 s50, s48, 5
    s_add_u32 s50, s50, s49
    s_lshl_b32 s50, s50, 12
    s_lshl_b32 s51, s4, 11
    s_add_u32 s50, s50, s51
    v_lshl_add_u32 v16, v13, 12, s50
    v_xor_b32 v17, v14, v15
    v_lshl_add_u32 v2, v17, 4, v16
    v_xor_b32 v3, 64, v2
    v_add_u32 v3, 32768, v3
    v_add_u32 v4, 65536, v2
    v_add_u32 v5, 65536, v3
    s_sub_u32 s49, s49, 8
    s_max_i32 s49, s49, 0
    s_lshl_b32 s49, s49, 12
    s_add_u32 s49, s49, s51
    v_lshl_add_u32 v16, v13, 12, s49
    v_lshlrev_b32 v17, 1, v15
    v_xor_b32 v17, v14, v17
    v_lshl_add_u32 v6, v17, 4, v16
    s_mul_i32 s49, s48, 98304
    s_lshl_b32 s50, s6, 7
    s_add_u32 s49, s49, s50
    s_movk_i32 s50, 6144
    v_mul_lo_u32 v16, v13, s50
    v_add_u32 v16, s49, v16
    v_and_b32 v17, 1, v15
    v_lshlrev_b32 v17, 1, v17
    v_xor_b32 v17, v14, v17
    v_lshl_add_u32 v7, v17, 4, v16
    v_xor_b32 v8, 64, v7
    v_add_u32 v8, 49152, v8
    v_add_u32 v9, 2048, v7
    v_add_u32 v10, 2048, v8
    v_add_u32 v11, 4096, v7
    v_add_u32 v12, 4096, v8
    s_mov_b32 s40, 0
    s_mov_b32 s41, 0
    s_mov_b32 s42, 0
    s_add_u32 s48, s42, s43
    s_add_u32 s49, s42, s44
    s_add_u32 m0, s48, 0
    s_nop 0
    buffer_load_dwordx4 v2, s[32:35], s40 offen lds
    s_add_u32 m0, s49, 0
    s_nop 0
    buffer_load_dwordx4 v7, s[36:39], s41 offen lds
    s_add_u32 m0, s49, 1024
    s_nop 0
    buffer_load_dwordx4 v8, s[36:39], s41 offen lds
    s_add_u32 m0, s48, 1024
    s_nop 0
    buffer_load_dwordx4 v3, s[32:35], s40 offen lds
    s_add_u32 m0, s49, 8192
    s_nop 0
    buffer_load_dwordx4 v9, s[36:39], s41 offen lds
    s_add_u32 m0, s49, 9216
    s_nop 0
    buffer_load_dwordx4 v10, s[36:39], s41 offen lds
    s_add_u32 m0, s48, 2048
    s_nop 0
    buffer_load_dwordx4 v4, s[32:35], s40 offen lds
    s_add_u32 m0, s49, 16384
    s_nop 0
    buffer_load_dwordx4 v11, s[36:39], s41 offen lds
    s_add_u32 m0, s49, 17408
    s_nop 0
    buffer_load_dwordx4 v12, s[36:39], s41 offen lds
    s_add_u32 m0, s48, 3072
    s_nop 0
    buffer_load_dwordx4 v5, s[32:35], s40 offen lds
    s_add_u32 m0, s42, 16384
    s_mov_b64 exec, s[46:47]
    buffer_load_dwordx4 v6, s[32:35], s40 offen lds
    s_mov_b64 exec, -1
    s_add_u32 s40, s40, 128
    s_add_u32 s41, s41, 393216
    s_add_u32 s42, s42, 41984
    s_cmp_eq_u32 s42, 125952
    s_cselect_b32 s42, 0, s42
    s_add_u32 s48, s42, s43
    s_add_u32 s49, s42, s44
    s_add_u32 m0, s48, 0
    s_nop 0
    buffer_load_dwordx4 v2, s[32:35], s40 offen lds
    s_add_u32 m0, s49, 0
    s_nop 0
    buffer_load_dwordx4 v7, s[36:39], s41 offen lds
    s_add_u32 m0, s49, 1024
    s_nop 0
    buffer_load_dwordx4 v8, s[36:39], s41 offen lds
    s_add_u32 m0, s48, 1024
    s_nop 0
    buffer_load_dwordx4 v3, s[32:35], s40 offen lds
    s_add_u32 m0, s49, 8192
    s_nop 0
    buffer_load_dwordx4 v9, s[36:39], s41 offen lds
    s_add_u32 m0, s49, 9216
    s_nop 0
    buffer_load_dwordx4 v10, s[36:39], s41 offen lds
    s_add_u32 m0, s48, 2048
    s_nop 0
    buffer_load_dwordx4 v4, s[32:35], s40 offen lds
    s_add_u32 m0, s49, 16384
    s_nop 0
    buffer_load_dwordx4 v11, s[36:39], s41 offen lds
    s_add_u32 m0, s49, 17408
    s_nop 0
    buffer_load_dwordx4 v12, s[36:39], s41 offen lds
    s_add_u32 m0, s48, 3072
    s_nop 0
    buffer_load_dwordx4 v5, s[32:35], s40 offen lds
    s_add_u32 m0, s42, 16384
    s_mov_b64 exec, s[46:47]
    buffer_load_dwordx4 v6, s[32:35], s40 offen lds
    s_mov_b64 exec, -1
    s_add_u32 s40, s40, 128
    s_add_u32 s41, s41, 393216
    s_add_u32 s42, s42, 41984
    s_cmp_eq_u32 s42, 125952
    s_cselect_b32 s42, 0, s42
    s_sub_u32 s70, s3, 4
    s_and_b32 s68, s2, 7
    s_lshl_b32 s68, s68, 1
    s_lshr_b32 s74, s2, 7
    s_add_u32 s68, s68, s74
    s_bfe_u32 s69, s2, 0x40003
    s_lshl_b32 s71, s68, 6
    s_lshl_b32 s74, s69, 2
    s_add_u32 s71, s71, s74
    s_add_u32 s71, s71, s70
    s_mul_i32 s80, s70, 8448
    s_add_u32 s80, s80, 125952
    s_mul_i32 s81, s70, 9216
    s_add_u32 s81, s81, 41984
    s_add_u32 s52, s30, 0xc00000
    s_addc_u32 s53, s31, 0
    s_mov_b32 s54, 0x4000
    s_mov_b32 s55, 0x20000
    s_mov_b32 s64, s30
    s_mov_b32 s65, s31
    s_mov_b32 s66, 0xc00000
    s_mov_b32 s67, 0x20000
    s_movk_i32 s84, 4096
    s_movk_i32 s85, 6144
    s_lshr_b32 s74, s71, 1
    s_lshl_b32 s74, s74, 2
    s_load_dword s72, s[18:19], s74
    s_waitcnt vmcnt(11)
    s_barrier
    s_add_u32 s48, s42, s43
    s_add_u32 s49, s42, s44
    s_add_u32 m0, s48, 0
    s_nop 0
    buffer_load_dwordx4 v2, s[32:35], s40 offen lds
    s_add_u32 m0, s49, 0
    s_nop 0
    buffer_load_dwordx4 v7, s[36:39], s41 offen lds
    s_add_u32 m0, s49, 1024
    s_nop 0
    buffer_load_dwordx4 v8, s[36:39], s41 offen lds
    s_add_u32 m0, s48, 1024
    s_nop 0
    buffer_load_dwordx4 v3, s[32:35], s40 offen lds
    s_add_u32 m0, s49, 8192
    s_nop 0
    buffer_load_dwordx4 v9, s[36:39], s41 offen lds
    s_add_u32 m0, s49, 9216
    s_nop 0
    buffer_load_dwordx4 v10, s[36:39], s41 offen lds
    s_add_u32 m0, s48, 2048
    s_nop 0
    buffer_load_dwordx4 v4, s[32:35], s40 offen lds
    s_add_u32 m0, s49, 16384
    s_nop 0
    buffer_load_dwordx4 v11, s[36:39], s41 offen lds
    s_add_u32 m0, s49, 17408
    s_nop 0
    buffer_load_dwordx4 v12, s[36:39], s41 offen lds
    s_add_u32 m0, s48, 3072
    s_nop 0
    buffer_load_dwordx4 v5, s[32:35], s40 offen lds
    s_add_u32 m0, s42, 16384
    s_mov_b64 exec, s[46:47]
    buffer_load_dwordx4 v6, s[32:35], s40 offen lds
    s_mov_b64 exec, -1
    s_add_u32 s40, s40, 128
    s_add_u32 s41, s41, 393216
    s_add_u32 s42, s42, 41984
    s_cmp_eq_u32 s42, 125952
    s_cselect_b32 s42, 0, s42
    s_mov_b32 s56, s14
    s_mov_b32 s57, s15
    s_mov_b32 s58, 0x2000
    s_mov_b32 s59, 0x20000
    s_lshl_b32 s74, s68, 9
    v_lshlrev_b32 v124, 4, v0
    s_add_u32 m0, s80, 4224
    s_mov_b64 exec, 0xffffffff
    buffer_load_dwordx4 v124, s[56:59], s74 offen lds
    s_mov_b64 exec, -1
    s_lshl_b32 s74, s69, 2
    s_add_u32 s74, s74, s70
    s_lshl_b32 s74, s74, 16
    s_lshl_b32 s75, s68, 7
    s_add_u32 s74, s74, s75
    v_and_b32 v125, 7, v0
    v_lshl_add_u32 v125, v125, 4, s74
    v_lshrrev_b32 v124, 3, v0
    v_lshl_add_u32 v124, v124, 13, v125
    v_subrev_u32 v125, 6144, v124
    v_subrev_u32 v126, 4096, v124
    v_subrev_u32 v127, 2048, v124
    s_mov_b32 s56, s10
    s_mov_b32 s57, s11
    s_mov_b32 s58, 0x400000
    s_mov_b32 s59, 0x20000
    s_mov_b32 s60, s12
    s_mov_b32 s61, s13
    s_mov_b32 s62, 0x400000
    s_mov_b32 s63, 0x20000
    buffer_load_dwordx4 v[16:19], v125, s[56:59], 0 offen
    buffer_load_dwordx4 v[20:23], v126, s[56:59], 0 offen
    buffer_load_dwordx4 v[24:27], v127, s[56:59], 0 offen
    buffer_load_dwordx4 v[28:31], v124, s[56:59], 0 offen offset:0
    buffer_load_dwordx4 v[32:35], v124, s[56:59], 0 offen offset:2048
    buffer_load_dwordx4 v[36:39], v124, s[56:59], s84 offen offset:0
    buffer_load_dwordx4 v[40:43], v124, s[56:59], s85 offen offset:0
    buffer_load_dwordx4 v[44:47], v124, s[60:63], 0 offen offset:0
    buffer_load_dwordx4 v[48:51], v124, s[60:63], 0 offen offset:2048
    buffer_load_dwordx4 v[52:55], v124, s[60:63], s84 offen offset:0
    buffer_load_dwordx4 v[56:59], v124, s[60:63], s85 offen offset:0
    s_waitcnt vmcnt(23)
    s_barrier
    s_add_u32 s48, s42, s43
    s_add_u32 s49, s42, s44
    s_add_u32 m0, s48, 0
    s_nop 0
    buffer_load_dwordx4 v2, s[32:35], s40 offen lds
    s_add_u32 m0, s49, 0
    s_nop 0
    buffer_load_dwordx4 v7, s[36:39], s41 offen lds
    s_add_u32 m0, s49, 1024
    s_nop 0
    buffer_load_dwordx4 v8, s[36:39], s41 offen lds
    s_add_u32 m0, s48, 1024
    s_nop 0
    buffer_load_dwordx4 v3, s[32:35], s40 offen lds
    s_add_u32 m0, s49, 8192
    s_nop 0
    buffer_load_dwordx4 v9, s[36:39], s41 offen lds
    s_add_u32 m0, s49, 9216
    s_nop 0
    buffer_load_dwordx4 v10, s[36:39], s41 offen lds
    s_add_u32 m0, s48, 2048
    s_nop 0
    buffer_load_dwordx4 v4, s[32:35], s40 offen lds
    s_add_u32 m0, s49, 16384
    s_nop 0
    buffer_load_dwordx4 v11, s[36:39], s41 offen lds
    s_add_u32 m0, s49, 17408
    s_nop 0
    buffer_load_dwordx4 v12, s[36:39], s41 offen lds
    s_add_u32 m0, s48, 3072
    s_nop 0
    buffer_load_dwordx4 v5, s[32:35], s40 offen lds
    s_add_u32 m0, s42, 16384
    s_mov_b64 exec, s[46:47]
    buffer_load_dwordx4 v6, s[32:35], s40 offen lds
    s_mov_b64 exec, -1
    s_add_u32 s40, s40, 128
    s_add_u32 s41, s41, 393216
    s_add_u32 s42, s42, 41984
    s_cmp_eq_u32 s42, 125952
    s_cselect_b32 s42, 0, s42
    s_waitcnt vmcnt(23)
    s_barrier
    s_add_u32 s48, s42, s43
    s_add_u32 s49, s42, s44
    s_add_u32 m0, s48, 0
    s_nop 0
    buffer_load_dwordx4 v2, s[32:35], s40 offen lds
    s_add_u32 m0, s49, 0
    s_nop 0
    buffer_load_dwordx4 v7, s[36:39], s41 offen lds
    s_add_u32 m0, s49, 1024
    s_nop 0
    buffer_load_dwordx4 v8, s[36:39], s41 offen lds
    s_add_u32 m0, s48, 1024
    s_nop 0
    buffer_load_dwordx4 v3, s[32:35], s40 offen lds
    s_add_u32 m0, s49, 8192
    s_nop 0
    buffer_load_dwordx4 v9, s[36:39], s41 offen lds
    s_add_u32 m0, s49, 9216
    s_nop 0
    buffer_load_dwordx4 v10, s[36:39], s41 offen lds
    s_add_u32 m0, s48, 2048
    s_nop 0
    buffer_load_dwordx4 v4, s[32:35], s40 offen lds
    s_add_u32 m0, s49, 16384
    s_nop 0
    buffer_load_dwordx4 v11, s[36:39], s41 offen lds
    s_add_u32 m0, s49, 17408
    s_nop 0
    buffer_load_dwordx4 v12, s[36:39], s41 offen lds
    s_add_u32 m0, s48, 3072
    s_nop 0
    buffer_load_dwordx4 v5, s[32:35], s40 offen lds
    s_add_u32 m0, s42, 16384
    s_mov_b64 exec, s[46:47]
    buffer_load_dwordx4 v6, s[32:35], s40 offen lds
    s_mov_b64 exec, -1
    s_add_u32 s40, s40, 128
    s_add_u32 s41, s41, 393216
    s_add_u32 s42, s42, 41984
    s_cmp_eq_u32 s42, 125952
    s_cselect_b32 s42, 0, s42
    s_waitcnt vmcnt(22)
    v_and_b32 v124, 7, v0
    v_lshlrev_b32 v124, 6, v124
    v_add_u32 v124, s80, v124
    ds_read_b128 v[60:63], v124 offset:4224
    ds_read_b128 v[64:67], v124 offset:4240
    ds_read_b128 v[68:71], v124 offset:4256
    ds_read_b128 v[72:75], v124 offset:4272
    v_and_b32 v125, 7, v0
    v_mul_u32_u24 v125, 528, v125
    v_lshrrev_b32 v126, 3, v0
    v_xor_b32 v126, 7, v126
    v_lshl_add_u32 v125, v126, 3, v125
    v_add_u32 v125, s80, v125
    v_lshrrev_b32 v126, 5, v0
    v_add_u32 v126, v0, v126
    v_lshl_add_u32 v126, v126, 4, s80
    s_waitcnt lgkmcnt(0)
    v_lshlrev_b32 v76, 16, v16
    v_and_b32 v83, 0xffff0000, v16
    v_lshlrev_b32 v77, 16, v20
    v_and_b32 v84, 0xffff0000, v20
    v_lshlrev_b32 v78, 16, v24
    v_and_b32 v85, 0xffff0000, v24
    v_lshlrev_b32 v79, 16, v28
    v_and_b32 v86, 0xffff0000, v28
    v_lshlrev_b32 v80, 16, v32
    v_and_b32 v87, 0xffff0000, v32
    v_lshlrev_b32 v81, 16, v36
    v_and_b32 v88, 0xffff0000, v36
    v_lshlrev_b32 v82, 16, v40
    v_and_b32 v89, 0xffff0000, v40
    v_lshlrev_b32 v98, 16, v60
    v_and_b32 v99, 0xffff0000, v60
    v_lshlrev_b32 v100, 16, v61
    v_and_b32 v101, 0xffff0000, v61
    v_lshlrev_b32 v102, 16, v62
    v_and_b32 v103, 0xffff0000, v62
    v_lshlrev_b32 v104, 16, v63
    v_and_b32 v105, 0xffff0000, v63
    v_lshlrev_b32 v90, 16, v44
    v_and_b32 v94, 0xffff0000, v44
    v_lshlrev_b32 v91, 16, v48
    v_and_b32 v95, 0xffff0000, v48
    v_lshlrev_b32 v92, 16, v52
    v_and_b32 v96, 0xffff0000, v52
    v_lshlrev_b32 v93, 16, v56
    v_and_b32 v97, 0xffff0000, v56
    v_mul_f32 v76, v76, v101
    v_fmac_f32 v76, v77, v100
    v_fmac_f32 v76, v78, v99
    v_fmac_f32 v76, v79, v98
    v_mul_f32 v76, v76, v90
    v_mul_f32 v77, v77, v101
    v_fmac_f32 v77, v78, v100
    v_fmac_f32 v77, v79, v99
    v_fmac_f32 v77, v80, v98
    v_mul_f32 v77, v77, v91
    v_mul_f32 v78, v78, v101
    v_fmac_f32 v78, v79, v100
    v_fmac_f32 v78, v80, v99
    v_fmac_f32 v78, v81, v98
    v_mul_f32 v78, v78, v92
    v_mul_f32 v79, v79, v101
    v_fmac_f32 v79, v80, v100
    v_fmac_f32 v79, v81, v99
    v_fmac_f32 v79, v82, v98
    v_mul_f32 v79, v79, v93
    v_cvt_pk_bf16_f32 v108, v79, v78
    v_cvt_pk_bf16_f32 v109, v77, v76
    ds_write_b64 v125, v[108:109] offset:0
    v_mul_f32 v83, v83, v105
    v_fmac_f32 v83, v84, v104
    v_fmac_f32 v83, v85, v103
    v_fmac_f32 v83, v86, v102
    v_mul_f32 v83, v83, v94
    v_mul_f32 v84, v84, v105
    v_fmac_f32 v84, v85, v104
    v_fmac_f32 v84, v86, v103
    v_fmac_f32 v84, v87, v102
    v_mul_f32 v84, v84, v95
    v_mul_f32 v85, v85, v105
    v_fmac_f32 v85, v86, v104
    v_fmac_f32 v85, v87, v103
    v_fmac_f32 v85, v88, v102
    v_mul_f32 v85, v85, v96
    v_mul_f32 v86, v86, v105
    v_fmac_f32 v86, v87, v104
    v_fmac_f32 v86, v88, v103
    v_fmac_f32 v86, v89, v102
    v_mul_f32 v86, v86, v97
    v_cvt_pk_bf16_f32 v110, v86, v85
    v_cvt_pk_bf16_f32 v111, v84, v83
    ds_write_b64 v125, v[110:111] offset:64
    v_lshlrev_b32 v76, 16, v17
    v_and_b32 v83, 0xffff0000, v17
    v_lshlrev_b32 v77, 16, v21
    v_and_b32 v84, 0xffff0000, v21
    v_lshlrev_b32 v78, 16, v25
    v_and_b32 v85, 0xffff0000, v25
    v_lshlrev_b32 v79, 16, v29
    v_and_b32 v86, 0xffff0000, v29
    v_lshlrev_b32 v80, 16, v33
    v_and_b32 v87, 0xffff0000, v33
    v_lshlrev_b32 v81, 16, v37
    v_and_b32 v88, 0xffff0000, v37
    v_lshlrev_b32 v82, 16, v41
    v_and_b32 v89, 0xffff0000, v41
    v_lshlrev_b32 v98, 16, v64
    v_and_b32 v99, 0xffff0000, v64
    v_lshlrev_b32 v100, 16, v65
    v_and_b32 v101, 0xffff0000, v65
    v_lshlrev_b32 v102, 16, v66
    v_and_b32 v103, 0xffff0000, v66
    v_lshlrev_b32 v104, 16, v67
    v_and_b32 v105, 0xffff0000, v67
    v_lshlrev_b32 v90, 16, v45
    v_and_b32 v94, 0xffff0000, v45
    v_lshlrev_b32 v91, 16, v49
    v_and_b32 v95, 0xffff0000, v49
    v_lshlrev_b32 v92, 16, v53
    v_and_b32 v96, 0xffff0000, v53
    v_lshlrev_b32 v93, 16, v57
    v_and_b32 v97, 0xffff0000, v57
    v_mul_f32 v76, v76, v101
    v_fmac_f32 v76, v77, v100
    v_fmac_f32 v76, v78, v99
    v_fmac_f32 v76, v79, v98
    v_mul_f32 v76, v76, v90
    v_mul_f32 v77, v77, v101
    v_fmac_f32 v77, v78, v100
    v_fmac_f32 v77, v79, v99
    v_fmac_f32 v77, v80, v98
    v_mul_f32 v77, v77, v91
    v_mul_f32 v78, v78, v101
    v_fmac_f32 v78, v79, v100
    v_fmac_f32 v78, v80, v99
    v_fmac_f32 v78, v81, v98
    v_mul_f32 v78, v78, v92
    v_mul_f32 v79, v79, v101
    v_fmac_f32 v79, v80, v100
    v_fmac_f32 v79, v81, v99
    v_fmac_f32 v79, v82, v98
    v_mul_f32 v79, v79, v93
    v_cvt_pk_bf16_f32 v112, v79, v78
    v_cvt_pk_bf16_f32 v113, v77, v76
    ds_write_b64 v125, v[112:113] offset:128
    v_mul_f32 v83, v83, v105
    v_fmac_f32 v83, v84, v104
    v_fmac_f32 v83, v85, v103
    v_fmac_f32 v83, v86, v102
    v_mul_f32 v83, v83, v94
    v_mul_f32 v84, v84, v105
    v_fmac_f32 v84, v85, v104
    v_fmac_f32 v84, v86, v103
    v_fmac_f32 v84, v87, v102
    v_mul_f32 v84, v84, v95
    v_mul_f32 v85, v85, v105
    v_fmac_f32 v85, v86, v104
    v_fmac_f32 v85, v87, v103
    v_fmac_f32 v85, v88, v102
    v_mul_f32 v85, v85, v96
    v_mul_f32 v86, v86, v105
    v_fmac_f32 v86, v87, v104
    v_fmac_f32 v86, v88, v103
    v_fmac_f32 v86, v89, v102
    v_mul_f32 v86, v86, v97
    v_cvt_pk_bf16_f32 v114, v86, v85
    v_cvt_pk_bf16_f32 v115, v84, v83
    ds_write_b64 v125, v[114:115] offset:192
    s_waitcnt vmcnt(11)
    s_barrier
    s_add_u32 s48, s42, s43
    s_add_u32 s49, s42, s44
    s_add_u32 m0, s48, 0
    s_nop 0
    buffer_load_dwordx4 v2, s[32:35], s40 offen lds
    s_add_u32 m0, s49, 0
    s_nop 0
    buffer_load_dwordx4 v7, s[36:39], s41 offen lds
    s_add_u32 m0, s49, 1024
    s_nop 0
    buffer_load_dwordx4 v8, s[36:39], s41 offen lds
    s_add_u32 m0, s48, 1024
    s_nop 0
    buffer_load_dwordx4 v3, s[32:35], s40 offen lds
    s_add_u32 m0, s49, 8192
    s_nop 0
    buffer_load_dwordx4 v9, s[36:39], s41 offen lds
    s_add_u32 m0, s49, 9216
    s_nop 0
    buffer_load_dwordx4 v10, s[36:39], s41 offen lds
    s_add_u32 m0, s48, 2048
    s_nop 0
    buffer_load_dwordx4 v4, s[32:35], s40 offen lds
    s_add_u32 m0, s49, 16384
    s_nop 0
    buffer_load_dwordx4 v11, s[36:39], s41 offen lds
    s_add_u32 m0, s49, 17408
    s_nop 0
    buffer_load_dwordx4 v12, s[36:39], s41 offen lds
    s_add_u32 m0, s48, 3072
    s_nop 0
    buffer_load_dwordx4 v5, s[32:35], s40 offen lds
    s_add_u32 m0, s42, 16384
    s_mov_b64 exec, s[46:47]
    buffer_load_dwordx4 v6, s[32:35], s40 offen lds
    s_mov_b64 exec, -1
    s_add_u32 s40, s40, 128
    s_add_u32 s41, s41, 393216
    s_add_u32 s42, s42, 41984
    s_cmp_eq_u32 s42, 125952
    s_cselect_b32 s42, 0, s42
    v_lshlrev_b32 v76, 16, v18
    v_and_b32 v83, 0xffff0000, v18
    v_lshlrev_b32 v77, 16, v22
    v_and_b32 v84, 0xffff0000, v22
    v_lshlrev_b32 v78, 16, v26
    v_and_b32 v85, 0xffff0000, v26
    v_lshlrev_b32 v79, 16, v30
    v_and_b32 v86, 0xffff0000, v30
    v_lshlrev_b32 v80, 16, v34
    v_and_b32 v87, 0xffff0000, v34
    v_lshlrev_b32 v81, 16, v38
    v_and_b32 v88, 0xffff0000, v38
    v_lshlrev_b32 v82, 16, v42
    v_and_b32 v89, 0xffff0000, v42
    v_lshlrev_b32 v98, 16, v68
    v_and_b32 v99, 0xffff0000, v68
    v_lshlrev_b32 v100, 16, v69
    v_and_b32 v101, 0xffff0000, v69
    v_lshlrev_b32 v102, 16, v70
    v_and_b32 v103, 0xffff0000, v70
    v_lshlrev_b32 v104, 16, v71
    v_and_b32 v105, 0xffff0000, v71
    v_lshlrev_b32 v90, 16, v46
    v_and_b32 v94, 0xffff0000, v46
    v_lshlrev_b32 v91, 16, v50
    v_and_b32 v95, 0xffff0000, v50
    v_lshlrev_b32 v92, 16, v54
    v_and_b32 v96, 0xffff0000, v54
    v_lshlrev_b32 v93, 16, v58
    v_and_b32 v97, 0xffff0000, v58
    v_mul_f32 v76, v76, v101
    v_fmac_f32 v76, v77, v100
    v_fmac_f32 v76, v78, v99
    v_fmac_f32 v76, v79, v98
    v_mul_f32 v76, v76, v90
    v_mul_f32 v77, v77, v101
    v_fmac_f32 v77, v78, v100
    v_fmac_f32 v77, v79, v99
    v_fmac_f32 v77, v80, v98
    v_mul_f32 v77, v77, v91
    v_mul_f32 v78, v78, v101
    v_fmac_f32 v78, v79, v100
    v_fmac_f32 v78, v80, v99
    v_fmac_f32 v78, v81, v98
    v_mul_f32 v78, v78, v92
    v_mul_f32 v79, v79, v101
    v_fmac_f32 v79, v80, v100
    v_fmac_f32 v79, v81, v99
    v_fmac_f32 v79, v82, v98
    v_mul_f32 v79, v79, v93
    v_cvt_pk_bf16_f32 v116, v79, v78
    v_cvt_pk_bf16_f32 v117, v77, v76
    ds_write_b64 v125, v[116:117] offset:256
    v_mul_f32 v83, v83, v105
    v_fmac_f32 v83, v84, v104
    v_fmac_f32 v83, v85, v103
    v_fmac_f32 v83, v86, v102
    v_mul_f32 v83, v83, v94
    v_mul_f32 v84, v84, v105
    v_fmac_f32 v84, v85, v104
    v_fmac_f32 v84, v86, v103
    v_fmac_f32 v84, v87, v102
    v_mul_f32 v84, v84, v95
    v_mul_f32 v85, v85, v105
    v_fmac_f32 v85, v86, v104
    v_fmac_f32 v85, v87, v103
    v_fmac_f32 v85, v88, v102
    v_mul_f32 v85, v85, v96
    v_mul_f32 v86, v86, v105
    v_fmac_f32 v86, v87, v104
    v_fmac_f32 v86, v88, v103
    v_fmac_f32 v86, v89, v102
    v_mul_f32 v86, v86, v97
    v_cvt_pk_bf16_f32 v118, v86, v85
    v_cvt_pk_bf16_f32 v119, v84, v83
    ds_write_b64 v125, v[118:119] offset:320
    v_lshlrev_b32 v76, 16, v19
    v_and_b32 v83, 0xffff0000, v19
    v_lshlrev_b32 v77, 16, v23
    v_and_b32 v84, 0xffff0000, v23
    v_lshlrev_b32 v78, 16, v27
    v_and_b32 v85, 0xffff0000, v27
    v_lshlrev_b32 v79, 16, v31
    v_and_b32 v86, 0xffff0000, v31
    v_lshlrev_b32 v80, 16, v35
    v_and_b32 v87, 0xffff0000, v35
    v_lshlrev_b32 v81, 16, v39
    v_and_b32 v88, 0xffff0000, v39
    v_lshlrev_b32 v82, 16, v43
    v_and_b32 v89, 0xffff0000, v43
    v_lshlrev_b32 v98, 16, v72
    v_and_b32 v99, 0xffff0000, v72
    v_lshlrev_b32 v100, 16, v73
    v_and_b32 v101, 0xffff0000, v73
    v_lshlrev_b32 v102, 16, v74
    v_and_b32 v103, 0xffff0000, v74
    v_lshlrev_b32 v104, 16, v75
    v_and_b32 v105, 0xffff0000, v75
    v_lshlrev_b32 v90, 16, v47
    v_and_b32 v94, 0xffff0000, v47
    v_lshlrev_b32 v91, 16, v51
    v_and_b32 v95, 0xffff0000, v51
    v_lshlrev_b32 v92, 16, v55
    v_and_b32 v96, 0xffff0000, v55
    v_lshlrev_b32 v93, 16, v59
    v_and_b32 v97, 0xffff0000, v59
    v_mul_f32 v76, v76, v101
    v_fmac_f32 v76, v77, v100
    v_fmac_f32 v76, v78, v99
    v_fmac_f32 v76, v79, v98
    v_mul_f32 v76, v76, v90
    v_mul_f32 v77, v77, v101
    v_fmac_f32 v77, v78, v100
    v_fmac_f32 v77, v79, v99
    v_fmac_f32 v77, v80, v98
    v_mul_f32 v77, v77, v91
    v_mul_f32 v78, v78, v101
    v_fmac_f32 v78, v79, v100
    v_fmac_f32 v78, v80, v99
    v_fmac_f32 v78, v81, v98
    v_mul_f32 v78, v78, v92
    v_mul_f32 v79, v79, v101
    v_fmac_f32 v79, v80, v100
    v_fmac_f32 v79, v81, v99
    v_fmac_f32 v79, v82, v98
    v_mul_f32 v79, v79, v93
    v_cvt_pk_bf16_f32 v120, v79, v78
    v_cvt_pk_bf16_f32 v121, v77, v76
    ds_write_b64 v125, v[120:121] offset:384
    v_mul_f32 v83, v83, v105
    v_fmac_f32 v83, v84, v104
    v_fmac_f32 v83, v85, v103
    v_fmac_f32 v83, v86, v102
    v_mul_f32 v83, v83, v94
    v_mul_f32 v84, v84, v105
    v_fmac_f32 v84, v85, v104
    v_fmac_f32 v84, v86, v103
    v_fmac_f32 v84, v87, v102
    v_mul_f32 v84, v84, v95
    v_mul_f32 v85, v85, v105
    v_fmac_f32 v85, v86, v104
    v_fmac_f32 v85, v87, v103
    v_fmac_f32 v85, v88, v102
    v_mul_f32 v85, v85, v96
    v_mul_f32 v86, v86, v105
    v_fmac_f32 v86, v87, v104
    v_fmac_f32 v86, v88, v103
    v_fmac_f32 v86, v89, v102
    v_mul_f32 v86, v86, v97
    v_cvt_pk_bf16_f32 v122, v86, v85
    v_cvt_pk_bf16_f32 v123, v84, v83
    ds_write_b64 v125, v[122:123] offset:448
    s_waitcnt vmcnt(11)
    s_barrier
    s_add_u32 s48, s42, s43
    s_add_u32 s49, s42, s44
    s_add_u32 m0, s48, 0
    s_nop 0
    buffer_load_dwordx4 v2, s[32:35], s40 offen lds
    s_add_u32 m0, s49, 0
    s_nop 0
    buffer_load_dwordx4 v7, s[36:39], s41 offen lds
    s_add_u32 m0, s49, 1024
    s_nop 0
    buffer_load_dwordx4 v8, s[36:39], s41 offen lds
    s_add_u32 m0, s48, 1024
    s_nop 0
    buffer_load_dwordx4 v3, s[32:35], s40 offen lds
    s_add_u32 m0, s49, 8192
    s_nop 0
    buffer_load_dwordx4 v9, s[36:39], s41 offen lds
    s_add_u32 m0, s49, 9216
    s_nop 0
    buffer_load_dwordx4 v10, s[36:39], s41 offen lds
    s_add_u32 m0, s48, 2048
    s_nop 0
    buffer_load_dwordx4 v4, s[32:35], s40 offen lds
    s_add_u32 m0, s49, 16384
    s_nop 0
    buffer_load_dwordx4 v11, s[36:39], s41 offen lds
    s_add_u32 m0, s49, 17408
    s_nop 0
    buffer_load_dwordx4 v12, s[36:39], s41 offen lds
    s_add_u32 m0, s48, 3072
    s_nop 0
    buffer_load_dwordx4 v5, s[32:35], s40 offen lds
    s_add_u32 m0, s42, 16384
    s_mov_b64 exec, s[46:47]
    buffer_load_dwordx4 v6, s[32:35], s40 offen lds
    s_mov_b64 exec, -1
    s_add_u32 s40, s40, 128
    s_add_u32 s41, s41, 393216
    s_add_u32 s42, s42, 41984
    s_cmp_eq_u32 s42, 125952
    s_cselect_b32 s42, 0, s42
    s_lshl_b32 s74, s71, 12
    s_add_u32 s56, s16, s74
    s_addc_u32 s57, s17, 0
    s_movk_i32 s58, 4096
    s_mov_b32 s59, 0x20000
    v_lshlrev_b32 v224, 4, v0
    v_subrev_u32 v129, 4, v224
    buffer_load_dwordx4 v[132:135], v224, s[56:59], 0 offen offset:0
    buffer_load_dwordx4 v[136:139], v224, s[56:59], 0 offen offset:1024
    buffer_load_dwordx4 v[140:143], v224, s[56:59], 0 offen offset:2048
    buffer_load_dwordx4 v[144:147], v224, s[56:59], 0 offen offset:3072
    buffer_load_dword v148, v129, s[56:59], 0 offen
    buffer_load_dword v149, v224, s[56:59], 0 offen offset:1020
    buffer_load_dword v150, v224, s[56:59], 0 offen offset:2044
    buffer_load_dword v151, v224, s[56:59], 0 offen offset:3068
    s_waitcnt lgkmcnt(0)
    ds_read_b128 v[108:111], v126 offset:0
    ds_read_b128 v[112:115], v126 offset:1056
    ds_read_b128 v[116:119], v126 offset:2112
    ds_read_b128 v[120:123], v126 offset:3168
    s_lshl_b32 s74, s69, 2
    s_add_u32 s74, s74, s70
    s_lshl_b32 s74, s74, 6
    s_sub_u32 s74, 4198336, s74
    s_lshl_b32 s75, s68, 18
    s_add_u32 s74, s74, s75
    v_and_b32 v127, 3, v0
    v_lshl_add_u32 v127, v127, 4, s74
    v_lshrrev_b32 v128, 2, v0
    v_lshl_add_u32 v127, v128, 12, v127
    s_mov_b32 s74, 0
    s_waitcnt lgkmcnt(3)
    buffer_store_dwordx4 v[108:111], v127, s[64:67], s74 offen sc1
    s_mov_b32 s74, 65536
    s_waitcnt lgkmcnt(2)
    buffer_store_dwordx4 v[112:115], v127, s[64:67], s74 offen sc1
    s_mov_b32 s74, 131072
    s_waitcnt lgkmcnt(1)
    buffer_store_dwordx4 v[116:119], v127, s[64:67], s74 offen sc1
    s_mov_b32 s74, 196608
    s_waitcnt lgkmcnt(0)
    buffer_store_dwordx4 v[120:123], v127, s[64:67], s74 offen sc1
    s_waitcnt vmcnt(23)
    s_barrier
    s_add_u32 s48, s42, s43
    s_add_u32 s49, s42, s44
    s_add_u32 m0, s48, 0
    s_nop 0
    buffer_load_dwordx4 v2, s[32:35], s40 offen lds
    s_add_u32 m0, s49, 0
    s_nop 0
    buffer_load_dwordx4 v7, s[36:39], s41 offen lds
    s_add_u32 m0, s49, 1024
    s_nop 0
    buffer_load_dwordx4 v8, s[36:39], s41 offen lds
    s_add_u32 m0, s48, 1024
    s_nop 0
    buffer_load_dwordx4 v3, s[32:35], s40 offen lds
    s_add_u32 m0, s49, 8192
    s_nop 0
    buffer_load_dwordx4 v9, s[36:39], s41 offen lds
    s_add_u32 m0, s49, 9216
    s_nop 0
    buffer_load_dwordx4 v10, s[36:39], s41 offen lds
    s_add_u32 m0, s48, 2048
    s_nop 0
    buffer_load_dwordx4 v4, s[32:35], s40 offen lds
    s_add_u32 m0, s49, 16384
    s_nop 0
    buffer_load_dwordx4 v11, s[36:39], s41 offen lds
    s_add_u32 m0, s49, 17408
    s_nop 0
    buffer_load_dwordx4 v12, s[36:39], s41 offen lds
    s_add_u32 m0, s48, 3072
    s_nop 0
    buffer_load_dwordx4 v5, s[32:35], s40 offen lds
    s_add_u32 m0, s42, 16384
    s_mov_b64 exec, s[46:47]
    buffer_load_dwordx4 v6, s[32:35], s40 offen lds
    s_mov_b64 exec, -1
    s_add_u32 s40, s40, 128
    s_add_u32 s41, s41, 393216
    s_add_u32 s42, s42, 41984
    s_cmp_eq_u32 s42, 125952
    s_cselect_b32 s42, 0, s42
    s_mov_b32 s60, s28
    s_mov_b32 s61, s29
    s_mov_b32 s62, 0x100
    s_mov_b32 s63, 0x20000
    s_lshl_b32 s73, s68, 8
    s_mov_b64 exec, 1
    buffer_load_dword v130, off, s[60:63], 0 sc1
    s_mov_b64 exec, -1
    s_waitcnt vmcnt(24)
    s_barrier
    s_add_u32 s48, s42, s43
    s_add_u32 s49, s42, s44
    s_add_u32 m0, s48, 0
    s_nop 0
    buffer_load_dwordx4 v2, s[32:35], s40 offen lds
    s_add_u32 m0, s49, 0
    s_nop 0
    buffer_load_dwordx4 v7, s[36:39], s41 offen lds
    s_add_u32 m0, s49, 1024
    s_nop 0
    buffer_load_dwordx4 v8, s[36:39], s41 offen lds
    s_add_u32 m0, s48, 1024
    s_nop 0
    buffer_load_dwordx4 v3, s[32:35], s40 offen lds
    s_add_u32 m0, s49, 8192
    s_nop 0
    buffer_load_dwordx4 v9, s[36:39], s41 offen lds
    s_add_u32 m0, s49, 9216
    s_nop 0
    buffer_load_dwordx4 v10, s[36:39], s41 offen lds
    s_add_u32 m0, s48, 2048
    s_nop 0
    buffer_load_dwordx4 v4, s[32:35], s40 offen lds
    s_add_u32 m0, s49, 16384
    s_nop 0
    buffer_load_dwordx4 v11, s[36:39], s41 offen lds
    s_add_u32 m0, s49, 17408
    s_nop 0
    buffer_load_dwordx4 v12, s[36:39], s41 offen lds
    s_add_u32 m0, s48, 3072
    s_nop 0
    buffer_load_dwordx4 v5, s[32:35], s40 offen lds
    s_add_u32 m0, s42, 16384
    s_mov_b64 exec, s[46:47]
    buffer_load_dwordx4 v6, s[32:35], s40 offen lds
    s_mov_b64 exec, -1
    s_add_u32 s40, s40, 128
    s_add_u32 s41, s41, 393216
    s_add_u32 s42, s42, 41984
    s_cmp_eq_u32 s42, 125952
    s_cselect_b32 s42, 0, s42
    s_waitcnt vmcnt(27)
    v_add_u32 v129, s80, v224
    v_alignbit_b32 v152, v132, v148, 16
    v_alignbit_b32 v153, v133, v132, 16
    v_alignbit_b32 v154, v134, v133, 16
    v_alignbit_b32 v155, v135, v134, 16
    ds_write_b128 v129, v[132:135] offset:64
    ds_write_b128 v129, v[152:155] offset:4288
    v_alignbit_b32 v156, v136, v149, 16
    v_alignbit_b32 v157, v137, v136, 16
    v_alignbit_b32 v158, v138, v137, 16
    v_alignbit_b32 v159, v139, v138, 16
    ds_write_b128 v129, v[136:139] offset:1088
    ds_write_b128 v129, v[156:159] offset:5312
    v_alignbit_b32 v160, v140, v150, 16
    v_alignbit_b32 v161, v141, v140, 16
    v_alignbit_b32 v162, v142, v141, 16
    v_alignbit_b32 v163, v143, v142, 16
    ds_write_b128 v129, v[140:143] offset:2112
    ds_write_b128 v129, v[160:163] offset:6336
    v_alignbit_b32 v164, v144, v151, 16
    v_alignbit_b32 v165, v145, v144, 16
    v_alignbit_b32 v166, v146, v145, 16
    v_alignbit_b32 v167, v147, v146, 16
    ds_write_b128 v129, v[144:147] offset:3136
    ds_write_b128 v129, v[164:167] offset:7360
    v_mov_b32 v228, 0
    v_mov_b32 v229, 0
    v_mov_b32 v230, 0
    v_mov_b32 v231, 0
    s_mov_b64 exec, 0xf
    ds_write_b128 v129, v[228:231]
    ds_write_b128 v129, v[228:231] offset:4224
    s_mov_b64 exec, -1
    s_waitcnt vmcnt(23)
    s_waitcnt vmcnt(12)
    s_barrier
    s_add_u32 s48, s42, s43
    s_add_u32 s49, s42, s44
    s_add_u32 m0, s48, 0
    s_nop 0
    buffer_load_dwordx4 v2, s[32:35], s40 offen lds
    s_add_u32 m0, s49, 0
    s_nop 0
    buffer_load_dwordx4 v7, s[36:39], s41 offen lds
    s_add_u32 m0, s49, 1024
    s_nop 0
    buffer_load_dwordx4 v8, s[36:39], s41 offen lds
    s_add_u32 m0, s48, 1024
    s_nop 0
    buffer_load_dwordx4 v3, s[32:35], s40 offen lds
    s_add_u32 m0, s49, 8192
    s_nop 0
    buffer_load_dwordx4 v9, s[36:39], s41 offen lds
    s_add_u32 m0, s49, 9216
    s_nop 0
    buffer_load_dwordx4 v10, s[36:39], s41 offen lds
    s_add_u32 m0, s48, 2048
    s_nop 0
    buffer_load_dwordx4 v4, s[32:35], s40 offen lds
    s_add_u32 m0, s49, 16384
    s_nop 0
    buffer_load_dwordx4 v11, s[36:39], s41 offen lds
    s_add_u32 m0, s49, 17408
    s_nop 0
    buffer_load_dwordx4 v12, s[36:39], s41 offen lds
    s_add_u32 m0, s48, 3072
    s_nop 0
    buffer_load_dwordx4 v5, s[32:35], s40 offen lds
    s_add_u32 m0, s42, 16384
    s_mov_b64 exec, s[46:47]
    buffer_load_dwordx4 v6, s[32:35], s40 offen lds
    s_mov_b64 exec, -1
    s_add_u32 s40, s40, 128
    s_add_u32 s41, s41, 393216
    s_add_u32 s42, s42, 41984
    s_cmp_eq_u32 s42, 125952
    s_cselect_b32 s42, 0, s42
    s_waitcnt vmcnt(22)
    s_cmp_lg_u32 s70, 0
    s_cbranch_scc1 L_sig_1
    s_mov_b64 exec, 1
    s_mov_b32 s75, 131072
L_sg_loop_3:
    v_readfirstlane_b32 s74, v130
    s_nop 0
    s_cmp_ge_u32 s74, 1
    s_cbranch_scc1 L_sg_done_2
    s_sub_u32 s75, s75, 1
    s_cbranch_scc1 L_sg_done_2
    buffer_load_dword v130, off, s[60:63], 0 sc1
    s_waitcnt vmcnt(0)
    s_branch L_sg_loop_3
L_sg_done_2:
    v_mov_b32 v130, 1
    buffer_atomic_add v130, off, s[52:55], s73 sc1
    s_mov_b64 exec, -1
L_sig_1:
    s_waitcnt vmcnt(11)
    s_barrier
    s_add_u32 s48, s42, s43
    s_add_u32 s49, s42, s44
    s_add_u32 m0, s48, 0
    s_nop 0
    buffer_load_dwordx4 v2, s[32:35], s40 offen lds
    s_add_u32 m0, s49, 0
    s_nop 0
    buffer_load_dwordx4 v7, s[36:39], s41 offen lds
    s_add_u32 m0, s49, 1024
    s_nop 0
    buffer_load_dwordx4 v8, s[36:39], s41 offen lds
    s_add_u32 m0, s48, 1024
    s_nop 0
    buffer_load_dwordx4 v3, s[32:35], s40 offen lds
    s_add_u32 m0, s49, 8192
    s_nop 0
    buffer_load_dwordx4 v9, s[36:39], s41 offen lds
    s_add_u32 m0, s49, 9216
    s_nop 0
    buffer_load_dwordx4 v10, s[36:39], s41 offen lds
    s_add_u32 m0, s48, 2048
    s_nop 0
    buffer_load_dwordx4 v4, s[32:35], s40 offen lds
    s_add_u32 m0, s49, 16384
    s_nop 0
    buffer_load_dwordx4 v11, s[36:39], s41 offen lds
    s_add_u32 m0, s49, 17408
    s_nop 0
    buffer_load_dwordx4 v12, s[36:39], s41 offen lds
    s_add_u32 m0, s48, 3072
    s_nop 0
    buffer_load_dwordx4 v5, s[32:35], s40 offen lds
    s_add_u32 m0, s42, 16384
    s_mov_b64 exec, s[46:47]
    buffer_load_dwordx4 v6, s[32:35], s40 offen lds
    s_mov_b64 exec, -1
    s_add_u32 s40, s40, 128
    s_add_u32 s41, s41, 393216
    s_add_u32 s42, s42, 41984
    s_cmp_eq_u32 s42, 125952
    s_cselect_b32 s42, 0, s42
    s_waitcnt vmcnt(11)
    s_barrier
    s_add_u32 s48, s42, s43
    s_add_u32 s49, s42, s44
    s_add_u32 m0, s48, 0
    s_nop 0
    buffer_load_dwordx4 v2, s[32:35], s40 offen lds
    s_add_u32 m0, s49, 0
    s_nop 0
    buffer_load_dwordx4 v7, s[36:39], s41 offen lds
    s_add_u32 m0, s49, 1024
    s_nop 0
    buffer_load_dwordx4 v8, s[36:39], s41 offen lds
    s_add_u32 m0, s48, 1024
    s_nop 0
    buffer_load_dwordx4 v3, s[32:35], s40 offen lds
    s_add_u32 m0, s49, 8192
    s_nop 0
    buffer_load_dwordx4 v9, s[36:39], s41 offen lds
    s_add_u32 m0, s49, 9216
    s_nop 0
    buffer_load_dwordx4 v10, s[36:39], s41 offen lds
    s_add_u32 m0, s48, 2048
    s_nop 0
    buffer_load_dwordx4 v4, s[32:35], s40 offen lds
    s_add_u32 m0, s49, 16384
    s_nop 0
    buffer_load_dwordx4 v11, s[36:39], s41 offen lds
    s_add_u32 m0, s49, 17408
    s_nop 0
    buffer_load_dwordx4 v12, s[36:39], s41 offen lds
    s_add_u32 m0, s48, 3072
    s_nop 0
    buffer_load_dwordx4 v5, s[32:35], s40 offen lds
    s_add_u32 m0, s42, 16384
    s_mov_b64 exec, s[46:47]
    buffer_load_dwordx4 v6, s[32:35], s40 offen lds
    s_mov_b64 exec, -1
    s_add_u32 s40, s40, 128
    s_add_u32 s41, s41, 393216
    s_add_u32 s42, s42, 41984
    s_cmp_eq_u32 s42, 125952
    s_cselect_b32 s42, 0, s42
    s_waitcnt vmcnt(11)
    s_barrier
    s_add_u32 s48, s42, s43
    s_add_u32 s49, s42, s44
    s_add_u32 m0, s48, 0
    s_nop 0
    buffer_load_dwordx4 v2, s[32:35], s40 offen lds
    s_add_u32 m0, s49, 0
    s_nop 0
    buffer_load_dwordx4 v7, s[36:39], s41 offen lds
    s_add_u32 m0, s49, 1024
    s_nop 0
    buffer_load_dwordx4 v8, s[36:39], s41 offen lds
    s_add_u32 m0, s48, 1024
    s_nop 0
    buffer_load_dwordx4 v3, s[32:35], s40 offen lds
    s_add_u32 m0, s49, 8192
    s_nop 0
    buffer_load_dwordx4 v9, s[36:39], s41 offen lds
    s_add_u32 m0, s49, 9216
    s_nop 0
    buffer_load_dwordx4 v10, s[36:39], s41 offen lds
    s_add_u32 m0, s48, 2048
    s_nop 0
    buffer_load_dwordx4 v4, s[32:35], s40 offen lds
    s_add_u32 m0, s49, 16384
    s_nop 0
    buffer_load_dwordx4 v11, s[36:39], s41 offen lds
    s_add_u32 m0, s49, 17408
    s_nop 0
    buffer_load_dwordx4 v12, s[36:39], s41 offen lds
    s_add_u32 m0, s48, 3072
    s_nop 0
    buffer_load_dwordx4 v5, s[32:35], s40 offen lds
    s_add_u32 m0, s42, 16384
    s_mov_b64 exec, s[46:47]
    buffer_load_dwordx4 v6, s[32:35], s40 offen lds
    s_mov_b64 exec, -1
    s_add_u32 s40, s40, 128
    s_add_u32 s41, s41, 393216
    s_add_u32 s42, s42, 41984
    s_cmp_eq_u32 s42, 125952
    s_cselect_b32 s42, 0, s42
    s_mov_b64 exec, 1
    buffer_load_dword v130, off, s[52:55], s73 sc1
    s_mov_b64 exec, -1
    s_waitcnt vmcnt(12)
    s_barrier
    s_add_u32 s48, s42, s43
    s_add_u32 s49, s42, s44
    s_add_u32 m0, s48, 0
    s_nop 0
    buffer_load_dwordx4 v2, s[32:35], s40 offen lds
    s_add_u32 m0, s49, 0
    s_nop 0
    buffer_load_dwordx4 v7, s[36:39], s41 offen lds
    s_add_u32 m0, s49, 1024
    s_nop 0
    buffer_load_dwordx4 v8, s[36:39], s41 offen lds
    s_add_u32 m0, s48, 1024
    s_nop 0
    buffer_load_dwordx4 v3, s[32:35], s40 offen lds
    s_add_u32 m0, s49, 8192
    s_nop 0
    buffer_load_dwordx4 v9, s[36:39], s41 offen lds
    s_add_u32 m0, s49, 9216
    s_nop 0
    buffer_load_dwordx4 v10, s[36:39], s41 offen lds
    s_add_u32 m0, s48, 2048
    s_nop 0
    buffer_load_dwordx4 v4, s[32:35], s40 offen lds
    s_add_u32 m0, s49, 16384
    s_nop 0
    buffer_load_dwordx4 v11, s[36:39], s41 offen lds
    s_add_u32 m0, s49, 17408
    s_nop 0
    buffer_load_dwordx4 v12, s[36:39], s41 offen lds
    s_add_u32 m0, s48, 3072
    s_nop 0
    buffer_load_dwordx4 v5, s[32:35], s40 offen lds
    s_add_u32 m0, s42, 16384
    s_mov_b64 exec, s[46:47]
    buffer_load_dwordx4 v6, s[32:35], s40 offen lds
    s_mov_b64 exec, -1
    s_add_u32 s40, s40, 128
    s_add_u32 s41, s41, 393216
    s_add_u32 s42, s42, 41984
    s_cmp_eq_u32 s42, 125952
    s_cselect_b32 s42, 0, s42
    s_waitcnt vmcnt(12)
    s_barrier
    s_add_u32 s48, s42, s43
    s_add_u32 s49, s42, s44
    s_add_u32 m0, s48, 0
    s_nop 0
    buffer_load_dwordx4 v2, s[32:35], s40 offen lds
    s_add_u32 m0, s49, 0
    s_nop 0
    buffer_load_dwordx4 v7, s[36:39], s41 offen lds
    s_add_u32 m0, s49, 1024
    s_nop 0
    buffer_load_dwordx4 v8, s[36:39], s41 offen lds
    s_add_u32 m0, s48, 1024
    s_nop 0
    buffer_load_dwordx4 v3, s[32:35], s40 offen lds
    s_add_u32 m0, s49, 8192
    s_nop 0
    buffer_load_dwordx4 v9, s[36:39], s41 offen lds
    s_add_u32 m0, s49, 9216
    s_nop 0
    buffer_load_dwordx4 v10, s[36:39], s41 offen lds
    s_add_u32 m0, s48, 2048
    s_nop 0
    buffer_load_dwordx4 v4, s[32:35], s40 offen lds
    s_add_u32 m0, s49, 16384
    s_nop 0
    buffer_load_dwordx4 v11, s[36:39], s41 offen lds
    s_add_u32 m0, s49, 17408
    s_nop 0
    buffer_load_dwordx4 v12, s[36:39], s41 offen lds
    s_add_u32 m0, s48, 3072
    s_nop 0
    buffer_load_dwordx4 v5, s[32:35], s40 offen lds
    s_add_u32 m0, s42, 16384
    s_mov_b64 exec, s[46:47]
    buffer_load_dwordx4 v6, s[32:35], s40 offen lds
    s_mov_b64 exec, -1
    s_add_u32 s40, s40, 128
    s_add_u32 s41, s41, 393216
    s_add_u32 s42, s42, 41984
    s_cmp_eq_u32 s42, 125952
    s_cselect_b32 s42, 0, s42
    s_waitcnt vmcnt(22)
    s_mov_b64 exec, 1
    s_mov_b32 s75, 131072
L_sg_loop_5:
    v_readfirstlane_b32 s74, v130
    s_nop 0
    s_cmp_ge_u32 s74, 16
    s_cbranch_scc1 L_sg_done_4
    s_sub_u32 s75, s75, 1
    s_cbranch_scc1 L_sg_done_4
    buffer_load_dword v130, off, s[52:55], s73 sc1
    s_waitcnt vmcnt(0)
    s_branch L_sg_loop_5
L_sg_done_4:
    s_mov_b64 exec, -1
    s_lshl_b32 s74, s71, 12
    s_add_u32 s74, s74, 4194304
    s_add_u32 s56, s30, s74
    s_addc_u32 s57, s31, 0
    s_movk_i32 s58, 4096
    s_mov_b32 s59, 0x20000
    buffer_load_dwordx4 v[176:179], v224, s[56:59], 0 offen offset:0 sc1
    buffer_load_dwordx4 v[180:183], v224, s[56:59], 0 offen offset:1024 sc1
    buffer_load_dwordx4 v[184:187], v224, s[56:59], 0 offen offset:2048 sc1
    buffer_load_dwordx4 v[188:191], v224, s[56:59], 0 offen offset:3072 sc1
    buffer_load_dwordx4 v[192:195], v224, s[56:59], 0 offen offset:4 sc1
    buffer_load_dwordx4 v[196:199], v224, s[56:59], 0 offen offset:1028 sc1
    buffer_load_dwordx4 v[200:203], v224, s[56:59], 0 offen offset:2052 sc1
    buffer_load_dwordx4 v[204:207], v224, s[56:59], 0 offen offset:3076 sc1
    s_waitcnt vmcnt(19)
    s_barrier
    s_add_u32 s48, s42, s43
    s_add_u32 s49, s42, s44
    s_add_u32 m0, s48, 0
    s_nop 0
    buffer_load_dwordx4 v2, s[32:35], s40 offen lds
    s_add_u32 m0, s49, 0
    s_nop 0
    buffer_load_dwordx4 v7, s[36:39], s41 offen lds
    s_add_u32 m0, s49, 1024
    s_nop 0
    buffer_load_dwordx4 v8, s[36:39], s41 offen lds
    s_add_u32 m0, s48, 1024
    s_nop 0
    buffer_load_dwordx4 v3, s[32:35], s40 offen lds
    s_add_u32 m0, s49, 8192
    s_nop 0
    buffer_load_dwordx4 v9, s[36:39], s41 offen lds
    s_add_u32 m0, s49, 9216
    s_nop 0
    buffer_load_dwordx4 v10, s[36:39], s41 offen lds
    s_add_u32 m0, s48, 2048
    s_nop 0
    buffer_load_dwordx4 v4, s[32:35], s40 offen lds
    s_add_u32 m0, s49, 16384
    s_nop 0
    buffer_load_dwordx4 v11, s[36:39], s41 offen lds
    s_add_u32 m0, s49, 17408
    s_nop 0
    buffer_load_dwordx4 v12, s[36:39], s41 offen lds
    s_add_u32 m0, s48, 3072
    s_nop 0
    buffer_load_dwordx4 v5, s[32:35], s40 offen lds
    s_add_u32 m0, s42, 16384
    s_mov_b64 exec, s[46:47]
    buffer_load_dwordx4 v6, s[32:35], s40 offen lds
    s_mov_b64 exec, -1
    s_add_u32 s40, s40, 128
    s_add_u32 s41, s41, 393216
    s_add_u32 s42, s42, 41984
    s_cmp_eq_u32 s42, 125952
    s_cselect_b32 s42, 0, s42
    s_lshr_b32 s74, s69, 2
    s_lshl_b32 s74, s74, 9
    s_and_b32 s75, s69, 3
    s_lshl_b32 s75, s75, 6
    s_add_u32 s74, s74, s75
    s_lshl_b32 s75, s70, 3
    s_add_u32 s74, s74, s75
    v_bfe_u32 v227, v0, 3, 1
    v_lshl_add_u32 v225, v227, 8, s74
    v_bfe_u32 v227, v0, 4, 1
    v_lshl_add_u32 v225, v227, 1, v225
    v_lshrrev_b32 v227, 5, v0
    v_lshl_add_u32 v225, v227, 5, v225
    s_lshl_b32 s74, s68, 7
    v_and_b32 v227, 7, v0
    v_lshl_add_u32 v227, v227, 4, s74
    v_lshl_add_u32 v226, v225, 12, v227
    v_lshl_add_u32 v225, v225, 11, v227
    s_mov_b32 s60, s8
    s_mov_b32 s61, s9
    s_mov_b32 s62, 0x400000
    s_mov_b32 s63, 0x20000
    s_movk_i32 s74, 8192
    buffer_load_dwordx4 v[208:211], v225, s[60:63], 0 offen offset:0
    buffer_load_dwordx4 v[212:215], v225, s[60:63], 0 offen offset:2048
    buffer_load_dwordx4 v[216:219], v225, s[60:63], s74 offen offset:0
    buffer_load_dwordx4 v[220:223], v225, s[60:63], s74 offen offset:2048
    s_waitcnt vmcnt(23)
    s_barrier
    s_waitcnt vmcnt(15)
    v_add_u32 v129, s81, v224
    ds_write_b128 v129, v[176:179] offset:0
    ds_write_b128 v129, v[180:183] offset:1024
    ds_write_b128 v129, v[184:187] offset:2048
    ds_write_b128 v129, v[188:191] offset:3072
    ds_write_b128 v129, v[192:195] offset:4576
    ds_write_b128 v129, v[196:199] offset:5600
    ds_write_b128 v129, v[200:203] offset:6624
    ds_write_b128 v129, v[204:207] offset:7648
    s_mov_b64 exec, 0xfffffff
    ds_write_b128 v129, v[228:231] offset:4096
    ds_write_b128 v129, v[228:231] offset:8672
    v_mov_b32 v227, 82944
    s_mov_b64 exec, 1
    ds_write_b128 v227, v[228:231]
    ds_write_b128 v227, v[228:231] offset:16
    s_mov_b64 exec, -1
    s_waitcnt lgkmcnt(0)
    s_waitcnt vmcnt(4)
    s_barrier
    v_and_b32 v234, 1, v0
    v_xor_b32 v234, 1, v234
    v_mul_u32_u24 v232, 4224, v234
    v_mul_u32_u24 v233, 4576, v234
    v_bfe_u32 v234, v0, 1, 3
    v_lshl_add_u32 v232, v234, 3, v232
    v_xor_b32 v234, 7, v234
    v_lshl_add_u32 v233, v234, 6, v233
    v_lshlrev_b32 v235, 6, v234
    v_lshrrev_b32 v234, 4, v0
    v_lshl_add_u32 v232, v234, 4, v232
    v_lshl_add_u32 v233, v234, 4, v233
    s_add_u32 s74, s80, 8
    v_add_u32 v232, s74, v232
    v_add_u32 v233, s81, v233
    v_xor_b32 v234, 3, v234
    v_lshl_add_u32 v235, v234, 4, v235
    v_and_b32 v234, 1, v0
    v_xor_b32 v234, 1, v234
    v_lshl_add_u32 v235, v234, 2, v235
    v_add_u32 v235, s81, v235
    s_waitcnt lgkmcnt(0)
    ds_read_b32 v176, v235 offset:3592
    ds_read_b32 v177, v235 offset:3584
    ds_read_b32 v178, v235 offset:3080
    ds_read_b32 v179, v235 offset:3072
    ds_read_b32 v180, v235 offset:2568
    ds_read_b32 v181, v235 offset:2560
    ds_read_b32 v182, v235 offset:2056
    ds_read_b32 v183, v235 offset:2048
    ds_read_b32 v184, v235 offset:1544
    ds_read_b32 v185, v235 offset:1536
    ds_read_b32 v186, v235 offset:1032
    ds_read_b32 v187, v235 offset:1024
    ds_read_b32 v188, v235 offset:520
    ds_read_b32 v189, v235 offset:512
    ds_read_b32 v190, v235 offset:8
    ds_read_b32 v191, v235 offset:0
    s_bitcmp1_b32 s71, 0
    s_cselect_b32 s74, 0, 16
    s_lshl_b32 s72, s72, s74
    s_and_b32 s72, s72, 0xffff0000
    s_waitcnt lgkmcnt(0)
    ds_read_b128 v[112:115], v233 offset:3584
    ds_read_b64 v[48:49], v232 offset:0
    ds_read_b64 v[50:51], v232 offset:8
    ds_read_b128 v[116:119], v233 offset:3072
    ds_read_b64 v[52:53], v232 offset:512
    ds_read_b64 v[54:55], v232 offset:520
    ds_read_b128 v[120:123], v233 offset:2560
    ds_read_b64 v[56:57], v232 offset:1024
    ds_read_b64 v[58:59], v232 offset:1032
    ds_read_b128 v[124:127], v233 offset:2048
    ds_read_b64 v[60:61], v232 offset:1536
    ds_read_b64 v[62:63], v232 offset:1544
    ds_read_b128 v[128:131], v233 offset:1536
    ds_read_b64 v[64:65], v232 offset:2048
    ds_read_b64 v[66:67], v232 offset:2056
    ds_read_b128 v[132:135], v233 offset:1024
    ds_read_b64 v[68:69], v232 offset:2560
    ds_read_b64 v[70:71], v232 offset:2568
    ds_read_b128 v[136:139], v233 offset:512
    ds_read_b64 v[72:73], v232 offset:3072
    ds_read_b64 v[74:75], v232 offset:3080
    ds_read_b128 v[140:143], v233 offset:0
    ds_read_b64 v[76:77], v232 offset:3584
    ds_read_b64 v[78:79], v232 offset:3592
    v_lshlrev_b32 v17, 16, v176
    v_and_b32 v16, 0xffff0000, v176
    v_lshlrev_b32 v19, 16, v177
    v_and_b32 v18, 0xffff0000, v177
    v_mul_f32 v16, s72, v16
    v_mul_f32 v17, s72, v17
    v_mul_f32 v18, s72, v18
    v_mul_f32 v19, s72, v19
    v_lshlrev_b32 v21, 16, v178
    v_and_b32 v20, 0xffff0000, v178
    v_lshlrev_b32 v23, 16, v179
    v_and_b32 v22, 0xffff0000, v179
    v_mul_f32 v20, s72, v20
    v_mul_f32 v21, s72, v21
    v_mul_f32 v22, s72, v22
    v_mul_f32 v23, s72, v23
    v_lshlrev_b32 v25, 16, v180
    v_and_b32 v24, 0xffff0000, v180
    v_lshlrev_b32 v27, 16, v181
    v_and_b32 v26, 0xffff0000, v181
    v_mul_f32 v24, s72, v24
    v_mul_f32 v25, s72, v25
    v_mul_f32 v26, s72, v26
    v_mul_f32 v27, s72, v27
    v_lshlrev_b32 v29, 16, v182
    v_and_b32 v28, 0xffff0000, v182
    v_lshlrev_b32 v31, 16, v183
    v_and_b32 v30, 0xffff0000, v183
    v_mul_f32 v28, s72, v28
    v_mul_f32 v29, s72, v29
    v_mul_f32 v30, s72, v30
    v_mul_f32 v31, s72, v31
    v_lshlrev_b32 v33, 16, v184
    v_and_b32 v32, 0xffff0000, v184
    v_lshlrev_b32 v35, 16, v185
    v_and_b32 v34, 0xffff0000, v185
    v_mul_f32 v32, s72, v32
    v_mul_f32 v33, s72, v33
    v_mul_f32 v34, s72, v34
    v_mul_f32 v35, s72, v35
    v_lshlrev_b32 v37, 16, v186
    v_and_b32 v36, 0xffff0000, v186
    v_lshlrev_b32 v39, 16, v187
    v_and_b32 v38, 0xffff0000, v187
    v_mul_f32 v36, s72, v36
    v_mul_f32 v37, s72, v37
    v_mul_f32 v38, s72, v38
    v_mul_f32 v39, s72, v39
    v_lshlrev_b32 v41, 16, v188
    v_and_b32 v40, 0xffff0000, v188
    v_lshlrev_b32 v43, 16, v189
    v_and_b32 v42, 0xffff0000, v189
    v_mul_f32 v40, s72, v40
    v_mul_f32 v41, s72, v41
    v_mul_f32 v42, s72, v42
    v_mul_f32 v43, s72, v43
    v_lshlrev_b32 v45, 16, v190
    v_and_b32 v44, 0xffff0000, v190
    v_lshlrev_b32 v47, 16, v191
    v_and_b32 v46, 0xffff0000, v191
    v_mul_f32 v44, s72, v44
    v_mul_f32 v45, s72, v45
    v_mul_f32 v46, s72, v46
    v_mul_f32 v47, s72, v47
    s_waitcnt lgkmcnt(0)
    s_barrier
    s_mov_b32 s74, 3
L_conv:
    v_mfma_f32_16x16x32_bf16 v[16:19], v[48:51], v[112:115], v[16:19]
    ds_read_b128 v[144:147], v233 offset:3648
    v_mfma_f32_16x16x32_bf16 v[20:23], v[48:51], v[116:119], v[20:23]
    ds_read_b64 v[80:81], v232 offset:64
    v_mfma_f32_16x16x32_bf16 v[20:23], v[52:55], v[112:115], v[20:23]
    ds_read_b64 v[82:83], v232 offset:72
    v_mfma_f32_16x16x32_bf16 v[24:27], v[48:51], v[120:123], v[24:27]
    ds_read_b128 v[148:151], v233 offset:3136
    v_mfma_f32_16x16x32_bf16 v[24:27], v[52:55], v[116:119], v[24:27]
    ds_read_b64 v[84:85], v232 offset:576
    v_mfma_f32_16x16x32_bf16 v[24:27], v[56:59], v[112:115], v[24:27]
    ds_read_b64 v[86:87], v232 offset:584
    v_mfma_f32_16x16x32_bf16 v[28:31], v[48:51], v[124:127], v[28:31]
    ds_read_b128 v[152:155], v233 offset:2624
    v_mfma_f32_16x16x32_bf16 v[28:31], v[52:55], v[120:123], v[28:31]
    ds_read_b64 v[88:89], v232 offset:1088
    v_mfma_f32_16x16x32_bf16 v[28:31], v[56:59], v[116:119], v[28:31]
    ds_read_b64 v[90:91], v232 offset:1096
    v_mfma_f32_16x16x32_bf16 v[28:31], v[60:63], v[112:115], v[28:31]
    ds_read_b128 v[156:159], v233 offset:2112
    v_mfma_f32_16x16x32_bf16 v[32:35], v[48:51], v[128:131], v[32:35]
    ds_read_b64 v[92:93], v232 offset:1600
    v_mfma_f32_16x16x32_bf16 v[32:35], v[52:55], v[124:127], v[32:35]
    ds_read_b64 v[94:95], v232 offset:1608
    v_mfma_f32_16x16x32_bf16 v[32:35], v[56:59], v[120:123], v[32:35]
    ds_read_b128 v[160:163], v233 offset:1600
    v_mfma_f32_16x16x32_bf16 v[32:35], v[60:63], v[116:119], v[32:35]
    ds_read_b64 v[96:97], v232 offset:2112
    v_mfma_f32_16x16x32_bf16 v[32:35], v[64:67], v[112:115], v[32:35]
    ds_read_b64 v[98:99], v232 offset:2120
    v_mfma_f32_16x16x32_bf16 v[36:39], v[48:51], v[132:135], v[36:39]
    ds_read_b128 v[164:167], v233 offset:1088
    v_mfma_f32_16x16x32_bf16 v[36:39], v[52:55], v[128:131], v[36:39]
    ds_read_b64 v[100:101], v232 offset:2624
    v_mfma_f32_16x16x32_bf16 v[36:39], v[56:59], v[124:127], v[36:39]
    ds_read_b64 v[102:103], v232 offset:2632
    v_mfma_f32_16x16x32_bf16 v[36:39], v[60:63], v[120:123], v[36:39]
    ds_read_b128 v[168:171], v233 offset:576
    v_mfma_f32_16x16x32_bf16 v[36:39], v[64:67], v[116:119], v[36:39]
    ds_read_b64 v[104:105], v232 offset:3136
    v_mfma_f32_16x16x32_bf16 v[36:39], v[68:71], v[112:115], v[36:39]
    ds_read_b64 v[106:107], v232 offset:3144
    v_mfma_f32_16x16x32_bf16 v[40:43], v[48:51], v[136:139], v[40:43]
    ds_read_b128 v[172:175], v233 offset:64
    v_mfma_f32_16x16x32_bf16 v[40:43], v[52:55], v[132:135], v[40:43]
    ds_read_b64 v[108:109], v232 offset:3648
    v_mfma_f32_16x16x32_bf16 v[40:43], v[56:59], v[128:131], v[40:43]
    ds_read_b64 v[110:111], v232 offset:3656
    v_mfma_f32_16x16x32_bf16 v[40:43], v[60:63], v[124:127], v[40:43]
    v_mfma_f32_16x16x32_bf16 v[40:43], v[64:67], v[120:123], v[40:43]
    v_mfma_f32_16x16x32_bf16 v[40:43], v[68:71], v[116:119], v[40:43]
    v_mfma_f32_16x16x32_bf16 v[40:43], v[72:75], v[112:115], v[40:43]
    v_mfma_f32_16x16x32_bf16 v[44:47], v[48:51], v[140:143], v[44:47]
    v_mfma_f32_16x16x32_bf16 v[44:47], v[52:55], v[136:139], v[44:47]
    v_mfma_f32_16x16x32_bf16 v[44:47], v[56:59], v[132:135], v[44:47]
    v_mfma_f32_16x16x32_bf16 v[44:47], v[60:63], v[128:131], v[44:47]
    v_mfma_f32_16x16x32_bf16 v[44:47], v[64:67], v[124:127], v[44:47]
    v_mfma_f32_16x16x32_bf16 v[44:47], v[68:71], v[120:123], v[44:47]
    v_mfma_f32_16x16x32_bf16 v[44:47], v[72:75], v[116:119], v[44:47]
    v_mfma_f32_16x16x32_bf16 v[44:47], v[76:79], v[112:115], v[44:47]
    s_waitcnt lgkmcnt(0)
    v_mfma_f32_16x16x32_bf16 v[16:19], v[80:83], v[144:147], v[16:19]
    ds_read_b128 v[112:115], v233 offset:3712
    v_mfma_f32_16x16x32_bf16 v[20:23], v[80:83], v[148:151], v[20:23]
    ds_read_b64 v[48:49], v232 offset:128
    v_mfma_f32_16x16x32_bf16 v[20:23], v[84:87], v[144:147], v[20:23]
    ds_read_b64 v[50:51], v232 offset:136
    v_mfma_f32_16x16x32_bf16 v[24:27], v[80:83], v[152:155], v[24:27]
    ds_read_b128 v[116:119], v233 offset:3200
    v_mfma_f32_16x16x32_bf16 v[24:27], v[84:87], v[148:151], v[24:27]
    ds_read_b64 v[52:53], v232 offset:640
    v_mfma_f32_16x16x32_bf16 v[24:27], v[88:91], v[144:147], v[24:27]
    ds_read_b64 v[54:55], v232 offset:648
    v_mfma_f32_16x16x32_bf16 v[28:31], v[80:83], v[156:159], v[28:31]
    ds_read_b128 v[120:123], v233 offset:2688
    v_mfma_f32_16x16x32_bf16 v[28:31], v[84:87], v[152:155], v[28:31]
    ds_read_b64 v[56:57], v232 offset:1152
    v_mfma_f32_16x16x32_bf16 v[28:31], v[88:91], v[148:151], v[28:31]
    ds_read_b64 v[58:59], v232 offset:1160
    v_mfma_f32_16x16x32_bf16 v[28:31], v[92:95], v[144:147], v[28:31]
    ds_read_b128 v[124:127], v233 offset:2176
    v_mfma_f32_16x16x32_bf16 v[32:35], v[80:83], v[160:163], v[32:35]
    ds_read_b64 v[60:61], v232 offset:1664
    v_mfma_f32_16x16x32_bf16 v[32:35], v[84:87], v[156:159], v[32:35]
    ds_read_b64 v[62:63], v232 offset:1672
    v_mfma_f32_16x16x32_bf16 v[32:35], v[88:91], v[152:155], v[32:35]
    ds_read_b128 v[128:131], v233 offset:1664
    v_mfma_f32_16x16x32_bf16 v[32:35], v[92:95], v[148:151], v[32:35]
    ds_read_b64 v[64:65], v232 offset:2176
    v_mfma_f32_16x16x32_bf16 v[32:35], v[96:99], v[144:147], v[32:35]
    ds_read_b64 v[66:67], v232 offset:2184
    v_mfma_f32_16x16x32_bf16 v[36:39], v[80:83], v[164:167], v[36:39]
    ds_read_b128 v[132:135], v233 offset:1152
    v_mfma_f32_16x16x32_bf16 v[36:39], v[84:87], v[160:163], v[36:39]
    ds_read_b64 v[68:69], v232 offset:2688
    v_mfma_f32_16x16x32_bf16 v[36:39], v[88:91], v[156:159], v[36:39]
    ds_read_b64 v[70:71], v232 offset:2696
    v_mfma_f32_16x16x32_bf16 v[36:39], v[92:95], v[152:155], v[36:39]
    ds_read_b128 v[136:139], v233 offset:640
    v_mfma_f32_16x16x32_bf16 v[36:39], v[96:99], v[148:151], v[36:39]
    ds_read_b64 v[72:73], v232 offset:3200
    v_mfma_f32_16x16x32_bf16 v[36:39], v[100:103], v[144:147], v[36:39]
    ds_read_b64 v[74:75], v232 offset:3208
    v_mfma_f32_16x16x32_bf16 v[40:43], v[80:83], v[168:171], v[40:43]
    ds_read_b128 v[140:143], v233 offset:128
    v_mfma_f32_16x16x32_bf16 v[40:43], v[84:87], v[164:167], v[40:43]
    ds_read_b64 v[76:77], v232 offset:3712
    v_mfma_f32_16x16x32_bf16 v[40:43], v[88:91], v[160:163], v[40:43]
    ds_read_b64 v[78:79], v232 offset:3720
    v_mfma_f32_16x16x32_bf16 v[40:43], v[92:95], v[156:159], v[40:43]
    v_add_u32 v232, 128, v232
    v_mfma_f32_16x16x32_bf16 v[40:43], v[96:99], v[152:155], v[40:43]
    v_add_u32 v233, 128, v233
    v_mfma_f32_16x16x32_bf16 v[40:43], v[100:103], v[148:151], v[40:43]
    s_sub_u32 s74, s74, 1
    v_mfma_f32_16x16x32_bf16 v[40:43], v[104:107], v[144:147], v[40:43]
    s_cmp_lg_u32 s74, 0
    v_mfma_f32_16x16x32_bf16 v[44:47], v[80:83], v[172:175], v[44:47]
    v_mfma_f32_16x16x32_bf16 v[44:47], v[84:87], v[168:171], v[44:47]
    v_mfma_f32_16x16x32_bf16 v[44:47], v[88:91], v[164:167], v[44:47]
    v_mfma_f32_16x16x32_bf16 v[44:47], v[92:95], v[160:163], v[44:47]
    v_mfma_f32_16x16x32_bf16 v[44:47], v[96:99], v[156:159], v[44:47]
    v_mfma_f32_16x16x32_bf16 v[44:47], v[100:103], v[152:155], v[44:47]
    v_mfma_f32_16x16x32_bf16 v[44:47], v[104:107], v[148:151], v[44:47]
    v_mfma_f32_16x16x32_bf16 v[44:47], v[108:111], v[144:147], v[44:47]
    s_waitcnt lgkmcnt(0)
    s_cbranch_scc1 L_conv
    v_mfma_f32_16x16x32_bf16 v[16:19], v[48:51], v[112:115], v[16:19]
    ds_read_b128 v[144:147], v233 offset:3648
    v_mfma_f32_16x16x32_bf16 v[20:23], v[48:51], v[116:119], v[20:23]
    ds_read_b64 v[80:81], v232 offset:64
    v_mfma_f32_16x16x32_bf16 v[20:23], v[52:55], v[112:115], v[20:23]
    ds_read_b64 v[82:83], v232 offset:72
    v_mfma_f32_16x16x32_bf16 v[24:27], v[48:51], v[120:123], v[24:27]
    ds_read_b128 v[148:151], v233 offset:3136
    v_mfma_f32_16x16x32_bf16 v[24:27], v[52:55], v[116:119], v[24:27]
    ds_read_b64 v[84:85], v232 offset:576
    v_mfma_f32_16x16x32_bf16 v[24:27], v[56:59], v[112:115], v[24:27]
    ds_read_b64 v[86:87], v232 offset:584
    v_mfma_f32_16x16x32_bf16 v[28:31], v[48:51], v[124:127], v[28:31]
    ds_read_b128 v[152:155], v233 offset:2624
    v_mfma_f32_16x16x32_bf16 v[28:31], v[52:55], v[120:123], v[28:31]
    ds_read_b64 v[88:89], v232 offset:1088
    v_mfma_f32_16x16x32_bf16 v[28:31], v[56:59], v[116:119], v[28:31]
    ds_read_b64 v[90:91], v232 offset:1096
    v_mfma_f32_16x16x32_bf16 v[28:31], v[60:63], v[112:115], v[28:31]
    ds_read_b128 v[156:159], v233 offset:2112
    v_mfma_f32_16x16x32_bf16 v[32:35], v[48:51], v[128:131], v[32:35]
    ds_read_b64 v[92:93], v232 offset:1600
    v_mfma_f32_16x16x32_bf16 v[32:35], v[52:55], v[124:127], v[32:35]
    ds_read_b64 v[94:95], v232 offset:1608
    v_mfma_f32_16x16x32_bf16 v[32:35], v[56:59], v[120:123], v[32:35]
    ds_read_b128 v[160:163], v233 offset:1600
    v_mfma_f32_16x16x32_bf16 v[32:35], v[60:63], v[116:119], v[32:35]
    ds_read_b64 v[96:97], v232 offset:2112
    v_mfma_f32_16x16x32_bf16 v[32:35], v[64:67], v[112:115], v[32:35]
    ds_read_b64 v[98:99], v232 offset:2120
    v_mfma_f32_16x16x32_bf16 v[36:39], v[48:51], v[132:135], v[36:39]
    ds_read_b128 v[164:167], v233 offset:1088
    v_mfma_f32_16x16x32_bf16 v[36:39], v[52:55], v[128:131], v[36:39]
    ds_read_b64 v[100:101], v232 offset:2624
    v_mfma_f32_16x16x32_bf16 v[36:39], v[56:59], v[124:127], v[36:39]
    ds_read_b64 v[102:103], v232 offset:2632
    v_mfma_f32_16x16x32_bf16 v[36:39], v[60:63], v[120:123], v[36:39]
    ds_read_b128 v[168:171], v233 offset:576
    v_mfma_f32_16x16x32_bf16 v[36:39], v[64:67], v[116:119], v[36:39]
    ds_read_b64 v[104:105], v232 offset:3136
    v_mfma_f32_16x16x32_bf16 v[36:39], v[68:71], v[112:115], v[36:39]
    ds_read_b64 v[106:107], v232 offset:3144
    v_mfma_f32_16x16x32_bf16 v[40:43], v[48:51], v[136:139], v[40:43]
    ds_read_b128 v[172:175], v233 offset:64
    v_mfma_f32_16x16x32_bf16 v[40:43], v[52:55], v[132:135], v[40:43]
    ds_read_b64 v[108:109], v232 offset:3648
    v_mfma_f32_16x16x32_bf16 v[40:43], v[56:59], v[128:131], v[40:43]
    ds_read_b64 v[110:111], v232 offset:3656
    v_mfma_f32_16x16x32_bf16 v[40:43], v[60:63], v[124:127], v[40:43]
    v_mfma_f32_16x16x32_bf16 v[40:43], v[64:67], v[120:123], v[40:43]
    v_mfma_f32_16x16x32_bf16 v[40:43], v[68:71], v[116:119], v[40:43]
    v_mfma_f32_16x16x32_bf16 v[40:43], v[72:75], v[112:115], v[40:43]
    v_mfma_f32_16x16x32_bf16 v[44:47], v[48:51], v[140:143], v[44:47]
    v_mfma_f32_16x16x32_bf16 v[44:47], v[52:55], v[136:139], v[44:47]
    v_mfma_f32_16x16x32_bf16 v[44:47], v[56:59], v[132:135], v[44:47]
    v_mfma_f32_16x16x32_bf16 v[44:47], v[60:63], v[128:131], v[44:47]
    v_mfma_f32_16x16x32_bf16 v[44:47], v[64:67], v[124:127], v[44:47]
    v_mfma_f32_16x16x32_bf16 v[44:47], v[68:71], v[120:123], v[44:47]
    v_mfma_f32_16x16x32_bf16 v[44:47], v[72:75], v[116:119], v[44:47]
    v_mfma_f32_16x16x32_bf16 v[44:47], v[76:79], v[112:115], v[44:47]
    s_waitcnt lgkmcnt(0)
    v_mfma_f32_16x16x32_bf16 v[16:19], v[80:83], v[144:147], v[16:19]
    s_lshl_b32 s74, s68, 18
    v_mfma_f32_16x16x32_bf16 v[20:23], v[80:83], v[148:151], v[20:23]
    s_and_b32 s75, s71, 63
    v_mfma_f32_16x16x32_bf16 v[20:23], v[84:87], v[144:147], v[20:23]
    s_lshl_b32 s75, s75, 6
    v_mfma_f32_16x16x32_bf16 v[24:27], v[80:83], v[152:155], v[24:27]
    s_add_u32 s74, s74, s75
    v_mfma_f32_16x16x32_bf16 v[24:27], v[84:87], v[148:151], v[24:27]
    s_add_u32 s74, s74, 8388608
    v_mfma_f32_16x16x32_bf16 v[24:27], v[88:91], v[144:147], v[24:27]
    v_and_b32 v234, 3, v0
    v_mfma_f32_16x16x32_bf16 v[28:31], v[80:83], v[156:159], v[28:31]
    v_lshl_add_u32 v234, v234, 4, s74
    v_mfma_f32_16x16x32_bf16 v[28:31], v[84:87], v[152:155], v[28:31]
    v_bfe_u32 v235, v0, 2, 2
    v_mfma_f32_16x16x32_bf16 v[28:31], v[88:91], v[148:151], v[28:31]
    v_lshl_add_u32 v234, v235, 14, v234
    v_mfma_f32_16x16x32_bf16 v[28:31], v[92:95], v[144:147], v[28:31]
    v_lshrrev_b32 v235, 4, v0
    v_mfma_f32_16x16x32_bf16 v[32:35], v[80:83], v[160:163], v[32:35]
    v_lshl_add_u32 v234, v235, 12, v234
    v_mfma_f32_16x16x32_bf16 v[32:35], v[84:87], v[156:159], v[32:35]
    s_and_b32 s75, s2, 3
    v_mfma_f32_16x16x32_bf16 v[32:35], v[88:91], v[152:155], v[32:35]
    s_lshl_b32 s75, s75, 2
    v_mfma_f32_16x16x32_bf16 v[32:35], v[92:95], v[148:151], v[32:35]
    s_bfe_u32 s74, s2, 0x20003
    v_mfma_f32_16x16x32_bf16 v[32:35], v[96:99], v[144:147], v[32:35]
    s_add_u32 s75, s75, s74
    v_mfma_f32_16x16x32_bf16 v[36:39], v[80:83], v[164:167], v[36:39]
    s_bfe_u32 s86, s2, 0x10002
    v_mfma_f32_16x16x32_bf16 v[36:39], v[84:87], v[160:163], v[36:39]
    s_lshl_b32 s86, s86, 3
    v_mfma_f32_16x16x32_bf16 v[36:39], v[88:91], v[156:159], v[36:39]
    s_lshr_b32 s74, s2, 5
    v_mfma_f32_16x16x32_bf16 v[36:39], v[92:95], v[152:155], v[36:39]
    s_add_u32 s86, s86, s74
    v_mfma_f32_16x16x32_bf16 v[36:39], v[96:99], v[148:151], v[36:39]
    v_lshrrev_b32 v236, 4, v0
    v_mfma_f32_16x16x32_bf16 v[36:39], v[100:103], v[144:147], v[36:39]
    v_lshlrev_b32 v236, 1, v236
    v_mfma_f32_16x16x32_bf16 v[40:43], v[80:83], v[168:171], v[40:43]
    v_xor_b32 v236, v0, v236
    v_mfma_f32_16x16x32_bf16 v[40:43], v[84:87], v[164:167], v[40:43]
    v_and_b32 v236, 7, v236
    v_mfma_f32_16x16x32_bf16 v[40:43], v[88:91], v[160:163], v[40:43]
    s_lshl_b32 s74, s86, 7
    v_mfma_f32_16x16x32_bf16 v[40:43], v[92:95], v[156:159], v[40:43]
    v_lshl_add_u32 v236, v236, 4, s74
    v_mfma_f32_16x16x32_bf16 v[40:43], v[96:99], v[152:155], v[40:43]
    v_lshrrev_b32 v235, 3, v0
    v_mfma_f32_16x16x32_bf16 v[40:43], v[100:103], v[148:151], v[40:43]
    v_lshl_add_u32 v235, v235, 11, v236
    v_mfma_f32_16x16x32_bf16 v[40:43], v[104:107], v[144:147], v[40:43]
    s_mov_b32 s56, s24
    v_mfma_f32_16x16x32_bf16 v[44:47], v[80:83], v[172:175], v[44:47]
    s_mov_b32 s57, s25
    v_mfma_f32_16x16x32_bf16 v[44:47], v[84:87], v[168:171], v[44:47]
    s_mov_b32 s58, 0x200000
    v_mfma_f32_16x16x32_bf16 v[44:47], v[88:91], v[164:167], v[44:47]
    s_mov_b32 s59, 0x20000
    v_mfma_f32_16x16x32_bf16 v[44:47], v[92:95], v[160:163], v[44:47]
    s_lshl_b32 s82, s3, 18
    v_mfma_f32_16x16x32_bf16 v[44:47], v[96:99], v[156:159], v[44:47]
    s_add_u32 s73, s68, 32
    v_mfma_f32_16x16x32_bf16 v[44:47], v[100:103], v[152:155], v[44:47]
    s_lshl_b32 s73, s73, 8
    v_mfma_f32_16x16x32_bf16 v[44:47], v[104:107], v[148:151], v[44:47]
    v_mfma_f32_16x16x32_bf16 v[44:47], v[108:111], v[144:147], v[44:47]
    v_cvt_pk_bf16_f32 v48, v16, v17
    v_cvt_pk_bf16_f32 v49, v18, v19
    v_cvt_pk_bf16_f32 v50, v20, v21
    v_cvt_pk_bf16_f32 v51, v22, v23
    v_cvt_pk_bf16_f32 v52, v24, v25
    v_cvt_pk_bf16_f32 v53, v26, v27
    v_cvt_pk_bf16_f32 v54, v28, v29
    v_cvt_pk_bf16_f32 v55, v30, v31
    v_cvt_pk_bf16_f32 v56, v32, v33
    v_cvt_pk_bf16_f32 v57, v34, v35
    v_cvt_pk_bf16_f32 v58, v36, v37
    v_cvt_pk_bf16_f32 v59, v38, v39
    v_cvt_pk_bf16_f32 v60, v40, v41
    v_cvt_pk_bf16_f32 v61, v42, v43
    v_cvt_pk_bf16_f32 v62, v44, v45
    v_cvt_pk_bf16_f32 v63, v46, v47
    s_mov_b32 s74, 0
    buffer_store_dwordx4 v[48:51], v234, s[64:67], s74 offen sc1
    s_mov_b32 s74, 65536
    buffer_store_dwordx4 v[52:55], v234, s[64:67], s74 offen sc1
    s_mov_b32 s74, 131072
    buffer_store_dwordx4 v[56:59], v234, s[64:67], s74 offen sc1
    s_mov_b32 s74, 196608
    buffer_store_dwordx4 v[60:63], v234, s[64:67], s74 offen sc1
    s_add_u32 m0, s80, 0
    s_add_u32 s83, s82, 0
    buffer_load_dwordx4 v235, s[56:59], s83 offen lds
    s_add_u32 m0, s80, 1024
    s_add_u32 s83, s82, 16384
    buffer_load_dwordx4 v235, s[56:59], s83 offen lds
    s_add_u32 m0, s80, 2048
    s_add_u32 s83, s82, 32768
    buffer_load_dwordx4 v235, s[56:59], s83 offen lds
    s_add_u32 m0, s80, 3072
    s_add_u32 s83, s82, 49152
    buffer_load_dwordx4 v235, s[56:59], s83 offen lds
    s_add_u32 m0, s80, 4096
    s_add_u32 s83, s82, 65536
    buffer_load_dwordx4 v235, s[56:59], s83 offen lds
    s_add_u32 m0, s80, 5120
    s_add_u32 s83, s82, 81920
    buffer_load_dwordx4 v235, s[56:59], s83 offen lds
    s_add_u32 m0, s80, 6144
    s_add_u32 s83, s82, 98304
    buffer_load_dwordx4 v235, s[56:59], s83 offen lds
    s_add_u32 m0, s80, 7168
    s_add_u32 s83, s82, 114688
    buffer_load_dwordx4 v235, s[56:59], s83 offen lds
    s_add_u32 m0, s81, 0
    s_add_u32 s83, s82, 131072
    buffer_load_dwordx4 v235, s[56:59], s83 offen lds
    s_add_u32 m0, s81, 1024
    s_add_u32 s83, s82, 147456
    buffer_load_dwordx4 v235, s[56:59], s83 offen lds
    s_add_u32 m0, s81, 2048
    s_add_u32 s83, s82, 163840
    buffer_load_dwordx4 v235, s[56:59], s83 offen lds
    s_add_u32 m0, s81, 3072
    s_add_u32 s83, s82, 180224
    buffer_load_dwordx4 v235, s[56:59], s83 offen lds
    s_add_u32 m0, s81, 4096
    s_add_u32 s83, s82, 196608
    buffer_load_dwordx4 v235, s[56:59], s83 offen lds
    s_add_u32 m0, s81, 5120
    s_add_u32 s83, s82, 212992
    buffer_load_dwordx4 v235, s[56:59], s83 offen lds
    s_add_u32 m0, s81, 6144
    s_add_u32 s83, s82, 229376
    buffer_load_dwordx4 v235, s[56:59], s83 offen lds
    s_add_u32 m0, s81, 7168
    s_add_u32 s83, s82, 245760
    buffer_load_dwordx4 v235, s[56:59], s83 offen lds
    s_waitcnt vmcnt(16)
    v_mov_b32 v238, 1
    s_mov_b64 exec, 1
    ds_add_rtn_u32 v237, v227, v238 offset:8
    s_waitcnt lgkmcnt(0)
    v_readfirstlane_b32 s76, v237
    s_nop 0
    s_cmp_eq_u32 s76, 3
    s_cbranch_scc0 L_jo_6a
    buffer_atomic_add v238, off, s[52:55], s73 sc1
L_jo_6a:
    s_mov_b64 exec, -1
    v_lshlrev_b32 v112, 16, v208
    v_and_b32 v113, 0xffff0000, v208
    v_lshlrev_b32 v114, 16, v209
    v_and_b32 v115, 0xffff0000, v209
    v_lshlrev_b32 v116, 16, v210
    v_and_b32 v117, 0xffff0000, v210
    v_lshlrev_b32 v118, 16, v211
    v_and_b32 v119, 0xffff0000, v211
    v_lshlrev_b32 v120, 16, v212
    v_and_b32 v121, 0xffff0000, v212
    v_lshlrev_b32 v122, 16, v213
    v_and_b32 v123, 0xffff0000, v213
    v_lshlrev_b32 v124, 16, v214
    v_and_b32 v125, 0xffff0000, v214
    v_lshlrev_b32 v126, 16, v215
    v_and_b32 v127, 0xffff0000, v215
    v_lshlrev_b32 v128, 16, v216
    v_and_b32 v129, 0xffff0000, v216
    v_lshlrev_b32 v130, 16, v217
    v_and_b32 v131, 0xffff0000, v217
    v_lshlrev_b32 v132, 16, v218
    v_and_b32 v133, 0xffff0000, v218
    v_lshlrev_b32 v134, 16, v219
    v_and_b32 v135, 0xffff0000, v219
    v_lshlrev_b32 v136, 16, v220
    v_and_b32 v137, 0xffff0000, v220
    v_lshlrev_b32 v138, 16, v221
    v_and_b32 v139, 0xffff0000, v221
    v_lshlrev_b32 v140, 16, v222
    v_and_b32 v141, 0xffff0000, v222
    v_lshlrev_b32 v142, 16, v223
    v_and_b32 v143, 0xffff0000, v223
    s_mul_i32 s77, s70, 4352
    s_add_u32 s77, s77, 83968
    v_lshrrev_b32 v234, 5, v0
    v_lshl_add_u32 v234, v234, 1, v0
    v_lshl_add_u32 v234, v234, 4, s77
    v_and_b32 v235, 7, v0
    v_mul_u32_u24 v235, 544, v235
    v_lshrrev_b32 v236, 3, v0
    v_lshl_add_u32 v235, v236, 3, v235
    v_add_u32 v235, s77, v235
    s_lshl_b32 s77, s68, 4
    s_add_u32 s77, s77, s69
    s_lshl_b32 s77, s77, 2
    s_add_u32 s77, s77, s70
    s_lshl_b32 s77, s77, 12
    s_add_u32 s77, s77, 8388608
    s_mov_b32 s60, s26
    s_mov_b32 s61, s27
    s_mov_b32 s62, 0x800000
    s_mov_b32 s63, 0x20000
    s_waitcnt vmcnt(0)
    s_mov_b64 exec, 1
    ds_add_u32 v227, v238 offset:12
    s_mov_b64 exec, 1
    s_cmp_eq_u32 s76, 3
    s_cbranch_scc0 L_jo_6
    v_mov_b32 v237, 0
    s_mov_b32 s75, 131072
L_sg_loop_9:
    v_readfirstlane_b32 s74, v237
    s_nop 0
    s_cmp_ge_u32 s74, 16
    s_cbranch_scc1 L_sg_done_8
    s_sub_u32 s75, s75, 1
    s_cbranch_scc1 L_sg_done_8
    buffer_load_dword v237, off, s[52:55], s73 sc1
    s_waitcnt vmcnt(0)
    s_branch L_sg_loop_9
L_sg_done_8:
    ds_write_b32 v227, v238 offset:16
    s_branch L_jd_7
L_jo_6:
    s_mov_b32 s75, 1048576
L_sl_loop_11:
    ds_read_b32 v237, v227 offset:16
    s_waitcnt lgkmcnt(0)
    v_readfirstlane_b32 s74, v237
    s_nop 0
    s_cmp_ge_u32 s74, 1
    s_cbranch_scc1 L_sl_done_10
    s_sleep 1
    s_sub_u32 s75, s75, 1
    s_cbranch_scc0 L_sl_loop_11
L_sl_done_10:
L_jd_7:
    s_mov_b64 exec, -1
    buffer_load_dwordx4 v[48:51], v224, s[64:67], s77 offen offset:0 sc1
    buffer_load_dwordx4 v[52:55], v224, s[64:67], s77 offen offset:1024 sc1
    buffer_load_dwordx4 v[56:59], v224, s[64:67], s77 offen offset:2048 sc1
    buffer_load_dwordx4 v[60:63], v224, s[64:67], s77 offen offset:3072 sc1
    s_waitcnt vmcnt(3)
    ds_write_b128 v234, v[48:51] offset:0
    s_waitcnt vmcnt(2)
    ds_write_b128 v234, v[52:55] offset:1088
    s_waitcnt vmcnt(1)
    ds_write_b128 v234, v[56:59] offset:2176
    s_waitcnt vmcnt(0)
    ds_write_b128 v234, v[60:63] offset:3264
    s_waitcnt lgkmcnt(0)
    ds_read_b64 v[64:65], v235 offset:0
    ds_read_b64 v[66:67], v235 offset:64
    ds_read_b64 v[68:69], v235 offset:128
    ds_read_b64 v[70:71], v235 offset:192
    ds_read_b64 v[72:73], v235 offset:256
    ds_read_b64 v[74:75], v235 offset:320
    ds_read_b64 v[76:77], v235 offset:384
    ds_read_b64 v[78:79], v235 offset:448
    s_waitcnt lgkmcnt(7)
    v_lshlrev_b32 v16, 16, v64
    v_and_b32 v24, 0xffff0000, v64
    v_lshlrev_b32 v32, 16, v65
    v_and_b32 v40, 0xffff0000, v65
    s_waitcnt lgkmcnt(6)
    v_lshlrev_b32 v17, 16, v66
    v_and_b32 v25, 0xffff0000, v66
    v_lshlrev_b32 v33, 16, v67
    v_and_b32 v41, 0xffff0000, v67
    s_waitcnt lgkmcnt(5)
    v_lshlrev_b32 v18, 16, v68
    v_and_b32 v26, 0xffff0000, v68
    v_lshlrev_b32 v34, 16, v69
    v_and_b32 v42, 0xffff0000, v69
    s_waitcnt lgkmcnt(4)
    v_lshlrev_b32 v19, 16, v70
    v_and_b32 v27, 0xffff0000, v70
    v_lshlrev_b32 v35, 16, v71
    v_and_b32 v43, 0xffff0000, v71
    s_waitcnt lgkmcnt(3)
    v_lshlrev_b32 v20, 16, v72
    v_and_b32 v28, 0xffff0000, v72
    v_lshlrev_b32 v36, 16, v73
    v_and_b32 v44, 0xffff0000, v73
    s_waitcnt lgkmcnt(2)
    v_lshlrev_b32 v21, 16, v74
    v_and_b32 v29, 0xffff0000, v74
    v_lshlrev_b32 v37, 16, v75
    v_and_b32 v45, 0xffff0000, v75
    s_waitcnt lgkmcnt(1)
    v_lshlrev_b32 v22, 16, v76
    v_and_b32 v30, 0xffff0000, v76
    v_lshlrev_b32 v38, 16, v77
    v_and_b32 v46, 0xffff0000, v77
    s_waitcnt lgkmcnt(0)
    v_lshlrev_b32 v23, 16, v78
    v_and_b32 v31, 0xffff0000, v78
    v_lshlrev_b32 v39, 16, v79
    v_and_b32 v47, 0xffff0000, v79
    v_mul_f32 v16, v16, v112
    v_mul_f32 v17, v17, v113
    v_mul_f32 v18, v18, v114
    v_mul_f32 v19, v19, v115
    v_mul_f32 v20, v20, v116
    v_mul_f32 v21, v21, v117
    v_mul_f32 v22, v22, v118
    v_mul_f32 v23, v23, v119
    v_cvt_pk_bf16_f32 v48, v16, v17
    v_cvt_pk_bf16_f32 v49, v18, v19
    v_cvt_pk_bf16_f32 v50, v20, v21
    v_cvt_pk_bf16_f32 v51, v22, v23
    s_mov_b32 s74, 0
    buffer_store_dwordx4 v[48:51], v226, s[60:63], s74 offen
    v_mul_f32 v24, v24, v120
    v_mul_f32 v25, v25, v121
    v_mul_f32 v26, v26, v122
    v_mul_f32 v27, v27, v123
    v_mul_f32 v28, v28, v124
    v_mul_f32 v29, v29, v125
    v_mul_f32 v30, v30, v126
    v_mul_f32 v31, v31, v127
    v_cvt_pk_bf16_f32 v52, v24, v25
    v_cvt_pk_bf16_f32 v53, v26, v27
    v_cvt_pk_bf16_f32 v54, v28, v29
    v_cvt_pk_bf16_f32 v55, v30, v31
    s_mov_b32 s74, 4096
    buffer_store_dwordx4 v[52:55], v226, s[60:63], s74 offen
    v_mul_f32 v32, v32, v128
    v_mul_f32 v33, v33, v129
    v_mul_f32 v34, v34, v130
    v_mul_f32 v35, v35, v131
    v_mul_f32 v36, v36, v132
    v_mul_f32 v37, v37, v133
    v_mul_f32 v38, v38, v134
    v_mul_f32 v39, v39, v135
    v_cvt_pk_bf16_f32 v56, v32, v33
    v_cvt_pk_bf16_f32 v57, v34, v35
    v_cvt_pk_bf16_f32 v58, v36, v37
    v_cvt_pk_bf16_f32 v59, v38, v39
    s_mov_b32 s74, 16384
    buffer_store_dwordx4 v[56:59], v226, s[60:63], s74 offen
    v_mul_f32 v40, v40, v136
    v_mul_f32 v41, v41, v137
    v_mul_f32 v42, v42, v138
    v_mul_f32 v43, v43, v139
    v_mul_f32 v44, v44, v140
    v_mul_f32 v45, v45, v141
    v_mul_f32 v46, v46, v142
    v_mul_f32 v47, v47, v143
    v_cvt_pk_bf16_f32 v60, v40, v41
    v_cvt_pk_bf16_f32 v61, v42, v43
    v_cvt_pk_bf16_f32 v62, v44, v45
    v_cvt_pk_bf16_f32 v63, v46, v47
    s_mov_b32 s74, 20480
    buffer_store_dwordx4 v[60:63], v226, s[60:63], s74 offen
    s_endpgm
L_grole:
    s_setprio 2
    s_add_u32 s52, s30, 0xc00000
    s_addc_u32 s53, s31, 0
    s_mov_b32 s54, 0x4000
    s_mov_b32 s55, 0x20000
    s_or_b32 s7, s2, s3
    s_cmp_lg_u32 s7, 0
    s_cbranch_scc1 L_noinit
    v_lshlrev_b32 v1, 8, v0
    v_mov_b32 v2, 0
    buffer_store_dword v2, v1, s[52:55], 0 offen sc1
L_noinit:
    s_lshr_b32 s32, s3, 1
    s_and_b32 s33, s3, 1
    v_and_b32 v1, 15, v0
    v_lshrrev_b32 v2, 4, v0
    v_lshrrev_b32 v3, 1, v1
    v_xor_b32 v3, v2, v3
    v_lshlrev_b32 v3, 4, v3
    v_lshl_add_u32 v3, v1, 7, v3
    s_lshl_b32 s37, s33, 13
    v_add_u32 v196, s37, v3
    v_xor_b32 v197, 64, v196
    v_and_b32 v3, 6, v1
    v_xor_b32 v3, v2, v3
    v_lshlrev_b32 v3, 4, v3
    v_and_b32 v198, 7, v1
    v_lshl_add_u32 v3, v198, 7, v3
    v_add_u32 v198, 16384, v3
    v_xor_b32 v199, 64, v198
    v_bfe_u32 v3, v0, 2, 2
    v_lshl_add_u32 v200, v2, 3, v3
    v_lshlrev_b32 v200, 7, v200
    v_bfe_u32 v3, v0, 3, 2
    v_xor_b32 v3, s3, v3
    v_lshl_add_u32 v200, v3, 5, v200
    v_and_b32 v3, 3, v0
    v_lshl_add_u32 v200, v3, 3, v200
    v_add_u32 v200, 17408, v200
    v_xor_b32 v201, 32, v200
    v_mov_b32 v4, 0
    v_mov_b32 v5, 0
    v_mov_b32 v6, 0
    v_mov_b32 v7, 0
    v_mov_b32 v8, 0
    v_mov_b32 v9, 0
    v_mov_b32 v10, 0
    v_mov_b32 v11, 0
    v_mov_b32 v12, 0
    v_mov_b32 v13, 0
    v_mov_b32 v14, 0
    v_mov_b32 v15, 0
    v_mov_b32 v16, 0
    v_mov_b32 v17, 0
    v_mov_b32 v18, 0
    v_mov_b32 v19, 0
    v_mov_b32 v20, 0
    v_mov_b32 v21, 0
    v_mov_b32 v22, 0
    v_mov_b32 v23, 0
    v_mov_b32 v24, 0
    v_mov_b32 v25, 0
    v_mov_b32 v26, 0
    v_mov_b32 v27, 0
    v_mov_b32 v28, 0
    v_mov_b32 v29, 0
    v_mov_b32 v30, 0
    v_mov_b32 v31, 0
    v_mov_b32 v32, 0
    v_mov_b32 v33, 0
    v_mov_b32 v34, 0
    v_mov_b32 v35, 0
    v_mov_b32 v36, 0
    v_mov_b32 v37, 0
    v_mov_b32 v38, 0
    v_mov_b32 v39, 0
    v_mov_b32 v40, 0
    v_mov_b32 v41, 0
    v_mov_b32 v42, 0
    v_mov_b32 v43, 0
    v_mov_b32 v44, 0
    v_mov_b32 v45, 0
    v_mov_b32 v46, 0
    v_mov_b32 v47, 0
    v_mov_b32 v48, 0
    v_mov_b32 v49, 0
    v_mov_b32 v50, 0
    v_mov_b32 v51, 0
    v_mov_b32 v52, 0
    v_mov_b32 v53, 0
    v_mov_b32 v54, 0
    v_mov_b32 v55, 0
    v_mov_b32 v56, 0
    v_mov_b32 v57, 0
    v_mov_b32 v58, 0
    v_mov_b32 v59, 0
    v_mov_b32 v60, 0
    v_mov_b32 v61, 0
    v_mov_b32 v62, 0
    v_mov_b32 v63, 0
    v_mov_b32 v64, 0
    v_mov_b32 v65, 0
    v_mov_b32 v66, 0
    v_mov_b32 v67, 0
    v_mov_b32 v68, 0
    v_mov_b32 v69, 0
    v_mov_b32 v70, 0
    v_mov_b32 v71, 0
    v_mov_b32 v72, 0
    v_mov_b32 v73, 0
    v_mov_b32 v74, 0
    v_mov_b32 v75, 0
    v_mov_b32 v76, 0
    v_mov_b32 v77, 0
    v_mov_b32 v78, 0
    v_mov_b32 v79, 0
    v_mov_b32 v80, 0
    v_mov_b32 v81, 0
    v_mov_b32 v82, 0
    v_mov_b32 v83, 0
    v_mov_b32 v84, 0
    v_mov_b32 v85, 0
    v_mov_b32 v86, 0
    v_mov_b32 v87, 0
    v_mov_b32 v88, 0
    v_mov_b32 v89, 0
    v_mov_b32 v90, 0
    v_mov_b32 v91, 0
    v_mov_b32 v92, 0
    v_mov_b32 v93, 0
    v_mov_b32 v94, 0
    v_mov_b32 v95, 0
    v_mov_b32 v96, 0
    v_mov_b32 v97, 0
    v_mov_b32 v98, 0
    v_mov_b32 v99, 0
    v_mov_b32 v100, 0
    v_mov_b32 v101, 0
    v_mov_b32 v102, 0
    v_mov_b32 v103, 0
    v_mov_b32 v104, 0
    v_mov_b32 v105, 0
    v_mov_b32 v106, 0
    v_mov_b32 v107, 0
    s_mov_b32 s34, 0
    v_and_b32 v1, 15, v0
    v_lshrrev_b32 v2, 4, v0
    v_lshlrev_b32 v2, 2, v2
    v_sub_u32 v1, v1, v2
    s_mov_b32 s37, 0xf149f2ca
    v_mov_b32 v3, s37
    s_or_b32 s38, s5, s33
    s_cmp_eq_u32 s38, 0
    s_cselect_b32 s38, s37, 0
    v_mov_b32 v216, 0
    v_mov_b32 v217, 0
    v_subrev_u32 v2, 0, v1
    v_cmp_gt_u32 vcc, 8, v2
    s_nop 1
    v_cndmask_b32 v204, v3, 0, vcc
    v_cmp_gt_i32 vcc, -8, v2
    s_nop 1
    v_cndmask_b32 v208, v3, 0, vcc
    v_min_f32 v212, s38, v208
    v_cmp_le_i32 vcc, 0, v2
    s_nop 1
    v_cndmask_b32 v2, 0, -1, vcc
    v_and_b32 v2, 0xffff, v2
    v_or_b32 v216, v216, v2
    v_subrev_u32 v2, 1, v1
    v_cmp_gt_u32 vcc, 8, v2
    s_nop 1
    v_cndmask_b32 v205, v3, 0, vcc
    v_cmp_gt_i32 vcc, -8, v2
    s_nop 1
    v_cndmask_b32 v209, v3, 0, vcc
    v_min_f32 v213, s38, v209
    v_cmp_le_i32 vcc, 0, v2
    s_nop 1
    v_cndmask_b32 v2, 0, -1, vcc
    v_and_b32 v2, 0xffff0000, v2
    v_or_b32 v216, v216, v2
    v_subrev_u32 v2, 2, v1
    v_cmp_gt_u32 vcc, 8, v2
    s_nop 1
    v_cndmask_b32 v206, v3, 0, vcc
    v_cmp_gt_i32 vcc, -8, v2
    s_nop 1
    v_cndmask_b32 v210, v3, 0, vcc
    v_min_f32 v214, s38, v210
    v_cmp_le_i32 vcc, 0, v2
    s_nop 1
    v_cndmask_b32 v2, 0, -1, vcc
    v_and_b32 v2, 0xffff, v2
    v_or_b32 v217, v217, v2
    v_subrev_u32 v2, 3, v1
    v_cmp_gt_u32 vcc, 8, v2
    s_nop 1
    v_cndmask_b32 v207, v3, 0, vcc
    v_cmp_gt_i32 vcc, -8, v2
    s_nop 1
    v_cndmask_b32 v211, v3, 0, vcc
    v_min_f32 v215, s38, v211
    v_cmp_le_i32 vcc, 0, v2
    s_nop 1
    v_cndmask_b32 v2, 0, -1, vcc
    v_and_b32 v2, 0xffff0000, v2
    v_or_b32 v217, v217, v2
    s_mul_i32 s37, s32, 80896
    s_add_u32 s37, s37, 78848
    v_lshl_add_u32 v220, v0, 3, s37
    s_lshl_b32 s38, s33, 9
    v_add_u32 v219, s38, v220
    s_mul_i32 s38, s33, 2560
    v_add_u32 v221, s38, v220
    v_xor_b32 v222, 512, v221
    s_lshl_b32 s37, s4, 6
    s_lshl_b32 s38, s5, 3
    s_add_u32 s37, s37, s38
    s_lshl_b32 s38, s33, 2
    s_add_u32 s37, s37, s38
    s_lshl_b32 s37, s37, 5
    s_lshl_b32 s38, s6, 1
    s_add_u32 s37, s37, s38
    s_add_u32 s37, s37, s32
    s_lshl_b32 s37, s37, 10
    v_lshl_add_u32 v218, v0, 4, s37
    s_mov_b32 s40, s30
    s_mov_b32 s41, s31
    s_mov_b32 s42, 0x400000
    s_mov_b32 s43, 0x20000
    s_and_b32 s58, s2, 3
    s_lshl_b32 s58, s58, 2
    s_bfe_u32 s37, s2, 0x20003
    s_add_u32 s58, s58, s37
    s_bfe_u32 s59, s2, 0x10002
    s_lshl_b32 s59, s59, 3
    s_lshr_b32 s37, s2, 5
    s_add_u32 s59, s59, s37
    s_mov_b32 s44, s24
    s_mov_b32 s45, s25
    s_mov_b32 s46, 0x200000
    s_mov_b32 s47, 0x20000
    s_mov_b32 s48, s26
    s_mov_b32 s49, s27
    s_mov_b32 s50, 0x800000
    s_mov_b32 s51, 0x20000
    s_lshl_b32 s56, s4, 3
    s_add_u32 s56, s56, s5
    s_add_u32 s56, s56, 16
    s_lshl_b32 s56, s56, 8
    s_add_u32 s57, s58, 16
    s_lshl_b32 s57, s57, 8
    s_lshl_b32 s37, s58, 2
    s_add_u32 s37, s37, s3
    s_lshl_b32 s37, s37, 16
    v_lshl_add_u32 v224, v0, 4, s37
    v_add_u32 v225, 0x8000, v224
    s_and_b32 s37, s58, 7
    s_lshl_b32 s37, s37, 2
    s_add_u32 s37, s37, s3
    s_lshl_b32 s37, s37, 18
    s_lshr_b32 s38, s58, 3
    s_lshl_b32 s38, s38, 12
    s_add_u32 s37, s37, s38
    s_lshl_b32 s38, s59, 7
    s_add_u32 s37, s37, s38
    s_add_u32 s37, s37, 2048
    v_and_b32 v1, 15, v0
    v_lshl_add_u32 v1, v1, 13, s37
    v_bfe_u32 v2, v0, 4, 1
    v_lshl_add_u32 v1, v2, 5, v1
    v_lshrrev_b32 v2, 5, v0
    v_lshl_add_u32 v226, v2, 4, v1
    v_lshrrev_b32 v1, 4, v0
    v_lshlrev_b32 v1, 1, v1
    v_xor_b32 v1, v0, v1
    v_and_b32 v1, 7, v1
    s_lshl_b32 s37, s59, 7
    v_lshl_add_u32 v1, v1, 4, s37
    v_lshrrev_b32 v227, 3, v0
    v_lshl_add_u32 v227, v227, 11, v1
    s_lshl_b32 s37, s3, 1
    s_add_u32 s37, s37, 0
    s_cmp_ge_u32 s37, 5
    s_cselect_b32 s38, 60416, 0
    s_lshl_b32 s37, s37, 13
    s_add_u32 s60, s37, s38
    s_lshl_b32 s37, s3, 1
    s_add_u32 s37, s37, 1
    s_cmp_ge_u32 s37, 5
    s_cselect_b32 s38, 60416, 0
    s_lshl_b32 s37, s37, 13
    s_add_u32 s61, s37, s38
    s_lshl_b32 s62, s3, 18
    v_mov_b32 v228, 82944
    v_lshrrev_b32 v1, 2, v0
    v_lshlrev_b32 v1, 7, v1
    v_bfe_u32 v2, v0, 3, 2
    v_lshl_add_u32 v1, v2, 5, v1
    v_and_b32 v2, 3, v0
    v_lshl_add_u32 v229, v2, 3, v1
    s_cmp_lg_u32 s7, 0
    s_cbranch_scc1 L_noinit2
    s_mov_b32 s64, s28
    s_mov_b32 s65, s29
    s_mov_b32 s66, 0x100
    s_mov_b32 s67, 0x20000
    v_mov_b32 v2, 1
    s_waitcnt vmcnt(0)
    s_mov_b64 exec, 1
    buffer_store_dword v2, off, s[64:67], 0 sc1
    s_mov_b64 exec, -1
L_noinit2:
    s_mov_b32 s37, 41984
    s_mov_b32 s36, 15
    s_barrier
    ds_read_b128 v[108:111], v196 offset:0
    ds_read_b64_tr_b16 v[128:129], v200 offset:0
    ds_read_b64_tr_b16 v[130:131], v200 offset:512
    ds_read_b128 v[112:115], v196 offset:2048
    ds_read_b64_tr_b16 v[132:133], v201 offset:0
    ds_read_b64_tr_b16 v[134:135], v201 offset:512
    ds_read_b128 v[116:119], v196 offset:4096
    ds_read_b64_tr_b16 v[136:137], v200 offset:8192
    ds_read_b64_tr_b16 v[138:139], v200 offset:8704
    ds_read_b128 v[120:123], v196 offset:6144
    ds_read_b64_tr_b16 v[140:141], v201 offset:8192
    ds_read_b64_tr_b16 v[142:143], v201 offset:8704
    ds_read_b128 v[124:127], v198
    ds_read_b64_tr_b16 v[144:145], v200 offset:16384
    ds_read_b64_tr_b16 v[146:147], v200 offset:16896
    ds_read_b64_tr_b16 v[148:149], v201 offset:16384
    ds_read_b64_tr_b16 v[150:151], v201 offset:16896
    s_waitcnt lgkmcnt(0)
L_g1_loop:
    v_mfma_f32_16x16x32_bf16 v[4:7], v[128:131], v[108:111], v[4:7]
    ds_read_b128 v[152:155], v197 offset:0
    v_mfma_f32_16x16x32_bf16 v[12:15], v[128:131], v[112:115], v[12:15]
    ds_read_b64_tr_b16 v[172:173], v200 offset:4096
    v_mfma_f32_16x16x32_bf16 v[20:23], v[128:131], v[116:119], v[20:23]
    ds_read_b64_tr_b16 v[174:175], v200 offset:4608
    v_mfma_f32_16x16x32_bf16 v[28:31], v[128:131], v[120:123], v[28:31]
    ds_read_b128 v[156:159], v197 offset:2048
    v_mfma_f32_16x16x32_bf16 v[8:11], v[132:135], v[108:111], v[8:11]
    ds_read_b64_tr_b16 v[176:177], v201 offset:4096
    v_mfma_f32_16x16x32_bf16 v[16:19], v[132:135], v[112:115], v[16:19]
    ds_read_b64_tr_b16 v[178:179], v201 offset:4608
    v_mfma_f32_16x16x32_bf16 v[24:27], v[132:135], v[116:119], v[24:27]
    ds_read_b128 v[160:163], v197 offset:4096
    v_mfma_f32_16x16x32_bf16 v[32:35], v[132:135], v[120:123], v[32:35]
    ds_read_b64_tr_b16 v[180:181], v200 offset:12288
    v_mfma_f32_16x16x32_bf16 v[36:39], v[136:139], v[108:111], v[36:39]
    ds_read_b64_tr_b16 v[182:183], v200 offset:12800
    v_mfma_f32_16x16x32_bf16 v[44:47], v[136:139], v[112:115], v[44:47]
    ds_read_b128 v[164:167], v197 offset:6144
    v_mfma_f32_16x16x32_bf16 v[52:55], v[136:139], v[116:119], v[52:55]
    ds_read_b64_tr_b16 v[184:185], v201 offset:12288
    v_mfma_f32_16x16x32_bf16 v[60:63], v[136:139], v[120:123], v[60:63]
    ds_read_b64_tr_b16 v[186:187], v201 offset:12800
    v_mfma_f32_16x16x32_bf16 v[100:103], v[136:139], v[124:127], v[100:103]
    ds_read_b128 v[168:171], v199
    v_mfma_f32_16x16x32_bf16 v[40:43], v[140:143], v[108:111], v[40:43]
    ds_read_b64_tr_b16 v[188:189], v200 offset:20480
    v_mfma_f32_16x16x32_bf16 v[48:51], v[140:143], v[112:115], v[48:51]
    ds_read_b64_tr_b16 v[190:191], v200 offset:20992
    v_mfma_f32_16x16x32_bf16 v[56:59], v[140:143], v[116:119], v[56:59]
    ds_read_b64_tr_b16 v[192:193], v201 offset:20480
    v_mfma_f32_16x16x32_bf16 v[64:67], v[140:143], v[120:123], v[64:67]
    ds_read_b64_tr_b16 v[194:195], v201 offset:20992
    v_mfma_f32_16x16x32_bf16 v[68:71], v[108:111], v[144:147], v[68:71]
    s_add_u32 s34, s34, 41984
    v_mfma_f32_16x16x32_bf16 v[76:79], v[112:115], v[144:147], v[76:79]
    s_cmp_eq_u32 s34, 125952
    v_mfma_f32_16x16x32_bf16 v[84:87], v[116:119], v[144:147], v[84:87]
    s_cselect_b32 s35, -83968, s37
    v_mfma_f32_16x16x32_bf16 v[92:95], v[120:123], v[144:147], v[92:95]
    s_cselect_b32 s34, 0, s34
    v_mfma_f32_16x16x32_bf16 v[104:107], v[124:127], v[144:147], v[104:107]
    v_mfma_f32_16x16x32_bf16 v[72:75], v[108:111], v[148:151], v[72:75]
    s_waitcnt lgkmcnt(0)
    v_mfma_f32_16x16x32_bf16 v[80:83], v[112:115], v[148:151], v[80:83]
    v_add_u32 v196, s35, v196
    v_add_u32 v197, s35, v197
    v_mfma_f32_16x16x32_bf16 v[88:91], v[116:119], v[148:151], v[88:91]
    v_add_u32 v198, s35, v198
    v_add_u32 v199, s35, v199
    v_mfma_f32_16x16x32_bf16 v[96:99], v[120:123], v[148:151], v[96:99]
    v_add_u32 v200, s35, v200
    v_add_u32 v201, s35, v201
    s_barrier
    v_mfma_f32_16x16x32_bf16 v[4:7], v[172:175], v[152:155], v[4:7]
    ds_read_b128 v[108:111], v196 offset:0
    v_mfma_f32_16x16x32_bf16 v[12:15], v[172:175], v[156:159], v[12:15]
    ds_read_b64_tr_b16 v[128:129], v200 offset:0
    v_mfma_f32_16x16x32_bf16 v[20:23], v[172:175], v[160:163], v[20:23]
    ds_read_b64_tr_b16 v[130:131], v200 offset:512
    v_mfma_f32_16x16x32_bf16 v[28:31], v[172:175], v[164:167], v[28:31]
    ds_read_b128 v[112:115], v196 offset:2048
    v_mfma_f32_16x16x32_bf16 v[8:11], v[176:179], v[152:155], v[8:11]
    ds_read_b64_tr_b16 v[132:133], v201 offset:0
    v_mfma_f32_16x16x32_bf16 v[16:19], v[176:179], v[156:159], v[16:19]
    ds_read_b64_tr_b16 v[134:135], v201 offset:512
    v_mfma_f32_16x16x32_bf16 v[24:27], v[176:179], v[160:163], v[24:27]
    ds_read_b128 v[116:119], v196 offset:4096
    v_mfma_f32_16x16x32_bf16 v[32:35], v[176:179], v[164:167], v[32:35]
    ds_read_b64_tr_b16 v[136:137], v200 offset:8192
    v_mfma_f32_16x16x32_bf16 v[36:39], v[180:183], v[152:155], v[36:39]
    ds_read_b64_tr_b16 v[138:139], v200 offset:8704
    v_mfma_f32_16x16x32_bf16 v[44:47], v[180:183], v[156:159], v[44:47]
    ds_read_b128 v[120:123], v196 offset:6144
    v_mfma_f32_16x16x32_bf16 v[52:55], v[180:183], v[160:163], v[52:55]
    ds_read_b64_tr_b16 v[140:141], v201 offset:8192
    v_mfma_f32_16x16x32_bf16 v[60:63], v[180:183], v[164:167], v[60:63]
    ds_read_b64_tr_b16 v[142:143], v201 offset:8704
    v_mfma_f32_16x16x32_bf16 v[100:103], v[180:183], v[168:171], v[100:103]
    ds_read_b128 v[124:127], v198
    v_mfma_f32_16x16x32_bf16 v[40:43], v[184:187], v[152:155], v[40:43]
    ds_read_b64_tr_b16 v[144:145], v200 offset:16384
    v_mfma_f32_16x16x32_bf16 v[48:51], v[184:187], v[156:159], v[48:51]
    ds_read_b64_tr_b16 v[146:147], v200 offset:16896
    v_mfma_f32_16x16x32_bf16 v[56:59], v[184:187], v[160:163], v[56:59]
    ds_read_b64_tr_b16 v[148:149], v201 offset:16384
    v_mfma_f32_16x16x32_bf16 v[64:67], v[184:187], v[164:167], v[64:67]
    ds_read_b64_tr_b16 v[150:151], v201 offset:16896
    v_mfma_f32_16x16x32_bf16 v[68:71], v[152:155], v[188:191], v[68:71]
    s_sub_u32 s36, s36, 1
    v_mfma_f32_16x16x32_bf16 v[76:79], v[156:159], v[188:191], v[76:79]
    s_cmp_lg_u32 s36, 0
    v_mfma_f32_16x16x32_bf16 v[84:87], v[160:163], v[188:191], v[84:87]
    v_mfma_f32_16x16x32_bf16 v[92:95], v[164:167], v[188:191], v[92:95]
    v_mfma_f32_16x16x32_bf16 v[104:107], v[168:171], v[188:191], v[104:107]
    v_mfma_f32_16x16x32_bf16 v[72:75], v[152:155], v[192:195], v[72:75]
    v_mfma_f32_16x16x32_bf16 v[80:83], v[156:159], v[192:195], v[80:83]
    v_mfma_f32_16x16x32_bf16 v[88:91], v[160:163], v[192:195], v[88:91]
    v_mfma_f32_16x16x32_bf16 v[96:99], v[164:167], v[192:195], v[96:99]
    s_waitcnt lgkmcnt(0)
    s_cbranch_scc1 L_g1_loop
    v_mfma_f32_16x16x32_bf16 v[4:7], v[128:131], v[108:111], v[4:7]
    ds_read_b128 v[152:155], v197 offset:0
    v_mfma_f32_16x16x32_bf16 v[12:15], v[128:131], v[112:115], v[12:15]
    ds_read_b64_tr_b16 v[172:173], v200 offset:4096
    v_mfma_f32_16x16x32_bf16 v[20:23], v[128:131], v[116:119], v[20:23]
    ds_read_b64_tr_b16 v[174:175], v200 offset:4608
    v_mfma_f32_16x16x32_bf16 v[28:31], v[128:131], v[120:123], v[28:31]
    ds_read_b128 v[156:159], v197 offset:2048
    v_mfma_f32_16x16x32_bf16 v[8:11], v[132:135], v[108:111], v[8:11]
    ds_read_b64_tr_b16 v[176:177], v201 offset:4096
    v_mfma_f32_16x16x32_bf16 v[16:19], v[132:135], v[112:115], v[16:19]
    ds_read_b64_tr_b16 v[178:179], v201 offset:4608
    v_mfma_f32_16x16x32_bf16 v[24:27], v[132:135], v[116:119], v[24:27]
    ds_read_b128 v[160:163], v197 offset:4096
    v_mfma_f32_16x16x32_bf16 v[32:35], v[132:135], v[120:123], v[32:35]
    ds_read_b64_tr_b16 v[180:181], v200 offset:12288
    v_mfma_f32_16x16x32_bf16 v[36:39], v[136:139], v[108:111], v[36:39]
    ds_read_b64_tr_b16 v[182:183], v200 offset:12800
    v_mfma_f32_16x16x32_bf16 v[44:47], v[136:139], v[112:115], v[44:47]
    ds_read_b128 v[164:167], v197 offset:6144
    v_mfma_f32_16x16x32_bf16 v[52:55], v[136:139], v[116:119], v[52:55]
    ds_read_b64_tr_b16 v[184:185], v201 offset:12288
    v_mfma_f32_16x16x32_bf16 v[60:63], v[136:139], v[120:123], v[60:63]
    ds_read_b64_tr_b16 v[186:187], v201 offset:12800
    v_mfma_f32_16x16x32_bf16 v[100:103], v[136:139], v[124:127], v[100:103]
    ds_read_b128 v[168:171], v199
    v_mfma_f32_16x16x32_bf16 v[40:43], v[140:143], v[108:111], v[40:43]
    ds_read_b64_tr_b16 v[188:189], v200 offset:20480
    v_mfma_f32_16x16x32_bf16 v[48:51], v[140:143], v[112:115], v[48:51]
    ds_read_b64_tr_b16 v[190:191], v200 offset:20992
    v_mfma_f32_16x16x32_bf16 v[56:59], v[140:143], v[116:119], v[56:59]
    ds_read_b64_tr_b16 v[192:193], v201 offset:20480
    v_mfma_f32_16x16x32_bf16 v[64:67], v[140:143], v[120:123], v[64:67]
    ds_read_b64_tr_b16 v[194:195], v201 offset:20992
    v_mfma_f32_16x16x32_bf16 v[68:71], v[108:111], v[144:147], v[68:71]
    v_mfma_f32_16x16x32_bf16 v[76:79], v[112:115], v[144:147], v[76:79]
    v_mfma_f32_16x16x32_bf16 v[84:87], v[116:119], v[144:147], v[84:87]
    v_mfma_f32_16x16x32_bf16 v[92:95], v[120:123], v[144:147], v[92:95]
    v_mfma_f32_16x16x32_bf16 v[104:107], v[124:127], v[144:147], v[104:107]
    v_mfma_f32_16x16x32_bf16 v[72:75], v[108:111], v[148:151], v[72:75]
    v_mfma_f32_16x16x32_bf16 v[80:83], v[112:115], v[148:151], v[80:83]
    v_mfma_f32_16x16x32_bf16 v[88:91], v[116:119], v[148:151], v[88:91]
    v_mfma_f32_16x16x32_bf16 v[96:99], v[120:123], v[148:151], v[96:99]
    s_waitcnt lgkmcnt(0)
    v_mfma_f32_16x16x32_bf16 v[4:7], v[172:175], v[152:155], v[4:7]
    v_mfma_f32_16x16x32_bf16 v[12:15], v[172:175], v[156:159], v[12:15]
    v_mfma_f32_16x16x32_bf16 v[20:23], v[172:175], v[160:163], v[20:23]
    v_mfma_f32_16x16x32_bf16 v[28:31], v[172:175], v[164:167], v[28:31]
    v_mfma_f32_16x16x32_bf16 v[8:11], v[176:179], v[152:155], v[8:11]
    v_mfma_f32_16x16x32_bf16 v[16:19], v[176:179], v[156:159], v[16:19]
    v_mfma_f32_16x16x32_bf16 v[24:27], v[176:179], v[160:163], v[24:27]
    v_mfma_f32_16x16x32_bf16 v[32:35], v[176:179], v[164:167], v[32:35]
    v_mfma_f32_16x16x32_bf16 v[36:39], v[180:183], v[152:155], v[36:39]
    v_mfma_f32_16x16x32_bf16 v[44:47], v[180:183], v[156:159], v[44:47]
    v_mfma_f32_16x16x32_bf16 v[52:55], v[180:183], v[160:163], v[52:55]
    v_mfma_f32_16x16x32_bf16 v[60:63], v[180:183], v[164:167], v[60:63]
    v_mfma_f32_16x16x32_bf16 v[100:103], v[180:183], v[168:171], v[100:103]
    v_mfma_f32_16x16x32_bf16 v[40:43], v[184:187], v[152:155], v[40:43]
    v_mfma_f32_16x16x32_bf16 v[48:51], v[184:187], v[156:159], v[48:51]
    v_mfma_f32_16x16x32_bf16 v[56:59], v[184:187], v[160:163], v[56:59]
    v_mfma_f32_16x16x32_bf16 v[64:67], v[184:187], v[164:167], v[64:67]
    v_mfma_f32_16x16x32_bf16 v[68:71], v[152:155], v[188:191], v[68:71]
    v_mfma_f32_16x16x32_bf16 v[76:79], v[156:159], v[188:191], v[76:79]
    v_mfma_f32_16x16x32_bf16 v[84:87], v[160:163], v[188:191], v[84:87]
    v_mfma_f32_16x16x32_bf16 v[92:95], v[164:167], v[188:191], v[92:95]
    v_mfma_f32_16x16x32_bf16 v[104:107], v[168:171], v[188:191], v[104:107]
    v_mfma_f32_16x16x32_bf16 v[72:75], v[152:155], v[192:195], v[72:75]
    v_mfma_f32_16x16x32_bf16 v[80:83], v[156:159], v[192:195], v[80:83]
    v_mfma_f32_16x16x32_bf16 v[88:91], v[160:163], v[192:195], v[88:91]
    v_mfma_f32_16x16x32_bf16 v[96:99], v[164:167], v[192:195], v[96:99]
    v_cvt_pk_bf16_f32 v164, v100, v101
    v_cvt_pk_bf16_f32 v165, v102, v103
    v_cvt_pk_bf16_f32 v140, v60, v61
    v_cvt_pk_bf16_f32 v141, v62, v63
    v_cvt_pk_bf16_f32 v142, v64, v65
    v_cvt_pk_bf16_f32 v143, v66, v67
    v_cvt_pk_bf16_f32 v166, v104, v105
    v_cvt_pk_bf16_f32 v167, v106, v107
    v_cvt_pk_bf16_f32 v152, v92, v93
    v_cvt_pk_bf16_f32 v153, v94, v95
    v_cvt_pk_bf16_f32 v162, v96, v97
    v_cvt_pk_bf16_f32 v163, v98, v99
    ds_write_b64 v219, v[164:165]
    ds_write_b64 v219, v[166:167] offset:1024
    s_cmp_eq_u32 s33, 0
    s_cbranch_scc0 L_at_nopub
    ds_write_b64 v220, v[140:141] offset:2048
    ds_write_b64 v220, v[152:153] offset:3072
    ds_write_b64 v220, v[142:143] offset:2560
    ds_write_b64 v220, v[162:163] offset:3584
L_at_nopub:
    v_cvt_pk_bf16_f32 v108, v4, v5
    v_cvt_pk_bf16_f32 v109, v6, v7
    v_cvt_pk_bf16_f32 v110, v8, v9
    v_cvt_pk_bf16_f32 v111, v10, v11
    v_cvt_pk_bf16_f32 v112, v12, v13
    v_cvt_pk_bf16_f32 v113, v14, v15
    v_cvt_pk_bf16_f32 v114, v16, v17
    v_cvt_pk_bf16_f32 v115, v18, v19
    v_cvt_pk_bf16_f32 v116, v20, v21
    v_cvt_pk_bf16_f32 v117, v22, v23
    v_cvt_pk_bf16_f32 v118, v24, v25
    v_cvt_pk_bf16_f32 v119, v26, v27
    v_cvt_pk_bf16_f32 v120, v28, v29
    v_cvt_pk_bf16_f32 v121, v30, v31
    v_cvt_pk_bf16_f32 v122, v32, v33
    v_cvt_pk_bf16_f32 v123, v34, v35
    s_waitcnt lgkmcnt(0)
    s_barrier
    ds_read_b64 v[124:125], v221
    ds_read_b64 v[126:127], v222
    ds_read_b64 v[144:145], v221 offset:1024
    ds_read_b64 v[154:155], v222 offset:1024
    v_cvt_pk_bf16_f32 v128, v36, v37
    v_cvt_pk_bf16_f32 v129, v38, v39
    v_cvt_pk_bf16_f32 v130, v40, v41
    v_cvt_pk_bf16_f32 v131, v42, v43
    v_cvt_pk_bf16_f32 v132, v44, v45
    v_cvt_pk_bf16_f32 v133, v46, v47
    v_cvt_pk_bf16_f32 v134, v48, v49
    s_add_u32 m0, s60, 0
    s_add_u32 s63, s62, 0
    buffer_load_dwordx4 v227, s[44:47], s63 offen lds
    v_cvt_pk_bf16_f32 v135, v50, v51
    v_cvt_pk_bf16_f32 v136, v52, v53
    v_cvt_pk_bf16_f32 v137, v54, v55
    v_cvt_pk_bf16_f32 v138, v56, v57
    v_cvt_pk_bf16_f32 v139, v58, v59
    v_mfma_f32_16x16x32_bf16 v[28:31], v[140:143], v[120:123], v[204:207]
    v_cvt_pk_bf16_f32 v146, v68, v69
    v_cvt_pk_bf16_f32 v147, v70, v71
    v_mfma_f32_16x16x32_bf16 v[32:35], v[136:139], v[120:123], v[208:211]
    v_cvt_pk_bf16_f32 v156, v72, v73
    v_cvt_pk_bf16_f32 v157, v74, v75
    s_add_u32 m0, s60, 1024
    s_add_u32 s63, s62, 16384
    buffer_load_dwordx4 v227, s[44:47], s63 offen lds
    v_mfma_f32_16x16x32_bf16 v[20:23], v[136:139], v[116:119], v[204:207]
    v_cvt_pk_bf16_f32 v148, v76, v77
    v_cvt_pk_bf16_f32 v149, v78, v79
    v_mfma_f32_16x16x32_bf16 v[24:27], v[132:135], v[116:119], v[208:211]
    v_cvt_pk_bf16_f32 v158, v80, v81
    v_cvt_pk_bf16_f32 v159, v82, v83
    v_mfma_f32_16x16x32_bf16 v[12:15], v[132:135], v[112:115], v[204:207]
    v_cvt_pk_bf16_f32 v150, v84, v85
    v_cvt_pk_bf16_f32 v151, v86, v87
    v_mfma_f32_16x16x32_bf16 v[16:19], v[128:131], v[112:115], v[208:211]
    v_cvt_pk_bf16_f32 v160, v88, v89
    s_add_u32 m0, s60, 2048
    s_add_u32 s63, s62, 32768
    buffer_load_dwordx4 v227, s[44:47], s63 offen lds
    v_cvt_pk_bf16_f32 v161, v90, v91
    v_mfma_f32_16x16x32_bf16 v[4:7], v[128:131], v[108:111], v[204:207]
    s_waitcnt lgkmcnt(0)
    v_mfma_f32_16x16x32_bf16 v[8:11], v[124:127], v[108:111], v[212:215]
    v_max_f32 v28, v28, v32
    v_max_f32 v29, v29, v33
    v_max_f32 v30, v30, v34
    v_max_f32 v31, v31, v35
    v_max3_f32 v39, v28, v29, v30
    v_max_f32 v39, v39, v31
    v_max_f32 v20, v20, v24
    s_add_u32 m0, s60, 3072
    s_add_u32 s63, s62, 49152
    buffer_load_dwordx4 v227, s[44:47], s63 offen lds
    v_max_f32 v21, v21, v25
    v_max_f32 v22, v22, v26
    v_max_f32 v23, v23, v27
    v_max3_f32 v38, v20, v21, v22
    v_max_f32 v38, v38, v23
    v_max_f32 v12, v12, v16
    v_max_f32 v13, v13, v17
    v_max_f32 v14, v14, v18
    v_max_f32 v15, v15, v19
    v_max3_f32 v37, v12, v13, v14
    v_max_f32 v37, v37, v15
    s_add_u32 m0, s60, 4096
    s_add_u32 s63, s62, 65536
    buffer_load_dwordx4 v227, s[44:47], s63 offen lds
    v_max_f32 v4, v4, v8
    v_max_f32 v5, v5, v9
    v_max_f32 v6, v6, v10
    v_max_f32 v7, v7, v11
    v_max3_f32 v36, v4, v5, v6
    v_max_f32 v36, v36, v7
    s_nop 1
    v_permlane32_swap_b32 v36, v37
    v_permlane32_swap_b32 v38, v39
    v_max_f32 v36, v36, v37
    v_max_f32 v38, v38, v39
    s_nop 1
    v_permlane16_swap_b32 v36, v38
    s_add_u32 m0, s60, 5120
    s_add_u32 s63, s62, 81920
    buffer_load_dwordx4 v227, s[44:47], s63 offen lds
    v_max_f32 v36, v36, v38
    s_mov_b32 s37, 0x3e8293ee
    v_mul_f32 v36, s37, v36
    v_mov_b32 v38, v36
    s_nop 1
    v_permlane16_swap_b32 v36, v38
    v_mov_b32 v37, v36
    v_mov_b32 v39, v38
    s_nop 0
    v_permlane32_swap_b32 v36, v37
    v_permlane32_swap_b32 v38, v39
    v_fma_f32 v4, v4, s37, -v36
    v_fma_f32 v5, v5, s37, -v36
    s_add_u32 m0, s60, 6144
    s_add_u32 s63, s62, 98304
    buffer_load_dwordx4 v227, s[44:47], s63 offen lds
    v_fma_f32 v6, v6, s37, -v36
    v_fma_f32 v7, v7, s37, -v36
    v_fma_f32 v12, v12, s37, -v37
    v_fma_f32 v13, v13, s37, -v37
    v_fma_f32 v14, v14, s37, -v37
    v_fma_f32 v15, v15, s37, -v37
    v_fma_f32 v20, v20, s37, -v38
    v_fma_f32 v21, v21, s37, -v38
    v_fma_f32 v22, v22, s37, -v38
    v_fma_f32 v23, v23, s37, -v38
    v_fma_f32 v28, v28, s37, -v39
    s_add_u32 m0, s60, 7168
    s_add_u32 s63, s62, 114688
    buffer_load_dwordx4 v227, s[44:47], s63 offen lds
    v_fma_f32 v29, v29, s37, -v39
    v_fma_f32 v30, v30, s37, -v39
    v_fma_f32 v31, v31, s37, -v39
    v_exp_f32 v4, v4
    v_exp_f32 v5, v5
    v_exp_f32 v6, v6
    v_exp_f32 v7, v7
    v_exp_f32 v12, v12
    v_exp_f32 v13, v13
    v_exp_f32 v14, v14
    v_exp_f32 v15, v15
    s_add_u32 m0, s61, 0
    s_add_u32 s63, s62, 131072
    buffer_load_dwordx4 v227, s[44:47], s63 offen lds
    v_exp_f32 v20, v20
    v_exp_f32 v21, v21
    v_exp_f32 v22, v22
    v_exp_f32 v23, v23
    v_exp_f32 v28, v28
    v_exp_f32 v29, v29
    v_exp_f32 v30, v30
    v_exp_f32 v31, v31
    v_add_f32 v36, v4, v5
    v_add_f32 v8, v6, v7
    v_add_f32 v36, v36, v8
    s_add_u32 m0, s61, 1024
    s_add_u32 s63, s62, 147456
    buffer_load_dwordx4 v227, s[44:47], s63 offen lds
    v_add_f32 v37, v12, v13
    v_add_f32 v16, v14, v15
    v_add_f32 v37, v37, v16
    v_add_f32 v38, v20, v21
    v_add_f32 v24, v22, v23
    v_add_f32 v38, v38, v24
    v_add_f32 v39, v28, v29
    v_add_f32 v32, v30, v31
    v_add_f32 v39, v39, v32
    v_permlane32_swap_b32 v36, v37
    s_nop 0
    v_permlane32_swap_b32 v38, v39
    s_add_u32 m0, s61, 2048
    s_add_u32 s63, s62, 163840
    buffer_load_dwordx4 v227, s[44:47], s63 offen lds
    v_add_f32 v36, v36, v37
    v_add_f32 v38, v38, v39
    s_nop 1
    v_permlane16_swap_b32 v36, v38
    v_add_f32 v36, v36, v38
    v_rcp_f32 v36, v36
    s_nop 0
    v_mov_b32 v38, v36
    s_nop 1
    v_permlane16_swap_b32 v36, v38
    v_mov_b32 v37, v36
    v_mov_b32 v39, v38
    s_nop 0
    v_permlane32_swap_b32 v36, v37
    v_permlane32_swap_b32 v38, v39
    s_add_u32 m0, s61, 3072
    s_add_u32 s63, s62, 180224
    buffer_load_dwordx4 v227, s[44:47], s63 offen lds
    v_mul_f32 v4, v4, v36
    v_mul_f32 v5, v5, v36
    v_mul_f32 v6, v6, v36
    v_mul_f32 v7, v7, v36
    v_cvt_pk_bf16_f32 v8, v4, v5
    v_cvt_pk_bf16_f32 v9, v6, v7
    v_and_b32 v10, v216, v8
    v_and_b32 v11, v217, v9
    v_xor_b32 v8, v8, v10
    v_xor_b32 v9, v9, v11
    v_mul_f32 v12, v12, v37
    s_add_u32 m0, s61, 4096
    s_add_u32 s63, s62, 196608
    buffer_load_dwordx4 v227, s[44:47], s63 offen lds
    v_mul_f32 v13, v13, v37
    v_mul_f32 v14, v14, v37
    v_mul_f32 v15, v15, v37
    v_cvt_pk_bf16_f32 v16, v12, v13
    v_cvt_pk_bf16_f32 v17, v14, v15
    v_and_b32 v18, v216, v16
    v_and_b32 v19, v217, v17
    v_xor_b32 v16, v16, v18
    v_xor_b32 v17, v17, v19
    v_mfma_f32_16x16x32_bf16 v[68:71], v[144:147], v[8:11], 0
    v_mfma_f32_16x16x32_bf16 v[72:75], v[154:157], v[8:11], 0
    s_add_u32 m0, s61, 5120
    s_add_u32 s63, s62, 212992
    buffer_load_dwordx4 v227, s[44:47], s63 offen lds
    v_mul_f32 v20, v20, v38
    v_mul_f32 v21, v21, v38
    v_mul_f32 v22, v22, v38
    v_mul_f32 v23, v23, v38
    v_cvt_pk_bf16_f32 v24, v20, v21
    v_cvt_pk_bf16_f32 v25, v22, v23
    v_and_b32 v26, v216, v24
    v_and_b32 v27, v217, v25
    v_xor_b32 v24, v24, v26
    v_xor_b32 v25, v25, v27
    v_mfma_f32_16x16x32_bf16 v[44:47], v[146:149], v[16:19], 0
    s_add_u32 m0, s61, 6144
    s_add_u32 s63, s62, 229376
    buffer_load_dwordx4 v227, s[44:47], s63 offen lds
    v_mfma_f32_16x16x32_bf16 v[48:51], v[156:159], v[16:19], 0
    v_mul_f32 v28, v28, v39
    v_mul_f32 v29, v29, v39
    v_mul_f32 v30, v30, v39
    v_mul_f32 v31, v31, v39
    v_cvt_pk_bf16_f32 v32, v28, v29
    v_cvt_pk_bf16_f32 v33, v30, v31
    v_and_b32 v34, v216, v32
    v_and_b32 v35, v217, v33
    v_xor_b32 v32, v32, v34
    v_xor_b32 v33, v33, v35
    s_add_u32 m0, s61, 7168
    s_add_u32 s63, s62, 245760
    buffer_load_dwordx4 v227, s[44:47], s63 offen lds
    v_mfma_f32_16x16x32_bf16 v[52:55], v[148:151], v[24:27], 0
    v_mfma_f32_16x16x32_bf16 v[56:59], v[158:161], v[24:27], 0
    v_mfma_f32_16x16x32_bf16 v[60:63], v[150:153], v[32:35], 0
    v_mfma_f32_16x16x32_bf16 v[64:67], v[160:163], v[32:35], 0
    v_cvt_pk_bf16_f32 v108, v68, v69
    v_cvt_pk_bf16_f32 v109, v70, v71
    v_cvt_pk_bf16_f32 v110, v72, v73
    v_cvt_pk_bf16_f32 v111, v74, v75
    v_cvt_pk_bf16_f32 v112, v44, v45
    v_cvt_pk_bf16_f32 v113, v46, v47
    v_cvt_pk_bf16_f32 v114, v48, v49
    v_cvt_pk_bf16_f32 v115, v50, v51
    v_cvt_pk_bf16_f32 v116, v52, v53
    v_cvt_pk_bf16_f32 v117, v54, v55
    v_cvt_pk_bf16_f32 v118, v56, v57
    v_cvt_pk_bf16_f32 v119, v58, v59
    v_cvt_pk_bf16_f32 v120, v60, v61
    v_cvt_pk_bf16_f32 v121, v62, v63
    v_cvt_pk_bf16_f32 v122, v64, v65
    v_cvt_pk_bf16_f32 v123, v66, v67
    s_cmp_eq_u32 s33, 0
    s_cbranch_scc1 L_at_noswap
    v_swap_b32 v108, v110
    v_swap_b32 v109, v111
    v_swap_b32 v112, v114
    v_swap_b32 v113, v115
    v_swap_b32 v116, v118
    v_swap_b32 v117, v119
    v_swap_b32 v120, v122
    v_swap_b32 v121, v123
L_at_noswap:
    s_mov_b32 s37, 0
    buffer_store_dwordx4 v[108:111], v218, s[40:43], s37 offen sc1
    s_mov_b32 s37, 32768
    buffer_store_dwordx4 v[112:115], v218, s[40:43], s37 offen sc1
    s_mov_b32 s37, 65536
    buffer_store_dwordx4 v[116:119], v218, s[40:43], s37 offen sc1
    s_mov_b32 s37, 98304
    buffer_store_dwordx4 v[120:123], v218, s[40:43], s37 offen sc1
    v_xor_b32 v68, 0, v229
    v_xor_b32 v69, 32, v229
    v_xor_b32 v70, 64, v229
    v_xor_b32 v71, 96, v229
    v_xor_b32 v72, 0, v229
    v_add_u32 v72, 60416, v72
    v_xor_b32 v73, 32, v229
    v_add_u32 v73, 60416, v73
    v_xor_b32 v74, 64, v229
    v_add_u32 v74, 60416, v74
    v_xor_b32 v75, 96, v229
    v_add_u32 v75, 60416, v75
    v_xor_b32 v76, 0, v229
    v_add_u32 v76, 125952, v76
    v_xor_b32 v77, 32, v229
    v_add_u32 v77, 125952, v77
    v_xor_b32 v78, 64, v229
    v_add_u32 v78, 125952, v78
    v_xor_b32 v79, 96, v229
    v_add_u32 v79, 125952, v79
    s_mov_b32 s64, 0
    s_mov_b32 s65, 4096
    s_mov_b32 s66, 8192
    s_mov_b32 s67, 12288
    s_mov_b32 s68, 16384
    s_mov_b32 s69, 20480
    s_mov_b32 s70, 24576
    s_mov_b32 s71, 28672
    s_waitcnt vmcnt(0)
    v_mov_b32 v2, 1
    s_mov_b64 exec, 1
    ds_add_rtn_u32 v1, v228, v2 offset:0
    s_waitcnt lgkmcnt(0)
    v_readfirstlane_b32 s39, v1
    s_nop 0
    s_cmp_eq_u32 s39, 3
    s_cbranch_scc0 L_jo_12a
    buffer_atomic_add v2, off, s[52:55], s56 sc1
L_jo_12a:
    s_cmp_eq_u32 s39, 3
    s_cbranch_scc0 L_jo_12
    v_mov_b32 v1, 0
    s_mov_b32 s38, 131072
L_sg_loop_15:
    v_readfirstlane_b32 s37, v1
    s_nop 0
    s_cmp_ge_u32 s37, 16
    s_cbranch_scc1 L_sg_done_14
    s_sub_u32 s38, s38, 1
    s_cbranch_scc1 L_sg_done_14
    buffer_load_dword v1, off, s[52:55], s57 sc1
    s_waitcnt vmcnt(0)
    s_branch L_sg_loop_15
L_sg_done_14:
    ds_write_b32 v228, v2 offset:4
    s_branch L_jd_13
L_jo_12:
    s_mov_b32 s38, 1048576
L_sl_loop_17:
    ds_read_b32 v1, v228 offset:4
    s_waitcnt lgkmcnt(0)
    v_readfirstlane_b32 s37, v1
    s_nop 0
    s_cmp_ge_u32 s37, 1
    s_cbranch_scc1 L_sl_done_16
    s_sleep 1
    s_sub_u32 s38, s38, 1
    s_cbranch_scc0 L_sl_loop_17
L_sl_done_16:
L_jd_13:
    s_mov_b64 exec, -1
    buffer_load_dwordx4 v[80:83], v224, s[40:43], s64 offen offset:0 sc1
    buffer_load_dwordx4 v[84:87], v225, s[40:43], s64 offen offset:0 sc1
    buffer_load_dwordx4 v[88:91], v224, s[40:43], s64 offen offset:1024 sc1
    buffer_load_dwordx4 v[92:95], v225, s[40:43], s64 offen offset:1024 sc1
    buffer_load_dwordx4 v[96:99], v224, s[40:43], s64 offen offset:2048 sc1
    buffer_load_dwordx4 v[100:103], v225, s[40:43], s64 offen offset:2048 sc1
    buffer_load_dwordx4 v[104:107], v224, s[40:43], s64 offen offset:3072 sc1
    buffer_load_dwordx4 v[108:111], v225, s[40:43], s64 offen offset:3072 sc1
    buffer_load_dwordx4 v[112:115], v224, s[40:43], s65 offen offset:0 sc1
    buffer_load_dwordx4 v[116:119], v225, s[40:43], s65 offen offset:0 sc1
    buffer_load_dwordx4 v[120:123], v224, s[40:43], s65 offen offset:1024 sc1
    buffer_load_dwordx4 v[124:127], v225, s[40:43], s65 offen offset:1024 sc1
    buffer_load_dwordx4 v[128:131], v224, s[40:43], s65 offen offset:2048 sc1
    buffer_load_dwordx4 v[132:135], v225, s[40:43], s65 offen offset:2048 sc1
    buffer_load_dwordx4 v[136:139], v224, s[40:43], s65 offen offset:3072 sc1
    buffer_load_dwordx4 v[140:143], v225, s[40:43], s65 offen offset:3072 sc1
    buffer_load_dwordx4 v[144:147], v224, s[40:43], s66 offen offset:0 sc1
    buffer_load_dwordx4 v[148:151], v225, s[40:43], s66 offen offset:0 sc1
    buffer_load_dwordx4 v[152:155], v224, s[40:43], s66 offen offset:1024 sc1
    buffer_load_dwordx4 v[156:159], v225, s[40:43], s66 offen offset:1024 sc1
    buffer_load_dwordx4 v[160:163], v224, s[40:43], s66 offen offset:2048 sc1
    buffer_load_dwordx4 v[164:167], v225, s[40:43], s66 offen offset:2048 sc1
    buffer_load_dwordx4 v[168:171], v224, s[40:43], s66 offen offset:3072 sc1
    buffer_load_dwordx4 v[172:175], v225, s[40:43], s66 offen offset:3072 sc1
    ds_read_b64_tr_b16 v[36:37], v68 offset:0
    ds_read_b64_tr_b16 v[38:39], v68 offset:2048
    ds_read_b64_tr_b16 v[40:41], v69 offset:0
    ds_read_b64_tr_b16 v[42:43], v69 offset:2048
    ds_read_b64_tr_b16 v[44:45], v70 offset:0
    ds_read_b64_tr_b16 v[46:47], v70 offset:2048
    ds_read_b64_tr_b16 v[48:49], v71 offset:0
    ds_read_b64_tr_b16 v[50:51], v71 offset:2048
    ds_read_b64_tr_b16 v[52:53], v68 offset:4096
    ds_read_b64_tr_b16 v[54:55], v68 offset:6144
    ds_read_b64_tr_b16 v[56:57], v69 offset:4096
    ds_read_b64_tr_b16 v[58:59], v69 offset:6144
    ds_read_b64_tr_b16 v[60:61], v70 offset:4096
    ds_read_b64_tr_b16 v[62:63], v70 offset:6144
    s_waitcnt vmcnt(22) lgkmcnt(12)
    v_mfma_f32_16x16x32_bf16 v[4:7], v[36:39], v[80:83], 0
    ds_read_b64_tr_b16 v[64:65], v71 offset:4096
    v_mfma_f32_16x16x32_bf16 v[20:23], v[36:39], v[84:87], 0
    ds_read_b64_tr_b16 v[66:67], v71 offset:6144
    s_waitcnt lgkmcnt(12)
    v_mfma_f32_16x16x32_bf16 v[8:11], v[40:43], v[80:83], 0
    ds_read_b64_tr_b16 v[36:37], v68 offset:8192
    v_mfma_f32_16x16x32_bf16 v[24:27], v[40:43], v[84:87], 0
    ds_read_b64_tr_b16 v[38:39], v68 offset:10240
    buffer_load_dwordx4 v[176:179], v224, s[40:43], s67 offen offset:0 sc1
    s_waitcnt lgkmcnt(12)
    v_mfma_f32_16x16x32_bf16 v[12:15], v[44:47], v[80:83], 0
    ds_read_b64_tr_b16 v[40:41], v69 offset:8192
    v_mfma_f32_16x16x32_bf16 v[28:31], v[44:47], v[84:87], 0
    ds_read_b64_tr_b16 v[42:43], v69 offset:10240
    s_waitcnt lgkmcnt(12)
    v_mfma_f32_16x16x32_bf16 v[16:19], v[48:51], v[80:83], 0
    ds_read_b64_tr_b16 v[44:45], v70 offset:8192
    v_mfma_f32_16x16x32_bf16 v[32:35], v[48:51], v[84:87], 0
    ds_read_b64_tr_b16 v[46:47], v70 offset:10240
    buffer_load_dwordx4 v[180:183], v225, s[40:43], s67 offen offset:0 sc1
    s_waitcnt vmcnt(22) lgkmcnt(12)
    v_mfma_f32_16x16x32_bf16 v[4:7], v[52:55], v[88:91], v[4:7]
    ds_read_b64_tr_b16 v[48:49], v71 offset:8192
    v_mfma_f32_16x16x32_bf16 v[20:23], v[52:55], v[92:95], v[20:23]
    ds_read_b64_tr_b16 v[50:51], v71 offset:10240
    s_waitcnt lgkmcnt(12)
    v_mfma_f32_16x16x32_bf16 v[8:11], v[56:59], v[88:91], v[8:11]
    ds_read_b64_tr_b16 v[52:53], v68 offset:12288
    v_mfma_f32_16x16x32_bf16 v[24:27], v[56:59], v[92:95], v[24:27]
    ds_read_b64_tr_b16 v[54:55], v68 offset:14336
    buffer_load_dwordx4 v[80:83], v224, s[40:43], s67 offen offset:1024 sc1
    s_waitcnt lgkmcnt(12)
    v_mfma_f32_16x16x32_bf16 v[12:15], v[60:63], v[88:91], v[12:15]
    ds_read_b64_tr_b16 v[56:57], v69 offset:12288
    v_mfma_f32_16x16x32_bf16 v[28:31], v[60:63], v[92:95], v[28:31]
    ds_read_b64_tr_b16 v[58:59], v69 offset:14336
    s_waitcnt lgkmcnt(12)
    v_mfma_f32_16x16x32_bf16 v[16:19], v[64:67], v[88:91], v[16:19]
    ds_read_b64_tr_b16 v[60:61], v70 offset:12288
    v_mfma_f32_16x16x32_bf16 v[32:35], v[64:67], v[92:95], v[32:35]
    ds_read_b64_tr_b16 v[62:63], v70 offset:14336
    buffer_load_dwordx4 v[84:87], v225, s[40:43], s67 offen offset:1024 sc1
    s_waitcnt vmcnt(22) lgkmcnt(12)
    v_mfma_f32_16x16x32_bf16 v[4:7], v[36:39], v[96:99], v[4:7]
    ds_read_b64_tr_b16 v[64:65], v71 offset:12288
    v_mfma_f32_16x16x32_bf16 v[20:23], v[36:39], v[100:103], v[20:23]
    ds_read_b64_tr_b16 v[66:67], v71 offset:14336
    s_waitcnt lgkmcnt(12)
    v_mfma_f32_16x16x32_bf16 v[8:11], v[40:43], v[96:99], v[8:11]
    ds_read_b64_tr_b16 v[36:37], v68 offset:16384
    v_mfma_f32_16x16x32_bf16 v[24:27], v[40:43], v[100:103], v[24:27]
    ds_read_b64_tr_b16 v[38:39], v68 offset:18432
    buffer_load_dwordx4 v[88:91], v224, s[40:43], s67 offen offset:2048 sc1
    s_waitcnt lgkmcnt(12)
    v_mfma_f32_16x16x32_bf16 v[12:15], v[44:47], v[96:99], v[12:15]
    ds_read_b64_tr_b16 v[40:41], v69 offset:16384
    v_mfma_f32_16x16x32_bf16 v[28:31], v[44:47], v[100:103], v[28:31]
    ds_read_b64_tr_b16 v[42:43], v69 offset:18432
    s_waitcnt lgkmcnt(12)
    v_mfma_f32_16x16x32_bf16 v[16:19], v[48:51], v[96:99], v[16:19]
    ds_read_b64_tr_b16 v[44:45], v70 offset:16384
    v_mfma_f32_16x16x32_bf16 v[32:35], v[48:51], v[100:103], v[32:35]
    ds_read_b64_tr_b16 v[46:47], v70 offset:18432
    buffer_load_dwordx4 v[92:95], v225, s[40:43], s67 offen offset:2048 sc1
    s_waitcnt vmcnt(22) lgkmcnt(12)
    v_mfma_f32_16x16x32_bf16 v[4:7], v[52:55], v[104:107], v[4:7]
    ds_read_b64_tr_b16 v[48:49], v71 offset:16384
    v_mfma_f32_16x16x32_bf16 v[20:23], v[52:55], v[108:111], v[20:23]
    ds_read_b64_tr_b16 v[50:51], v71 offset:18432
    s_waitcnt lgkmcnt(12)
    v_mfma_f32_16x16x32_bf16 v[8:11], v[56:59], v[104:107], v[8:11]
    ds_read_b64_tr_b16 v[52:53], v68 offset:20480
    v_mfma_f32_16x16x32_bf16 v[24:27], v[56:59], v[108:111], v[24:27]
    ds_read_b64_tr_b16 v[54:55], v68 offset:22528
    buffer_load_dwordx4 v[96:99], v224, s[40:43], s67 offen offset:3072 sc1
    s_waitcnt lgkmcnt(12)
    v_mfma_f32_16x16x32_bf16 v[12:15], v[60:63], v[104:107], v[12:15]
    ds_read_b64_tr_b16 v[56:57], v69 offset:20480
    v_mfma_f32_16x16x32_bf16 v[28:31], v[60:63], v[108:111], v[28:31]
    ds_read_b64_tr_b16 v[58:59], v69 offset:22528
    s_waitcnt lgkmcnt(12)
    v_mfma_f32_16x16x32_bf16 v[16:19], v[64:67], v[104:107], v[16:19]
    ds_read_b64_tr_b16 v[60:61], v70 offset:20480
    v_mfma_f32_16x16x32_bf16 v[32:35], v[64:67], v[108:111], v[32:35]
    ds_read_b64_tr_b16 v[62:63], v70 offset:22528
    buffer_load_dwordx4 v[100:103], v225, s[40:43], s67 offen offset:3072 sc1
    s_waitcnt vmcnt(22) lgkmcnt(12)
    v_mfma_f32_16x16x32_bf16 v[4:7], v[36:39], v[112:115], v[4:7]
    ds_read_b64_tr_b16 v[64:65], v71 offset:20480
    v_mfma_f32_16x16x32_bf16 v[20:23], v[36:39], v[116:119], v[20:23]
    ds_read_b64_tr_b16 v[66:67], v71 offset:22528
    s_waitcnt lgkmcnt(12)
    v_mfma_f32_16x16x32_bf16 v[8:11], v[40:43], v[112:115], v[8:11]
    ds_read_b64_tr_b16 v[36:37], v68 offset:24576
    v_mfma_f32_16x16x32_bf16 v[24:27], v[40:43], v[116:119], v[24:27]
    ds_read_b64_tr_b16 v[38:39], v68 offset:26624
    buffer_load_dwordx4 v[104:107], v224, s[40:43], s68 offen offset:0 sc1
    s_waitcnt lgkmcnt(12)
    v_mfma_f32_16x16x32_bf16 v[12:15], v[44:47], v[112:115], v[12:15]
    ds_read_b64_tr_b16 v[40:41], v69 offset:24576
    v_mfma_f32_16x16x32_bf16 v[28:31], v[44:47], v[116:119], v[28:31]
    ds_read_b64_tr_b16 v[42:43], v69 offset:26624
    s_waitcnt lgkmcnt(12)
    v_mfma_f32_16x16x32_bf16 v[16:19], v[48:51], v[112:115], v[16:19]
    ds_read_b64_tr_b16 v[44:45], v70 offset:24576
    v_mfma_f32_16x16x32_bf16 v[32:35], v[48:51], v[116:119], v[32:35]
    ds_read_b64_tr_b16 v[46:47], v70 offset:26624
    buffer_load_dwordx4 v[108:111], v225, s[40:43], s68 offen offset:0 sc1
    s_waitcnt vmcnt(22) lgkmcnt(12)
    v_mfma_f32_16x16x32_bf16 v[4:7], v[52:55], v[120:123], v[4:7]
    ds_read_b64_tr_b16 v[48:49], v71 offset:24576
    v_mfma_f32_16x16x32_bf16 v[20:23], v[52:55], v[124:127], v[20:23]
    ds_read_b64_tr_b16 v[50:51], v71 offset:26624
    s_waitcnt lgkmcnt(12)
    v_mfma_f32_16x16x32_bf16 v[8:11], v[56:59], v[120:123], v[8:11]
    ds_read_b64_tr_b16 v[52:53], v68 offset:28672
    v_mfma_f32_16x16x32_bf16 v[24:27], v[56:59], v[124:127], v[24:27]
    ds_read_b64_tr_b16 v[54:55], v68 offset:30720
    buffer_load_dwordx4 v[112:115], v224, s[40:43], s68 offen offset:1024 sc1
    s_waitcnt lgkmcnt(12)
    v_mfma_f32_16x16x32_bf16 v[12:15], v[60:63], v[120:123], v[12:15]
    ds_read_b64_tr_b16 v[56:57], v69 offset:28672
    v_mfma_f32_16x16x32_bf16 v[28:31], v[60:63], v[124:127], v[28:31]
    ds_read_b64_tr_b16 v[58:59], v69 offset:30720
    s_waitcnt lgkmcnt(12)
    v_mfma_f32_16x16x32_bf16 v[16:19], v[64:67], v[120:123], v[16:19]
    ds_read_b64_tr_b16 v[60:61], v70 offset:28672
    v_mfma_f32_16x16x32_bf16 v[32:35], v[64:67], v[124:127], v[32:35]
    ds_read_b64_tr_b16 v[62:63], v70 offset:30720
    buffer_load_dwordx4 v[116:119], v225, s[40:43], s68 offen offset:1024 sc1
    s_waitcnt vmcnt(22) lgkmcnt(12)
    v_mfma_f32_16x16x32_bf16 v[4:7], v[36:39], v[128:131], v[4:7]
    ds_read_b64_tr_b16 v[64:65], v71 offset:28672
    v_mfma_f32_16x16x32_bf16 v[20:23], v[36:39], v[132:135], v[20:23]
    ds_read_b64_tr_b16 v[66:67], v71 offset:30720
    s_waitcnt lgkmcnt(12)
    v_mfma_f32_16x16x32_bf16 v[8:11], v[40:43], v[128:131], v[8:11]
    ds_read_b64_tr_b16 v[36:37], v68 offset:32768
    v_mfma_f32_16x16x32_bf16 v[24:27], v[40:43], v[132:135], v[24:27]
    ds_read_b64_tr_b16 v[38:39], v68 offset:34816
    buffer_load_dwordx4 v[120:123], v224, s[40:43], s68 offen offset:2048 sc1
    s_waitcnt lgkmcnt(12)
    v_mfma_f32_16x16x32_bf16 v[12:15], v[44:47], v[128:131], v[12:15]
    ds_read_b64_tr_b16 v[40:41], v69 offset:32768
    v_mfma_f32_16x16x32_bf16 v[28:31], v[44:47], v[132:135], v[28:31]
    ds_read_b64_tr_b16 v[42:43], v69 offset:34816
    s_waitcnt lgkmcnt(12)
    v_mfma_f32_16x16x32_bf16 v[16:19], v[48:51], v[128:131], v[16:19]
    ds_read_b64_tr_b16 v[44:45], v70 offset:32768
    v_mfma_f32_16x16x32_bf16 v[32:35], v[48:51], v[132:135], v[32:35]
    ds_read_b64_tr_b16 v[46:47], v70 offset:34816
    buffer_load_dwordx4 v[124:127], v225, s[40:43], s68 offen offset:2048 sc1
    s_waitcnt vmcnt(22) lgkmcnt(12)
    v_mfma_f32_16x16x32_bf16 v[4:7], v[52:55], v[136:139], v[4:7]
    ds_read_b64_tr_b16 v[48:49], v71 offset:32768
    v_mfma_f32_16x16x32_bf16 v[20:23], v[52:55], v[140:143], v[20:23]
    ds_read_b64_tr_b16 v[50:51], v71 offset:34816
    s_waitcnt lgkmcnt(12)
    v_mfma_f32_16x16x32_bf16 v[8:11], v[56:59], v[136:139], v[8:11]
    ds_read_b64_tr_b16 v[52:53], v68 offset:36864
    v_mfma_f32_16x16x32_bf16 v[24:27], v[56:59], v[140:143], v[24:27]
    ds_read_b64_tr_b16 v[54:55], v68 offset:38912
    buffer_load_dwordx4 v[128:131], v224, s[40:43], s68 offen offset:3072 sc1
    s_waitcnt lgkmcnt(12)
    v_mfma_f32_16x16x32_bf16 v[12:15], v[60:63], v[136:139], v[12:15]
    ds_read_b64_tr_b16 v[56:57], v69 offset:36864
    v_mfma_f32_16x16x32_bf16 v[28:31], v[60:63], v[140:143], v[28:31]
    ds_read_b64_tr_b16 v[58:59], v69 offset:38912
    s_waitcnt lgkmcnt(12)
    v_mfma_f32_16x16x32_bf16 v[16:19], v[64:67], v[136:139], v[16:19]
    ds_read_b64_tr_b16 v[60:61], v70 offset:36864
    v_mfma_f32_16x16x32_bf16 v[32:35], v[64:67], v[140:143], v[32:35]
    ds_read_b64_tr_b16 v[62:63], v70 offset:38912
    buffer_load_dwordx4 v[132:135], v225, s[40:43], s68 offen offset:3072 sc1
    s_waitcnt vmcnt(22) lgkmcnt(12)
    v_mfma_f32_16x16x32_bf16 v[4:7], v[36:39], v[144:147], v[4:7]
    ds_read_b64_tr_b16 v[64:65], v71 offset:36864
    v_mfma_f32_16x16x32_bf16 v[20:23], v[36:39], v[148:151], v[20:23]
    ds_read_b64_tr_b16 v[66:67], v71 offset:38912
    s_waitcnt lgkmcnt(12)
    v_mfma_f32_16x16x32_bf16 v[8:11], v[40:43], v[144:147], v[8:11]
    ds_read_b64_tr_b16 v[36:37], v72 offset:40960
    v_mfma_f32_16x16x32_bf16 v[24:27], v[40:43], v[148:151], v[24:27]
    ds_read_b64_tr_b16 v[38:39], v72 offset:43008
    buffer_load_dwordx4 v[136:139], v224, s[40:43], s69 offen offset:0 sc1
    s_waitcnt lgkmcnt(12)
    v_mfma_f32_16x16x32_bf16 v[12:15], v[44:47], v[144:147], v[12:15]
    ds_read_b64_tr_b16 v[40:41], v73 offset:40960
    v_mfma_f32_16x16x32_bf16 v[28:31], v[44:47], v[148:151], v[28:31]
    ds_read_b64_tr_b16 v[42:43], v73 offset:43008
    s_waitcnt lgkmcnt(12)
    v_mfma_f32_16x16x32_bf16 v[16:19], v[48:51], v[144:147], v[16:19]
    ds_read_b64_tr_b16 v[44:45], v74 offset:40960
    v_mfma_f32_16x16x32_bf16 v[32:35], v[48:51], v[148:151], v[32:35]
    ds_read_b64_tr_b16 v[46:47], v74 offset:43008
    buffer_load_dwordx4 v[140:143], v225, s[40:43], s69 offen offset:0 sc1
    s_waitcnt vmcnt(22) lgkmcnt(12)
    v_mfma_f32_16x16x32_bf16 v[4:7], v[52:55], v[152:155], v[4:7]
    ds_read_b64_tr_b16 v[48:49], v75 offset:40960
    v_mfma_f32_16x16x32_bf16 v[20:23], v[52:55], v[156:159], v[20:23]
    ds_read_b64_tr_b16 v[50:51], v75 offset:43008
    s_waitcnt lgkmcnt(12)
    v_mfma_f32_16x16x32_bf16 v[8:11], v[56:59], v[152:155], v[8:11]
    ds_read_b64_tr_b16 v[52:53], v72 offset:45056
    v_mfma_f32_16x16x32_bf16 v[24:27], v[56:59], v[156:159], v[24:27]
    ds_read_b64_tr_b16 v[54:55], v72 offset:47104
    buffer_load_dwordx4 v[144:147], v224, s[40:43], s69 offen offset:1024 sc1
    s_waitcnt lgkmcnt(12)
    v_mfma_f32_16x16x32_bf16 v[12:15], v[60:63], v[152:155], v[12:15]
    ds_read_b64_tr_b16 v[56:57], v73 offset:45056
    v_mfma_f32_16x16x32_bf16 v[28:31], v[60:63], v[156:159], v[28:31]
    ds_read_b64_tr_b16 v[58:59], v73 offset:47104
    s_waitcnt lgkmcnt(12)
    v_mfma_f32_16x16x32_bf16 v[16:19], v[64:67], v[152:155], v[16:19]
    ds_read_b64_tr_b16 v[60:61], v74 offset:45056
    v_mfma_f32_16x16x32_bf16 v[32:35], v[64:67], v[156:159], v[32:35]
    ds_read_b64_tr_b16 v[62:63], v74 offset:47104
    buffer_load_dwordx4 v[148:151], v225, s[40:43], s69 offen offset:1024 sc1
    s_waitcnt vmcnt(22) lgkmcnt(12)
    v_mfma_f32_16x16x32_bf16 v[4:7], v[36:39], v[160:163], v[4:7]
    ds_read_b64_tr_b16 v[64:65], v75 offset:45056
    v_mfma_f32_16x16x32_bf16 v[20:23], v[36:39], v[164:167], v[20:23]
    ds_read_b64_tr_b16 v[66:67], v75 offset:47104
    s_waitcnt lgkmcnt(12)
    v_mfma_f32_16x16x32_bf16 v[8:11], v[40:43], v[160:163], v[8:11]
    ds_read_b64_tr_b16 v[36:37], v72 offset:49152
    v_mfma_f32_16x16x32_bf16 v[24:27], v[40:43], v[164:167], v[24:27]
    ds_read_b64_tr_b16 v[38:39], v72 offset:51200
    buffer_load_dwordx4 v[152:155], v224, s[40:43], s69 offen offset:2048 sc1
    s_waitcnt lgkmcnt(12)
    v_mfma_f32_16x16x32_bf16 v[12:15], v[44:47], v[160:163], v[12:15]
    ds_read_b64_tr_b16 v[40:41], v73 offset:49152
    v_mfma_f32_16x16x32_bf16 v[28:31], v[44:47], v[164:167], v[28:31]
    ds_read_b64_tr_b16 v[42:43], v73 offset:51200
    s_waitcnt lgkmcnt(12)
    v_mfma_f32_16x16x32_bf16 v[16:19], v[48:51], v[160:163], v[16:19]
    ds_read_b64_tr_b16 v[44:45], v74 offset:49152
    v_mfma_f32_16x16x32_bf16 v[32:35], v[48:51], v[164:167], v[32:35]
    ds_read_b64_tr_b16 v[46:47], v74 offset:51200
    buffer_load_dwordx4 v[156:159], v225, s[40:43], s69 offen offset:2048 sc1
    s_waitcnt vmcnt(22) lgkmcnt(12)
    v_mfma_f32_16x16x32_bf16 v[4:7], v[52:55], v[168:171], v[4:7]
    ds_read_b64_tr_b16 v[48:49], v75 offset:49152
    v_mfma_f32_16x16x32_bf16 v[20:23], v[52:55], v[172:175], v[20:23]
    ds_read_b64_tr_b16 v[50:51], v75 offset:51200
    s_waitcnt lgkmcnt(12)
    v_mfma_f32_16x16x32_bf16 v[8:11], v[56:59], v[168:171], v[8:11]
    ds_read_b64_tr_b16 v[52:53], v72 offset:53248
    v_mfma_f32_16x16x32_bf16 v[24:27], v[56:59], v[172:175], v[24:27]
    ds_read_b64_tr_b16 v[54:55], v72 offset:55296
    buffer_load_dwordx4 v[160:163], v224, s[40:43], s69 offen offset:3072 sc1
    s_waitcnt lgkmcnt(12)
    v_mfma_f32_16x16x32_bf16 v[12:15], v[60:63], v[168:171], v[12:15]
    ds_read_b64_tr_b16 v[56:57], v73 offset:53248
    v_mfma_f32_16x16x32_bf16 v[28:31], v[60:63], v[172:175], v[28:31]
    ds_read_b64_tr_b16 v[58:59], v73 offset:55296
    s_waitcnt lgkmcnt(12)
    v_mfma_f32_16x16x32_bf16 v[16:19], v[64:67], v[168:171], v[16:19]
    ds_read_b64_tr_b16 v[60:61], v74 offset:53248
    v_mfma_f32_16x16x32_bf16 v[32:35], v[64:67], v[172:175], v[32:35]
    ds_read_b64_tr_b16 v[62:63], v74 offset:55296
    buffer_load_dwordx4 v[164:167], v225, s[40:43], s69 offen offset:3072 sc1
    s_waitcnt vmcnt(22) lgkmcnt(12)
    v_mfma_f32_16x16x32_bf16 v[4:7], v[36:39], v[176:179], v[4:7]
    ds_read_b64_tr_b16 v[64:65], v75 offset:53248
    v_mfma_f32_16x16x32_bf16 v[20:23], v[36:39], v[180:183], v[20:23]
    ds_read_b64_tr_b16 v[66:67], v75 offset:55296
    s_waitcnt lgkmcnt(12)
    v_mfma_f32_16x16x32_bf16 v[8:11], v[40:43], v[176:179], v[8:11]
    ds_read_b64_tr_b16 v[36:37], v72 offset:57344
    v_mfma_f32_16x16x32_bf16 v[24:27], v[40:43], v[180:183], v[24:27]
    ds_read_b64_tr_b16 v[38:39], v72 offset:59392
    buffer_load_dwordx4 v[168:171], v224, s[40:43], s70 offen offset:0 sc1
    s_waitcnt lgkmcnt(12)
    v_mfma_f32_16x16x32_bf16 v[12:15], v[44:47], v[176:179], v[12:15]
    ds_read_b64_tr_b16 v[40:41], v73 offset:57344
    v_mfma_f32_16x16x32_bf16 v[28:31], v[44:47], v[180:183], v[28:31]
    ds_read_b64_tr_b16 v[42:43], v73 offset:59392
    ds_read_b32 v1, v228 offset:12
    s_waitcnt lgkmcnt(13)
    v_mfma_f32_16x16x32_bf16 v[16:19], v[48:51], v[176:179], v[16:19]
    ds_read_b64_tr_b16 v[44:45], v74 offset:57344
    v_mfma_f32_16x16x32_bf16 v[32:35], v[48:51], v[180:183], v[32:35]
    ds_read_b64_tr_b16 v[46:47], v74 offset:59392
    buffer_load_dwordx4 v[172:175], v225, s[40:43], s70 offen offset:0 sc1
    s_waitcnt vmcnt(22) lgkmcnt(13)
    v_mfma_f32_16x16x32_bf16 v[4:7], v[52:55], v[80:83], v[4:7]
    ds_read_b64_tr_b16 v[48:49], v75 offset:57344
    v_mfma_f32_16x16x32_bf16 v[20:23], v[52:55], v[84:87], v[20:23]
    ds_read_b64_tr_b16 v[50:51], v75 offset:59392
    s_waitcnt lgkmcnt(13)
    v_mfma_f32_16x16x32_bf16 v[8:11], v[56:59], v[80:83], v[8:11]
    ds_read_b64_tr_b16 v[52:53], v72 offset:61440
    v_mfma_f32_16x16x32_bf16 v[24:27], v[56:59], v[84:87], v[24:27]
    ds_read_b64_tr_b16 v[54:55], v72 offset:63488
    buffer_load_dwordx4 v[176:179], v224, s[40:43], s70 offen offset:1024 sc1
    s_waitcnt lgkmcnt(13)
    v_mfma_f32_16x16x32_bf16 v[12:15], v[60:63], v[80:83], v[12:15]
    ds_read_b64_tr_b16 v[56:57], v73 offset:61440
    v_mfma_f32_16x16x32_bf16 v[28:31], v[60:63], v[84:87], v[28:31]
    ds_read_b64_tr_b16 v[58:59], v73 offset:63488
    s_waitcnt lgkmcnt(13)
    v_mfma_f32_16x16x32_bf16 v[16:19], v[64:67], v[80:83], v[16:19]
    ds_read_b64_tr_b16 v[60:61], v74 offset:61440
    v_mfma_f32_16x16x32_bf16 v[32:35], v[64:67], v[84:87], v[32:35]
    ds_read_b64_tr_b16 v[62:63], v74 offset:63488
    buffer_load_dwordx4 v[180:183], v225, s[40:43], s70 offen offset:1024 sc1
    s_waitcnt vmcnt(22) lgkmcnt(13)
    v_mfma_f32_16x16x32_bf16 v[4:7], v[36:39], v[88:91], v[4:7]
    ds_read_b64_tr_b16 v[64:65], v75 offset:61440
    v_mfma_f32_16x16x32_bf16 v[20:23], v[36:39], v[92:95], v[20:23]
    ds_read_b64_tr_b16 v[66:67], v75 offset:63488
    s_waitcnt lgkmcnt(12)
    v_readfirstlane_b32 s37, v1
    s_nop 0
    s_cmp_ge_u32 s37, 4
    s_cbranch_scc1 L_sl_done_18
    s_mov_b32 s38, 1048576
L_sl_loop_19:
    ds_read_b32 v1, v228 offset:12
    s_waitcnt lgkmcnt(0)
    v_readfirstlane_b32 s37, v1
    s_nop 0
    s_cmp_ge_u32 s37, 4
    s_cbranch_scc1 L_sl_done_18
    s_sleep 1
    s_sub_u32 s38, s38, 1
    s_cbranch_scc0 L_sl_loop_19
L_sl_done_18:
    v_mfma_f32_16x16x32_bf16 v[8:11], v[40:43], v[88:91], v[8:11]
    ds_read_b64_tr_b16 v[36:37], v76 offset:0
    v_mfma_f32_16x16x32_bf16 v[24:27], v[40:43], v[92:95], v[24:27]
    ds_read_b64_tr_b16 v[38:39], v76 offset:2048
    buffer_load_dwordx4 v[80:83], v224, s[40:43], s70 offen offset:2048 sc1
    s_waitcnt lgkmcnt(12)
    v_mfma_f32_16x16x32_bf16 v[12:15], v[44:47], v[88:91], v[12:15]
    ds_read_b64_tr_b16 v[40:41], v77 offset:0
    v_mfma_f32_16x16x32_bf16 v[28:31], v[44:47], v[92:95], v[28:31]
    ds_read_b64_tr_b16 v[42:43], v77 offset:2048
    s_waitcnt lgkmcnt(12)
    v_mfma_f32_16x16x32_bf16 v[16:19], v[48:51], v[88:91], v[16:19]
    ds_read_b64_tr_b16 v[44:45], v78 offset:0
    v_mfma_f32_16x16x32_bf16 v[32:35], v[48:51], v[92:95], v[32:35]
    ds_read_b64_tr_b16 v[46:47], v78 offset:2048
    buffer_load_dwordx4 v[84:87], v225, s[40:43], s70 offen offset:2048 sc1
    s_waitcnt vmcnt(22) lgkmcnt(12)
    v_mfma_f32_16x16x32_bf16 v[4:7], v[52:55], v[96:99], v[4:7]
    ds_read_b64_tr_b16 v[48:49], v79 offset:0
    v_mfma_f32_16x16x32_bf16 v[20:23], v[52:55], v[100:103], v[20:23]
    ds_read_b64_tr_b16 v[50:51], v79 offset:2048
    s_waitcnt lgkmcnt(12)
    v_mfma_f32_16x16x32_bf16 v[8:11], v[56:59], v[96:99], v[8:11]
    ds_read_b64_tr_b16 v[52:53], v76 offset:4096
    v_mfma_f32_16x16x32_bf16 v[24:27], v[56:59], v[100:103], v[24:27]
    ds_read_b64_tr_b16 v[54:55], v76 offset:6144
    buffer_load_dwordx4 v[88:91], v224, s[40:43], s70 offen offset:3072 sc1
    s_waitcnt lgkmcnt(12)
    v_mfma_f32_16x16x32_bf16 v[12:15], v[60:63], v[96:99], v[12:15]
    ds_read_b64_tr_b16 v[56:57], v77 offset:4096
    v_mfma_f32_16x16x32_bf16 v[28:31], v[60:63], v[100:103], v[28:31]
    ds_read_b64_tr_b16 v[58:59], v77 offset:6144
    s_waitcnt lgkmcnt(12)
    v_mfma_f32_16x16x32_bf16 v[16:19], v[64:67], v[96:99], v[16:19]
    ds_read_b64_tr_b16 v[60:61], v78 offset:4096
    v_mfma_f32_16x16x32_bf16 v[32:35], v[64:67], v[100:103], v[32:35]
    ds_read_b64_tr_b16 v[62:63], v78 offset:6144
    buffer_load_dwordx4 v[92:95], v225, s[40:43], s70 offen offset:3072 sc1
    s_waitcnt vmcnt(22) lgkmcnt(12)
    v_mfma_f32_16x16x32_bf16 v[4:7], v[36:39], v[104:107], v[4:7]
    ds_read_b64_tr_b16 v[64:65], v79 offset:4096
    v_mfma_f32_16x16x32_bf16 v[20:23], v[36:39], v[108:111], v[20:23]
    ds_read_b64_tr_b16 v[66:67], v79 offset:6144
    s_waitcnt lgkmcnt(12)
    v_mfma_f32_16x16x32_bf16 v[8:11], v[40:43], v[104:107], v[8:11]
    ds_read_b64_tr_b16 v[36:37], v68 offset:41984
    v_mfma_f32_16x16x32_bf16 v[24:27], v[40:43], v[108:111], v[24:27]
    ds_read_b64_tr_b16 v[38:39], v68 offset:44032
    buffer_load_dwordx4 v[96:99], v224, s[40:43], s71 offen offset:0 sc1
    s_waitcnt lgkmcnt(12)
    v_mfma_f32_16x16x32_bf16 v[12:15], v[44:47], v[104:107], v[12:15]
    ds_read_b64_tr_b16 v[40:41], v69 offset:41984
    v_mfma_f32_16x16x32_bf16 v[28:31], v[44:47], v[108:111], v[28:31]
    ds_read_b64_tr_b16 v[42:43], v69 offset:44032
    s_waitcnt lgkmcnt(12)
    v_mfma_f32_16x16x32_bf16 v[16:19], v[48:51], v[104:107], v[16:19]
    ds_read_b64_tr_b16 v[44:45], v70 offset:41984
    v_mfma_f32_16x16x32_bf16 v[32:35], v[48:51], v[108:111], v[32:35]
    ds_read_b64_tr_b16 v[46:47], v70 offset:44032
    buffer_load_dwordx4 v[100:103], v225, s[40:43], s71 offen offset:0 sc1
    s_waitcnt vmcnt(22) lgkmcnt(12)
    v_mfma_f32_16x16x32_bf16 v[4:7], v[52:55], v[112:115], v[4:7]
    ds_read_b64_tr_b16 v[48:49], v71 offset:41984
    v_mfma_f32_16x16x32_bf16 v[20:23], v[52:55], v[116:119], v[20:23]
    ds_read_b64_tr_b16 v[50:51], v71 offset:44032
    s_waitcnt lgkmcnt(12)
    v_mfma_f32_16x16x32_bf16 v[8:11], v[56:59], v[112:115], v[8:11]
    ds_read_b64_tr_b16 v[52:53], v68 offset:46080
    v_mfma_f32_16x16x32_bf16 v[24:27], v[56:59], v[116:119], v[24:27]
    ds_read_b64_tr_b16 v[54:55], v68 offset:48128
    buffer_load_dwordx4 v[104:107], v224, s[40:43], s71 offen offset:1024 sc1
    s_waitcnt lgkmcnt(12)
    v_mfma_f32_16x16x32_bf16 v[12:15], v[60:63], v[112:115], v[12:15]
    ds_read_b64_tr_b16 v[56:57], v69 offset:46080
    v_mfma_f32_16x16x32_bf16 v[28:31], v[60:63], v[116:119], v[28:31]
    ds_read_b64_tr_b16 v[58:59], v69 offset:48128
    s_waitcnt lgkmcnt(12)
    v_mfma_f32_16x16x32_bf16 v[16:19], v[64:67], v[112:115], v[16:19]
    ds_read_b64_tr_b16 v[60:61], v70 offset:46080
    v_mfma_f32_16x16x32_bf16 v[32:35], v[64:67], v[116:119], v[32:35]
    ds_read_b64_tr_b16 v[62:63], v70 offset:48128
    buffer_load_dwordx4 v[108:111], v225, s[40:43], s71 offen offset:1024 sc1
    s_waitcnt vmcnt(22) lgkmcnt(12)
    v_mfma_f32_16x16x32_bf16 v[4:7], v[36:39], v[120:123], v[4:7]
    ds_read_b64_tr_b16 v[64:65], v71 offset:46080
    v_mfma_f32_16x16x32_bf16 v[20:23], v[36:39], v[124:127], v[20:23]
    ds_read_b64_tr_b16 v[66:67], v71 offset:48128
    s_waitcnt lgkmcnt(12)
    v_mfma_f32_16x16x32_bf16 v[8:11], v[40:43], v[120:123], v[8:11]
    ds_read_b64_tr_b16 v[36:37], v76 offset:8448
    v_mfma_f32_16x16x32_bf16 v[24:27], v[40:43], v[124:127], v[24:27]
    ds_read_b64_tr_b16 v[38:39], v76 offset:10496
    buffer_load_dwordx4 v[112:115], v224, s[40:43], s71 offen offset:2048 sc1
    s_waitcnt lgkmcnt(12)
    v_mfma_f32_16x16x32_bf16 v[12:15], v[44:47], v[120:123], v[12:15]
    ds_read_b64_tr_b16 v[40:41], v77 offset:8448
    v_mfma_f32_16x16x32_bf16 v[28:31], v[44:47], v[124:127], v[28:31]
    ds_read_b64_tr_b16 v[42:43], v77 offset:10496
    s_waitcnt lgkmcnt(12)
    v_mfma_f32_16x16x32_bf16 v[16:19], v[48:51], v[120:123], v[16:19]
    ds_read_b64_tr_b16 v[44:45], v78 offset:8448
    v_mfma_f32_16x16x32_bf16 v[32:35], v[48:51], v[124:127], v[32:35]
    ds_read_b64_tr_b16 v[46:47], v78 offset:10496
    buffer_load_dwordx4 v[116:119], v225, s[40:43], s71 offen offset:2048 sc1
    s_waitcnt vmcnt(22) lgkmcnt(12)
    v_mfma_f32_16x16x32_bf16 v[4:7], v[52:55], v[128:131], v[4:7]
    ds_read_b64_tr_b16 v[48:49], v79 offset:8448
    v_mfma_f32_16x16x32_bf16 v[20:23], v[52:55], v[132:135], v[20:23]
    ds_read_b64_tr_b16 v[50:51], v79 offset:10496
    s_waitcnt lgkmcnt(12)
    v_mfma_f32_16x16x32_bf16 v[8:11], v[56:59], v[128:131], v[8:11]
    ds_read_b64_tr_b16 v[52:53], v76 offset:12544
    v_mfma_f32_16x16x32_bf16 v[24:27], v[56:59], v[132:135], v[24:27]
    ds_read_b64_tr_b16 v[54:55], v76 offset:14592
    buffer_load_dwordx4 v[120:123], v224, s[40:43], s71 offen offset:3072 sc1
    s_waitcnt lgkmcnt(12)
    v_mfma_f32_16x16x32_bf16 v[12:15], v[60:63], v[128:131], v[12:15]
    ds_read_b64_tr_b16 v[56:57], v77 offset:12544
    v_mfma_f32_16x16x32_bf16 v[28:31], v[60:63], v[132:135], v[28:31]
    ds_read_b64_tr_b16 v[58:59], v77 offset:14592
    s_waitcnt lgkmcnt(12)
    v_mfma_f32_16x16x32_bf16 v[16:19], v[64:67], v[128:131], v[16:19]
    ds_read_b64_tr_b16 v[60:61], v78 offset:12544
    v_mfma_f32_16x16x32_bf16 v[32:35], v[64:67], v[132:135], v[32:35]
    ds_read_b64_tr_b16 v[62:63], v78 offset:14592
    buffer_load_dwordx4 v[124:127], v225, s[40:43], s71 offen offset:3072 sc1
    s_waitcnt vmcnt(22) lgkmcnt(12)
    v_mfma_f32_16x16x32_bf16 v[4:7], v[36:39], v[136:139], v[4:7]
    ds_read_b64_tr_b16 v[64:65], v79 offset:12544
    v_mfma_f32_16x16x32_bf16 v[20:23], v[36:39], v[140:143], v[20:23]
    ds_read_b64_tr_b16 v[66:67], v79 offset:14592
    s_waitcnt lgkmcnt(12)
    v_mfma_f32_16x16x32_bf16 v[8:11], v[40:43], v[136:139], v[8:11]
    ds_read_b64_tr_b16 v[36:37], v68 offset:51200
    v_mfma_f32_16x16x32_bf16 v[24:27], v[40:43], v[140:143], v[24:27]
    ds_read_b64_tr_b16 v[38:39], v68 offset:53248
    s_waitcnt lgkmcnt(12)
    v_mfma_f32_16x16x32_bf16 v[12:15], v[44:47], v[136:139], v[12:15]
    ds_read_b64_tr_b16 v[40:41], v69 offset:51200
    v_mfma_f32_16x16x32_bf16 v[28:31], v[44:47], v[140:143], v[28:31]
    ds_read_b64_tr_b16 v[42:43], v69 offset:53248
    s_waitcnt lgkmcnt(12)
    v_mfma_f32_16x16x32_bf16 v[16:19], v[48:51], v[136:139], v[16:19]
    ds_read_b64_tr_b16 v[44:45], v70 offset:51200
    v_mfma_f32_16x16x32_bf16 v[32:35], v[48:51], v[140:143], v[32:35]
    ds_read_b64_tr_b16 v[46:47], v70 offset:53248
    s_waitcnt vmcnt(20) lgkmcnt(12)
    v_mfma_f32_16x16x32_bf16 v[4:7], v[52:55], v[144:147], v[4:7]
    ds_read_b64_tr_b16 v[48:49], v71 offset:51200
    v_mfma_f32_16x16x32_bf16 v[20:23], v[52:55], v[148:151], v[20:23]
    ds_read_b64_tr_b16 v[50:51], v71 offset:53248
    s_waitcnt lgkmcnt(12)
    v_mfma_f32_16x16x32_bf16 v[8:11], v[56:59], v[144:147], v[8:11]
    ds_read_b64_tr_b16 v[52:53], v68 offset:55296
    v_mfma_f32_16x16x32_bf16 v[24:27], v[56:59], v[148:151], v[24:27]
    ds_read_b64_tr_b16 v[54:55], v68 offset:57344
    s_waitcnt lgkmcnt(12)
    v_mfma_f32_16x16x32_bf16 v[12:15], v[60:63], v[144:147], v[12:15]
    ds_read_b64_tr_b16 v[56:57], v69 offset:55296
    v_mfma_f32_16x16x32_bf16 v[28:31], v[60:63], v[148:151], v[28:31]
    ds_read_b64_tr_b16 v[58:59], v69 offset:57344
    s_waitcnt lgkmcnt(12)
    v_mfma_f32_16x16x32_bf16 v[16:19], v[64:67], v[144:147], v[16:19]
    ds_read_b64_tr_b16 v[60:61], v70 offset:55296
    v_mfma_f32_16x16x32_bf16 v[32:35], v[64:67], v[148:151], v[32:35]
    ds_read_b64_tr_b16 v[62:63], v70 offset:57344
    s_waitcnt vmcnt(18) lgkmcnt(12)
    v_mfma_f32_16x16x32_bf16 v[4:7], v[36:39], v[152:155], v[4:7]
    ds_read_b64_tr_b16 v[64:65], v71 offset:55296
    v_mfma_f32_16x16x32_bf16 v[20:23], v[36:39], v[156:159], v[20:23]
    ds_read_b64_tr_b16 v[66:67], v71 offset:57344
    s_waitcnt lgkmcnt(12)
    v_mfma_f32_16x16x32_bf16 v[8:11], v[40:43], v[152:155], v[8:11]
    ds_read_b64_tr_b16 v[36:37], v76 offset:16896
    v_mfma_f32_16x16x32_bf16 v[24:27], v[40:43], v[156:159], v[24:27]
    ds_read_b64_tr_b16 v[38:39], v76 offset:18944
    s_waitcnt lgkmcnt(12)
    v_mfma_f32_16x16x32_bf16 v[12:15], v[44:47], v[152:155], v[12:15]
    ds_read_b64_tr_b16 v[40:41], v77 offset:16896
    v_mfma_f32_16x16x32_bf16 v[28:31], v[44:47], v[156:159], v[28:31]
    ds_read_b64_tr_b16 v[42:43], v77 offset:18944
    s_waitcnt lgkmcnt(12)
    v_mfma_f32_16x16x32_bf16 v[16:19], v[48:51], v[152:155], v[16:19]
    ds_read_b64_tr_b16 v[44:45], v78 offset:16896
    v_mfma_f32_16x16x32_bf16 v[32:35], v[48:51], v[156:159], v[32:35]
    ds_read_b64_tr_b16 v[46:47], v78 offset:18944
    s_waitcnt vmcnt(16) lgkmcnt(12)
    v_mfma_f32_16x16x32_bf16 v[4:7], v[52:55], v[160:163], v[4:7]
    ds_read_b64_tr_b16 v[48:49], v79 offset:16896
    v_mfma_f32_16x16x32_bf16 v[20:23], v[52:55], v[164:167], v[20:23]
    ds_read_b64_tr_b16 v[50:51], v79 offset:18944
    s_waitcnt lgkmcnt(12)
    v_mfma_f32_16x16x32_bf16 v[8:11], v[56:59], v[160:163], v[8:11]
    ds_read_b64_tr_b16 v[52:53], v76 offset:20992
    v_mfma_f32_16x16x32_bf16 v[24:27], v[56:59], v[164:167], v[24:27]
    ds_read_b64_tr_b16 v[54:55], v76 offset:23040
    s_waitcnt lgkmcnt(12)
    v_mfma_f32_16x16x32_bf16 v[12:15], v[60:63], v[160:163], v[12:15]
    ds_read_b64_tr_b16 v[56:57], v77 offset:20992
    v_mfma_f32_16x16x32_bf16 v[28:31], v[60:63], v[164:167], v[28:31]
    ds_read_b64_tr_b16 v[58:59], v77 offset:23040
    s_waitcnt lgkmcnt(12)
    v_mfma_f32_16x16x32_bf16 v[16:19], v[64:67], v[160:163], v[16:19]
    ds_read_b64_tr_b16 v[60:61], v78 offset:20992
    v_mfma_f32_16x16x32_bf16 v[32:35], v[64:67], v[164:167], v[32:35]
    ds_read_b64_tr_b16 v[62:63], v78 offset:23040
    s_waitcnt vmcnt(14) lgkmcnt(12)
    v_mfma_f32_16x16x32_bf16 v[4:7], v[36:39], v[168:171], v[4:7]
    ds_read_b64_tr_b16 v[64:65], v79 offset:20992
    v_mfma_f32_16x16x32_bf16 v[20:23], v[36:39], v[172:175], v[20:23]
    ds_read_b64_tr_b16 v[66:67], v79 offset:23040
    s_waitcnt lgkmcnt(12)
    v_mfma_f32_16x16x32_bf16 v[8:11], v[40:43], v[168:171], v[8:11]
    ds_read_b64_tr_b16 v[36:37], v72 offset:0
    v_mfma_f32_16x16x32_bf16 v[24:27], v[40:43], v[172:175], v[24:27]
    ds_read_b64_tr_b16 v[38:39], v72 offset:2048
    s_waitcnt lgkmcnt(12)
    v_mfma_f32_16x16x32_bf16 v[12:15], v[44:47], v[168:171], v[12:15]
    ds_read_b64_tr_b16 v[40:41], v73 offset:0
    v_mfma_f32_16x16x32_bf16 v[28:31], v[44:47], v[172:175], v[28:31]
    ds_read_b64_tr_b16 v[42:43], v73 offset:2048
    s_waitcnt lgkmcnt(12)
    v_mfma_f32_16x16x32_bf16 v[16:19], v[48:51], v[168:171], v[16:19]
    ds_read_b64_tr_b16 v[44:45], v74 offset:0
    v_mfma_f32_16x16x32_bf16 v[32:35], v[48:51], v[172:175], v[32:35]
    ds_read_b64_tr_b16 v[46:47], v74 offset:2048
    s_waitcnt vmcnt(12) lgkmcnt(12)
    v_mfma_f32_16x16x32_bf16 v[4:7], v[52:55], v[176:179], v[4:7]
    ds_read_b64_tr_b16 v[48:49], v75 offset:0
    v_mfma_f32_16x16x32_bf16 v[20:23], v[52:55], v[180:183], v[20:23]
    ds_read_b64_tr_b16 v[50:51], v75 offset:2048
    s_waitcnt lgkmcnt(12)
    v_mfma_f32_16x16x32_bf16 v[8:11], v[56:59], v[176:179], v[8:11]
    ds_read_b64_tr_b16 v[52:53], v72 offset:4096
    v_mfma_f32_16x16x32_bf16 v[24:27], v[56:59], v[180:183], v[24:27]
    ds_read_b64_tr_b16 v[54:55], v72 offset:6144
    s_waitcnt lgkmcnt(12)
    v_mfma_f32_16x16x32_bf16 v[12:15], v[60:63], v[176:179], v[12:15]
    ds_read_b64_tr_b16 v[56:57], v73 offset:4096
    v_mfma_f32_16x16x32_bf16 v[28:31], v[60:63], v[180:183], v[28:31]
    ds_read_b64_tr_b16 v[58:59], v73 offset:6144
    s_waitcnt lgkmcnt(12)
    v_mfma_f32_16x16x32_bf16 v[16:19], v[64:67], v[176:179], v[16:19]
    ds_read_b64_tr_b16 v[60:61], v74 offset:4096
    v_mfma_f32_16x16x32_bf16 v[32:35], v[64:67], v[180:183], v[32:35]
    ds_read_b64_tr_b16 v[62:63], v74 offset:6144
    s_waitcnt vmcnt(10) lgkmcnt(12)
    v_mfma_f32_16x16x32_bf16 v[4:7], v[36:39], v[80:83], v[4:7]
    ds_read_b64_tr_b16 v[64:65], v75 offset:4096
    v_mfma_f32_16x16x32_bf16 v[20:23], v[36:39], v[84:87], v[20:23]
    ds_read_b64_tr_b16 v[66:67], v75 offset:6144
    s_waitcnt lgkmcnt(12)
    v_mfma_f32_16x16x32_bf16 v[8:11], v[40:43], v[80:83], v[8:11]
    ds_read_b64_tr_b16 v[36:37], v76 offset:25344
    v_mfma_f32_16x16x32_bf16 v[24:27], v[40:43], v[84:87], v[24:27]
    ds_read_b64_tr_b16 v[38:39], v76 offset:27392
    s_waitcnt lgkmcnt(12)
    v_mfma_f32_16x16x32_bf16 v[12:15], v[44:47], v[80:83], v[12:15]
    ds_read_b64_tr_b16 v[40:41], v77 offset:25344
    v_mfma_f32_16x16x32_bf16 v[28:31], v[44:47], v[84:87], v[28:31]
    ds_read_b64_tr_b16 v[42:43], v77 offset:27392
    s_waitcnt lgkmcnt(12)
    v_mfma_f32_16x16x32_bf16 v[16:19], v[48:51], v[80:83], v[16:19]
    ds_read_b64_tr_b16 v[44:45], v78 offset:25344
    v_mfma_f32_16x16x32_bf16 v[32:35], v[48:51], v[84:87], v[32:35]
    ds_read_b64_tr_b16 v[46:47], v78 offset:27392
    s_waitcnt vmcnt(8) lgkmcnt(12)
    v_mfma_f32_16x16x32_bf16 v[4:7], v[52:55], v[88:91], v[4:7]
    ds_read_b64_tr_b16 v[48:49], v79 offset:25344
    v_mfma_f32_16x16x32_bf16 v[20:23], v[52:55], v[92:95], v[20:23]
    ds_read_b64_tr_b16 v[50:51], v79 offset:27392
    s_waitcnt lgkmcnt(12)
    v_mfma_f32_16x16x32_bf16 v[8:11], v[56:59], v[88:91], v[8:11]
    ds_read_b64_tr_b16 v[52:53], v76 offset:29440
    v_mfma_f32_16x16x32_bf16 v[24:27], v[56:59], v[92:95], v[24:27]
    ds_read_b64_tr_b16 v[54:55], v76 offset:31488
    s_waitcnt lgkmcnt(12)
    v_mfma_f32_16x16x32_bf16 v[12:15], v[60:63], v[88:91], v[12:15]
    ds_read_b64_tr_b16 v[56:57], v77 offset:29440
    v_mfma_f32_16x16x32_bf16 v[28:31], v[60:63], v[92:95], v[28:31]
    ds_read_b64_tr_b16 v[58:59], v77 offset:31488
    s_waitcnt lgkmcnt(12)
    v_mfma_f32_16x16x32_bf16 v[16:19], v[64:67], v[88:91], v[16:19]
    ds_read_b64_tr_b16 v[60:61], v78 offset:29440
    v_mfma_f32_16x16x32_bf16 v[32:35], v[64:67], v[92:95], v[32:35]
    ds_read_b64_tr_b16 v[62:63], v78 offset:31488
    s_waitcnt vmcnt(6) lgkmcnt(12)
    v_mfma_f32_16x16x32_bf16 v[4:7], v[36:39], v[96:99], v[4:7]
    ds_read_b64_tr_b16 v[64:65], v79 offset:29440
    v_mfma_f32_16x16x32_bf16 v[20:23], v[36:39], v[100:103], v[20:23]
    ds_read_b64_tr_b16 v[66:67], v79 offset:31488
    s_waitcnt lgkmcnt(12)
    v_mfma_f32_16x16x32_bf16 v[8:11], v[40:43], v[96:99], v[8:11]
    ds_read_b64_tr_b16 v[36:37], v72 offset:9216
    v_mfma_f32_16x16x32_bf16 v[24:27], v[40:43], v[100:103], v[24:27]
    ds_read_b64_tr_b16 v[38:39], v72 offset:11264
    s_waitcnt lgkmcnt(12)
    v_mfma_f32_16x16x32_bf16 v[12:15], v[44:47], v[96:99], v[12:15]
    ds_read_b64_tr_b16 v[40:41], v73 offset:9216
    v_mfma_f32_16x16x32_bf16 v[28:31], v[44:47], v[100:103], v[28:31]
    ds_read_b64_tr_b16 v[42:43], v73 offset:11264
    s_waitcnt lgkmcnt(12)
    v_mfma_f32_16x16x32_bf16 v[16:19], v[48:51], v[96:99], v[16:19]
    ds_read_b64_tr_b16 v[44:45], v74 offset:9216
    v_mfma_f32_16x16x32_bf16 v[32:35], v[48:51], v[100:103], v[32:35]
    ds_read_b64_tr_b16 v[46:47], v74 offset:11264
    s_waitcnt vmcnt(4) lgkmcnt(12)
    v_mfma_f32_16x16x32_bf16 v[4:7], v[52:55], v[104:107], v[4:7]
    ds_read_b64_tr_b16 v[48:49], v75 offset:9216
    v_mfma_f32_16x16x32_bf16 v[20:23], v[52:55], v[108:111], v[20:23]
    ds_read_b64_tr_b16 v[50:51], v75 offset:11264
    s_waitcnt lgkmcnt(12)
    v_mfma_f32_16x16x32_bf16 v[8:11], v[56:59], v[104:107], v[8:11]
    ds_read_b64_tr_b16 v[52:53], v72 offset:13312
    v_mfma_f32_16x16x32_bf16 v[24:27], v[56:59], v[108:111], v[24:27]
    ds_read_b64_tr_b16 v[54:55], v72 offset:15360
    s_waitcnt lgkmcnt(12)
    v_mfma_f32_16x16x32_bf16 v[12:15], v[60:63], v[104:107], v[12:15]
    ds_read_b64_tr_b16 v[56:57], v73 offset:13312
    v_mfma_f32_16x16x32_bf16 v[28:31], v[60:63], v[108:111], v[28:31]
    ds_read_b64_tr_b16 v[58:59], v73 offset:15360
    s_waitcnt lgkmcnt(12)
    v_mfma_f32_16x16x32_bf16 v[16:19], v[64:67], v[104:107], v[16:19]
    ds_read_b64_tr_b16 v[60:61], v74 offset:13312
    v_mfma_f32_16x16x32_bf16 v[32:35], v[64:67], v[108:111], v[32:35]
    ds_read_b64_tr_b16 v[62:63], v74 offset:15360
    s_waitcnt vmcnt(2) lgkmcnt(12)
    v_mfma_f32_16x16x32_bf16 v[4:7], v[36:39], v[112:115], v[4:7]
    ds_read_b64_tr_b16 v[64:65], v75 offset:13312
    v_mfma_f32_16x16x32_bf16 v[20:23], v[36:39], v[116:119], v[20:23]
    ds_read_b64_tr_b16 v[66:67], v75 offset:15360
    s_waitcnt lgkmcnt(12)
    v_mfma_f32_16x16x32_bf16 v[8:11], v[40:43], v[112:115], v[8:11]
    v_mfma_f32_16x16x32_bf16 v[24:27], v[40:43], v[116:119], v[24:27]
    s_waitcnt lgkmcnt(10)
    v_mfma_f32_16x16x32_bf16 v[12:15], v[44:47], v[112:115], v[12:15]
    v_mfma_f32_16x16x32_bf16 v[28:31], v[44:47], v[116:119], v[28:31]
    s_waitcnt lgkmcnt(8)
    v_mfma_f32_16x16x32_bf16 v[16:19], v[48:51], v[112:115], v[16:19]
    v_mfma_f32_16x16x32_bf16 v[32:35], v[48:51], v[116:119], v[32:35]
    s_waitcnt vmcnt(0) lgkmcnt(6)
    v_mfma_f32_16x16x32_bf16 v[4:7], v[52:55], v[120:123], v[4:7]
    v_mfma_f32_16x16x32_bf16 v[20:23], v[52:55], v[124:127], v[20:23]
    s_waitcnt lgkmcnt(4)
    v_mfma_f32_16x16x32_bf16 v[8:11], v[56:59], v[120:123], v[8:11]
    v_mfma_f32_16x16x32_bf16 v[24:27], v[56:59], v[124:127], v[24:27]
    s_waitcnt lgkmcnt(2)
    v_mfma_f32_16x16x32_bf16 v[12:15], v[60:63], v[120:123], v[12:15]
    v_mfma_f32_16x16x32_bf16 v[28:31], v[60:63], v[124:127], v[28:31]
    s_waitcnt lgkmcnt(0)
    v_mfma_f32_16x16x32_bf16 v[16:19], v[64:67], v[120:123], v[16:19]
    v_mfma_f32_16x16x32_bf16 v[32:35], v[64:67], v[124:127], v[32:35]
    v_cvt_pk_bf16_f32 v36, v4, v5
    v_cvt_pk_bf16_f32 v37, v6, v7
    v_cvt_pk_bf16_f32 v38, v8, v9
    v_cvt_pk_bf16_f32 v39, v10, v11
    v_cvt_pk_bf16_f32 v40, v12, v13
    v_cvt_pk_bf16_f32 v41, v14, v15
    s_nop 0
    v_cvt_pk_bf16_f32 v42, v16, v17
    v_cvt_pk_bf16_f32 v43, v18, v19
    v_cvt_pk_bf16_f32 v44, v20, v21
    v_cvt_pk_bf16_f32 v45, v22, v23
    v_cvt_pk_bf16_f32 v46, v24, v25
    v_cvt_pk_bf16_f32 v47, v26, v27
    v_cvt_pk_bf16_f32 v48, v28, v29
    v_cvt_pk_bf16_f32 v49, v30, v31
    v_cvt_pk_bf16_f32 v50, v32, v33
    v_cvt_pk_bf16_f32 v51, v34, v35
    v_permlane16_swap_b32 v36, v38
    v_permlane16_swap_b32 v37, v39
    v_permlane16_swap_b32 v40, v42
    v_permlane16_swap_b32 v41, v43
    v_permlane16_swap_b32 v44, v46
    v_permlane16_swap_b32 v45, v47
    v_permlane16_swap_b32 v48, v50
    v_permlane16_swap_b32 v49, v51
    s_mov_b32 s37, 131072
    buffer_store_dwordx4 v[36:39], v226, s[48:51], 0 offen offset:0
    buffer_store_dwordx4 v[40:43], v226, s[48:51], 0 offen offset:64
    buffer_store_dwordx4 v[44:47], v226, s[48:51], s37 offen offset:0
    buffer_store_dwordx4 v[48:51], v226, s[48:51], s37 offen offset:64
    s_endpgm
L_end:
    s_endpgm
.section .rodata,"a"
.p2align 6
.amdhsa_kernel concat_heads__ssm_conv_h3__sliding_local_dilated__prompt_kernel
  .amdhsa_next_free_vgpr 256
  .amdhsa_next_free_sgpr 102
  .amdhsa_accum_offset 256
  .amdhsa_group_segment_fixed_size 0
  .amdhsa_kernarg_size 96
  .amdhsa_user_sgpr_count 2
  .amdhsa_user_sgpr_kernarg_segment_ptr 1
  .amdhsa_system_sgpr_workgroup_id_x 1
  .amdhsa_float_denorm_mode_32 3
.end_amdhsa_kernel
```

```asm
; @launch grid=(256,1,1) block=(512,1,1) lds=163840
.amdgcn_target "amdgcn-amd-amdhsa--gfx950"
.text
.globl concat_heads__ssm_conv_h3__sliding_local_dilated__prompt_kernel
.p2align 8
.type concat_heads__ssm_conv_h3__sliding_local_dilated__prompt_kernel,@function
concat_heads__ssm_conv_h3__sliding_local_dilated__prompt_kernel:
L_entry:
    s_getpc_b64 s[32:33]
    s_cmp_ge_u32 s2, 256
    s_cbranch_scc1 L_end
    s_load_dwordx16 s[8:23], s[0:1], 0
    s_load_dwordx8 s[24:31], s[0:1], 64
    v_lshrrev_b32 v1, 6, v0
    s_and_b32 s4, s2, 1
    v_readfirstlane_b32 s3, v1
    v_and_b32 v0, 63, v0
    s_bfe_u32 s5, s2, 0x30003
    s_bfe_u32 s6, s2, 0x20001
    s_lshr_b32 s7, s2, 6
    s_lshl2_add_u32 s6, s6, s7
    s_cmp_ge_u32 s3, 4
    s_cbranch_scc1 L_crole
    s_bfe_u32 s34, s2, 0x20003
    s_lshl2_add_u32 s34, s34, s3
    s_lshl_b32 s34, s34, 7
    v_lshl_add_u32 v1, v0, 11, s34
    v_min_u32 v1, L_end-L_entry-8, v1
    s_mov_b64 exec, 0xffff
    global_load_dword v249, v1, s[32:33]
    s_mov_b64 exec, -1
    s_and_b32 s84, s2, 7
    s_lshr_b32 s87, s3, 1
    s_lshl1_add_u32 s84, s84, s87
    s_lshr_b32 s85, s2, 3
    s_and_b32 s87, s3, 1
    s_lshl1_add_u32 s85, s85, s87
    s_mul_i32 s86, s3, 4736
    s_add_u32 s86, s86, 83968
    s_lshl_b32 s87, s85, 9
    s_add_u32 s87, s87, s84
    s_lshl_b32 s87, s87, 7
    v_and_b32 v231, 7, v0
    v_lshl_add_u32 v231, v231, 4, s87
    v_lshrrev_b32 v230, 3, v0
    v_lshl_add_u32 v230, v230, 13, v231
    v_subrev_u32 v231, 6144, v230
    v_subrev_u32 v232, 4096, v230
    v_subrev_u32 v233, 2048, v230
    v_add_u32 v234, 4096, v230
    v_lshlrev_b32 v235, 4, v0
    s_lshl_b32 s87, s84, 9
    s_add_u32 m0, s86, 4224
    s_lshr_b32 s90, s2, 3
    s_and_b32 s91, s3, 3
    s_lshl2_add_u32 s90, s90, s91
    s_and_b32 s91, s2, 6
    s_lshl3_add_u32 s88, s90, s91
    s_lshl1_add_u32 s88, s88, s4
    s_lshl_b32 s88, s88, 11
    s_and_b32 s89, s2, 7
    s_and_b32 s91, s90, 1
    s_lshl1_add_u32 s89, s89, s91
    s_lshr_b32 s90, s90, 1
    s_mul_i32 s90, s90, 48
    s_add_u32 s89, s89, s90
    s_lshl_b32 s89, s89, 7
    v_and_b32 v251, 1, v0
    v_lshlrev_b32 v251, 12, v251
    v_lshrrev_b32 v252, 1, v0
    v_lshl_add_u32 v251, v252, 7, v251
    v_lshrrev_b32 v250, 2, v0
    v_mul_u32_u24 v250, 393216, v250
    v_and_b32 v252, 3, v0
    v_lshl_add_u32 v252, v252, 11, v250
    s_or_b32 s7, s2, s3
    s_waitcnt lgkmcnt(0)
    s_add_u32 s52, s30, 0xe00000
    s_addc_u32 s53, s31, 0
    s_mov_b32 s54, 0x4000
    s_mov_b32 s55, 0x20000
    s_cmp_lg_u32 s7, 0
    s_cbranch_scc1 L_noinit
    v_lshlrev_b32 v1, 8, v0
    v_mov_b32 v2, 0
    buffer_store_dword v2, v1, s[52:55], 0 offen sc1
L_noinit:
    s_mov_b32 s80, s14
    s_mov_b32 s81, s15
    s_mov_b32 s82, 0x2000
    s_mov_b32 s83, 0x20000
    s_mov_b32 s72, s10
    s_mov_b32 s73, s11
    s_mov_b32 s74, 0x400000
    s_mov_b32 s75, 0x20000
    s_mov_b32 exec_hi, 0
    buffer_load_dwordx4 v235, s[80:83], s87 offen lds
    s_mov_b64 exec, -1
    buffer_load_dwordx4 v[108:111], v231, s[72:75], 0 offen offset:0 nt
    buffer_load_dwordx4 v[112:115], v232, s[72:75], 0 offen offset:0 nt
    buffer_load_dwordx4 v[116:119], v233, s[72:75], 0 offen offset:0 nt
    buffer_load_dwordx4 v[120:123], v230, s[72:75], 0 offen offset:0 nt
    buffer_load_dwordx4 v[124:127], v230, s[72:75], 0 offen offset:2048 nt
    buffer_load_dwordx4 v[128:131], v234, s[72:75], 0 offen offset:0 nt
    buffer_load_dwordx4 v[132:135], v234, s[72:75], 0 offen offset:2048 nt
    s_mov_b32 s76, s12
    s_mov_b32 s77, s13
    s_mov_b32 s78, 0x400000
    s_mov_b32 s79, 0x20000
    buffer_load_dwordx4 v[136:139], v230, s[76:79], 0 offen offset:0 nt
    buffer_load_dwordx4 v[140:143], v230, s[76:79], 0 offen offset:2048 nt
    buffer_load_dwordx4 v[144:147], v234, s[76:79], 0 offen offset:0 nt
    buffer_load_dwordx4 v[148:151], v234, s[76:79], 0 offen offset:2048 nt
    s_mov_b32 s64, s20
    s_mov_b32 s65, s21
    s_mov_b32 s66, 0x400000
    s_mov_b32 s67, 0x20000
    s_mov_b32 s68, s22
    s_mov_b32 s69, s23
    s_mov_b32 s70, 0x600000
    s_mov_b32 s71, 0x20000
    s_mov_b32 exec_lo, 0x777777
    s_mov_b32 exec_hi, 0x0
    buffer_load_dword v250, v252, s[68:71], s89 offen
    s_xor_b32 s89, s89, 256
    buffer_load_dword v250, v252, s[68:71], s89 offen
    s_xor_b32 s89, s89, 256
    s_mov_b32 exec_lo, 0xfff
    s_mov_b32 exec_hi, 0
    buffer_load_dword v250, v251, s[64:67], s88 offen
    s_mov_b64 exec, -1
    s_barrier
    s_branch L_grole
L_crole:
    s_sub_u32 s70, s3, 4
    s_lshl_b32 s43, s70, 12
    s_lshl_b32 s44, s70, 11
    s_add_u32 s44, s44, 17408
    s_lshl_b32 s49, s70, 4
    s_lshl_b64 s[46:47], 0xffff, s49
    v_lshrrev_b32 v13, 3, v0
    v_and_b32 v14, 7, v0
    v_lshrrev_b32 v15, 4, v0
    s_lshl2_add_u32 s50, s5, s70
    s_lshl_b32 s50, s50, 6
    s_add_u32 s50, s50, s4
    s_lshl_b32 s50, s50, 11
    v_lshl_add_u32 v16, v13, 12, s50
    v_xor_b32 v17, v14, v15
    v_lshl_add_u32 v2, v17, 4, v16
    v_xor_b32 v3, 64, v2
    v_add_u32 v3, 31744, v3
    v_add_u32 v4, 63488, v2
    v_add_u32 v5, 63488, v3
    s_lshl_b32 s49, s5, 7
    s_sub_u32 s49, s49, 8
    s_max_i32 s49, s49, 0
    s_lshl1_add_u32 s49, s49, s4
    s_lshl_b32 s49, s49, 11
    v_lshl_add_u32 v16, v13, 12, s49
    v_lshlrev_b32 v17, 1, v15
    v_xor_b32 v18, v14, v17
    v_lshl_add_u32 v6, v18, 4, v16
    s_mul_i32 s49, s70, 768
    s_add_u32 s49, s49, s6
    s_lshl_b32 s49, s49, 7
    v_mul_u32_u24 v16, 6144, v13
    v_and_b32 v17, 2, v17
    v_xor_b32 v17, v14, v17
    v_lshlrev_b32 v17, 4, v17
    v_add3_u32 v7, v17, v16, s49
    v_xor_b32 v8, 64, v7
    v_add_u32 v8, 48128, v8
    v_add_u32 v9, 2048, v7
    v_add_u32 v10, 2048, v8
    v_add_u32 v11, 4096, v7
    v_add_u32 v12, 4096, v8
    s_mov_b32 s40, 0
    s_mov_b32 s41, 0
    s_waitcnt lgkmcnt(0)
    s_mov_b32 s32, s20
    s_mov_b32 s33, s21
    s_mov_b32 s34, 0x400000
    s_mov_b32 s35, 0x20000
    s_mov_b32 s36, s22
    s_mov_b32 s37, s23
    s_mov_b32 s38, 0x600000
    s_mov_b32 s39, 0x20000
    s_setprio 0
    s_and_b32 s73, s2, 7
    s_lshr_b32 s74, s2, 7
    s_lshl1_add_u32 s68, s73, s74
    s_lshl_b32 s73, s73, 8
    s_bfe_u32 s69, s2, 0x40003
    s_lshl4_add_u32 s71, s68, s69
    s_lshl2_add_u32 s71, s71, s70
    s_mul_i32 s80, s70, 8448
    s_add_u32 s80, s80, 125952
    s_mul_i32 s81, s70, 9216
    s_add_u32 s81, s81, 41984
    s_add_u32 s52, s30, 0xe00000
    s_addc_u32 s53, s31, 0
    s_mov_b32 s54, 0x4000
    s_mov_b32 s55, 0x20000
    s_add_u32 s64, s30, 0x900000
    s_addc_u32 s65, s31, 0
    s_mov_b32 s66, 0x420000
    s_mov_b32 s67, 0x20000
    s_lshl_b32 s84, s71, 12
    s_mul_i32 s85, s71, 4224
    s_add_u32 s85, s85, 4194304
    s_lshr_b32 s74, s71, 1
    s_lshl_b32 s74, s74, 2
    s_load_dword s72, s[18:19], s74
    v_lshlrev_b32 v224, 4, v0
    v_mov_b32 v228, 0
    v_mov_b32 v229, 0
    v_mov_b32 v230, 0
    v_mov_b32 v231, 0
    v_mov_b32 v227, 134352
    v_mov_b32 v244, 1
    s_bfe_u32 s87, s2, 0x10003
    s_mov_b64 exec, 1
    ds_write_b128 v227, v[228:231]
    ds_write_b128 v227, v[228:231] offset:16
    s_mov_b64 exec, -1
    s_lshr_b32 s90, s2, 3
    s_and_b32 s91, s3, 3
    s_lshl2_add_u32 s90, s90, s91
    s_and_b32 s91, s2, 6
    s_lshl3_add_u32 s88, s90, s91
    s_lshl1_add_u32 s88, s88, s4
    s_lshl_b32 s88, s88, 11
    s_and_b32 s89, s2, 7
    s_and_b32 s91, s90, 1
    s_lshl1_add_u32 s89, s89, s91
    s_lshr_b32 s90, s90, 1
    s_mul_i32 s90, s90, 48
    s_add_u32 s89, s89, s90
    s_lshl_b32 s89, s89, 7
    v_and_b32 v251, 1, v0
    v_lshlrev_b32 v251, 12, v251
    v_lshrrev_b32 v252, 1, v0
    v_lshl_add_u32 v251, v252, 7, v251
    v_lshrrev_b32 v250, 2, v0
    v_mul_u32_u24 v250, 393216, v250
    v_and_b32 v252, 3, v0
    v_lshl_add_u32 v252, v252, 11, v250
    s_barrier
    s_add_u32 m0, s43, 0
    s_nop 0
    buffer_load_dwordx4 v2, s[32:35], s40 offen offset:0 lds
    s_add_u32 m0, s44, 0
    s_nop 0
    buffer_load_dwordx4 v7, s[36:39], s41 offen offset:0 lds
    buffer_load_dwordx4 v8, s[36:39], s41 offen offset:1024 lds
    s_add_u32 m0, s43, 0
    s_nop 0
    buffer_load_dwordx4 v3, s[32:35], s40 offen offset:1024 lds
    s_add_u32 m0, s44, 8192
    s_nop 0
    buffer_load_dwordx4 v9, s[36:39], s41 offen offset:0 lds
    buffer_load_dwordx4 v10, s[36:39], s41 offen offset:1024 lds
    s_add_u32 m0, s43, 0
    s_nop 0
    buffer_load_dwordx4 v4, s[32:35], s40 offen offset:2048 lds
    s_add_u32 m0, s44, 16384
    s_nop 0
    buffer_load_dwordx4 v11, s[36:39], s41 offen offset:0 lds
    buffer_load_dwordx4 v12, s[36:39], s41 offen offset:1024 lds
    s_add_u32 m0, s43, 0
    s_nop 0
    buffer_load_dwordx4 v5, s[32:35], s40 offen offset:3072 lds
    s_mov_b32 m0, 16384
    s_mov_b64 exec, s[46:47]
    buffer_load_dwordx4 v6, s[32:35], s40 offen lds
    s_mov_b64 exec, -1
    s_movk_i32 s40, 128
    s_mov_b32 s41, 393216
    s_add_u32 m0, s43, 41984
    s_nop 0
    buffer_load_dwordx4 v2, s[32:35], s40 offen offset:0 lds
    s_add_u32 m0, s44, 41984
    s_nop 0
    buffer_load_dwordx4 v7, s[36:39], s41 offen offset:0 lds
    buffer_load_dwordx4 v8, s[36:39], s41 offen offset:1024 lds
    s_add_u32 m0, s43, 41984
    s_nop 0
    buffer_load_dwordx4 v3, s[32:35], s40 offen offset:1024 lds
    s_add_u32 m0, s44, 50176
    s_nop 0
    buffer_load_dwordx4 v9, s[36:39], s41 offen offset:0 lds
    buffer_load_dwordx4 v10, s[36:39], s41 offen offset:1024 lds
    s_add_u32 m0, s43, 41984
    s_nop 0
    buffer_load_dwordx4 v4, s[32:35], s40 offen offset:2048 lds
    s_add_u32 m0, s44, 58368
    s_nop 0
    buffer_load_dwordx4 v11, s[36:39], s41 offen offset:0 lds
    buffer_load_dwordx4 v12, s[36:39], s41 offen offset:1024 lds
    s_add_u32 m0, s43, 41984
    s_nop 0
    buffer_load_dwordx4 v5, s[32:35], s40 offen offset:3072 lds
    s_mov_b32 m0, 58368
    s_mov_b64 exec, s[46:47]
    buffer_load_dwordx4 v6, s[32:35], s40 offen lds
    s_mov_b64 exec, -1
    s_movk_i32 s40, 256
    s_mov_b32 s41, 786432
    s_waitcnt vmcnt(11)
    s_barrier
    s_add_u32 m0, s43, 83968
    s_nop 0
    buffer_load_dwordx4 v2, s[32:35], s40 offen offset:0 lds
    s_add_u32 m0, s44, 83968
    s_nop 0
    buffer_load_dwordx4 v7, s[36:39], s41 offen offset:0 lds
    buffer_load_dwordx4 v8, s[36:39], s41 offen offset:1024 lds
    s_add_u32 m0, s43, 83968
    s_nop 0
    buffer_load_dwordx4 v3, s[32:35], s40 offen offset:1024 lds
    s_add_u32 m0, s44, 92160
    s_nop 0
    buffer_load_dwordx4 v9, s[36:39], s41 offen offset:0 lds
    buffer_load_dwordx4 v10, s[36:39], s41 offen offset:1024 lds
    s_add_u32 m0, s43, 83968
    s_nop 0
    buffer_load_dwordx4 v4, s[32:35], s40 offen offset:2048 lds
    s_add_u32 m0, s44, 100352
    s_nop 0
    buffer_load_dwordx4 v11, s[36:39], s41 offen offset:0 lds
    buffer_load_dwordx4 v12, s[36:39], s41 offen offset:1024 lds
    s_add_u32 m0, s43, 83968
    s_nop 0
    buffer_load_dwordx4 v5, s[32:35], s40 offen offset:3072 lds
    s_mov_b32 m0, 100352
    s_mov_b64 exec, s[46:47]
    buffer_load_dwordx4 v6, s[32:35], s40 offen lds
    s_mov_b64 exec, -1
    s_movk_i32 s40, 384
    s_mov_b32 s41, 1179648
    s_waitcnt vmcnt(11)
    s_barrier
    s_cmp_lg_u32 s87, 0
    s_cbranch_scc1 L_stg_3
    s_mov_b32 exec_lo, 0x77000000
    s_mov_b32 exec_hi, 0x777
    buffer_load_dword v250, v252, s[36:39], s89 offen
    s_xor_b32 s89, s89, 256
    buffer_load_dword v250, v252, s[36:39], s89 offen
    s_xor_b32 s89, s89, 256
    s_mov_b32 exec_lo, 0x3ff000
    s_mov_b32 exec_hi, 0
    buffer_load_dword v250, v251, s[32:35], s88 offen
    s_mov_b64 exec, -1
L_stg_3:
    s_add_u32 m0, s43, 0
    s_nop 0
    buffer_load_dwordx4 v2, s[32:35], s40 offen offset:0 lds
    s_add_u32 m0, s44, 0
    s_nop 0
    buffer_load_dwordx4 v7, s[36:39], s41 offen offset:0 lds
    buffer_load_dwordx4 v8, s[36:39], s41 offen offset:1024 lds
    s_add_u32 m0, s43, 0
    s_nop 0
    buffer_load_dwordx4 v3, s[32:35], s40 offen offset:1024 lds
    s_add_u32 m0, s44, 8192
    s_nop 0
    buffer_load_dwordx4 v9, s[36:39], s41 offen offset:0 lds
    buffer_load_dwordx4 v10, s[36:39], s41 offen offset:1024 lds
    s_add_u32 m0, s43, 0
    s_nop 0
    buffer_load_dwordx4 v4, s[32:35], s40 offen offset:2048 lds
    s_add_u32 m0, s44, 16384
    s_nop 0
    buffer_load_dwordx4 v11, s[36:39], s41 offen offset:0 lds
    buffer_load_dwordx4 v12, s[36:39], s41 offen offset:1024 lds
    s_add_u32 m0, s43, 0
    s_nop 0
    buffer_load_dwordx4 v5, s[32:35], s40 offen offset:3072 lds
    s_mov_b32 m0, 16384
    s_mov_b64 exec, s[46:47]
    buffer_load_dwordx4 v6, s[32:35], s40 offen lds
    s_mov_b64 exec, -1
    s_movk_i32 s40, 512
    s_mov_b32 s41, 1572864
    s_waitcnt vmcnt(14)
    s_bitcmp1_b32 1, s87
    s_cbranch_scc1 L_mw_4
    s_waitcnt vmcnt(11)
L_mw_4:
    s_barrier
    s_cmp_lg_u32 s87, 1
    s_cbranch_scc1 L_stg_5
    s_mov_b32 exec_lo, 0x77000000
    s_mov_b32 exec_hi, 0x777
    buffer_load_dword v250, v252, s[36:39], s89 offen
    s_xor_b32 s89, s89, 256
    buffer_load_dword v250, v252, s[36:39], s89 offen
    s_xor_b32 s89, s89, 256
    s_mov_b32 exec_lo, 0x3ff000
    s_mov_b32 exec_hi, 0
    buffer_load_dword v250, v251, s[32:35], s88 offen
    s_mov_b64 exec, -1
L_stg_5:
    s_add_u32 m0, s43, 41984
    s_nop 0
    buffer_load_dwordx4 v2, s[32:35], s40 offen offset:0 lds
    s_add_u32 m0, s44, 41984
    s_nop 0
    buffer_load_dwordx4 v7, s[36:39], s41 offen offset:0 lds
    buffer_load_dwordx4 v8, s[36:39], s41 offen offset:1024 lds
    s_add_u32 m0, s43, 41984
    s_nop 0
    buffer_load_dwordx4 v3, s[32:35], s40 offen offset:1024 lds
    s_add_u32 m0, s44, 50176
    s_nop 0
    buffer_load_dwordx4 v9, s[36:39], s41 offen offset:0 lds
    buffer_load_dwordx4 v10, s[36:39], s41 offen offset:1024 lds
    s_add_u32 m0, s43, 41984
    s_nop 0
    buffer_load_dwordx4 v4, s[32:35], s40 offen offset:2048 lds
    s_add_u32 m0, s44, 58368
    s_nop 0
    buffer_load_dwordx4 v11, s[36:39], s41 offen offset:0 lds
    buffer_load_dwordx4 v12, s[36:39], s41 offen offset:1024 lds
    s_add_u32 m0, s43, 41984
    s_nop 0
    buffer_load_dwordx4 v5, s[32:35], s40 offen offset:3072 lds
    s_mov_b32 m0, 58368
    s_mov_b64 exec, s[46:47]
    buffer_load_dwordx4 v6, s[32:35], s40 offen lds
    s_mov_b64 exec, -1
    s_movk_i32 s40, 640
    s_mov_b32 s41, 1966080
    s_waitcnt vmcnt(14)
    s_bitcmp1_b32 2, s87
    s_cbranch_scc1 L_mw_6
    s_waitcnt vmcnt(11)
L_mw_6:
    s_barrier
    s_load_dword s78, s[28:29], 0
    s_add_u32 m0, s43, 83968
    s_nop 0
    buffer_load_dwordx4 v2, s[32:35], s40 offen offset:0 lds
    s_add_u32 m0, s44, 83968
    s_nop 0
    buffer_load_dwordx4 v7, s[36:39], s41 offen offset:0 lds
    buffer_load_dwordx4 v8, s[36:39], s41 offen offset:1024 lds
    s_add_u32 m0, s43, 83968
    s_nop 0
    buffer_load_dwordx4 v3, s[32:35], s40 offen offset:1024 lds
    s_add_u32 m0, s44, 92160
    s_nop 0
    buffer_load_dwordx4 v9, s[36:39], s41 offen offset:0 lds
    buffer_load_dwordx4 v10, s[36:39], s41 offen offset:1024 lds
    s_add_u32 m0, s43, 83968
    s_nop 0
    buffer_load_dwordx4 v4, s[32:35], s40 offen offset:2048 lds
    s_add_u32 m0, s44, 100352
    s_nop 0
    buffer_load_dwordx4 v11, s[36:39], s41 offen offset:0 lds
    buffer_load_dwordx4 v12, s[36:39], s41 offen offset:1024 lds
    s_add_u32 m0, s43, 83968
    s_nop 0
    buffer_load_dwordx4 v5, s[32:35], s40 offen offset:3072 lds
    s_mov_b32 m0, 100352
    s_mov_b64 exec, s[46:47]
    buffer_load_dwordx4 v6, s[32:35], s40 offen lds
    s_mov_b64 exec, -1
    s_movk_i32 s40, 768
    s_mov_b32 s41, 2359296
    v_and_b32 v234, 1, v0
    v_xor_b32 v234, 1, v234
    v_mul_u32_u24 v232, 4224, v234
    v_mul_u32_u24 v233, 4576, v234
    v_bfe_u32 v234, v0, 1, 3
    v_lshl_add_u32 v232, v234, 3, v232
    v_xor_b32 v234, 7, v234
    v_lshl_add_u32 v233, v234, 6, v233
    v_lshrrev_b32 v234, 4, v0
    v_lshl_add_u32 v232, v234, 4, v232
    v_lshl_add_u32 v233, v234, 4, v233
    v_add3_u32 v232, v232, s80, 8
    v_add_u32 v233, s81, v233
    s_waitcnt lgkmcnt(0)
    s_bitcmp1_b32 s71, 0
    s_cselect_b32 s74, 0, 16
    s_lshl_b32 s72, s72, s74
    s_and_b32 s72, s72, 0xffff0000
    v_and_b32 v235, 1, v0
    v_lshlrev_b32 v235, 4, v235
    v_lshrrev_b32 v235, v235, s72
    v_bfe_u32 v236, v0, 1, 3
    v_lshl_add_u32 v236, v234, 1, v236
    v_cmp_eq_u32 vcc, 7, v236
    v_mov_b32 v241, 0
    v_mov_b32 v243, 0
    v_cndmask_b32 v240, 0, v235, vcc
    v_cmp_eq_u32 vcc, 6, v236
    s_nop 1
    v_cndmask_b32 v242, 0, v235, vcc
    s_waitcnt vmcnt(11)
    s_barrier
    s_cmp_lg_u32 s70, 0
    s_cbranch_scc1 L_sig_8
    s_mov_b32 s79, 131072
    s_branch L_sg_chk_11
L_sg_loop_10:
    s_load_dword s78, s[28:29], 0 glc
L_sg_chk_11:
    s_waitcnt lgkmcnt(0)
    s_cmp_ge_u32 s78, 1
    s_cbranch_scc1 L_sg_done_9
    s_sub_u32 s79, s79, 1
    s_cbranch_scc0 L_sg_loop_10
L_sg_done_9:
    s_mov_b64 exec, 1
    buffer_atomic_add v244, off, s[52:55], s73 sc1
    s_mov_b64 exec, -1
L_sig_8:
    s_add_u32 m0, s43, 0
    s_nop 0
    buffer_load_dwordx4 v2, s[32:35], s40 offen offset:0 lds
    s_add_u32 m0, s44, 0
    s_nop 0
    buffer_load_dwordx4 v7, s[36:39], s41 offen offset:0 lds
    buffer_load_dwordx4 v8, s[36:39], s41 offen offset:1024 lds
    s_add_u32 m0, s43, 0
    s_nop 0
    buffer_load_dwordx4 v3, s[32:35], s40 offen offset:1024 lds
    s_add_u32 m0, s44, 8192
    s_nop 0
    buffer_load_dwordx4 v9, s[36:39], s41 offen offset:0 lds
    buffer_load_dwordx4 v10, s[36:39], s41 offen offset:1024 lds
    s_add_u32 m0, s43, 0
    s_nop 0
    buffer_load_dwordx4 v4, s[32:35], s40 offen offset:2048 lds
    s_add_u32 m0, s44, 16384
    s_nop 0
    buffer_load_dwordx4 v11, s[36:39], s41 offen offset:0 lds
    buffer_load_dwordx4 v12, s[36:39], s41 offen offset:1024 lds
    s_add_u32 m0, s43, 0
    s_nop 0
    buffer_load_dwordx4 v5, s[32:35], s40 offen offset:3072 lds
    s_mov_b32 m0, 16384
    s_mov_b64 exec, s[46:47]
    buffer_load_dwordx4 v6, s[32:35], s40 offen lds
    s_mov_b64 exec, -1
    s_movk_i32 s40, 896
    s_mov_b32 s41, 2752512
    s_load_dwordx2 s[90:91], s[16:17], s84 offset:60
    s_load_dwordx2 s[90:91], s[16:17], s84 offset:188
    s_load_dwordx2 s[90:91], s[16:17], s84 offset:316
    s_load_dwordx2 s[90:91], s[16:17], s84 offset:444
    s_waitcnt vmcnt(11)
    s_barrier
    s_cmp_lg_u32 s87, 0
    s_cbranch_scc1 L_stg_13
    s_mov_b32 exec_lo, 0x0
    s_mov_b32 exec_hi, 0x77777000
    buffer_load_dword v250, v252, s[36:39], s89 offen
    s_xor_b32 s89, s89, 256
    buffer_load_dword v250, v252, s[36:39], s89 offen
    s_xor_b32 s89, s89, 256
    s_mov_b32 exec_lo, 0xffc00000
    s_mov_b32 exec_hi, 0
    buffer_load_dword v250, v251, s[32:35], s88 offen
    s_mov_b64 exec, -1
L_stg_13:
    s_add_u32 m0, s43, 41984
    s_nop 0
    buffer_load_dwordx4 v2, s[32:35], s40 offen offset:0 lds
    s_add_u32 m0, s44, 41984
    s_nop 0
    buffer_load_dwordx4 v7, s[36:39], s41 offen offset:0 lds
    buffer_load_dwordx4 v8, s[36:39], s41 offen offset:1024 lds
    s_add_u32 m0, s43, 41984
    s_nop 0
    buffer_load_dwordx4 v3, s[32:35], s40 offen offset:1024 lds
    s_add_u32 m0, s44, 50176
    s_nop 0
    buffer_load_dwordx4 v9, s[36:39], s41 offen offset:0 lds
    buffer_load_dwordx4 v10, s[36:39], s41 offen offset:1024 lds
    s_add_u32 m0, s43, 41984
    s_nop 0
    buffer_load_dwordx4 v4, s[32:35], s40 offen offset:2048 lds
    s_add_u32 m0, s44, 58368
    s_nop 0
    buffer_load_dwordx4 v11, s[36:39], s41 offen offset:0 lds
    buffer_load_dwordx4 v12, s[36:39], s41 offen offset:1024 lds
    s_add_u32 m0, s43, 41984
    s_nop 0
    buffer_load_dwordx4 v5, s[32:35], s40 offen offset:3072 lds
    s_mov_b32 m0, 58368
    s_mov_b64 exec, s[46:47]
    buffer_load_dwordx4 v6, s[32:35], s40 offen lds
    s_mov_b64 exec, -1
    s_movk_i32 s40, 1024
    s_mov_b32 s41, 3145728
    s_load_dwordx2 s[90:91], s[16:17], s84 offset:572
    s_load_dwordx2 s[90:91], s[16:17], s84 offset:700
    s_load_dwordx2 s[90:91], s[16:17], s84 offset:828
    s_load_dwordx2 s[90:91], s[16:17], s84 offset:956
    s_waitcnt vmcnt(14)
    s_bitcmp1_b32 1, s87
    s_cbranch_scc1 L_mw_14
    s_waitcnt vmcnt(11)
L_mw_14:
    s_barrier
    s_cmp_lg_u32 s87, 1
    s_cbranch_scc1 L_stg_15
    s_mov_b32 exec_lo, 0x0
    s_mov_b32 exec_hi, 0x77777000
    buffer_load_dword v250, v252, s[36:39], s89 offen
    s_xor_b32 s89, s89, 256
    buffer_load_dword v250, v252, s[36:39], s89 offen
    s_xor_b32 s89, s89, 256
    s_mov_b32 exec_lo, 0xffc00000
    s_mov_b32 exec_hi, 0
    buffer_load_dword v250, v251, s[32:35], s88 offen
    s_mov_b64 exec, -1
L_stg_15:
    s_add_u32 m0, s43, 83968
    s_nop 0
    buffer_load_dwordx4 v2, s[32:35], s40 offen offset:0 lds
    s_add_u32 m0, s44, 83968
    s_nop 0
    buffer_load_dwordx4 v7, s[36:39], s41 offen offset:0 lds
    buffer_load_dwordx4 v8, s[36:39], s41 offen offset:1024 lds
    s_add_u32 m0, s43, 83968
    s_nop 0
    buffer_load_dwordx4 v3, s[32:35], s40 offen offset:1024 lds
    s_add_u32 m0, s44, 92160
    s_nop 0
    buffer_load_dwordx4 v9, s[36:39], s41 offen offset:0 lds
    buffer_load_dwordx4 v10, s[36:39], s41 offen offset:1024 lds
    s_add_u32 m0, s43, 83968
    s_nop 0
    buffer_load_dwordx4 v4, s[32:35], s40 offen offset:2048 lds
    s_add_u32 m0, s44, 100352
    s_nop 0
    buffer_load_dwordx4 v11, s[36:39], s41 offen offset:0 lds
    buffer_load_dwordx4 v12, s[36:39], s41 offen offset:1024 lds
    s_add_u32 m0, s43, 83968
    s_nop 0
    buffer_load_dwordx4 v5, s[32:35], s40 offen offset:3072 lds
    s_mov_b32 m0, 100352
    s_mov_b64 exec, s[46:47]
    buffer_load_dwordx4 v6, s[32:35], s40 offen lds
    s_mov_b64 exec, -1
    s_movk_i32 s40, 1152
    s_mov_b32 s41, 3538944
    s_load_dwordx2 s[90:91], s[16:17], s84 offset:1084
    s_load_dwordx2 s[90:91], s[16:17], s84 offset:1212
    s_load_dwordx2 s[90:91], s[16:17], s84 offset:1340
    s_load_dwordx2 s[90:91], s[16:17], s84 offset:1468
    s_waitcnt vmcnt(14)
    s_bitcmp1_b32 2, s87
    s_cbranch_scc1 L_mw_16
    s_waitcnt vmcnt(11)
L_mw_16:
    s_barrier
    s_add_u32 m0, s43, 0
    s_nop 0
    buffer_load_dwordx4 v2, s[32:35], s40 offen offset:0 lds
    s_add_u32 m0, s44, 0
    s_nop 0
    buffer_load_dwordx4 v7, s[36:39], s41 offen offset:0 lds
    buffer_load_dwordx4 v8, s[36:39], s41 offen offset:1024 lds
    s_add_u32 m0, s43, 0
    s_nop 0
    buffer_load_dwordx4 v3, s[32:35], s40 offen offset:1024 lds
    s_add_u32 m0, s44, 8192
    s_nop 0
    buffer_load_dwordx4 v9, s[36:39], s41 offen offset:0 lds
    buffer_load_dwordx4 v10, s[36:39], s41 offen offset:1024 lds
    s_add_u32 m0, s43, 0
    s_nop 0
    buffer_load_dwordx4 v4, s[32:35], s40 offen offset:2048 lds
    s_add_u32 m0, s44, 16384
    s_nop 0
    buffer_load_dwordx4 v11, s[36:39], s41 offen offset:0 lds
    buffer_load_dwordx4 v12, s[36:39], s41 offen offset:1024 lds
    s_add_u32 m0, s43, 0
    s_nop 0
    buffer_load_dwordx4 v5, s[32:35], s40 offen offset:3072 lds
    s_mov_b32 m0, 16384
    s_mov_b64 exec, s[46:47]
    buffer_load_dwordx4 v6, s[32:35], s40 offen lds
    s_mov_b64 exec, -1
    s_movk_i32 s40, 1280
    s_mov_b32 s41, 3932160
    s_load_dwordx2 s[90:91], s[16:17], s84 offset:1596
    s_load_dwordx2 s[90:91], s[16:17], s84 offset:1724
    s_load_dwordx2 s[90:91], s[16:17], s84 offset:1852
    s_load_dwordx2 s[90:91], s[16:17], s84 offset:1980
    s_waitcnt vmcnt(11)
    s_barrier
    s_add_u32 m0, s43, 41984
    s_nop 0
    buffer_load_dwordx4 v2, s[32:35], s40 offen offset:0 lds
    s_add_u32 m0, s44, 41984
    s_nop 0
    buffer_load_dwordx4 v7, s[36:39], s41 offen offset:0 lds
    buffer_load_dwordx4 v8, s[36:39], s41 offen offset:1024 lds
    s_add_u32 m0, s43, 41984
    s_nop 0
    buffer_load_dwordx4 v3, s[32:35], s40 offen offset:1024 lds
    s_add_u32 m0, s44, 50176
    s_nop 0
    buffer_load_dwordx4 v9, s[36:39], s41 offen offset:0 lds
    buffer_load_dwordx4 v10, s[36:39], s41 offen offset:1024 lds
    s_add_u32 m0, s43, 41984
    s_nop 0
    buffer_load_dwordx4 v4, s[32:35], s40 offen offset:2048 lds
    s_add_u32 m0, s44, 58368
    s_nop 0
    buffer_load_dwordx4 v11, s[36:39], s41 offen offset:0 lds
    buffer_load_dwordx4 v12, s[36:39], s41 offen offset:1024 lds
    s_add_u32 m0, s43, 41984
    s_nop 0
    buffer_load_dwordx4 v5, s[32:35], s40 offen offset:3072 lds
    s_mov_b32 m0, 58368
    s_mov_b64 exec, s[46:47]
    buffer_load_dwordx4 v6, s[32:35], s40 offen lds
    s_mov_b64 exec, -1
    s_movk_i32 s40, 1408
    s_mov_b32 s41, 4325376
    s_load_dwordx2 s[90:91], s[16:17], s84 offset:2108
    s_load_dwordx2 s[90:91], s[16:17], s84 offset:2236
    s_load_dwordx2 s[90:91], s[16:17], s84 offset:2364
    s_load_dwordx2 s[90:91], s[16:17], s84 offset:2492
    s_waitcnt vmcnt(11)
    s_barrier
    s_add_u32 m0, s43, 83968
    s_nop 0
    buffer_load_dwordx4 v2, s[32:35], s40 offen offset:0 lds
    s_add_u32 m0, s44, 83968
    s_nop 0
    buffer_load_dwordx4 v7, s[36:39], s41 offen offset:0 lds
    buffer_load_dwordx4 v8, s[36:39], s41 offen offset:1024 lds
    s_add_u32 m0, s43, 83968
    s_nop 0
    buffer_load_dwordx4 v3, s[32:35], s40 offen offset:1024 lds
    s_add_u32 m0, s44, 92160
    s_nop 0
    buffer_load_dwordx4 v9, s[36:39], s41 offen offset:0 lds
    buffer_load_dwordx4 v10, s[36:39], s41 offen offset:1024 lds
    s_add_u32 m0, s43, 83968
    s_nop 0
    buffer_load_dwordx4 v4, s[32:35], s40 offen offset:2048 lds
    s_add_u32 m0, s44, 100352
    s_nop 0
    buffer_load_dwordx4 v11, s[36:39], s41 offen offset:0 lds
    buffer_load_dwordx4 v12, s[36:39], s41 offen offset:1024 lds
    s_add_u32 m0, s43, 83968
    s_nop 0
    buffer_load_dwordx4 v5, s[32:35], s40 offen offset:3072 lds
    s_mov_b32 m0, 100352
    s_mov_b64 exec, s[46:47]
    buffer_load_dwordx4 v6, s[32:35], s40 offen lds
    s_mov_b64 exec, -1
    s_movk_i32 s40, 1536
    s_mov_b32 s41, 4718592
    s_load_dwordx2 s[90:91], s[16:17], s84 offset:2620
    s_load_dwordx2 s[90:91], s[16:17], s84 offset:2748
    s_load_dwordx2 s[90:91], s[16:17], s84 offset:2876
    s_load_dwordx2 s[90:91], s[16:17], s84 offset:3004
    s_waitcnt vmcnt(11)
    s_barrier
    s_add_u32 m0, s43, 0
    s_nop 0
    buffer_load_dwordx4 v2, s[32:35], s40 offen offset:0 lds
    s_add_u32 m0, s44, 0
    s_nop 0
    buffer_load_dwordx4 v7, s[36:39], s41 offen offset:0 lds
    buffer_load_dwordx4 v8, s[36:39], s41 offen offset:1024 lds
    s_add_u32 m0, s43, 0
    s_nop 0
    buffer_load_dwordx4 v3, s[32:35], s40 offen offset:1024 lds
    s_add_u32 m0, s44, 8192
    s_nop 0
    buffer_load_dwordx4 v9, s[36:39], s41 offen offset:0 lds
    buffer_load_dwordx4 v10, s[36:39], s41 offen offset:1024 lds
    s_add_u32 m0, s43, 0
    s_nop 0
    buffer_load_dwordx4 v4, s[32:35], s40 offen offset:2048 lds
    s_add_u32 m0, s44, 16384
    s_nop 0
    buffer_load_dwordx4 v11, s[36:39], s41 offen offset:0 lds
    buffer_load_dwordx4 v12, s[36:39], s41 offen offset:1024 lds
    s_add_u32 m0, s43, 0
    s_nop 0
    buffer_load_dwordx4 v5, s[32:35], s40 offen offset:3072 lds
    s_mov_b32 m0, 16384
    s_mov_b64 exec, s[46:47]
    buffer_load_dwordx4 v6, s[32:35], s40 offen lds
    s_mov_b64 exec, -1
    s_movk_i32 s40, 1664
    s_mov_b32 s41, 5111808
    s_load_dwordx2 s[90:91], s[16:17], s84 offset:3132
    s_load_dwordx2 s[90:91], s[16:17], s84 offset:3260
    s_load_dwordx2 s[90:91], s[16:17], s84 offset:3388
    s_load_dwordx2 s[90:91], s[16:17], s84 offset:3516
    s_waitcnt vmcnt(11)
    s_barrier
    s_add_u32 m0, s43, 41984
    s_nop 0
    buffer_load_dwordx4 v2, s[32:35], s40 offen offset:0 lds
    s_add_u32 m0, s44, 41984
    s_nop 0
    buffer_load_dwordx4 v7, s[36:39], s41 offen offset:0 lds
    buffer_load_dwordx4 v8, s[36:39], s41 offen offset:1024 lds
    s_add_u32 m0, s43, 41984
    s_nop 0
    buffer_load_dwordx4 v3, s[32:35], s40 offen offset:1024 lds
    s_add_u32 m0, s44, 50176
    s_nop 0
    buffer_load_dwordx4 v9, s[36:39], s41 offen offset:0 lds
    buffer_load_dwordx4 v10, s[36:39], s41 offen offset:1024 lds
    s_add_u32 m0, s43, 41984
    s_nop 0
    buffer_load_dwordx4 v4, s[32:35], s40 offen offset:2048 lds
    s_add_u32 m0, s44, 58368
    s_nop 0
    buffer_load_dwordx4 v11, s[36:39], s41 offen offset:0 lds
    buffer_load_dwordx4 v12, s[36:39], s41 offen offset:1024 lds
    s_add_u32 m0, s43, 41984
    s_nop 0
    buffer_load_dwordx4 v5, s[32:35], s40 offen offset:3072 lds
    s_mov_b32 m0, 58368
    s_mov_b64 exec, s[46:47]
    buffer_load_dwordx4 v6, s[32:35], s40 offen lds
    s_mov_b64 exec, -1
    s_movk_i32 s40, 1792
    s_mov_b32 s41, 5505024
    s_load_dwordx2 s[90:91], s[16:17], s84 offset:3644
    s_load_dwordx2 s[90:91], s[16:17], s84 offset:3772
    s_load_dwordx2 s[90:91], s[16:17], s84 offset:3900
    s_load_dwordx2 s[90:91], s[16:17], s84 offset:4028
    s_waitcnt vmcnt(11)
    s_barrier
    s_add_u32 m0, s43, 83968
    s_nop 0
    buffer_load_dwordx4 v2, s[32:35], s40 offen offset:0 lds
    s_add_u32 m0, s44, 83968
    s_nop 0
    buffer_load_dwordx4 v7, s[36:39], s41 offen offset:0 lds
    buffer_load_dwordx4 v8, s[36:39], s41 offen offset:1024 lds
    s_add_u32 m0, s43, 83968
    s_nop 0
    buffer_load_dwordx4 v3, s[32:35], s40 offen offset:1024 lds
    s_add_u32 m0, s44, 92160
    s_nop 0
    buffer_load_dwordx4 v9, s[36:39], s41 offen offset:0 lds
    buffer_load_dwordx4 v10, s[36:39], s41 offen offset:1024 lds
    s_add_u32 m0, s43, 83968
    s_nop 0
    buffer_load_dwordx4 v4, s[32:35], s40 offen offset:2048 lds
    s_add_u32 m0, s44, 100352
    s_nop 0
    buffer_load_dwordx4 v11, s[36:39], s41 offen offset:0 lds
    buffer_load_dwordx4 v12, s[36:39], s41 offen offset:1024 lds
    s_add_u32 m0, s43, 83968
    s_nop 0
    buffer_load_dwordx4 v5, s[32:35], s40 offen offset:3072 lds
    s_mov_b32 m0, 100352
    s_mov_b64 exec, s[46:47]
    buffer_load_dwordx4 v6, s[32:35], s40 offen lds
    s_mov_b64 exec, -1
    s_movk_i32 s40, 1920
    s_mov_b32 s41, 5898240
    s_waitcnt vmcnt(11)
    s_barrier
    s_load_dword s78, s[52:53], s73
    s_add_u32 m0, s43, 0
    s_nop 0
    buffer_load_dwordx4 v2, s[32:35], s40 offen offset:0 lds
    s_add_u32 m0, s44, 0
    s_nop 0
    buffer_load_dwordx4 v7, s[36:39], s41 offen offset:0 lds
    buffer_load_dwordx4 v8, s[36:39], s41 offen offset:1024 lds
    s_add_u32 m0, s43, 0
    s_nop 0
    buffer_load_dwordx4 v3, s[32:35], s40 offen offset:1024 lds
    s_add_u32 m0, s44, 8192
    s_nop 0
    buffer_load_dwordx4 v9, s[36:39], s41 offen offset:0 lds
    buffer_load_dwordx4 v10, s[36:39], s41 offen offset:1024 lds
    s_add_u32 m0, s43, 0
    s_nop 0
    buffer_load_dwordx4 v4, s[32:35], s40 offen offset:2048 lds
    s_add_u32 m0, s44, 16384
    s_nop 0
    buffer_load_dwordx4 v11, s[36:39], s41 offen offset:0 lds
    buffer_load_dwordx4 v12, s[36:39], s41 offen offset:1024 lds
    s_add_u32 m0, s43, 0
    s_nop 0
    buffer_load_dwordx4 v5, s[32:35], s40 offen offset:3072 lds
    s_mov_b32 m0, 16384
    s_mov_b64 exec, s[46:47]
    buffer_load_dwordx4 v6, s[32:35], s40 offen lds
    s_mov_b64 exec, -1
    s_movk_i32 s40, 2048
    s_mov_b32 s41, 6291456
    s_mov_b32 s79, 131072
    s_branch L_sg_chk_25
L_sg_loop_24:
    s_load_dword s78, s[52:53], s73 glc
L_sg_chk_25:
    s_waitcnt lgkmcnt(0)
    s_cmp_ge_u32 s78, 32
    s_cbranch_scc1 L_sg_done_23
    s_sub_u32 s79, s79, 1
    s_cbranch_scc0 L_sg_loop_24
L_sg_done_23:
    s_waitcnt vmcnt(11)
    s_barrier
    s_add_u32 s56, s30, s85
    s_addc_u32 s57, s31, 0
    s_movk_i32 s58, 4096
    s_mov_b32 s59, 0x20000
    s_add_u32 m0, s81, 0
    s_nop 0
    buffer_load_dwordx4 v224, s[56:59], 0 offen offset:0 sc1 lds
    buffer_load_dwordx4 v224, s[56:59], 0 offen offset:1024 sc1 lds
    buffer_load_dwordx4 v224, s[56:59], 0 offen offset:2048 sc1 lds
    buffer_load_dwordx4 v224, s[56:59], 0 offen offset:3072 sc1 lds
    s_add_u32 m0, s81, 4572
    s_nop 0
    buffer_load_dwordx4 v224, s[56:59], 0 offen offset:0 sc1 lds
    buffer_load_dwordx4 v224, s[56:59], 0 offen offset:1024 sc1 lds
    buffer_load_dwordx4 v224, s[56:59], 0 offen offset:2048 sc1 lds
    buffer_load_dwordx4 v224, s[56:59], 0 offen offset:3072 sc1 lds
    s_waitcnt vmcnt(8)
    s_mov_b64 exec, 1
    ds_add_u32 v227, v244 offset:24
    s_mov_b64 exec, -1
    s_add_u32 s56, s16, s84
    s_addc_u32 s57, s17, 0
    s_movk_i32 s58, 4096
    s_mov_b32 s59, 0x20000
    s_add_u32 m0, s80, 64
    v_mov_b32 v132, 0
    v_mov_b32 v133, 0
    v_mov_b32 v134, 0
    v_mov_b32 v135, 0
    buffer_load_dwordx4 v224, s[56:59], 0 offen offset:0 lds
    buffer_load_dwordx4 v224, s[56:59], 0 offen offset:1024 lds
    buffer_load_dwordx4 v224, s[56:59], 0 offen offset:2048 lds
    buffer_load_dwordx4 v224, s[56:59], 0 offen offset:3072 lds
    s_add_u32 m0, s80, 4304
    s_mov_b64 exec, 0x100
    buffer_load_dwordx4 v[132:135], off, s[56:59], 0
    s_mov_b64 exec, -1
    buffer_load_dwordx4 v224, s[56:59], 14 offen offset:0 lds
    buffer_load_dwordx4 v224, s[56:59], 14 offen offset:1024 lds
    buffer_load_dwordx4 v224, s[56:59], 14 offen offset:2048 lds
    buffer_load_dwordx4 v224, s[56:59], 14 offen offset:3072 lds
    v_lshrrev_b32 v234, 5, v0
    v_mul_u32_u24 v234, 4064, v234
    v_add3_u32 v234, v234, v224, s81
    s_mov_b32 exec_lo, 0xfffffff
    s_mov_b32 exec_hi, 0xfffffff
    ds_write_b128 v234, v[228:231] offset:4096
    s_mov_b64 exec, 1
    ds_write_b32 v234, v228 offset:8668
    s_mov_b64 exec, -1
    s_setprio 3
    s_mov_b32 s60, s24
    s_mov_b32 s61, s25
    s_mov_b32 s62, 0x200000
    s_mov_b32 s63, 0x20000
    s_lshr_b32 s74, s2, 3
    s_lshl2_add_u32 s74, s74, s70
    s_bfe_u32 s75, s2, 0x10002
    s_lshl4_add_u32 s74, s74, s75
    s_lshl_b32 s74, s74, 10
    v_lshrrev_b32 v234, 3, v0
    v_and_b32 v235, 7, v0
    v_lshlrev_b32 v235, 7, v235
    v_lshl_add_u32 v234, v234, 11, v235
    buffer_load_dword v250, v234, s[60:63], s74 offen
    s_lshr_b32 s74, s69, 2
    s_and_b32 s75, s69, 3
    s_lshl3_add_u32 s74, s74, s75
    s_lshl3_add_u32 s74, s74, s70
    s_lshl_b32 s74, s74, 3
    v_bfe_u32 v234, v0, 3, 1
    v_lshl_add_u32 v225, v234, 8, s74
    v_bfe_u32 v234, v0, 4, 1
    v_lshl_add_u32 v225, v234, 1, v225
    v_lshrrev_b32 v234, 5, v0
    v_lshl_add_u32 v225, v234, 5, v225
    s_lshl_b32 s74, s68, 7
    v_and_b32 v234, 7, v0
    v_lshl_add_u32 v234, v234, 4, s74
    v_lshl_add_u32 v226, v225, 12, v234
    v_lshl_add_u32 v225, v225, 11, v234
    s_mov_b32 s60, s8
    s_mov_b32 s61, s9
    s_mov_b32 s62, 0x400000
    s_mov_b32 s63, 0x20000
    s_movk_i32 s74, 8192
    buffer_load_dwordx4 v[208:211], v225, s[60:63], 0 offen offset:0 nt
    buffer_load_dwordx4 v[212:215], v225, s[60:63], 0 offen offset:2048 nt
    buffer_load_dwordx4 v[216:219], v225, s[60:63], s74 offen offset:0 nt
    buffer_load_dwordx4 v[220:223], v225, s[60:63], s74 offen offset:2048 nt
    s_waitcnt vmcnt(14)
    s_waitcnt vmcnt(5)
    v_cmp_lt_u32 vcc, 3, v0
    v_mov_b32 v140, 4160
    v_lshlrev_b32 v136, 16, v132
    v_cndmask_b32 v140, 0, v140, vcc
    v_alignbit_b32 v137, v133, v132, 16
    v_alignbit_b32 v138, v134, v133, 16
    v_alignbit_b32 v139, v135, v134, 16
    v_add3_u32 v140, v140, v224, s80
    s_mov_b64 exec, 0x1ff
    ds_write_b128 v140, v[136:139]
    s_mov_b64 exec, -1
    ds_read_b128 v[112:115], v233 offset:3584
    ds_read_b64 v[48:49], v232 offset:0
    ds_read_b64 v[50:51], v232 offset:8
    ds_read_b128 v[116:119], v233 offset:3072
    ds_read_b64 v[52:53], v232 offset:512
    ds_read_b64 v[54:55], v232 offset:520
    ds_read_b128 v[120:123], v233 offset:2560
    ds_read_b64 v[56:57], v232 offset:1024
    ds_read_b64 v[58:59], v232 offset:1032
    ds_read_b128 v[124:127], v233 offset:2048
    ds_read_b64 v[60:61], v232 offset:1536
    ds_read_b64 v[62:63], v232 offset:1544
    ds_read_b128 v[128:131], v233 offset:1536
    ds_read_b64 v[64:65], v232 offset:2048
    ds_read_b64 v[66:67], v232 offset:2056
    ds_read_b128 v[132:135], v233 offset:1024
    ds_read_b64 v[68:69], v232 offset:2560
    ds_read_b64 v[70:71], v232 offset:2568
    ds_read_b128 v[136:139], v233 offset:512
    ds_read_b64 v[72:73], v232 offset:3072
    ds_read_b64 v[74:75], v232 offset:3080
    ds_read_b128 v[140:143], v233 offset:0
    ds_read_b64 v[76:77], v232 offset:3584
    ds_read_b64 v[78:79], v232 offset:3592
    s_setprio 1
    s_mov_b32 s74, 3
    s_waitcnt lgkmcnt(0)
    v_mfma_f32_16x16x32_bf16 v[16:19], v[240:243], v[112:115], 0
    v_mfma_f32_16x16x32_bf16 v[20:23], v[240:243], v[116:119], 0
    v_mfma_f32_16x16x32_bf16 v[24:27], v[240:243], v[120:123], 0
    v_mfma_f32_16x16x32_bf16 v[28:31], v[240:243], v[124:127], 0
    v_mfma_f32_16x16x32_bf16 v[32:35], v[240:243], v[128:131], 0
    v_mfma_f32_16x16x32_bf16 v[36:39], v[240:243], v[132:135], 0
    v_mfma_f32_16x16x32_bf16 v[40:43], v[240:243], v[136:139], 0
    v_mfma_f32_16x16x32_bf16 v[44:47], v[240:243], v[140:143], 0
L_conv:
    v_mfma_f32_16x16x32_bf16 v[16:19], v[48:51], v[112:115], v[16:19]
    ds_read_b128 v[144:147], v233 offset:3648
    v_mfma_f32_16x16x32_bf16 v[20:23], v[48:51], v[116:119], v[20:23]
    ds_read_b64 v[80:81], v232 offset:64
    v_mfma_f32_16x16x32_bf16 v[20:23], v[52:55], v[112:115], v[20:23]
    ds_read_b64 v[82:83], v232 offset:72
    v_mfma_f32_16x16x32_bf16 v[24:27], v[48:51], v[120:123], v[24:27]
    ds_read_b128 v[148:151], v233 offset:3136
    v_mfma_f32_16x16x32_bf16 v[24:27], v[52:55], v[116:119], v[24:27]
    ds_read_b64 v[84:85], v232 offset:576
    v_mfma_f32_16x16x32_bf16 v[24:27], v[56:59], v[112:115], v[24:27]
    ds_read_b64 v[86:87], v232 offset:584
    v_mfma_f32_16x16x32_bf16 v[28:31], v[48:51], v[124:127], v[28:31]
    ds_read_b128 v[152:155], v233 offset:2624
    v_mfma_f32_16x16x32_bf16 v[28:31], v[52:55], v[120:123], v[28:31]
    ds_read_b64 v[88:89], v232 offset:1088
    v_mfma_f32_16x16x32_bf16 v[28:31], v[56:59], v[116:119], v[28:31]
    ds_read_b64 v[90:91], v232 offset:1096
    v_mfma_f32_16x16x32_bf16 v[28:31], v[60:63], v[112:115], v[28:31]
    ds_read_b128 v[156:159], v233 offset:2112
    v_mfma_f32_16x16x32_bf16 v[32:35], v[48:51], v[128:131], v[32:35]
    ds_read_b64 v[92:93], v232 offset:1600
    v_mfma_f32_16x16x32_bf16 v[32:35], v[52:55], v[124:127], v[32:35]
    ds_read_b64 v[94:95], v232 offset:1608
    v_mfma_f32_16x16x32_bf16 v[32:35], v[56:59], v[120:123], v[32:35]
    ds_read_b128 v[160:163], v233 offset:1600
    v_mfma_f32_16x16x32_bf16 v[32:35], v[60:63], v[116:119], v[32:35]
    ds_read_b64 v[96:97], v232 offset:2112
    v_mfma_f32_16x16x32_bf16 v[32:35], v[64:67], v[112:115], v[32:35]
    ds_read_b64 v[98:99], v232 offset:2120
    v_mfma_f32_16x16x32_bf16 v[36:39], v[48:51], v[132:135], v[36:39]
    ds_read_b128 v[164:167], v233 offset:1088
    v_mfma_f32_16x16x32_bf16 v[36:39], v[52:55], v[128:131], v[36:39]
    ds_read_b64 v[100:101], v232 offset:2624
    v_mfma_f32_16x16x32_bf16 v[36:39], v[56:59], v[124:127], v[36:39]
    ds_read_b64 v[102:103], v232 offset:2632
    v_mfma_f32_16x16x32_bf16 v[36:39], v[60:63], v[120:123], v[36:39]
    ds_read_b128 v[168:171], v233 offset:576
    v_mfma_f32_16x16x32_bf16 v[36:39], v[64:67], v[116:119], v[36:39]
    ds_read_b64 v[104:105], v232 offset:3136
    v_mfma_f32_16x16x32_bf16 v[36:39], v[68:71], v[112:115], v[36:39]
    ds_read_b64 v[106:107], v232 offset:3144
    v_mfma_f32_16x16x32_bf16 v[40:43], v[48:51], v[136:139], v[40:43]
    ds_read_b128 v[172:175], v233 offset:64
    v_mfma_f32_16x16x32_bf16 v[40:43], v[52:55], v[132:135], v[40:43]
    ds_read_b64 v[108:109], v232 offset:3648
    v_mfma_f32_16x16x32_bf16 v[40:43], v[56:59], v[128:131], v[40:43]
    ds_read_b64 v[110:111], v232 offset:3656
    v_mfma_f32_16x16x32_bf16 v[40:43], v[60:63], v[124:127], v[40:43]
    v_mfma_f32_16x16x32_bf16 v[40:43], v[64:67], v[120:123], v[40:43]
    v_mfma_f32_16x16x32_bf16 v[40:43], v[68:71], v[116:119], v[40:43]
    v_mfma_f32_16x16x32_bf16 v[40:43], v[72:75], v[112:115], v[40:43]
    v_mfma_f32_16x16x32_bf16 v[44:47], v[48:51], v[140:143], v[44:47]
    v_mfma_f32_16x16x32_bf16 v[44:47], v[52:55], v[136:139], v[44:47]
    v_mfma_f32_16x16x32_bf16 v[44:47], v[56:59], v[132:135], v[44:47]
    v_mfma_f32_16x16x32_bf16 v[44:47], v[60:63], v[128:131], v[44:47]
    v_mfma_f32_16x16x32_bf16 v[44:47], v[64:67], v[124:127], v[44:47]
    v_mfma_f32_16x16x32_bf16 v[44:47], v[68:71], v[120:123], v[44:47]
    v_mfma_f32_16x16x32_bf16 v[44:47], v[72:75], v[116:119], v[44:47]
    v_mfma_f32_16x16x32_bf16 v[44:47], v[76:79], v[112:115], v[44:47]
    s_waitcnt lgkmcnt(0)
    v_mfma_f32_16x16x32_bf16 v[16:19], v[80:83], v[144:147], v[16:19]
    ds_read_b128 v[112:115], v233 offset:3712
    v_mfma_f32_16x16x32_bf16 v[20:23], v[80:83], v[148:151], v[20:23]
    ds_read_b64 v[48:49], v232 offset:128
    v_mfma_f32_16x16x32_bf16 v[20:23], v[84:87], v[144:147], v[20:23]
    ds_read_b64 v[50:51], v232 offset:136
    v_mfma_f32_16x16x32_bf16 v[24:27], v[80:83], v[152:155], v[24:27]
    ds_read_b128 v[116:119], v233 offset:3200
    v_mfma_f32_16x16x32_bf16 v[24:27], v[84:87], v[148:151], v[24:27]
    ds_read_b64 v[52:53], v232 offset:640
    v_mfma_f32_16x16x32_bf16 v[24:27], v[88:91], v[144:147], v[24:27]
    ds_read_b64 v[54:55], v232 offset:648
    v_mfma_f32_16x16x32_bf16 v[28:31], v[80:83], v[156:159], v[28:31]
    ds_read_b128 v[120:123], v233 offset:2688
    v_mfma_f32_16x16x32_bf16 v[28:31], v[84:87], v[152:155], v[28:31]
    ds_read_b64 v[56:57], v232 offset:1152
    v_mfma_f32_16x16x32_bf16 v[28:31], v[88:91], v[148:151], v[28:31]
    ds_read_b64 v[58:59], v232 offset:1160
    v_mfma_f32_16x16x32_bf16 v[28:31], v[92:95], v[144:147], v[28:31]
    ds_read_b128 v[124:127], v233 offset:2176
    v_mfma_f32_16x16x32_bf16 v[32:35], v[80:83], v[160:163], v[32:35]
    ds_read_b64 v[60:61], v232 offset:1664
    v_mfma_f32_16x16x32_bf16 v[32:35], v[84:87], v[156:159], v[32:35]
    ds_read_b64 v[62:63], v232 offset:1672
    v_mfma_f32_16x16x32_bf16 v[32:35], v[88:91], v[152:155], v[32:35]
    ds_read_b128 v[128:131], v233 offset:1664
    v_mfma_f32_16x16x32_bf16 v[32:35], v[92:95], v[148:151], v[32:35]
    ds_read_b64 v[64:65], v232 offset:2176
    v_mfma_f32_16x16x32_bf16 v[32:35], v[96:99], v[144:147], v[32:35]
    ds_read_b64 v[66:67], v232 offset:2184
    v_mfma_f32_16x16x32_bf16 v[36:39], v[80:83], v[164:167], v[36:39]
    ds_read_b128 v[132:135], v233 offset:1152
    v_mfma_f32_16x16x32_bf16 v[36:39], v[84:87], v[160:163], v[36:39]
    ds_read_b64 v[68:69], v232 offset:2688
    v_mfma_f32_16x16x32_bf16 v[36:39], v[88:91], v[156:159], v[36:39]
    ds_read_b64 v[70:71], v232 offset:2696
    v_mfma_f32_16x16x32_bf16 v[36:39], v[92:95], v[152:155], v[36:39]
    ds_read_b128 v[136:139], v233 offset:640
    v_mfma_f32_16x16x32_bf16 v[36:39], v[96:99], v[148:151], v[36:39]
    ds_read_b64 v[72:73], v232 offset:3200
    v_mfma_f32_16x16x32_bf16 v[36:39], v[100:103], v[144:147], v[36:39]
    ds_read_b64 v[74:75], v232 offset:3208
    v_mfma_f32_16x16x32_bf16 v[40:43], v[80:83], v[168:171], v[40:43]
    ds_read_b128 v[140:143], v233 offset:128
    v_mfma_f32_16x16x32_bf16 v[40:43], v[84:87], v[164:167], v[40:43]
    ds_read_b64 v[76:77], v232 offset:3712
    v_mfma_f32_16x16x32_bf16 v[40:43], v[88:91], v[160:163], v[40:43]
    ds_read_b64 v[78:79], v232 offset:3720
    v_mfma_f32_16x16x32_bf16 v[40:43], v[92:95], v[156:159], v[40:43]
    v_add_u32 v232, 128, v232
    v_mfma_f32_16x16x32_bf16 v[40:43], v[96:99], v[152:155], v[40:43]
    v_add_u32 v233, 128, v233
    v_mfma_f32_16x16x32_bf16 v[40:43], v[100:103], v[148:151], v[40:43]
    s_sub_u32 s74, s74, 1
    v_mfma_f32_16x16x32_bf16 v[40:43], v[104:107], v[144:147], v[40:43]
    s_cmp_lg_u32 s74, 0
    v_mfma_f32_16x16x32_bf16 v[44:47], v[80:83], v[172:175], v[44:47]
    v_mfma_f32_16x16x32_bf16 v[44:47], v[84:87], v[168:171], v[44:47]
    v_mfma_f32_16x16x32_bf16 v[44:47], v[88:91], v[164:167], v[44:47]
    v_mfma_f32_16x16x32_bf16 v[44:47], v[92:95], v[160:163], v[44:47]
    v_mfma_f32_16x16x32_bf16 v[44:47], v[96:99], v[156:159], v[44:47]
    v_mfma_f32_16x16x32_bf16 v[44:47], v[100:103], v[152:155], v[44:47]
    v_mfma_f32_16x16x32_bf16 v[44:47], v[104:107], v[148:151], v[44:47]
    v_mfma_f32_16x16x32_bf16 v[44:47], v[108:111], v[144:147], v[44:47]
    s_waitcnt lgkmcnt(0)
    s_cbranch_scc1 L_conv
    v_mfma_f32_16x16x32_bf16 v[16:19], v[48:51], v[112:115], v[16:19]
    ds_read_b128 v[144:147], v233 offset:3648
    v_mfma_f32_16x16x32_bf16 v[20:23], v[48:51], v[116:119], v[20:23]
    ds_read_b64 v[80:81], v232 offset:64
    v_mfma_f32_16x16x32_bf16 v[20:23], v[52:55], v[112:115], v[20:23]
    ds_read_b64 v[82:83], v232 offset:72
    v_mfma_f32_16x16x32_bf16 v[24:27], v[48:51], v[120:123], v[24:27]
    ds_read_b128 v[148:151], v233 offset:3136
    v_mfma_f32_16x16x32_bf16 v[24:27], v[52:55], v[116:119], v[24:27]
    ds_read_b64 v[84:85], v232 offset:576
    v_mfma_f32_16x16x32_bf16 v[24:27], v[56:59], v[112:115], v[24:27]
    ds_read_b64 v[86:87], v232 offset:584
    v_mfma_f32_16x16x32_bf16 v[28:31], v[48:51], v[124:127], v[28:31]
    ds_read_b128 v[152:155], v233 offset:2624
    v_mfma_f32_16x16x32_bf16 v[28:31], v[52:55], v[120:123], v[28:31]
    ds_read_b64 v[88:89], v232 offset:1088
    v_mfma_f32_16x16x32_bf16 v[28:31], v[56:59], v[116:119], v[28:31]
    ds_read_b64 v[90:91], v232 offset:1096
    v_mfma_f32_16x16x32_bf16 v[28:31], v[60:63], v[112:115], v[28:31]
    ds_read_b128 v[156:159], v233 offset:2112
    v_mfma_f32_16x16x32_bf16 v[32:35], v[48:51], v[128:131], v[32:35]
    ds_read_b64 v[92:93], v232 offset:1600
    v_mfma_f32_16x16x32_bf16 v[32:35], v[52:55], v[124:127], v[32:35]
    ds_read_b64 v[94:95], v232 offset:1608
    v_mfma_f32_16x16x32_bf16 v[32:35], v[56:59], v[120:123], v[32:35]
    ds_read_b128 v[160:163], v233 offset:1600
    v_mfma_f32_16x16x32_bf16 v[32:35], v[60:63], v[116:119], v[32:35]
    ds_read_b64 v[96:97], v232 offset:2112
    v_mfma_f32_16x16x32_bf16 v[32:35], v[64:67], v[112:115], v[32:35]
    ds_read_b64 v[98:99], v232 offset:2120
    v_mfma_f32_16x16x32_bf16 v[36:39], v[48:51], v[132:135], v[36:39]
    ds_read_b128 v[164:167], v233 offset:1088
    v_mfma_f32_16x16x32_bf16 v[36:39], v[52:55], v[128:131], v[36:39]
    ds_read_b64 v[100:101], v232 offset:2624
    v_mfma_f32_16x16x32_bf16 v[36:39], v[56:59], v[124:127], v[36:39]
    ds_read_b64 v[102:103], v232 offset:2632
    v_mfma_f32_16x16x32_bf16 v[36:39], v[60:63], v[120:123], v[36:39]
    ds_read_b128 v[168:171], v233 offset:576
    v_mfma_f32_16x16x32_bf16 v[36:39], v[64:67], v[116:119], v[36:39]
    ds_read_b64 v[104:105], v232 offset:3136
    v_mfma_f32_16x16x32_bf16 v[36:39], v[68:71], v[112:115], v[36:39]
    ds_read_b64 v[106:107], v232 offset:3144
    v_mfma_f32_16x16x32_bf16 v[40:43], v[48:51], v[136:139], v[40:43]
    ds_read_b128 v[172:175], v233 offset:64
    v_mfma_f32_16x16x32_bf16 v[40:43], v[52:55], v[132:135], v[40:43]
    ds_read_b64 v[108:109], v232 offset:3648
    v_mfma_f32_16x16x32_bf16 v[40:43], v[56:59], v[128:131], v[40:43]
    ds_read_b64 v[110:111], v232 offset:3656
    v_mfma_f32_16x16x32_bf16 v[40:43], v[60:63], v[124:127], v[40:43]
    s_mul_i32 s74, s68, 4224
    v_mfma_f32_16x16x32_bf16 v[40:43], v[64:67], v[120:123], v[40:43]
    s_and_b32 s75, s71, 63
    v_mfma_f32_16x16x32_bf16 v[40:43], v[68:71], v[116:119], v[40:43]
    s_add_u32 s74, s74, s75
    v_mfma_f32_16x16x32_bf16 v[40:43], v[72:75], v[112:115], v[40:43]
    s_lshl_b32 s74, s74, 6
    v_mfma_f32_16x16x32_bf16 v[44:47], v[48:51], v[140:143], v[44:47]
    v_and_b32 v234, 3, v0
    v_mfma_f32_16x16x32_bf16 v[44:47], v[52:55], v[136:139], v[44:47]
    v_lshl_add_u32 v234, v234, 4, s74
    v_mfma_f32_16x16x32_bf16 v[44:47], v[56:59], v[132:135], v[44:47]
    v_and_b32 v235, 12, v0
    v_mfma_f32_16x16x32_bf16 v[44:47], v[60:63], v[128:131], v[44:47]
    v_lshrrev_b32 v236, 4, v0
    v_mfma_f32_16x16x32_bf16 v[44:47], v[64:67], v[124:127], v[44:47]
    v_add_u32 v235, v235, v236
    v_mfma_f32_16x16x32_bf16 v[44:47], v[68:71], v[120:123], v[44:47]
    v_mul_u32_u24 v235, 4224, v235
    v_mfma_f32_16x16x32_bf16 v[44:47], v[72:75], v[116:119], v[44:47]
    v_add_u32 v234, v234, v235
    v_mfma_f32_16x16x32_bf16 v[44:47], v[76:79], v[112:115], v[44:47]
    s_waitcnt lgkmcnt(0)
    v_mfma_f32_16x16x32_bf16 v[16:19], v[80:83], v[144:147], v[16:19]
    s_bfe_u32 s86, s2, 0x10002
    s_lshr_b32 s74, s2, 5
    v_mfma_f32_16x16x32_bf16 v[20:23], v[80:83], v[148:151], v[20:23]
    s_lshl3_add_u32 s86, s86, s74
    v_lshrrev_b32 v236, 4, v0
    v_mfma_f32_16x16x32_bf16 v[20:23], v[84:87], v[144:147], v[20:23]
    v_lshlrev_b32 v236, 1, v236
    v_xor_b32 v236, v0, v236
    v_mfma_f32_16x16x32_bf16 v[24:27], v[80:83], v[152:155], v[24:27]
    v_and_b32 v236, 7, v236
    s_lshl_b32 s74, s86, 7
    v_cvt_pk_bf16_f32 v48, v16, v17
    v_cvt_pk_bf16_f32 v49, v18, v19
    v_mfma_f32_16x16x32_bf16 v[24:27], v[84:87], v[148:151], v[24:27]
    v_lshl_add_u32 v236, v236, 4, s74
    v_lshrrev_b32 v235, 3, v0
    v_cvt_pk_bf16_f32 v50, v20, v21
    v_cvt_pk_bf16_f32 v51, v22, v23
    v_mfma_f32_16x16x32_bf16 v[24:27], v[88:91], v[144:147], v[24:27]
    v_lshl_add_u32 v235, v235, 11, v236
    s_mov_b32 s56, s24
    s_mov_b32 s76, 0
    buffer_store_dwordx4 v[48:51], v234, s[64:67], s76 offen sc1
    v_mfma_f32_16x16x32_bf16 v[28:31], v[80:83], v[156:159], v[28:31]
    s_mov_b32 s57, s25
    s_mov_b32 s58, 0x200000
    v_mfma_f32_16x16x32_bf16 v[28:31], v[84:87], v[152:155], v[28:31]
    s_mov_b32 s59, 0x20000
    s_mul_i32 s74, s86, 4
    v_cvt_pk_bf16_f32 v52, v24, v25
    v_cvt_pk_bf16_f32 v53, v26, v27
    v_mfma_f32_16x16x32_bf16 v[28:31], v[88:91], v[148:151], v[28:31]
    s_and_b32 s74, s74, 7
    s_lshl1_add_u32 s82, s74, s70
    v_mfma_f32_16x16x32_bf16 v[28:31], v[92:95], v[144:147], v[28:31]
    s_lshl_b32 s82, s82, 17
    s_add_u32 s73, s68, 32
    v_mfma_f32_16x16x32_bf16 v[32:35], v[80:83], v[160:163], v[32:35]
    s_lshl_b32 s73, s73, 8
    v_mfma_f32_16x16x32_bf16 v[32:35], v[84:87], v[156:159], v[32:35]
    v_mfma_f32_16x16x32_bf16 v[32:35], v[88:91], v[152:155], v[32:35]
    v_mfma_f32_16x16x32_bf16 v[32:35], v[92:95], v[148:151], v[32:35]
    v_mfma_f32_16x16x32_bf16 v[32:35], v[96:99], v[144:147], v[32:35]
    v_mfma_f32_16x16x32_bf16 v[36:39], v[80:83], v[164:167], v[36:39]
    v_mfma_f32_16x16x32_bf16 v[36:39], v[84:87], v[160:163], v[36:39]
    v_cvt_pk_bf16_f32 v54, v28, v29
    v_cvt_pk_bf16_f32 v55, v30, v31
    v_mfma_f32_16x16x32_bf16 v[36:39], v[88:91], v[156:159], v[36:39]
    s_mov_b32 s76, 67584
    buffer_store_dwordx4 v[52:55], v234, s[64:67], s76 offen sc1
    v_mfma_f32_16x16x32_bf16 v[36:39], v[92:95], v[152:155], v[36:39]
    v_cvt_pk_bf16_f32 v56, v32, v33
    v_cvt_pk_bf16_f32 v57, v34, v35
    v_mfma_f32_16x16x32_bf16 v[36:39], v[96:99], v[148:151], v[36:39]
    v_mfma_f32_16x16x32_bf16 v[36:39], v[100:103], v[144:147], v[36:39]
    v_mfma_f32_16x16x32_bf16 v[40:43], v[80:83], v[168:171], v[40:43]
    v_mfma_f32_16x16x32_bf16 v[40:43], v[84:87], v[164:167], v[40:43]
    v_mfma_f32_16x16x32_bf16 v[40:43], v[88:91], v[160:163], v[40:43]
    v_mfma_f32_16x16x32_bf16 v[40:43], v[92:95], v[156:159], v[40:43]
    v_mfma_f32_16x16x32_bf16 v[40:43], v[96:99], v[152:155], v[40:43]
    v_mfma_f32_16x16x32_bf16 v[40:43], v[100:103], v[148:151], v[40:43]
    v_mfma_f32_16x16x32_bf16 v[40:43], v[104:107], v[144:147], v[40:43]
    v_mfma_f32_16x16x32_bf16 v[44:47], v[80:83], v[172:175], v[44:47]
    v_cvt_pk_bf16_f32 v58, v36, v37
    v_cvt_pk_bf16_f32 v59, v38, v39
    v_mfma_f32_16x16x32_bf16 v[44:47], v[84:87], v[168:171], v[44:47]
    s_mov_b32 s76, 135168
    buffer_store_dwordx4 v[56:59], v234, s[64:67], s76 offen sc1
    v_mfma_f32_16x16x32_bf16 v[44:47], v[88:91], v[164:167], v[44:47]
    v_mfma_f32_16x16x32_bf16 v[44:47], v[92:95], v[160:163], v[44:47]
    v_cvt_pk_bf16_f32 v60, v40, v41
    v_cvt_pk_bf16_f32 v61, v42, v43
    v_mfma_f32_16x16x32_bf16 v[44:47], v[96:99], v[156:159], v[44:47]
    v_mfma_f32_16x16x32_bf16 v[44:47], v[100:103], v[152:155], v[44:47]
    v_mfma_f32_16x16x32_bf16 v[44:47], v[104:107], v[148:151], v[44:47]
    v_mfma_f32_16x16x32_bf16 v[44:47], v[108:111], v[144:147], v[44:47]
    s_nop 7
    v_cvt_pk_bf16_f32 v62, v44, v45
    v_cvt_pk_bf16_f32 v63, v46, v47
    s_mov_b32 s76, 202752
    buffer_store_dwordx4 v[60:63], v234, s[64:67], s76 offen sc1
    s_add_u32 m0, s80, 0
    s_add_u32 s83, s82, 1310720
    s_and_b32 s83, s83, 0x1fffff
    buffer_load_dwordx4 v235, s[56:59], s83 offen lds
    s_add_u32 m0, s80, 1024
    s_add_u32 s83, s82, 1327104
    s_and_b32 s83, s83, 0x1fffff
    buffer_load_dwordx4 v235, s[56:59], s83 offen lds
    s_add_u32 m0, s80, 2048
    s_add_u32 s83, s82, 1343488
    s_and_b32 s83, s83, 0x1fffff
    buffer_load_dwordx4 v235, s[56:59], s83 offen lds
    s_add_u32 m0, s80, 3072
    s_add_u32 s83, s82, 1359872
    s_and_b32 s83, s83, 0x1fffff
    buffer_load_dwordx4 v235, s[56:59], s83 offen lds
    s_add_u32 m0, s80, 4096
    s_add_u32 s83, s82, 1376256
    s_and_b32 s83, s83, 0x1fffff
    buffer_load_dwordx4 v235, s[56:59], s83 offen lds
    s_add_u32 m0, s80, 5120
    s_add_u32 s83, s82, 1392640
    s_and_b32 s83, s83, 0x1fffff
    buffer_load_dwordx4 v235, s[56:59], s83 offen lds
    s_add_u32 m0, s80, 6144
    s_add_u32 s83, s82, 1409024
    s_and_b32 s83, s83, 0x1fffff
    buffer_load_dwordx4 v235, s[56:59], s83 offen lds
    s_add_u32 m0, s80, 7168
    s_add_u32 s83, s82, 1425408
    s_and_b32 s83, s83, 0x1fffff
    buffer_load_dwordx4 v235, s[56:59], s83 offen lds
    s_waitcnt vmcnt(8)
    v_mov_b32 v238, 1
    s_mov_b64 exec, 1
    ds_add_rtn_u32 v237, v227, v238 offset:8
    s_waitcnt lgkmcnt(0)
    v_readfirstlane_b32 s76, v237
    s_nop 0
    s_cmp_eq_u32 s76, 3
    s_cbranch_scc0 L_jo_30a
    buffer_atomic_add v238, off, s[52:55], s73 sc1
L_jo_30a:
    s_mov_b64 exec, -1
    s_cmp_ge_u32 s70, 2
    s_cbranch_scc1 L_nowo3
    s_add_u32 m0, s81, 0
    s_add_u32 s83, s82, 1835008
    s_and_b32 s83, s83, 0x1fffff
    buffer_load_dwordx4 v235, s[56:59], s83 offen lds
    s_add_u32 m0, s81, 1024
    s_add_u32 s83, s82, 1851392
    s_and_b32 s83, s83, 0x1fffff
    buffer_load_dwordx4 v235, s[56:59], s83 offen lds
    s_add_u32 m0, s81, 2048
    s_add_u32 s83, s82, 1867776
    s_and_b32 s83, s83, 0x1fffff
    buffer_load_dwordx4 v235, s[56:59], s83 offen lds
    s_add_u32 m0, s81, 3072
    s_add_u32 s83, s82, 1884160
    s_and_b32 s83, s83, 0x1fffff
    buffer_load_dwordx4 v235, s[56:59], s83 offen lds
    s_add_u32 m0, s81, 4096
    s_add_u32 s83, s82, 1900544
    s_and_b32 s83, s83, 0x1fffff
    buffer_load_dwordx4 v235, s[56:59], s83 offen lds
    s_add_u32 m0, s81, 5120
    s_add_u32 s83, s82, 1916928
    s_and_b32 s83, s83, 0x1fffff
    buffer_load_dwordx4 v235, s[56:59], s83 offen lds
    s_add_u32 m0, s81, 6144
    s_add_u32 s83, s82, 1933312
    s_and_b32 s83, s83, 0x1fffff
    buffer_load_dwordx4 v235, s[56:59], s83 offen lds
    s_add_u32 m0, s81, 7168
    s_add_u32 s83, s82, 1949696
    s_and_b32 s83, s83, 0x1fffff
    buffer_load_dwordx4 v235, s[56:59], s83 offen lds
L_nowo3:
    v_lshlrev_b32 v112, 16, v208
    v_and_b32 v113, 0xffff0000, v208
    v_lshlrev_b32 v114, 16, v209
    v_and_b32 v115, 0xffff0000, v209
    v_lshlrev_b32 v116, 16, v210
    v_and_b32 v117, 0xffff0000, v210
    v_lshlrev_b32 v118, 16, v211
    v_and_b32 v119, 0xffff0000, v211
    v_lshlrev_b32 v120, 16, v212
    v_and_b32 v121, 0xffff0000, v212
    v_lshlrev_b32 v122, 16, v213
    v_and_b32 v123, 0xffff0000, v213
    v_lshlrev_b32 v124, 16, v214
    v_and_b32 v125, 0xffff0000, v214
    v_lshlrev_b32 v126, 16, v215
    v_and_b32 v127, 0xffff0000, v215
    v_lshlrev_b32 v128, 16, v216
    v_and_b32 v129, 0xffff0000, v216
    v_lshlrev_b32 v130, 16, v217
    v_and_b32 v131, 0xffff0000, v217
    v_lshlrev_b32 v132, 16, v218
    v_and_b32 v133, 0xffff0000, v218
    v_lshlrev_b32 v134, 16, v219
    v_and_b32 v135, 0xffff0000, v219
    v_lshlrev_b32 v136, 16, v220
    v_and_b32 v137, 0xffff0000, v220
    v_lshlrev_b32 v138, 16, v221
    v_and_b32 v139, 0xffff0000, v221
    v_lshlrev_b32 v140, 16, v222
    v_and_b32 v141, 0xffff0000, v222
    v_lshlrev_b32 v142, 16, v223
    v_and_b32 v143, 0xffff0000, v223
    s_mul_i32 s77, s70, 4352
    s_add_u32 s77, s77, 60416
    v_lshrrev_b32 v234, 5, v0
    v_lshl_add_u32 v234, v234, 1, v0
    v_lshl_add_u32 v234, v234, 4, s77
    v_and_b32 v235, 7, v0
    v_mul_u32_u24 v235, 544, v235
    v_lshrrev_b32 v236, 3, v0
    v_lshl_add_u32 v235, v236, 3, v235
    v_add_u32 v235, s77, v235
    s_mul_i32 s77, s71, 4224
    s_mov_b32 s60, s26
    s_mov_b32 s61, s27
    s_mov_b32 s62, 0x800000
    s_mov_b32 s63, 0x20000
    s_waitcnt vmcnt(0)
    s_mov_b64 exec, 1
    ds_add_u32 v227, v244 offset:12
    s_mov_b64 exec, -1
    s_cmp_eq_u32 s76, 3
    s_cbranch_scc0 L_jo_30
    s_mov_b32 s75, 131072
L_sg_loop_33:
    s_load_dword s74, s[52:53], s73 glc
L_sg_chk_34:
    s_waitcnt lgkmcnt(0)
    s_cmp_ge_u32 s74, 16
    s_cbranch_scc1 L_sg_done_32
    s_sub_u32 s75, s75, 1
    s_cbranch_scc0 L_sg_loop_33
L_sg_done_32:
    v_mov_b32 v237, 16
    s_mov_b64 exec, 1
    ds_add_u32 v227, v237 offset:16
    s_mov_b64 exec, -1
    s_branch L_jd_31
L_jo_30:
    s_mov_b32 s75, 1048576
L_sl_loop_36:
    ds_read_b32 v237, v227 offset:16
    s_waitcnt lgkmcnt(0)
    v_readfirstlane_b32 s74, v237
    s_nop 0
    s_cmp_ge_u32 s74, 16
    s_cbranch_scc1 L_sl_done_35
    s_sleep 1
    s_sub_u32 s75, s75, 1
    s_cbranch_scc0 L_sl_loop_36
L_sl_done_35:
L_jd_31:
    buffer_load_dwordx4 v[48:51], v224, s[64:67], s77 offen offset:0 sc1
    buffer_load_dwordx4 v[52:55], v224, s[64:67], s77 offen offset:1024 sc1
    buffer_load_dwordx4 v[56:59], v224, s[64:67], s77 offen offset:2048 sc1
    buffer_load_dwordx4 v[60:63], v224, s[64:67], s77 offen offset:3072 sc1
    s_waitcnt vmcnt(3)
    ds_write_b128 v234, v[48:51] offset:0
    s_waitcnt vmcnt(2)
    ds_write_b128 v234, v[52:55] offset:1088
    s_waitcnt vmcnt(1)
    ds_write_b128 v234, v[56:59] offset:2176
    s_waitcnt vmcnt(0)
    ds_write_b128 v234, v[60:63] offset:3264
    ds_read_b64 v[64:65], v235 offset:0
    ds_read_b64 v[66:67], v235 offset:64
    ds_read_b64 v[68:69], v235 offset:128
    ds_read_b64 v[70:71], v235 offset:192
    ds_read_b64 v[72:73], v235 offset:256
    ds_read_b64 v[74:75], v235 offset:320
    ds_read_b64 v[76:77], v235 offset:384
    ds_read_b64 v[78:79], v235 offset:448
    s_waitcnt lgkmcnt(7)
    v_lshlrev_b32 v16, 16, v64
    v_and_b32 v24, 0xffff0000, v64
    v_lshlrev_b32 v32, 16, v65
    v_and_b32 v40, 0xffff0000, v65
    s_waitcnt lgkmcnt(6)
    v_lshlrev_b32 v17, 16, v66
    v_and_b32 v25, 0xffff0000, v66
    v_lshlrev_b32 v33, 16, v67
    v_and_b32 v41, 0xffff0000, v67
    s_waitcnt lgkmcnt(5)
    v_lshlrev_b32 v18, 16, v68
    v_and_b32 v26, 0xffff0000, v68
    v_lshlrev_b32 v34, 16, v69
    v_and_b32 v42, 0xffff0000, v69
    s_waitcnt lgkmcnt(4)
    v_lshlrev_b32 v19, 16, v70
    v_and_b32 v27, 0xffff0000, v70
    v_lshlrev_b32 v35, 16, v71
    v_and_b32 v43, 0xffff0000, v71
    s_waitcnt lgkmcnt(3)
    v_lshlrev_b32 v20, 16, v72
    v_and_b32 v28, 0xffff0000, v72
    v_lshlrev_b32 v36, 16, v73
    v_and_b32 v44, 0xffff0000, v73
    s_waitcnt lgkmcnt(2)
    v_lshlrev_b32 v21, 16, v74
    v_and_b32 v29, 0xffff0000, v74
    v_lshlrev_b32 v37, 16, v75
    v_and_b32 v45, 0xffff0000, v75
    s_waitcnt lgkmcnt(1)
    v_lshlrev_b32 v22, 16, v76
    v_and_b32 v30, 0xffff0000, v76
    v_lshlrev_b32 v38, 16, v77
    v_and_b32 v46, 0xffff0000, v77
    s_waitcnt lgkmcnt(0)
    v_lshlrev_b32 v23, 16, v78
    v_and_b32 v31, 0xffff0000, v78
    v_lshlrev_b32 v39, 16, v79
    v_and_b32 v47, 0xffff0000, v79
    v_mul_f32 v16, v16, v112
    v_mul_f32 v17, v17, v113
    v_mul_f32 v18, v18, v114
    v_mul_f32 v19, v19, v115
    v_mul_f32 v20, v20, v116
    v_mul_f32 v21, v21, v117
    v_mul_f32 v22, v22, v118
    v_mul_f32 v23, v23, v119
    v_cvt_pk_bf16_f32 v48, v16, v17
    v_cvt_pk_bf16_f32 v49, v18, v19
    v_cvt_pk_bf16_f32 v50, v20, v21
    v_cvt_pk_bf16_f32 v51, v22, v23
    s_mov_b32 s74, 0
    buffer_store_dwordx4 v[48:51], v226, s[60:63], s74 offen
    v_mul_f32 v24, v24, v120
    v_mul_f32 v25, v25, v121
    v_mul_f32 v26, v26, v122
    v_mul_f32 v27, v27, v123
    v_mul_f32 v28, v28, v124
    v_mul_f32 v29, v29, v125
    v_mul_f32 v30, v30, v126
    v_mul_f32 v31, v31, v127
    v_cvt_pk_bf16_f32 v52, v24, v25
    v_cvt_pk_bf16_f32 v53, v26, v27
    v_cvt_pk_bf16_f32 v54, v28, v29
    v_cvt_pk_bf16_f32 v55, v30, v31
    s_mov_b32 s74, 4096
    buffer_store_dwordx4 v[52:55], v226, s[60:63], s74 offen
    v_mul_f32 v32, v32, v128
    v_mul_f32 v33, v33, v129
    v_mul_f32 v34, v34, v130
    v_mul_f32 v35, v35, v131
    v_mul_f32 v36, v36, v132
    v_mul_f32 v37, v37, v133
    v_mul_f32 v38, v38, v134
    v_mul_f32 v39, v39, v135
    v_cvt_pk_bf16_f32 v56, v32, v33
    v_cvt_pk_bf16_f32 v57, v34, v35
    v_cvt_pk_bf16_f32 v58, v36, v37
    v_cvt_pk_bf16_f32 v59, v38, v39
    s_mov_b32 s74, 16384
    buffer_store_dwordx4 v[56:59], v226, s[60:63], s74 offen
    v_mul_f32 v40, v40, v136
    v_mul_f32 v41, v41, v137
    v_mul_f32 v42, v42, v138
    v_mul_f32 v43, v43, v139
    v_mul_f32 v44, v44, v140
    v_mul_f32 v45, v45, v141
    v_mul_f32 v46, v46, v142
    v_mul_f32 v47, v47, v143
    v_cvt_pk_bf16_f32 v60, v40, v41
    v_cvt_pk_bf16_f32 v61, v42, v43
    v_cvt_pk_bf16_f32 v62, v44, v45
    v_cvt_pk_bf16_f32 v63, v46, v47
    s_mov_b32 s74, 20480
    buffer_store_dwordx4 v[60:63], v226, s[60:63], s74 offen
    s_endpgm
L_grole:
    s_setprio 2
    s_lshr_b32 s32, s3, 1
    s_and_b32 s33, s3, 1
    v_and_b32 v1, 15, v0
    v_lshrrev_b32 v2, 4, v0
    v_lshrrev_b32 v3, 1, v1
    v_xor_b32 v3, v2, v3
    v_lshlrev_b32 v3, 4, v3
    v_lshl_add_u32 v3, v1, 7, v3
    s_lshl_b32 s37, s33, 13
    v_add_u32 v196, s37, v3
    v_xor_b32 v197, 64, v196
    v_and_b32 v3, 6, v1
    v_xor_b32 v3, v2, v3
    v_lshlrev_b32 v3, 4, v3
    v_and_b32 v198, 7, v1
    v_lshl_add_u32 v3, v198, 7, v3
    v_add_u32 v198, 16384, v3
    v_xor_b32 v199, 64, v198
    v_bfe_u32 v3, v0, 2, 2
    v_lshl_add_u32 v200, v2, 3, v3
    v_lshlrev_b32 v200, 7, v200
    v_bfe_u32 v3, v0, 3, 2
    v_xor_b32 v3, s3, v3
    v_lshl_add_u32 v200, v3, 5, v200
    v_and_b32 v3, 3, v0
    v_lshl_add_u32 v200, v3, 3, v200
    v_add_u32 v200, 17408, v200
    v_xor_b32 v201, 32, v200
    v_mov_b64 v[52:53], 0
    v_mov_b64 v[54:55], 0
    v_mov_b64 v[56:57], 0
    v_mov_b64 v[58:59], 0
    v_mov_b64 v[60:61], 0
    v_mov_b64 v[62:63], 0
    v_mov_b64 v[64:65], 0
    v_mov_b64 v[66:67], 0
    v_mov_b64 v[68:69], 0
    v_mov_b64 v[70:71], 0
    v_mov_b64 v[72:73], 0
    v_mov_b64 v[74:75], 0
    v_mov_b64 v[76:77], 0
    v_mov_b64 v[78:79], 0
    v_mov_b64 v[80:81], 0
    v_mov_b64 v[82:83], 0
    v_mov_b64 v[84:85], 0
    v_mov_b64 v[86:87], 0
    v_mov_b64 v[88:89], 0
    v_mov_b64 v[90:91], 0
    v_mov_b64 v[92:93], 0
    v_mov_b64 v[94:95], 0
    v_mov_b64 v[96:97], 0
    v_mov_b64 v[98:99], 0
    v_mov_b64 v[100:101], 0
    v_mov_b64 v[102:103], 0
    v_mov_b64 v[104:105], 0
    v_mov_b64 v[106:107], 0
    s_mov_b32 s34, 0
    v_mov_b32 v228, 134352
    v_and_b32 v1, 15, v0
    v_lshrrev_b32 v2, 4, v0
    v_lshlrev_b32 v2, 2, v2
    v_sub_u32 v1, v1, v2
    s_mov_b32 s37, 0xf149f2ca
    v_mov_b32 v3, s37
    s_or_b32 s38, s5, s33
    s_cmp_eq_u32 s38, 0
    s_cselect_b32 s38, s37, 0
    v_subrev_u32 v2, 0, v1
    v_cmp_gt_u32 vcc, 8, v2
    v_cmp_gt_i32 s[64:65], -8, v2
    v_ashrrev_i32 v2, 31, v2
    v_cndmask_b32 v204, v3, 0, vcc
    v_cndmask_b32 v208, v3, 0, s[64:65]
    v_mov_b32 v216, v2
    v_min_f32 v212, s38, v208
    v_subrev_u32 v2, 1, v1
    v_cmp_gt_u32 vcc, 8, v2
    v_cmp_gt_i32 s[64:65], -8, v2
    v_ashrrev_i32 v2, 31, v2
    v_cndmask_b32 v205, v3, 0, vcc
    v_cndmask_b32 v209, v3, 0, s[64:65]
    v_alignbit_b32 v216, v2, v216, 16
    v_min_f32 v213, s38, v209
    v_subrev_u32 v2, 2, v1
    v_cmp_gt_u32 vcc, 8, v2
    v_cmp_gt_i32 s[64:65], -8, v2
    v_ashrrev_i32 v2, 31, v2
    v_cndmask_b32 v206, v3, 0, vcc
    v_cndmask_b32 v210, v3, 0, s[64:65]
    v_mov_b32 v217, v2
    v_min_f32 v214, s38, v210
    v_subrev_u32 v2, 3, v1
    v_cmp_gt_u32 vcc, 8, v2
    v_cmp_gt_i32 s[64:65], -8, v2
    v_ashrrev_i32 v2, 31, v2
    v_cndmask_b32 v207, v3, 0, vcc
    v_cndmask_b32 v211, v3, 0, s[64:65]
    v_alignbit_b32 v217, v2, v217, 16
    v_min_f32 v215, s38, v211
    s_mul_i32 s37, s32, 80896
    s_add_u32 s37, s37, 78848
    v_lshl_add_u32 v220, v0, 3, s37
    s_lshl_b32 s38, s33, 9
    v_add_u32 v219, s38, v220
    s_mul_i32 s38, s33, 2560
    v_add_u32 v221, s38, v220
    v_xor_b32 v222, 512, v221
    s_lshl3_add_u32 s37, s4, s5
    s_lshl1_add_u32 s37, s37, s33
    s_lshl_b32 s37, s37, 7
    s_lshl1_add_u32 s38, s6, s32
    s_add_u32 s37, s37, s38
    s_lshl_b32 s37, s37, 10
    v_lshl_add_u32 v218, v0, 4, s37
    s_mov_b32 s40, s30
    s_mov_b32 s41, s31
    s_mov_b32 s42, 0x400000
    s_mov_b32 s43, 0x20000
    s_and_b32 s58, s2, 3
    s_bfe_u32 s37, s2, 0x20003
    s_lshl2_add_u32 s58, s58, s37
    s_bfe_u32 s59, s2, 0x10002
    s_lshr_b32 s37, s2, 5
    s_lshl3_add_u32 s59, s59, s37
    s_mov_b32 s44, s24
    s_mov_b32 s45, s25
    s_mov_b32 s46, 0x200000
    s_mov_b32 s47, 0x20000
    s_mov_b32 s48, s26
    s_mov_b32 s49, s27
    s_mov_b32 s50, 0x800000
    s_mov_b32 s51, 0x20000
    s_lshl3_add_u32 s56, s4, s5
    s_add_u32 s56, s56, 16
    s_lshl_b32 s56, s56, 8
    s_add_u32 s57, s58, 16
    s_lshl_b32 s57, s57, 8
    s_lshl2_add_u32 s37, s58, s3
    s_lshl_b32 s38, s37, 16
    v_lshl_add_u32 v224, v0, 4, s38
    v_add_u32 v225, 0x8000, v224
    s_and_b32 s37, s37, 31
    s_lshl_b32 s37, s37, 6
    s_lshr_b32 s38, s58, 3
    s_add_u32 s37, s37, s38
    s_lshl_b32 s37, s37, 5
    s_add_u32 s37, s37, s59
    s_add_u32 s37, s37, 16
    s_lshl_b32 s37, s37, 7
    v_and_b32 v1, 15, v0
    v_lshl_add_u32 v1, v1, 13, s37
    v_bfe_u32 v2, v0, 4, 1
    v_lshl_add_u32 v1, v2, 5, v1
    v_lshrrev_b32 v2, 5, v0
    v_lshl_add_u32 v226, v2, 4, v1
    v_lshrrev_b32 v1, 4, v0
    v_lshlrev_b32 v1, 1, v1
    v_xor_b32 v1, v0, v1
    v_and_b32 v1, 7, v1
    s_lshl_b32 s37, s59, 7
    v_lshl_add_u32 v1, v1, 4, s37
    v_lshrrev_b32 v227, 3, v0
    v_lshl_add_u32 v227, v227, 11, v1
    s_lshl_b32 s60, s3, 11
    s_mul_i32 s61, s59, 4
    s_and_b32 s61, s61, 7
    s_lshl3_add_u32 s62, s61, s3
    s_lshl_b32 s62, s62, 15
    v_lshrrev_b32 v1, 2, v0
    v_lshlrev_b32 v1, 7, v1
    v_bfe_u32 v2, v0, 3, 2
    v_lshl_add_u32 v1, v2, 5, v1
    v_and_b32 v2, 3, v0
    v_lshl_add_u32 v229, v2, 3, v1
    v_and_b32 v231, 7, v0
    v_lshl_add_u32 v230, v231, 6, s86
    v_mul_u32_u24 v231, 528, v231
    v_lshrrev_b32 v232, 3, v0
    v_xor_b32 v232, 7, v232
    v_lshl_add_u32 v231, v232, 3, v231
    v_add_u32 v231, s86, v231
    v_lshrrev_b32 v232, 5, v0
    v_add_u32 v232, v0, v232
    v_lshl_add_u32 v232, v232, 4, s86
    s_mul_i32 s87, s84, 4224
    s_sub_u32 s87, s87, s85
    s_lshl_b32 s87, s87, 6
    s_add_u32 s87, s87, 4032
    v_and_b32 v233, 3, v0
    v_lshl_add_u32 v233, v233, 4, s87
    v_lshrrev_b32 v234, 2, v0
    v_mul_u32_u24 v234, 4224, v234
    v_add_u32 v233, v233, v234
    s_add_u32 s80, s30, 0x400000
    s_addc_u32 s81, s31, 0
    s_mov_b32 s82, 0x420000
    s_mov_b32 s83, 0x20000
    s_waitcnt vmcnt(14)
    ds_read_b128 v[36:39], v230 offset:4224
    ds_read_b128 v[40:43], v230 offset:4240
    ds_read_b128 v[44:47], v230 offset:4256
    ds_read_b128 v[48:51], v230 offset:4272
    s_waitcnt lgkmcnt(3)
    v_lshlrev_b32 v152, 16, v36
    v_and_b32 v154, 0xffff0000, v36
    v_lshlrev_b32 v156, 16, v37
    v_and_b32 v158, 0xffff0000, v37
    v_lshlrev_b32 v153, 16, v38
    v_and_b32 v155, 0xffff0000, v38
    v_lshlrev_b32 v157, 16, v39
    v_and_b32 v159, 0xffff0000, v39
    s_waitcnt lgkmcnt(2)
    v_lshlrev_b32 v160, 16, v40
    v_and_b32 v162, 0xffff0000, v40
    v_lshlrev_b32 v164, 16, v41
    v_and_b32 v166, 0xffff0000, v41
    v_lshlrev_b32 v161, 16, v42
    v_and_b32 v163, 0xffff0000, v42
    v_lshlrev_b32 v165, 16, v43
    v_and_b32 v167, 0xffff0000, v43
    s_waitcnt lgkmcnt(1)
    v_lshlrev_b32 v168, 16, v44
    v_and_b32 v170, 0xffff0000, v44
    v_lshlrev_b32 v172, 16, v45
    v_and_b32 v174, 0xffff0000, v45
    v_lshlrev_b32 v169, 16, v46
    v_and_b32 v171, 0xffff0000, v46
    v_lshlrev_b32 v173, 16, v47
    v_and_b32 v175, 0xffff0000, v47
    s_waitcnt lgkmcnt(0)
    v_lshlrev_b32 v176, 16, v48
    v_and_b32 v178, 0xffff0000, v48
    v_lshlrev_b32 v180, 16, v49
    v_and_b32 v182, 0xffff0000, v49
    v_lshlrev_b32 v177, 16, v50
    v_and_b32 v179, 0xffff0000, v50
    v_lshlrev_b32 v181, 16, v51
    v_and_b32 v183, 0xffff0000, v51
    v_mov_b64 v[36:37], 0
    v_mov_b64 v[38:39], 0
    v_mov_b64 v[40:41], 0
    v_mov_b64 v[42:43], 0
    v_mov_b64 v[44:45], 0
    v_mov_b64 v[46:47], 0
    v_mov_b64 v[48:49], 0
    v_mov_b64 v[50:51], 0
    s_waitcnt vmcnt(13)
    v_lshlrev_b32 v184, 16, v108
    v_and_b32 v185, 0xffff0000, v108
    v_lshlrev_b32 v186, 16, v109
    v_and_b32 v187, 0xffff0000, v109
    v_lshlrev_b32 v188, 16, v110
    v_and_b32 v189, 0xffff0000, v110
    v_lshlrev_b32 v190, 16, v111
    v_and_b32 v191, 0xffff0000, v111
    v_pk_mul_f32 v[4:5], v[184:185], v[158:159]
    v_pk_mul_f32 v[12:13], v[186:187], v[166:167]
    v_pk_mul_f32 v[20:21], v[188:189], v[174:175]
    v_pk_mul_f32 v[28:29], v[190:191], v[182:183]
    s_waitcnt vmcnt(12)
    v_lshlrev_b32 v184, 16, v112
    v_and_b32 v185, 0xffff0000, v112
    v_lshlrev_b32 v186, 16, v113
    v_and_b32 v187, 0xffff0000, v113
    v_lshlrev_b32 v188, 16, v114
    v_and_b32 v189, 0xffff0000, v114
    v_lshlrev_b32 v190, 16, v115
    v_and_b32 v191, 0xffff0000, v115
    v_pk_fma_f32 v[4:5], v[184:185], v[156:157], v[4:5]
    v_pk_fma_f32 v[12:13], v[186:187], v[164:165], v[12:13]
    v_pk_fma_f32 v[20:21], v[188:189], v[172:173], v[20:21]
    v_pk_fma_f32 v[28:29], v[190:191], v[180:181], v[28:29]
    v_pk_mul_f32 v[6:7], v[184:185], v[158:159]
    v_pk_mul_f32 v[14:15], v[186:187], v[166:167]
    v_pk_mul_f32 v[22:23], v[188:189], v[174:175]
    v_pk_mul_f32 v[30:31], v[190:191], v[182:183]
    s_waitcnt vmcnt(11)
    v_lshlrev_b32 v184, 16, v116
    v_and_b32 v185, 0xffff0000, v116
    v_lshlrev_b32 v186, 16, v117
    v_and_b32 v187, 0xffff0000, v117
    v_lshlrev_b32 v188, 16, v118
    v_and_b32 v189, 0xffff0000, v118
    v_lshlrev_b32 v190, 16, v119
    v_and_b32 v191, 0xffff0000, v119
    v_pk_fma_f32 v[4:5], v[184:185], v[154:155], v[4:5]
    v_pk_fma_f32 v[12:13], v[186:187], v[162:163], v[12:13]
    v_pk_fma_f32 v[20:21], v[188:189], v[170:171], v[20:21]
    v_pk_fma_f32 v[28:29], v[190:191], v[178:179], v[28:29]
    v_pk_fma_f32 v[6:7], v[184:185], v[156:157], v[6:7]
    v_pk_fma_f32 v[14:15], v[186:187], v[164:165], v[14:15]
    v_pk_fma_f32 v[22:23], v[188:189], v[172:173], v[22:23]
    v_pk_fma_f32 v[30:31], v[190:191], v[180:181], v[30:31]
    v_pk_mul_f32 v[8:9], v[184:185], v[158:159]
    v_pk_mul_f32 v[16:17], v[186:187], v[166:167]
    v_pk_mul_f32 v[24:25], v[188:189], v[174:175]
    v_pk_mul_f32 v[32:33], v[190:191], v[182:183]
    s_waitcnt vmcnt(10)
    v_lshlrev_b32 v184, 16, v120
    v_and_b32 v185, 0xffff0000, v120
    v_lshlrev_b32 v186, 16, v121
    v_and_b32 v187, 0xffff0000, v121
    v_lshlrev_b32 v188, 16, v122
    v_and_b32 v189, 0xffff0000, v122
    v_lshlrev_b32 v190, 16, v123
    v_and_b32 v191, 0xffff0000, v123
    v_pk_fma_f32 v[4:5], v[184:185], v[152:153], v[4:5]
    v_pk_fma_f32 v[12:13], v[186:187], v[160:161], v[12:13]
    v_pk_fma_f32 v[20:21], v[188:189], v[168:169], v[20:21]
    v_pk_fma_f32 v[28:29], v[190:191], v[176:177], v[28:29]
    v_pk_fma_f32 v[6:7], v[184:185], v[154:155], v[6:7]
    v_pk_fma_f32 v[14:15], v[186:187], v[162:163], v[14:15]
    v_pk_fma_f32 v[22:23], v[188:189], v[170:171], v[22:23]
    v_pk_fma_f32 v[30:31], v[190:191], v[178:179], v[30:31]
    v_pk_fma_f32 v[8:9], v[184:185], v[156:157], v[8:9]
    v_pk_fma_f32 v[16:17], v[186:187], v[164:165], v[16:17]
    v_pk_fma_f32 v[24:25], v[188:189], v[172:173], v[24:25]
    v_pk_fma_f32 v[32:33], v[190:191], v[180:181], v[32:33]
    v_pk_mul_f32 v[10:11], v[184:185], v[158:159]
    v_pk_mul_f32 v[18:19], v[186:187], v[166:167]
    v_pk_mul_f32 v[26:27], v[188:189], v[174:175]
    v_pk_mul_f32 v[34:35], v[190:191], v[182:183]
    s_waitcnt vmcnt(9)
    v_lshlrev_b32 v184, 16, v124
    v_and_b32 v185, 0xffff0000, v124
    v_lshlrev_b32 v186, 16, v125
    v_and_b32 v187, 0xffff0000, v125
    v_lshlrev_b32 v188, 16, v126
    v_and_b32 v189, 0xffff0000, v126
    v_lshlrev_b32 v190, 16, v127
    v_and_b32 v191, 0xffff0000, v127
    v_pk_fma_f32 v[6:7], v[184:185], v[152:153], v[6:7]
    v_pk_fma_f32 v[14:15], v[186:187], v[160:161], v[14:15]
    v_pk_fma_f32 v[22:23], v[188:189], v[168:169], v[22:23]
    v_pk_fma_f32 v[30:31], v[190:191], v[176:177], v[30:31]
    v_pk_fma_f32 v[8:9], v[184:185], v[154:155], v[8:9]
    v_pk_fma_f32 v[16:17], v[186:187], v[162:163], v[16:17]
    v_pk_fma_f32 v[24:25], v[188:189], v[170:171], v[24:25]
    v_pk_fma_f32 v[32:33], v[190:191], v[178:179], v[32:33]
    v_pk_fma_f32 v[10:11], v[184:185], v[156:157], v[10:11]
    v_pk_fma_f32 v[18:19], v[186:187], v[164:165], v[18:19]
    v_pk_fma_f32 v[26:27], v[188:189], v[172:173], v[26:27]
    v_pk_fma_f32 v[34:35], v[190:191], v[180:181], v[34:35]
    s_waitcnt vmcnt(8)
    v_lshlrev_b32 v184, 16, v128
    v_and_b32 v185, 0xffff0000, v128
    v_lshlrev_b32 v186, 16, v129
    v_and_b32 v187, 0xffff0000, v129
    v_lshlrev_b32 v188, 16, v130
    v_and_b32 v189, 0xffff0000, v130
    v_lshlrev_b32 v190, 16, v131
    v_and_b32 v191, 0xffff0000, v131
    v_pk_fma_f32 v[8:9], v[184:185], v[152:153], v[8:9]
    v_pk_fma_f32 v[16:17], v[186:187], v[160:161], v[16:17]
    v_pk_fma_f32 v[24:25], v[188:189], v[168:169], v[24:25]
    v_pk_fma_f32 v[32:33], v[190:191], v[176:177], v[32:33]
    v_pk_fma_f32 v[10:11], v[184:185], v[154:155], v[10:11]
    v_pk_fma_f32 v[18:19], v[186:187], v[162:163], v[18:19]
    v_pk_fma_f32 v[26:27], v[188:189], v[170:171], v[26:27]
    v_pk_fma_f32 v[34:35], v[190:191], v[178:179], v[34:35]
    s_waitcnt vmcnt(7)
    v_lshlrev_b32 v184, 16, v132
    v_and_b32 v185, 0xffff0000, v132
    v_lshlrev_b32 v186, 16, v133
    v_and_b32 v187, 0xffff0000, v133
    v_lshlrev_b32 v188, 16, v134
    v_and_b32 v189, 0xffff0000, v134
    v_lshlrev_b32 v190, 16, v135
    v_and_b32 v191, 0xffff0000, v135
    v_pk_fma_f32 v[10:11], v[184:185], v[152:153], v[10:11]
    v_pk_fma_f32 v[18:19], v[186:187], v[160:161], v[18:19]
    v_pk_fma_f32 v[26:27], v[188:189], v[168:169], v[26:27]
    v_pk_fma_f32 v[34:35], v[190:191], v[176:177], v[34:35]
    s_waitcnt vmcnt(6)
    v_lshlrev_b32 v184, 16, v136
    v_and_b32 v185, 0xffff0000, v136
    v_lshlrev_b32 v186, 16, v137
    v_and_b32 v187, 0xffff0000, v137
    v_lshlrev_b32 v188, 16, v138
    v_and_b32 v189, 0xffff0000, v138
    v_lshlrev_b32 v190, 16, v139
    v_and_b32 v191, 0xffff0000, v139
    v_pk_mul_f32 v[4:5], v[4:5], v[184:185]
    v_pk_mul_f32 v[12:13], v[12:13], v[186:187]
    v_pk_mul_f32 v[20:21], v[20:21], v[188:189]
    v_pk_mul_f32 v[28:29], v[28:29], v[190:191]
    s_waitcnt vmcnt(5)
    v_lshlrev_b32 v184, 16, v140
    v_and_b32 v185, 0xffff0000, v140
    v_lshlrev_b32 v186, 16, v141
    v_and_b32 v187, 0xffff0000, v141
    v_lshlrev_b32 v188, 16, v142
    v_and_b32 v189, 0xffff0000, v142
    v_lshlrev_b32 v190, 16, v143
    v_and_b32 v191, 0xffff0000, v143
    v_pk_mul_f32 v[6:7], v[6:7], v[184:185]
    v_pk_mul_f32 v[14:15], v[14:15], v[186:187]
    v_pk_mul_f32 v[22:23], v[22:23], v[188:189]
    v_pk_mul_f32 v[30:31], v[30:31], v[190:191]
    s_waitcnt vmcnt(4)
    v_lshlrev_b32 v184, 16, v144
    v_and_b32 v185, 0xffff0000, v144
    v_lshlrev_b32 v186, 16, v145
    v_and_b32 v187, 0xffff0000, v145
    v_lshlrev_b32 v188, 16, v146
    v_and_b32 v189, 0xffff0000, v146
    v_lshlrev_b32 v190, 16, v147
    v_and_b32 v191, 0xffff0000, v147
    v_pk_mul_f32 v[8:9], v[8:9], v[184:185]
    v_pk_mul_f32 v[16:17], v[16:17], v[186:187]
    v_pk_mul_f32 v[24:25], v[24:25], v[188:189]
    v_pk_mul_f32 v[32:33], v[32:33], v[190:191]
    s_waitcnt vmcnt(3)
    v_lshlrev_b32 v184, 16, v148
    v_and_b32 v185, 0xffff0000, v148
    v_lshlrev_b32 v186, 16, v149
    v_and_b32 v187, 0xffff0000, v149
    v_lshlrev_b32 v188, 16, v150
    v_and_b32 v189, 0xffff0000, v150
    v_lshlrev_b32 v190, 16, v151
    v_and_b32 v191, 0xffff0000, v151
    v_pk_mul_f32 v[10:11], v[10:11], v[184:185]
    v_pk_mul_f32 v[18:19], v[18:19], v[186:187]
    v_pk_mul_f32 v[26:27], v[26:27], v[188:189]
    v_pk_mul_f32 v[34:35], v[34:35], v[190:191]
    v_cvt_pk_bf16_f32 v108, v10, v8
    v_cvt_pk_bf16_f32 v109, v6, v4
    ds_write_b64 v231, v[108:109] offset:0
    v_cvt_pk_bf16_f32 v110, v11, v9
    v_cvt_pk_bf16_f32 v111, v7, v5
    ds_write_b64 v231, v[110:111] offset:64
    v_cvt_pk_bf16_f32 v112, v18, v16
    v_cvt_pk_bf16_f32 v113, v14, v12
    ds_write_b64 v231, v[112:113] offset:128
    v_cvt_pk_bf16_f32 v114, v19, v17
    v_cvt_pk_bf16_f32 v115, v15, v13
    ds_write_b64 v231, v[114:115] offset:192
    v_cvt_pk_bf16_f32 v116, v26, v24
    v_cvt_pk_bf16_f32 v117, v22, v20
    ds_write_b64 v231, v[116:117] offset:256
    v_cvt_pk_bf16_f32 v118, v27, v25
    v_cvt_pk_bf16_f32 v119, v23, v21
    ds_write_b64 v231, v[118:119] offset:320
    v_cvt_pk_bf16_f32 v120, v34, v32
    v_cvt_pk_bf16_f32 v121, v30, v28
    ds_write_b64 v231, v[120:121] offset:384
    v_cvt_pk_bf16_f32 v122, v35, v33
    v_cvt_pk_bf16_f32 v123, v31, v29
    ds_write_b64 v231, v[122:123] offset:448
    ds_read_b128 v[152:155], v232 offset:0
    ds_read_b128 v[156:159], v232 offset:1056
    ds_read_b128 v[160:163], v232 offset:2112
    ds_read_b128 v[164:167], v232 offset:3168
    v_mov_b64 v[4:5], 0
    v_mov_b64 v[6:7], 0
    v_mov_b64 v[8:9], 0
    v_mov_b64 v[10:11], 0
    v_mov_b64 v[12:13], 0
    v_mov_b64 v[14:15], 0
    v_mov_b64 v[16:17], 0
    v_mov_b64 v[18:19], 0
    v_mov_b64 v[20:21], 0
    v_mov_b64 v[22:23], 0
    v_mov_b64 v[24:25], 0
    v_mov_b64 v[26:27], 0
    v_mov_b64 v[28:29], 0
    v_mov_b64 v[30:31], 0
    v_mov_b64 v[32:33], 0
    v_mov_b64 v[34:35], 0
    s_mov_b32 s87, 0
    s_waitcnt lgkmcnt(3)
    buffer_store_dwordx4 v[152:155], v233, s[80:83], s87 offen sc1
    s_mov_b32 s87, 67584
    s_waitcnt lgkmcnt(2)
    buffer_store_dwordx4 v[156:159], v233, s[80:83], s87 offen sc1
    s_mov_b32 s87, 135168
    s_waitcnt lgkmcnt(1)
    buffer_store_dwordx4 v[160:163], v233, s[80:83], s87 offen sc1
    s_mov_b32 s87, 202752
    s_waitcnt lgkmcnt(0)
    buffer_store_dwordx4 v[164:167], v233, s[80:83], s87 offen sc1
    s_cmp_lg_u32 s7, 0
    s_cbranch_scc1 L_noinit2
    s_mov_b32 s64, s28
    s_mov_b32 s65, s29
    s_mov_b32 s66, 0x100
    s_mov_b32 s67, 0x20000
    v_mov_b32 v2, 1
    s_mov_b64 exec, 1
    buffer_store_dword v2, off, s[64:67], 0 sc1
    s_mov_b64 exec, -1
L_noinit2:
    s_mov_b32 s37, 41984
    s_mov_b32 s36, 15
    s_barrier
    ds_read_b128 v[108:111], v196 offset:0
    ds_read_b64_tr_b16 v[128:129], v200 offset:0
    ds_read_b64_tr_b16 v[130:131], v200 offset:512
    ds_read_b128 v[112:115], v196 offset:2048
    ds_read_b64_tr_b16 v[132:133], v201 offset:0
    ds_read_b64_tr_b16 v[134:135], v201 offset:512
    ds_read_b128 v[116:119], v196 offset:4096
    ds_read_b64_tr_b16 v[136:137], v200 offset:8192
    ds_read_b64_tr_b16 v[138:139], v200 offset:8704
    ds_read_b128 v[120:123], v196 offset:6144
    ds_read_b64_tr_b16 v[140:141], v201 offset:8192
    ds_read_b64_tr_b16 v[142:143], v201 offset:8704
    ds_read_b128 v[124:127], v198
    ds_read_b64_tr_b16 v[144:145], v200 offset:16384
    ds_read_b64_tr_b16 v[146:147], v200 offset:16896
    ds_read_b64_tr_b16 v[148:149], v201 offset:16384
    ds_read_b64_tr_b16 v[150:151], v201 offset:16896
    s_waitcnt lgkmcnt(0)
L_g1_loop:
    v_mfma_f32_16x16x32_bf16 v[4:7], v[128:131], v[108:111], v[4:7]
    ds_read_b128 v[152:155], v197 offset:0
    v_mfma_f32_16x16x32_bf16 v[12:15], v[128:131], v[112:115], v[12:15]
    ds_read_b64_tr_b16 v[172:173], v200 offset:4096
    v_mfma_f32_16x16x32_bf16 v[20:23], v[128:131], v[116:119], v[20:23]
    ds_read_b64_tr_b16 v[174:175], v200 offset:4608
    v_mfma_f32_16x16x32_bf16 v[28:31], v[128:131], v[120:123], v[28:31]
    ds_read_b128 v[156:159], v197 offset:2048
    v_mfma_f32_16x16x32_bf16 v[8:11], v[132:135], v[108:111], v[8:11]
    ds_read_b64_tr_b16 v[176:177], v201 offset:4096
    v_mfma_f32_16x16x32_bf16 v[16:19], v[132:135], v[112:115], v[16:19]
    ds_read_b64_tr_b16 v[178:179], v201 offset:4608
    v_mfma_f32_16x16x32_bf16 v[24:27], v[132:135], v[116:119], v[24:27]
    ds_read_b128 v[160:163], v197 offset:4096
    v_mfma_f32_16x16x32_bf16 v[32:35], v[132:135], v[120:123], v[32:35]
    ds_read_b64_tr_b16 v[180:181], v200 offset:12288
    v_mfma_f32_16x16x32_bf16 v[36:39], v[136:139], v[108:111], v[36:39]
    ds_read_b64_tr_b16 v[182:183], v200 offset:12800
    v_mfma_f32_16x16x32_bf16 v[44:47], v[136:139], v[112:115], v[44:47]
    ds_read_b128 v[164:167], v197 offset:6144
    v_mfma_f32_16x16x32_bf16 v[52:55], v[136:139], v[116:119], v[52:55]
    ds_read_b64_tr_b16 v[184:185], v201 offset:12288
    v_mfma_f32_16x16x32_bf16 v[60:63], v[136:139], v[120:123], v[60:63]
    ds_read_b64_tr_b16 v[186:187], v201 offset:12800
    v_mfma_f32_16x16x32_bf16 v[100:103], v[136:139], v[124:127], v[100:103]
    ds_read_b128 v[168:171], v199
    v_mfma_f32_16x16x32_bf16 v[40:43], v[140:143], v[108:111], v[40:43]
    ds_read_b64_tr_b16 v[188:189], v200 offset:20480
    v_mfma_f32_16x16x32_bf16 v[48:51], v[140:143], v[112:115], v[48:51]
    ds_read_b64_tr_b16 v[190:191], v200 offset:20992
    v_mfma_f32_16x16x32_bf16 v[56:59], v[140:143], v[116:119], v[56:59]
    ds_read_b64_tr_b16 v[192:193], v201 offset:20480
    v_mfma_f32_16x16x32_bf16 v[64:67], v[140:143], v[120:123], v[64:67]
    ds_read_b64_tr_b16 v[194:195], v201 offset:20992
    v_mfma_f32_16x16x32_bf16 v[68:71], v[108:111], v[144:147], v[68:71]
    ds_read_b32 v1, v228 offset:24
    v_mfma_f32_16x16x32_bf16 v[76:79], v[112:115], v[144:147], v[76:79]
    s_add_u32 s34, s34, 41984
    v_mfma_f32_16x16x32_bf16 v[84:87], v[116:119], v[144:147], v[84:87]
    s_cmp_eq_u32 s34, 125952
    v_mfma_f32_16x16x32_bf16 v[92:95], v[120:123], v[144:147], v[92:95]
    s_cselect_b32 s35, -83968, s37
    v_mfma_f32_16x16x32_bf16 v[104:107], v[124:127], v[144:147], v[104:107]
    s_cselect_b32 s34, 0, s34
    v_mfma_f32_16x16x32_bf16 v[72:75], v[108:111], v[148:151], v[72:75]
    s_bitcmp1_b32 0x1002, s36
    s_waitcnt lgkmcnt(0)
    v_mfma_f32_16x16x32_bf16 v[80:83], v[112:115], v[148:151], v[80:83]
    v_add_u32 v196, s35, v196
    v_add_u32 v197, s35, v197
    v_mfma_f32_16x16x32_bf16 v[88:91], v[116:119], v[148:151], v[88:91]
    v_add_u32 v198, s35, v198
    v_add_u32 v199, s35, v199
    v_mfma_f32_16x16x32_bf16 v[96:99], v[120:123], v[148:151], v[96:99]
    v_add_u32 v200, s35, v200
    v_add_u32 v201, s35, v201
    s_cbranch_scc1 L_g1_rare
L_g1_bar:
    s_barrier
L_g1_nobar:
    v_mfma_f32_16x16x32_bf16 v[4:7], v[172:175], v[152:155], v[4:7]
    ds_read_b128 v[108:111], v196 offset:0
    v_mfma_f32_16x16x32_bf16 v[12:15], v[172:175], v[156:159], v[12:15]
    ds_read_b64_tr_b16 v[128:129], v200 offset:0
    v_mfma_f32_16x16x32_bf16 v[20:23], v[172:175], v[160:163], v[20:23]
    ds_read_b64_tr_b16 v[130:131], v200 offset:512
    v_mfma_f32_16x16x32_bf16 v[28:31], v[172:175], v[164:167], v[28:31]
    ds_read_b128 v[112:115], v196 offset:2048
    v_mfma_f32_16x16x32_bf16 v[8:11], v[176:179], v[152:155], v[8:11]
    ds_read_b64_tr_b16 v[132:133], v201 offset:0
    v_mfma_f32_16x16x32_bf16 v[16:19], v[176:179], v[156:159], v[16:19]
    ds_read_b64_tr_b16 v[134:135], v201 offset:512
    v_mfma_f32_16x16x32_bf16 v[24:27], v[176:179], v[160:163], v[24:27]
    ds_read_b128 v[116:119], v196 offset:4096
    v_mfma_f32_16x16x32_bf16 v[32:35], v[176:179], v[164:167], v[32:35]
    ds_read_b64_tr_b16 v[136:137], v200 offset:8192
    v_mfma_f32_16x16x32_bf16 v[36:39], v[180:183], v[152:155], v[36:39]
    ds_read_b64_tr_b16 v[138:139], v200 offset:8704
    v_mfma_f32_16x16x32_bf16 v[44:47], v[180:183], v[156:159], v[44:47]
    ds_read_b128 v[120:123], v196 offset:6144
    v_mfma_f32_16x16x32_bf16 v[52:55], v[180:183], v[160:163], v[52:55]
    ds_read_b64_tr_b16 v[140:141], v201 offset:8192
    v_mfma_f32_16x16x32_bf16 v[60:63], v[180:183], v[164:167], v[60:63]
    ds_read_b64_tr_b16 v[142:143], v201 offset:8704
    v_mfma_f32_16x16x32_bf16 v[100:103], v[180:183], v[168:171], v[100:103]
    ds_read_b128 v[124:127], v198
    v_mfma_f32_16x16x32_bf16 v[40:43], v[184:187], v[152:155], v[40:43]
    ds_read_b64_tr_b16 v[144:145], v200 offset:16384
    v_mfma_f32_16x16x32_bf16 v[48:51], v[184:187], v[156:159], v[48:51]
    ds_read_b64_tr_b16 v[146:147], v200 offset:16896
    v_mfma_f32_16x16x32_bf16 v[56:59], v[184:187], v[160:163], v[56:59]
    ds_read_b64_tr_b16 v[148:149], v201 offset:16384
    v_mfma_f32_16x16x32_bf16 v[64:67], v[184:187], v[164:167], v[64:67]
    ds_read_b64_tr_b16 v[150:151], v201 offset:16896
    v_mfma_f32_16x16x32_bf16 v[68:71], v[152:155], v[188:191], v[68:71]
    s_sub_u32 s36, s36, 1
    v_mfma_f32_16x16x32_bf16 v[76:79], v[156:159], v[188:191], v[76:79]
    s_cmp_lg_u32 s36, 0
    v_mfma_f32_16x16x32_bf16 v[84:87], v[160:163], v[188:191], v[84:87]
    v_mfma_f32_16x16x32_bf16 v[92:95], v[164:167], v[188:191], v[92:95]
    v_mfma_f32_16x16x32_bf16 v[104:107], v[168:171], v[188:191], v[104:107]
    v_mfma_f32_16x16x32_bf16 v[72:75], v[152:155], v[192:195], v[72:75]
    v_mfma_f32_16x16x32_bf16 v[80:83], v[156:159], v[192:195], v[80:83]
    v_mfma_f32_16x16x32_bf16 v[88:91], v[160:163], v[192:195], v[88:91]
    v_mfma_f32_16x16x32_bf16 v[96:99], v[164:167], v[192:195], v[96:99]
    s_waitcnt lgkmcnt(0)
    s_cbranch_scc1 L_g1_loop
    v_mfma_f32_16x16x32_bf16 v[4:7], v[128:131], v[108:111], v[4:7]
    ds_read_b128 v[152:155], v197 offset:0
    v_mfma_f32_16x16x32_bf16 v[12:15], v[128:131], v[112:115], v[12:15]
    ds_read_b64_tr_b16 v[172:173], v200 offset:4096
    v_mfma_f32_16x16x32_bf16 v[20:23], v[128:131], v[116:119], v[20:23]
    ds_read_b64_tr_b16 v[174:175], v200 offset:4608
    v_mfma_f32_16x16x32_bf16 v[28:31], v[128:131], v[120:123], v[28:31]
    ds_read_b128 v[156:159], v197 offset:2048
    v_mfma_f32_16x16x32_bf16 v[8:11], v[132:135], v[108:111], v[8:11]
    ds_read_b64_tr_b16 v[176:177], v201 offset:4096
    v_mfma_f32_16x16x32_bf16 v[16:19], v[132:135], v[112:115], v[16:19]
    ds_read_b64_tr_b16 v[178:179], v201 offset:4608
    v_mfma_f32_16x16x32_bf16 v[24:27], v[132:135], v[116:119], v[24:27]
    ds_read_b128 v[160:163], v197 offset:4096
    v_mfma_f32_16x16x32_bf16 v[32:35], v[132:135], v[120:123], v[32:35]
    ds_read_b64_tr_b16 v[180:181], v200 offset:12288
    v_mfma_f32_16x16x32_bf16 v[36:39], v[136:139], v[108:111], v[36:39]
    ds_read_b64_tr_b16 v[182:183], v200 offset:12800
    v_mfma_f32_16x16x32_bf16 v[44:47], v[136:139], v[112:115], v[44:47]
    ds_read_b128 v[164:167], v197 offset:6144
    v_mfma_f32_16x16x32_bf16 v[52:55], v[136:139], v[116:119], v[52:55]
    ds_read_b64_tr_b16 v[184:185], v201 offset:12288
    v_mfma_f32_16x16x32_bf16 v[60:63], v[136:139], v[120:123], v[60:63]
    ds_read_b64_tr_b16 v[186:187], v201 offset:12800
    v_mfma_f32_16x16x32_bf16 v[100:103], v[136:139], v[124:127], v[100:103]
    ds_read_b128 v[168:171], v199
    v_mfma_f32_16x16x32_bf16 v[40:43], v[140:143], v[108:111], v[40:43]
    ds_read_b64_tr_b16 v[188:189], v200 offset:20480
    v_mfma_f32_16x16x32_bf16 v[48:51], v[140:143], v[112:115], v[48:51]
    ds_read_b64_tr_b16 v[190:191], v200 offset:20992
    v_mfma_f32_16x16x32_bf16 v[56:59], v[140:143], v[116:119], v[56:59]
    ds_read_b64_tr_b16 v[192:193], v201 offset:20480
    v_mfma_f32_16x16x32_bf16 v[64:67], v[140:143], v[120:123], v[64:67]
    ds_read_b64_tr_b16 v[194:195], v201 offset:20992
    v_mfma_f32_16x16x32_bf16 v[68:71], v[108:111], v[144:147], v[68:71]
    v_mfma_f32_16x16x32_bf16 v[76:79], v[112:115], v[144:147], v[76:79]
    v_mfma_f32_16x16x32_bf16 v[84:87], v[116:119], v[144:147], v[84:87]
    v_mfma_f32_16x16x32_bf16 v[92:95], v[120:123], v[144:147], v[92:95]
    v_mfma_f32_16x16x32_bf16 v[104:107], v[124:127], v[144:147], v[104:107]
    v_mfma_f32_16x16x32_bf16 v[72:75], v[108:111], v[148:151], v[72:75]
    v_mfma_f32_16x16x32_bf16 v[80:83], v[112:115], v[148:151], v[80:83]
    v_mfma_f32_16x16x32_bf16 v[88:91], v[116:119], v[148:151], v[88:91]
    v_mfma_f32_16x16x32_bf16 v[96:99], v[120:123], v[148:151], v[96:99]
    s_waitcnt lgkmcnt(0)
    s_setprio 2
    v_mov_b32 v2, 1
    v_mfma_f32_16x16x32_bf16 v[100:103], v[180:183], v[168:171], v[100:103]
    v_mfma_f32_16x16x32_bf16 v[104:107], v[168:171], v[188:191], v[104:107]
    v_mfma_f32_16x16x32_bf16 v[60:63], v[180:183], v[164:167], v[60:63]
    v_mfma_f32_16x16x32_bf16 v[64:67], v[184:187], v[164:167], v[64:67]
    v_mfma_f32_16x16x32_bf16 v[92:95], v[164:167], v[188:191], v[92:95]
    v_mfma_f32_16x16x32_bf16 v[96:99], v[164:167], v[192:195], v[96:99]
    v_mfma_f32_16x16x32_bf16 v[28:31], v[172:175], v[164:167], v[28:31]
    v_mfma_f32_16x16x32_bf16 v[32:35], v[176:179], v[164:167], v[32:35]
    v_mfma_f32_16x16x32_bf16 v[52:55], v[180:183], v[160:163], v[52:55]
    v_cvt_pk_bf16_f32 v144, v100, v101
    v_cvt_pk_bf16_f32 v145, v102, v103
    v_mfma_f32_16x16x32_bf16 v[56:59], v[184:187], v[160:163], v[56:59]
    ds_write_b64 v219, v[144:145]
    v_cvt_pk_bf16_f32 v146, v104, v105
    v_mfma_f32_16x16x32_bf16 v[20:23], v[172:175], v[160:163], v[20:23]
    v_cvt_pk_bf16_f32 v147, v106, v107
    ds_write_b64 v219, v[146:147] offset:1024
    v_mfma_f32_16x16x32_bf16 v[24:27], v[176:179], v[160:163], v[24:27]
    v_cvt_pk_bf16_f32 v140, v60, v61
    v_cvt_pk_bf16_f32 v141, v62, v63
    v_mfma_f32_16x16x32_bf16 v[44:47], v[180:183], v[156:159], v[44:47]
    v_cvt_pk_bf16_f32 v142, v64, v65
    v_cvt_pk_bf16_f32 v143, v66, v67
    v_mfma_f32_16x16x32_bf16 v[48:51], v[184:187], v[156:159], v[48:51]
    v_cvt_pk_bf16_f32 v238, v92, v93
    v_cvt_pk_bf16_f32 v239, v94, v95
    v_mfma_f32_16x16x32_bf16 v[12:15], v[172:175], v[156:159], v[12:15]
    v_cvt_pk_bf16_f32 v248, v96, v97
    v_cvt_pk_bf16_f32 v249, v98, v99
    v_mfma_f32_16x16x32_bf16 v[16:19], v[176:179], v[156:159], v[16:19]
    s_cmp_eq_u32 s33, 0
    s_cbranch_scc0 L_at_nopub
    ds_write_b64 v220, v[140:141] offset:2048
    ds_write_b64 v220, v[238:239] offset:3072
    ds_write_b64 v220, v[142:143] offset:2560
    ds_write_b64 v220, v[248:249] offset:3584
L_at_nopub:
    s_mov_b64 exec, 1
    ds_add_u32 v228, v2 offset:20
    s_mov_b64 exec, -1
    v_cvt_pk_bf16_f32 v120, v28, v29
    v_mfma_f32_16x16x32_bf16 v[36:39], v[180:183], v[152:155], v[36:39]
    v_cvt_pk_bf16_f32 v121, v30, v31
    v_cvt_pk_bf16_f32 v122, v32, v33
    v_mfma_f32_16x16x32_bf16 v[40:43], v[184:187], v[152:155], v[40:43]
    v_cvt_pk_bf16_f32 v123, v34, v35
    v_cvt_pk_bf16_f32 v136, v52, v53
    v_mfma_f32_16x16x32_bf16 v[4:7], v[172:175], v[152:155], v[4:7]
    v_cvt_pk_bf16_f32 v137, v54, v55
    v_cvt_pk_bf16_f32 v138, v56, v57
    v_mfma_f32_16x16x32_bf16 v[8:11], v[176:179], v[152:155], v[8:11]
    v_cvt_pk_bf16_f32 v139, v58, v59
    v_cvt_pk_bf16_f32 v116, v20, v21
    v_mfma_f32_16x16x32_bf16 v[84:87], v[160:163], v[188:191], v[84:87]
    v_cvt_pk_bf16_f32 v117, v22, v23
    v_cvt_pk_bf16_f32 v118, v24, v25
    v_mfma_f32_16x16x32_bf16 v[88:91], v[160:163], v[192:195], v[88:91]
    v_cvt_pk_bf16_f32 v119, v26, v27
    v_cvt_pk_bf16_f32 v132, v44, v45
    v_mfma_f32_16x16x32_bf16 v[76:79], v[156:159], v[188:191], v[76:79]
    v_cvt_pk_bf16_f32 v133, v46, v47
    v_cvt_pk_bf16_f32 v134, v48, v49
    v_mfma_f32_16x16x32_bf16 v[80:83], v[156:159], v[192:195], v[80:83]
    v_cvt_pk_bf16_f32 v135, v50, v51
    v_cvt_pk_bf16_f32 v112, v12, v13
    v_mfma_f32_16x16x32_bf16 v[68:71], v[152:155], v[188:191], v[68:71]
    v_cvt_pk_bf16_f32 v113, v14, v15
    v_cvt_pk_bf16_f32 v114, v16, v17
    v_mfma_f32_16x16x32_bf16 v[72:75], v[152:155], v[192:195], v[72:75]
    v_cvt_pk_bf16_f32 v115, v18, v19
    v_cvt_pk_bf16_f32 v128, v36, v37
    v_mfma_f32_16x16x32_bf16 v[28:31], v[140:143], v[120:123], v[204:207]
    v_cvt_pk_bf16_f32 v129, v38, v39
    v_cvt_pk_bf16_f32 v130, v40, v41
    v_mfma_f32_16x16x32_bf16 v[32:35], v[136:139], v[120:123], v[208:211]
    v_cvt_pk_bf16_f32 v131, v42, v43
    v_cvt_pk_bf16_f32 v108, v4, v5
    v_mfma_f32_16x16x32_bf16 v[20:23], v[136:139], v[116:119], v[204:207]
    v_cvt_pk_bf16_f32 v109, v6, v7
    v_cvt_pk_bf16_f32 v110, v8, v9
    v_mfma_f32_16x16x32_bf16 v[24:27], v[132:135], v[116:119], v[208:211]
    v_cvt_pk_bf16_f32 v111, v10, v11
    v_cvt_pk_bf16_f32 v236, v84, v85
    v_mfma_f32_16x16x32_bf16 v[12:15], v[132:135], v[112:115], v[204:207]
    v_cvt_pk_bf16_f32 v237, v86, v87
    v_cvt_pk_bf16_f32 v246, v88, v89
    v_mfma_f32_16x16x32_bf16 v[16:19], v[128:131], v[112:115], v[208:211]
    v_cvt_pk_bf16_f32 v247, v90, v91
    v_cvt_pk_bf16_f32 v234, v76, v77
    v_mfma_f32_16x16x32_bf16 v[4:7], v[128:131], v[108:111], v[204:207]
    v_cvt_pk_bf16_f32 v235, v78, v79
    ds_read_b32 v1, v228 offset:20
    v_cvt_pk_bf16_f32 v244, v80, v81
    v_cvt_pk_bf16_f32 v245, v82, v83
    v_cvt_pk_bf16_f32 v232, v68, v69
    v_cvt_pk_bf16_f32 v233, v70, v71
    v_cvt_pk_bf16_f32 v242, v72, v73
    v_cvt_pk_bf16_f32 v243, v74, v75
    s_waitcnt lgkmcnt(0)
    v_readfirstlane_b32 s37, v1
    s_nop 0
    s_cmp_ge_u32 s37, 4
    s_cbranch_scc1 L_sl_done_37
    s_mov_b32 s38, 1048576
L_sl_loop_38:
    ds_read_b32 v1, v228 offset:20
    s_waitcnt lgkmcnt(0)
    v_readfirstlane_b32 s37, v1
    s_nop 0
    s_cmp_ge_u32 s37, 4
    s_cbranch_scc1 L_sl_done_37
    s_sleep 1
    s_sub_u32 s38, s38, 1
    s_cbranch_scc0 L_sl_loop_38
L_sl_done_37:
    ds_read_b64 v[124:125], v221
    ds_read_b64 v[126:127], v222
    ds_read_b64 v[230:231], v221 offset:1024
    ds_read_b64 v[240:241], v222 offset:1024
    v_max_f32 v28, v28, v32
    v_max_f32 v29, v29, v33
    v_max_f32 v30, v30, v34
    v_max_f32 v31, v31, v35
    v_max3_f32 v39, v28, v29, v30
    v_max_f32 v39, v39, v31
    v_max_f32 v20, v20, v24
    v_max_f32 v21, v21, v25
    v_max_f32 v22, v22, v26
    v_max_f32 v23, v23, v27
    v_max3_f32 v38, v20, v21, v22
    v_max_f32 v38, v38, v23
    s_waitcnt lgkmcnt(2)
    v_mfma_f32_16x16x32_bf16 v[8:11], v[124:127], v[108:111], v[212:215]
    s_mov_b32 s37, 0x3e8293ee
    v_max_f32 v12, v12, v16
    v_max_f32 v13, v13, v17
    v_max_f32 v14, v14, v18
    v_max_f32 v15, v15, v19
    v_max3_f32 v37, v12, v13, v14
    v_max_f32 v37, v37, v15
    s_nop 0
    v_max_f32 v4, v4, v8
    v_max_f32 v5, v5, v9
    v_max_f32 v6, v6, v10
    v_max_f32 v7, v7, v11
    v_max3_f32 v36, v4, v5, v6
    v_max_f32 v36, v36, v7
    v_permlane32_swap_b32 v38, v39
    s_nop 0
    v_permlane32_swap_b32 v36, v37
    v_max_f32 v38, v38, v39
    v_max_f32 v36, v36, v37
    s_nop 1
    v_permlane16_swap_b32 v36, v38
    v_max_f32 v36, v36, v38
    v_mul_f32 v38, s37, v36
    v_mul_f32 v36, s37, v36
    s_nop 1
    v_permlane16_swap_b32 v36, v38
    v_mov_b32 v37, v36
    v_mov_b32 v39, v38
    s_nop 0
    v_permlane32_swap_b32 v36, v37
    v_permlane32_swap_b32 v38, v39
    v_fma_f32 v4, v4, s37, -v36
    v_fma_f32 v5, v5, s37, -v36
    v_fma_f32 v6, v6, s37, -v36
    v_fma_f32 v7, v7, s37, -v36
    v_fma_f32 v12, v12, s37, -v37
    v_fma_f32 v13, v13, s37, -v37
    v_fma_f32 v14, v14, s37, -v37
    v_fma_f32 v15, v15, s37, -v37
    v_fma_f32 v20, v20, s37, -v38
    v_fma_f32 v21, v21, s37, -v38
    v_fma_f32 v22, v22, s37, -v38
    v_fma_f32 v23, v23, s37, -v38
    v_fma_f32 v28, v28, s37, -v39
    v_fma_f32 v29, v29, s37, -v39
    v_fma_f32 v30, v30, s37, -v39
    v_fma_f32 v31, v31, s37, -v39
    v_exp_f32 v28, v28
    v_exp_f32 v29, v29
    v_exp_f32 v30, v30
    v_exp_f32 v31, v31
    v_exp_f32 v20, v20
    v_exp_f32 v21, v21
    v_exp_f32 v22, v22
    v_exp_f32 v23, v23
    v_exp_f32 v12, v12
    v_exp_f32 v13, v13
    v_exp_f32 v14, v14
    v_exp_f32 v15, v15
    v_exp_f32 v4, v4
    v_exp_f32 v5, v5
    v_exp_f32 v6, v6
    v_exp_f32 v7, v7
    v_add_f32 v39, v28, v29
    v_add_f32 v32, v30, v31
    v_add_f32 v39, v39, v32
    v_add_f32 v38, v20, v21
    v_add_f32 v24, v22, v23
    v_add_f32 v38, v38, v24
    v_add_f32 v37, v12, v13
    v_add_f32 v16, v14, v15
    v_add_f32 v37, v37, v16
    v_add_f32 v36, v4, v5
    v_add_f32 v8, v6, v7
    v_add_f32 v36, v36, v8
    v_permlane32_swap_b32 v38, v39
    s_nop 0
    v_permlane32_swap_b32 v36, v37
    v_add_f32 v38, v38, v39
    v_add_f32 v36, v36, v37
    s_nop 1
    v_permlane16_swap_b32 v36, v38
    v_add_f32 v36, v36, v38
    v_rcp_f32 v38, v36
    v_rcp_f32 v36, v36
    s_nop 1
    v_permlane16_swap_b32 v36, v38
    v_mov_b32 v37, v36
    v_mov_b32 v39, v38
    s_nop 0
    v_permlane32_swap_b32 v36, v37
    v_permlane32_swap_b32 v38, v39
    s_waitcnt lgkmcnt(0)
    s_cmp_eq_u32 s33, 0
    v_mul_f32 v4, v4, v36
    v_mul_f32 v5, v5, v36
    v_mul_f32 v6, v6, v36
    v_mul_f32 v7, v7, v36
    v_cvt_pk_bf16_f32 v10, v4, v5
    v_cvt_pk_bf16_f32 v11, v6, v7
    v_and_b32 v8, v216, v10
    v_and_b32 v9, v217, v11
    v_xor_b32 v10, v8, v10
    v_xor_b32 v11, v9, v11
    s_nop 1
    v_mfma_f32_16x16x32_bf16 v[68:71], v[230:233], v[8:11], 0
    v_mfma_f32_16x16x32_bf16 v[72:75], v[240:243], v[8:11], 0
    v_mul_f32 v12, v12, v37
    v_mul_f32 v13, v13, v37
    v_mul_f32 v14, v14, v37
    v_mul_f32 v15, v15, v37
    v_cvt_pk_bf16_f32 v18, v12, v13
    v_cvt_pk_bf16_f32 v19, v14, v15
    v_and_b32 v16, v216, v18
    v_and_b32 v17, v217, v19
    v_xor_b32 v18, v16, v18
    v_xor_b32 v19, v17, v19
    v_cvt_pk_bf16_f32 v108, v68, v69
    v_cvt_pk_bf16_f32 v109, v70, v71
    v_cvt_pk_bf16_f32 v110, v72, v73
    v_cvt_pk_bf16_f32 v111, v74, v75
    s_cbranch_scc1 L_at_noswap0
    v_swap_b32 v108, v110
    v_swap_b32 v109, v111
L_at_noswap0:
    s_mov_b32 s37, 0
    buffer_store_dwordx4 v[108:111], v218, s[40:43], s37 offen sc1
    v_mfma_f32_16x16x32_bf16 v[76:79], v[232:235], v[16:19], 0
    v_mfma_f32_16x16x32_bf16 v[80:83], v[242:245], v[16:19], 0
    v_mul_f32 v20, v20, v38
    v_mul_f32 v21, v21, v38
    v_mul_f32 v22, v22, v38
    v_mul_f32 v23, v23, v38
    v_cvt_pk_bf16_f32 v26, v20, v21
    v_cvt_pk_bf16_f32 v27, v22, v23
    v_and_b32 v24, v216, v26
    v_and_b32 v25, v217, v27
    v_xor_b32 v26, v24, v26
    v_xor_b32 v27, v25, v27
    v_cvt_pk_bf16_f32 v112, v76, v77
    v_cvt_pk_bf16_f32 v113, v78, v79
    v_cvt_pk_bf16_f32 v114, v80, v81
    v_cvt_pk_bf16_f32 v115, v82, v83
    s_cbranch_scc1 L_at_noswap1
    v_swap_b32 v112, v114
    v_swap_b32 v113, v115
L_at_noswap1:
    s_mov_b32 s37, 32768
    buffer_store_dwordx4 v[112:115], v218, s[40:43], s37 offen sc1
    v_mfma_f32_16x16x32_bf16 v[84:87], v[234:237], v[24:27], 0
    v_mfma_f32_16x16x32_bf16 v[88:91], v[244:247], v[24:27], 0
    v_mul_f32 v28, v28, v39
    v_mul_f32 v29, v29, v39
    v_mul_f32 v30, v30, v39
    v_mul_f32 v31, v31, v39
    v_cvt_pk_bf16_f32 v34, v28, v29
    v_cvt_pk_bf16_f32 v35, v30, v31
    v_and_b32 v32, v216, v34
    v_and_b32 v33, v217, v35
    v_xor_b32 v34, v32, v34
    v_xor_b32 v35, v33, v35
    v_cvt_pk_bf16_f32 v116, v84, v85
    v_cvt_pk_bf16_f32 v117, v86, v87
    v_cvt_pk_bf16_f32 v118, v88, v89
    v_cvt_pk_bf16_f32 v119, v90, v91
    s_cbranch_scc1 L_at_noswap2
    v_swap_b32 v116, v118
    v_swap_b32 v117, v119
L_at_noswap2:
    s_mov_b32 s37, 65536
    buffer_store_dwordx4 v[116:119], v218, s[40:43], s37 offen sc1
    v_mfma_f32_16x16x32_bf16 v[92:95], v[236:239], v[32:35], 0
    v_mfma_f32_16x16x32_bf16 v[96:99], v[246:249], v[32:35], 0
    s_nop 6
    v_cvt_pk_bf16_f32 v120, v92, v93
    v_cvt_pk_bf16_f32 v121, v94, v95
    v_cvt_pk_bf16_f32 v122, v96, v97
    v_cvt_pk_bf16_f32 v123, v98, v99
    s_cbranch_scc1 L_at_noswap3
    v_swap_b32 v120, v122
    v_swap_b32 v121, v123
L_at_noswap3:
    s_mov_b32 s37, 98304
    buffer_store_dwordx4 v[120:123], v218, s[40:43], s37 offen sc1
    s_add_u32 m0, s60, 0
    s_add_u32 s63, s62, 0
    s_and_b32 s63, s63, 0x1fffff
    buffer_load_dwordx4 v227, s[44:47], s63 offen lds
    s_add_u32 m0, s60, 1024
    s_add_u32 s63, s62, 16384
    s_and_b32 s63, s63, 0x1fffff
    buffer_load_dwordx4 v227, s[44:47], s63 offen lds
    s_add_u32 m0, s60, 8192
    s_add_u32 s63, s62, 131072
    s_and_b32 s63, s63, 0x1fffff
    buffer_load_dwordx4 v227, s[44:47], s63 offen lds
    s_add_u32 m0, s60, 9216
    s_add_u32 s63, s62, 147456
    s_and_b32 s63, s63, 0x1fffff
    buffer_load_dwordx4 v227, s[44:47], s63 offen lds
    s_add_u32 m0, s60, 16384
    s_add_u32 s63, s62, 262144
    s_and_b32 s63, s63, 0x1fffff
    buffer_load_dwordx4 v227, s[44:47], s63 offen lds
    s_add_u32 m0, s60, 17408
    s_add_u32 s63, s62, 278528
    s_and_b32 s63, s63, 0x1fffff
    buffer_load_dwordx4 v227, s[44:47], s63 offen lds
    v_xor_b32 v68, 0, v229
    v_xor_b32 v69, 32, v229
    v_xor_b32 v70, 64, v229
    v_xor_b32 v71, 96, v229
    v_add_u32 v72, 83968, v68
    v_add_u32 v73, 83968, v69
    v_add_u32 v74, 83968, v70
    v_add_u32 v75, 83968, v71
    v_add_u32 v76, 125952, v68
    v_add_u32 v77, 125952, v69
    v_add_u32 v78, 125952, v70
    v_add_u32 v79, 125952, v71
    s_add_u32 s64, s61, 0
    s_and_b32 s64, s64, 7
    s_lshl_b32 s64, s64, 12
    s_add_u32 s65, s61, 1
    s_and_b32 s65, s65, 7
    s_lshl_b32 s65, s65, 12
    s_add_u32 s66, s61, 2
    s_and_b32 s66, s66, 7
    s_lshl_b32 s66, s66, 12
    s_add_u32 s67, s61, 3
    s_and_b32 s67, s67, 7
    s_lshl_b32 s67, s67, 12
    s_add_u32 s68, s61, 4
    s_and_b32 s68, s68, 7
    s_lshl_b32 s68, s68, 12
    s_add_u32 s69, s61, 5
    s_and_b32 s69, s69, 7
    s_lshl_b32 s69, s69, 12
    s_add_u32 s70, s61, 6
    s_and_b32 s70, s70, 7
    s_lshl_b32 s70, s70, 12
    s_add_u32 s71, s61, 7
    s_and_b32 s71, s71, 7
    s_lshl_b32 s71, s71, 12
    s_waitcnt vmcnt(6)
    v_mov_b32 v2, 1
    s_mov_b64 exec, 1
    ds_add_rtn_u32 v1, v228, v2 offset:0
    s_waitcnt lgkmcnt(0)
    v_readfirstlane_b32 s39, v1
    s_nop 0
    s_cmp_eq_u32 s39, 3
    s_cbranch_scc0 L_jo_39a
    buffer_atomic_add v2, off, s[52:55], s56 sc1
L_jo_39a:
    s_mov_b64 exec, -1
    s_add_u32 m0, s60, 24576
    s_add_u32 s63, s62, 393216
    s_and_b32 s63, s63, 0x1fffff
    buffer_load_dwordx4 v227, s[44:47], s63 offen lds
    s_add_u32 m0, s60, 25600
    s_add_u32 s63, s62, 409600
    s_and_b32 s63, s63, 0x1fffff
    buffer_load_dwordx4 v227, s[44:47], s63 offen lds
    s_add_u32 m0, s60, 32768
    s_add_u32 s63, s62, 524288
    s_and_b32 s63, s63, 0x1fffff
    buffer_load_dwordx4 v227, s[44:47], s63 offen lds
    s_add_u32 m0, s60, 33792
    s_add_u32 s63, s62, 540672
    s_and_b32 s63, s63, 0x1fffff
    buffer_load_dwordx4 v227, s[44:47], s63 offen lds
    s_add_u32 m0, s60, 83968
    s_add_u32 s63, s62, 655360
    s_and_b32 s63, s63, 0x1fffff
    buffer_load_dwordx4 v227, s[44:47], s63 offen lds
    s_add_u32 m0, s60, 84992
    s_add_u32 s63, s62, 671744
    s_and_b32 s63, s63, 0x1fffff
    buffer_load_dwordx4 v227, s[44:47], s63 offen lds
    s_add_u32 m0, s60, 92160
    s_add_u32 s63, s62, 786432
    s_and_b32 s63, s63, 0x1fffff
    buffer_load_dwordx4 v227, s[44:47], s63 offen lds
    s_add_u32 m0, s60, 93184
    s_add_u32 s63, s62, 802816
    s_and_b32 s63, s63, 0x1fffff
    buffer_load_dwordx4 v227, s[44:47], s63 offen lds
    s_add_u32 m0, s60, 100352
    s_add_u32 s63, s62, 917504
    s_and_b32 s63, s63, 0x1fffff
    buffer_load_dwordx4 v227, s[44:47], s63 offen lds
    s_add_u32 m0, s60, 101376
    s_add_u32 s63, s62, 933888
    s_and_b32 s63, s63, 0x1fffff
    buffer_load_dwordx4 v227, s[44:47], s63 offen lds
    s_add_u32 m0, s60, 108544
    s_add_u32 s63, s62, 1048576
    s_and_b32 s63, s63, 0x1fffff
    buffer_load_dwordx4 v227, s[44:47], s63 offen lds
    s_add_u32 m0, s60, 109568
    s_add_u32 s63, s62, 1064960
    s_and_b32 s63, s63, 0x1fffff
    buffer_load_dwordx4 v227, s[44:47], s63 offen lds
    s_add_u32 m0, s60, 116736
    s_add_u32 s63, s62, 1179648
    s_and_b32 s63, s63, 0x1fffff
    buffer_load_dwordx4 v227, s[44:47], s63 offen lds
    s_add_u32 m0, s60, 117760
    s_add_u32 s63, s62, 1196032
    s_and_b32 s63, s63, 0x1fffff
    buffer_load_dwordx4 v227, s[44:47], s63 offen lds
    s_setprio 0
    s_waitcnt vmcnt(0)
    s_mov_b64 exec, 1
    ds_add_u32 v228, v2 offset:4
    s_mov_b64 exec, -1
    s_cmp_eq_u32 s39, 3
    s_cbranch_scc0 L_jo_39
    s_mov_b32 s38, 131072
L_sg_loop_42:
    s_load_dword s37, s[52:53], s57 glc
L_sg_chk_43:
    s_waitcnt lgkmcnt(0)
    s_cmp_ge_u32 s37, 16
    s_cbranch_scc1 L_sg_done_41
    s_sub_u32 s38, s38, 1
    s_cbranch_scc0 L_sg_loop_42
L_sg_done_41:
    v_mov_b32 v1, 16
    s_mov_b64 exec, 1
    ds_add_u32 v228, v1 offset:4
    s_mov_b64 exec, -1
L_jo_39:
    s_mov_b32 s38, 1048576
L_sl_loop_45:
    ds_read_b32 v1, v228 offset:4
    s_waitcnt lgkmcnt(0)
    v_readfirstlane_b32 s37, v1
    s_nop 0
    s_cmp_ge_u32 s37, 20
    s_cbranch_scc1 L_sl_done_44
    s_sleep 1
    s_sub_u32 s38, s38, 1
    s_cbranch_scc0 L_sl_loop_45
L_sl_done_44:
L_jd_40:
    buffer_load_dwordx4 v[80:83], v224, s[40:43], s64 offen offset:0 sc1
    buffer_load_dwordx4 v[84:87], v225, s[40:43], s64 offen offset:0 sc1
    ds_read_b64_tr_b16 v[36:37], v68 offset:0
    ds_read_b64_tr_b16 v[38:39], v68 offset:2048
    buffer_load_dwordx4 v[88:91], v224, s[40:43], s64 offen offset:1024 sc1
    buffer_load_dwordx4 v[92:95], v225, s[40:43], s64 offen offset:1024 sc1
    ds_read_b64_tr_b16 v[40:41], v69 offset:0
    ds_read_b64_tr_b16 v[42:43], v69 offset:2048
    buffer_load_dwordx4 v[96:99], v224, s[40:43], s64 offen offset:2048 sc1
    buffer_load_dwordx4 v[100:103], v225, s[40:43], s64 offen offset:2048 sc1
    ds_read_b64_tr_b16 v[44:45], v70 offset:0
    ds_read_b64_tr_b16 v[46:47], v70 offset:2048
    buffer_load_dwordx4 v[104:107], v224, s[40:43], s64 offen offset:3072 sc1
    buffer_load_dwordx4 v[108:111], v225, s[40:43], s64 offen offset:3072 sc1
    ds_read_b64_tr_b16 v[48:49], v71 offset:0
    ds_read_b64_tr_b16 v[50:51], v71 offset:2048
    buffer_load_dwordx4 v[112:115], v224, s[40:43], s65 offen offset:0 sc1
    buffer_load_dwordx4 v[116:119], v225, s[40:43], s65 offen offset:0 sc1
    ds_read_b64_tr_b16 v[52:53], v68 offset:4096
    ds_read_b64_tr_b16 v[54:55], v68 offset:6144
    buffer_load_dwordx4 v[120:123], v224, s[40:43], s65 offen offset:1024 sc1
    buffer_load_dwordx4 v[124:127], v225, s[40:43], s65 offen offset:1024 sc1
    ds_read_b64_tr_b16 v[56:57], v69 offset:4096
    ds_read_b64_tr_b16 v[58:59], v69 offset:6144
    buffer_load_dwordx4 v[128:131], v224, s[40:43], s65 offen offset:2048 sc1
    buffer_load_dwordx4 v[132:135], v225, s[40:43], s65 offen offset:2048 sc1
    ds_read_b64_tr_b16 v[60:61], v70 offset:4096
    ds_read_b64_tr_b16 v[62:63], v70 offset:6144
    buffer_load_dwordx4 v[136:139], v224, s[40:43], s65 offen offset:3072 sc1
    buffer_load_dwordx4 v[140:143], v225, s[40:43], s65 offen offset:3072 sc1
    s_waitcnt vmcnt(14) lgkmcnt(12)
    v_mfma_f32_16x16x32_bf16 v[4:7], v[36:39], v[80:83], 0
    ds_read_b64_tr_b16 v[64:65], v71 offset:4096
    v_mfma_f32_16x16x32_bf16 v[20:23], v[36:39], v[84:87], 0
    ds_read_b64_tr_b16 v[66:67], v71 offset:6144
    s_waitcnt lgkmcnt(12)
    v_mfma_f32_16x16x32_bf16 v[8:11], v[40:43], v[80:83], 0
    ds_read_b64_tr_b16 v[36:37], v68 offset:8192
    v_mfma_f32_16x16x32_bf16 v[24:27], v[40:43], v[84:87], 0
    ds_read_b64_tr_b16 v[38:39], v68 offset:10240
    buffer_load_dwordx4 v[144:147], v224, s[40:43], s66 offen offset:0 sc1
    s_waitcnt lgkmcnt(12)
    v_mfma_f32_16x16x32_bf16 v[12:15], v[44:47], v[80:83], 0
    ds_read_b64_tr_b16 v[40:41], v69 offset:8192
    v_mfma_f32_16x16x32_bf16 v[28:31], v[44:47], v[84:87], 0
    ds_read_b64_tr_b16 v[42:43], v69 offset:10240
    s_waitcnt lgkmcnt(12)
    v_mfma_f32_16x16x32_bf16 v[16:19], v[48:51], v[80:83], 0
    ds_read_b64_tr_b16 v[44:45], v70 offset:8192
    v_mfma_f32_16x16x32_bf16 v[32:35], v[48:51], v[84:87], 0
    ds_read_b64_tr_b16 v[46:47], v70 offset:10240
    buffer_load_dwordx4 v[148:151], v225, s[40:43], s66 offen offset:0 sc1
    s_waitcnt vmcnt(14) lgkmcnt(12)
    v_mfma_f32_16x16x32_bf16 v[4:7], v[52:55], v[88:91], v[4:7]
    ds_read_b64_tr_b16 v[48:49], v71 offset:8192
    v_mfma_f32_16x16x32_bf16 v[20:23], v[52:55], v[92:95], v[20:23]
    ds_read_b64_tr_b16 v[50:51], v71 offset:10240
    s_waitcnt lgkmcnt(12)
    v_mfma_f32_16x16x32_bf16 v[8:11], v[56:59], v[88:91], v[8:11]
    ds_read_b64_tr_b16 v[52:53], v68 offset:12288
    v_mfma_f32_16x16x32_bf16 v[24:27], v[56:59], v[92:95], v[24:27]
    ds_read_b64_tr_b16 v[54:55], v68 offset:14336
    buffer_load_dwordx4 v[80:83], v224, s[40:43], s66 offen offset:1024 sc1
    s_waitcnt lgkmcnt(12)
    v_mfma_f32_16x16x32_bf16 v[12:15], v[60:63], v[88:91], v[12:15]
    ds_read_b64_tr_b16 v[56:57], v69 offset:12288
    v_mfma_f32_16x16x32_bf16 v[28:31], v[60:63], v[92:95], v[28:31]
    ds_read_b64_tr_b16 v[58:59], v69 offset:14336
    s_waitcnt lgkmcnt(12)
    v_mfma_f32_16x16x32_bf16 v[16:19], v[64:67], v[88:91], v[16:19]
    ds_read_b64_tr_b16 v[60:61], v70 offset:12288
    v_mfma_f32_16x16x32_bf16 v[32:35], v[64:67], v[92:95], v[32:35]
    ds_read_b64_tr_b16 v[62:63], v70 offset:14336
    buffer_load_dwordx4 v[84:87], v225, s[40:43], s66 offen offset:1024 sc1
    s_waitcnt vmcnt(14) lgkmcnt(12)
    v_mfma_f32_16x16x32_bf16 v[4:7], v[36:39], v[96:99], v[4:7]
    ds_read_b64_tr_b16 v[64:65], v71 offset:12288
    v_mfma_f32_16x16x32_bf16 v[20:23], v[36:39], v[100:103], v[20:23]
    ds_read_b64_tr_b16 v[66:67], v71 offset:14336
    s_waitcnt lgkmcnt(12)
    v_mfma_f32_16x16x32_bf16 v[8:11], v[40:43], v[96:99], v[8:11]
    ds_read_b64_tr_b16 v[36:37], v68 offset:16384
    v_mfma_f32_16x16x32_bf16 v[24:27], v[40:43], v[100:103], v[24:27]
    ds_read_b64_tr_b16 v[38:39], v68 offset:18432
    buffer_load_dwordx4 v[88:91], v224, s[40:43], s66 offen offset:2048 sc1
    s_waitcnt lgkmcnt(12)
    v_mfma_f32_16x16x32_bf16 v[12:15], v[44:47], v[96:99], v[12:15]
    ds_read_b64_tr_b16 v[40:41], v69 offset:16384
    v_mfma_f32_16x16x32_bf16 v[28:31], v[44:47], v[100:103], v[28:31]
    ds_read_b64_tr_b16 v[42:43], v69 offset:18432
    s_waitcnt lgkmcnt(12)
    v_mfma_f32_16x16x32_bf16 v[16:19], v[48:51], v[96:99], v[16:19]
    ds_read_b64_tr_b16 v[44:45], v70 offset:16384
    v_mfma_f32_16x16x32_bf16 v[32:35], v[48:51], v[100:103], v[32:35]
    ds_read_b64_tr_b16 v[46:47], v70 offset:18432
    buffer_load_dwordx4 v[92:95], v225, s[40:43], s66 offen offset:2048 sc1
    s_waitcnt vmcnt(14) lgkmcnt(12)
    v_mfma_f32_16x16x32_bf16 v[4:7], v[52:55], v[104:107], v[4:7]
    ds_read_b64_tr_b16 v[48:49], v71 offset:16384
    v_mfma_f32_16x16x32_bf16 v[20:23], v[52:55], v[108:111], v[20:23]
    ds_read_b64_tr_b16 v[50:51], v71 offset:18432
    s_waitcnt lgkmcnt(12)
    v_mfma_f32_16x16x32_bf16 v[8:11], v[56:59], v[104:107], v[8:11]
    ds_read_b64_tr_b16 v[52:53], v68 offset:20480
    v_mfma_f32_16x16x32_bf16 v[24:27], v[56:59], v[108:111], v[24:27]
    ds_read_b64_tr_b16 v[54:55], v68 offset:22528
    buffer_load_dwordx4 v[96:99], v224, s[40:43], s66 offen offset:3072 sc1
    s_waitcnt lgkmcnt(12)
    v_mfma_f32_16x16x32_bf16 v[12:15], v[60:63], v[104:107], v[12:15]
    ds_read_b64_tr_b16 v[56:57], v69 offset:20480
    v_mfma_f32_16x16x32_bf16 v[28:31], v[60:63], v[108:111], v[28:31]
    ds_read_b64_tr_b16 v[58:59], v69 offset:22528
    s_waitcnt lgkmcnt(12)
    v_mfma_f32_16x16x32_bf16 v[16:19], v[64:67], v[104:107], v[16:19]
    ds_read_b64_tr_b16 v[60:61], v70 offset:20480
    v_mfma_f32_16x16x32_bf16 v[32:35], v[64:67], v[108:111], v[32:35]
    ds_read_b64_tr_b16 v[62:63], v70 offset:22528
    buffer_load_dwordx4 v[100:103], v225, s[40:43], s66 offen offset:3072 sc1
    s_waitcnt vmcnt(14) lgkmcnt(12)
    v_mfma_f32_16x16x32_bf16 v[4:7], v[36:39], v[112:115], v[4:7]
    ds_read_b64_tr_b16 v[64:65], v71 offset:20480
    v_mfma_f32_16x16x32_bf16 v[20:23], v[36:39], v[116:119], v[20:23]
    ds_read_b64_tr_b16 v[66:67], v71 offset:22528
    s_waitcnt lgkmcnt(12)
    v_mfma_f32_16x16x32_bf16 v[8:11], v[40:43], v[112:115], v[8:11]
    ds_read_b64_tr_b16 v[36:37], v68 offset:24576
    v_mfma_f32_16x16x32_bf16 v[24:27], v[40:43], v[116:119], v[24:27]
    ds_read_b64_tr_b16 v[38:39], v68 offset:26624
    buffer_load_dwordx4 v[104:107], v224, s[40:43], s67 offen offset:0 sc1
    s_waitcnt lgkmcnt(12)
    v_mfma_f32_16x16x32_bf16 v[12:15], v[44:47], v[112:115], v[12:15]
    ds_read_b64_tr_b16 v[40:41], v69 offset:24576
    v_mfma_f32_16x16x32_bf16 v[28:31], v[44:47], v[116:119], v[28:31]
    ds_read_b64_tr_b16 v[42:43], v69 offset:26624
    s_waitcnt lgkmcnt(12)
    v_mfma_f32_16x16x32_bf16 v[16:19], v[48:51], v[112:115], v[16:19]
    ds_read_b64_tr_b16 v[44:45], v70 offset:24576
    v_mfma_f32_16x16x32_bf16 v[32:35], v[48:51], v[116:119], v[32:35]
    ds_read_b64_tr_b16 v[46:47], v70 offset:26624
    buffer_load_dwordx4 v[108:111], v225, s[40:43], s67 offen offset:0 sc1
    s_waitcnt vmcnt(14) lgkmcnt(12)
    v_mfma_f32_16x16x32_bf16 v[4:7], v[52:55], v[120:123], v[4:7]
    ds_read_b64_tr_b16 v[48:49], v71 offset:24576
    v_mfma_f32_16x16x32_bf16 v[20:23], v[52:55], v[124:127], v[20:23]
    ds_read_b64_tr_b16 v[50:51], v71 offset:26624
    s_waitcnt lgkmcnt(12)
    v_mfma_f32_16x16x32_bf16 v[8:11], v[56:59], v[120:123], v[8:11]
    ds_read_b64_tr_b16 v[52:53], v68 offset:28672
    v_mfma_f32_16x16x32_bf16 v[24:27], v[56:59], v[124:127], v[24:27]
    ds_read_b64_tr_b16 v[54:55], v68 offset:30720
    buffer_load_dwordx4 v[112:115], v224, s[40:43], s67 offen offset:1024 sc1
    s_waitcnt lgkmcnt(12)
    v_mfma_f32_16x16x32_bf16 v[12:15], v[60:63], v[120:123], v[12:15]
    ds_read_b64_tr_b16 v[56:57], v69 offset:28672
    v_mfma_f32_16x16x32_bf16 v[28:31], v[60:63], v[124:127], v[28:31]
    ds_read_b64_tr_b16 v[58:59], v69 offset:30720
    s_waitcnt lgkmcnt(12)
    v_mfma_f32_16x16x32_bf16 v[16:19], v[64:67], v[120:123], v[16:19]
    ds_read_b64_tr_b16 v[60:61], v70 offset:28672
    v_mfma_f32_16x16x32_bf16 v[32:35], v[64:67], v[124:127], v[32:35]
    ds_read_b64_tr_b16 v[62:63], v70 offset:30720
    buffer_load_dwordx4 v[116:119], v225, s[40:43], s67 offen offset:1024 sc1
    s_waitcnt vmcnt(14) lgkmcnt(12)
    v_mfma_f32_16x16x32_bf16 v[4:7], v[36:39], v[128:131], v[4:7]
    ds_read_b64_tr_b16 v[64:65], v71 offset:28672
    v_mfma_f32_16x16x32_bf16 v[20:23], v[36:39], v[132:135], v[20:23]
    ds_read_b64_tr_b16 v[66:67], v71 offset:30720
    s_waitcnt lgkmcnt(12)
    v_mfma_f32_16x16x32_bf16 v[8:11], v[40:43], v[128:131], v[8:11]
    ds_read_b64_tr_b16 v[36:37], v68 offset:32768
    v_mfma_f32_16x16x32_bf16 v[24:27], v[40:43], v[132:135], v[24:27]
    ds_read_b64_tr_b16 v[38:39], v68 offset:34816
    buffer_load_dwordx4 v[120:123], v224, s[40:43], s67 offen offset:2048 sc1
    s_waitcnt lgkmcnt(12)
    v_mfma_f32_16x16x32_bf16 v[12:15], v[44:47], v[128:131], v[12:15]
    ds_read_b64_tr_b16 v[40:41], v69 offset:32768
    v_mfma_f32_16x16x32_bf16 v[28:31], v[44:47], v[132:135], v[28:31]
    ds_read_b64_tr_b16 v[42:43], v69 offset:34816
    s_waitcnt lgkmcnt(12)
    v_mfma_f32_16x16x32_bf16 v[16:19], v[48:51], v[128:131], v[16:19]
    ds_read_b64_tr_b16 v[44:45], v70 offset:32768
    v_mfma_f32_16x16x32_bf16 v[32:35], v[48:51], v[132:135], v[32:35]
    ds_read_b64_tr_b16 v[46:47], v70 offset:34816
    buffer_load_dwordx4 v[124:127], v225, s[40:43], s67 offen offset:2048 sc1
    s_waitcnt vmcnt(14) lgkmcnt(12)
    v_mfma_f32_16x16x32_bf16 v[4:7], v[52:55], v[136:139], v[4:7]
    ds_read_b64_tr_b16 v[48:49], v71 offset:32768
    v_mfma_f32_16x16x32_bf16 v[20:23], v[52:55], v[140:143], v[20:23]
    ds_read_b64_tr_b16 v[50:51], v71 offset:34816
    s_waitcnt lgkmcnt(12)
    v_mfma_f32_16x16x32_bf16 v[8:11], v[56:59], v[136:139], v[8:11]
    ds_read_b64_tr_b16 v[52:53], v68 offset:36864
    v_mfma_f32_16x16x32_bf16 v[24:27], v[56:59], v[140:143], v[24:27]
    ds_read_b64_tr_b16 v[54:55], v68 offset:38912
    buffer_load_dwordx4 v[128:131], v224, s[40:43], s67 offen offset:3072 sc1
    s_waitcnt lgkmcnt(12)
    v_mfma_f32_16x16x32_bf16 v[12:15], v[60:63], v[136:139], v[12:15]
    ds_read_b64_tr_b16 v[56:57], v69 offset:36864
    v_mfma_f32_16x16x32_bf16 v[28:31], v[60:63], v[140:143], v[28:31]
    ds_read_b64_tr_b16 v[58:59], v69 offset:38912
    s_waitcnt lgkmcnt(12)
    v_mfma_f32_16x16x32_bf16 v[16:19], v[64:67], v[136:139], v[16:19]
    ds_read_b64_tr_b16 v[60:61], v70 offset:36864
    v_mfma_f32_16x16x32_bf16 v[32:35], v[64:67], v[140:143], v[32:35]
    ds_read_b64_tr_b16 v[62:63], v70 offset:38912
    buffer_load_dwordx4 v[132:135], v225, s[40:43], s67 offen offset:3072 sc1
    s_waitcnt vmcnt(14) lgkmcnt(12)
    v_mfma_f32_16x16x32_bf16 v[4:7], v[36:39], v[144:147], v[4:7]
    ds_read_b64_tr_b16 v[64:65], v71 offset:36864
    v_mfma_f32_16x16x32_bf16 v[20:23], v[36:39], v[148:151], v[20:23]
    ds_read_b64_tr_b16 v[66:67], v71 offset:38912
    s_waitcnt lgkmcnt(12)
    v_mfma_f32_16x16x32_bf16 v[8:11], v[40:43], v[144:147], v[8:11]
    ds_read_b64_tr_b16 v[36:37], v72 offset:0
    v_mfma_f32_16x16x32_bf16 v[24:27], v[40:43], v[148:151], v[24:27]
    ds_read_b64_tr_b16 v[38:39], v72 offset:2048
    buffer_load_dwordx4 v[136:139], v224, s[40:43], s68 offen offset:0 sc1
    s_waitcnt lgkmcnt(12)
    v_mfma_f32_16x16x32_bf16 v[12:15], v[44:47], v[144:147], v[12:15]
    ds_read_b64_tr_b16 v[40:41], v73 offset:0
    v_mfma_f32_16x16x32_bf16 v[28:31], v[44:47], v[148:151], v[28:31]
    ds_read_b64_tr_b16 v[42:43], v73 offset:2048
    s_waitcnt lgkmcnt(12)
    v_mfma_f32_16x16x32_bf16 v[16:19], v[48:51], v[144:147], v[16:19]
    ds_read_b64_tr_b16 v[44:45], v74 offset:0
    v_mfma_f32_16x16x32_bf16 v[32:35], v[48:51], v[148:151], v[32:35]
    ds_read_b64_tr_b16 v[46:47], v74 offset:2048
    buffer_load_dwordx4 v[140:143], v225, s[40:43], s68 offen offset:0 sc1
    s_waitcnt vmcnt(14) lgkmcnt(12)
    v_mfma_f32_16x16x32_bf16 v[4:7], v[52:55], v[80:83], v[4:7]
    ds_read_b64_tr_b16 v[48:49], v75 offset:0
    v_mfma_f32_16x16x32_bf16 v[20:23], v[52:55], v[84:87], v[20:23]
    ds_read_b64_tr_b16 v[50:51], v75 offset:2048
    s_waitcnt lgkmcnt(12)
    v_mfma_f32_16x16x32_bf16 v[8:11], v[56:59], v[80:83], v[8:11]
    ds_read_b64_tr_b16 v[52:53], v72 offset:4096
    v_mfma_f32_16x16x32_bf16 v[24:27], v[56:59], v[84:87], v[24:27]
    ds_read_b64_tr_b16 v[54:55], v72 offset:6144
    buffer_load_dwordx4 v[144:147], v224, s[40:43], s68 offen offset:1024 sc1
    s_waitcnt lgkmcnt(12)
    v_mfma_f32_16x16x32_bf16 v[12:15], v[60:63], v[80:83], v[12:15]
    ds_read_b64_tr_b16 v[56:57], v73 offset:4096
    v_mfma_f32_16x16x32_bf16 v[28:31], v[60:63], v[84:87], v[28:31]
    ds_read_b64_tr_b16 v[58:59], v73 offset:6144
    s_waitcnt lgkmcnt(12)
    v_mfma_f32_16x16x32_bf16 v[16:19], v[64:67], v[80:83], v[16:19]
    ds_read_b64_tr_b16 v[60:61], v74 offset:4096
    v_mfma_f32_16x16x32_bf16 v[32:35], v[64:67], v[84:87], v[32:35]
    ds_read_b64_tr_b16 v[62:63], v74 offset:6144
    buffer_load_dwordx4 v[148:151], v225, s[40:43], s68 offen offset:1024 sc1
    s_waitcnt vmcnt(14) lgkmcnt(12)
    v_mfma_f32_16x16x32_bf16 v[4:7], v[36:39], v[88:91], v[4:7]
    ds_read_b64_tr_b16 v[64:65], v75 offset:4096
    v_mfma_f32_16x16x32_bf16 v[20:23], v[36:39], v[92:95], v[20:23]
    ds_read_b64_tr_b16 v[66:67], v75 offset:6144
    s_waitcnt lgkmcnt(12)
    v_mfma_f32_16x16x32_bf16 v[8:11], v[40:43], v[88:91], v[8:11]
    ds_read_b64_tr_b16 v[36:37], v72 offset:8192
    v_mfma_f32_16x16x32_bf16 v[24:27], v[40:43], v[92:95], v[24:27]
    ds_read_b64_tr_b16 v[38:39], v72 offset:10240
    buffer_load_dwordx4 v[80:83], v224, s[40:43], s68 offen offset:2048 sc1
    s_waitcnt lgkmcnt(12)
    v_mfma_f32_16x16x32_bf16 v[12:15], v[44:47], v[88:91], v[12:15]
    ds_read_b64_tr_b16 v[40:41], v73 offset:8192
    v_mfma_f32_16x16x32_bf16 v[28:31], v[44:47], v[92:95], v[28:31]
    ds_read_b64_tr_b16 v[42:43], v73 offset:10240
    s_waitcnt lgkmcnt(12)
    v_mfma_f32_16x16x32_bf16 v[16:19], v[48:51], v[88:91], v[16:19]
    ds_read_b64_tr_b16 v[44:45], v74 offset:8192
    v_mfma_f32_16x16x32_bf16 v[32:35], v[48:51], v[92:95], v[32:35]
    ds_read_b64_tr_b16 v[46:47], v74 offset:10240
    buffer_load_dwordx4 v[84:87], v225, s[40:43], s68 offen offset:2048 sc1
    s_waitcnt vmcnt(14) lgkmcnt(12)
    v_mfma_f32_16x16x32_bf16 v[4:7], v[52:55], v[96:99], v[4:7]
    ds_read_b64_tr_b16 v[48:49], v75 offset:8192
    v_mfma_f32_16x16x32_bf16 v[20:23], v[52:55], v[100:103], v[20:23]
    ds_read_b64_tr_b16 v[50:51], v75 offset:10240
    s_waitcnt lgkmcnt(12)
    v_mfma_f32_16x16x32_bf16 v[8:11], v[56:59], v[96:99], v[8:11]
    ds_read_b64_tr_b16 v[52:53], v72 offset:12288
    v_mfma_f32_16x16x32_bf16 v[24:27], v[56:59], v[100:103], v[24:27]
    ds_read_b64_tr_b16 v[54:55], v72 offset:14336
    buffer_load_dwordx4 v[88:91], v224, s[40:43], s68 offen offset:3072 sc1
    s_waitcnt lgkmcnt(12)
    v_mfma_f32_16x16x32_bf16 v[12:15], v[60:63], v[96:99], v[12:15]
    ds_read_b64_tr_b16 v[56:57], v73 offset:12288
    v_mfma_f32_16x16x32_bf16 v[28:31], v[60:63], v[100:103], v[28:31]
    ds_read_b64_tr_b16 v[58:59], v73 offset:14336
    s_waitcnt lgkmcnt(12)
    v_mfma_f32_16x16x32_bf16 v[16:19], v[64:67], v[96:99], v[16:19]
    ds_read_b64_tr_b16 v[60:61], v74 offset:12288
    v_mfma_f32_16x16x32_bf16 v[32:35], v[64:67], v[100:103], v[32:35]
    ds_read_b64_tr_b16 v[62:63], v74 offset:14336
    buffer_load_dwordx4 v[92:95], v225, s[40:43], s68 offen offset:3072 sc1
    s_waitcnt vmcnt(14) lgkmcnt(12)
    v_mfma_f32_16x16x32_bf16 v[4:7], v[36:39], v[104:107], v[4:7]
    ds_read_b64_tr_b16 v[64:65], v75 offset:12288
    v_mfma_f32_16x16x32_bf16 v[20:23], v[36:39], v[108:111], v[20:23]
    ds_read_b64_tr_b16 v[66:67], v75 offset:14336
    s_waitcnt lgkmcnt(12)
    v_mfma_f32_16x16x32_bf16 v[8:11], v[40:43], v[104:107], v[8:11]
    ds_read_b64_tr_b16 v[36:37], v72 offset:16384
    v_mfma_f32_16x16x32_bf16 v[24:27], v[40:43], v[108:111], v[24:27]
    ds_read_b64_tr_b16 v[38:39], v72 offset:18432
    buffer_load_dwordx4 v[96:99], v224, s[40:43], s69 offen offset:0 sc1
    s_waitcnt lgkmcnt(12)
    v_mfma_f32_16x16x32_bf16 v[12:15], v[44:47], v[104:107], v[12:15]
    ds_read_b64_tr_b16 v[40:41], v73 offset:16384
    v_mfma_f32_16x16x32_bf16 v[28:31], v[44:47], v[108:111], v[28:31]
    ds_read_b64_tr_b16 v[42:43], v73 offset:18432
    s_waitcnt lgkmcnt(12)
    v_mfma_f32_16x16x32_bf16 v[16:19], v[48:51], v[104:107], v[16:19]
    ds_read_b64_tr_b16 v[44:45], v74 offset:16384
    v_mfma_f32_16x16x32_bf16 v[32:35], v[48:51], v[108:111], v[32:35]
    ds_read_b64_tr_b16 v[46:47], v74 offset:18432
    buffer_load_dwordx4 v[100:103], v225, s[40:43], s69 offen offset:0 sc1
    s_waitcnt vmcnt(14) lgkmcnt(12)
    v_mfma_f32_16x16x32_bf16 v[4:7], v[52:55], v[112:115], v[4:7]
    ds_read_b64_tr_b16 v[48:49], v75 offset:16384
    v_mfma_f32_16x16x32_bf16 v[20:23], v[52:55], v[116:119], v[20:23]
    ds_read_b64_tr_b16 v[50:51], v75 offset:18432
    s_waitcnt lgkmcnt(12)
    v_mfma_f32_16x16x32_bf16 v[8:11], v[56:59], v[112:115], v[8:11]
    ds_read_b64_tr_b16 v[52:53], v72 offset:20480
    v_mfma_f32_16x16x32_bf16 v[24:27], v[56:59], v[116:119], v[24:27]
    ds_read_b64_tr_b16 v[54:55], v72 offset:22528
    buffer_load_dwordx4 v[104:107], v224, s[40:43], s69 offen offset:1024 sc1
    s_waitcnt lgkmcnt(12)
    v_mfma_f32_16x16x32_bf16 v[12:15], v[60:63], v[112:115], v[12:15]
    ds_read_b64_tr_b16 v[56:57], v73 offset:20480
    v_mfma_f32_16x16x32_bf16 v[28:31], v[60:63], v[116:119], v[28:31]
    ds_read_b64_tr_b16 v[58:59], v73 offset:22528
    s_waitcnt lgkmcnt(12)
    v_mfma_f32_16x16x32_bf16 v[16:19], v[64:67], v[112:115], v[16:19]
    ds_read_b64_tr_b16 v[60:61], v74 offset:20480
    v_mfma_f32_16x16x32_bf16 v[32:35], v[64:67], v[116:119], v[32:35]
    ds_read_b64_tr_b16 v[62:63], v74 offset:22528
    buffer_load_dwordx4 v[108:111], v225, s[40:43], s69 offen offset:1024 sc1
    s_waitcnt vmcnt(14) lgkmcnt(12)
    v_mfma_f32_16x16x32_bf16 v[4:7], v[36:39], v[120:123], v[4:7]
    ds_read_b64_tr_b16 v[64:65], v75 offset:20480
    v_mfma_f32_16x16x32_bf16 v[20:23], v[36:39], v[124:127], v[20:23]
    ds_read_b64_tr_b16 v[66:67], v75 offset:22528
    s_waitcnt lgkmcnt(12)
    v_mfma_f32_16x16x32_bf16 v[8:11], v[40:43], v[120:123], v[8:11]
    ds_read_b64_tr_b16 v[36:37], v72 offset:24576
    v_mfma_f32_16x16x32_bf16 v[24:27], v[40:43], v[124:127], v[24:27]
    ds_read_b64_tr_b16 v[38:39], v72 offset:26624
    buffer_load_dwordx4 v[112:115], v224, s[40:43], s69 offen offset:2048 sc1
    s_waitcnt lgkmcnt(12)
    v_mfma_f32_16x16x32_bf16 v[12:15], v[44:47], v[120:123], v[12:15]
    ds_read_b64_tr_b16 v[40:41], v73 offset:24576
    v_mfma_f32_16x16x32_bf16 v[28:31], v[44:47], v[124:127], v[28:31]
    ds_read_b64_tr_b16 v[42:43], v73 offset:26624
    s_waitcnt lgkmcnt(12)
    v_mfma_f32_16x16x32_bf16 v[16:19], v[48:51], v[120:123], v[16:19]
    ds_read_b64_tr_b16 v[44:45], v74 offset:24576
    v_mfma_f32_16x16x32_bf16 v[32:35], v[48:51], v[124:127], v[32:35]
    ds_read_b64_tr_b16 v[46:47], v74 offset:26624
    buffer_load_dwordx4 v[116:119], v225, s[40:43], s69 offen offset:2048 sc1
    s_waitcnt vmcnt(14) lgkmcnt(12)
    v_mfma_f32_16x16x32_bf16 v[4:7], v[52:55], v[128:131], v[4:7]
    ds_read_b64_tr_b16 v[48:49], v75 offset:24576
    v_mfma_f32_16x16x32_bf16 v[20:23], v[52:55], v[132:135], v[20:23]
    ds_read_b64_tr_b16 v[50:51], v75 offset:26624
    s_waitcnt lgkmcnt(12)
    v_mfma_f32_16x16x32_bf16 v[8:11], v[56:59], v[128:131], v[8:11]
    ds_read_b64_tr_b16 v[52:53], v72 offset:28672
    v_mfma_f32_16x16x32_bf16 v[24:27], v[56:59], v[132:135], v[24:27]
    ds_read_b64_tr_b16 v[54:55], v72 offset:30720
    buffer_load_dwordx4 v[120:123], v224, s[40:43], s69 offen offset:3072 sc1
    s_waitcnt lgkmcnt(12)
    v_mfma_f32_16x16x32_bf16 v[12:15], v[60:63], v[128:131], v[12:15]
    ds_read_b64_tr_b16 v[56:57], v73 offset:28672
    v_mfma_f32_16x16x32_bf16 v[28:31], v[60:63], v[132:135], v[28:31]
    ds_read_b64_tr_b16 v[58:59], v73 offset:30720
    s_waitcnt lgkmcnt(12)
    v_mfma_f32_16x16x32_bf16 v[16:19], v[64:67], v[128:131], v[16:19]
    ds_read_b64_tr_b16 v[60:61], v74 offset:28672
    v_mfma_f32_16x16x32_bf16 v[32:35], v[64:67], v[132:135], v[32:35]
    ds_read_b64_tr_b16 v[62:63], v74 offset:30720
    buffer_load_dwordx4 v[124:127], v225, s[40:43], s69 offen offset:3072 sc1
    s_waitcnt vmcnt(14) lgkmcnt(12)
    v_mfma_f32_16x16x32_bf16 v[4:7], v[36:39], v[136:139], v[4:7]
    ds_read_b64_tr_b16 v[64:65], v75 offset:28672
    v_mfma_f32_16x16x32_bf16 v[20:23], v[36:39], v[140:143], v[20:23]
    ds_read_b64_tr_b16 v[66:67], v75 offset:30720
    s_waitcnt lgkmcnt(12)
    v_mfma_f32_16x16x32_bf16 v[8:11], v[40:43], v[136:139], v[8:11]
    ds_read_b64_tr_b16 v[36:37], v72 offset:32768
    v_mfma_f32_16x16x32_bf16 v[24:27], v[40:43], v[140:143], v[24:27]
    ds_read_b64_tr_b16 v[38:39], v72 offset:34816
    buffer_load_dwordx4 v[128:131], v224, s[40:43], s70 offen offset:0 sc1
    s_waitcnt lgkmcnt(12)
    v_mfma_f32_16x16x32_bf16 v[12:15], v[44:47], v[136:139], v[12:15]
    ds_read_b64_tr_b16 v[40:41], v73 offset:32768
    v_mfma_f32_16x16x32_bf16 v[28:31], v[44:47], v[140:143], v[28:31]
    ds_read_b64_tr_b16 v[42:43], v73 offset:34816
    ds_read_b32 v1, v228 offset:12
    s_waitcnt lgkmcnt(13)
    v_mfma_f32_16x16x32_bf16 v[16:19], v[48:51], v[136:139], v[16:19]
    ds_read_b64_tr_b16 v[44:45], v74 offset:32768
    v_mfma_f32_16x16x32_bf16 v[32:35], v[48:51], v[140:143], v[32:35]
    ds_read_b64_tr_b16 v[46:47], v74 offset:34816
    buffer_load_dwordx4 v[132:135], v225, s[40:43], s70 offen offset:0 sc1
    s_waitcnt vmcnt(14) lgkmcnt(13)
    v_mfma_f32_16x16x32_bf16 v[4:7], v[52:55], v[144:147], v[4:7]
    ds_read_b64_tr_b16 v[48:49], v75 offset:32768
    v_mfma_f32_16x16x32_bf16 v[20:23], v[52:55], v[148:151], v[20:23]
    ds_read_b64_tr_b16 v[50:51], v75 offset:34816
    s_waitcnt lgkmcnt(13)
    v_mfma_f32_16x16x32_bf16 v[8:11], v[56:59], v[144:147], v[8:11]
    ds_read_b64_tr_b16 v[52:53], v72 offset:36864
    v_mfma_f32_16x16x32_bf16 v[24:27], v[56:59], v[148:151], v[24:27]
    ds_read_b64_tr_b16 v[54:55], v72 offset:38912
    buffer_load_dwordx4 v[136:139], v224, s[40:43], s70 offen offset:1024 sc1
    s_waitcnt lgkmcnt(13)
    v_mfma_f32_16x16x32_bf16 v[12:15], v[60:63], v[144:147], v[12:15]
    ds_read_b64_tr_b16 v[56:57], v73 offset:36864
    v_mfma_f32_16x16x32_bf16 v[28:31], v[60:63], v[148:151], v[28:31]
    ds_read_b64_tr_b16 v[58:59], v73 offset:38912
    s_waitcnt lgkmcnt(13)
    v_mfma_f32_16x16x32_bf16 v[16:19], v[64:67], v[144:147], v[16:19]
    ds_read_b64_tr_b16 v[60:61], v74 offset:36864
    v_mfma_f32_16x16x32_bf16 v[32:35], v[64:67], v[148:151], v[32:35]
    ds_read_b64_tr_b16 v[62:63], v74 offset:38912
    buffer_load_dwordx4 v[140:143], v225, s[40:43], s70 offen offset:1024 sc1
    s_waitcnt vmcnt(14) lgkmcnt(13)
    v_mfma_f32_16x16x32_bf16 v[4:7], v[36:39], v[80:83], v[4:7]
    ds_read_b64_tr_b16 v[64:65], v75 offset:36864
    v_mfma_f32_16x16x32_bf16 v[20:23], v[36:39], v[84:87], v[20:23]
    ds_read_b64_tr_b16 v[66:67], v75 offset:38912
    s_waitcnt lgkmcnt(12)
    v_readfirstlane_b32 s37, v1
    s_nop 0
    s_cmp_ge_u32 s37, 4
    s_cbranch_scc1 L_sl_done_46
    s_mov_b32 s38, 1048576
L_sl_loop_47:
    ds_read_b32 v1, v228 offset:12
    s_waitcnt lgkmcnt(0)
    v_readfirstlane_b32 s37, v1
    s_nop 0
    s_cmp_ge_u32 s37, 4
    s_cbranch_scc1 L_sl_done_46
    s_sleep 1
    s_sub_u32 s38, s38, 1
    s_cbranch_scc0 L_sl_loop_47
L_sl_done_46:
    v_mfma_f32_16x16x32_bf16 v[8:11], v[40:43], v[80:83], v[8:11]
    ds_read_b64_tr_b16 v[36:37], v76 offset:0
    v_mfma_f32_16x16x32_bf16 v[24:27], v[40:43], v[84:87], v[24:27]
    ds_read_b64_tr_b16 v[38:39], v76 offset:2048
    buffer_load_dwordx4 v[144:147], v224, s[40:43], s70 offen offset:2048 sc1
    s_waitcnt lgkmcnt(12)
    v_mfma_f32_16x16x32_bf16 v[12:15], v[44:47], v[80:83], v[12:15]
    ds_read_b64_tr_b16 v[40:41], v77 offset:0
    v_mfma_f32_16x16x32_bf16 v[28:31], v[44:47], v[84:87], v[28:31]
    ds_read_b64_tr_b16 v[42:43], v77 offset:2048
    s_waitcnt lgkmcnt(12)
    v_mfma_f32_16x16x32_bf16 v[16:19], v[48:51], v[80:83], v[16:19]
    ds_read_b64_tr_b16 v[44:45], v78 offset:0
    v_mfma_f32_16x16x32_bf16 v[32:35], v[48:51], v[84:87], v[32:35]
    ds_read_b64_tr_b16 v[46:47], v78 offset:2048
    buffer_load_dwordx4 v[148:151], v225, s[40:43], s70 offen offset:2048 sc1
    s_waitcnt vmcnt(14) lgkmcnt(12)
    v_mfma_f32_16x16x32_bf16 v[4:7], v[52:55], v[88:91], v[4:7]
    ds_read_b64_tr_b16 v[48:49], v79 offset:0
    v_mfma_f32_16x16x32_bf16 v[20:23], v[52:55], v[92:95], v[20:23]
    ds_read_b64_tr_b16 v[50:51], v79 offset:2048
    s_waitcnt lgkmcnt(12)
    v_mfma_f32_16x16x32_bf16 v[8:11], v[56:59], v[88:91], v[8:11]
    ds_read_b64_tr_b16 v[52:53], v76 offset:4096
    v_mfma_f32_16x16x32_bf16 v[24:27], v[56:59], v[92:95], v[24:27]
    ds_read_b64_tr_b16 v[54:55], v76 offset:6144
    buffer_load_dwordx4 v[80:83], v224, s[40:43], s70 offen offset:3072 sc1
    s_waitcnt lgkmcnt(12)
    v_mfma_f32_16x16x32_bf16 v[12:15], v[60:63], v[88:91], v[12:15]
    ds_read_b64_tr_b16 v[56:57], v77 offset:4096
    v_mfma_f32_16x16x32_bf16 v[28:31], v[60:63], v[92:95], v[28:31]
    ds_read_b64_tr_b16 v[58:59], v77 offset:6144
    s_waitcnt lgkmcnt(12)
    v_mfma_f32_16x16x32_bf16 v[16:19], v[64:67], v[88:91], v[16:19]
    ds_read_b64_tr_b16 v[60:61], v78 offset:4096
    v_mfma_f32_16x16x32_bf16 v[32:35], v[64:67], v[92:95], v[32:35]
    ds_read_b64_tr_b16 v[62:63], v78 offset:6144
    buffer_load_dwordx4 v[84:87], v225, s[40:43], s70 offen offset:3072 sc1
    s_waitcnt vmcnt(14) lgkmcnt(12)
    v_mfma_f32_16x16x32_bf16 v[4:7], v[36:39], v[96:99], v[4:7]
    ds_read_b64_tr_b16 v[64:65], v79 offset:4096
    v_mfma_f32_16x16x32_bf16 v[20:23], v[36:39], v[100:103], v[20:23]
    ds_read_b64_tr_b16 v[66:67], v79 offset:6144
    s_waitcnt lgkmcnt(12)
    v_mfma_f32_16x16x32_bf16 v[8:11], v[40:43], v[96:99], v[8:11]
    ds_read_b64_tr_b16 v[36:37], v76 offset:8448
    v_mfma_f32_16x16x32_bf16 v[24:27], v[40:43], v[100:103], v[24:27]
    ds_read_b64_tr_b16 v[38:39], v76 offset:10496
    buffer_load_dwordx4 v[88:91], v224, s[40:43], s71 offen offset:0 sc1
    s_waitcnt lgkmcnt(12)
    v_mfma_f32_16x16x32_bf16 v[12:15], v[44:47], v[96:99], v[12:15]
    ds_read_b64_tr_b16 v[40:41], v77 offset:8448
    v_mfma_f32_16x16x32_bf16 v[28:31], v[44:47], v[100:103], v[28:31]
    ds_read_b64_tr_b16 v[42:43], v77 offset:10496
    s_waitcnt lgkmcnt(12)
    v_mfma_f32_16x16x32_bf16 v[16:19], v[48:51], v[96:99], v[16:19]
    ds_read_b64_tr_b16 v[44:45], v78 offset:8448
    v_mfma_f32_16x16x32_bf16 v[32:35], v[48:51], v[100:103], v[32:35]
    ds_read_b64_tr_b16 v[46:47], v78 offset:10496
    buffer_load_dwordx4 v[92:95], v225, s[40:43], s71 offen offset:0 sc1
    s_waitcnt vmcnt(14) lgkmcnt(12)
    v_mfma_f32_16x16x32_bf16 v[4:7], v[52:55], v[104:107], v[4:7]
    ds_read_b64_tr_b16 v[48:49], v79 offset:8448
    v_mfma_f32_16x16x32_bf16 v[20:23], v[52:55], v[108:111], v[20:23]
    ds_read_b64_tr_b16 v[50:51], v79 offset:10496
    s_waitcnt lgkmcnt(12)
    v_mfma_f32_16x16x32_bf16 v[8:11], v[56:59], v[104:107], v[8:11]
    ds_read_b64_tr_b16 v[52:53], v76 offset:12544
    v_mfma_f32_16x16x32_bf16 v[24:27], v[56:59], v[108:111], v[24:27]
    ds_read_b64_tr_b16 v[54:55], v76 offset:14592
    buffer_load_dwordx4 v[96:99], v224, s[40:43], s71 offen offset:1024 sc1
    s_waitcnt lgkmcnt(12)
    v_mfma_f32_16x16x32_bf16 v[12:15], v[60:63], v[104:107], v[12:15]
    ds_read_b64_tr_b16 v[56:57], v77 offset:12544
    v_mfma_f32_16x16x32_bf16 v[28:31], v[60:63], v[108:111], v[28:31]
    ds_read_b64_tr_b16 v[58:59], v77 offset:14592
    s_waitcnt lgkmcnt(12)
    v_mfma_f32_16x16x32_bf16 v[16:19], v[64:67], v[104:107], v[16:19]
    ds_read_b64_tr_b16 v[60:61], v78 offset:12544
    v_mfma_f32_16x16x32_bf16 v[32:35], v[64:67], v[108:111], v[32:35]
    ds_read_b64_tr_b16 v[62:63], v78 offset:14592
    buffer_load_dwordx4 v[100:103], v225, s[40:43], s71 offen offset:1024 sc1
    s_waitcnt vmcnt(14) lgkmcnt(12)
    v_mfma_f32_16x16x32_bf16 v[4:7], v[36:39], v[112:115], v[4:7]
    ds_read_b64_tr_b16 v[64:65], v79 offset:12544
    v_mfma_f32_16x16x32_bf16 v[20:23], v[36:39], v[116:119], v[20:23]
    ds_read_b64_tr_b16 v[66:67], v79 offset:14592
    s_waitcnt lgkmcnt(12)
    v_mfma_f32_16x16x32_bf16 v[8:11], v[40:43], v[112:115], v[8:11]
    ds_read_b64_tr_b16 v[36:37], v76 offset:16896
    v_mfma_f32_16x16x32_bf16 v[24:27], v[40:43], v[116:119], v[24:27]
    ds_read_b64_tr_b16 v[38:39], v76 offset:18944
    buffer_load_dwordx4 v[104:107], v224, s[40:43], s71 offen offset:2048 sc1
    s_waitcnt lgkmcnt(12)
    v_mfma_f32_16x16x32_bf16 v[12:15], v[44:47], v[112:115], v[12:15]
    ds_read_b64_tr_b16 v[40:41], v77 offset:16896
    v_mfma_f32_16x16x32_bf16 v[28:31], v[44:47], v[116:119], v[28:31]
    ds_read_b64_tr_b16 v[42:43], v77 offset:18944
    s_waitcnt lgkmcnt(12)
    v_mfma_f32_16x16x32_bf16 v[16:19], v[48:51], v[112:115], v[16:19]
    ds_read_b64_tr_b16 v[44:45], v78 offset:16896
    v_mfma_f32_16x16x32_bf16 v[32:35], v[48:51], v[116:119], v[32:35]
    ds_read_b64_tr_b16 v[46:47], v78 offset:18944
    buffer_load_dwordx4 v[108:111], v225, s[40:43], s71 offen offset:2048 sc1
    s_waitcnt vmcnt(14) lgkmcnt(12)
    v_mfma_f32_16x16x32_bf16 v[4:7], v[52:55], v[120:123], v[4:7]
    ds_read_b64_tr_b16 v[48:49], v79 offset:16896
    v_mfma_f32_16x16x32_bf16 v[20:23], v[52:55], v[124:127], v[20:23]
    ds_read_b64_tr_b16 v[50:51], v79 offset:18944
    s_waitcnt lgkmcnt(12)
    v_mfma_f32_16x16x32_bf16 v[8:11], v[56:59], v[120:123], v[8:11]
    ds_read_b64_tr_b16 v[52:53], v76 offset:20992
    v_mfma_f32_16x16x32_bf16 v[24:27], v[56:59], v[124:127], v[24:27]
    ds_read_b64_tr_b16 v[54:55], v76 offset:23040
    buffer_load_dwordx4 v[112:115], v224, s[40:43], s71 offen offset:3072 sc1
    s_waitcnt lgkmcnt(12)
    v_mfma_f32_16x16x32_bf16 v[12:15], v[60:63], v[120:123], v[12:15]
    ds_read_b64_tr_b16 v[56:57], v77 offset:20992
    v_mfma_f32_16x16x32_bf16 v[28:31], v[60:63], v[124:127], v[28:31]
    ds_read_b64_tr_b16 v[58:59], v77 offset:23040
    s_waitcnt lgkmcnt(12)
    v_mfma_f32_16x16x32_bf16 v[16:19], v[64:67], v[120:123], v[16:19]
    ds_read_b64_tr_b16 v[60:61], v78 offset:20992
    v_mfma_f32_16x16x32_bf16 v[32:35], v[64:67], v[124:127], v[32:35]
    ds_read_b64_tr_b16 v[62:63], v78 offset:23040
    buffer_load_dwordx4 v[116:119], v225, s[40:43], s71 offen offset:3072 sc1
    s_waitcnt vmcnt(14) lgkmcnt(12)
    v_mfma_f32_16x16x32_bf16 v[4:7], v[36:39], v[128:131], v[4:7]
    ds_read_b64_tr_b16 v[64:65], v79 offset:20992
    v_mfma_f32_16x16x32_bf16 v[20:23], v[36:39], v[132:135], v[20:23]
    ds_read_b64_tr_b16 v[66:67], v79 offset:23040
    s_waitcnt lgkmcnt(12)
    v_mfma_f32_16x16x32_bf16 v[8:11], v[40:43], v[128:131], v[8:11]
    ds_read_b64_tr_b16 v[36:37], v76 offset:25344
    v_mfma_f32_16x16x32_bf16 v[24:27], v[40:43], v[132:135], v[24:27]
    ds_read_b64_tr_b16 v[38:39], v76 offset:27392
    s_waitcnt lgkmcnt(12)
    v_mfma_f32_16x16x32_bf16 v[12:15], v[44:47], v[128:131], v[12:15]
    ds_read_b64_tr_b16 v[40:41], v77 offset:25344
    v_mfma_f32_16x16x32_bf16 v[28:31], v[44:47], v[132:135], v[28:31]
    ds_read_b64_tr_b16 v[42:43], v77 offset:27392
    s_waitcnt lgkmcnt(12)
    v_mfma_f32_16x16x32_bf16 v[16:19], v[48:51], v[128:131], v[16:19]
    ds_read_b64_tr_b16 v[44:45], v78 offset:25344
    v_mfma_f32_16x16x32_bf16 v[32:35], v[48:51], v[132:135], v[32:35]
    ds_read_b64_tr_b16 v[46:47], v78 offset:27392
    s_waitcnt vmcnt(12) lgkmcnt(12)
    v_mfma_f32_16x16x32_bf16 v[4:7], v[52:55], v[136:139], v[4:7]
    ds_read_b64_tr_b16 v[48:49], v79 offset:25344
    v_mfma_f32_16x16x32_bf16 v[20:23], v[52:55], v[140:143], v[20:23]
    ds_read_b64_tr_b16 v[50:51], v79 offset:27392
    s_waitcnt lgkmcnt(12)
    v_mfma_f32_16x16x32_bf16 v[8:11], v[56:59], v[136:139], v[8:11]
    ds_read_b64_tr_b16 v[52:53], v76 offset:29440
    v_mfma_f32_16x16x32_bf16 v[24:27], v[56:59], v[140:143], v[24:27]
    ds_read_b64_tr_b16 v[54:55], v76 offset:31488
    s_waitcnt lgkmcnt(12)
    v_mfma_f32_16x16x32_bf16 v[12:15], v[60:63], v[136:139], v[12:15]
    ds_read_b64_tr_b16 v[56:57], v77 offset:29440
    v_mfma_f32_16x16x32_bf16 v[28:31], v[60:63], v[140:143], v[28:31]
    ds_read_b64_tr_b16 v[58:59], v77 offset:31488
    s_waitcnt lgkmcnt(12)
    v_mfma_f32_16x16x32_bf16 v[16:19], v[64:67], v[136:139], v[16:19]
    ds_read_b64_tr_b16 v[60:61], v78 offset:29440
    v_mfma_f32_16x16x32_bf16 v[32:35], v[64:67], v[140:143], v[32:35]
    ds_read_b64_tr_b16 v[62:63], v78 offset:31488
    s_waitcnt vmcnt(10) lgkmcnt(12)
    v_mfma_f32_16x16x32_bf16 v[4:7], v[36:39], v[144:147], v[4:7]
    ds_read_b64_tr_b16 v[64:65], v79 offset:29440
    v_mfma_f32_16x16x32_bf16 v[20:23], v[36:39], v[148:151], v[20:23]
    ds_read_b64_tr_b16 v[66:67], v79 offset:31488
    s_waitcnt lgkmcnt(12)
    v_mfma_f32_16x16x32_bf16 v[8:11], v[40:43], v[144:147], v[8:11]
    ds_read_b64_tr_b16 v[36:37], v68 offset:41984
    v_mfma_f32_16x16x32_bf16 v[24:27], v[40:43], v[148:151], v[24:27]
    ds_read_b64_tr_b16 v[38:39], v68 offset:44032
    s_waitcnt lgkmcnt(12)
    v_mfma_f32_16x16x32_bf16 v[12:15], v[44:47], v[144:147], v[12:15]
    ds_read_b64_tr_b16 v[40:41], v69 offset:41984
    v_mfma_f32_16x16x32_bf16 v[28:31], v[44:47], v[148:151], v[28:31]
    ds_read_b64_tr_b16 v[42:43], v69 offset:44032
    s_waitcnt lgkmcnt(12)
    v_mfma_f32_16x16x32_bf16 v[16:19], v[48:51], v[144:147], v[16:19]
    ds_read_b64_tr_b16 v[44:45], v70 offset:41984
    v_mfma_f32_16x16x32_bf16 v[32:35], v[48:51], v[148:151], v[32:35]
    ds_read_b64_tr_b16 v[46:47], v70 offset:44032
    s_waitcnt vmcnt(8) lgkmcnt(12)
    v_mfma_f32_16x16x32_bf16 v[4:7], v[52:55], v[80:83], v[4:7]
    ds_read_b64_tr_b16 v[48:49], v71 offset:41984
    v_mfma_f32_16x16x32_bf16 v[20:23], v[52:55], v[84:87], v[20:23]
    ds_read_b64_tr_b16 v[50:51], v71 offset:44032
    s_waitcnt lgkmcnt(12)
    v_mfma_f32_16x16x32_bf16 v[8:11], v[56:59], v[80:83], v[8:11]
    ds_read_b64_tr_b16 v[52:53], v68 offset:46080
    v_mfma_f32_16x16x32_bf16 v[24:27], v[56:59], v[84:87], v[24:27]
    ds_read_b64_tr_b16 v[54:55], v68 offset:48128
    s_waitcnt lgkmcnt(12)
    v_mfma_f32_16x16x32_bf16 v[12:15], v[60:63], v[80:83], v[12:15]
    ds_read_b64_tr_b16 v[56:57], v69 offset:46080
    v_mfma_f32_16x16x32_bf16 v[28:31], v[60:63], v[84:87], v[28:31]
    ds_read_b64_tr_b16 v[58:59], v69 offset:48128
    s_waitcnt lgkmcnt(12)
    v_mfma_f32_16x16x32_bf16 v[16:19], v[64:67], v[80:83], v[16:19]
    ds_read_b64_tr_b16 v[60:61], v70 offset:46080
    v_mfma_f32_16x16x32_bf16 v[32:35], v[64:67], v[84:87], v[32:35]
    ds_read_b64_tr_b16 v[62:63], v70 offset:48128
    s_waitcnt vmcnt(6) lgkmcnt(12)
    v_mfma_f32_16x16x32_bf16 v[4:7], v[36:39], v[88:91], v[4:7]
    ds_read_b64_tr_b16 v[64:65], v71 offset:46080
    v_mfma_f32_16x16x32_bf16 v[20:23], v[36:39], v[92:95], v[20:23]
    ds_read_b64_tr_b16 v[66:67], v71 offset:48128
    s_waitcnt lgkmcnt(12)
    v_mfma_f32_16x16x32_bf16 v[8:11], v[40:43], v[88:91], v[8:11]
    ds_read_b64_tr_b16 v[36:37], v68 offset:51200
    v_mfma_f32_16x16x32_bf16 v[24:27], v[40:43], v[92:95], v[24:27]
    ds_read_b64_tr_b16 v[38:39], v68 offset:53248
    s_waitcnt lgkmcnt(12)
    v_mfma_f32_16x16x32_bf16 v[12:15], v[44:47], v[88:91], v[12:15]
    ds_read_b64_tr_b16 v[40:41], v69 offset:51200
    v_mfma_f32_16x16x32_bf16 v[28:31], v[44:47], v[92:95], v[28:31]
    ds_read_b64_tr_b16 v[42:43], v69 offset:53248
    s_waitcnt lgkmcnt(12)
    v_mfma_f32_16x16x32_bf16 v[16:19], v[48:51], v[88:91], v[16:19]
    ds_read_b64_tr_b16 v[44:45], v70 offset:51200
    v_mfma_f32_16x16x32_bf16 v[32:35], v[48:51], v[92:95], v[32:35]
    ds_read_b64_tr_b16 v[46:47], v70 offset:53248
    s_waitcnt vmcnt(4) lgkmcnt(12)
    v_mfma_f32_16x16x32_bf16 v[4:7], v[52:55], v[96:99], v[4:7]
    ds_read_b64_tr_b16 v[48:49], v71 offset:51200
    v_mfma_f32_16x16x32_bf16 v[20:23], v[52:55], v[100:103], v[20:23]
    ds_read_b64_tr_b16 v[50:51], v71 offset:53248
    s_waitcnt lgkmcnt(12)
    v_mfma_f32_16x16x32_bf16 v[8:11], v[56:59], v[96:99], v[8:11]
    ds_read_b64_tr_b16 v[52:53], v68 offset:55296
    v_mfma_f32_16x16x32_bf16 v[24:27], v[56:59], v[100:103], v[24:27]
    ds_read_b64_tr_b16 v[54:55], v68 offset:57344
    s_waitcnt lgkmcnt(12)
    v_mfma_f32_16x16x32_bf16 v[12:15], v[60:63], v[96:99], v[12:15]
    ds_read_b64_tr_b16 v[56:57], v69 offset:55296
    v_mfma_f32_16x16x32_bf16 v[28:31], v[60:63], v[100:103], v[28:31]
    ds_read_b64_tr_b16 v[58:59], v69 offset:57344
    s_waitcnt lgkmcnt(12)
    v_mfma_f32_16x16x32_bf16 v[16:19], v[64:67], v[96:99], v[16:19]
    ds_read_b64_tr_b16 v[60:61], v70 offset:55296
    v_mfma_f32_16x16x32_bf16 v[32:35], v[64:67], v[100:103], v[32:35]
    ds_read_b64_tr_b16 v[62:63], v70 offset:57344
    s_waitcnt vmcnt(2) lgkmcnt(12)
    v_mfma_f32_16x16x32_bf16 v[4:7], v[36:39], v[104:107], v[4:7]
    ds_read_b64_tr_b16 v[64:65], v71 offset:55296
    v_mfma_f32_16x16x32_bf16 v[20:23], v[36:39], v[108:111], v[20:23]
    ds_read_b64_tr_b16 v[66:67], v71 offset:57344
    s_waitcnt lgkmcnt(12)
    v_mfma_f32_16x16x32_bf16 v[8:11], v[40:43], v[104:107], v[8:11]
    v_mfma_f32_16x16x32_bf16 v[24:27], v[40:43], v[108:111], v[24:27]
    s_waitcnt lgkmcnt(10)
    v_mfma_f32_16x16x32_bf16 v[12:15], v[44:47], v[104:107], v[12:15]
    v_mfma_f32_16x16x32_bf16 v[28:31], v[44:47], v[108:111], v[28:31]
    s_waitcnt lgkmcnt(8)
    v_mfma_f32_16x16x32_bf16 v[16:19], v[48:51], v[104:107], v[16:19]
    v_mfma_f32_16x16x32_bf16 v[32:35], v[48:51], v[108:111], v[32:35]
    s_waitcnt vmcnt(0) lgkmcnt(6)
    v_mfma_f32_16x16x32_bf16 v[4:7], v[52:55], v[112:115], v[4:7]
    v_mfma_f32_16x16x32_bf16 v[20:23], v[52:55], v[116:119], v[20:23]
    s_waitcnt lgkmcnt(4)
    v_mfma_f32_16x16x32_bf16 v[8:11], v[56:59], v[112:115], v[8:11]
    v_mfma_f32_16x16x32_bf16 v[24:27], v[56:59], v[116:119], v[24:27]
    s_waitcnt lgkmcnt(2)
    v_mfma_f32_16x16x32_bf16 v[12:15], v[60:63], v[112:115], v[12:15]
    v_mfma_f32_16x16x32_bf16 v[28:31], v[60:63], v[116:119], v[28:31]
    s_waitcnt lgkmcnt(0)
    v_mfma_f32_16x16x32_bf16 v[16:19], v[64:67], v[112:115], v[16:19]
    v_mfma_f32_16x16x32_bf16 v[32:35], v[64:67], v[116:119], v[32:35]
    s_mov_b32 s37, 131072
    v_cvt_pk_bf16_f32 v36, v4, v5
    v_cvt_pk_bf16_f32 v37, v6, v7
    v_cvt_pk_bf16_f32 v38, v8, v9
    v_cvt_pk_bf16_f32 v39, v10, v11
    v_cvt_pk_bf16_f32 v44, v20, v21
    v_cvt_pk_bf16_f32 v45, v22, v23
    v_cvt_pk_bf16_f32 v46, v24, v25
    v_cvt_pk_bf16_f32 v47, v26, v27
    v_permlane16_swap_b32 v36, v38
    v_permlane16_swap_b32 v37, v39
    v_permlane16_swap_b32 v44, v46
    v_permlane16_swap_b32 v45, v47
    buffer_store_dwordx4 v[36:39], v226, s[48:51], 0 offen offset:0
    buffer_store_dwordx4 v[44:47], v226, s[48:51], s37 offen offset:0
    v_cvt_pk_bf16_f32 v40, v12, v13
    v_cvt_pk_bf16_f32 v41, v14, v15
    v_cvt_pk_bf16_f32 v42, v16, v17
    v_cvt_pk_bf16_f32 v43, v18, v19
    v_cvt_pk_bf16_f32 v48, v28, v29
    v_cvt_pk_bf16_f32 v49, v30, v31
    v_cvt_pk_bf16_f32 v50, v32, v33
    v_cvt_pk_bf16_f32 v51, v34, v35
    v_permlane16_swap_b32 v40, v42
    v_permlane16_swap_b32 v41, v43
    v_permlane16_swap_b32 v48, v50
    v_permlane16_swap_b32 v49, v51
    buffer_store_dwordx4 v[40:43], v226, s[48:51], 0 offen offset:64
    buffer_store_dwordx4 v[48:51], v226, s[48:51], s37 offen offset:64
    s_endpgm
L_g1_rare:
    s_waitcnt vmcnt(0)
    s_cmp_lg_u32 s36, 1
    s_cbranch_scc1 L_g1_bar
    v_readfirstlane_b32 s38, v1
    s_nop 0
    s_cmp_ge_u32 s38, 4
    s_cbranch_scc1 L_sl_done_48
    s_mov_b32 s39, 1048576
L_sl_loop_49:
    ds_read_b32 v1, v228 offset:24
    s_waitcnt lgkmcnt(0)
    v_readfirstlane_b32 s38, v1
    s_nop 0
    s_cmp_ge_u32 s38, 4
    s_cbranch_scc1 L_sl_done_48
    s_sleep 1
    s_sub_u32 s39, s39, 1
    s_cbranch_scc0 L_sl_loop_49
L_sl_done_48:
    s_branch L_g1_nobar
L_end:
    s_endpgm
.section .rodata,"a"
.p2align 6
.amdhsa_kernel concat_heads__ssm_conv_h3__sliding_local_dilated__prompt_kernel
  .amdhsa_next_free_vgpr 256
  .amdhsa_next_free_sgpr 102
  .amdhsa_accum_offset 256
  .amdhsa_group_segment_fixed_size 0
  .amdhsa_kernarg_size 96
  .amdhsa_user_sgpr_count 2
  .amdhsa_user_sgpr_kernarg_segment_ptr 1
  .amdhsa_system_sgpr_workgroup_id_x 1
  .amdhsa_float_denorm_mode_32 3
.end_amdhsa_kernel
```

```asm
; @launch grid=(256,1,1) block=(512,1,1) lds=163840
.amdgcn_target "amdgcn-amd-amdhsa--gfx950"
.text
.globl concat_heads__ssm_conv_h3__sliding_local_dilated__prompt_kernel
.p2align 8
.type concat_heads__ssm_conv_h3__sliding_local_dilated__prompt_kernel,@function
concat_heads__ssm_conv_h3__sliding_local_dilated__prompt_kernel:
L_entry:
    s_getpc_b64 s[32:33]
    s_cmp_ge_u32 s2, 256
    s_cbranch_scc1 L_end
    s_load_dwordx16 s[8:23], s[0:1], 0
    s_load_dwordx8 s[24:31], s[0:1], 64
    v_lshrrev_b32 v1, 6, v0
    s_and_b32 s4, s2, 1
    v_readfirstlane_b32 s3, v1
    v_and_b32 v0, 63, v0
    s_bfe_u32 s5, s2, 0x30003
    s_bfe_u32 s6, s2, 0x20001
    s_lshr_b32 s7, s2, 6
    s_lshl2_add_u32 s6, s6, s7
    s_cmp_ge_u32 s3, 4
    s_cbranch_scc1 L_crole
    s_bfe_u32 s34, s2, 0x20003
    s_lshl2_add_u32 s34, s34, s3
    s_lshl_b32 s34, s34, 7
    v_lshl_add_u32 v1, v0, 11, s34
    v_min_u32 v1, L_end-L_entry-8, v1
    s_mov_b64 exec, 0xffff
    global_load_dword v249, v1, s[32:33]
    s_mov_b64 exec, -1
    s_and_b32 s84, s2, 7
    s_lshr_b32 s87, s3, 1
    s_lshl1_add_u32 s84, s84, s87
    s_lshr_b32 s85, s2, 3
    s_and_b32 s87, s3, 1
    s_lshl1_add_u32 s85, s85, s87
    s_mul_i32 s86, s3, 4736
    s_add_u32 s86, s86, 83968
    s_lshl_b32 s87, s85, 9
    s_add_u32 s87, s87, s84
    s_lshl_b32 s87, s87, 7
    v_and_b32 v231, 7, v0
    v_lshl_add_u32 v231, v231, 4, s87
    v_lshrrev_b32 v230, 3, v0
    v_lshl_add_u32 v230, v230, 13, v231
    v_subrev_u32 v231, 6144, v230
    v_subrev_u32 v232, 4096, v230
    v_subrev_u32 v233, 2048, v230
    v_add_u32 v234, 4096, v230
    v_lshlrev_b32 v235, 4, v0
    s_lshl_b32 s87, s84, 9
    s_add_u32 m0, s86, 4224
    s_lshr_b32 s90, s2, 3
    s_and_b32 s91, s3, 3
    s_lshl2_add_u32 s90, s90, s91
    s_and_b32 s91, s2, 6
    s_lshl3_add_u32 s88, s90, s91
    s_lshl1_add_u32 s88, s88, s4
    s_lshl_b32 s88, s88, 11
    s_and_b32 s89, s2, 7
    s_and_b32 s91, s90, 1
    s_lshl1_add_u32 s89, s89, s91
    s_lshr_b32 s90, s90, 1
    s_mul_i32 s90, s90, 48
    s_add_u32 s89, s89, s90
    s_lshl_b32 s89, s89, 7
    v_and_b32 v251, 1, v0
    v_lshlrev_b32 v251, 12, v251
    v_lshrrev_b32 v252, 1, v0
    v_lshl_add_u32 v251, v252, 7, v251
    v_lshrrev_b32 v250, 2, v0
    v_mul_u32_u24 v250, 393216, v250
    v_and_b32 v252, 3, v0
    v_lshl_add_u32 v252, v252, 11, v250
    s_or_b32 s7, s2, s3
    s_waitcnt lgkmcnt(0)
    s_add_u32 s52, s30, 0xe00000
    s_addc_u32 s53, s31, 0
    s_mov_b32 s54, 0x4000
    s_mov_b32 s55, 0x20000
    s_cmp_lg_u32 s7, 0
    s_cbranch_scc1 L_noinit
    v_lshlrev_b32 v1, 8, v0
    v_mov_b32 v2, 0
    buffer_store_dword v2, v1, s[52:55], 0 offen sc1
L_noinit:
    s_mov_b32 s80, s14
    s_mov_b32 s81, s15
    s_mov_b32 s82, 0x2000
    s_mov_b32 s83, 0x20000
    s_mov_b32 s72, s10
    s_mov_b32 s73, s11
    s_mov_b32 s74, 0x400000
    s_mov_b32 s75, 0x20000
    s_mov_b32 exec_hi, 0
    buffer_load_dwordx4 v235, s[80:83], s87 offen lds
    s_mov_b64 exec, -1
    buffer_load_dwordx4 v[108:111], v231, s[72:75], 0 offen offset:0 nt
    buffer_load_dwordx4 v[112:115], v232, s[72:75], 0 offen offset:0 nt
    buffer_load_dwordx4 v[116:119], v233, s[72:75], 0 offen offset:0 nt
    buffer_load_dwordx4 v[120:123], v230, s[72:75], 0 offen offset:0 nt
    buffer_load_dwordx4 v[124:127], v230, s[72:75], 0 offen offset:2048 nt
    buffer_load_dwordx4 v[128:131], v234, s[72:75], 0 offen offset:0 nt
    buffer_load_dwordx4 v[132:135], v234, s[72:75], 0 offen offset:2048 nt
    s_mov_b32 s76, s12
    s_mov_b32 s77, s13
    s_mov_b32 s78, 0x400000
    s_mov_b32 s79, 0x20000
    buffer_load_dwordx4 v[136:139], v230, s[76:79], 0 offen offset:0 nt
    buffer_load_dwordx4 v[140:143], v230, s[76:79], 0 offen offset:2048 nt
    buffer_load_dwordx4 v[144:147], v234, s[76:79], 0 offen offset:0 nt
    buffer_load_dwordx4 v[148:151], v234, s[76:79], 0 offen offset:2048 nt
    s_mov_b32 s64, s20
    s_mov_b32 s65, s21
    s_mov_b32 s66, 0x400000
    s_mov_b32 s67, 0x20000
    s_mov_b32 s68, s22
    s_mov_b32 s69, s23
    s_mov_b32 s70, 0x600000
    s_mov_b32 s71, 0x20000
    s_mov_b32 exec_lo, 0x777777
    s_mov_b32 exec_hi, 0x0
    buffer_load_dword v250, v252, s[68:71], s89 offen
    s_xor_b32 s89, s89, 256
    buffer_load_dword v250, v252, s[68:71], s89 offen
    s_xor_b32 s89, s89, 256
    s_mov_b32 exec_lo, 0xfff
    s_mov_b32 exec_hi, 0
    buffer_load_dword v250, v251, s[64:67], s88 offen
    s_mov_b64 exec, -1
    s_barrier
    s_branch L_grole
L_crole:
    s_sub_u32 s70, s3, 4
    s_lshl_b32 s43, s70, 12
    s_lshl_b32 s44, s70, 11
    s_add_u32 s44, s44, 17408
    s_lshl_b32 s49, s70, 4
    s_lshl_b64 s[46:47], 0xffff, s49
    v_lshrrev_b32 v13, 3, v0
    v_and_b32 v14, 7, v0
    v_lshrrev_b32 v15, 4, v0
    s_lshl2_add_u32 s50, s5, s70
    s_lshl_b32 s50, s50, 6
    s_add_u32 s50, s50, s4
    s_lshl_b32 s50, s50, 11
    v_lshl_add_u32 v16, v13, 12, s50
    v_xor_b32 v17, v14, v15
    v_lshl_add_u32 v2, v17, 4, v16
    v_xor_b32 v3, 64, v2
    v_add_u32 v3, 31744, v3
    v_add_u32 v4, 63488, v2
    v_add_u32 v5, 63488, v3
    s_lshl_b32 s49, s5, 7
    s_sub_u32 s49, s49, 8
    s_max_i32 s49, s49, 0
    s_lshl1_add_u32 s49, s49, s4
    s_lshl_b32 s49, s49, 11
    v_lshl_add_u32 v16, v13, 12, s49
    v_lshlrev_b32 v17, 1, v15
    v_xor_b32 v18, v14, v17
    v_lshl_add_u32 v6, v18, 4, v16
    s_mul_i32 s49, s70, 768
    s_add_u32 s49, s49, s6
    s_lshl_b32 s49, s49, 7
    v_mul_u32_u24 v16, 6144, v13
    v_and_b32 v17, 2, v17
    v_xor_b32 v17, v14, v17
    v_lshlrev_b32 v17, 4, v17
    v_add3_u32 v7, v17, v16, s49
    v_xor_b32 v8, 64, v7
    v_add_u32 v8, 48128, v8
    v_add_u32 v9, 2048, v7
    v_add_u32 v10, 2048, v8
    v_add_u32 v11, 4096, v7
    v_add_u32 v12, 4096, v8
    s_mov_b32 s40, 0
    s_mov_b32 s41, 0
    s_waitcnt lgkmcnt(0)
    s_mov_b32 s32, s20
    s_mov_b32 s33, s21
    s_mov_b32 s34, 0x400000
    s_mov_b32 s35, 0x20000
    s_mov_b32 s36, s22
    s_mov_b32 s37, s23
    s_mov_b32 s38, 0x600000
    s_mov_b32 s39, 0x20000
    s_setprio 0
    s_and_b32 s73, s2, 7
    s_lshr_b32 s74, s2, 7
    s_lshl1_add_u32 s68, s73, s74
    s_lshl_b32 s73, s73, 8
    s_bfe_u32 s69, s2, 0x40003
    s_lshl4_add_u32 s71, s68, s69
    s_lshl2_add_u32 s71, s71, s70
    s_mul_i32 s80, s70, 8448
    s_add_u32 s80, s80, 125952
    s_mul_i32 s81, s70, 9216
    s_add_u32 s81, s81, 41984
    s_add_u32 s52, s30, 0xe00000
    s_addc_u32 s53, s31, 0
    s_mov_b32 s54, 0x4000
    s_mov_b32 s55, 0x20000
    s_add_u32 s64, s30, 0x900000
    s_addc_u32 s65, s31, 0
    s_mov_b32 s66, 0x420000
    s_mov_b32 s67, 0x20000
    s_lshl_b32 s84, s71, 12
    s_mul_i32 s85, s71, 4224
    s_add_u32 s85, s85, 4194304
    s_lshr_b32 s74, s71, 1
    s_lshl_b32 s74, s74, 2
    s_load_dword s72, s[18:19], s74
    v_lshlrev_b32 v224, 4, v0
    v_mov_b32 v228, 0
    v_mov_b32 v229, 0
    v_mov_b32 v230, 0
    v_mov_b32 v231, 0
    v_mov_b32 v227, 134352
    v_mov_b32 v244, 1
    s_bfe_u32 s87, s2, 0x10003
    s_mov_b64 exec, 1
    ds_write_b128 v227, v[228:231]
    ds_write_b128 v227, v[228:231] offset:16
    s_mov_b64 exec, -1
    s_lshr_b32 s90, s2, 3
    s_and_b32 s91, s3, 3
    s_lshl2_add_u32 s90, s90, s91
    s_and_b32 s91, s2, 6
    s_lshl3_add_u32 s88, s90, s91
    s_lshl1_add_u32 s88, s88, s4
    s_lshl_b32 s88, s88, 11
    s_and_b32 s89, s2, 7
    s_and_b32 s91, s90, 1
    s_lshl1_add_u32 s89, s89, s91
    s_lshr_b32 s90, s90, 1
    s_mul_i32 s90, s90, 48
    s_add_u32 s89, s89, s90
    s_lshl_b32 s89, s89, 7
    v_and_b32 v251, 1, v0
    v_lshlrev_b32 v251, 12, v251
    v_lshrrev_b32 v252, 1, v0
    v_lshl_add_u32 v251, v252, 7, v251
    v_lshrrev_b32 v250, 2, v0
    v_mul_u32_u24 v250, 393216, v250
    v_and_b32 v252, 3, v0
    v_lshl_add_u32 v252, v252, 11, v250
    s_barrier
    s_add_u32 m0, s43, 0
    s_nop 0
    buffer_load_dwordx4 v2, s[32:35], s40 offen offset:0 lds
    s_add_u32 m0, s44, 0
    s_nop 0
    buffer_load_dwordx4 v7, s[36:39], s41 offen offset:0 lds
    buffer_load_dwordx4 v8, s[36:39], s41 offen offset:1024 lds
    s_add_u32 m0, s43, 0
    s_nop 0
    buffer_load_dwordx4 v3, s[32:35], s40 offen offset:1024 lds
    s_add_u32 m0, s44, 8192
    s_nop 0
    buffer_load_dwordx4 v9, s[36:39], s41 offen offset:0 lds
    buffer_load_dwordx4 v10, s[36:39], s41 offen offset:1024 lds
    s_add_u32 m0, s43, 0
    s_nop 0
    buffer_load_dwordx4 v4, s[32:35], s40 offen offset:2048 lds
    s_add_u32 m0, s44, 16384
    s_nop 0
    buffer_load_dwordx4 v11, s[36:39], s41 offen offset:0 lds
    buffer_load_dwordx4 v12, s[36:39], s41 offen offset:1024 lds
    s_add_u32 m0, s43, 0
    s_nop 0
    buffer_load_dwordx4 v5, s[32:35], s40 offen offset:3072 lds
    s_mov_b32 m0, 16384
    s_mov_b64 exec, s[46:47]
    buffer_load_dwordx4 v6, s[32:35], s40 offen lds
    s_mov_b64 exec, -1
    s_movk_i32 s40, 128
    s_mov_b32 s41, 393216
    s_add_u32 m0, s43, 41984
    s_nop 0
    buffer_load_dwordx4 v2, s[32:35], s40 offen offset:0 lds
    s_add_u32 m0, s44, 41984
    s_nop 0
    buffer_load_dwordx4 v7, s[36:39], s41 offen offset:0 lds
    buffer_load_dwordx4 v8, s[36:39], s41 offen offset:1024 lds
    s_add_u32 m0, s43, 41984
    s_nop 0
    buffer_load_dwordx4 v3, s[32:35], s40 offen offset:1024 lds
    s_add_u32 m0, s44, 50176
    s_nop 0
    buffer_load_dwordx4 v9, s[36:39], s41 offen offset:0 lds
    buffer_load_dwordx4 v10, s[36:39], s41 offen offset:1024 lds
    s_add_u32 m0, s43, 41984
    s_nop 0
    buffer_load_dwordx4 v4, s[32:35], s40 offen offset:2048 lds
    s_add_u32 m0, s44, 58368
    s_nop 0
    buffer_load_dwordx4 v11, s[36:39], s41 offen offset:0 lds
    buffer_load_dwordx4 v12, s[36:39], s41 offen offset:1024 lds
    s_add_u32 m0, s43, 41984
    s_nop 0
    buffer_load_dwordx4 v5, s[32:35], s40 offen offset:3072 lds
    s_mov_b32 m0, 58368
    s_mov_b64 exec, s[46:47]
    buffer_load_dwordx4 v6, s[32:35], s40 offen lds
    s_mov_b64 exec, -1
    s_movk_i32 s40, 256
    s_mov_b32 s41, 786432
    s_waitcnt vmcnt(11)
    s_barrier
    s_add_u32 m0, s43, 83968
    s_nop 0
    buffer_load_dwordx4 v2, s[32:35], s40 offen offset:0 lds
    s_add_u32 m0, s44, 83968
    s_nop 0
    buffer_load_dwordx4 v7, s[36:39], s41 offen offset:0 lds
    buffer_load_dwordx4 v8, s[36:39], s41 offen offset:1024 lds
    s_add_u32 m0, s43, 83968
    s_nop 0
    buffer_load_dwordx4 v3, s[32:35], s40 offen offset:1024 lds
    s_add_u32 m0, s44, 92160
    s_nop 0
    buffer_load_dwordx4 v9, s[36:39], s41 offen offset:0 lds
    buffer_load_dwordx4 v10, s[36:39], s41 offen offset:1024 lds
    s_add_u32 m0, s43, 83968
    s_nop 0
    buffer_load_dwordx4 v4, s[32:35], s40 offen offset:2048 lds
    s_add_u32 m0, s44, 100352
    s_nop 0
    buffer_load_dwordx4 v11, s[36:39], s41 offen offset:0 lds
    buffer_load_dwordx4 v12, s[36:39], s41 offen offset:1024 lds
    s_add_u32 m0, s43, 83968
    s_nop 0
    buffer_load_dwordx4 v5, s[32:35], s40 offen offset:3072 lds
    s_mov_b32 m0, 100352
    s_mov_b64 exec, s[46:47]
    buffer_load_dwordx4 v6, s[32:35], s40 offen lds
    s_mov_b64 exec, -1
    s_movk_i32 s40, 384
    s_mov_b32 s41, 1179648
    s_waitcnt vmcnt(11)
    s_barrier
    s_cmp_lg_u32 s87, 0
    s_cbranch_scc1 L_stg_3
    s_mov_b32 exec_lo, 0x77000000
    s_mov_b32 exec_hi, 0x777
    buffer_load_dword v250, v252, s[36:39], s89 offen
    s_xor_b32 s89, s89, 256
    buffer_load_dword v250, v252, s[36:39], s89 offen
    s_xor_b32 s89, s89, 256
    s_mov_b32 exec_lo, 0x3ff000
    s_mov_b32 exec_hi, 0
    buffer_load_dword v250, v251, s[32:35], s88 offen
    s_mov_b64 exec, -1
L_stg_3:
    s_add_u32 m0, s43, 0
    s_nop 0
    buffer_load_dwordx4 v2, s[32:35], s40 offen offset:0 lds
    s_add_u32 m0, s44, 0
    s_nop 0
    buffer_load_dwordx4 v7, s[36:39], s41 offen offset:0 lds
    buffer_load_dwordx4 v8, s[36:39], s41 offen offset:1024 lds
    s_add_u32 m0, s43, 0
    s_nop 0
    buffer_load_dwordx4 v3, s[32:35], s40 offen offset:1024 lds
    s_add_u32 m0, s44, 8192
    s_nop 0
    buffer_load_dwordx4 v9, s[36:39], s41 offen offset:0 lds
    buffer_load_dwordx4 v10, s[36:39], s41 offen offset:1024 lds
    s_add_u32 m0, s43, 0
    s_nop 0
    buffer_load_dwordx4 v4, s[32:35], s40 offen offset:2048 lds
    s_add_u32 m0, s44, 16384
    s_nop 0
    buffer_load_dwordx4 v11, s[36:39], s41 offen offset:0 lds
    buffer_load_dwordx4 v12, s[36:39], s41 offen offset:1024 lds
    s_add_u32 m0, s43, 0
    s_nop 0
    buffer_load_dwordx4 v5, s[32:35], s40 offen offset:3072 lds
    s_mov_b32 m0, 16384
    s_mov_b64 exec, s[46:47]
    buffer_load_dwordx4 v6, s[32:35], s40 offen lds
    s_mov_b64 exec, -1
    s_movk_i32 s40, 512
    s_mov_b32 s41, 1572864
    s_waitcnt vmcnt(14)
    s_bitcmp1_b32 1, s87
    s_cbranch_scc1 L_mw_4
    s_waitcnt vmcnt(11)
L_mw_4:
    s_barrier
    s_cmp_lg_u32 s87, 1
    s_cbranch_scc1 L_stg_5
    s_mov_b32 exec_lo, 0x77000000
    s_mov_b32 exec_hi, 0x777
    buffer_load_dword v250, v252, s[36:39], s89 offen
    s_xor_b32 s89, s89, 256
    buffer_load_dword v250, v252, s[36:39], s89 offen
    s_xor_b32 s89, s89, 256
    s_mov_b32 exec_lo, 0x3ff000
    s_mov_b32 exec_hi, 0
    buffer_load_dword v250, v251, s[32:35], s88 offen
    s_mov_b64 exec, -1
L_stg_5:
    s_add_u32 m0, s43, 41984
    s_nop 0
    buffer_load_dwordx4 v2, s[32:35], s40 offen offset:0 lds
    s_add_u32 m0, s44, 41984
    s_nop 0
    buffer_load_dwordx4 v7, s[36:39], s41 offen offset:0 lds
    buffer_load_dwordx4 v8, s[36:39], s41 offen offset:1024 lds
    s_add_u32 m0, s43, 41984
    s_nop 0
    buffer_load_dwordx4 v3, s[32:35], s40 offen offset:1024 lds
    s_add_u32 m0, s44, 50176
    s_nop 0
    buffer_load_dwordx4 v9, s[36:39], s41 offen offset:0 lds
    buffer_load_dwordx4 v10, s[36:39], s41 offen offset:1024 lds
    s_add_u32 m0, s43, 41984
    s_nop 0
    buffer_load_dwordx4 v4, s[32:35], s40 offen offset:2048 lds
    s_add_u32 m0, s44, 58368
    s_nop 0
    buffer_load_dwordx4 v11, s[36:39], s41 offen offset:0 lds
    buffer_load_dwordx4 v12, s[36:39], s41 offen offset:1024 lds
    s_add_u32 m0, s43, 41984
    s_nop 0
    buffer_load_dwordx4 v5, s[32:35], s40 offen offset:3072 lds
    s_mov_b32 m0, 58368
    s_mov_b64 exec, s[46:47]
    buffer_load_dwordx4 v6, s[32:35], s40 offen lds
    s_mov_b64 exec, -1
    s_movk_i32 s40, 640
    s_mov_b32 s41, 1966080
    s_waitcnt vmcnt(14)
    s_bitcmp1_b32 2, s87
    s_cbranch_scc1 L_mw_6
    s_waitcnt vmcnt(11)
L_mw_6:
    s_barrier
    s_load_dword s78, s[28:29], 0
    s_add_u32 m0, s43, 83968
    s_nop 0
    buffer_load_dwordx4 v2, s[32:35], s40 offen offset:0 lds
    s_add_u32 m0, s44, 83968
    s_nop 0
    buffer_load_dwordx4 v7, s[36:39], s41 offen offset:0 lds
    buffer_load_dwordx4 v8, s[36:39], s41 offen offset:1024 lds
    s_add_u32 m0, s43, 83968
    s_nop 0
    buffer_load_dwordx4 v3, s[32:35], s40 offen offset:1024 lds
    s_add_u32 m0, s44, 92160
    s_nop 0
    buffer_load_dwordx4 v9, s[36:39], s41 offen offset:0 lds
    buffer_load_dwordx4 v10, s[36:39], s41 offen offset:1024 lds
    s_add_u32 m0, s43, 83968
    s_nop 0
    buffer_load_dwordx4 v4, s[32:35], s40 offen offset:2048 lds
    s_add_u32 m0, s44, 100352
    s_nop 0
    buffer_load_dwordx4 v11, s[36:39], s41 offen offset:0 lds
    buffer_load_dwordx4 v12, s[36:39], s41 offen offset:1024 lds
    s_add_u32 m0, s43, 83968
    s_nop 0
    buffer_load_dwordx4 v5, s[32:35], s40 offen offset:3072 lds
    s_mov_b32 m0, 100352
    s_mov_b64 exec, s[46:47]
    buffer_load_dwordx4 v6, s[32:35], s40 offen lds
    s_mov_b64 exec, -1
    s_movk_i32 s40, 768
    s_mov_b32 s41, 2359296
    v_and_b32 v234, 1, v0
    v_xor_b32 v234, 1, v234
    v_mul_u32_u24 v232, 4224, v234
    v_mul_u32_u24 v233, 4576, v234
    v_bfe_u32 v234, v0, 1, 3
    v_lshl_add_u32 v232, v234, 3, v232
    v_xor_b32 v234, 7, v234
    v_lshl_add_u32 v233, v234, 6, v233
    v_lshrrev_b32 v234, 4, v0
    v_lshl_add_u32 v232, v234, 4, v232
    v_lshl_add_u32 v233, v234, 4, v233
    v_add3_u32 v232, v232, s80, 8
    v_add_u32 v233, s81, v233
    s_waitcnt lgkmcnt(0)
    s_bitcmp1_b32 s71, 0
    s_cselect_b32 s74, 0, 16
    s_lshl_b32 s72, s72, s74
    s_and_b32 s72, s72, 0xffff0000
    v_and_b32 v235, 1, v0
    v_lshlrev_b32 v235, 4, v235
    v_lshrrev_b32 v235, v235, s72
    v_bfe_u32 v236, v0, 1, 3
    v_lshl_add_u32 v236, v234, 1, v236
    v_cmp_eq_u32 vcc, 7, v236
    v_mov_b32 v241, 0
    v_mov_b32 v243, 0
    v_cndmask_b32 v240, 0, v235, vcc
    v_cmp_eq_u32 vcc, 6, v236
    s_nop 1
    v_cndmask_b32 v242, 0, v235, vcc
    s_waitcnt vmcnt(11)
    s_barrier
    s_cmp_lg_u32 s70, 0
    s_cbranch_scc1 L_sig_8
    s_mov_b32 s79, 131072
    s_branch L_sg_chk_11
L_sg_loop_10:
    s_load_dword s78, s[28:29], 0 glc
L_sg_chk_11:
    s_waitcnt lgkmcnt(0)
    s_cmp_ge_u32 s78, 1
    s_cbranch_scc1 L_sg_done_9
    s_sub_u32 s79, s79, 1
    s_cbranch_scc0 L_sg_loop_10
L_sg_done_9:
    s_mov_b64 exec, 1
    buffer_atomic_add v244, off, s[52:55], s73 sc1
    s_mov_b64 exec, -1
L_sig_8:
    s_add_u32 m0, s43, 0
    s_nop 0
    buffer_load_dwordx4 v2, s[32:35], s40 offen offset:0 lds
    s_add_u32 m0, s44, 0
    s_nop 0
    buffer_load_dwordx4 v7, s[36:39], s41 offen offset:0 lds
    buffer_load_dwordx4 v8, s[36:39], s41 offen offset:1024 lds
    s_add_u32 m0, s43, 0
    s_nop 0
    buffer_load_dwordx4 v3, s[32:35], s40 offen offset:1024 lds
    s_add_u32 m0, s44, 8192
    s_nop 0
    buffer_load_dwordx4 v9, s[36:39], s41 offen offset:0 lds
    buffer_load_dwordx4 v10, s[36:39], s41 offen offset:1024 lds
    s_add_u32 m0, s43, 0
    s_nop 0
    buffer_load_dwordx4 v4, s[32:35], s40 offen offset:2048 lds
    s_add_u32 m0, s44, 16384
    s_nop 0
    buffer_load_dwordx4 v11, s[36:39], s41 offen offset:0 lds
    buffer_load_dwordx4 v12, s[36:39], s41 offen offset:1024 lds
    s_add_u32 m0, s43, 0
    s_nop 0
    buffer_load_dwordx4 v5, s[32:35], s40 offen offset:3072 lds
    s_mov_b32 m0, 16384
    s_mov_b64 exec, s[46:47]
    buffer_load_dwordx4 v6, s[32:35], s40 offen lds
    s_mov_b64 exec, -1
    s_movk_i32 s40, 896
    s_mov_b32 s41, 2752512
    s_load_dwordx2 s[90:91], s[16:17], s84 offset:60
    s_load_dwordx2 s[90:91], s[16:17], s84 offset:188
    s_load_dwordx2 s[90:91], s[16:17], s84 offset:316
    s_load_dwordx2 s[90:91], s[16:17], s84 offset:444
    s_waitcnt vmcnt(11)
    s_barrier
    s_cmp_lg_u32 s87, 0
    s_cbranch_scc1 L_stg_13
    s_mov_b32 exec_lo, 0x0
    s_mov_b32 exec_hi, 0x77777000
    buffer_load_dword v250, v252, s[36:39], s89 offen
    s_xor_b32 s89, s89, 256
    buffer_load_dword v250, v252, s[36:39], s89 offen
    s_xor_b32 s89, s89, 256
    s_mov_b32 exec_lo, 0xffc00000
    s_mov_b32 exec_hi, 0
    buffer_load_dword v250, v251, s[32:35], s88 offen
    s_mov_b64 exec, -1
L_stg_13:
    s_add_u32 m0, s43, 41984
    s_nop 0
    buffer_load_dwordx4 v2, s[32:35], s40 offen offset:0 lds
    s_add_u32 m0, s44, 41984
    s_nop 0
    buffer_load_dwordx4 v7, s[36:39], s41 offen offset:0 lds
    buffer_load_dwordx4 v8, s[36:39], s41 offen offset:1024 lds
    s_add_u32 m0, s43, 41984
    s_nop 0
    buffer_load_dwordx4 v3, s[32:35], s40 offen offset:1024 lds
    s_add_u32 m0, s44, 50176
    s_nop 0
    buffer_load_dwordx4 v9, s[36:39], s41 offen offset:0 lds
    buffer_load_dwordx4 v10, s[36:39], s41 offen offset:1024 lds
    s_add_u32 m0, s43, 41984
    s_nop 0
    buffer_load_dwordx4 v4, s[32:35], s40 offen offset:2048 lds
    s_add_u32 m0, s44, 58368
    s_nop 0
    buffer_load_dwordx4 v11, s[36:39], s41 offen offset:0 lds
    buffer_load_dwordx4 v12, s[36:39], s41 offen offset:1024 lds
    s_add_u32 m0, s43, 41984
    s_nop 0
    buffer_load_dwordx4 v5, s[32:35], s40 offen offset:3072 lds
    s_mov_b32 m0, 58368
    s_mov_b64 exec, s[46:47]
    buffer_load_dwordx4 v6, s[32:35], s40 offen lds
    s_mov_b64 exec, -1
    s_movk_i32 s40, 1024
    s_mov_b32 s41, 3145728
    s_load_dwordx2 s[90:91], s[16:17], s84 offset:572
    s_load_dwordx2 s[90:91], s[16:17], s84 offset:700
    s_load_dwordx2 s[90:91], s[16:17], s84 offset:828
    s_load_dwordx2 s[90:91], s[16:17], s84 offset:956
    s_waitcnt vmcnt(14)
    s_bitcmp1_b32 1, s87
    s_cbranch_scc1 L_mw_14
    s_waitcnt vmcnt(11)
L_mw_14:
    s_barrier
    s_cmp_lg_u32 s87, 1
    s_cbranch_scc1 L_stg_15
    s_mov_b32 exec_lo, 0x0
    s_mov_b32 exec_hi, 0x77777000
    buffer_load_dword v250, v252, s[36:39], s89 offen
    s_xor_b32 s89, s89, 256
    buffer_load_dword v250, v252, s[36:39], s89 offen
    s_xor_b32 s89, s89, 256
    s_mov_b32 exec_lo, 0xffc00000
    s_mov_b32 exec_hi, 0
    buffer_load_dword v250, v251, s[32:35], s88 offen
    s_mov_b64 exec, -1
L_stg_15:
    s_add_u32 m0, s43, 83968
    s_nop 0
    buffer_load_dwordx4 v2, s[32:35], s40 offen offset:0 lds
    s_add_u32 m0, s44, 83968
    s_nop 0
    buffer_load_dwordx4 v7, s[36:39], s41 offen offset:0 lds
    buffer_load_dwordx4 v8, s[36:39], s41 offen offset:1024 lds
    s_add_u32 m0, s43, 83968
    s_nop 0
    buffer_load_dwordx4 v3, s[32:35], s40 offen offset:1024 lds
    s_add_u32 m0, s44, 92160
    s_nop 0
    buffer_load_dwordx4 v9, s[36:39], s41 offen offset:0 lds
    buffer_load_dwordx4 v10, s[36:39], s41 offen offset:1024 lds
    s_add_u32 m0, s43, 83968
    s_nop 0
    buffer_load_dwordx4 v4, s[32:35], s40 offen offset:2048 lds
    s_add_u32 m0, s44, 100352
    s_nop 0
    buffer_load_dwordx4 v11, s[36:39], s41 offen offset:0 lds
    buffer_load_dwordx4 v12, s[36:39], s41 offen offset:1024 lds
    s_add_u32 m0, s43, 83968
    s_nop 0
    buffer_load_dwordx4 v5, s[32:35], s40 offen offset:3072 lds
    s_mov_b32 m0, 100352
    s_mov_b64 exec, s[46:47]
    buffer_load_dwordx4 v6, s[32:35], s40 offen lds
    s_mov_b64 exec, -1
    s_movk_i32 s40, 1152
    s_mov_b32 s41, 3538944
    s_load_dwordx2 s[90:91], s[16:17], s84 offset:1084
    s_load_dwordx2 s[90:91], s[16:17], s84 offset:1212
    s_load_dwordx2 s[90:91], s[16:17], s84 offset:1340
    s_load_dwordx2 s[90:91], s[16:17], s84 offset:1468
    s_waitcnt vmcnt(14)
    s_bitcmp1_b32 2, s87
    s_cbranch_scc1 L_mw_16
    s_waitcnt vmcnt(11)
L_mw_16:
    s_barrier
    s_add_u32 m0, s43, 0
    s_nop 0
    buffer_load_dwordx4 v2, s[32:35], s40 offen offset:0 lds
    s_add_u32 m0, s44, 0
    s_nop 0
    buffer_load_dwordx4 v7, s[36:39], s41 offen offset:0 lds
    buffer_load_dwordx4 v8, s[36:39], s41 offen offset:1024 lds
    s_add_u32 m0, s43, 0
    s_nop 0
    buffer_load_dwordx4 v3, s[32:35], s40 offen offset:1024 lds
    s_add_u32 m0, s44, 8192
    s_nop 0
    buffer_load_dwordx4 v9, s[36:39], s41 offen offset:0 lds
    buffer_load_dwordx4 v10, s[36:39], s41 offen offset:1024 lds
    s_add_u32 m0, s43, 0
    s_nop 0
    buffer_load_dwordx4 v4, s[32:35], s40 offen offset:2048 lds
    s_add_u32 m0, s44, 16384
    s_nop 0
    buffer_load_dwordx4 v11, s[36:39], s41 offen offset:0 lds
    buffer_load_dwordx4 v12, s[36:39], s41 offen offset:1024 lds
    s_add_u32 m0, s43, 0
    s_nop 0
    buffer_load_dwordx4 v5, s[32:35], s40 offen offset:3072 lds
    s_mov_b32 m0, 16384
    s_mov_b64 exec, s[46:47]
    buffer_load_dwordx4 v6, s[32:35], s40 offen lds
    s_mov_b64 exec, -1
    s_movk_i32 s40, 1280
    s_mov_b32 s41, 3932160
    s_load_dwordx2 s[90:91], s[16:17], s84 offset:1596
    s_load_dwordx2 s[90:91], s[16:17], s84 offset:1724
    s_load_dwordx2 s[90:91], s[16:17], s84 offset:1852
    s_load_dwordx2 s[90:91], s[16:17], s84 offset:1980
    s_waitcnt vmcnt(11)
    s_barrier
    s_add_u32 m0, s43, 41984
    s_nop 0
    buffer_load_dwordx4 v2, s[32:35], s40 offen offset:0 lds
    s_add_u32 m0, s44, 41984
    s_nop 0
    buffer_load_dwordx4 v7, s[36:39], s41 offen offset:0 lds
    buffer_load_dwordx4 v8, s[36:39], s41 offen offset:1024 lds
    s_add_u32 m0, s43, 41984
    s_nop 0
    buffer_load_dwordx4 v3, s[32:35], s40 offen offset:1024 lds
    s_add_u32 m0, s44, 50176
    s_nop 0
    buffer_load_dwordx4 v9, s[36:39], s41 offen offset:0 lds
    buffer_load_dwordx4 v10, s[36:39], s41 offen offset:1024 lds
    s_add_u32 m0, s43, 41984
    s_nop 0
    buffer_load_dwordx4 v4, s[32:35], s40 offen offset:2048 lds
    s_add_u32 m0, s44, 58368
    s_nop 0
    buffer_load_dwordx4 v11, s[36:39], s41 offen offset:0 lds
    buffer_load_dwordx4 v12, s[36:39], s41 offen offset:1024 lds
    s_add_u32 m0, s43, 41984
    s_nop 0
    buffer_load_dwordx4 v5, s[32:35], s40 offen offset:3072 lds
    s_mov_b32 m0, 58368
    s_mov_b64 exec, s[46:47]
    buffer_load_dwordx4 v6, s[32:35], s40 offen lds
    s_mov_b64 exec, -1
    s_movk_i32 s40, 1408
    s_mov_b32 s41, 4325376
    s_load_dwordx2 s[90:91], s[16:17], s84 offset:2108
    s_load_dwordx2 s[90:91], s[16:17], s84 offset:2236
    s_load_dwordx2 s[90:91], s[16:17], s84 offset:2364
    s_load_dwordx2 s[90:91], s[16:17], s84 offset:2492
    s_waitcnt vmcnt(11)
    s_barrier
    s_add_u32 m0, s43, 83968
    s_nop 0
    buffer_load_dwordx4 v2, s[32:35], s40 offen offset:0 lds
    s_add_u32 m0, s44, 83968
    s_nop 0
    buffer_load_dwordx4 v7, s[36:39], s41 offen offset:0 lds
    buffer_load_dwordx4 v8, s[36:39], s41 offen offset:1024 lds
    s_add_u32 m0, s43, 83968
    s_nop 0
    buffer_load_dwordx4 v3, s[32:35], s40 offen offset:1024 lds
    s_add_u32 m0, s44, 92160
    s_nop 0
    buffer_load_dwordx4 v9, s[36:39], s41 offen offset:0 lds
    buffer_load_dwordx4 v10, s[36:39], s41 offen offset:1024 lds
    s_add_u32 m0, s43, 83968
    s_nop 0
    buffer_load_dwordx4 v4, s[32:35], s40 offen offset:2048 lds
    s_add_u32 m0, s44, 100352
    s_nop 0
    buffer_load_dwordx4 v11, s[36:39], s41 offen offset:0 lds
    buffer_load_dwordx4 v12, s[36:39], s41 offen offset:1024 lds
    s_add_u32 m0, s43, 83968
    s_nop 0
    buffer_load_dwordx4 v5, s[32:35], s40 offen offset:3072 lds
    s_mov_b32 m0, 100352
    s_mov_b64 exec, s[46:47]
    buffer_load_dwordx4 v6, s[32:35], s40 offen lds
    s_mov_b64 exec, -1
    s_movk_i32 s40, 1536
    s_mov_b32 s41, 4718592
    s_load_dwordx2 s[90:91], s[16:17], s84 offset:2620
    s_load_dwordx2 s[90:91], s[16:17], s84 offset:2748
    s_load_dwordx2 s[90:91], s[16:17], s84 offset:2876
    s_load_dwordx2 s[90:91], s[16:17], s84 offset:3004
    s_waitcnt vmcnt(11)
    s_barrier
    s_add_u32 m0, s43, 0
    s_nop 0
    buffer_load_dwordx4 v2, s[32:35], s40 offen offset:0 lds
    s_add_u32 m0, s44, 0
    s_nop 0
    buffer_load_dwordx4 v7, s[36:39], s41 offen offset:0 lds
    buffer_load_dwordx4 v8, s[36:39], s41 offen offset:1024 lds
    s_add_u32 m0, s43, 0
    s_nop 0
    buffer_load_dwordx4 v3, s[32:35], s40 offen offset:1024 lds
    s_add_u32 m0, s44, 8192
    s_nop 0
    buffer_load_dwordx4 v9, s[36:39], s41 offen offset:0 lds
    buffer_load_dwordx4 v10, s[36:39], s41 offen offset:1024 lds
    s_add_u32 m0, s43, 0
    s_nop 0
    buffer_load_dwordx4 v4, s[32:35], s40 offen offset:2048 lds
    s_add_u32 m0, s44, 16384
    s_nop 0
    buffer_load_dwordx4 v11, s[36:39], s41 offen offset:0 lds
    buffer_load_dwordx4 v12, s[36:39], s41 offen offset:1024 lds
    s_add_u32 m0, s43, 0
    s_nop 0
    buffer_load_dwordx4 v5, s[32:35], s40 offen offset:3072 lds
    s_mov_b32 m0, 16384
    s_mov_b64 exec, s[46:47]
    buffer_load_dwordx4 v6, s[32:35], s40 offen lds
    s_mov_b64 exec, -1
    s_movk_i32 s40, 1664
    s_mov_b32 s41, 5111808
    s_load_dwordx2 s[90:91], s[16:17], s84 offset:3132
    s_load_dwordx2 s[90:91], s[16:17], s84 offset:3260
    s_load_dwordx2 s[90:91], s[16:17], s84 offset:3388
    s_load_dwordx2 s[90:91], s[16:17], s84 offset:3516
    s_waitcnt vmcnt(11)
    s_barrier
    s_add_u32 m0, s43, 41984
    s_nop 0
    buffer_load_dwordx4 v2, s[32:35], s40 offen offset:0 lds
    s_add_u32 m0, s44, 41984
    s_nop 0
    buffer_load_dwordx4 v7, s[36:39], s41 offen offset:0 lds
    buffer_load_dwordx4 v8, s[36:39], s41 offen offset:1024 lds
    s_add_u32 m0, s43, 41984
    s_nop 0
    buffer_load_dwordx4 v3, s[32:35], s40 offen offset:1024 lds
    s_add_u32 m0, s44, 50176
    s_nop 0
    buffer_load_dwordx4 v9, s[36:39], s41 offen offset:0 lds
    buffer_load_dwordx4 v10, s[36:39], s41 offen offset:1024 lds
    s_add_u32 m0, s43, 41984
    s_nop 0
    buffer_load_dwordx4 v4, s[32:35], s40 offen offset:2048 lds
    s_add_u32 m0, s44, 58368
    s_nop 0
    buffer_load_dwordx4 v11, s[36:39], s41 offen offset:0 lds
    buffer_load_dwordx4 v12, s[36:39], s41 offen offset:1024 lds
    s_add_u32 m0, s43, 41984
    s_nop 0
    buffer_load_dwordx4 v5, s[32:35], s40 offen offset:3072 lds
    s_mov_b32 m0, 58368
    s_mov_b64 exec, s[46:47]
    buffer_load_dwordx4 v6, s[32:35], s40 offen lds
    s_mov_b64 exec, -1
    s_movk_i32 s40, 1792
    s_mov_b32 s41, 5505024
    s_load_dwordx2 s[90:91], s[16:17], s84 offset:3644
    s_load_dwordx2 s[90:91], s[16:17], s84 offset:3772
    s_load_dwordx2 s[90:91], s[16:17], s84 offset:3900
    s_load_dwordx2 s[90:91], s[16:17], s84 offset:4028
    s_waitcnt vmcnt(11)
    s_barrier
    s_add_u32 m0, s43, 83968
    s_nop 0
    buffer_load_dwordx4 v2, s[32:35], s40 offen offset:0 lds
    s_add_u32 m0, s44, 83968
    s_nop 0
    buffer_load_dwordx4 v7, s[36:39], s41 offen offset:0 lds
    buffer_load_dwordx4 v8, s[36:39], s41 offen offset:1024 lds
    s_add_u32 m0, s43, 83968
    s_nop 0
    buffer_load_dwordx4 v3, s[32:35], s40 offen offset:1024 lds
    s_add_u32 m0, s44, 92160
    s_nop 0
    buffer_load_dwordx4 v9, s[36:39], s41 offen offset:0 lds
    buffer_load_dwordx4 v10, s[36:39], s41 offen offset:1024 lds
    s_add_u32 m0, s43, 83968
    s_nop 0
    buffer_load_dwordx4 v4, s[32:35], s40 offen offset:2048 lds
    s_add_u32 m0, s44, 100352
    s_nop 0
    buffer_load_dwordx4 v11, s[36:39], s41 offen offset:0 lds
    buffer_load_dwordx4 v12, s[36:39], s41 offen offset:1024 lds
    s_add_u32 m0, s43, 83968
    s_nop 0
    buffer_load_dwordx4 v5, s[32:35], s40 offen offset:3072 lds
    s_mov_b32 m0, 100352
    s_mov_b64 exec, s[46:47]
    buffer_load_dwordx4 v6, s[32:35], s40 offen lds
    s_mov_b64 exec, -1
    s_movk_i32 s40, 1920
    s_mov_b32 s41, 5898240
    s_waitcnt vmcnt(11)
    s_barrier
    s_load_dword s78, s[52:53], s73
    s_add_u32 m0, s43, 0
    s_nop 0
    buffer_load_dwordx4 v2, s[32:35], s40 offen offset:0 lds
    s_add_u32 m0, s44, 0
    s_nop 0
    buffer_load_dwordx4 v7, s[36:39], s41 offen offset:0 lds
    buffer_load_dwordx4 v8, s[36:39], s41 offen offset:1024 lds
    s_add_u32 m0, s43, 0
    s_nop 0
    buffer_load_dwordx4 v3, s[32:35], s40 offen offset:1024 lds
    s_add_u32 m0, s44, 8192
    s_nop 0
    buffer_load_dwordx4 v9, s[36:39], s41 offen offset:0 lds
    buffer_load_dwordx4 v10, s[36:39], s41 offen offset:1024 lds
    s_add_u32 m0, s43, 0
    s_nop 0
    buffer_load_dwordx4 v4, s[32:35], s40 offen offset:2048 lds
    s_add_u32 m0, s44, 16384
    s_nop 0
    buffer_load_dwordx4 v11, s[36:39], s41 offen offset:0 lds
    buffer_load_dwordx4 v12, s[36:39], s41 offen offset:1024 lds
    s_add_u32 m0, s43, 0
    s_nop 0
    buffer_load_dwordx4 v5, s[32:35], s40 offen offset:3072 lds
    s_mov_b32 m0, 16384
    s_mov_b64 exec, s[46:47]
    buffer_load_dwordx4 v6, s[32:35], s40 offen lds
    s_mov_b64 exec, -1
    s_movk_i32 s40, 2048
    s_mov_b32 s41, 6291456
    s_mov_b32 s79, 131072
    s_branch L_sg_chk_25
L_sg_loop_24:
    s_load_dword s78, s[52:53], s73 glc
L_sg_chk_25:
    s_waitcnt lgkmcnt(0)
    s_cmp_ge_u32 s78, 32
    s_cbranch_scc1 L_sg_done_23
    s_sub_u32 s79, s79, 1
    s_cbranch_scc0 L_sg_loop_24
L_sg_done_23:
    s_waitcnt vmcnt(11)
    s_barrier
    s_add_u32 s56, s30, s85
    s_addc_u32 s57, s31, 0
    s_movk_i32 s58, 4096
    s_mov_b32 s59, 0x20000
    s_add_u32 m0, s81, 0
    s_nop 0
    buffer_load_dwordx4 v224, s[56:59], 0 offen offset:0 sc1 lds
    buffer_load_dwordx4 v224, s[56:59], 0 offen offset:1024 sc1 lds
    buffer_load_dwordx4 v224, s[56:59], 0 offen offset:2048 sc1 lds
    buffer_load_dwordx4 v224, s[56:59], 0 offen offset:3072 sc1 lds
    s_add_u32 m0, s81, 4572
    s_nop 0
    buffer_load_dwordx4 v224, s[56:59], 0 offen offset:0 sc1 lds
    buffer_load_dwordx4 v224, s[56:59], 0 offen offset:1024 sc1 lds
    buffer_load_dwordx4 v224, s[56:59], 0 offen offset:2048 sc1 lds
    buffer_load_dwordx4 v224, s[56:59], 0 offen offset:3072 sc1 lds
    s_waitcnt vmcnt(8)
    s_mov_b64 exec, 1
    ds_add_u32 v227, v244 offset:24
    s_mov_b64 exec, -1
    s_add_u32 s56, s16, s84
    s_addc_u32 s57, s17, 0
    s_movk_i32 s58, 4096
    s_mov_b32 s59, 0x20000
    s_add_u32 m0, s80, 64
    v_mov_b32 v132, 0
    v_mov_b32 v133, 0
    v_mov_b32 v134, 0
    v_mov_b32 v135, 0
    buffer_load_dwordx4 v224, s[56:59], 0 offen offset:0 lds
    buffer_load_dwordx4 v224, s[56:59], 0 offen offset:1024 lds
    buffer_load_dwordx4 v224, s[56:59], 0 offen offset:2048 lds
    buffer_load_dwordx4 v224, s[56:59], 0 offen offset:3072 lds
    s_add_u32 m0, s80, 4304
    s_mov_b64 exec, 0x100
    buffer_load_dwordx4 v[132:135], off, s[56:59], 0
    s_mov_b64 exec, -1
    buffer_load_dwordx4 v224, s[56:59], 14 offen offset:0 lds
    buffer_load_dwordx4 v224, s[56:59], 14 offen offset:1024 lds
    buffer_load_dwordx4 v224, s[56:59], 14 offen offset:2048 lds
    buffer_load_dwordx4 v224, s[56:59], 14 offen offset:3072 lds
    v_lshrrev_b32 v234, 5, v0
    v_mul_u32_u24 v234, 4064, v234
    v_add3_u32 v234, v234, v224, s81
    s_mov_b32 exec_lo, 0xfffffff
    s_mov_b32 exec_hi, 0xfffffff
    ds_write_b128 v234, v[228:231] offset:4096
    s_mov_b64 exec, 1
    ds_write_b32 v234, v228 offset:8668
    s_mov_b64 exec, -1
    s_setprio 3
    s_mov_b32 s60, s24
    s_mov_b32 s61, s25
    s_mov_b32 s62, 0x200000
    s_mov_b32 s63, 0x20000
    s_lshr_b32 s74, s2, 3
    s_lshl2_add_u32 s74, s74, s70
    s_bfe_u32 s75, s2, 0x10002
    s_lshl4_add_u32 s74, s74, s75
    s_lshl_b32 s74, s74, 10
    v_lshrrev_b32 v234, 3, v0
    v_and_b32 v235, 7, v0
    v_lshlrev_b32 v235, 7, v235
    v_lshl_add_u32 v234, v234, 11, v235
    buffer_load_dword v250, v234, s[60:63], s74 offen
    s_lshr_b32 s74, s69, 2
    s_and_b32 s75, s69, 3
    s_lshl3_add_u32 s74, s74, s75
    s_lshl3_add_u32 s74, s74, s70
    s_lshl_b32 s74, s74, 3
    v_bfe_u32 v234, v0, 3, 1
    v_lshl_add_u32 v225, v234, 8, s74
    v_bfe_u32 v234, v0, 4, 1
    v_lshl_add_u32 v225, v234, 1, v225
    v_lshrrev_b32 v234, 5, v0
    v_lshl_add_u32 v225, v234, 5, v225
    s_lshl_b32 s74, s68, 7
    v_and_b32 v234, 7, v0
    v_lshl_add_u32 v234, v234, 4, s74
    v_lshl_add_u32 v226, v225, 12, v234
    v_lshl_add_u32 v225, v225, 11, v234
    s_mov_b32 s60, s8
    s_mov_b32 s61, s9
    s_mov_b32 s62, 0x400000
    s_mov_b32 s63, 0x20000
    s_movk_i32 s74, 8192
    buffer_load_dwordx4 v[208:211], v225, s[60:63], 0 offen offset:0 nt
    buffer_load_dwordx4 v[212:215], v225, s[60:63], 0 offen offset:2048 nt
    buffer_load_dwordx4 v[216:219], v225, s[60:63], s74 offen offset:0 nt
    buffer_load_dwordx4 v[220:223], v225, s[60:63], s74 offen offset:2048 nt
    s_waitcnt vmcnt(14)
    s_waitcnt vmcnt(5)
    v_cmp_lt_u32 vcc, 3, v0
    v_mov_b32 v140, 4160
    v_lshlrev_b32 v136, 16, v132
    v_cndmask_b32 v140, 0, v140, vcc
    v_alignbit_b32 v137, v133, v132, 16
    v_alignbit_b32 v138, v134, v133, 16
    v_alignbit_b32 v139, v135, v134, 16
    v_add3_u32 v140, v140, v224, s80
    s_mov_b64 exec, 0x1ff
    ds_write_b128 v140, v[136:139]
    s_mov_b64 exec, -1
    ds_read_b128 v[112:115], v233 offset:3584
    ds_read_b64 v[48:49], v232 offset:0
    ds_read_b64 v[50:51], v232 offset:8
    ds_read_b128 v[116:119], v233 offset:3072
    ds_read_b64 v[52:53], v232 offset:512
    ds_read_b64 v[54:55], v232 offset:520
    ds_read_b128 v[120:123], v233 offset:2560
    ds_read_b64 v[56:57], v232 offset:1024
    ds_read_b64 v[58:59], v232 offset:1032
    ds_read_b128 v[124:127], v233 offset:2048
    ds_read_b64 v[60:61], v232 offset:1536
    ds_read_b64 v[62:63], v232 offset:1544
    ds_read_b128 v[128:131], v233 offset:1536
    ds_read_b64 v[64:65], v232 offset:2048
    ds_read_b64 v[66:67], v232 offset:2056
    ds_read_b128 v[132:135], v233 offset:1024
    ds_read_b64 v[68:69], v232 offset:2560
    ds_read_b64 v[70:71], v232 offset:2568
    ds_read_b128 v[136:139], v233 offset:512
    ds_read_b64 v[72:73], v232 offset:3072
    ds_read_b64 v[74:75], v232 offset:3080
    ds_read_b128 v[140:143], v233 offset:0
    ds_read_b64 v[76:77], v232 offset:3584
    ds_read_b64 v[78:79], v232 offset:3592
    s_setprio 1
    s_mov_b32 s74, 3
    s_waitcnt lgkmcnt(0)
    v_mfma_f32_16x16x32_bf16 v[16:19], v[240:243], v[112:115], 0
    v_mfma_f32_16x16x32_bf16 v[20:23], v[240:243], v[116:119], 0
    v_mfma_f32_16x16x32_bf16 v[24:27], v[240:243], v[120:123], 0
    v_mfma_f32_16x16x32_bf16 v[28:31], v[240:243], v[124:127], 0
    v_mfma_f32_16x16x32_bf16 v[32:35], v[240:243], v[128:131], 0
    v_mfma_f32_16x16x32_bf16 v[36:39], v[240:243], v[132:135], 0
    v_mfma_f32_16x16x32_bf16 v[40:43], v[240:243], v[136:139], 0
    v_mfma_f32_16x16x32_bf16 v[44:47], v[240:243], v[140:143], 0
L_conv:
    v_mfma_f32_16x16x32_bf16 v[16:19], v[48:51], v[112:115], v[16:19]
    ds_read_b128 v[144:147], v233 offset:3648
    v_mfma_f32_16x16x32_bf16 v[20:23], v[48:51], v[116:119], v[20:23]
    ds_read_b64 v[80:81], v232 offset:64
    v_mfma_f32_16x16x32_bf16 v[20:23], v[52:55], v[112:115], v[20:23]
    ds_read_b64 v[82:83], v232 offset:72
    v_mfma_f32_16x16x32_bf16 v[24:27], v[48:51], v[120:123], v[24:27]
    ds_read_b128 v[148:151], v233 offset:3136
    v_mfma_f32_16x16x32_bf16 v[24:27], v[52:55], v[116:119], v[24:27]
    ds_read_b64 v[84:85], v232 offset:576
    v_mfma_f32_16x16x32_bf16 v[24:27], v[56:59], v[112:115], v[24:27]
    ds_read_b64 v[86:87], v232 offset:584
    v_mfma_f32_16x16x32_bf16 v[28:31], v[48:51], v[124:127], v[28:31]
    ds_read_b128 v[152:155], v233 offset:2624
    v_mfma_f32_16x16x32_bf16 v[28:31], v[52:55], v[120:123], v[28:31]
    ds_read_b64 v[88:89], v232 offset:1088
    v_mfma_f32_16x16x32_bf16 v[28:31], v[56:59], v[116:119], v[28:31]
    ds_read_b64 v[90:91], v232 offset:1096
    v_mfma_f32_16x16x32_bf16 v[28:31], v[60:63], v[112:115], v[28:31]
    ds_read_b128 v[156:159], v233 offset:2112
    v_mfma_f32_16x16x32_bf16 v[32:35], v[48:51], v[128:131], v[32:35]
    ds_read_b64 v[92:93], v232 offset:1600
    v_mfma_f32_16x16x32_bf16 v[32:35], v[52:55], v[124:127], v[32:35]
    ds_read_b64 v[94:95], v232 offset:1608
    v_mfma_f32_16x16x32_bf16 v[32:35], v[56:59], v[120:123], v[32:35]
    ds_read_b128 v[160:163], v233 offset:1600
    v_mfma_f32_16x16x32_bf16 v[32:35], v[60:63], v[116:119], v[32:35]
    ds_read_b64 v[96:97], v232 offset:2112
    v_mfma_f32_16x16x32_bf16 v[32:35], v[64:67], v[112:115], v[32:35]
    ds_read_b64 v[98:99], v232 offset:2120
    v_mfma_f32_16x16x32_bf16 v[36:39], v[48:51], v[132:135], v[36:39]
    ds_read_b128 v[164:167], v233 offset:1088
    v_mfma_f32_16x16x32_bf16 v[36:39], v[52:55], v[128:131], v[36:39]
    ds_read_b64 v[100:101], v232 offset:2624
    v_mfma_f32_16x16x32_bf16 v[36:39], v[56:59], v[124:127], v[36:39]
    ds_read_b64 v[102:103], v232 offset:2632
    v_mfma_f32_16x16x32_bf16 v[36:39], v[60:63], v[120:123], v[36:39]
    ds_read_b128 v[168:171], v233 offset:576
    v_mfma_f32_16x16x32_bf16 v[36:39], v[64:67], v[116:119], v[36:39]
    ds_read_b64 v[104:105], v232 offset:3136
    v_mfma_f32_16x16x32_bf16 v[36:39], v[68:71], v[112:115], v[36:39]
    ds_read_b64 v[106:107], v232 offset:3144
    v_mfma_f32_16x16x32_bf16 v[40:43], v[48:51], v[136:139], v[40:43]
    ds_read_b128 v[172:175], v233 offset:64
    v_mfma_f32_16x16x32_bf16 v[40:43], v[52:55], v[132:135], v[40:43]
    ds_read_b64 v[108:109], v232 offset:3648
    v_mfma_f32_16x16x32_bf16 v[40:43], v[56:59], v[128:131], v[40:43]
    ds_read_b64 v[110:111], v232 offset:3656
    v_mfma_f32_16x16x32_bf16 v[40:43], v[60:63], v[124:127], v[40:43]
    v_mfma_f32_16x16x32_bf16 v[40:43], v[64:67], v[120:123], v[40:43]
    v_mfma_f32_16x16x32_bf16 v[40:43], v[68:71], v[116:119], v[40:43]
    v_mfma_f32_16x16x32_bf16 v[40:43], v[72:75], v[112:115], v[40:43]
    v_mfma_f32_16x16x32_bf16 v[44:47], v[48:51], v[140:143], v[44:47]
    v_mfma_f32_16x16x32_bf16 v[44:47], v[52:55], v[136:139], v[44:47]
    v_mfma_f32_16x16x32_bf16 v[44:47], v[56:59], v[132:135], v[44:47]
    v_mfma_f32_16x16x32_bf16 v[44:47], v[60:63], v[128:131], v[44:47]
    v_mfma_f32_16x16x32_bf16 v[44:47], v[64:67], v[124:127], v[44:47]
    v_mfma_f32_16x16x32_bf16 v[44:47], v[68:71], v[120:123], v[44:47]
    v_mfma_f32_16x16x32_bf16 v[44:47], v[72:75], v[116:119], v[44:47]
    v_mfma_f32_16x16x32_bf16 v[44:47], v[76:79], v[112:115], v[44:47]
    s_waitcnt lgkmcnt(0)
    v_mfma_f32_16x16x32_bf16 v[16:19], v[80:83], v[144:147], v[16:19]
    ds_read_b128 v[112:115], v233 offset:3712
    v_mfma_f32_16x16x32_bf16 v[20:23], v[80:83], v[148:151], v[20:23]
    ds_read_b64 v[48:49], v232 offset:128
    v_mfma_f32_16x16x32_bf16 v[20:23], v[84:87], v[144:147], v[20:23]
    ds_read_b64 v[50:51], v232 offset:136
    v_mfma_f32_16x16x32_bf16 v[24:27], v[80:83], v[152:155], v[24:27]
    ds_read_b128 v[116:119], v233 offset:3200
    v_mfma_f32_16x16x32_bf16 v[24:27], v[84:87], v[148:151], v[24:27]
    ds_read_b64 v[52:53], v232 offset:640
    v_mfma_f32_16x16x32_bf16 v[24:27], v[88:91], v[144:147], v[24:27]
    ds_read_b64 v[54:55], v232 offset:648
    v_mfma_f32_16x16x32_bf16 v[28:31], v[80:83], v[156:159], v[28:31]
    ds_read_b128 v[120:123], v233 offset:2688
    v_mfma_f32_16x16x32_bf16 v[28:31], v[84:87], v[152:155], v[28:31]
    ds_read_b64 v[56:57], v232 offset:1152
    v_mfma_f32_16x16x32_bf16 v[28:31], v[88:91], v[148:151], v[28:31]
    ds_read_b64 v[58:59], v232 offset:1160
    v_mfma_f32_16x16x32_bf16 v[28:31], v[92:95], v[144:147], v[28:31]
    ds_read_b128 v[124:127], v233 offset:2176
    v_mfma_f32_16x16x32_bf16 v[32:35], v[80:83], v[160:163], v[32:35]
    ds_read_b64 v[60:61], v232 offset:1664
    v_mfma_f32_16x16x32_bf16 v[32:35], v[84:87], v[156:159], v[32:35]
    ds_read_b64 v[62:63], v232 offset:1672
    v_mfma_f32_16x16x32_bf16 v[32:35], v[88:91], v[152:155], v[32:35]
    ds_read_b128 v[128:131], v233 offset:1664
    v_mfma_f32_16x16x32_bf16 v[32:35], v[92:95], v[148:151], v[32:35]
    ds_read_b64 v[64:65], v232 offset:2176
    v_mfma_f32_16x16x32_bf16 v[32:35], v[96:99], v[144:147], v[32:35]
    ds_read_b64 v[66:67], v232 offset:2184
    v_mfma_f32_16x16x32_bf16 v[36:39], v[80:83], v[164:167], v[36:39]
    ds_read_b128 v[132:135], v233 offset:1152
    v_mfma_f32_16x16x32_bf16 v[36:39], v[84:87], v[160:163], v[36:39]
    ds_read_b64 v[68:69], v232 offset:2688
    v_mfma_f32_16x16x32_bf16 v[36:39], v[88:91], v[156:159], v[36:39]
    ds_read_b64 v[70:71], v232 offset:2696
    v_mfma_f32_16x16x32_bf16 v[36:39], v[92:95], v[152:155], v[36:39]
    ds_read_b128 v[136:139], v233 offset:640
    v_mfma_f32_16x16x32_bf16 v[36:39], v[96:99], v[148:151], v[36:39]
    ds_read_b64 v[72:73], v232 offset:3200
    v_mfma_f32_16x16x32_bf16 v[36:39], v[100:103], v[144:147], v[36:39]
    ds_read_b64 v[74:75], v232 offset:3208
    v_mfma_f32_16x16x32_bf16 v[40:43], v[80:83], v[168:171], v[40:43]
    ds_read_b128 v[140:143], v233 offset:128
    v_mfma_f32_16x16x32_bf16 v[40:43], v[84:87], v[164:167], v[40:43]
    ds_read_b64 v[76:77], v232 offset:3712
    v_mfma_f32_16x16x32_bf16 v[40:43], v[88:91], v[160:163], v[40:43]
    ds_read_b64 v[78:79], v232 offset:3720
    v_mfma_f32_16x16x32_bf16 v[40:43], v[92:95], v[156:159], v[40:43]
    v_add_u32 v232, 128, v232
    v_mfma_f32_16x16x32_bf16 v[40:43], v[96:99], v[152:155], v[40:43]
    v_add_u32 v233, 128, v233
    v_mfma_f32_16x16x32_bf16 v[40:43], v[100:103], v[148:151], v[40:43]
    s_sub_u32 s74, s74, 1
    v_mfma_f32_16x16x32_bf16 v[40:43], v[104:107], v[144:147], v[40:43]
    s_cmp_lg_u32 s74, 0
    v_mfma_f32_16x16x32_bf16 v[44:47], v[80:83], v[172:175], v[44:47]
    v_mfma_f32_16x16x32_bf16 v[44:47], v[84:87], v[168:171], v[44:47]
    v_mfma_f32_16x16x32_bf16 v[44:47], v[88:91], v[164:167], v[44:47]
    v_mfma_f32_16x16x32_bf16 v[44:47], v[92:95], v[160:163], v[44:47]
    v_mfma_f32_16x16x32_bf16 v[44:47], v[96:99], v[156:159], v[44:47]
    v_mfma_f32_16x16x32_bf16 v[44:47], v[100:103], v[152:155], v[44:47]
    v_mfma_f32_16x16x32_bf16 v[44:47], v[104:107], v[148:151], v[44:47]
    v_mfma_f32_16x16x32_bf16 v[44:47], v[108:111], v[144:147], v[44:47]
    s_waitcnt lgkmcnt(0)
    s_cbranch_scc1 L_conv
    v_mfma_f32_16x16x32_bf16 v[16:19], v[48:51], v[112:115], v[16:19]
    ds_read_b128 v[144:147], v233 offset:3648
    v_mfma_f32_16x16x32_bf16 v[20:23], v[48:51], v[116:119], v[20:23]
    ds_read_b64 v[80:81], v232 offset:64
    v_mfma_f32_16x16x32_bf16 v[20:23], v[52:55], v[112:115], v[20:23]
    ds_read_b64 v[82:83], v232 offset:72
    v_mfma_f32_16x16x32_bf16 v[24:27], v[48:51], v[120:123], v[24:27]
    ds_read_b128 v[148:151], v233 offset:3136
    v_mfma_f32_16x16x32_bf16 v[24:27], v[52:55], v[116:119], v[24:27]
    ds_read_b64 v[84:85], v232 offset:576
    v_mfma_f32_16x16x32_bf16 v[24:27], v[56:59], v[112:115], v[24:27]
    ds_read_b64 v[86:87], v232 offset:584
    v_mfma_f32_16x16x32_bf16 v[28:31], v[48:51], v[124:127], v[28:31]
    ds_read_b128 v[152:155], v233 offset:2624
    v_mfma_f32_16x16x32_bf16 v[28:31], v[52:55], v[120:123], v[28:31]
    ds_read_b64 v[88:89], v232 offset:1088
    v_mfma_f32_16x16x32_bf16 v[28:31], v[56:59], v[116:119], v[28:31]
    ds_read_b64 v[90:91], v232 offset:1096
    v_mfma_f32_16x16x32_bf16 v[28:31], v[60:63], v[112:115], v[28:31]
    ds_read_b128 v[156:159], v233 offset:2112
    v_mfma_f32_16x16x32_bf16 v[32:35], v[48:51], v[128:131], v[32:35]
    ds_read_b64 v[92:93], v232 offset:1600
    v_mfma_f32_16x16x32_bf16 v[32:35], v[52:55], v[124:127], v[32:35]
    ds_read_b64 v[94:95], v232 offset:1608
    v_mfma_f32_16x16x32_bf16 v[32:35], v[56:59], v[120:123], v[32:35]
    ds_read_b128 v[160:163], v233 offset:1600
    v_mfma_f32_16x16x32_bf16 v[32:35], v[60:63], v[116:119], v[32:35]
    ds_read_b64 v[96:97], v232 offset:2112
    v_mfma_f32_16x16x32_bf16 v[32:35], v[64:67], v[112:115], v[32:35]
    ds_read_b64 v[98:99], v232 offset:2120
    v_mfma_f32_16x16x32_bf16 v[36:39], v[48:51], v[132:135], v[36:39]
    ds_read_b128 v[164:167], v233 offset:1088
    v_mfma_f32_16x16x32_bf16 v[36:39], v[52:55], v[128:131], v[36:39]
    ds_read_b64 v[100:101], v232 offset:2624
    v_mfma_f32_16x16x32_bf16 v[36:39], v[56:59], v[124:127], v[36:39]
    ds_read_b64 v[102:103], v232 offset:2632
    v_mfma_f32_16x16x32_bf16 v[36:39], v[60:63], v[120:123], v[36:39]
    ds_read_b128 v[168:171], v233 offset:576
    v_mfma_f32_16x16x32_bf16 v[36:39], v[64:67], v[116:119], v[36:39]
    ds_read_b64 v[104:105], v232 offset:3136
    v_mfma_f32_16x16x32_bf16 v[36:39], v[68:71], v[112:115], v[36:39]
    ds_read_b64 v[106:107], v232 offset:3144
    v_mfma_f32_16x16x32_bf16 v[40:43], v[48:51], v[136:139], v[40:43]
    ds_read_b128 v[172:175], v233 offset:64
    v_mfma_f32_16x16x32_bf16 v[40:43], v[52:55], v[132:135], v[40:43]
    ds_read_b64 v[108:109], v232 offset:3648
    v_mfma_f32_16x16x32_bf16 v[40:43], v[56:59], v[128:131], v[40:43]
    ds_read_b64 v[110:111], v232 offset:3656
    v_mfma_f32_16x16x32_bf16 v[40:43], v[60:63], v[124:127], v[40:43]
    s_mul_i32 s74, s68, 4224
    v_mfma_f32_16x16x32_bf16 v[40:43], v[64:67], v[120:123], v[40:43]
    s_and_b32 s75, s71, 63
    v_mfma_f32_16x16x32_bf16 v[40:43], v[68:71], v[116:119], v[40:43]
    s_add_u32 s74, s74, s75
    v_mfma_f32_16x16x32_bf16 v[40:43], v[72:75], v[112:115], v[40:43]
    s_lshl_b32 s74, s74, 6
    v_mfma_f32_16x16x32_bf16 v[44:47], v[48:51], v[140:143], v[44:47]
    v_and_b32 v234, 3, v0
    v_mfma_f32_16x16x32_bf16 v[44:47], v[52:55], v[136:139], v[44:47]
    v_lshl_add_u32 v234, v234, 4, s74
    v_mfma_f32_16x16x32_bf16 v[44:47], v[56:59], v[132:135], v[44:47]
    v_and_b32 v235, 12, v0
    v_mfma_f32_16x16x32_bf16 v[44:47], v[60:63], v[128:131], v[44:47]
    v_lshrrev_b32 v236, 4, v0
    v_mfma_f32_16x16x32_bf16 v[44:47], v[64:67], v[124:127], v[44:47]
    v_add_u32 v235, v235, v236
    v_mfma_f32_16x16x32_bf16 v[44:47], v[68:71], v[120:123], v[44:47]
    v_mul_u32_u24 v235, 4224, v235
    v_mfma_f32_16x16x32_bf16 v[44:47], v[72:75], v[116:119], v[44:47]
    v_add_u32 v234, v234, v235
    v_mfma_f32_16x16x32_bf16 v[44:47], v[76:79], v[112:115], v[44:47]
    s_waitcnt lgkmcnt(0)
    v_mfma_f32_16x16x32_bf16 v[16:19], v[80:83], v[144:147], v[16:19]
    s_bfe_u32 s86, s2, 0x10002
    s_lshr_b32 s74, s2, 5
    v_mfma_f32_16x16x32_bf16 v[20:23], v[80:83], v[148:151], v[20:23]
    s_lshl3_add_u32 s86, s86, s74
    v_lshrrev_b32 v236, 4, v0
    v_mfma_f32_16x16x32_bf16 v[20:23], v[84:87], v[144:147], v[20:23]
    v_lshlrev_b32 v236, 1, v236
    v_xor_b32 v236, v0, v236
    v_mfma_f32_16x16x32_bf16 v[24:27], v[80:83], v[152:155], v[24:27]
    v_and_b32 v236, 7, v236
    s_lshl_b32 s74, s86, 7
    v_cvt_pk_bf16_f32 v48, v16, v17
    v_cvt_pk_bf16_f32 v49, v18, v19
    v_mfma_f32_16x16x32_bf16 v[24:27], v[84:87], v[148:151], v[24:27]
    v_lshl_add_u32 v236, v236, 4, s74
    v_lshrrev_b32 v235, 3, v0
    v_cvt_pk_bf16_f32 v50, v20, v21
    v_cvt_pk_bf16_f32 v51, v22, v23
    v_mfma_f32_16x16x32_bf16 v[24:27], v[88:91], v[144:147], v[24:27]
    v_lshl_add_u32 v235, v235, 11, v236
    s_mov_b32 s56, s24
    s_mov_b32 s76, 0
    buffer_store_dwordx4 v[48:51], v234, s[64:67], s76 offen sc1
    v_mfma_f32_16x16x32_bf16 v[28:31], v[80:83], v[156:159], v[28:31]
    s_mov_b32 s57, s25
    s_mov_b32 s58, 0x200000
    v_mfma_f32_16x16x32_bf16 v[28:31], v[84:87], v[152:155], v[28:31]
    s_mov_b32 s59, 0x20000
    s_mul_i32 s74, s86, 4
    v_cvt_pk_bf16_f32 v52, v24, v25
    v_cvt_pk_bf16_f32 v53, v26, v27
    v_mfma_f32_16x16x32_bf16 v[28:31], v[88:91], v[148:151], v[28:31]
    s_and_b32 s74, s74, 7
    s_lshl1_add_u32 s82, s74, s70
    v_mfma_f32_16x16x32_bf16 v[28:31], v[92:95], v[144:147], v[28:31]
    s_lshl_b32 s82, s82, 17
    s_add_u32 s73, s68, 32
    v_mfma_f32_16x16x32_bf16 v[32:35], v[80:83], v[160:163], v[32:35]
    s_lshl_b32 s73, s73, 8
    v_mfma_f32_16x16x32_bf16 v[32:35], v[84:87], v[156:159], v[32:35]
    v_mfma_f32_16x16x32_bf16 v[32:35], v[88:91], v[152:155], v[32:35]
    v_mfma_f32_16x16x32_bf16 v[32:35], v[92:95], v[148:151], v[32:35]
    v_mfma_f32_16x16x32_bf16 v[32:35], v[96:99], v[144:147], v[32:35]
    v_mfma_f32_16x16x32_bf16 v[36:39], v[80:83], v[164:167], v[36:39]
    v_mfma_f32_16x16x32_bf16 v[36:39], v[84:87], v[160:163], v[36:39]
    v_cvt_pk_bf16_f32 v54, v28, v29
    v_cvt_pk_bf16_f32 v55, v30, v31
    v_mfma_f32_16x16x32_bf16 v[36:39], v[88:91], v[156:159], v[36:39]
    s_mov_b32 s76, 67584
    buffer_store_dwordx4 v[52:55], v234, s[64:67], s76 offen sc1
    v_mfma_f32_16x16x32_bf16 v[36:39], v[92:95], v[152:155], v[36:39]
    v_cvt_pk_bf16_f32 v56, v32, v33
    v_cvt_pk_bf16_f32 v57, v34, v35
    v_mfma_f32_16x16x32_bf16 v[36:39], v[96:99], v[148:151], v[36:39]
    v_mfma_f32_16x16x32_bf16 v[36:39], v[100:103], v[144:147], v[36:39]
    v_mfma_f32_16x16x32_bf16 v[40:43], v[80:83], v[168:171], v[40:43]
    v_mfma_f32_16x16x32_bf16 v[40:43], v[84:87], v[164:167], v[40:43]
    v_mfma_f32_16x16x32_bf16 v[40:43], v[88:91], v[160:163], v[40:43]
    v_mfma_f32_16x16x32_bf16 v[40:43], v[92:95], v[156:159], v[40:43]
    v_mfma_f32_16x16x32_bf16 v[40:43], v[96:99], v[152:155], v[40:43]
    v_mfma_f32_16x16x32_bf16 v[40:43], v[100:103], v[148:151], v[40:43]
    v_mfma_f32_16x16x32_bf16 v[40:43], v[104:107], v[144:147], v[40:43]
    v_mfma_f32_16x16x32_bf16 v[44:47], v[80:83], v[172:175], v[44:47]
    v_cvt_pk_bf16_f32 v58, v36, v37
    v_cvt_pk_bf16_f32 v59, v38, v39
    v_mfma_f32_16x16x32_bf16 v[44:47], v[84:87], v[168:171], v[44:47]
    s_mov_b32 s76, 135168
    buffer_store_dwordx4 v[56:59], v234, s[64:67], s76 offen sc1
    v_mfma_f32_16x16x32_bf16 v[44:47], v[88:91], v[164:167], v[44:47]
    v_mfma_f32_16x16x32_bf16 v[44:47], v[92:95], v[160:163], v[44:47]
    v_cvt_pk_bf16_f32 v60, v40, v41
    v_cvt_pk_bf16_f32 v61, v42, v43
    v_mfma_f32_16x16x32_bf16 v[44:47], v[96:99], v[156:159], v[44:47]
    v_mfma_f32_16x16x32_bf16 v[44:47], v[100:103], v[152:155], v[44:47]
    v_mfma_f32_16x16x32_bf16 v[44:47], v[104:107], v[148:151], v[44:47]
    v_mfma_f32_16x16x32_bf16 v[44:47], v[108:111], v[144:147], v[44:47]
    s_nop 7
    v_cvt_pk_bf16_f32 v62, v44, v45
    v_cvt_pk_bf16_f32 v63, v46, v47
    s_mov_b32 s76, 202752
    buffer_store_dwordx4 v[60:63], v234, s[64:67], s76 offen sc1
    s_add_u32 m0, s80, 0
    s_add_u32 s83, s82, 1310720
    s_and_b32 s83, s83, 0x1fffff
    buffer_load_dwordx4 v235, s[56:59], s83 offen lds
    s_add_u32 m0, s80, 1024
    s_add_u32 s83, s82, 1327104
    s_and_b32 s83, s83, 0x1fffff
    buffer_load_dwordx4 v235, s[56:59], s83 offen lds
    s_add_u32 m0, s80, 2048
    s_add_u32 s83, s82, 1343488
    s_and_b32 s83, s83, 0x1fffff
    buffer_load_dwordx4 v235, s[56:59], s83 offen lds
    s_add_u32 m0, s80, 3072
    s_add_u32 s83, s82, 1359872
    s_and_b32 s83, s83, 0x1fffff
    buffer_load_dwordx4 v235, s[56:59], s83 offen lds
    s_add_u32 m0, s80, 4096
    s_add_u32 s83, s82, 1376256
    s_and_b32 s83, s83, 0x1fffff
    buffer_load_dwordx4 v235, s[56:59], s83 offen lds
    s_add_u32 m0, s80, 5120
    s_add_u32 s83, s82, 1392640
    s_and_b32 s83, s83, 0x1fffff
    buffer_load_dwordx4 v235, s[56:59], s83 offen lds
    s_add_u32 m0, s80, 6144
    s_add_u32 s83, s82, 1409024
    s_and_b32 s83, s83, 0x1fffff
    buffer_load_dwordx4 v235, s[56:59], s83 offen lds
    s_add_u32 m0, s80, 7168
    s_add_u32 s83, s82, 1425408
    s_and_b32 s83, s83, 0x1fffff
    buffer_load_dwordx4 v235, s[56:59], s83 offen lds
    s_waitcnt vmcnt(8)
    v_mov_b32 v238, 1
    s_mov_b64 exec, 1
    ds_add_rtn_u32 v237, v227, v238 offset:8
    s_waitcnt lgkmcnt(0)
    v_readfirstlane_b32 s76, v237
    s_nop 0
    s_cmp_eq_u32 s76, 3
    s_cbranch_scc0 L_jo_30a
    buffer_atomic_add v238, off, s[52:55], s73 sc1
L_jo_30a:
    s_mov_b64 exec, -1
    s_cmp_ge_u32 s70, 2
    s_cbranch_scc1 L_nowo3
    s_add_u32 m0, s81, 0
    s_add_u32 s83, s82, 1835008
    s_and_b32 s83, s83, 0x1fffff
    buffer_load_dwordx4 v235, s[56:59], s83 offen lds
    s_add_u32 m0, s81, 1024
    s_add_u32 s83, s82, 1851392
    s_and_b32 s83, s83, 0x1fffff
    buffer_load_dwordx4 v235, s[56:59], s83 offen lds
    s_add_u32 m0, s81, 2048
    s_add_u32 s83, s82, 1867776
    s_and_b32 s83, s83, 0x1fffff
    buffer_load_dwordx4 v235, s[56:59], s83 offen lds
    s_add_u32 m0, s81, 3072
    s_add_u32 s83, s82, 1884160
    s_and_b32 s83, s83, 0x1fffff
    buffer_load_dwordx4 v235, s[56:59], s83 offen lds
    s_add_u32 m0, s81, 4096
    s_add_u32 s83, s82, 1900544
    s_and_b32 s83, s83, 0x1fffff
    buffer_load_dwordx4 v235, s[56:59], s83 offen lds
    s_add_u32 m0, s81, 5120
    s_add_u32 s83, s82, 1916928
    s_and_b32 s83, s83, 0x1fffff
    buffer_load_dwordx4 v235, s[56:59], s83 offen lds
    s_add_u32 m0, s81, 6144
    s_add_u32 s83, s82, 1933312
    s_and_b32 s83, s83, 0x1fffff
    buffer_load_dwordx4 v235, s[56:59], s83 offen lds
    s_add_u32 m0, s81, 7168
    s_add_u32 s83, s82, 1949696
    s_and_b32 s83, s83, 0x1fffff
    buffer_load_dwordx4 v235, s[56:59], s83 offen lds
L_nowo3:
    v_lshlrev_b32 v112, 16, v208
    v_and_b32 v113, 0xffff0000, v208
    v_lshlrev_b32 v114, 16, v209
    v_and_b32 v115, 0xffff0000, v209
    v_lshlrev_b32 v116, 16, v210
    v_and_b32 v117, 0xffff0000, v210
    v_lshlrev_b32 v118, 16, v211
    v_and_b32 v119, 0xffff0000, v211
    v_lshlrev_b32 v120, 16, v212
    v_and_b32 v121, 0xffff0000, v212
    v_lshlrev_b32 v122, 16, v213
    v_and_b32 v123, 0xffff0000, v213
    v_lshlrev_b32 v124, 16, v214
    v_and_b32 v125, 0xffff0000, v214
    v_lshlrev_b32 v126, 16, v215
    v_and_b32 v127, 0xffff0000, v215
    v_lshlrev_b32 v128, 16, v216
    v_and_b32 v129, 0xffff0000, v216
    v_lshlrev_b32 v130, 16, v217
    v_and_b32 v131, 0xffff0000, v217
    v_lshlrev_b32 v132, 16, v218
    v_and_b32 v133, 0xffff0000, v218
    v_lshlrev_b32 v134, 16, v219
    v_and_b32 v135, 0xffff0000, v219
    v_lshlrev_b32 v136, 16, v220
    v_and_b32 v137, 0xffff0000, v220
    v_lshlrev_b32 v138, 16, v221
    v_and_b32 v139, 0xffff0000, v221
    v_lshlrev_b32 v140, 16, v222
    v_and_b32 v141, 0xffff0000, v222
    v_lshlrev_b32 v142, 16, v223
    v_and_b32 v143, 0xffff0000, v223
    s_mul_i32 s77, s70, 4352
    s_add_u32 s77, s77, 60416
    v_lshrrev_b32 v234, 5, v0
    v_lshl_add_u32 v234, v234, 1, v0
    v_lshl_add_u32 v234, v234, 4, s77
    v_and_b32 v235, 7, v0
    v_mul_u32_u24 v235, 544, v235
    v_lshrrev_b32 v236, 3, v0
    v_lshl_add_u32 v235, v236, 3, v235
    v_add_u32 v235, s77, v235
    s_mul_i32 s77, s71, 4224
    s_mov_b32 s60, s26
    s_mov_b32 s61, s27
    s_mov_b32 s62, 0x800000
    s_mov_b32 s63, 0x20000
    s_waitcnt vmcnt(0)
    s_mov_b64 exec, 1
    ds_add_u32 v227, v244 offset:12
    s_mov_b64 exec, -1
    s_cmp_eq_u32 s76, 3
    s_cbranch_scc0 L_jo_30
    s_mov_b32 s75, 131072
L_sg_loop_33:
    s_load_dword s74, s[52:53], s73 glc
L_sg_chk_34:
    s_waitcnt lgkmcnt(0)
    s_cmp_ge_u32 s74, 16
    s_cbranch_scc1 L_sg_done_32
    s_sub_u32 s75, s75, 1
    s_cbranch_scc0 L_sg_loop_33
L_sg_done_32:
    v_mov_b32 v237, 16
    s_mov_b64 exec, 1
    ds_add_u32 v227, v237 offset:16
    s_mov_b64 exec, -1
    s_branch L_jd_31
L_jo_30:
    s_mov_b32 s75, 1048576
L_sl_loop_36:
    ds_read_b32 v237, v227 offset:16
    s_waitcnt lgkmcnt(0)
    v_readfirstlane_b32 s74, v237
    s_nop 0
    s_cmp_ge_u32 s74, 16
    s_cbranch_scc1 L_sl_done_35
    s_sleep 1
    s_sub_u32 s75, s75, 1
    s_cbranch_scc0 L_sl_loop_36
L_sl_done_35:
L_jd_31:
    buffer_load_dwordx4 v[48:51], v224, s[64:67], s77 offen offset:0 sc1
    buffer_load_dwordx4 v[52:55], v224, s[64:67], s77 offen offset:1024 sc1
    buffer_load_dwordx4 v[56:59], v224, s[64:67], s77 offen offset:2048 sc1
    buffer_load_dwordx4 v[60:63], v224, s[64:67], s77 offen offset:3072 sc1
    s_waitcnt vmcnt(3)
    ds_write_b128 v234, v[48:51] offset:0
    s_waitcnt vmcnt(2)
    ds_write_b128 v234, v[52:55] offset:1088
    s_waitcnt vmcnt(1)
    ds_write_b128 v234, v[56:59] offset:2176
    s_waitcnt vmcnt(0)
    ds_write_b128 v234, v[60:63] offset:3264
    ds_read_b64 v[64:65], v235 offset:0
    ds_read_b64 v[66:67], v235 offset:64
    ds_read_b64 v[68:69], v235 offset:128
    ds_read_b64 v[70:71], v235 offset:192
    ds_read_b64 v[72:73], v235 offset:256
    ds_read_b64 v[74:75], v235 offset:320
    ds_read_b64 v[76:77], v235 offset:384
    ds_read_b64 v[78:79], v235 offset:448
    s_waitcnt lgkmcnt(7)
    v_lshlrev_b32 v16, 16, v64
    v_and_b32 v24, 0xffff0000, v64
    v_lshlrev_b32 v32, 16, v65
    v_and_b32 v40, 0xffff0000, v65
    s_waitcnt lgkmcnt(6)
    v_lshlrev_b32 v17, 16, v66
    v_and_b32 v25, 0xffff0000, v66
    v_lshlrev_b32 v33, 16, v67
    v_and_b32 v41, 0xffff0000, v67
    s_waitcnt lgkmcnt(5)
    v_lshlrev_b32 v18, 16, v68
    v_and_b32 v26, 0xffff0000, v68
    v_lshlrev_b32 v34, 16, v69
    v_and_b32 v42, 0xffff0000, v69
    s_waitcnt lgkmcnt(4)
    v_lshlrev_b32 v19, 16, v70
    v_and_b32 v27, 0xffff0000, v70
    v_lshlrev_b32 v35, 16, v71
    v_and_b32 v43, 0xffff0000, v71
    s_waitcnt lgkmcnt(3)
    v_lshlrev_b32 v20, 16, v72
    v_and_b32 v28, 0xffff0000, v72
    v_lshlrev_b32 v36, 16, v73
    v_and_b32 v44, 0xffff0000, v73
    s_waitcnt lgkmcnt(2)
    v_lshlrev_b32 v21, 16, v74
    v_and_b32 v29, 0xffff0000, v74
    v_lshlrev_b32 v37, 16, v75
    v_and_b32 v45, 0xffff0000, v75
    s_waitcnt lgkmcnt(1)
    v_lshlrev_b32 v22, 16, v76
    v_and_b32 v30, 0xffff0000, v76
    v_lshlrev_b32 v38, 16, v77
    v_and_b32 v46, 0xffff0000, v77
    s_waitcnt lgkmcnt(0)
    v_lshlrev_b32 v23, 16, v78
    v_and_b32 v31, 0xffff0000, v78
    v_lshlrev_b32 v39, 16, v79
    v_and_b32 v47, 0xffff0000, v79
    v_mul_f32 v16, v16, v112
    v_mul_f32 v17, v17, v113
    v_mul_f32 v18, v18, v114
    v_mul_f32 v19, v19, v115
    v_mul_f32 v20, v20, v116
    v_mul_f32 v21, v21, v117
    v_mul_f32 v22, v22, v118
    v_mul_f32 v23, v23, v119
    v_cvt_pk_bf16_f32 v48, v16, v17
    v_cvt_pk_bf16_f32 v49, v18, v19
    v_cvt_pk_bf16_f32 v50, v20, v21
    v_cvt_pk_bf16_f32 v51, v22, v23
    s_mov_b32 s74, 0
    buffer_store_dwordx4 v[48:51], v226, s[60:63], s74 offen nt
    v_mul_f32 v24, v24, v120
    v_mul_f32 v25, v25, v121
    v_mul_f32 v26, v26, v122
    v_mul_f32 v27, v27, v123
    v_mul_f32 v28, v28, v124
    v_mul_f32 v29, v29, v125
    v_mul_f32 v30, v30, v126
    v_mul_f32 v31, v31, v127
    v_cvt_pk_bf16_f32 v52, v24, v25
    v_cvt_pk_bf16_f32 v53, v26, v27
    v_cvt_pk_bf16_f32 v54, v28, v29
    v_cvt_pk_bf16_f32 v55, v30, v31
    s_mov_b32 s74, 4096
    buffer_store_dwordx4 v[52:55], v226, s[60:63], s74 offen nt
    v_mul_f32 v32, v32, v128
    v_mul_f32 v33, v33, v129
    v_mul_f32 v34, v34, v130
    v_mul_f32 v35, v35, v131
    v_mul_f32 v36, v36, v132
    v_mul_f32 v37, v37, v133
    v_mul_f32 v38, v38, v134
    v_mul_f32 v39, v39, v135
    v_cvt_pk_bf16_f32 v56, v32, v33
    v_cvt_pk_bf16_f32 v57, v34, v35
    v_cvt_pk_bf16_f32 v58, v36, v37
    v_cvt_pk_bf16_f32 v59, v38, v39
    s_mov_b32 s74, 16384
    buffer_store_dwordx4 v[56:59], v226, s[60:63], s74 offen nt
    v_mul_f32 v40, v40, v136
    v_mul_f32 v41, v41, v137
    v_mul_f32 v42, v42, v138
    v_mul_f32 v43, v43, v139
    v_mul_f32 v44, v44, v140
    v_mul_f32 v45, v45, v141
    v_mul_f32 v46, v46, v142
    v_mul_f32 v47, v47, v143
    v_cvt_pk_bf16_f32 v60, v40, v41
    v_cvt_pk_bf16_f32 v61, v42, v43
    v_cvt_pk_bf16_f32 v62, v44, v45
    v_cvt_pk_bf16_f32 v63, v46, v47
    s_mov_b32 s74, 20480
    buffer_store_dwordx4 v[60:63], v226, s[60:63], s74 offen nt
    s_endpgm
L_grole:
    s_setprio 2
    s_lshr_b32 s32, s3, 1
    s_and_b32 s33, s3, 1
    v_and_b32 v1, 15, v0
    v_lshrrev_b32 v2, 4, v0
    v_lshrrev_b32 v3, 1, v1
    v_xor_b32 v3, v2, v3
    v_lshlrev_b32 v3, 4, v3
    v_lshl_add_u32 v3, v1, 7, v3
    s_lshl_b32 s37, s33, 13
    v_add_u32 v196, s37, v3
    v_xor_b32 v197, 64, v196
    v_and_b32 v3, 6, v1
    v_xor_b32 v3, v2, v3
    v_lshlrev_b32 v3, 4, v3
    v_and_b32 v198, 7, v1
    v_lshl_add_u32 v3, v198, 7, v3
    v_add_u32 v198, 16384, v3
    v_xor_b32 v199, 64, v198
    v_bfe_u32 v3, v0, 2, 2
    v_lshl_add_u32 v200, v2, 3, v3
    v_lshlrev_b32 v200, 7, v200
    v_bfe_u32 v3, v0, 3, 2
    v_xor_b32 v3, s3, v3
    v_lshl_add_u32 v200, v3, 5, v200
    v_and_b32 v3, 3, v0
    v_lshl_add_u32 v200, v3, 3, v200
    v_add_u32 v200, 17408, v200
    v_xor_b32 v201, 32, v200
    v_mov_b64 v[52:53], 0
    v_mov_b64 v[54:55], 0
    v_mov_b64 v[56:57], 0
    v_mov_b64 v[58:59], 0
    v_mov_b64 v[60:61], 0
    v_mov_b64 v[62:63], 0
    v_mov_b64 v[64:65], 0
    v_mov_b64 v[66:67], 0
    v_mov_b64 v[68:69], 0
    v_mov_b64 v[70:71], 0
    v_mov_b64 v[72:73], 0
    v_mov_b64 v[74:75], 0
    v_mov_b64 v[76:77], 0
    v_mov_b64 v[78:79], 0
    v_mov_b64 v[80:81], 0
    v_mov_b64 v[82:83], 0
    v_mov_b64 v[84:85], 0
    v_mov_b64 v[86:87], 0
    v_mov_b64 v[88:89], 0
    v_mov_b64 v[90:91], 0
    v_mov_b64 v[92:93], 0
    v_mov_b64 v[94:95], 0
    v_mov_b64 v[96:97], 0
    v_mov_b64 v[98:99], 0
    v_mov_b64 v[100:101], 0
    v_mov_b64 v[102:103], 0
    v_mov_b64 v[104:105], 0
    v_mov_b64 v[106:107], 0
    s_mov_b32 s34, 0
    v_mov_b32 v228, 134352
    v_and_b32 v1, 15, v0
    v_lshrrev_b32 v2, 4, v0
    v_lshlrev_b32 v2, 2, v2
    v_sub_u32 v1, v1, v2
    s_mov_b32 s37, 0xf149f2ca
    v_mov_b32 v3, s37
    s_or_b32 s38, s5, s33
    s_cmp_eq_u32 s38, 0
    s_cselect_b32 s38, s37, 0
    v_subrev_u32 v2, 0, v1
    v_cmp_gt_u32 vcc, 8, v2
    v_cmp_gt_i32 s[64:65], -8, v2
    v_ashrrev_i32 v2, 31, v2
    v_cndmask_b32 v204, v3, 0, vcc
    v_cndmask_b32 v208, v3, 0, s[64:65]
    v_mov_b32 v216, v2
    v_min_f32 v212, s38, v208
    v_subrev_u32 v2, 1, v1
    v_cmp_gt_u32 vcc, 8, v2
    v_cmp_gt_i32 s[64:65], -8, v2
    v_ashrrev_i32 v2, 31, v2
    v_cndmask_b32 v205, v3, 0, vcc
    v_cndmask_b32 v209, v3, 0, s[64:65]
    v_alignbit_b32 v216, v2, v216, 16
    v_min_f32 v213, s38, v209
    v_subrev_u32 v2, 2, v1
    v_cmp_gt_u32 vcc, 8, v2
    v_cmp_gt_i32 s[64:65], -8, v2
    v_ashrrev_i32 v2, 31, v2
    v_cndmask_b32 v206, v3, 0, vcc
    v_cndmask_b32 v210, v3, 0, s[64:65]
    v_mov_b32 v217, v2
    v_min_f32 v214, s38, v210
    v_subrev_u32 v2, 3, v1
    v_cmp_gt_u32 vcc, 8, v2
    v_cmp_gt_i32 s[64:65], -8, v2
    v_ashrrev_i32 v2, 31, v2
    v_cndmask_b32 v207, v3, 0, vcc
    v_cndmask_b32 v211, v3, 0, s[64:65]
    v_alignbit_b32 v217, v2, v217, 16
    v_min_f32 v215, s38, v211
    s_mul_i32 s37, s32, 80896
    s_add_u32 s37, s37, 78848
    v_lshl_add_u32 v220, v0, 3, s37
    s_lshl_b32 s38, s33, 9
    v_add_u32 v219, s38, v220
    s_mul_i32 s38, s33, 2560
    v_add_u32 v221, s38, v220
    v_xor_b32 v222, 512, v221
    s_lshl3_add_u32 s37, s4, s5
    s_lshl1_add_u32 s37, s37, s33
    s_lshl_b32 s37, s37, 7
    s_lshl1_add_u32 s38, s6, s32
    s_add_u32 s37, s37, s38
    s_lshl_b32 s37, s37, 10
    v_lshl_add_u32 v218, v0, 4, s37
    s_mov_b32 s40, s30
    s_mov_b32 s41, s31
    s_mov_b32 s42, 0x400000
    s_mov_b32 s43, 0x20000
    s_and_b32 s58, s2, 3
    s_bfe_u32 s37, s2, 0x20003
    s_lshl2_add_u32 s58, s58, s37
    s_bfe_u32 s59, s2, 0x10002
    s_lshr_b32 s37, s2, 5
    s_lshl3_add_u32 s59, s59, s37
    s_mov_b32 s44, s24
    s_mov_b32 s45, s25
    s_mov_b32 s46, 0x200000
    s_mov_b32 s47, 0x20000
    s_mov_b32 s48, s26
    s_mov_b32 s49, s27
    s_mov_b32 s50, 0x800000
    s_mov_b32 s51, 0x20000
    s_lshl3_add_u32 s56, s4, s5
    s_add_u32 s56, s56, 16
    s_lshl_b32 s56, s56, 8
    s_add_u32 s57, s58, 16
    s_lshl_b32 s57, s57, 8
    s_lshl2_add_u32 s37, s58, s3
    s_lshl_b32 s38, s37, 16
    v_lshl_add_u32 v224, v0, 4, s38
    v_add_u32 v225, 0x8000, v224
    s_and_b32 s37, s37, 31
    s_lshl_b32 s37, s37, 6
    s_lshr_b32 s38, s58, 3
    s_add_u32 s37, s37, s38
    s_lshl_b32 s37, s37, 5
    s_add_u32 s37, s37, s59
    s_add_u32 s37, s37, 16
    s_lshl_b32 s37, s37, 7
    v_and_b32 v1, 15, v0
    v_lshl_add_u32 v1, v1, 13, s37
    v_bfe_u32 v2, v0, 4, 1
    v_lshl_add_u32 v1, v2, 5, v1
    v_lshrrev_b32 v2, 5, v0
    v_lshl_add_u32 v226, v2, 4, v1
    v_lshrrev_b32 v1, 4, v0
    v_lshlrev_b32 v1, 1, v1
    v_xor_b32 v1, v0, v1
    v_and_b32 v1, 7, v1
    s_lshl_b32 s37, s59, 7
    v_lshl_add_u32 v1, v1, 4, s37
    v_lshrrev_b32 v227, 3, v0
    v_lshl_add_u32 v227, v227, 11, v1
    s_lshl_b32 s60, s3, 11
    s_mul_i32 s61, s59, 4
    s_and_b32 s61, s61, 7
    s_lshl3_add_u32 s62, s61, s3
    s_lshl_b32 s62, s62, 15
    v_lshrrev_b32 v1, 2, v0
    v_lshlrev_b32 v1, 7, v1
    v_bfe_u32 v2, v0, 3, 2
    v_lshl_add_u32 v1, v2, 5, v1
    v_and_b32 v2, 3, v0
    v_lshl_add_u32 v229, v2, 3, v1
    v_and_b32 v231, 7, v0
    v_lshl_add_u32 v230, v231, 6, s86
    v_mul_u32_u24 v231, 528, v231
    v_lshrrev_b32 v232, 3, v0
    v_xor_b32 v232, 7, v232
    v_lshl_add_u32 v231, v232, 3, v231
    v_add_u32 v231, s86, v231
    v_lshrrev_b32 v232, 5, v0
    v_add_u32 v232, v0, v232
    v_lshl_add_u32 v232, v232, 4, s86
    s_mul_i32 s87, s84, 4224
    s_sub_u32 s87, s87, s85
    s_lshl_b32 s87, s87, 6
    s_add_u32 s87, s87, 4032
    v_and_b32 v233, 3, v0
    v_lshl_add_u32 v233, v233, 4, s87
    v_lshrrev_b32 v234, 2, v0
    v_mul_u32_u24 v234, 4224, v234
    v_add_u32 v233, v233, v234
    s_add_u32 s80, s30, 0x400000
    s_addc_u32 s81, s31, 0
    s_mov_b32 s82, 0x420000
    s_mov_b32 s83, 0x20000
    s_waitcnt vmcnt(14)
    ds_read_b128 v[36:39], v230 offset:4224
    ds_read_b128 v[40:43], v230 offset:4240
    ds_read_b128 v[44:47], v230 offset:4256
    ds_read_b128 v[48:51], v230 offset:4272
    s_waitcnt lgkmcnt(3)
    v_lshlrev_b32 v152, 16, v36
    v_and_b32 v154, 0xffff0000, v36
    v_lshlrev_b32 v156, 16, v37
    v_and_b32 v158, 0xffff0000, v37
    v_lshlrev_b32 v153, 16, v38
    v_and_b32 v155, 0xffff0000, v38
    v_lshlrev_b32 v157, 16, v39
    v_and_b32 v159, 0xffff0000, v39
    s_waitcnt lgkmcnt(2)
    v_lshlrev_b32 v160, 16, v40
    v_and_b32 v162, 0xffff0000, v40
    v_lshlrev_b32 v164, 16, v41
    v_and_b32 v166, 0xffff0000, v41
    v_lshlrev_b32 v161, 16, v42
    v_and_b32 v163, 0xffff0000, v42
    v_lshlrev_b32 v165, 16, v43
    v_and_b32 v167, 0xffff0000, v43
    s_waitcnt lgkmcnt(1)
    v_lshlrev_b32 v168, 16, v44
    v_and_b32 v170, 0xffff0000, v44
    v_lshlrev_b32 v172, 16, v45
    v_and_b32 v174, 0xffff0000, v45
    v_lshlrev_b32 v169, 16, v46
    v_and_b32 v171, 0xffff0000, v46
    v_lshlrev_b32 v173, 16, v47
    v_and_b32 v175, 0xffff0000, v47
    s_waitcnt lgkmcnt(0)
    v_lshlrev_b32 v176, 16, v48
    v_and_b32 v178, 0xffff0000, v48
    v_lshlrev_b32 v180, 16, v49
    v_and_b32 v182, 0xffff0000, v49
    v_lshlrev_b32 v177, 16, v50
    v_and_b32 v179, 0xffff0000, v50
    v_lshlrev_b32 v181, 16, v51
    v_and_b32 v183, 0xffff0000, v51
    v_mov_b64 v[36:37], 0
    v_mov_b64 v[38:39], 0
    v_mov_b64 v[40:41], 0
    v_mov_b64 v[42:43], 0
    v_mov_b64 v[44:45], 0
    v_mov_b64 v[46:47], 0
    v_mov_b64 v[48:49], 0
    v_mov_b64 v[50:51], 0
    s_waitcnt vmcnt(13)
    v_lshlrev_b32 v184, 16, v108
    v_and_b32 v185, 0xffff0000, v108
    v_lshlrev_b32 v186, 16, v109
    v_and_b32 v187, 0xffff0000, v109
    v_lshlrev_b32 v188, 16, v110
    v_and_b32 v189, 0xffff0000, v110
    v_lshlrev_b32 v190, 16, v111
    v_and_b32 v191, 0xffff0000, v111
    v_pk_mul_f32 v[4:5], v[184:185], v[158:159]
    v_pk_mul_f32 v[12:13], v[186:187], v[166:167]
    v_pk_mul_f32 v[20:21], v[188:189], v[174:175]
    v_pk_mul_f32 v[28:29], v[190:191], v[182:183]
    s_waitcnt vmcnt(12)
    v_lshlrev_b32 v184, 16, v112
    v_and_b32 v185, 0xffff0000, v112
    v_lshlrev_b32 v186, 16, v113
    v_and_b32 v187, 0xffff0000, v113
    v_lshlrev_b32 v188, 16, v114
    v_and_b32 v189, 0xffff0000, v114
    v_lshlrev_b32 v190, 16, v115
    v_and_b32 v191, 0xffff0000, v115
    v_pk_fma_f32 v[4:5], v[184:185], v[156:157], v[4:5]
    v_pk_fma_f32 v[12:13], v[186:187], v[164:165], v[12:13]
    v_pk_fma_f32 v[20:21], v[188:189], v[172:173], v[20:21]
    v_pk_fma_f32 v[28:29], v[190:191], v[180:181], v[28:29]
    v_pk_mul_f32 v[6:7], v[184:185], v[158:159]
    v_pk_mul_f32 v[14:15], v[186:187], v[166:167]
    v_pk_mul_f32 v[22:23], v[188:189], v[174:175]
    v_pk_mul_f32 v[30:31], v[190:191], v[182:183]
    s_waitcnt vmcnt(11)
    v_lshlrev_b32 v184, 16, v116
    v_and_b32 v185, 0xffff0000, v116
    v_lshlrev_b32 v186, 16, v117
    v_and_b32 v187, 0xffff0000, v117
    v_lshlrev_b32 v188, 16, v118
    v_and_b32 v189, 0xffff0000, v118
    v_lshlrev_b32 v190, 16, v119
    v_and_b32 v191, 0xffff0000, v119
    v_pk_fma_f32 v[4:5], v[184:185], v[154:155], v[4:5]
    v_pk_fma_f32 v[12:13], v[186:187], v[162:163], v[12:13]
    v_pk_fma_f32 v[20:21], v[188:189], v[170:171], v[20:21]
    v_pk_fma_f32 v[28:29], v[190:191], v[178:179], v[28:29]
    v_pk_fma_f32 v[6:7], v[184:185], v[156:157], v[6:7]
    v_pk_fma_f32 v[14:15], v[186:187], v[164:165], v[14:15]
    v_pk_fma_f32 v[22:23], v[188:189], v[172:173], v[22:23]
    v_pk_fma_f32 v[30:31], v[190:191], v[180:181], v[30:31]
    v_pk_mul_f32 v[8:9], v[184:185], v[158:159]
    v_pk_mul_f32 v[16:17], v[186:187], v[166:167]
    v_pk_mul_f32 v[24:25], v[188:189], v[174:175]
    v_pk_mul_f32 v[32:33], v[190:191], v[182:183]
    s_waitcnt vmcnt(10)
    v_lshlrev_b32 v184, 16, v120
    v_and_b32 v185, 0xffff0000, v120
    v_lshlrev_b32 v186, 16, v121
    v_and_b32 v187, 0xffff0000, v121
    v_lshlrev_b32 v188, 16, v122
    v_and_b32 v189, 0xffff0000, v122
    v_lshlrev_b32 v190, 16, v123
    v_and_b32 v191, 0xffff0000, v123
    v_pk_fma_f32 v[4:5], v[184:185], v[152:153], v[4:5]
    v_pk_fma_f32 v[12:13], v[186:187], v[160:161], v[12:13]
    v_pk_fma_f32 v[20:21], v[188:189], v[168:169], v[20:21]
    v_pk_fma_f32 v[28:29], v[190:191], v[176:177], v[28:29]
    v_pk_fma_f32 v[6:7], v[184:185], v[154:155], v[6:7]
    v_pk_fma_f32 v[14:15], v[186:187], v[162:163], v[14:15]
    v_pk_fma_f32 v[22:23], v[188:189], v[170:171], v[22:23]
    v_pk_fma_f32 v[30:31], v[190:191], v[178:179], v[30:31]
    v_pk_fma_f32 v[8:9], v[184:185], v[156:157], v[8:9]
    v_pk_fma_f32 v[16:17], v[186:187], v[164:165], v[16:17]
    v_pk_fma_f32 v[24:25], v[188:189], v[172:173], v[24:25]
    v_pk_fma_f32 v[32:33], v[190:191], v[180:181], v[32:33]
    v_pk_mul_f32 v[10:11], v[184:185], v[158:159]
    v_pk_mul_f32 v[18:19], v[186:187], v[166:167]
    v_pk_mul_f32 v[26:27], v[188:189], v[174:175]
    v_pk_mul_f32 v[34:35], v[190:191], v[182:183]
    s_waitcnt vmcnt(9)
    v_lshlrev_b32 v184, 16, v124
    v_and_b32 v185, 0xffff0000, v124
    v_lshlrev_b32 v186, 16, v125
    v_and_b32 v187, 0xffff0000, v125
    v_lshlrev_b32 v188, 16, v126
    v_and_b32 v189, 0xffff0000, v126
    v_lshlrev_b32 v190, 16, v127
    v_and_b32 v191, 0xffff0000, v127
    v_pk_fma_f32 v[6:7], v[184:185], v[152:153], v[6:7]
    v_pk_fma_f32 v[14:15], v[186:187], v[160:161], v[14:15]
    v_pk_fma_f32 v[22:23], v[188:189], v[168:169], v[22:23]
    v_pk_fma_f32 v[30:31], v[190:191], v[176:177], v[30:31]
    v_pk_fma_f32 v[8:9], v[184:185], v[154:155], v[8:9]
    v_pk_fma_f32 v[16:17], v[186:187], v[162:163], v[16:17]
    v_pk_fma_f32 v[24:25], v[188:189], v[170:171], v[24:25]
    v_pk_fma_f32 v[32:33], v[190:191], v[178:179], v[32:33]
    v_pk_fma_f32 v[10:11], v[184:185], v[156:157], v[10:11]
    v_pk_fma_f32 v[18:19], v[186:187], v[164:165], v[18:19]
    v_pk_fma_f32 v[26:27], v[188:189], v[172:173], v[26:27]
    v_pk_fma_f32 v[34:35], v[190:191], v[180:181], v[34:35]
    s_waitcnt vmcnt(8)
    v_lshlrev_b32 v184, 16, v128
    v_and_b32 v185, 0xffff0000, v128
    v_lshlrev_b32 v186, 16, v129
    v_and_b32 v187, 0xffff0000, v129
    v_lshlrev_b32 v188, 16, v130
    v_and_b32 v189, 0xffff0000, v130
    v_lshlrev_b32 v190, 16, v131
    v_and_b32 v191, 0xffff0000, v131
    v_pk_fma_f32 v[8:9], v[184:185], v[152:153], v[8:9]
    v_pk_fma_f32 v[16:17], v[186:187], v[160:161], v[16:17]
    v_pk_fma_f32 v[24:25], v[188:189], v[168:169], v[24:25]
    v_pk_fma_f32 v[32:33], v[190:191], v[176:177], v[32:33]
    v_pk_fma_f32 v[10:11], v[184:185], v[154:155], v[10:11]
    v_pk_fma_f32 v[18:19], v[186:187], v[162:163], v[18:19]
    v_pk_fma_f32 v[26:27], v[188:189], v[170:171], v[26:27]
    v_pk_fma_f32 v[34:35], v[190:191], v[178:179], v[34:35]
    s_waitcnt vmcnt(7)
    v_lshlrev_b32 v184, 16, v132
    v_and_b32 v185, 0xffff0000, v132
    v_lshlrev_b32 v186, 16, v133
    v_and_b32 v187, 0xffff0000, v133
    v_lshlrev_b32 v188, 16, v134
    v_and_b32 v189, 0xffff0000, v134
    v_lshlrev_b32 v190, 16, v135
    v_and_b32 v191, 0xffff0000, v135
    v_pk_fma_f32 v[10:11], v[184:185], v[152:153], v[10:11]
    v_pk_fma_f32 v[18:19], v[186:187], v[160:161], v[18:19]
    v_pk_fma_f32 v[26:27], v[188:189], v[168:169], v[26:27]
    v_pk_fma_f32 v[34:35], v[190:191], v[176:177], v[34:35]
    s_waitcnt vmcnt(6)
    v_lshlrev_b32 v184, 16, v136
    v_and_b32 v185, 0xffff0000, v136
    v_lshlrev_b32 v186, 16, v137
    v_and_b32 v187, 0xffff0000, v137
    v_lshlrev_b32 v188, 16, v138
    v_and_b32 v189, 0xffff0000, v138
    v_lshlrev_b32 v190, 16, v139
    v_and_b32 v191, 0xffff0000, v139
    v_pk_mul_f32 v[4:5], v[4:5], v[184:185]
    v_pk_mul_f32 v[12:13], v[12:13], v[186:187]
    v_pk_mul_f32 v[20:21], v[20:21], v[188:189]
    v_pk_mul_f32 v[28:29], v[28:29], v[190:191]
    s_waitcnt vmcnt(5)
    v_lshlrev_b32 v184, 16, v140
    v_and_b32 v185, 0xffff0000, v140
    v_lshlrev_b32 v186, 16, v141
    v_and_b32 v187, 0xffff0000, v141
    v_lshlrev_b32 v188, 16, v142
    v_and_b32 v189, 0xffff0000, v142
    v_lshlrev_b32 v190, 16, v143
    v_and_b32 v191, 0xffff0000, v143
    v_pk_mul_f32 v[6:7], v[6:7], v[184:185]
    v_pk_mul_f32 v[14:15], v[14:15], v[186:187]
    v_pk_mul_f32 v[22:23], v[22:23], v[188:189]
    v_pk_mul_f32 v[30:31], v[30:31], v[190:191]
    s_waitcnt vmcnt(4)
    v_lshlrev_b32 v184, 16, v144
    v_and_b32 v185, 0xffff0000, v144
    v_lshlrev_b32 v186, 16, v145
    v_and_b32 v187, 0xffff0000, v145
    v_lshlrev_b32 v188, 16, v146
    v_and_b32 v189, 0xffff0000, v146
    v_lshlrev_b32 v190, 16, v147
    v_and_b32 v191, 0xffff0000, v147
    v_pk_mul_f32 v[8:9], v[8:9], v[184:185]
    v_pk_mul_f32 v[16:17], v[16:17], v[186:187]
    v_pk_mul_f32 v[24:25], v[24:25], v[188:189]
    v_pk_mul_f32 v[32:33], v[32:33], v[190:191]
    s_waitcnt vmcnt(3)
    v_lshlrev_b32 v184, 16, v148
    v_and_b32 v185, 0xffff0000, v148
    v_lshlrev_b32 v186, 16, v149
    v_and_b32 v187, 0xffff0000, v149
    v_lshlrev_b32 v188, 16, v150
    v_and_b32 v189, 0xffff0000, v150
    v_lshlrev_b32 v190, 16, v151
    v_and_b32 v191, 0xffff0000, v151
    v_pk_mul_f32 v[10:11], v[10:11], v[184:185]
    v_pk_mul_f32 v[18:19], v[18:19], v[186:187]
    v_pk_mul_f32 v[26:27], v[26:27], v[188:189]
    v_pk_mul_f32 v[34:35], v[34:35], v[190:191]
    v_cvt_pk_bf16_f32 v108, v10, v8
    v_cvt_pk_bf16_f32 v109, v6, v4
    ds_write_b64 v231, v[108:109] offset:0
    v_cvt_pk_bf16_f32 v110, v11, v9
    v_cvt_pk_bf16_f32 v111, v7, v5
    ds_write_b64 v231, v[110:111] offset:64
    v_cvt_pk_bf16_f32 v112, v18, v16
    v_cvt_pk_bf16_f32 v113, v14, v12
    ds_write_b64 v231, v[112:113] offset:128
    v_cvt_pk_bf16_f32 v114, v19, v17
    v_cvt_pk_bf16_f32 v115, v15, v13
    ds_write_b64 v231, v[114:115] offset:192
    v_cvt_pk_bf16_f32 v116, v26, v24
    v_cvt_pk_bf16_f32 v117, v22, v20
    ds_write_b64 v231, v[116:117] offset:256
    v_cvt_pk_bf16_f32 v118, v27, v25
    v_cvt_pk_bf16_f32 v119, v23, v21
    ds_write_b64 v231, v[118:119] offset:320
    v_cvt_pk_bf16_f32 v120, v34, v32
    v_cvt_pk_bf16_f32 v121, v30, v28
    ds_write_b64 v231, v[120:121] offset:384
    v_cvt_pk_bf16_f32 v122, v35, v33
    v_cvt_pk_bf16_f32 v123, v31, v29
    ds_write_b64 v231, v[122:123] offset:448
    ds_read_b128 v[152:155], v232 offset:0
    ds_read_b128 v[156:159], v232 offset:1056
    ds_read_b128 v[160:163], v232 offset:2112
    ds_read_b128 v[164:167], v232 offset:3168
    v_mov_b64 v[4:5], 0
    v_mov_b64 v[6:7], 0
    v_mov_b64 v[8:9], 0
    v_mov_b64 v[10:11], 0
    v_mov_b64 v[12:13], 0
    v_mov_b64 v[14:15], 0
    v_mov_b64 v[16:17], 0
    v_mov_b64 v[18:19], 0
    v_mov_b64 v[20:21], 0
    v_mov_b64 v[22:23], 0
    v_mov_b64 v[24:25], 0
    v_mov_b64 v[26:27], 0
    v_mov_b64 v[28:29], 0
    v_mov_b64 v[30:31], 0
    v_mov_b64 v[32:33], 0
    v_mov_b64 v[34:35], 0
    s_mov_b32 s87, 0
    s_waitcnt lgkmcnt(3)
    buffer_store_dwordx4 v[152:155], v233, s[80:83], s87 offen sc1
    s_mov_b32 s87, 67584
    s_waitcnt lgkmcnt(2)
    buffer_store_dwordx4 v[156:159], v233, s[80:83], s87 offen sc1
    s_mov_b32 s87, 135168
    s_waitcnt lgkmcnt(1)
    buffer_store_dwordx4 v[160:163], v233, s[80:83], s87 offen sc1
    s_mov_b32 s87, 202752
    s_waitcnt lgkmcnt(0)
    buffer_store_dwordx4 v[164:167], v233, s[80:83], s87 offen sc1
    s_cmp_lg_u32 s7, 0
    s_cbranch_scc1 L_noinit2
    s_mov_b32 s64, s28
    s_mov_b32 s65, s29
    s_mov_b32 s66, 0x100
    s_mov_b32 s67, 0x20000
    v_mov_b32 v2, 1
    s_mov_b64 exec, 1
    buffer_store_dword v2, off, s[64:67], 0 sc1
    s_mov_b64 exec, -1
L_noinit2:
    s_mov_b32 s37, 41984
    s_mov_b32 s36, 15
    s_barrier
    ds_read_b128 v[108:111], v196 offset:0
    ds_read_b64_tr_b16 v[128:129], v200 offset:0
    ds_read_b64_tr_b16 v[130:131], v200 offset:512
    ds_read_b128 v[112:115], v196 offset:2048
    ds_read_b64_tr_b16 v[132:133], v201 offset:0
    ds_read_b64_tr_b16 v[134:135], v201 offset:512
    ds_read_b128 v[116:119], v196 offset:4096
    ds_read_b64_tr_b16 v[136:137], v200 offset:8192
    ds_read_b64_tr_b16 v[138:139], v200 offset:8704
    ds_read_b128 v[120:123], v196 offset:6144
    ds_read_b64_tr_b16 v[140:141], v201 offset:8192
    ds_read_b64_tr_b16 v[142:143], v201 offset:8704
    ds_read_b128 v[124:127], v198
    ds_read_b64_tr_b16 v[144:145], v200 offset:16384
    ds_read_b64_tr_b16 v[146:147], v200 offset:16896
    ds_read_b64_tr_b16 v[148:149], v201 offset:16384
    ds_read_b64_tr_b16 v[150:151], v201 offset:16896
    s_waitcnt lgkmcnt(0)
L_g1_loop:
    v_mfma_f32_16x16x32_bf16 v[4:7], v[128:131], v[108:111], v[4:7]
    ds_read_b128 v[152:155], v197 offset:0
    v_mfma_f32_16x16x32_bf16 v[12:15], v[128:131], v[112:115], v[12:15]
    ds_read_b64_tr_b16 v[172:173], v200 offset:4096
    v_mfma_f32_16x16x32_bf16 v[20:23], v[128:131], v[116:119], v[20:23]
    ds_read_b64_tr_b16 v[174:175], v200 offset:4608
    v_mfma_f32_16x16x32_bf16 v[28:31], v[128:131], v[120:123], v[28:31]
    ds_read_b128 v[156:159], v197 offset:2048
    v_mfma_f32_16x16x32_bf16 v[8:11], v[132:135], v[108:111], v[8:11]
    ds_read_b64_tr_b16 v[176:177], v201 offset:4096
    v_mfma_f32_16x16x32_bf16 v[16:19], v[132:135], v[112:115], v[16:19]
    ds_read_b64_tr_b16 v[178:179], v201 offset:4608
    v_mfma_f32_16x16x32_bf16 v[24:27], v[132:135], v[116:119], v[24:27]
    ds_read_b128 v[160:163], v197 offset:4096
    v_mfma_f32_16x16x32_bf16 v[32:35], v[132:135], v[120:123], v[32:35]
    ds_read_b64_tr_b16 v[180:181], v200 offset:12288
    v_mfma_f32_16x16x32_bf16 v[36:39], v[136:139], v[108:111], v[36:39]
    ds_read_b64_tr_b16 v[182:183], v200 offset:12800
    v_mfma_f32_16x16x32_bf16 v[44:47], v[136:139], v[112:115], v[44:47]
    ds_read_b128 v[164:167], v197 offset:6144
    v_mfma_f32_16x16x32_bf16 v[52:55], v[136:139], v[116:119], v[52:55]
    ds_read_b64_tr_b16 v[184:185], v201 offset:12288
    v_mfma_f32_16x16x32_bf16 v[60:63], v[136:139], v[120:123], v[60:63]
    ds_read_b64_tr_b16 v[186:187], v201 offset:12800
    v_mfma_f32_16x16x32_bf16 v[100:103], v[136:139], v[124:127], v[100:103]
    ds_read_b128 v[168:171], v199
    v_mfma_f32_16x16x32_bf16 v[40:43], v[140:143], v[108:111], v[40:43]
    ds_read_b64_tr_b16 v[188:189], v200 offset:20480
    v_mfma_f32_16x16x32_bf16 v[48:51], v[140:143], v[112:115], v[48:51]
    ds_read_b64_tr_b16 v[190:191], v200 offset:20992
    v_mfma_f32_16x16x32_bf16 v[56:59], v[140:143], v[116:119], v[56:59]
    ds_read_b64_tr_b16 v[192:193], v201 offset:20480
    v_mfma_f32_16x16x32_bf16 v[64:67], v[140:143], v[120:123], v[64:67]
    ds_read_b64_tr_b16 v[194:195], v201 offset:20992
    v_mfma_f32_16x16x32_bf16 v[68:71], v[108:111], v[144:147], v[68:71]
    ds_read_b32 v1, v228 offset:24
    v_mfma_f32_16x16x32_bf16 v[76:79], v[112:115], v[144:147], v[76:79]
    s_add_u32 s34, s34, 41984
    v_mfma_f32_16x16x32_bf16 v[84:87], v[116:119], v[144:147], v[84:87]
    s_cmp_eq_u32 s34, 125952
    v_mfma_f32_16x16x32_bf16 v[92:95], v[120:123], v[144:147], v[92:95]
    s_cselect_b32 s35, -83968, s37
    v_mfma_f32_16x16x32_bf16 v[104:107], v[124:127], v[144:147], v[104:107]
    s_cselect_b32 s34, 0, s34
    v_mfma_f32_16x16x32_bf16 v[72:75], v[108:111], v[148:151], v[72:75]
    s_bitcmp1_b32 0x1002, s36
    s_waitcnt lgkmcnt(0)
    v_mfma_f32_16x16x32_bf16 v[80:83], v[112:115], v[148:151], v[80:83]
    v_add_u32 v196, s35, v196
    v_add_u32 v197, s35, v197
    v_mfma_f32_16x16x32_bf16 v[88:91], v[116:119], v[148:151], v[88:91]
    v_add_u32 v198, s35, v198
    v_add_u32 v199, s35, v199
    v_mfma_f32_16x16x32_bf16 v[96:99], v[120:123], v[148:151], v[96:99]
    v_add_u32 v200, s35, v200
    v_add_u32 v201, s35, v201
    s_cbranch_scc1 L_g1_rare
L_g1_bar:
    s_barrier
L_g1_nobar:
    v_mfma_f32_16x16x32_bf16 v[4:7], v[172:175], v[152:155], v[4:7]
    ds_read_b128 v[108:111], v196 offset:0
    v_mfma_f32_16x16x32_bf16 v[12:15], v[172:175], v[156:159], v[12:15]
    ds_read_b64_tr_b16 v[128:129], v200 offset:0
    v_mfma_f32_16x16x32_bf16 v[20:23], v[172:175], v[160:163], v[20:23]
    ds_read_b64_tr_b16 v[130:131], v200 offset:512
    v_mfma_f32_16x16x32_bf16 v[28:31], v[172:175], v[164:167], v[28:31]
    ds_read_b128 v[112:115], v196 offset:2048
    v_mfma_f32_16x16x32_bf16 v[8:11], v[176:179], v[152:155], v[8:11]
    ds_read_b64_tr_b16 v[132:133], v201 offset:0
    v_mfma_f32_16x16x32_bf16 v[16:19], v[176:179], v[156:159], v[16:19]
    ds_read_b64_tr_b16 v[134:135], v201 offset:512
    v_mfma_f32_16x16x32_bf16 v[24:27], v[176:179], v[160:163], v[24:27]
    ds_read_b128 v[116:119], v196 offset:4096
    v_mfma_f32_16x16x32_bf16 v[32:35], v[176:179], v[164:167], v[32:35]
    ds_read_b64_tr_b16 v[136:137], v200 offset:8192
    v_mfma_f32_16x16x32_bf16 v[36:39], v[180:183], v[152:155], v[36:39]
    ds_read_b64_tr_b16 v[138:139], v200 offset:8704
    v_mfma_f32_16x16x32_bf16 v[44:47], v[180:183], v[156:159], v[44:47]
    ds_read_b128 v[120:123], v196 offset:6144
    v_mfma_f32_16x16x32_bf16 v[52:55], v[180:183], v[160:163], v[52:55]
    ds_read_b64_tr_b16 v[140:141], v201 offset:8192
    v_mfma_f32_16x16x32_bf16 v[60:63], v[180:183], v[164:167], v[60:63]
    ds_read_b64_tr_b16 v[142:143], v201 offset:8704
    v_mfma_f32_16x16x32_bf16 v[100:103], v[180:183], v[168:171], v[100:103]
    ds_read_b128 v[124:127], v198
    v_mfma_f32_16x16x32_bf16 v[40:43], v[184:187], v[152:155], v[40:43]
    ds_read_b64_tr_b16 v[144:145], v200 offset:16384
    v_mfma_f32_16x16x32_bf16 v[48:51], v[184:187], v[156:159], v[48:51]
    ds_read_b64_tr_b16 v[146:147], v200 offset:16896
    v_mfma_f32_16x16x32_bf16 v[56:59], v[184:187], v[160:163], v[56:59]
    ds_read_b64_tr_b16 v[148:149], v201 offset:16384
    v_mfma_f32_16x16x32_bf16 v[64:67], v[184:187], v[164:167], v[64:67]
    ds_read_b64_tr_b16 v[150:151], v201 offset:16896
    v_mfma_f32_16x16x32_bf16 v[68:71], v[152:155], v[188:191], v[68:71]
    s_sub_u32 s36, s36, 1
    v_mfma_f32_16x16x32_bf16 v[76:79], v[156:159], v[188:191], v[76:79]
    s_cmp_lg_u32 s36, 0
    v_mfma_f32_16x16x32_bf16 v[84:87], v[160:163], v[188:191], v[84:87]
    v_mfma_f32_16x16x32_bf16 v[92:95], v[164:167], v[188:191], v[92:95]
    v_mfma_f32_16x16x32_bf16 v[104:107], v[168:171], v[188:191], v[104:107]
    v_mfma_f32_16x16x32_bf16 v[72:75], v[152:155], v[192:195], v[72:75]
    v_mfma_f32_16x16x32_bf16 v[80:83], v[156:159], v[192:195], v[80:83]
    v_mfma_f32_16x16x32_bf16 v[88:91], v[160:163], v[192:195], v[88:91]
    v_mfma_f32_16x16x32_bf16 v[96:99], v[164:167], v[192:195], v[96:99]
    s_waitcnt lgkmcnt(0)
    s_cbranch_scc1 L_g1_loop
    v_mfma_f32_16x16x32_bf16 v[4:7], v[128:131], v[108:111], v[4:7]
    ds_read_b128 v[152:155], v197 offset:0
    v_mfma_f32_16x16x32_bf16 v[12:15], v[128:131], v[112:115], v[12:15]
    ds_read_b64_tr_b16 v[172:173], v200 offset:4096
    v_mfma_f32_16x16x32_bf16 v[20:23], v[128:131], v[116:119], v[20:23]
    ds_read_b64_tr_b16 v[174:175], v200 offset:4608
    v_mfma_f32_16x16x32_bf16 v[28:31], v[128:131], v[120:123], v[28:31]
    ds_read_b128 v[156:159], v197 offset:2048
    v_mfma_f32_16x16x32_bf16 v[8:11], v[132:135], v[108:111], v[8:11]
    ds_read_b64_tr_b16 v[176:177], v201 offset:4096
    v_mfma_f32_16x16x32_bf16 v[16:19], v[132:135], v[112:115], v[16:19]
    ds_read_b64_tr_b16 v[178:179], v201 offset:4608
    v_mfma_f32_16x16x32_bf16 v[24:27], v[132:135], v[116:119], v[24:27]
    ds_read_b128 v[160:163], v197 offset:4096
    v_mfma_f32_16x16x32_bf16 v[32:35], v[132:135], v[120:123], v[32:35]
    ds_read_b64_tr_b16 v[180:181], v200 offset:12288
    v_mfma_f32_16x16x32_bf16 v[36:39], v[136:139], v[108:111], v[36:39]
    ds_read_b64_tr_b16 v[182:183], v200 offset:12800
    v_mfma_f32_16x16x32_bf16 v[44:47], v[136:139], v[112:115], v[44:47]
    ds_read_b128 v[164:167], v197 offset:6144
    v_mfma_f32_16x16x32_bf16 v[52:55], v[136:139], v[116:119], v[52:55]
    ds_read_b64_tr_b16 v[184:185], v201 offset:12288
    v_mfma_f32_16x16x32_bf16 v[60:63], v[136:139], v[120:123], v[60:63]
    ds_read_b64_tr_b16 v[186:187], v201 offset:12800
    v_mfma_f32_16x16x32_bf16 v[100:103], v[136:139], v[124:127], v[100:103]
    ds_read_b128 v[168:171], v199
    v_mfma_f32_16x16x32_bf16 v[40:43], v[140:143], v[108:111], v[40:43]
    ds_read_b64_tr_b16 v[188:189], v200 offset:20480
    v_mfma_f32_16x16x32_bf16 v[48:51], v[140:143], v[112:115], v[48:51]
    ds_read_b64_tr_b16 v[190:191], v200 offset:20992
    v_mfma_f32_16x16x32_bf16 v[56:59], v[140:143], v[116:119], v[56:59]
    ds_read_b64_tr_b16 v[192:193], v201 offset:20480
    v_mfma_f32_16x16x32_bf16 v[64:67], v[140:143], v[120:123], v[64:67]
    ds_read_b64_tr_b16 v[194:195], v201 offset:20992
    v_mfma_f32_16x16x32_bf16 v[68:71], v[108:111], v[144:147], v[68:71]
    v_mfma_f32_16x16x32_bf16 v[76:79], v[112:115], v[144:147], v[76:79]
    v_mfma_f32_16x16x32_bf16 v[84:87], v[116:119], v[144:147], v[84:87]
    v_mfma_f32_16x16x32_bf16 v[92:95], v[120:123], v[144:147], v[92:95]
    v_mfma_f32_16x16x32_bf16 v[104:107], v[124:127], v[144:147], v[104:107]
    v_mfma_f32_16x16x32_bf16 v[72:75], v[108:111], v[148:151], v[72:75]
    v_mfma_f32_16x16x32_bf16 v[80:83], v[112:115], v[148:151], v[80:83]
    v_mfma_f32_16x16x32_bf16 v[88:91], v[116:119], v[148:151], v[88:91]
    v_mfma_f32_16x16x32_bf16 v[96:99], v[120:123], v[148:151], v[96:99]
    s_waitcnt lgkmcnt(0)
    s_setprio 2
    v_mov_b32 v2, 1
    v_mfma_f32_16x16x32_bf16 v[100:103], v[180:183], v[168:171], v[100:103]
    v_mfma_f32_16x16x32_bf16 v[104:107], v[168:171], v[188:191], v[104:107]
    v_mfma_f32_16x16x32_bf16 v[60:63], v[180:183], v[164:167], v[60:63]
    v_mfma_f32_16x16x32_bf16 v[64:67], v[184:187], v[164:167], v[64:67]
    v_mfma_f32_16x16x32_bf16 v[92:95], v[164:167], v[188:191], v[92:95]
    v_mfma_f32_16x16x32_bf16 v[96:99], v[164:167], v[192:195], v[96:99]
    v_mfma_f32_16x16x32_bf16 v[28:31], v[172:175], v[164:167], v[28:31]
    v_mfma_f32_16x16x32_bf16 v[32:35], v[176:179], v[164:167], v[32:35]
    v_mfma_f32_16x16x32_bf16 v[52:55], v[180:183], v[160:163], v[52:55]
    v_cvt_pk_bf16_f32 v144, v100, v101
    v_cvt_pk_bf16_f32 v145, v102, v103
    v_mfma_f32_16x16x32_bf16 v[56:59], v[184:187], v[160:163], v[56:59]
    ds_write_b64 v219, v[144:145]
    v_cvt_pk_bf16_f32 v146, v104, v105
    v_mfma_f32_16x16x32_bf16 v[20:23], v[172:175], v[160:163], v[20:23]
    v_cvt_pk_bf16_f32 v147, v106, v107
    ds_write_b64 v219, v[146:147] offset:1024
    v_mfma_f32_16x16x32_bf16 v[24:27], v[176:179], v[160:163], v[24:27]
    v_cvt_pk_bf16_f32 v140, v60, v61
    v_cvt_pk_bf16_f32 v141, v62, v63
    v_mfma_f32_16x16x32_bf16 v[44:47], v[180:183], v[156:159], v[44:47]
    v_cvt_pk_bf16_f32 v142, v64, v65
    v_cvt_pk_bf16_f32 v143, v66, v67
    v_mfma_f32_16x16x32_bf16 v[48:51], v[184:187], v[156:159], v[48:51]
    v_cvt_pk_bf16_f32 v238, v92, v93
    v_cvt_pk_bf16_f32 v239, v94, v95
    v_mfma_f32_16x16x32_bf16 v[12:15], v[172:175], v[156:159], v[12:15]
    v_cvt_pk_bf16_f32 v248, v96, v97
    v_cvt_pk_bf16_f32 v249, v98, v99
    v_mfma_f32_16x16x32_bf16 v[16:19], v[176:179], v[156:159], v[16:19]
    s_cmp_eq_u32 s33, 0
    s_cbranch_scc0 L_at_nopub
    ds_write_b64 v220, v[140:141] offset:2048
    ds_write_b64 v220, v[238:239] offset:3072
    ds_write_b64 v220, v[142:143] offset:2560
    ds_write_b64 v220, v[248:249] offset:3584
L_at_nopub:
    s_mov_b64 exec, 1
    ds_add_u32 v228, v2 offset:20
    s_mov_b64 exec, -1
    v_cvt_pk_bf16_f32 v120, v28, v29
    v_mfma_f32_16x16x32_bf16 v[36:39], v[180:183], v[152:155], v[36:39]
    v_cvt_pk_bf16_f32 v121, v30, v31
    v_cvt_pk_bf16_f32 v122, v32, v33
    v_mfma_f32_16x16x32_bf16 v[40:43], v[184:187], v[152:155], v[40:43]
    v_cvt_pk_bf16_f32 v123, v34, v35
    v_cvt_pk_bf16_f32 v136, v52, v53
    v_mfma_f32_16x16x32_bf16 v[4:7], v[172:175], v[152:155], v[4:7]
    v_cvt_pk_bf16_f32 v137, v54, v55
    v_cvt_pk_bf16_f32 v138, v56, v57
    v_mfma_f32_16x16x32_bf16 v[8:11], v[176:179], v[152:155], v[8:11]
    v_cvt_pk_bf16_f32 v139, v58, v59
    v_cvt_pk_bf16_f32 v116, v20, v21
    v_mfma_f32_16x16x32_bf16 v[84:87], v[160:163], v[188:191], v[84:87]
    v_cvt_pk_bf16_f32 v117, v22, v23
    v_cvt_pk_bf16_f32 v118, v24, v25
    v_mfma_f32_16x16x32_bf16 v[88:91], v[160:163], v[192:195], v[88:91]
    v_cvt_pk_bf16_f32 v119, v26, v27
    v_cvt_pk_bf16_f32 v132, v44, v45
    v_mfma_f32_16x16x32_bf16 v[76:79], v[156:159], v[188:191], v[76:79]
    v_cvt_pk_bf16_f32 v133, v46, v47
    v_cvt_pk_bf16_f32 v134, v48, v49
    v_mfma_f32_16x16x32_bf16 v[80:83], v[156:159], v[192:195], v[80:83]
    v_cvt_pk_bf16_f32 v135, v50, v51
    v_cvt_pk_bf16_f32 v112, v12, v13
    v_mfma_f32_16x16x32_bf16 v[68:71], v[152:155], v[188:191], v[68:71]
    v_cvt_pk_bf16_f32 v113, v14, v15
    v_cvt_pk_bf16_f32 v114, v16, v17
    v_mfma_f32_16x16x32_bf16 v[72:75], v[152:155], v[192:195], v[72:75]
    v_cvt_pk_bf16_f32 v115, v18, v19
    v_cvt_pk_bf16_f32 v128, v36, v37
    v_mfma_f32_16x16x32_bf16 v[28:31], v[140:143], v[120:123], v[204:207]
    v_cvt_pk_bf16_f32 v129, v38, v39
    v_cvt_pk_bf16_f32 v130, v40, v41
    v_mfma_f32_16x16x32_bf16 v[32:35], v[136:139], v[120:123], v[208:211]
    v_cvt_pk_bf16_f32 v131, v42, v43
    v_cvt_pk_bf16_f32 v108, v4, v5
    v_mfma_f32_16x16x32_bf16 v[20:23], v[136:139], v[116:119], v[204:207]
    v_cvt_pk_bf16_f32 v109, v6, v7
    v_cvt_pk_bf16_f32 v110, v8, v9
    v_mfma_f32_16x16x32_bf16 v[24:27], v[132:135], v[116:119], v[208:211]
    v_cvt_pk_bf16_f32 v111, v10, v11
    v_cvt_pk_bf16_f32 v236, v84, v85
    v_mfma_f32_16x16x32_bf16 v[12:15], v[132:135], v[112:115], v[204:207]
    v_cvt_pk_bf16_f32 v237, v86, v87
    v_cvt_pk_bf16_f32 v246, v88, v89
    v_mfma_f32_16x16x32_bf16 v[16:19], v[128:131], v[112:115], v[208:211]
    v_cvt_pk_bf16_f32 v247, v90, v91
    v_cvt_pk_bf16_f32 v234, v76, v77
    v_mfma_f32_16x16x32_bf16 v[4:7], v[128:131], v[108:111], v[204:207]
    v_cvt_pk_bf16_f32 v235, v78, v79
    ds_read_b32 v1, v228 offset:20
    v_cvt_pk_bf16_f32 v244, v80, v81
    v_cvt_pk_bf16_f32 v245, v82, v83
    v_cvt_pk_bf16_f32 v232, v68, v69
    v_cvt_pk_bf16_f32 v233, v70, v71
    v_cvt_pk_bf16_f32 v242, v72, v73
    v_cvt_pk_bf16_f32 v243, v74, v75
    s_waitcnt lgkmcnt(0)
    v_readfirstlane_b32 s37, v1
    s_nop 0
    s_cmp_ge_u32 s37, 4
    s_cbranch_scc1 L_sl_done_37
    s_mov_b32 s38, 1048576
L_sl_loop_38:
    ds_read_b32 v1, v228 offset:20
    s_waitcnt lgkmcnt(0)
    v_readfirstlane_b32 s37, v1
    s_nop 0
    s_cmp_ge_u32 s37, 4
    s_cbranch_scc1 L_sl_done_37
    s_sleep 1
    s_sub_u32 s38, s38, 1
    s_cbranch_scc0 L_sl_loop_38
L_sl_done_37:
    ds_read_b64 v[124:125], v221
    ds_read_b64 v[126:127], v222
    ds_read_b64 v[230:231], v221 offset:1024
    ds_read_b64 v[240:241], v222 offset:1024
    v_max_f32 v28, v28, v32
    v_max_f32 v29, v29, v33
    v_max_f32 v30, v30, v34
    v_max_f32 v31, v31, v35
    v_max3_f32 v39, v28, v29, v30
    v_max_f32 v39, v39, v31
    v_max_f32 v20, v20, v24
    v_max_f32 v21, v21, v25
    v_max_f32 v22, v22, v26
    v_max_f32 v23, v23, v27
    v_max3_f32 v38, v20, v21, v22
    v_max_f32 v38, v38, v23
    s_waitcnt lgkmcnt(2)
    v_mfma_f32_16x16x32_bf16 v[8:11], v[124:127], v[108:111], v[212:215]
    s_mov_b32 s37, 0x3e8293ee
    v_max_f32 v12, v12, v16
    v_max_f32 v13, v13, v17
    v_max_f32 v14, v14, v18
    v_max_f32 v15, v15, v19
    v_max3_f32 v37, v12, v13, v14
    v_max_f32 v37, v37, v15
    s_nop 0
    v_max_f32 v4, v4, v8
    v_max_f32 v5, v5, v9
    v_max_f32 v6, v6, v10
    v_max_f32 v7, v7, v11
    v_max3_f32 v36, v4, v5, v6
    v_max_f32 v36, v36, v7
    v_permlane32_swap_b32 v38, v39
    s_nop 0
    v_permlane32_swap_b32 v36, v37
    v_max_f32 v38, v38, v39
    v_max_f32 v36, v36, v37
    s_nop 1
    v_permlane16_swap_b32 v36, v38
    v_max_f32 v36, v36, v38
    v_mul_f32 v38, s37, v36
    v_mul_f32 v36, s37, v36
    s_nop 1
    v_permlane16_swap_b32 v36, v38
    v_mov_b32 v37, v36
    v_mov_b32 v39, v38
    s_nop 0
    v_permlane32_swap_b32 v36, v37
    v_permlane32_swap_b32 v38, v39
    v_fma_f32 v4, v4, s37, -v36
    v_fma_f32 v5, v5, s37, -v36
    v_fma_f32 v6, v6, s37, -v36
    v_fma_f32 v7, v7, s37, -v36
    v_fma_f32 v12, v12, s37, -v37
    v_fma_f32 v13, v13, s37, -v37
    v_fma_f32 v14, v14, s37, -v37
    v_fma_f32 v15, v15, s37, -v37
    v_fma_f32 v20, v20, s37, -v38
    v_fma_f32 v21, v21, s37, -v38
    v_fma_f32 v22, v22, s37, -v38
    v_fma_f32 v23, v23, s37, -v38
    v_fma_f32 v28, v28, s37, -v39
    v_fma_f32 v29, v29, s37, -v39
    v_fma_f32 v30, v30, s37, -v39
    v_fma_f32 v31, v31, s37, -v39
    v_exp_f32 v28, v28
    v_exp_f32 v29, v29
    v_exp_f32 v30, v30
    v_exp_f32 v31, v31
    v_exp_f32 v20, v20
    v_exp_f32 v21, v21
    v_exp_f32 v22, v22
    v_exp_f32 v23, v23
    v_exp_f32 v12, v12
    v_exp_f32 v13, v13
    v_exp_f32 v14, v14
    v_exp_f32 v15, v15
    v_exp_f32 v4, v4
    v_exp_f32 v5, v5
    v_exp_f32 v6, v6
    v_exp_f32 v7, v7
    v_add_f32 v39, v28, v29
    v_add_f32 v32, v30, v31
    v_add_f32 v39, v39, v32
    v_add_f32 v38, v20, v21
    v_add_f32 v24, v22, v23
    v_add_f32 v38, v38, v24
    v_add_f32 v37, v12, v13
    v_add_f32 v16, v14, v15
    v_add_f32 v37, v37, v16
    v_add_f32 v36, v4, v5
    v_add_f32 v8, v6, v7
    v_add_f32 v36, v36, v8
    v_permlane32_swap_b32 v38, v39
    s_nop 0
    v_permlane32_swap_b32 v36, v37
    v_add_f32 v38, v38, v39
    v_add_f32 v36, v36, v37
    s_nop 1
    v_permlane16_swap_b32 v36, v38
    v_add_f32 v36, v36, v38
    v_rcp_f32 v38, v36
    v_rcp_f32 v36, v36
    s_nop 1
    v_permlane16_swap_b32 v36, v38
    v_mov_b32 v37, v36
    v_mov_b32 v39, v38
    s_nop 0
    v_permlane32_swap_b32 v36, v37
    v_permlane32_swap_b32 v38, v39
    s_waitcnt lgkmcnt(0)
    s_cmp_eq_u32 s33, 0
    v_mul_f32 v4, v4, v36
    v_mul_f32 v5, v5, v36
    v_mul_f32 v6, v6, v36
    v_mul_f32 v7, v7, v36
    v_cvt_pk_bf16_f32 v10, v4, v5
    v_cvt_pk_bf16_f32 v11, v6, v7
    v_and_b32 v8, v216, v10
    v_and_b32 v9, v217, v11
    v_xor_b32 v10, v8, v10
    v_xor_b32 v11, v9, v11
    s_nop 1
    v_mfma_f32_16x16x32_bf16 v[68:71], v[230:233], v[8:11], 0
    v_mfma_f32_16x16x32_bf16 v[72:75], v[240:243], v[8:11], 0
    v_mul_f32 v12, v12, v37
    v_mul_f32 v13, v13, v37
    v_mul_f32 v14, v14, v37
    v_mul_f32 v15, v15, v37
    v_cvt_pk_bf16_f32 v18, v12, v13
    v_cvt_pk_bf16_f32 v19, v14, v15
    v_and_b32 v16, v216, v18
    v_and_b32 v17, v217, v19
    v_xor_b32 v18, v16, v18
    v_xor_b32 v19, v17, v19
    v_cvt_pk_bf16_f32 v108, v68, v69
    v_cvt_pk_bf16_f32 v109, v70, v71
    v_cvt_pk_bf16_f32 v110, v72, v73
    v_cvt_pk_bf16_f32 v111, v74, v75
    s_cbranch_scc1 L_at_noswap0
    v_swap_b32 v108, v110
    v_swap_b32 v109, v111
L_at_noswap0:
    s_mov_b32 s37, 0
    buffer_store_dwordx4 v[108:111], v218, s[40:43], s37 offen sc1
    v_mfma_f32_16x16x32_bf16 v[76:79], v[232:235], v[16:19], 0
    v_mfma_f32_16x16x32_bf16 v[80:83], v[242:245], v[16:19], 0
    v_mul_f32 v20, v20, v38
    v_mul_f32 v21, v21, v38
    v_mul_f32 v22, v22, v38
    v_mul_f32 v23, v23, v38
    v_cvt_pk_bf16_f32 v26, v20, v21
    v_cvt_pk_bf16_f32 v27, v22, v23
    v_and_b32 v24, v216, v26
    v_and_b32 v25, v217, v27
    v_xor_b32 v26, v24, v26
    v_xor_b32 v27, v25, v27
    v_cvt_pk_bf16_f32 v112, v76, v77
    v_cvt_pk_bf16_f32 v113, v78, v79
    v_cvt_pk_bf16_f32 v114, v80, v81
    v_cvt_pk_bf16_f32 v115, v82, v83
    s_cbranch_scc1 L_at_noswap1
    v_swap_b32 v112, v114
    v_swap_b32 v113, v115
L_at_noswap1:
    s_mov_b32 s37, 32768
    buffer_store_dwordx4 v[112:115], v218, s[40:43], s37 offen sc1
    v_mfma_f32_16x16x32_bf16 v[84:87], v[234:237], v[24:27], 0
    v_mfma_f32_16x16x32_bf16 v[88:91], v[244:247], v[24:27], 0
    v_mul_f32 v28, v28, v39
    v_mul_f32 v29, v29, v39
    v_mul_f32 v30, v30, v39
    v_mul_f32 v31, v31, v39
    v_cvt_pk_bf16_f32 v34, v28, v29
    v_cvt_pk_bf16_f32 v35, v30, v31
    v_and_b32 v32, v216, v34
    v_and_b32 v33, v217, v35
    v_xor_b32 v34, v32, v34
    v_xor_b32 v35, v33, v35
    v_cvt_pk_bf16_f32 v116, v84, v85
    v_cvt_pk_bf16_f32 v117, v86, v87
    v_cvt_pk_bf16_f32 v118, v88, v89
    v_cvt_pk_bf16_f32 v119, v90, v91
    s_cbranch_scc1 L_at_noswap2
    v_swap_b32 v116, v118
    v_swap_b32 v117, v119
L_at_noswap2:
    s_mov_b32 s37, 65536
    buffer_store_dwordx4 v[116:119], v218, s[40:43], s37 offen sc1
    v_mfma_f32_16x16x32_bf16 v[92:95], v[236:239], v[32:35], 0
    v_mfma_f32_16x16x32_bf16 v[96:99], v[246:249], v[32:35], 0
    s_nop 6
    v_cvt_pk_bf16_f32 v120, v92, v93
    v_cvt_pk_bf16_f32 v121, v94, v95
    v_cvt_pk_bf16_f32 v122, v96, v97
    v_cvt_pk_bf16_f32 v123, v98, v99
    s_cbranch_scc1 L_at_noswap3
    v_swap_b32 v120, v122
    v_swap_b32 v121, v123
L_at_noswap3:
    s_mov_b32 s37, 98304
    buffer_store_dwordx4 v[120:123], v218, s[40:43], s37 offen sc1
    s_add_u32 m0, s60, 0
    s_add_u32 s63, s62, 0
    s_and_b32 s63, s63, 0x1fffff
    buffer_load_dwordx4 v227, s[44:47], s63 offen lds
    s_add_u32 m0, s60, 1024
    s_add_u32 s63, s62, 16384
    s_and_b32 s63, s63, 0x1fffff
    buffer_load_dwordx4 v227, s[44:47], s63 offen lds
    s_add_u32 m0, s60, 8192
    s_add_u32 s63, s62, 131072
    s_and_b32 s63, s63, 0x1fffff
    buffer_load_dwordx4 v227, s[44:47], s63 offen lds
    s_add_u32 m0, s60, 9216
    s_add_u32 s63, s62, 147456
    s_and_b32 s63, s63, 0x1fffff
    buffer_load_dwordx4 v227, s[44:47], s63 offen lds
    s_add_u32 m0, s60, 16384
    s_add_u32 s63, s62, 262144
    s_and_b32 s63, s63, 0x1fffff
    buffer_load_dwordx4 v227, s[44:47], s63 offen lds
    s_add_u32 m0, s60, 17408
    s_add_u32 s63, s62, 278528
    s_and_b32 s63, s63, 0x1fffff
    buffer_load_dwordx4 v227, s[44:47], s63 offen lds
    v_xor_b32 v68, 0, v229
    v_xor_b32 v69, 32, v229
    v_xor_b32 v70, 64, v229
    v_xor_b32 v71, 96, v229
    v_add_u32 v72, 83968, v68
    v_add_u32 v73, 83968, v69
    v_add_u32 v74, 83968, v70
    v_add_u32 v75, 83968, v71
    v_add_u32 v76, 125952, v68
    v_add_u32 v77, 125952, v69
    v_add_u32 v78, 125952, v70
    v_add_u32 v79, 125952, v71
    s_add_u32 s64, s61, 0
    s_and_b32 s64, s64, 7
    s_lshl_b32 s64, s64, 12
    s_add_u32 s65, s61, 1
    s_and_b32 s65, s65, 7
    s_lshl_b32 s65, s65, 12
    s_add_u32 s66, s61, 2
    s_and_b32 s66, s66, 7
    s_lshl_b32 s66, s66, 12
    s_add_u32 s67, s61, 3
    s_and_b32 s67, s67, 7
    s_lshl_b32 s67, s67, 12
    s_add_u32 s68, s61, 4
    s_and_b32 s68, s68, 7
    s_lshl_b32 s68, s68, 12
    s_add_u32 s69, s61, 5
    s_and_b32 s69, s69, 7
    s_lshl_b32 s69, s69, 12
    s_add_u32 s70, s61, 6
    s_and_b32 s70, s70, 7
    s_lshl_b32 s70, s70, 12
    s_add_u32 s71, s61, 7
    s_and_b32 s71, s71, 7
    s_lshl_b32 s71, s71, 12
    s_waitcnt vmcnt(6)
    v_mov_b32 v2, 1
    s_mov_b64 exec, 1
    ds_add_rtn_u32 v1, v228, v2 offset:0
    s_waitcnt lgkmcnt(0)
    v_readfirstlane_b32 s39, v1
    s_nop 0
    s_cmp_eq_u32 s39, 3
    s_cbranch_scc0 L_jo_39a
    buffer_atomic_add v2, off, s[52:55], s56 sc1
L_jo_39a:
    s_mov_b64 exec, -1
    s_add_u32 m0, s60, 24576
    s_add_u32 s63, s62, 393216
    s_and_b32 s63, s63, 0x1fffff
    buffer_load_dwordx4 v227, s[44:47], s63 offen lds
    s_add_u32 m0, s60, 25600
    s_add_u32 s63, s62, 409600
    s_and_b32 s63, s63, 0x1fffff
    buffer_load_dwordx4 v227, s[44:47], s63 offen lds
    s_add_u32 m0, s60, 32768
    s_add_u32 s63, s62, 524288
    s_and_b32 s63, s63, 0x1fffff
    buffer_load_dwordx4 v227, s[44:47], s63 offen lds
    s_add_u32 m0, s60, 33792
    s_add_u32 s63, s62, 540672
    s_and_b32 s63, s63, 0x1fffff
    buffer_load_dwordx4 v227, s[44:47], s63 offen lds
    s_add_u32 m0, s60, 83968
    s_add_u32 s63, s62, 655360
    s_and_b32 s63, s63, 0x1fffff
    buffer_load_dwordx4 v227, s[44:47], s63 offen lds
    s_add_u32 m0, s60, 84992
    s_add_u32 s63, s62, 671744
    s_and_b32 s63, s63, 0x1fffff
    buffer_load_dwordx4 v227, s[44:47], s63 offen lds
    s_add_u32 m0, s60, 92160
    s_add_u32 s63, s62, 786432
    s_and_b32 s63, s63, 0x1fffff
    buffer_load_dwordx4 v227, s[44:47], s63 offen lds
    s_add_u32 m0, s60, 93184
    s_add_u32 s63, s62, 802816
    s_and_b32 s63, s63, 0x1fffff
    buffer_load_dwordx4 v227, s[44:47], s63 offen lds
    s_add_u32 m0, s60, 100352
    s_add_u32 s63, s62, 917504
    s_and_b32 s63, s63, 0x1fffff
    buffer_load_dwordx4 v227, s[44:47], s63 offen lds
    s_add_u32 m0, s60, 101376
    s_add_u32 s63, s62, 933888
    s_and_b32 s63, s63, 0x1fffff
    buffer_load_dwordx4 v227, s[44:47], s63 offen lds
    s_add_u32 m0, s60, 108544
    s_add_u32 s63, s62, 1048576
    s_and_b32 s63, s63, 0x1fffff
    buffer_load_dwordx4 v227, s[44:47], s63 offen lds
    s_add_u32 m0, s60, 109568
    s_add_u32 s63, s62, 1064960
    s_and_b32 s63, s63, 0x1fffff
    buffer_load_dwordx4 v227, s[44:47], s63 offen lds
    s_add_u32 m0, s60, 116736
    s_add_u32 s63, s62, 1179648
    s_and_b32 s63, s63, 0x1fffff
    buffer_load_dwordx4 v227, s[44:47], s63 offen lds
    s_add_u32 m0, s60, 117760
    s_add_u32 s63, s62, 1196032
    s_and_b32 s63, s63, 0x1fffff
    buffer_load_dwordx4 v227, s[44:47], s63 offen lds
    s_setprio 0
    s_waitcnt vmcnt(0)
    s_mov_b64 exec, 1
    ds_add_u32 v228, v2 offset:4
    s_mov_b64 exec, -1
    s_cmp_eq_u32 s39, 3
    s_cbranch_scc0 L_jo_39
    s_mov_b32 s38, 131072
L_sg_loop_42:
    s_load_dword s37, s[52:53], s57 glc
L_sg_chk_43:
    s_waitcnt lgkmcnt(0)
    s_cmp_ge_u32 s37, 16
    s_cbranch_scc1 L_sg_done_41
    s_sub_u32 s38, s38, 1
    s_cbranch_scc0 L_sg_loop_42
L_sg_done_41:
    v_mov_b32 v1, 16
    s_mov_b64 exec, 1
    ds_add_u32 v228, v1 offset:4
    s_mov_b64 exec, -1
L_jo_39:
    s_mov_b32 s38, 1048576
L_sl_loop_45:
    ds_read_b32 v1, v228 offset:4
    s_waitcnt lgkmcnt(0)
    v_readfirstlane_b32 s37, v1
    s_nop 0
    s_cmp_ge_u32 s37, 20
    s_cbranch_scc1 L_sl_done_44
    s_sleep 1
    s_sub_u32 s38, s38, 1
    s_cbranch_scc0 L_sl_loop_45
L_sl_done_44:
L_jd_40:
    buffer_load_dwordx4 v[80:83], v224, s[40:43], s64 offen offset:0 sc1
    buffer_load_dwordx4 v[84:87], v225, s[40:43], s64 offen offset:0 sc1
    ds_read_b64_tr_b16 v[36:37], v68 offset:0
    ds_read_b64_tr_b16 v[38:39], v68 offset:2048
    buffer_load_dwordx4 v[88:91], v224, s[40:43], s64 offen offset:1024 sc1
    buffer_load_dwordx4 v[92:95], v225, s[40:43], s64 offen offset:1024 sc1
    ds_read_b64_tr_b16 v[40:41], v69 offset:0
    ds_read_b64_tr_b16 v[42:43], v69 offset:2048
    buffer_load_dwordx4 v[96:99], v224, s[40:43], s64 offen offset:2048 sc1
    buffer_load_dwordx4 v[100:103], v225, s[40:43], s64 offen offset:2048 sc1
    ds_read_b64_tr_b16 v[44:45], v70 offset:0
    ds_read_b64_tr_b16 v[46:47], v70 offset:2048
    buffer_load_dwordx4 v[104:107], v224, s[40:43], s64 offen offset:3072 sc1
    buffer_load_dwordx4 v[108:111], v225, s[40:43], s64 offen offset:3072 sc1
    ds_read_b64_tr_b16 v[48:49], v71 offset:0
    ds_read_b64_tr_b16 v[50:51], v71 offset:2048
    buffer_load_dwordx4 v[112:115], v224, s[40:43], s65 offen offset:0 sc1
    buffer_load_dwordx4 v[116:119], v225, s[40:43], s65 offen offset:0 sc1
    ds_read_b64_tr_b16 v[52:53], v68 offset:4096
    ds_read_b64_tr_b16 v[54:55], v68 offset:6144
    buffer_load_dwordx4 v[120:123], v224, s[40:43], s65 offen offset:1024 sc1
    buffer_load_dwordx4 v[124:127], v225, s[40:43], s65 offen offset:1024 sc1
    ds_read_b64_tr_b16 v[56:57], v69 offset:4096
    ds_read_b64_tr_b16 v[58:59], v69 offset:6144
    buffer_load_dwordx4 v[128:131], v224, s[40:43], s65 offen offset:2048 sc1
    buffer_load_dwordx4 v[132:135], v225, s[40:43], s65 offen offset:2048 sc1
    ds_read_b64_tr_b16 v[60:61], v70 offset:4096
    ds_read_b64_tr_b16 v[62:63], v70 offset:6144
    buffer_load_dwordx4 v[136:139], v224, s[40:43], s65 offen offset:3072 sc1
    buffer_load_dwordx4 v[140:143], v225, s[40:43], s65 offen offset:3072 sc1
    s_waitcnt vmcnt(14) lgkmcnt(12)
    v_mfma_f32_16x16x32_bf16 v[4:7], v[36:39], v[80:83], 0
    ds_read_b64_tr_b16 v[64:65], v71 offset:4096
    v_mfma_f32_16x16x32_bf16 v[20:23], v[36:39], v[84:87], 0
    ds_read_b64_tr_b16 v[66:67], v71 offset:6144
    s_waitcnt lgkmcnt(12)
    v_mfma_f32_16x16x32_bf16 v[8:11], v[40:43], v[80:83], 0
    ds_read_b64_tr_b16 v[36:37], v68 offset:8192
    v_mfma_f32_16x16x32_bf16 v[24:27], v[40:43], v[84:87], 0
    ds_read_b64_tr_b16 v[38:39], v68 offset:10240
    buffer_load_dwordx4 v[144:147], v224, s[40:43], s66 offen offset:0 sc1
    s_waitcnt lgkmcnt(12)
    v_mfma_f32_16x16x32_bf16 v[12:15], v[44:47], v[80:83], 0
    ds_read_b64_tr_b16 v[40:41], v69 offset:8192
    v_mfma_f32_16x16x32_bf16 v[28:31], v[44:47], v[84:87], 0
    ds_read_b64_tr_b16 v[42:43], v69 offset:10240
    s_waitcnt lgkmcnt(12)
    v_mfma_f32_16x16x32_bf16 v[16:19], v[48:51], v[80:83], 0
    ds_read_b64_tr_b16 v[44:45], v70 offset:8192
    v_mfma_f32_16x16x32_bf16 v[32:35], v[48:51], v[84:87], 0
    ds_read_b64_tr_b16 v[46:47], v70 offset:10240
    buffer_load_dwordx4 v[148:151], v225, s[40:43], s66 offen offset:0 sc1
    s_waitcnt vmcnt(14) lgkmcnt(12)
    v_mfma_f32_16x16x32_bf16 v[4:7], v[52:55], v[88:91], v[4:7]
    ds_read_b64_tr_b16 v[48:49], v71 offset:8192
    v_mfma_f32_16x16x32_bf16 v[20:23], v[52:55], v[92:95], v[20:23]
    ds_read_b64_tr_b16 v[50:51], v71 offset:10240
    s_waitcnt lgkmcnt(12)
    v_mfma_f32_16x16x32_bf16 v[8:11], v[56:59], v[88:91], v[8:11]
    ds_read_b64_tr_b16 v[52:53], v68 offset:12288
    v_mfma_f32_16x16x32_bf16 v[24:27], v[56:59], v[92:95], v[24:27]
    ds_read_b64_tr_b16 v[54:55], v68 offset:14336
    buffer_load_dwordx4 v[80:83], v224, s[40:43], s66 offen offset:1024 sc1
    s_waitcnt lgkmcnt(12)
    v_mfma_f32_16x16x32_bf16 v[12:15], v[60:63], v[88:91], v[12:15]
    ds_read_b64_tr_b16 v[56:57], v69 offset:12288
    v_mfma_f32_16x16x32_bf16 v[28:31], v[60:63], v[92:95], v[28:31]
    ds_read_b64_tr_b16 v[58:59], v69 offset:14336
    s_waitcnt lgkmcnt(12)
    v_mfma_f32_16x16x32_bf16 v[16:19], v[64:67], v[88:91], v[16:19]
    ds_read_b64_tr_b16 v[60:61], v70 offset:12288
    v_mfma_f32_16x16x32_bf16 v[32:35], v[64:67], v[92:95], v[32:35]
    ds_read_b64_tr_b16 v[62:63], v70 offset:14336
    buffer_load_dwordx4 v[84:87], v225, s[40:43], s66 offen offset:1024 sc1
    s_waitcnt vmcnt(14) lgkmcnt(12)
    v_mfma_f32_16x16x32_bf16 v[4:7], v[36:39], v[96:99], v[4:7]
    ds_read_b64_tr_b16 v[64:65], v71 offset:12288
    v_mfma_f32_16x16x32_bf16 v[20:23], v[36:39], v[100:103], v[20:23]
    ds_read_b64_tr_b16 v[66:67], v71 offset:14336
    s_waitcnt lgkmcnt(12)
    v_mfma_f32_16x16x32_bf16 v[8:11], v[40:43], v[96:99], v[8:11]
    ds_read_b64_tr_b16 v[36:37], v68 offset:16384
    v_mfma_f32_16x16x32_bf16 v[24:27], v[40:43], v[100:103], v[24:27]
    ds_read_b64_tr_b16 v[38:39], v68 offset:18432
    buffer_load_dwordx4 v[88:91], v224, s[40:43], s66 offen offset:2048 sc1
    s_waitcnt lgkmcnt(12)
    v_mfma_f32_16x16x32_bf16 v[12:15], v[44:47], v[96:99], v[12:15]
    ds_read_b64_tr_b16 v[40:41], v69 offset:16384
    v_mfma_f32_16x16x32_bf16 v[28:31], v[44:47], v[100:103], v[28:31]
    ds_read_b64_tr_b16 v[42:43], v69 offset:18432
    s_waitcnt lgkmcnt(12)
    v_mfma_f32_16x16x32_bf16 v[16:19], v[48:51], v[96:99], v[16:19]
    ds_read_b64_tr_b16 v[44:45], v70 offset:16384
    v_mfma_f32_16x16x32_bf16 v[32:35], v[48:51], v[100:103], v[32:35]
    ds_read_b64_tr_b16 v[46:47], v70 offset:18432
    buffer_load_dwordx4 v[92:95], v225, s[40:43], s66 offen offset:2048 sc1
    s_waitcnt vmcnt(14) lgkmcnt(12)
    v_mfma_f32_16x16x32_bf16 v[4:7], v[52:55], v[104:107], v[4:7]
    ds_read_b64_tr_b16 v[48:49], v71 offset:16384
    v_mfma_f32_16x16x32_bf16 v[20:23], v[52:55], v[108:111], v[20:23]
    ds_read_b64_tr_b16 v[50:51], v71 offset:18432
    s_waitcnt lgkmcnt(12)
    v_mfma_f32_16x16x32_bf16 v[8:11], v[56:59], v[104:107], v[8:11]
    ds_read_b64_tr_b16 v[52:53], v68 offset:20480
    v_mfma_f32_16x16x32_bf16 v[24:27], v[56:59], v[108:111], v[24:27]
    ds_read_b64_tr_b16 v[54:55], v68 offset:22528
    buffer_load_dwordx4 v[96:99], v224, s[40:43], s66 offen offset:3072 sc1
    s_waitcnt lgkmcnt(12)
    v_mfma_f32_16x16x32_bf16 v[12:15], v[60:63], v[104:107], v[12:15]
    ds_read_b64_tr_b16 v[56:57], v69 offset:20480
    v_mfma_f32_16x16x32_bf16 v[28:31], v[60:63], v[108:111], v[28:31]
    ds_read_b64_tr_b16 v[58:59], v69 offset:22528
    s_waitcnt lgkmcnt(12)
    v_mfma_f32_16x16x32_bf16 v[16:19], v[64:67], v[104:107], v[16:19]
    ds_read_b64_tr_b16 v[60:61], v70 offset:20480
    v_mfma_f32_16x16x32_bf16 v[32:35], v[64:67], v[108:111], v[32:35]
    ds_read_b64_tr_b16 v[62:63], v70 offset:22528
    buffer_load_dwordx4 v[100:103], v225, s[40:43], s66 offen offset:3072 sc1
    s_waitcnt vmcnt(14) lgkmcnt(12)
    v_mfma_f32_16x16x32_bf16 v[4:7], v[36:39], v[112:115], v[4:7]
    ds_read_b64_tr_b16 v[64:65], v71 offset:20480
    v_mfma_f32_16x16x32_bf16 v[20:23], v[36:39], v[116:119], v[20:23]
    ds_read_b64_tr_b16 v[66:67], v71 offset:22528
    s_waitcnt lgkmcnt(12)
    v_mfma_f32_16x16x32_bf16 v[8:11], v[40:43], v[112:115], v[8:11]
    ds_read_b64_tr_b16 v[36:37], v68 offset:24576
    v_mfma_f32_16x16x32_bf16 v[24:27], v[40:43], v[116:119], v[24:27]
    ds_read_b64_tr_b16 v[38:39], v68 offset:26624
    buffer_load_dwordx4 v[104:107], v224, s[40:43], s67 offen offset:0 sc1
    s_waitcnt lgkmcnt(12)
    v_mfma_f32_16x16x32_bf16 v[12:15], v[44:47], v[112:115], v[12:15]
    ds_read_b64_tr_b16 v[40:41], v69 offset:24576
    v_mfma_f32_16x16x32_bf16 v[28:31], v[44:47], v[116:119], v[28:31]
    ds_read_b64_tr_b16 v[42:43], v69 offset:26624
    s_waitcnt lgkmcnt(12)
    v_mfma_f32_16x16x32_bf16 v[16:19], v[48:51], v[112:115], v[16:19]
    ds_read_b64_tr_b16 v[44:45], v70 offset:24576
    v_mfma_f32_16x16x32_bf16 v[32:35], v[48:51], v[116:119], v[32:35]
    ds_read_b64_tr_b16 v[46:47], v70 offset:26624
    buffer_load_dwordx4 v[108:111], v225, s[40:43], s67 offen offset:0 sc1
    s_waitcnt vmcnt(14) lgkmcnt(12)
    v_mfma_f32_16x16x32_bf16 v[4:7], v[52:55], v[120:123], v[4:7]
    ds_read_b64_tr_b16 v[48:49], v71 offset:24576
    v_mfma_f32_16x16x32_bf16 v[20:23], v[52:55], v[124:127], v[20:23]
    ds_read_b64_tr_b16 v[50:51], v71 offset:26624
    s_waitcnt lgkmcnt(12)
    v_mfma_f32_16x16x32_bf16 v[8:11], v[56:59], v[120:123], v[8:11]
    ds_read_b64_tr_b16 v[52:53], v68 offset:28672
    v_mfma_f32_16x16x32_bf16 v[24:27], v[56:59], v[124:127], v[24:27]
    ds_read_b64_tr_b16 v[54:55], v68 offset:30720
    buffer_load_dwordx4 v[112:115], v224, s[40:43], s67 offen offset:1024 sc1
    s_waitcnt lgkmcnt(12)
    v_mfma_f32_16x16x32_bf16 v[12:15], v[60:63], v[120:123], v[12:15]
    ds_read_b64_tr_b16 v[56:57], v69 offset:28672
    v_mfma_f32_16x16x32_bf16 v[28:31], v[60:63], v[124:127], v[28:31]
    ds_read_b64_tr_b16 v[58:59], v69 offset:30720
    s_waitcnt lgkmcnt(12)
    v_mfma_f32_16x16x32_bf16 v[16:19], v[64:67], v[120:123], v[16:19]
    ds_read_b64_tr_b16 v[60:61], v70 offset:28672
    v_mfma_f32_16x16x32_bf16 v[32:35], v[64:67], v[124:127], v[32:35]
    ds_read_b64_tr_b16 v[62:63], v70 offset:30720
    buffer_load_dwordx4 v[116:119], v225, s[40:43], s67 offen offset:1024 sc1
    s_waitcnt vmcnt(14) lgkmcnt(12)
    v_mfma_f32_16x16x32_bf16 v[4:7], v[36:39], v[128:131], v[4:7]
    ds_read_b64_tr_b16 v[64:65], v71 offset:28672
    v_mfma_f32_16x16x32_bf16 v[20:23], v[36:39], v[132:135], v[20:23]
    ds_read_b64_tr_b16 v[66:67], v71 offset:30720
    s_waitcnt lgkmcnt(12)
    v_mfma_f32_16x16x32_bf16 v[8:11], v[40:43], v[128:131], v[8:11]
    ds_read_b64_tr_b16 v[36:37], v68 offset:32768
    v_mfma_f32_16x16x32_bf16 v[24:27], v[40:43], v[132:135], v[24:27]
    ds_read_b64_tr_b16 v[38:39], v68 offset:34816
    buffer_load_dwordx4 v[120:123], v224, s[40:43], s67 offen offset:2048 sc1
    s_waitcnt lgkmcnt(12)
    v_mfma_f32_16x16x32_bf16 v[12:15], v[44:47], v[128:131], v[12:15]
    ds_read_b64_tr_b16 v[40:41], v69 offset:32768
    v_mfma_f32_16x16x32_bf16 v[28:31], v[44:47], v[132:135], v[28:31]
    ds_read_b64_tr_b16 v[42:43], v69 offset:34816
    s_waitcnt lgkmcnt(12)
    v_mfma_f32_16x16x32_bf16 v[16:19], v[48:51], v[128:131], v[16:19]
    ds_read_b64_tr_b16 v[44:45], v70 offset:32768
    v_mfma_f32_16x16x32_bf16 v[32:35], v[48:51], v[132:135], v[32:35]
    ds_read_b64_tr_b16 v[46:47], v70 offset:34816
    buffer_load_dwordx4 v[124:127], v225, s[40:43], s67 offen offset:2048 sc1
    s_waitcnt vmcnt(14) lgkmcnt(12)
    v_mfma_f32_16x16x32_bf16 v[4:7], v[52:55], v[136:139], v[4:7]
    ds_read_b64_tr_b16 v[48:49], v71 offset:32768
    v_mfma_f32_16x16x32_bf16 v[20:23], v[52:55], v[140:143], v[20:23]
    ds_read_b64_tr_b16 v[50:51], v71 offset:34816
    s_waitcnt lgkmcnt(12)
    v_mfma_f32_16x16x32_bf16 v[8:11], v[56:59], v[136:139], v[8:11]
    ds_read_b64_tr_b16 v[52:53], v68 offset:36864
    v_mfma_f32_16x16x32_bf16 v[24:27], v[56:59], v[140:143], v[24:27]
    ds_read_b64_tr_b16 v[54:55], v68 offset:38912
    buffer_load_dwordx4 v[128:131], v224, s[40:43], s67 offen offset:3072 sc1
    s_waitcnt lgkmcnt(12)
    v_mfma_f32_16x16x32_bf16 v[12:15], v[60:63], v[136:139], v[12:15]
    ds_read_b64_tr_b16 v[56:57], v69 offset:36864
    v_mfma_f32_16x16x32_bf16 v[28:31], v[60:63], v[140:143], v[28:31]
    ds_read_b64_tr_b16 v[58:59], v69 offset:38912
    s_waitcnt lgkmcnt(12)
    v_mfma_f32_16x16x32_bf16 v[16:19], v[64:67], v[136:139], v[16:19]
    ds_read_b64_tr_b16 v[60:61], v70 offset:36864
    v_mfma_f32_16x16x32_bf16 v[32:35], v[64:67], v[140:143], v[32:35]
    ds_read_b64_tr_b16 v[62:63], v70 offset:38912
    buffer_load_dwordx4 v[132:135], v225, s[40:43], s67 offen offset:3072 sc1
    s_waitcnt vmcnt(14) lgkmcnt(12)
    v_mfma_f32_16x16x32_bf16 v[4:7], v[36:39], v[144:147], v[4:7]
    ds_read_b64_tr_b16 v[64:65], v71 offset:36864
    v_mfma_f32_16x16x32_bf16 v[20:23], v[36:39], v[148:151], v[20:23]
    ds_read_b64_tr_b16 v[66:67], v71 offset:38912
    s_waitcnt lgkmcnt(12)
    v_mfma_f32_16x16x32_bf16 v[8:11], v[40:43], v[144:147], v[8:11]
    ds_read_b64_tr_b16 v[36:37], v72 offset:0
    v_mfma_f32_16x16x32_bf16 v[24:27], v[40:43], v[148:151], v[24:27]
    ds_read_b64_tr_b16 v[38:39], v72 offset:2048
    buffer_load_dwordx4 v[136:139], v224, s[40:43], s68 offen offset:0 sc1
    s_waitcnt lgkmcnt(12)
    v_mfma_f32_16x16x32_bf16 v[12:15], v[44:47], v[144:147], v[12:15]
    ds_read_b64_tr_b16 v[40:41], v73 offset:0
    v_mfma_f32_16x16x32_bf16 v[28:31], v[44:47], v[148:151], v[28:31]
    ds_read_b64_tr_b16 v[42:43], v73 offset:2048
    s_waitcnt lgkmcnt(12)
    v_mfma_f32_16x16x32_bf16 v[16:19], v[48:51], v[144:147], v[16:19]
    ds_read_b64_tr_b16 v[44:45], v74 offset:0
    v_mfma_f32_16x16x32_bf16 v[32:35], v[48:51], v[148:151], v[32:35]
    ds_read_b64_tr_b16 v[46:47], v74 offset:2048
    buffer_load_dwordx4 v[140:143], v225, s[40:43], s68 offen offset:0 sc1
    s_waitcnt vmcnt(14) lgkmcnt(12)
    v_mfma_f32_16x16x32_bf16 v[4:7], v[52:55], v[80:83], v[4:7]
    ds_read_b64_tr_b16 v[48:49], v75 offset:0
    v_mfma_f32_16x16x32_bf16 v[20:23], v[52:55], v[84:87], v[20:23]
    ds_read_b64_tr_b16 v[50:51], v75 offset:2048
    s_waitcnt lgkmcnt(12)
    v_mfma_f32_16x16x32_bf16 v[8:11], v[56:59], v[80:83], v[8:11]
    ds_read_b64_tr_b16 v[52:53], v72 offset:4096
    v_mfma_f32_16x16x32_bf16 v[24:27], v[56:59], v[84:87], v[24:27]
    ds_read_b64_tr_b16 v[54:55], v72 offset:6144
    buffer_load_dwordx4 v[144:147], v224, s[40:43], s68 offen offset:1024 sc1
    s_waitcnt lgkmcnt(12)
    v_mfma_f32_16x16x32_bf16 v[12:15], v[60:63], v[80:83], v[12:15]
    ds_read_b64_tr_b16 v[56:57], v73 offset:4096
    v_mfma_f32_16x16x32_bf16 v[28:31], v[60:63], v[84:87], v[28:31]
    ds_read_b64_tr_b16 v[58:59], v73 offset:6144
    s_waitcnt lgkmcnt(12)
    v_mfma_f32_16x16x32_bf16 v[16:19], v[64:67], v[80:83], v[16:19]
    ds_read_b64_tr_b16 v[60:61], v74 offset:4096
    v_mfma_f32_16x16x32_bf16 v[32:35], v[64:67], v[84:87], v[32:35]
    ds_read_b64_tr_b16 v[62:63], v74 offset:6144
    buffer_load_dwordx4 v[148:151], v225, s[40:43], s68 offen offset:1024 sc1
    s_waitcnt vmcnt(14) lgkmcnt(12)
    v_mfma_f32_16x16x32_bf16 v[4:7], v[36:39], v[88:91], v[4:7]
    ds_read_b64_tr_b16 v[64:65], v75 offset:4096
    v_mfma_f32_16x16x32_bf16 v[20:23], v[36:39], v[92:95], v[20:23]
    ds_read_b64_tr_b16 v[66:67], v75 offset:6144
    s_waitcnt lgkmcnt(12)
    v_mfma_f32_16x16x32_bf16 v[8:11], v[40:43], v[88:91], v[8:11]
    ds_read_b64_tr_b16 v[36:37], v72 offset:8192
    v_mfma_f32_16x16x32_bf16 v[24:27], v[40:43], v[92:95], v[24:27]
    ds_read_b64_tr_b16 v[38:39], v72 offset:10240
    buffer_load_dwordx4 v[80:83], v224, s[40:43], s68 offen offset:2048 sc1
    s_waitcnt lgkmcnt(12)
    v_mfma_f32_16x16x32_bf16 v[12:15], v[44:47], v[88:91], v[12:15]
    ds_read_b64_tr_b16 v[40:41], v73 offset:8192
    v_mfma_f32_16x16x32_bf16 v[28:31], v[44:47], v[92:95], v[28:31]
    ds_read_b64_tr_b16 v[42:43], v73 offset:10240
    s_waitcnt lgkmcnt(12)
    v_mfma_f32_16x16x32_bf16 v[16:19], v[48:51], v[88:91], v[16:19]
    ds_read_b64_tr_b16 v[44:45], v74 offset:8192
    v_mfma_f32_16x16x32_bf16 v[32:35], v[48:51], v[92:95], v[32:35]
    ds_read_b64_tr_b16 v[46:47], v74 offset:10240
    buffer_load_dwordx4 v[84:87], v225, s[40:43], s68 offen offset:2048 sc1
    s_waitcnt vmcnt(14) lgkmcnt(12)
    v_mfma_f32_16x16x32_bf16 v[4:7], v[52:55], v[96:99], v[4:7]
    ds_read_b64_tr_b16 v[48:49], v75 offset:8192
    v_mfma_f32_16x16x32_bf16 v[20:23], v[52:55], v[100:103], v[20:23]
    ds_read_b64_tr_b16 v[50:51], v75 offset:10240
    s_waitcnt lgkmcnt(12)
    v_mfma_f32_16x16x32_bf16 v[8:11], v[56:59], v[96:99], v[8:11]
    ds_read_b64_tr_b16 v[52:53], v72 offset:12288
    v_mfma_f32_16x16x32_bf16 v[24:27], v[56:59], v[100:103], v[24:27]
    ds_read_b64_tr_b16 v[54:55], v72 offset:14336
    buffer_load_dwordx4 v[88:91], v224, s[40:43], s68 offen offset:3072 sc1
    s_waitcnt lgkmcnt(12)
    v_mfma_f32_16x16x32_bf16 v[12:15], v[60:63], v[96:99], v[12:15]
    ds_read_b64_tr_b16 v[56:57], v73 offset:12288
    v_mfma_f32_16x16x32_bf16 v[28:31], v[60:63], v[100:103], v[28:31]
    ds_read_b64_tr_b16 v[58:59], v73 offset:14336
    s_waitcnt lgkmcnt(12)
    v_mfma_f32_16x16x32_bf16 v[16:19], v[64:67], v[96:99], v[16:19]
    ds_read_b64_tr_b16 v[60:61], v74 offset:12288
    v_mfma_f32_16x16x32_bf16 v[32:35], v[64:67], v[100:103], v[32:35]
    ds_read_b64_tr_b16 v[62:63], v74 offset:14336
    buffer_load_dwordx4 v[92:95], v225, s[40:43], s68 offen offset:3072 sc1
    s_waitcnt vmcnt(14) lgkmcnt(12)
    v_mfma_f32_16x16x32_bf16 v[4:7], v[36:39], v[104:107], v[4:7]
    ds_read_b64_tr_b16 v[64:65], v75 offset:12288
    v_mfma_f32_16x16x32_bf16 v[20:23], v[36:39], v[108:111], v[20:23]
    ds_read_b64_tr_b16 v[66:67], v75 offset:14336
    s_waitcnt lgkmcnt(12)
    v_mfma_f32_16x16x32_bf16 v[8:11], v[40:43], v[104:107], v[8:11]
    ds_read_b64_tr_b16 v[36:37], v72 offset:16384
    v_mfma_f32_16x16x32_bf16 v[24:27], v[40:43], v[108:111], v[24:27]
    ds_read_b64_tr_b16 v[38:39], v72 offset:18432
    buffer_load_dwordx4 v[96:99], v224, s[40:43], s69 offen offset:0 sc1
    s_waitcnt lgkmcnt(12)
    v_mfma_f32_16x16x32_bf16 v[12:15], v[44:47], v[104:107], v[12:15]
    ds_read_b64_tr_b16 v[40:41], v73 offset:16384
    v_mfma_f32_16x16x32_bf16 v[28:31], v[44:47], v[108:111], v[28:31]
    ds_read_b64_tr_b16 v[42:43], v73 offset:18432
    s_waitcnt lgkmcnt(12)
    v_mfma_f32_16x16x32_bf16 v[16:19], v[48:51], v[104:107], v[16:19]
    ds_read_b64_tr_b16 v[44:45], v74 offset:16384
    v_mfma_f32_16x16x32_bf16 v[32:35], v[48:51], v[108:111], v[32:35]
    ds_read_b64_tr_b16 v[46:47], v74 offset:18432
    buffer_load_dwordx4 v[100:103], v225, s[40:43], s69 offen offset:0 sc1
    s_waitcnt vmcnt(14) lgkmcnt(12)
    v_mfma_f32_16x16x32_bf16 v[4:7], v[52:55], v[112:115], v[4:7]
    ds_read_b64_tr_b16 v[48:49], v75 offset:16384
    v_mfma_f32_16x16x32_bf16 v[20:23], v[52:55], v[116:119], v[20:23]
    ds_read_b64_tr_b16 v[50:51], v75 offset:18432
    s_waitcnt lgkmcnt(12)
    v_mfma_f32_16x16x32_bf16 v[8:11], v[56:59], v[112:115], v[8:11]
    ds_read_b64_tr_b16 v[52:53], v72 offset:20480
    v_mfma_f32_16x16x32_bf16 v[24:27], v[56:59], v[116:119], v[24:27]
    ds_read_b64_tr_b16 v[54:55], v72 offset:22528
    buffer_load_dwordx4 v[104:107], v224, s[40:43], s69 offen offset:1024 sc1
    s_waitcnt lgkmcnt(12)
    v_mfma_f32_16x16x32_bf16 v[12:15], v[60:63], v[112:115], v[12:15]
    ds_read_b64_tr_b16 v[56:57], v73 offset:20480
    v_mfma_f32_16x16x32_bf16 v[28:31], v[60:63], v[116:119], v[28:31]
    ds_read_b64_tr_b16 v[58:59], v73 offset:22528
    s_waitcnt lgkmcnt(12)
    v_mfma_f32_16x16x32_bf16 v[16:19], v[64:67], v[112:115], v[16:19]
    ds_read_b64_tr_b16 v[60:61], v74 offset:20480
    v_mfma_f32_16x16x32_bf16 v[32:35], v[64:67], v[116:119], v[32:35]
    ds_read_b64_tr_b16 v[62:63], v74 offset:22528
    buffer_load_dwordx4 v[108:111], v225, s[40:43], s69 offen offset:1024 sc1
    s_waitcnt vmcnt(14) lgkmcnt(12)
    v_mfma_f32_16x16x32_bf16 v[4:7], v[36:39], v[120:123], v[4:7]
    ds_read_b64_tr_b16 v[64:65], v75 offset:20480
    v_mfma_f32_16x16x32_bf16 v[20:23], v[36:39], v[124:127], v[20:23]
    ds_read_b64_tr_b16 v[66:67], v75 offset:22528
    s_waitcnt lgkmcnt(12)
    v_mfma_f32_16x16x32_bf16 v[8:11], v[40:43], v[120:123], v[8:11]
    ds_read_b64_tr_b16 v[36:37], v72 offset:24576
    v_mfma_f32_16x16x32_bf16 v[24:27], v[40:43], v[124:127], v[24:27]
    ds_read_b64_tr_b16 v[38:39], v72 offset:26624
    buffer_load_dwordx4 v[112:115], v224, s[40:43], s69 offen offset:2048 sc1
    s_waitcnt lgkmcnt(12)
    v_mfma_f32_16x16x32_bf16 v[12:15], v[44:47], v[120:123], v[12:15]
    ds_read_b64_tr_b16 v[40:41], v73 offset:24576
    v_mfma_f32_16x16x32_bf16 v[28:31], v[44:47], v[124:127], v[28:31]
    ds_read_b64_tr_b16 v[42:43], v73 offset:26624
    s_waitcnt lgkmcnt(12)
    v_mfma_f32_16x16x32_bf16 v[16:19], v[48:51], v[120:123], v[16:19]
    ds_read_b64_tr_b16 v[44:45], v74 offset:24576
    v_mfma_f32_16x16x32_bf16 v[32:35], v[48:51], v[124:127], v[32:35]
    ds_read_b64_tr_b16 v[46:47], v74 offset:26624
    buffer_load_dwordx4 v[116:119], v225, s[40:43], s69 offen offset:2048 sc1
    s_waitcnt vmcnt(14) lgkmcnt(12)
    v_mfma_f32_16x16x32_bf16 v[4:7], v[52:55], v[128:131], v[4:7]
    ds_read_b64_tr_b16 v[48:49], v75 offset:24576
    v_mfma_f32_16x16x32_bf16 v[20:23], v[52:55], v[132:135], v[20:23]
    ds_read_b64_tr_b16 v[50:51], v75 offset:26624
    s_waitcnt lgkmcnt(12)
    v_mfma_f32_16x16x32_bf16 v[8:11], v[56:59], v[128:131], v[8:11]
    ds_read_b64_tr_b16 v[52:53], v72 offset:28672
    v_mfma_f32_16x16x32_bf16 v[24:27], v[56:59], v[132:135], v[24:27]
    ds_read_b64_tr_b16 v[54:55], v72 offset:30720
    buffer_load_dwordx4 v[120:123], v224, s[40:43], s69 offen offset:3072 sc1
    s_waitcnt lgkmcnt(12)
    v_mfma_f32_16x16x32_bf16 v[12:15], v[60:63], v[128:131], v[12:15]
    ds_read_b64_tr_b16 v[56:57], v73 offset:28672
    v_mfma_f32_16x16x32_bf16 v[28:31], v[60:63], v[132:135], v[28:31]
    ds_read_b64_tr_b16 v[58:59], v73 offset:30720
    s_waitcnt lgkmcnt(12)
    v_mfma_f32_16x16x32_bf16 v[16:19], v[64:67], v[128:131], v[16:19]
    ds_read_b64_tr_b16 v[60:61], v74 offset:28672
    v_mfma_f32_16x16x32_bf16 v[32:35], v[64:67], v[132:135], v[32:35]
    ds_read_b64_tr_b16 v[62:63], v74 offset:30720
    buffer_load_dwordx4 v[124:127], v225, s[40:43], s69 offen offset:3072 sc1
    s_waitcnt vmcnt(14) lgkmcnt(12)
    v_mfma_f32_16x16x32_bf16 v[4:7], v[36:39], v[136:139], v[4:7]
    ds_read_b64_tr_b16 v[64:65], v75 offset:28672
    v_mfma_f32_16x16x32_bf16 v[20:23], v[36:39], v[140:143], v[20:23]
    ds_read_b64_tr_b16 v[66:67], v75 offset:30720
    s_waitcnt lgkmcnt(12)
    v_mfma_f32_16x16x32_bf16 v[8:11], v[40:43], v[136:139], v[8:11]
    ds_read_b64_tr_b16 v[36:37], v72 offset:32768
    v_mfma_f32_16x16x32_bf16 v[24:27], v[40:43], v[140:143], v[24:27]
    ds_read_b64_tr_b16 v[38:39], v72 offset:34816
    buffer_load_dwordx4 v[128:131], v224, s[40:43], s70 offen offset:0 sc1
    s_waitcnt lgkmcnt(12)
    v_mfma_f32_16x16x32_bf16 v[12:15], v[44:47], v[136:139], v[12:15]
    ds_read_b64_tr_b16 v[40:41], v73 offset:32768
    v_mfma_f32_16x16x32_bf16 v[28:31], v[44:47], v[140:143], v[28:31]
    ds_read_b64_tr_b16 v[42:43], v73 offset:34816
    ds_read_b32 v1, v228 offset:12
    s_waitcnt lgkmcnt(13)
    v_mfma_f32_16x16x32_bf16 v[16:19], v[48:51], v[136:139], v[16:19]
    ds_read_b64_tr_b16 v[44:45], v74 offset:32768
    v_mfma_f32_16x16x32_bf16 v[32:35], v[48:51], v[140:143], v[32:35]
    ds_read_b64_tr_b16 v[46:47], v74 offset:34816
    buffer_load_dwordx4 v[132:135], v225, s[40:43], s70 offen offset:0 sc1
    s_waitcnt vmcnt(14) lgkmcnt(13)
    v_mfma_f32_16x16x32_bf16 v[4:7], v[52:55], v[144:147], v[4:7]
    ds_read_b64_tr_b16 v[48:49], v75 offset:32768
    v_mfma_f32_16x16x32_bf16 v[20:23], v[52:55], v[148:151], v[20:23]
    ds_read_b64_tr_b16 v[50:51], v75 offset:34816
    s_waitcnt lgkmcnt(13)
    v_mfma_f32_16x16x32_bf16 v[8:11], v[56:59], v[144:147], v[8:11]
    ds_read_b64_tr_b16 v[52:53], v72 offset:36864
    v_mfma_f32_16x16x32_bf16 v[24:27], v[56:59], v[148:151], v[24:27]
    ds_read_b64_tr_b16 v[54:55], v72 offset:38912
    buffer_load_dwordx4 v[136:139], v224, s[40:43], s70 offen offset:1024 sc1
    s_waitcnt lgkmcnt(13)
    v_mfma_f32_16x16x32_bf16 v[12:15], v[60:63], v[144:147], v[12:15]
    ds_read_b64_tr_b16 v[56:57], v73 offset:36864
    v_mfma_f32_16x16x32_bf16 v[28:31], v[60:63], v[148:151], v[28:31]
    ds_read_b64_tr_b16 v[58:59], v73 offset:38912
    s_waitcnt lgkmcnt(13)
    v_mfma_f32_16x16x32_bf16 v[16:19], v[64:67], v[144:147], v[16:19]
    ds_read_b64_tr_b16 v[60:61], v74 offset:36864
    v_mfma_f32_16x16x32_bf16 v[32:35], v[64:67], v[148:151], v[32:35]
    ds_read_b64_tr_b16 v[62:63], v74 offset:38912
    buffer_load_dwordx4 v[140:143], v225, s[40:43], s70 offen offset:1024 sc1
    s_waitcnt vmcnt(14) lgkmcnt(13)
    v_mfma_f32_16x16x32_bf16 v[4:7], v[36:39], v[80:83], v[4:7]
    ds_read_b64_tr_b16 v[64:65], v75 offset:36864
    v_mfma_f32_16x16x32_bf16 v[20:23], v[36:39], v[84:87], v[20:23]
    ds_read_b64_tr_b16 v[66:67], v75 offset:38912
    s_waitcnt lgkmcnt(12)
    v_readfirstlane_b32 s37, v1
    s_nop 0
    s_cmp_ge_u32 s37, 4
    s_cbranch_scc1 L_sl_done_46
    s_mov_b32 s38, 1048576
L_sl_loop_47:
    ds_read_b32 v1, v228 offset:12
    s_waitcnt lgkmcnt(0)
    v_readfirstlane_b32 s37, v1
    s_nop 0
    s_cmp_ge_u32 s37, 4
    s_cbranch_scc1 L_sl_done_46
    s_sleep 1
    s_sub_u32 s38, s38, 1
    s_cbranch_scc0 L_sl_loop_47
L_sl_done_46:
    v_mfma_f32_16x16x32_bf16 v[8:11], v[40:43], v[80:83], v[8:11]
    ds_read_b64_tr_b16 v[36:37], v76 offset:0
    v_mfma_f32_16x16x32_bf16 v[24:27], v[40:43], v[84:87], v[24:27]
    ds_read_b64_tr_b16 v[38:39], v76 offset:2048
    buffer_load_dwordx4 v[144:147], v224, s[40:43], s70 offen offset:2048 sc1
    s_waitcnt lgkmcnt(12)
    v_mfma_f32_16x16x32_bf16 v[12:15], v[44:47], v[80:83], v[12:15]
    ds_read_b64_tr_b16 v[40:41], v77 offset:0
    v_mfma_f32_16x16x32_bf16 v[28:31], v[44:47], v[84:87], v[28:31]
    ds_read_b64_tr_b16 v[42:43], v77 offset:2048
    s_waitcnt lgkmcnt(12)
    v_mfma_f32_16x16x32_bf16 v[16:19], v[48:51], v[80:83], v[16:19]
    ds_read_b64_tr_b16 v[44:45], v78 offset:0
    v_mfma_f32_16x16x32_bf16 v[32:35], v[48:51], v[84:87], v[32:35]
    ds_read_b64_tr_b16 v[46:47], v78 offset:2048
    buffer_load_dwordx4 v[148:151], v225, s[40:43], s70 offen offset:2048 sc1
    s_waitcnt vmcnt(14) lgkmcnt(12)
    v_mfma_f32_16x16x32_bf16 v[4:7], v[52:55], v[88:91], v[4:7]
    ds_read_b64_tr_b16 v[48:49], v79 offset:0
    v_mfma_f32_16x16x32_bf16 v[20:23], v[52:55], v[92:95], v[20:23]
    ds_read_b64_tr_b16 v[50:51], v79 offset:2048
    s_waitcnt lgkmcnt(12)
    v_mfma_f32_16x16x32_bf16 v[8:11], v[56:59], v[88:91], v[8:11]
    ds_read_b64_tr_b16 v[52:53], v76 offset:4096
    v_mfma_f32_16x16x32_bf16 v[24:27], v[56:59], v[92:95], v[24:27]
    ds_read_b64_tr_b16 v[54:55], v76 offset:6144
    buffer_load_dwordx4 v[80:83], v224, s[40:43], s70 offen offset:3072 sc1
    s_waitcnt lgkmcnt(12)
    v_mfma_f32_16x16x32_bf16 v[12:15], v[60:63], v[88:91], v[12:15]
    ds_read_b64_tr_b16 v[56:57], v77 offset:4096
    v_mfma_f32_16x16x32_bf16 v[28:31], v[60:63], v[92:95], v[28:31]
    ds_read_b64_tr_b16 v[58:59], v77 offset:6144
    s_waitcnt lgkmcnt(12)
    v_mfma_f32_16x16x32_bf16 v[16:19], v[64:67], v[88:91], v[16:19]
    ds_read_b64_tr_b16 v[60:61], v78 offset:4096
    v_mfma_f32_16x16x32_bf16 v[32:35], v[64:67], v[92:95], v[32:35]
    ds_read_b64_tr_b16 v[62:63], v78 offset:6144
    buffer_load_dwordx4 v[84:87], v225, s[40:43], s70 offen offset:3072 sc1
    s_waitcnt vmcnt(14) lgkmcnt(12)
    v_mfma_f32_16x16x32_bf16 v[4:7], v[36:39], v[96:99], v[4:7]
    ds_read_b64_tr_b16 v[64:65], v79 offset:4096
    v_mfma_f32_16x16x32_bf16 v[20:23], v[36:39], v[100:103], v[20:23]
    ds_read_b64_tr_b16 v[66:67], v79 offset:6144
    s_waitcnt lgkmcnt(12)
    v_mfma_f32_16x16x32_bf16 v[8:11], v[40:43], v[96:99], v[8:11]
    ds_read_b64_tr_b16 v[36:37], v76 offset:8448
    v_mfma_f32_16x16x32_bf16 v[24:27], v[40:43], v[100:103], v[24:27]
    ds_read_b64_tr_b16 v[38:39], v76 offset:10496
    buffer_load_dwordx4 v[88:91], v224, s[40:43], s71 offen offset:0 sc1
    s_waitcnt lgkmcnt(12)
    v_mfma_f32_16x16x32_bf16 v[12:15], v[44:47], v[96:99], v[12:15]
    ds_read_b64_tr_b16 v[40:41], v77 offset:8448
    v_mfma_f32_16x16x32_bf16 v[28:31], v[44:47], v[100:103], v[28:31]
    ds_read_b64_tr_b16 v[42:43], v77 offset:10496
    s_waitcnt lgkmcnt(12)
    v_mfma_f32_16x16x32_bf16 v[16:19], v[48:51], v[96:99], v[16:19]
    ds_read_b64_tr_b16 v[44:45], v78 offset:8448
    v_mfma_f32_16x16x32_bf16 v[32:35], v[48:51], v[100:103], v[32:35]
    ds_read_b64_tr_b16 v[46:47], v78 offset:10496
    buffer_load_dwordx4 v[92:95], v225, s[40:43], s71 offen offset:0 sc1
    s_waitcnt vmcnt(14) lgkmcnt(12)
    v_mfma_f32_16x16x32_bf16 v[4:7], v[52:55], v[104:107], v[4:7]
    ds_read_b64_tr_b16 v[48:49], v79 offset:8448
    v_mfma_f32_16x16x32_bf16 v[20:23], v[52:55], v[108:111], v[20:23]
    ds_read_b64_tr_b16 v[50:51], v79 offset:10496
    s_waitcnt lgkmcnt(12)
    v_mfma_f32_16x16x32_bf16 v[8:11], v[56:59], v[104:107], v[8:11]
    ds_read_b64_tr_b16 v[52:53], v76 offset:12544
    v_mfma_f32_16x16x32_bf16 v[24:27], v[56:59], v[108:111], v[24:27]
    ds_read_b64_tr_b16 v[54:55], v76 offset:14592
    buffer_load_dwordx4 v[96:99], v224, s[40:43], s71 offen offset:1024 sc1
    s_waitcnt lgkmcnt(12)
    v_mfma_f32_16x16x32_bf16 v[12:15], v[60:63], v[104:107], v[12:15]
    ds_read_b64_tr_b16 v[56:57], v77 offset:12544
    v_mfma_f32_16x16x32_bf16 v[28:31], v[60:63], v[108:111], v[28:31]
    ds_read_b64_tr_b16 v[58:59], v77 offset:14592
    s_waitcnt lgkmcnt(12)
    v_mfma_f32_16x16x32_bf16 v[16:19], v[64:67], v[104:107], v[16:19]
    ds_read_b64_tr_b16 v[60:61], v78 offset:12544
    v_mfma_f32_16x16x32_bf16 v[32:35], v[64:67], v[108:111], v[32:35]
    ds_read_b64_tr_b16 v[62:63], v78 offset:14592
    buffer_load_dwordx4 v[100:103], v225, s[40:43], s71 offen offset:1024 sc1
    s_waitcnt vmcnt(14) lgkmcnt(12)
    v_mfma_f32_16x16x32_bf16 v[4:7], v[36:39], v[112:115], v[4:7]
    ds_read_b64_tr_b16 v[64:65], v79 offset:12544
    v_mfma_f32_16x16x32_bf16 v[20:23], v[36:39], v[116:119], v[20:23]
    ds_read_b64_tr_b16 v[66:67], v79 offset:14592
    s_waitcnt lgkmcnt(12)
    v_mfma_f32_16x16x32_bf16 v[8:11], v[40:43], v[112:115], v[8:11]
    ds_read_b64_tr_b16 v[36:37], v76 offset:16896
    v_mfma_f32_16x16x32_bf16 v[24:27], v[40:43], v[116:119], v[24:27]
    ds_read_b64_tr_b16 v[38:39], v76 offset:18944
    buffer_load_dwordx4 v[104:107], v224, s[40:43], s71 offen offset:2048 sc1
    s_waitcnt lgkmcnt(12)
    v_mfma_f32_16x16x32_bf16 v[12:15], v[44:47], v[112:115], v[12:15]
    ds_read_b64_tr_b16 v[40:41], v77 offset:16896
    v_mfma_f32_16x16x32_bf16 v[28:31], v[44:47], v[116:119], v[28:31]
    ds_read_b64_tr_b16 v[42:43], v77 offset:18944
    s_waitcnt lgkmcnt(12)
    v_mfma_f32_16x16x32_bf16 v[16:19], v[48:51], v[112:115], v[16:19]
    ds_read_b64_tr_b16 v[44:45], v78 offset:16896
    v_mfma_f32_16x16x32_bf16 v[32:35], v[48:51], v[116:119], v[32:35]
    ds_read_b64_tr_b16 v[46:47], v78 offset:18944
    buffer_load_dwordx4 v[108:111], v225, s[40:43], s71 offen offset:2048 sc1
    s_waitcnt vmcnt(14) lgkmcnt(12)
    v_mfma_f32_16x16x32_bf16 v[4:7], v[52:55], v[120:123], v[4:7]
    ds_read_b64_tr_b16 v[48:49], v79 offset:16896
    v_mfma_f32_16x16x32_bf16 v[20:23], v[52:55], v[124:127], v[20:23]
    ds_read_b64_tr_b16 v[50:51], v79 offset:18944
    s_waitcnt lgkmcnt(12)
    v_mfma_f32_16x16x32_bf16 v[8:11], v[56:59], v[120:123], v[8:11]
    ds_read_b64_tr_b16 v[52:53], v76 offset:20992
    v_mfma_f32_16x16x32_bf16 v[24:27], v[56:59], v[124:127], v[24:27]
    ds_read_b64_tr_b16 v[54:55], v76 offset:23040
    buffer_load_dwordx4 v[112:115], v224, s[40:43], s71 offen offset:3072 sc1
    s_waitcnt lgkmcnt(12)
    v_mfma_f32_16x16x32_bf16 v[12:15], v[60:63], v[120:123], v[12:15]
    ds_read_b64_tr_b16 v[56:57], v77 offset:20992
    v_mfma_f32_16x16x32_bf16 v[28:31], v[60:63], v[124:127], v[28:31]
    ds_read_b64_tr_b16 v[58:59], v77 offset:23040
    s_waitcnt lgkmcnt(12)
    v_mfma_f32_16x16x32_bf16 v[16:19], v[64:67], v[120:123], v[16:19]
    ds_read_b64_tr_b16 v[60:61], v78 offset:20992
    v_mfma_f32_16x16x32_bf16 v[32:35], v[64:67], v[124:127], v[32:35]
    ds_read_b64_tr_b16 v[62:63], v78 offset:23040
    buffer_load_dwordx4 v[116:119], v225, s[40:43], s71 offen offset:3072 sc1
    s_waitcnt vmcnt(14) lgkmcnt(12)
    v_mfma_f32_16x16x32_bf16 v[4:7], v[36:39], v[128:131], v[4:7]
    ds_read_b64_tr_b16 v[64:65], v79 offset:20992
    v_mfma_f32_16x16x32_bf16 v[20:23], v[36:39], v[132:135], v[20:23]
    ds_read_b64_tr_b16 v[66:67], v79 offset:23040
    s_waitcnt lgkmcnt(12)
    v_mfma_f32_16x16x32_bf16 v[8:11], v[40:43], v[128:131], v[8:11]
    ds_read_b64_tr_b16 v[36:37], v76 offset:25344
    v_mfma_f32_16x16x32_bf16 v[24:27], v[40:43], v[132:135], v[24:27]
    ds_read_b64_tr_b16 v[38:39], v76 offset:27392
    s_waitcnt lgkmcnt(12)
    v_mfma_f32_16x16x32_bf16 v[12:15], v[44:47], v[128:131], v[12:15]
    ds_read_b64_tr_b16 v[40:41], v77 offset:25344
    v_mfma_f32_16x16x32_bf16 v[28:31], v[44:47], v[132:135], v[28:31]
    ds_read_b64_tr_b16 v[42:43], v77 offset:27392
    s_waitcnt lgkmcnt(12)
    v_mfma_f32_16x16x32_bf16 v[16:19], v[48:51], v[128:131], v[16:19]
    ds_read_b64_tr_b16 v[44:45], v78 offset:25344
    v_mfma_f32_16x16x32_bf16 v[32:35], v[48:51], v[132:135], v[32:35]
    ds_read_b64_tr_b16 v[46:47], v78 offset:27392
    s_waitcnt vmcnt(12) lgkmcnt(12)
    v_mfma_f32_16x16x32_bf16 v[4:7], v[52:55], v[136:139], v[4:7]
    ds_read_b64_tr_b16 v[48:49], v79 offset:25344
    v_mfma_f32_16x16x32_bf16 v[20:23], v[52:55], v[140:143], v[20:23]
    ds_read_b64_tr_b16 v[50:51], v79 offset:27392
    s_waitcnt lgkmcnt(12)
    v_mfma_f32_16x16x32_bf16 v[8:11], v[56:59], v[136:139], v[8:11]
    ds_read_b64_tr_b16 v[52:53], v76 offset:29440
    v_mfma_f32_16x16x32_bf16 v[24:27], v[56:59], v[140:143], v[24:27]
    ds_read_b64_tr_b16 v[54:55], v76 offset:31488
    s_waitcnt lgkmcnt(12)
    v_mfma_f32_16x16x32_bf16 v[12:15], v[60:63], v[136:139], v[12:15]
    ds_read_b64_tr_b16 v[56:57], v77 offset:29440
    v_mfma_f32_16x16x32_bf16 v[28:31], v[60:63], v[140:143], v[28:31]
    ds_read_b64_tr_b16 v[58:59], v77 offset:31488
    s_waitcnt lgkmcnt(12)
    v_mfma_f32_16x16x32_bf16 v[16:19], v[64:67], v[136:139], v[16:19]
    ds_read_b64_tr_b16 v[60:61], v78 offset:29440
    v_mfma_f32_16x16x32_bf16 v[32:35], v[64:67], v[140:143], v[32:35]
    ds_read_b64_tr_b16 v[62:63], v78 offset:31488
    s_waitcnt vmcnt(10) lgkmcnt(12)
    v_mfma_f32_16x16x32_bf16 v[4:7], v[36:39], v[144:147], v[4:7]
    ds_read_b64_tr_b16 v[64:65], v79 offset:29440
    v_mfma_f32_16x16x32_bf16 v[20:23], v[36:39], v[148:151], v[20:23]
    ds_read_b64_tr_b16 v[66:67], v79 offset:31488
    s_waitcnt lgkmcnt(12)
    v_mfma_f32_16x16x32_bf16 v[8:11], v[40:43], v[144:147], v[8:11]
    ds_read_b64_tr_b16 v[36:37], v68 offset:41984
    v_mfma_f32_16x16x32_bf16 v[24:27], v[40:43], v[148:151], v[24:27]
    ds_read_b64_tr_b16 v[38:39], v68 offset:44032
    s_waitcnt lgkmcnt(12)
    v_mfma_f32_16x16x32_bf16 v[12:15], v[44:47], v[144:147], v[12:15]
    ds_read_b64_tr_b16 v[40:41], v69 offset:41984
    v_mfma_f32_16x16x32_bf16 v[28:31], v[44:47], v[148:151], v[28:31]
    ds_read_b64_tr_b16 v[42:43], v69 offset:44032
    s_waitcnt lgkmcnt(12)
    v_mfma_f32_16x16x32_bf16 v[16:19], v[48:51], v[144:147], v[16:19]
    ds_read_b64_tr_b16 v[44:45], v70 offset:41984
    v_mfma_f32_16x16x32_bf16 v[32:35], v[48:51], v[148:151], v[32:35]
    ds_read_b64_tr_b16 v[46:47], v70 offset:44032
    s_waitcnt vmcnt(8) lgkmcnt(12)
    v_mfma_f32_16x16x32_bf16 v[4:7], v[52:55], v[80:83], v[4:7]
    ds_read_b64_tr_b16 v[48:49], v71 offset:41984
    v_mfma_f32_16x16x32_bf16 v[20:23], v[52:55], v[84:87], v[20:23]
    ds_read_b64_tr_b16 v[50:51], v71 offset:44032
    s_waitcnt lgkmcnt(12)
    v_mfma_f32_16x16x32_bf16 v[8:11], v[56:59], v[80:83], v[8:11]
    ds_read_b64_tr_b16 v[52:53], v68 offset:46080
    v_mfma_f32_16x16x32_bf16 v[24:27], v[56:59], v[84:87], v[24:27]
    ds_read_b64_tr_b16 v[54:55], v68 offset:48128
    s_waitcnt lgkmcnt(12)
    v_mfma_f32_16x16x32_bf16 v[12:15], v[60:63], v[80:83], v[12:15]
    ds_read_b64_tr_b16 v[56:57], v69 offset:46080
    v_mfma_f32_16x16x32_bf16 v[28:31], v[60:63], v[84:87], v[28:31]
    ds_read_b64_tr_b16 v[58:59], v69 offset:48128
    s_waitcnt lgkmcnt(12)
    v_mfma_f32_16x16x32_bf16 v[16:19], v[64:67], v[80:83], v[16:19]
    ds_read_b64_tr_b16 v[60:61], v70 offset:46080
    v_mfma_f32_16x16x32_bf16 v[32:35], v[64:67], v[84:87], v[32:35]
    ds_read_b64_tr_b16 v[62:63], v70 offset:48128
    s_waitcnt vmcnt(6) lgkmcnt(12)
    v_mfma_f32_16x16x32_bf16 v[4:7], v[36:39], v[88:91], v[4:7]
    ds_read_b64_tr_b16 v[64:65], v71 offset:46080
    v_mfma_f32_16x16x32_bf16 v[20:23], v[36:39], v[92:95], v[20:23]
    ds_read_b64_tr_b16 v[66:67], v71 offset:48128
    s_waitcnt lgkmcnt(12)
    v_mfma_f32_16x16x32_bf16 v[8:11], v[40:43], v[88:91], v[8:11]
    ds_read_b64_tr_b16 v[36:37], v68 offset:51200
    v_mfma_f32_16x16x32_bf16 v[24:27], v[40:43], v[92:95], v[24:27]
    ds_read_b64_tr_b16 v[38:39], v68 offset:53248
    s_waitcnt lgkmcnt(12)
    v_mfma_f32_16x16x32_bf16 v[12:15], v[44:47], v[88:91], v[12:15]
    ds_read_b64_tr_b16 v[40:41], v69 offset:51200
    v_mfma_f32_16x16x32_bf16 v[28:31], v[44:47], v[92:95], v[28:31]
    ds_read_b64_tr_b16 v[42:43], v69 offset:53248
    s_waitcnt lgkmcnt(12)
    v_mfma_f32_16x16x32_bf16 v[16:19], v[48:51], v[88:91], v[16:19]
    ds_read_b64_tr_b16 v[44:45], v70 offset:51200
    v_mfma_f32_16x16x32_bf16 v[32:35], v[48:51], v[92:95], v[32:35]
    ds_read_b64_tr_b16 v[46:47], v70 offset:53248
    s_waitcnt vmcnt(4) lgkmcnt(12)
    v_mfma_f32_16x16x32_bf16 v[4:7], v[52:55], v[96:99], v[4:7]
    ds_read_b64_tr_b16 v[48:49], v71 offset:51200
    v_mfma_f32_16x16x32_bf16 v[20:23], v[52:55], v[100:103], v[20:23]
    ds_read_b64_tr_b16 v[50:51], v71 offset:53248
    s_waitcnt lgkmcnt(12)
    v_mfma_f32_16x16x32_bf16 v[8:11], v[56:59], v[96:99], v[8:11]
    ds_read_b64_tr_b16 v[52:53], v68 offset:55296
    v_mfma_f32_16x16x32_bf16 v[24:27], v[56:59], v[100:103], v[24:27]
    ds_read_b64_tr_b16 v[54:55], v68 offset:57344
    s_waitcnt lgkmcnt(12)
    v_mfma_f32_16x16x32_bf16 v[12:15], v[60:63], v[96:99], v[12:15]
    ds_read_b64_tr_b16 v[56:57], v69 offset:55296
    v_mfma_f32_16x16x32_bf16 v[28:31], v[60:63], v[100:103], v[28:31]
    ds_read_b64_tr_b16 v[58:59], v69 offset:57344
    s_waitcnt lgkmcnt(12)
    v_mfma_f32_16x16x32_bf16 v[16:19], v[64:67], v[96:99], v[16:19]
    ds_read_b64_tr_b16 v[60:61], v70 offset:55296
    v_mfma_f32_16x16x32_bf16 v[32:35], v[64:67], v[100:103], v[32:35]
    ds_read_b64_tr_b16 v[62:63], v70 offset:57344
    s_waitcnt vmcnt(2) lgkmcnt(12)
    v_mfma_f32_16x16x32_bf16 v[4:7], v[36:39], v[104:107], v[4:7]
    ds_read_b64_tr_b16 v[64:65], v71 offset:55296
    v_mfma_f32_16x16x32_bf16 v[20:23], v[36:39], v[108:111], v[20:23]
    ds_read_b64_tr_b16 v[66:67], v71 offset:57344
    s_waitcnt lgkmcnt(12)
    v_mfma_f32_16x16x32_bf16 v[8:11], v[40:43], v[104:107], v[8:11]
    v_mfma_f32_16x16x32_bf16 v[24:27], v[40:43], v[108:111], v[24:27]
    s_waitcnt lgkmcnt(10)
    v_mfma_f32_16x16x32_bf16 v[12:15], v[44:47], v[104:107], v[12:15]
    v_mfma_f32_16x16x32_bf16 v[28:31], v[44:47], v[108:111], v[28:31]
    s_waitcnt lgkmcnt(8)
    v_mfma_f32_16x16x32_bf16 v[16:19], v[48:51], v[104:107], v[16:19]
    v_mfma_f32_16x16x32_bf16 v[32:35], v[48:51], v[108:111], v[32:35]
    s_waitcnt vmcnt(0) lgkmcnt(6)
    v_mfma_f32_16x16x32_bf16 v[4:7], v[52:55], v[112:115], v[4:7]
    v_mfma_f32_16x16x32_bf16 v[20:23], v[52:55], v[116:119], v[20:23]
    s_waitcnt lgkmcnt(4)
    v_mfma_f32_16x16x32_bf16 v[8:11], v[56:59], v[112:115], v[8:11]
    v_mfma_f32_16x16x32_bf16 v[24:27], v[56:59], v[116:119], v[24:27]
    s_waitcnt lgkmcnt(2)
    v_mfma_f32_16x16x32_bf16 v[12:15], v[60:63], v[112:115], v[12:15]
    v_mfma_f32_16x16x32_bf16 v[28:31], v[60:63], v[116:119], v[28:31]
    s_waitcnt lgkmcnt(0)
    v_mfma_f32_16x16x32_bf16 v[16:19], v[64:67], v[112:115], v[16:19]
    v_mfma_f32_16x16x32_bf16 v[32:35], v[64:67], v[116:119], v[32:35]
    s_mov_b32 s37, 131072
    v_cvt_pk_bf16_f32 v36, v4, v5
    v_cvt_pk_bf16_f32 v37, v6, v7
    v_cvt_pk_bf16_f32 v38, v8, v9
    v_cvt_pk_bf16_f32 v39, v10, v11
    v_cvt_pk_bf16_f32 v44, v20, v21
    v_cvt_pk_bf16_f32 v45, v22, v23
    v_cvt_pk_bf16_f32 v46, v24, v25
    v_cvt_pk_bf16_f32 v47, v26, v27
    v_permlane16_swap_b32 v36, v38
    v_permlane16_swap_b32 v37, v39
    v_permlane16_swap_b32 v44, v46
    v_permlane16_swap_b32 v45, v47
    buffer_store_dwordx4 v[36:39], v226, s[48:51], 0 offen offset:0 nt
    buffer_store_dwordx4 v[44:47], v226, s[48:51], s37 offen offset:0 nt
    v_cvt_pk_bf16_f32 v40, v12, v13
    v_cvt_pk_bf16_f32 v41, v14, v15
    v_cvt_pk_bf16_f32 v42, v16, v17
    v_cvt_pk_bf16_f32 v43, v18, v19
    v_cvt_pk_bf16_f32 v48, v28, v29
    v_cvt_pk_bf16_f32 v49, v30, v31
    v_cvt_pk_bf16_f32 v50, v32, v33
    v_cvt_pk_bf16_f32 v51, v34, v35
    v_permlane16_swap_b32 v40, v42
    v_permlane16_swap_b32 v41, v43
    v_permlane16_swap_b32 v48, v50
    v_permlane16_swap_b32 v49, v51
    buffer_store_dwordx4 v[40:43], v226, s[48:51], 0 offen offset:64 nt
    buffer_store_dwordx4 v[48:51], v226, s[48:51], s37 offen offset:64 nt
    s_endpgm
L_g1_rare:
    s_waitcnt vmcnt(0)
    s_cmp_lg_u32 s36, 1
    s_cbranch_scc1 L_g1_bar
    v_readfirstlane_b32 s38, v1
    s_nop 0
    s_cmp_ge_u32 s38, 4
    s_cbranch_scc1 L_sl_done_48
    s_mov_b32 s39, 1048576
L_sl_loop_49:
    ds_read_b32 v1, v228 offset:24
    s_waitcnt lgkmcnt(0)
    v_readfirstlane_b32 s38, v1
    s_nop 0
    s_cmp_ge_u32 s38, 4
    s_cbranch_scc1 L_sl_done_48
    s_sleep 1
    s_sub_u32 s39, s39, 1
    s_cbranch_scc0 L_sl_loop_49
L_sl_done_48:
    s_branch L_g1_nobar
L_end:
    s_endpgm
.section .rodata,"a"
.p2align 6
.amdhsa_kernel concat_heads__ssm_conv_h3__sliding_local_dilated__prompt_kernel
  .amdhsa_next_free_vgpr 256
  .amdhsa_next_free_sgpr 102
  .amdhsa_accum_offset 256
  .amdhsa_group_segment_fixed_size 0
  .amdhsa_kernarg_size 96
  .amdhsa_user_sgpr_count 2
  .amdhsa_user_sgpr_kernarg_segment_ptr 1
  .amdhsa_system_sgpr_workgroup_id_x 1
  .amdhsa_float_denorm_mode_32 3
.end_amdhsa_kernel
```

```asm
; @launch grid=(256,1,1) block=(512,1,1) lds=163840
.amdgcn_target "amdgcn-amd-amdhsa--gfx950"
.text
.globl concat_heads__ssm_conv_h3__sliding_local_dilated__prompt_kernel
.p2align 8
.type concat_heads__ssm_conv_h3__sliding_local_dilated__prompt_kernel,@function
concat_heads__ssm_conv_h3__sliding_local_dilated__prompt_kernel:
L_entry:
    s_getpc_b64 s[32:33]
    s_cmp_ge_u32 s2, 256
    s_cbranch_scc1 L_end
    s_load_dwordx16 s[8:23], s[0:1], 0
    s_load_dwordx8 s[24:31], s[0:1], 64
    v_lshrrev_b32 v1, 6, v0
    s_and_b32 s4, s2, 1
    v_readfirstlane_b32 s3, v1
    v_and_b32 v0, 63, v0
    s_bfe_u32 s5, s2, 0x30003
    s_bfe_u32 s6, s2, 0x20001
    s_lshr_b32 s7, s2, 6
    s_lshl2_add_u32 s6, s6, s7
    s_cmp_ge_u32 s3, 4
    s_cbranch_scc1 L_crole
    s_bfe_u32 s34, s2, 0x20003
    s_lshl2_add_u32 s34, s34, s3
    s_lshl_b32 s34, s34, 7
    v_lshl_add_u32 v1, v0, 11, s34
    v_min_u32 v1, L_end-L_entry-8, v1
    s_mov_b64 exec, 0xffff
    global_load_dword v249, v1, s[32:33]
    s_mov_b64 exec, -1
    s_and_b32 s84, s2, 3
    s_lshl2_add_u32 s84, s84, s3
    s_lshr_b32 s85, s2, 2
    s_mul_i32 s86, s3, 8448
    s_add_u32 s86, s86, 125952
    s_lshl_b32 s87, s85, 9
    s_add_u32 s87, s87, s84
    s_lshl_b32 s87, s87, 7
    v_and_b32 v231, 7, v0
    v_lshl_add_u32 v231, v231, 4, s87
    v_lshrrev_b32 v230, 3, v0
    v_lshl_add_u32 v230, v230, 13, v231
    v_subrev_u32 v231, 6144, v230
    v_subrev_u32 v232, 4096, v230
    v_subrev_u32 v233, 2048, v230
    v_add_u32 v234, 4096, v230
    v_lshlrev_b32 v235, 4, v0
    s_lshl_b32 s87, s84, 9
    s_add_u32 m0, s86, 4224
    s_waitcnt lgkmcnt(0)
    s_mov_b32 s80, s14
    s_mov_b32 s81, s15
    s_mov_b32 s82, 0x2000
    s_mov_b32 s83, 0x20000
    s_mov_b32 s72, s10
    s_mov_b32 s73, s11
    s_mov_b32 s74, 0x400000
    s_mov_b32 s75, 0x20000
    s_mov_b32 exec_hi, 0
    buffer_load_dwordx4 v235, s[80:83], s87 offen lds
    s_mov_b64 exec, -1
    buffer_load_dwordx4 v[108:111], v231, s[72:75], 0 offen offset:0 nt
    buffer_load_dwordx4 v[112:115], v232, s[72:75], 0 offen offset:0 nt
    buffer_load_dwordx4 v[116:119], v233, s[72:75], 0 offen offset:0 nt
    buffer_load_dwordx4 v[120:123], v230, s[72:75], 0 offen offset:0 nt
    buffer_load_dwordx4 v[124:127], v230, s[72:75], 0 offen offset:2048 nt
    buffer_load_dwordx4 v[128:131], v234, s[72:75], 0 offen offset:0 nt
    buffer_load_dwordx4 v[132:135], v234, s[72:75], 0 offen offset:2048 nt
    s_mov_b32 s76, s12
    s_mov_b32 s77, s13
    s_mov_b32 s78, 0x400000
    s_mov_b32 s79, 0x20000
    buffer_load_dwordx4 v[136:139], v230, s[76:79], 0 offen offset:0 nt
    buffer_load_dwordx4 v[140:143], v230, s[76:79], 0 offen offset:2048 nt
    buffer_load_dwordx4 v[144:147], v234, s[76:79], 0 offen offset:0 nt
    buffer_load_dwordx4 v[148:151], v234, s[76:79], 0 offen offset:2048 nt
    s_lshr_b32 s90, s2, 3
    s_and_b32 s91, s3, 3
    s_lshl2_add_u32 s90, s90, s91
    s_and_b32 s91, s2, 6
    s_lshl3_add_u32 s88, s90, s91
    s_lshl1_add_u32 s88, s88, s4
    s_lshl_b32 s88, s88, 11
    s_and_b32 s89, s2, 7
    s_and_b32 s91, s90, 1
    s_lshl1_add_u32 s89, s89, s91
    s_lshr_b32 s90, s90, 1
    s_mul_i32 s90, s90, 48
    s_add_u32 s89, s89, s90
    s_lshl_b32 s89, s89, 7
    v_and_b32 v251, 1, v0
    v_lshlrev_b32 v251, 12, v251
    v_lshrrev_b32 v252, 1, v0
    v_lshl_add_u32 v251, v252, 7, v251
    v_lshrrev_b32 v250, 2, v0
    v_mul_u32_u24 v250, 393216, v250
    v_and_b32 v252, 3, v0
    v_lshl_add_u32 v252, v252, 11, v250
    s_mov_b32 s64, s20
    s_mov_b32 s65, s21
    s_mov_b32 s66, 0x400000
    s_mov_b32 s67, 0x20000
    s_mov_b32 s68, s22
    s_mov_b32 s69, s23
    s_mov_b32 s70, 0x600000
    s_mov_b32 s71, 0x20000
    s_mov_b32 exec_lo, 0x777
    s_mov_b32 exec_hi, 0x0
    buffer_load_dword v250, v252, s[68:71], s89 offen
    s_xor_b32 s89, s89, 256
    buffer_load_dword v250, v252, s[68:71], s89 offen
    s_xor_b32 s89, s89, 256
    s_mov_b32 exec_lo, 0x3f
    s_mov_b32 exec_hi, 0
    buffer_load_dword v250, v251, s[64:67], s88 offen
    s_mov_b64 exec, -1
    s_barrier
    s_branch L_grole
L_crole:
    s_sub_u32 s70, s3, 4
    s_lshl_b32 s43, s70, 12
    s_lshl_b32 s44, s70, 11
    s_add_u32 s44, s44, 17408
    s_lshl_b32 s49, s70, 4
    s_lshl_b64 s[46:47], 0xffff, s49
    v_lshrrev_b32 v13, 3, v0
    v_and_b32 v14, 7, v0
    v_lshrrev_b32 v15, 4, v0
    s_lshl2_add_u32 s50, s5, s70
    s_lshl_b32 s50, s50, 6
    s_add_u32 s50, s50, s4
    s_lshl_b32 s50, s50, 11
    v_lshl_add_u32 v16, v13, 12, s50
    v_xor_b32 v17, v14, v15
    v_lshl_add_u32 v2, v17, 4, v16
    v_xor_b32 v3, 64, v2
    v_add_u32 v3, 31744, v3
    v_add_u32 v4, 63488, v2
    v_add_u32 v5, 63488, v3
    s_lshl_b32 s49, s5, 7
    s_sub_u32 s49, s49, 8
    s_max_i32 s49, s49, 0
    s_lshl1_add_u32 s49, s49, s4
    s_lshl_b32 s49, s49, 11
    v_lshl_add_u32 v16, v13, 12, s49
    v_lshlrev_b32 v17, 1, v15
    v_xor_b32 v18, v14, v17
    v_lshl_add_u32 v6, v18, 4, v16
    s_mul_i32 s49, s70, 768
    s_add_u32 s49, s49, s6
    s_lshl_b32 s49, s49, 7
    v_mul_u32_u24 v16, 6144, v13
    v_and_b32 v17, 2, v17
    v_xor_b32 v17, v14, v17
    v_lshlrev_b32 v17, 4, v17
    v_add3_u32 v7, v17, v16, s49
    v_xor_b32 v8, 64, v7
    v_add_u32 v8, 48128, v8
    v_add_u32 v9, 2048, v7
    v_add_u32 v10, 2048, v8
    v_add_u32 v11, 4096, v7
    v_add_u32 v12, 4096, v8
    s_mov_b32 s40, 0
    s_mov_b32 s41, 0
    s_lshr_b32 s90, s2, 3
    s_and_b32 s91, s3, 3
    s_lshl2_add_u32 s90, s90, s91
    s_and_b32 s91, s2, 6
    s_lshl3_add_u32 s88, s90, s91
    s_lshl1_add_u32 s88, s88, s4
    s_lshl_b32 s88, s88, 11
    s_and_b32 s89, s2, 7
    s_and_b32 s91, s90, 1
    s_lshl1_add_u32 s89, s89, s91
    s_lshr_b32 s90, s90, 1
    s_mul_i32 s90, s90, 48
    s_add_u32 s89, s89, s90
    s_lshl_b32 s89, s89, 7
    v_and_b32 v251, 1, v0
    v_lshlrev_b32 v251, 12, v251
    v_lshrrev_b32 v252, 1, v0
    v_lshl_add_u32 v251, v252, 7, v251
    v_lshrrev_b32 v250, 2, v0
    v_mul_u32_u24 v250, 393216, v250
    v_and_b32 v252, 3, v0
    v_lshl_add_u32 v252, v252, 11, v250
    s_waitcnt lgkmcnt(0)
    s_mov_b32 s32, s20
    s_mov_b32 s33, s21
    s_mov_b32 s34, 0x400000
    s_mov_b32 s35, 0x20000
    s_mov_b32 s36, s22
    s_mov_b32 s37, s23
    s_mov_b32 s38, 0x600000
    s_mov_b32 s39, 0x20000
    s_setprio 0
    s_and_b32 s73, s2, 7
    s_xor_b32 s73, s73, 2
    s_lshr_b32 s74, s2, 7
    s_lshl1_add_u32 s68, s73, s74
    s_lshr_b32 s45, s68, 2
    s_lshl_b32 s45, s45, 8
    s_and_b32 s73, s2, 3
    s_lshl_b32 s73, s73, 8
    s_bfe_u32 s69, s2, 0x40003
    s_lshl4_add_u32 s71, s68, s69
    s_lshl2_add_u32 s71, s71, s70
    s_mul_i32 s80, s70, 8448
    s_add_u32 s80, s80, 125952
    s_mul_i32 s81, s70, 9216
    s_add_u32 s81, s81, 41984
    s_add_u32 s52, s30, 0xe00000
    s_addc_u32 s53, s31, 0
    s_mov_b32 s54, 0x30000
    s_mov_b32 s55, 0x20000
    s_add_u32 s64, s30, 0x900000
    s_addc_u32 s65, s31, 0
    s_mov_b32 s66, 0x420000
    s_mov_b32 s67, 0x20000
    s_lshl_b32 s84, s71, 12
    s_mul_i32 s85, s71, 4224
    s_add_u32 s85, s85, 4194304
    s_lshr_b32 s72, s71, 1
    s_lshl_b32 s72, s72, 2
    v_lshlrev_b32 v224, 4, v0
    v_mov_b32 v228, 0
    v_mov_b32 v229, 0
    v_mov_b32 v230, 0
    v_mov_b32 v231, 0
    v_mov_b32 v227, 134352
    v_mov_b32 v244, 1
    s_bfe_u32 s87, s2, 0x10003
    s_mov_b64 exec, 1
    ds_write_b128 v227, v[228:231]
    ds_write_b128 v227, v[228:231] offset:16
    s_mov_b64 exec, -1
    s_cmp_lg_u32 s2, 0
    s_cbranch_scc1 L_noinit
    v_lshlrev_b32 v20, 8, v0
    s_lshl_b32 s74, s70, 14
    s_add_u32 s74, s74, 0
    buffer_store_dword v228, v20, s[52:55], s74 offen sc1
    s_lshl_b32 s74, s70, 14
    s_add_u32 s74, s74, 65536
    buffer_store_dword v228, v20, s[52:55], s74 offen sc1
    s_lshl_b32 s74, s70, 14
    s_add_u32 s74, s74, 131072
    buffer_store_dword v228, v20, s[52:55], s74 offen sc1
L_noinit:
    s_waitcnt lgkmcnt(0)
    s_barrier
    s_load_dword s72, s[18:19], s72
    s_add_u32 m0, s43, 0
    s_nop 0
    buffer_load_dwordx4 v2, s[32:35], s40 offen offset:0 lds
    s_add_u32 m0, s44, 0
    s_nop 0
    buffer_load_dwordx4 v7, s[36:39], s41 offen offset:0 lds
    buffer_load_dwordx4 v8, s[36:39], s41 offen offset:1024 lds
    s_add_u32 m0, s43, 0
    s_nop 0
    buffer_load_dwordx4 v3, s[32:35], s40 offen offset:1024 lds
    s_add_u32 m0, s44, 8192
    s_nop 0
    buffer_load_dwordx4 v9, s[36:39], s41 offen offset:0 lds
    buffer_load_dwordx4 v10, s[36:39], s41 offen offset:1024 lds
    s_add_u32 m0, s43, 0
    s_nop 0
    buffer_load_dwordx4 v4, s[32:35], s40 offen offset:2048 lds
    s_add_u32 m0, s44, 16384
    s_nop 0
    buffer_load_dwordx4 v11, s[36:39], s41 offen offset:0 lds
    buffer_load_dwordx4 v12, s[36:39], s41 offen offset:1024 lds
    s_add_u32 m0, s43, 0
    s_nop 0
    buffer_load_dwordx4 v5, s[32:35], s40 offen offset:3072 lds
    s_mov_b32 m0, 16384
    s_mov_b64 exec, s[46:47]
    buffer_load_dwordx4 v6, s[32:35], s40 offen lds
    s_mov_b64 exec, -1
    s_movk_i32 s40, 128
    s_mov_b32 s41, 393216
    s_add_u32 m0, s43, 41984
    s_nop 0
    buffer_load_dwordx4 v2, s[32:35], s40 offen offset:0 lds
    s_add_u32 m0, s44, 41984
    s_nop 0
    buffer_load_dwordx4 v7, s[36:39], s41 offen offset:0 lds
    buffer_load_dwordx4 v8, s[36:39], s41 offen offset:1024 lds
    s_add_u32 m0, s43, 41984
    s_nop 0
    buffer_load_dwordx4 v3, s[32:35], s40 offen offset:1024 lds
    s_add_u32 m0, s44, 50176
    s_nop 0
    buffer_load_dwordx4 v9, s[36:39], s41 offen offset:0 lds
    buffer_load_dwordx4 v10, s[36:39], s41 offen offset:1024 lds
    s_add_u32 m0, s43, 41984
    s_nop 0
    buffer_load_dwordx4 v4, s[32:35], s40 offen offset:2048 lds
    s_add_u32 m0, s44, 58368
    s_nop 0
    buffer_load_dwordx4 v11, s[36:39], s41 offen offset:0 lds
    buffer_load_dwordx4 v12, s[36:39], s41 offen offset:1024 lds
    s_add_u32 m0, s43, 41984
    s_nop 0
    buffer_load_dwordx4 v5, s[32:35], s40 offen offset:3072 lds
    s_mov_b32 m0, 58368
    s_mov_b64 exec, s[46:47]
    buffer_load_dwordx4 v6, s[32:35], s40 offen lds
    s_mov_b64 exec, -1
    s_movk_i32 s40, 256
    s_mov_b32 s41, 786432
    s_waitcnt vmcnt(11)
    s_barrier
    s_or_b32 s74, s2, s70
    s_cmp_lg_u32 s74, 0
    s_cbranch_scc1 L_noinit2
    s_mov_b32 s60, s28
    s_mov_b32 s61, s29
    s_mov_b32 s62, 0x100
    s_mov_b32 s63, 0x20000
    s_mov_b64 exec, 1
    buffer_store_dword v244, off, s[60:63], 0 sc1
    s_mov_b64 exec, -1
L_noinit2:
    s_add_u32 m0, s43, 83968
    s_nop 0
    buffer_load_dwordx4 v2, s[32:35], s40 offen offset:0 lds
    s_add_u32 m0, s44, 83968
    s_nop 0
    buffer_load_dwordx4 v7, s[36:39], s41 offen offset:0 lds
    buffer_load_dwordx4 v8, s[36:39], s41 offen offset:1024 lds
    s_add_u32 m0, s43, 83968
    s_nop 0
    buffer_load_dwordx4 v3, s[32:35], s40 offen offset:1024 lds
    s_add_u32 m0, s44, 92160
    s_nop 0
    buffer_load_dwordx4 v9, s[36:39], s41 offen offset:0 lds
    buffer_load_dwordx4 v10, s[36:39], s41 offen offset:1024 lds
    s_add_u32 m0, s43, 83968
    s_nop 0
    buffer_load_dwordx4 v4, s[32:35], s40 offen offset:2048 lds
    s_add_u32 m0, s44, 100352
    s_nop 0
    buffer_load_dwordx4 v11, s[36:39], s41 offen offset:0 lds
    buffer_load_dwordx4 v12, s[36:39], s41 offen offset:1024 lds
    s_add_u32 m0, s43, 83968
    s_nop 0
    buffer_load_dwordx4 v5, s[32:35], s40 offen offset:3072 lds
    s_mov_b32 m0, 100352
    s_mov_b64 exec, s[46:47]
    buffer_load_dwordx4 v6, s[32:35], s40 offen lds
    s_mov_b64 exec, -1
    s_movk_i32 s40, 384
    s_mov_b32 s41, 1179648
    s_mov_b32 exec_lo, 0x7777000
    s_mov_b32 exec_hi, 0x0
    buffer_load_dword v250, v252, s[36:39], s89 offen
    s_xor_b32 s89, s89, 256
    buffer_load_dword v250, v252, s[36:39], s89 offen
    s_xor_b32 s89, s89, 256
    s_mov_b32 exec_lo, 0x3fc0
    s_mov_b32 exec_hi, 0
    buffer_load_dword v250, v251, s[32:35], s88 offen
    s_mov_b64 exec, -1
    s_waitcnt vmcnt(14)
    s_barrier
    s_add_u32 m0, s43, 0
    s_nop 0
    buffer_load_dwordx4 v2, s[32:35], s40 offen offset:0 lds
    s_add_u32 m0, s44, 0
    s_nop 0
    buffer_load_dwordx4 v7, s[36:39], s41 offen offset:0 lds
    buffer_load_dwordx4 v8, s[36:39], s41 offen offset:1024 lds
    s_add_u32 m0, s43, 0
    s_nop 0
    buffer_load_dwordx4 v3, s[32:35], s40 offen offset:1024 lds
    s_add_u32 m0, s44, 8192
    s_nop 0
    buffer_load_dwordx4 v9, s[36:39], s41 offen offset:0 lds
    buffer_load_dwordx4 v10, s[36:39], s41 offen offset:1024 lds
    s_add_u32 m0, s43, 0
    s_nop 0
    buffer_load_dwordx4 v4, s[32:35], s40 offen offset:2048 lds
    s_add_u32 m0, s44, 16384
    s_nop 0
    buffer_load_dwordx4 v11, s[36:39], s41 offen offset:0 lds
    buffer_load_dwordx4 v12, s[36:39], s41 offen offset:1024 lds
    s_add_u32 m0, s43, 0
    s_nop 0
    buffer_load_dwordx4 v5, s[32:35], s40 offen offset:3072 lds
    s_mov_b32 m0, 16384
    s_mov_b64 exec, s[46:47]
    buffer_load_dwordx4 v6, s[32:35], s40 offen lds
    s_mov_b64 exec, -1
    s_movk_i32 s40, 512
    s_mov_b32 s41, 1572864
    s_waitcnt vmcnt(14)
    s_barrier
    s_add_u32 m0, s43, 41984
    s_nop 0
    buffer_load_dwordx4 v2, s[32:35], s40 offen offset:0 lds
    s_add_u32 m0, s44, 41984
    s_nop 0
    buffer_load_dwordx4 v7, s[36:39], s41 offen offset:0 lds
    buffer_load_dwordx4 v8, s[36:39], s41 offen offset:1024 lds
    s_add_u32 m0, s43, 41984
    s_nop 0
    buffer_load_dwordx4 v3, s[32:35], s40 offen offset:1024 lds
    s_add_u32 m0, s44, 50176
    s_nop 0
    buffer_load_dwordx4 v9, s[36:39], s41 offen offset:0 lds
    buffer_load_dwordx4 v10, s[36:39], s41 offen offset:1024 lds
    s_add_u32 m0, s43, 41984
    s_nop 0
    buffer_load_dwordx4 v4, s[32:35], s40 offen offset:2048 lds
    s_add_u32 m0, s44, 58368
    s_nop 0
    buffer_load_dwordx4 v11, s[36:39], s41 offen offset:0 lds
    buffer_load_dwordx4 v12, s[36:39], s41 offen offset:1024 lds
    s_add_u32 m0, s43, 41984
    s_nop 0
    buffer_load_dwordx4 v5, s[32:35], s40 offen offset:3072 lds
    s_mov_b32 m0, 58368
    s_mov_b64 exec, s[46:47]
    buffer_load_dwordx4 v6, s[32:35], s40 offen lds
    s_mov_b64 exec, -1
    s_movk_i32 s40, 640
    s_mov_b32 s41, 1966080
    s_cmp_lg_u32 s87, 0
    s_cbranch_scc1 L_stg_4
    s_mov_b32 exec_lo, 0x70000000
    s_mov_b32 exec_hi, 0x777
    buffer_load_dword v250, v252, s[36:39], s89 offen
    s_xor_b32 s89, s89, 256
    buffer_load_dword v250, v252, s[36:39], s89 offen
    s_xor_b32 s89, s89, 256
    s_mov_b32 exec_lo, 0x3fc000
    s_mov_b32 exec_hi, 0
    buffer_load_dword v250, v251, s[32:35], s88 offen
    s_mov_b64 exec, -1
L_stg_4:
    s_waitcnt vmcnt(14)
    s_bitcmp1_b32 1, s87
    s_cbranch_scc1 L_mw_5
    s_waitcnt vmcnt(11)
L_mw_5:
    s_barrier
    s_load_dword s78, s[28:29], 0
    s_add_u32 m0, s43, 83968
    s_nop 0
    buffer_load_dwordx4 v2, s[32:35], s40 offen offset:0 lds
    s_add_u32 m0, s44, 83968
    s_nop 0
    buffer_load_dwordx4 v7, s[36:39], s41 offen offset:0 lds
    buffer_load_dwordx4 v8, s[36:39], s41 offen offset:1024 lds
    s_add_u32 m0, s43, 83968
    s_nop 0
    buffer_load_dwordx4 v3, s[32:35], s40 offen offset:1024 lds
    s_add_u32 m0, s44, 92160
    s_nop 0
    buffer_load_dwordx4 v9, s[36:39], s41 offen offset:0 lds
    buffer_load_dwordx4 v10, s[36:39], s41 offen offset:1024 lds
    s_add_u32 m0, s43, 83968
    s_nop 0
    buffer_load_dwordx4 v4, s[32:35], s40 offen offset:2048 lds
    s_add_u32 m0, s44, 100352
    s_nop 0
    buffer_load_dwordx4 v11, s[36:39], s41 offen offset:0 lds
    buffer_load_dwordx4 v12, s[36:39], s41 offen offset:1024 lds
    s_add_u32 m0, s43, 83968
    s_nop 0
    buffer_load_dwordx4 v5, s[32:35], s40 offen offset:3072 lds
    s_mov_b32 m0, 100352
    s_mov_b64 exec, s[46:47]
    buffer_load_dwordx4 v6, s[32:35], s40 offen lds
    s_mov_b64 exec, -1
    s_movk_i32 s40, 768
    s_mov_b32 s41, 2359296
    s_cmp_lg_u32 s87, 1
    s_cbranch_scc1 L_stg_6
    s_mov_b32 exec_lo, 0x70000000
    s_mov_b32 exec_hi, 0x777
    buffer_load_dword v250, v252, s[36:39], s89 offen
    s_xor_b32 s89, s89, 256
    buffer_load_dword v250, v252, s[36:39], s89 offen
    s_xor_b32 s89, s89, 256
    s_mov_b32 exec_lo, 0x3fc000
    s_mov_b32 exec_hi, 0
    buffer_load_dword v250, v251, s[32:35], s88 offen
    s_mov_b64 exec, -1
L_stg_6:
    v_and_b32 v234, 1, v0
    v_xor_b32 v234, 1, v234
    v_mul_u32_u24 v232, 4224, v234
    v_mul_u32_u24 v233, 4576, v234
    v_bfe_u32 v234, v0, 1, 3
    v_lshl_add_u32 v232, v234, 3, v232
    v_xor_b32 v234, 7, v234
    v_lshl_add_u32 v233, v234, 6, v233
    v_lshrrev_b32 v234, 4, v0
    v_lshl_add_u32 v232, v234, 4, v232
    v_lshl_add_u32 v233, v234, 4, v233
    v_add3_u32 v232, v232, s80, 8
    v_add_u32 v233, s81, v233
    s_waitcnt lgkmcnt(0)
    s_bitcmp1_b32 s71, 0
    s_cselect_b32 s74, 0, 16
    s_lshl_b32 s72, s72, s74
    s_and_b32 s72, s72, 0xffff0000
    v_and_b32 v235, 1, v0
    v_lshlrev_b32 v235, 4, v235
    v_lshrrev_b32 v235, v235, s72
    v_bfe_u32 v236, v0, 1, 3
    v_lshl_add_u32 v236, v234, 1, v236
    v_cmp_eq_u32 vcc, 7, v236
    v_mov_b32 v241, 0
    v_mov_b32 v243, 0
    v_cndmask_b32 v240, 0, v235, vcc
    v_cmp_eq_u32 vcc, 6, v236
    s_nop 1
    v_cndmask_b32 v242, 0, v235, vcc
    s_lshr_b32 s74, s69, 2
    s_and_b32 s75, s69, 3
    s_lshl3_add_u32 s74, s74, s75
    s_lshl3_add_u32 s74, s74, s70
    s_lshl_b32 s74, s74, 3
    v_bfe_u32 v234, v0, 3, 1
    v_lshl_add_u32 v225, v234, 8, s74
    v_bfe_u32 v234, v0, 4, 1
    v_lshl_add_u32 v225, v234, 1, v225
    v_lshrrev_b32 v234, 5, v0
    v_lshl_add_u32 v225, v234, 5, v225
    s_lshl_b32 s74, s68, 7
    v_and_b32 v234, 7, v0
    v_lshl_add_u32 v234, v234, 4, s74
    v_lshl_add_u32 v226, v225, 12, v234
    v_lshl_add_u32 v225, v225, 11, v234
    s_waitcnt vmcnt(14)
    s_barrier
    s_cmp_lg_u32 s70, 0
    s_cbranch_scc1 L_sig_8
    s_mov_b32 s79, 131072
    s_branch L_sg_chk_11
L_sg_loop_10:
    s_load_dword s78, s[28:29], 0 glc
L_sg_chk_11:
    s_waitcnt lgkmcnt(0)
    s_cmp_ge_u32 s78, 1
    s_cbranch_scc1 L_sg_done_9
    s_sub_u32 s79, s79, 1
    s_cbranch_scc0 L_sg_loop_10
L_sg_done_9:
    s_mov_b64 exec, 1
    buffer_atomic_add v244, off, s[52:55], s73 sc1
    s_mov_b64 exec, -1
L_sig_8:
    s_add_u32 m0, s43, 0
    s_nop 0
    buffer_load_dwordx4 v2, s[32:35], s40 offen offset:0 lds
    s_add_u32 m0, s44, 0
    s_nop 0
    buffer_load_dwordx4 v7, s[36:39], s41 offen offset:0 lds
    buffer_load_dwordx4 v8, s[36:39], s41 offen offset:1024 lds
    s_add_u32 m0, s43, 0
    s_nop 0
    buffer_load_dwordx4 v3, s[32:35], s40 offen offset:1024 lds
    s_add_u32 m0, s44, 8192
    s_nop 0
    buffer_load_dwordx4 v9, s[36:39], s41 offen offset:0 lds
    buffer_load_dwordx4 v10, s[36:39], s41 offen offset:1024 lds
    s_add_u32 m0, s43, 0
    s_nop 0
    buffer_load_dwordx4 v4, s[32:35], s40 offen offset:2048 lds
    s_add_u32 m0, s44, 16384
    s_nop 0
    buffer_load_dwordx4 v11, s[36:39], s41 offen offset:0 lds
    buffer_load_dwordx4 v12, s[36:39], s41 offen offset:1024 lds
    s_add_u32 m0, s43, 0
    s_nop 0
    buffer_load_dwordx4 v5, s[32:35], s40 offen offset:3072 lds
    s_mov_b32 m0, 16384
    s_mov_b64 exec, s[46:47]
    buffer_load_dwordx4 v6, s[32:35], s40 offen lds
    s_mov_b64 exec, -1
    s_movk_i32 s40, 896
    s_mov_b32 s41, 2752512
    s_load_dwordx2 s[90:91], s[16:17], s84 offset:60
    s_load_dwordx2 s[90:91], s[16:17], s84 offset:188
    s_load_dwordx2 s[90:91], s[16:17], s84 offset:316
    s_load_dwordx2 s[90:91], s[16:17], s84 offset:444
    s_waitcnt vmcnt(14)
    s_bitcmp1_b32 2, s87
    s_cbranch_scc1 L_mw_12
    s_waitcnt vmcnt(11)
L_mw_12:
    s_barrier
    s_add_u32 m0, s43, 41984
    s_nop 0
    buffer_load_dwordx4 v2, s[32:35], s40 offen offset:0 lds
    s_add_u32 m0, s44, 41984
    s_nop 0
    buffer_load_dwordx4 v7, s[36:39], s41 offen offset:0 lds
    buffer_load_dwordx4 v8, s[36:39], s41 offen offset:1024 lds
    s_add_u32 m0, s43, 41984
    s_nop 0
    buffer_load_dwordx4 v3, s[32:35], s40 offen offset:1024 lds
    s_add_u32 m0, s44, 50176
    s_nop 0
    buffer_load_dwordx4 v9, s[36:39], s41 offen offset:0 lds
    buffer_load_dwordx4 v10, s[36:39], s41 offen offset:1024 lds
    s_add_u32 m0, s43, 41984
    s_nop 0
    buffer_load_dwordx4 v4, s[32:35], s40 offen offset:2048 lds
    s_add_u32 m0, s44, 58368
    s_nop 0
    buffer_load_dwordx4 v11, s[36:39], s41 offen offset:0 lds
    buffer_load_dwordx4 v12, s[36:39], s41 offen offset:1024 lds
    s_add_u32 m0, s43, 41984
    s_nop 0
    buffer_load_dwordx4 v5, s[32:35], s40 offen offset:3072 lds
    s_mov_b32 m0, 58368
    s_mov_b64 exec, s[46:47]
    buffer_load_dwordx4 v6, s[32:35], s40 offen lds
    s_mov_b64 exec, -1
    s_movk_i32 s40, 1024
    s_mov_b32 s41, 3145728
    s_load_dwordx2 s[90:91], s[16:17], s84 offset:572
    s_load_dwordx2 s[90:91], s[16:17], s84 offset:700
    s_load_dwordx2 s[90:91], s[16:17], s84 offset:828
    s_load_dwordx2 s[90:91], s[16:17], s84 offset:956
    s_waitcnt vmcnt(11)
    s_barrier
    s_add_u32 m0, s43, 83968
    s_nop 0
    buffer_load_dwordx4 v2, s[32:35], s40 offen offset:0 lds
    s_add_u32 m0, s44, 83968
    s_nop 0
    buffer_load_dwordx4 v7, s[36:39], s41 offen offset:0 lds
    buffer_load_dwordx4 v8, s[36:39], s41 offen offset:1024 lds
    s_add_u32 m0, s43, 83968
    s_nop 0
    buffer_load_dwordx4 v3, s[32:35], s40 offen offset:1024 lds
    s_add_u32 m0, s44, 92160
    s_nop 0
    buffer_load_dwordx4 v9, s[36:39], s41 offen offset:0 lds
    buffer_load_dwordx4 v10, s[36:39], s41 offen offset:1024 lds
    s_add_u32 m0, s43, 83968
    s_nop 0
    buffer_load_dwordx4 v4, s[32:35], s40 offen offset:2048 lds
    s_add_u32 m0, s44, 100352
    s_nop 0
    buffer_load_dwordx4 v11, s[36:39], s41 offen offset:0 lds
    buffer_load_dwordx4 v12, s[36:39], s41 offen offset:1024 lds
    s_add_u32 m0, s43, 83968
    s_nop 0
    buffer_load_dwordx4 v5, s[32:35], s40 offen offset:3072 lds
    s_mov_b32 m0, 100352
    s_mov_b64 exec, s[46:47]
    buffer_load_dwordx4 v6, s[32:35], s40 offen lds
    s_mov_b64 exec, -1
    s_movk_i32 s40, 1152
    s_mov_b32 s41, 3538944
    s_cmp_lg_u32 s87, 0
    s_cbranch_scc1 L_stg_14
    s_mov_b32 exec_lo, 0x0
    s_mov_b32 exec_hi, 0x77777000
    buffer_load_dword v250, v252, s[36:39], s89 offen
    s_xor_b32 s89, s89, 256
    buffer_load_dword v250, v252, s[36:39], s89 offen
    s_xor_b32 s89, s89, 256
    s_mov_b32 exec_lo, 0xffc00000
    s_mov_b32 exec_hi, 0
    buffer_load_dword v250, v251, s[32:35], s88 offen
    s_mov_b64 exec, -1
L_stg_14:
    s_load_dwordx2 s[90:91], s[16:17], s84 offset:1084
    s_load_dwordx2 s[90:91], s[16:17], s84 offset:1212
    s_load_dwordx2 s[90:91], s[16:17], s84 offset:1340
    s_load_dwordx2 s[90:91], s[16:17], s84 offset:1468
    s_waitcnt vmcnt(14)
    s_bitcmp1_b32 1, s87
    s_cbranch_scc1 L_mw_15
    s_waitcnt vmcnt(11)
L_mw_15:
    s_barrier
    s_add_u32 m0, s43, 0
    s_nop 0
    buffer_load_dwordx4 v2, s[32:35], s40 offen offset:0 lds
    s_add_u32 m0, s44, 0
    s_nop 0
    buffer_load_dwordx4 v7, s[36:39], s41 offen offset:0 lds
    buffer_load_dwordx4 v8, s[36:39], s41 offen offset:1024 lds
    s_add_u32 m0, s43, 0
    s_nop 0
    buffer_load_dwordx4 v3, s[32:35], s40 offen offset:1024 lds
    s_add_u32 m0, s44, 8192
    s_nop 0
    buffer_load_dwordx4 v9, s[36:39], s41 offen offset:0 lds
    buffer_load_dwordx4 v10, s[36:39], s41 offen offset:1024 lds
    s_add_u32 m0, s43, 0
    s_nop 0
    buffer_load_dwordx4 v4, s[32:35], s40 offen offset:2048 lds
    s_add_u32 m0, s44, 16384
    s_nop 0
    buffer_load_dwordx4 v11, s[36:39], s41 offen offset:0 lds
    buffer_load_dwordx4 v12, s[36:39], s41 offen offset:1024 lds
    s_add_u32 m0, s43, 0
    s_nop 0
    buffer_load_dwordx4 v5, s[32:35], s40 offen offset:3072 lds
    s_mov_b32 m0, 16384
    s_mov_b64 exec, s[46:47]
    buffer_load_dwordx4 v6, s[32:35], s40 offen lds
    s_mov_b64 exec, -1
    s_movk_i32 s40, 1280
    s_mov_b32 s41, 3932160
    s_cmp_lg_u32 s87, 1
    s_cbranch_scc1 L_stg_16
    s_mov_b32 exec_lo, 0x0
    s_mov_b32 exec_hi, 0x77777000
    buffer_load_dword v250, v252, s[36:39], s89 offen
    s_xor_b32 s89, s89, 256
    buffer_load_dword v250, v252, s[36:39], s89 offen
    s_xor_b32 s89, s89, 256
    s_mov_b32 exec_lo, 0xffc00000
    s_mov_b32 exec_hi, 0
    buffer_load_dword v250, v251, s[32:35], s88 offen
    s_mov_b64 exec, -1
L_stg_16:
    s_load_dwordx2 s[90:91], s[16:17], s84 offset:1596
    s_load_dwordx2 s[90:91], s[16:17], s84 offset:1724
    s_load_dwordx2 s[90:91], s[16:17], s84 offset:1852
    s_load_dwordx2 s[90:91], s[16:17], s84 offset:1980
    s_waitcnt vmcnt(14)
    s_barrier
    s_add_u32 m0, s43, 41984
    s_nop 0
    buffer_load_dwordx4 v2, s[32:35], s40 offen offset:0 lds
    s_add_u32 m0, s44, 41984
    s_nop 0
    buffer_load_dwordx4 v7, s[36:39], s41 offen offset:0 lds
    buffer_load_dwordx4 v8, s[36:39], s41 offen offset:1024 lds
    s_add_u32 m0, s43, 41984
    s_nop 0
    buffer_load_dwordx4 v3, s[32:35], s40 offen offset:1024 lds
    s_add_u32 m0, s44, 50176
    s_nop 0
    buffer_load_dwordx4 v9, s[36:39], s41 offen offset:0 lds
    buffer_load_dwordx4 v10, s[36:39], s41 offen offset:1024 lds
    s_add_u32 m0, s43, 41984
    s_nop 0
    buffer_load_dwordx4 v4, s[32:35], s40 offen offset:2048 lds
    s_add_u32 m0, s44, 58368
    s_nop 0
    buffer_load_dwordx4 v11, s[36:39], s41 offen offset:0 lds
    buffer_load_dwordx4 v12, s[36:39], s41 offen offset:1024 lds
    s_add_u32 m0, s43, 41984
    s_nop 0
    buffer_load_dwordx4 v5, s[32:35], s40 offen offset:3072 lds
    s_mov_b32 m0, 58368
    s_mov_b64 exec, s[46:47]
    buffer_load_dwordx4 v6, s[32:35], s40 offen lds
    s_mov_b64 exec, -1
    s_movk_i32 s40, 1408
    s_mov_b32 s41, 4325376
    s_load_dwordx2 s[90:91], s[16:17], s84 offset:2108
    s_load_dwordx2 s[90:91], s[16:17], s84 offset:2236
    s_load_dwordx2 s[90:91], s[16:17], s84 offset:2364
    s_load_dwordx2 s[90:91], s[16:17], s84 offset:2492
    s_waitcnt vmcnt(14)
    s_bitcmp1_b32 2, s87
    s_cbranch_scc1 L_mw_18
    s_waitcnt vmcnt(11)
L_mw_18:
    s_barrier
    s_add_u32 m0, s43, 83968
    s_nop 0
    buffer_load_dwordx4 v2, s[32:35], s40 offen offset:0 lds
    s_add_u32 m0, s44, 83968
    s_nop 0
    buffer_load_dwordx4 v7, s[36:39], s41 offen offset:0 lds
    buffer_load_dwordx4 v8, s[36:39], s41 offen offset:1024 lds
    s_add_u32 m0, s43, 83968
    s_nop 0
    buffer_load_dwordx4 v3, s[32:35], s40 offen offset:1024 lds
    s_add_u32 m0, s44, 92160
    s_nop 0
    buffer_load_dwordx4 v9, s[36:39], s41 offen offset:0 lds
    buffer_load_dwordx4 v10, s[36:39], s41 offen offset:1024 lds
    s_add_u32 m0, s43, 83968
    s_nop 0
    buffer_load_dwordx4 v4, s[32:35], s40 offen offset:2048 lds
    s_add_u32 m0, s44, 100352
    s_nop 0
    buffer_load_dwordx4 v11, s[36:39], s41 offen offset:0 lds
    buffer_load_dwordx4 v12, s[36:39], s41 offen offset:1024 lds
    s_add_u32 m0, s43, 83968
    s_nop 0
    buffer_load_dwordx4 v5, s[32:35], s40 offen offset:3072 lds
    s_mov_b32 m0, 100352
    s_mov_b64 exec, s[46:47]
    buffer_load_dwordx4 v6, s[32:35], s40 offen lds
    s_mov_b64 exec, -1
    s_movk_i32 s40, 1536
    s_mov_b32 s41, 4718592
    s_load_dwordx2 s[90:91], s[16:17], s84 offset:2620
    s_load_dwordx2 s[90:91], s[16:17], s84 offset:2748
    s_load_dwordx2 s[90:91], s[16:17], s84 offset:2876
    s_load_dwordx2 s[90:91], s[16:17], s84 offset:3004
    s_waitcnt vmcnt(11)
    s_barrier
    s_add_u32 m0, s43, 0
    s_nop 0
    buffer_load_dwordx4 v2, s[32:35], s40 offen offset:0 lds
    s_add_u32 m0, s44, 0
    s_nop 0
    buffer_load_dwordx4 v7, s[36:39], s41 offen offset:0 lds
    buffer_load_dwordx4 v8, s[36:39], s41 offen offset:1024 lds
    s_add_u32 m0, s43, 0
    s_nop 0
    buffer_load_dwordx4 v3, s[32:35], s40 offen offset:1024 lds
    s_add_u32 m0, s44, 8192
    s_nop 0
    buffer_load_dwordx4 v9, s[36:39], s41 offen offset:0 lds
    buffer_load_dwordx4 v10, s[36:39], s41 offen offset:1024 lds
    s_add_u32 m0, s43, 0
    s_nop 0
    buffer_load_dwordx4 v4, s[32:35], s40 offen offset:2048 lds
    s_add_u32 m0, s44, 16384
    s_nop 0
    buffer_load_dwordx4 v11, s[36:39], s41 offen offset:0 lds
    buffer_load_dwordx4 v12, s[36:39], s41 offen offset:1024 lds
    s_add_u32 m0, s43, 0
    s_nop 0
    buffer_load_dwordx4 v5, s[32:35], s40 offen offset:3072 lds
    s_mov_b32 m0, 16384
    s_mov_b64 exec, s[46:47]
    buffer_load_dwordx4 v6, s[32:35], s40 offen lds
    s_mov_b64 exec, -1
    s_movk_i32 s40, 1664
    s_mov_b32 s41, 5111808
    s_load_dwordx2 s[90:91], s[16:17], s84 offset:3132
    s_load_dwordx2 s[90:91], s[16:17], s84 offset:3260
    s_load_dwordx2 s[90:91], s[16:17], s84 offset:3388
    s_load_dwordx2 s[90:91], s[16:17], s84 offset:3516
    s_waitcnt vmcnt(11)
    s_barrier
    s_add_u32 m0, s43, 41984
    s_nop 0
    buffer_load_dwordx4 v2, s[32:35], s40 offen offset:0 lds
    s_add_u32 m0, s44, 41984
    s_nop 0
    buffer_load_dwordx4 v7, s[36:39], s41 offen offset:0 lds
    buffer_load_dwordx4 v8, s[36:39], s41 offen offset:1024 lds
    s_add_u32 m0, s43, 41984
    s_nop 0
    buffer_load_dwordx4 v3, s[32:35], s40 offen offset:1024 lds
    s_add_u32 m0, s44, 50176
    s_nop 0
    buffer_load_dwordx4 v9, s[36:39], s41 offen offset:0 lds
    buffer_load_dwordx4 v10, s[36:39], s41 offen offset:1024 lds
    s_add_u32 m0, s43, 41984
    s_nop 0
    buffer_load_dwordx4 v4, s[32:35], s40 offen offset:2048 lds
    s_add_u32 m0, s44, 58368
    s_nop 0
    buffer_load_dwordx4 v11, s[36:39], s41 offen offset:0 lds
    buffer_load_dwordx4 v12, s[36:39], s41 offen offset:1024 lds
    s_add_u32 m0, s43, 41984
    s_nop 0
    buffer_load_dwordx4 v5, s[32:35], s40 offen offset:3072 lds
    s_mov_b32 m0, 58368
    s_mov_b64 exec, s[46:47]
    buffer_load_dwordx4 v6, s[32:35], s40 offen lds
    s_mov_b64 exec, -1
    s_movk_i32 s40, 1792
    s_mov_b32 s41, 5505024
    s_load_dwordx2 s[90:91], s[16:17], s84 offset:3644
    s_load_dwordx2 s[90:91], s[16:17], s84 offset:3772
    s_load_dwordx2 s[90:91], s[16:17], s84 offset:3900
    s_load_dwordx2 s[90:91], s[16:17], s84 offset:4028
    s_waitcnt vmcnt(11)
    s_barrier
    s_add_u32 m0, s43, 83968
    s_nop 0
    buffer_load_dwordx4 v2, s[32:35], s40 offen offset:0 lds
    s_add_u32 m0, s44, 83968
    s_nop 0
    buffer_load_dwordx4 v7, s[36:39], s41 offen offset:0 lds
    buffer_load_dwordx4 v8, s[36:39], s41 offen offset:1024 lds
    s_add_u32 m0, s43, 83968
    s_nop 0
    buffer_load_dwordx4 v3, s[32:35], s40 offen offset:1024 lds
    s_add_u32 m0, s44, 92160
    s_nop 0
    buffer_load_dwordx4 v9, s[36:39], s41 offen offset:0 lds
    buffer_load_dwordx4 v10, s[36:39], s41 offen offset:1024 lds
    s_add_u32 m0, s43, 83968
    s_nop 0
    buffer_load_dwordx4 v4, s[32:35], s40 offen offset:2048 lds
    s_add_u32 m0, s44, 100352
    s_nop 0
    buffer_load_dwordx4 v11, s[36:39], s41 offen offset:0 lds
    buffer_load_dwordx4 v12, s[36:39], s41 offen offset:1024 lds
    s_add_u32 m0, s43, 83968
    s_nop 0
    buffer_load_dwordx4 v5, s[32:35], s40 offen offset:3072 lds
    s_mov_b32 m0, 100352
    s_mov_b64 exec, s[46:47]
    buffer_load_dwordx4 v6, s[32:35], s40 offen lds
    s_mov_b64 exec, -1
    s_movk_i32 s40, 1920
    s_mov_b32 s41, 5898240
    s_waitcnt vmcnt(11)
    s_barrier
    s_load_dword s78, s[52:53], s45
    s_add_u32 m0, s43, 0
    s_nop 0
    buffer_load_dwordx4 v2, s[32:35], s40 offen offset:0 lds
    s_add_u32 m0, s44, 0
    s_nop 0
    buffer_load_dwordx4 v7, s[36:39], s41 offen offset:0 lds
    buffer_load_dwordx4 v8, s[36:39], s41 offen offset:1024 lds
    s_add_u32 m0, s43, 0
    s_nop 0
    buffer_load_dwordx4 v3, s[32:35], s40 offen offset:1024 lds
    s_add_u32 m0, s44, 8192
    s_nop 0
    buffer_load_dwordx4 v9, s[36:39], s41 offen offset:0 lds
    buffer_load_dwordx4 v10, s[36:39], s41 offen offset:1024 lds
    s_add_u32 m0, s43, 0
    s_nop 0
    buffer_load_dwordx4 v4, s[32:35], s40 offen offset:2048 lds
    s_add_u32 m0, s44, 16384
    s_nop 0
    buffer_load_dwordx4 v11, s[36:39], s41 offen offset:0 lds
    buffer_load_dwordx4 v12, s[36:39], s41 offen offset:1024 lds
    s_add_u32 m0, s43, 0
    s_nop 0
    buffer_load_dwordx4 v5, s[32:35], s40 offen offset:3072 lds
    s_mov_b32 m0, 16384
    s_mov_b64 exec, s[46:47]
    buffer_load_dwordx4 v6, s[32:35], s40 offen lds
    s_mov_b64 exec, -1
    s_movk_i32 s40, 2048
    s_mov_b32 s41, 6291456
    s_mov_b32 s79, 131072
    s_branch L_sg_chk_25
L_sg_loop_24:
    s_load_dword s78, s[52:53], s45 glc
L_sg_chk_25:
    s_waitcnt lgkmcnt(0)
    s_cmp_ge_u32 s78, 64
    s_cbranch_scc1 L_sg_done_23
    s_sub_u32 s79, s79, 1
    s_cbranch_scc0 L_sg_loop_24
L_sg_done_23:
    s_waitcnt vmcnt(11)
    s_barrier
    s_add_u32 s56, s30, s85
    s_addc_u32 s57, s31, 0
    s_movk_i32 s58, 4096
    s_mov_b32 s59, 0x20000
    s_add_u32 m0, s81, 0
    s_nop 0
    buffer_load_dwordx4 v224, s[56:59], 0 offen offset:0 sc1 lds
    buffer_load_dwordx4 v224, s[56:59], 0 offen offset:1024 sc1 lds
    buffer_load_dwordx4 v224, s[56:59], 0 offen offset:2048 sc1 lds
    buffer_load_dwordx4 v224, s[56:59], 0 offen offset:3072 sc1 lds
    s_add_u32 m0, s81, 4572
    s_nop 0
    buffer_load_dwordx4 v224, s[56:59], 0 offen offset:0 sc1 lds
    buffer_load_dwordx4 v224, s[56:59], 0 offen offset:1024 sc1 lds
    buffer_load_dwordx4 v224, s[56:59], 0 offen offset:2048 sc1 lds
    buffer_load_dwordx4 v224, s[56:59], 0 offen offset:3072 sc1 lds
    s_waitcnt vmcnt(8)
    s_mov_b64 exec, 1
    ds_add_u32 v227, v244 offset:24
    s_mov_b64 exec, -1
    s_add_u32 s56, s16, s84
    s_addc_u32 s57, s17, 0
    s_movk_i32 s58, 4096
    s_mov_b32 s59, 0x20000
    s_add_u32 m0, s80, 64
    v_mov_b32 v132, 0
    v_mov_b32 v133, 0
    v_mov_b32 v134, 0
    v_mov_b32 v135, 0
    buffer_load_dwordx4 v224, s[56:59], 0 offen offset:0 lds
    buffer_load_dwordx4 v224, s[56:59], 0 offen offset:1024 lds
    buffer_load_dwordx4 v224, s[56:59], 0 offen offset:2048 lds
    buffer_load_dwordx4 v224, s[56:59], 0 offen offset:3072 lds
    s_add_u32 m0, s80, 4304
    s_mov_b64 exec, 0x100
    buffer_load_dwordx4 v[132:135], off, s[56:59], 0
    s_mov_b64 exec, -1
    buffer_load_dwordx4 v224, s[56:59], 14 offen offset:0 lds
    buffer_load_dwordx4 v224, s[56:59], 14 offen offset:1024 lds
    buffer_load_dwordx4 v224, s[56:59], 14 offen offset:2048 lds
    buffer_load_dwordx4 v224, s[56:59], 14 offen offset:3072 lds
    v_lshrrev_b32 v234, 5, v0
    v_mul_u32_u24 v234, 4064, v234
    v_add3_u32 v234, v234, v224, s81
    s_mov_b32 exec_lo, 0xfffffff
    s_mov_b32 exec_hi, 0xfffffff
    ds_write_b128 v234, v[228:231] offset:4096
    s_mov_b64 exec, 1
    ds_write_b32 v234, v228 offset:8668
    s_mov_b64 exec, -1
    s_setprio 3
    s_mov_b32 s60, s24
    s_mov_b32 s61, s25
    s_mov_b32 s62, 0x200000
    s_mov_b32 s63, 0x20000
    s_lshr_b32 s74, s2, 3
    s_lshl2_add_u32 s74, s74, s70
    s_bfe_u32 s75, s2, 0x10002
    s_lshl4_add_u32 s74, s74, s75
    s_lshl_b32 s74, s74, 10
    v_lshrrev_b32 v234, 3, v0
    v_and_b32 v235, 7, v0
    v_lshlrev_b32 v235, 7, v235
    v_lshl_add_u32 v234, v234, 11, v235
    buffer_load_dword v250, v234, s[60:63], s74 offen
    s_mov_b32 s60, s8
    s_mov_b32 s61, s9
    s_mov_b32 s62, 0x400000
    s_mov_b32 s63, 0x20000
    s_movk_i32 s75, 8192
    buffer_load_dwordx4 v[208:211], v225, s[60:63], 0 offen offset:0 nt
    buffer_load_dwordx4 v[212:215], v225, s[60:63], 0 offen offset:2048 nt
    buffer_load_dwordx4 v[216:219], v225, s[60:63], s75 offen offset:0 nt
    buffer_load_dwordx4 v[220:223], v225, s[60:63], s75 offen offset:2048 nt
    s_waitcnt vmcnt(14)
    s_waitcnt vmcnt(5)
    v_cmp_lt_u32 vcc, 3, v0
    v_mov_b32 v140, 4160
    v_lshlrev_b32 v136, 16, v132
    v_cndmask_b32 v140, 0, v140, vcc
    v_alignbit_b32 v137, v133, v132, 16
    v_alignbit_b32 v138, v134, v133, 16
    v_alignbit_b32 v139, v135, v134, 16
    v_add3_u32 v140, v140, v224, s80
    s_mov_b64 exec, 0x1ff
    ds_write_b128 v140, v[136:139]
    s_mov_b64 exec, -1
    ds_read_b128 v[112:115], v233 offset:3584
    ds_read_b64 v[48:49], v232 offset:0
    ds_read_b64 v[50:51], v232 offset:8
    ds_read_b128 v[116:119], v233 offset:3072
    ds_read_b64 v[52:53], v232 offset:512
    ds_read_b64 v[54:55], v232 offset:520
    ds_read_b128 v[120:123], v233 offset:2560
    ds_read_b64 v[56:57], v232 offset:1024
    ds_read_b64 v[58:59], v232 offset:1032
    ds_read_b128 v[124:127], v233 offset:2048
    ds_read_b64 v[60:61], v232 offset:1536
    ds_read_b64 v[62:63], v232 offset:1544
    ds_read_b128 v[128:131], v233 offset:1536
    ds_read_b64 v[64:65], v232 offset:2048
    ds_read_b64 v[66:67], v232 offset:2056
    ds_read_b128 v[132:135], v233 offset:1024
    ds_read_b64 v[68:69], v232 offset:2560
    ds_read_b64 v[70:71], v232 offset:2568
    ds_read_b128 v[136:139], v233 offset:512
    ds_read_b64 v[72:73], v232 offset:3072
    ds_read_b64 v[74:75], v232 offset:3080
    ds_read_b128 v[140:143], v233 offset:0
    ds_read_b64 v[76:77], v232 offset:3584
    ds_read_b64 v[78:79], v232 offset:3592
    s_setprio 1
    s_mov_b32 s74, 3
    s_waitcnt lgkmcnt(0)
    v_mfma_f32_16x16x32_bf16 v[16:19], v[240:243], v[112:115], 0
    v_mfma_f32_16x16x32_bf16 v[20:23], v[240:243], v[116:119], 0
    v_mfma_f32_16x16x32_bf16 v[24:27], v[240:243], v[120:123], 0
    v_mfma_f32_16x16x32_bf16 v[28:31], v[240:243], v[124:127], 0
    v_mfma_f32_16x16x32_bf16 v[32:35], v[240:243], v[128:131], 0
    v_mfma_f32_16x16x32_bf16 v[36:39], v[240:243], v[132:135], 0
    v_mfma_f32_16x16x32_bf16 v[40:43], v[240:243], v[136:139], 0
    v_mfma_f32_16x16x32_bf16 v[44:47], v[240:243], v[140:143], 0
L_conv:
    v_mfma_f32_16x16x32_bf16 v[16:19], v[48:51], v[112:115], v[16:19]
    ds_read_b128 v[144:147], v233 offset:3648
    v_mfma_f32_16x16x32_bf16 v[20:23], v[48:51], v[116:119], v[20:23]
    ds_read_b64 v[80:81], v232 offset:64
    v_mfma_f32_16x16x32_bf16 v[20:23], v[52:55], v[112:115], v[20:23]
    ds_read_b64 v[82:83], v232 offset:72
    v_mfma_f32_16x16x32_bf16 v[24:27], v[48:51], v[120:123], v[24:27]
    ds_read_b128 v[148:151], v233 offset:3136
    v_mfma_f32_16x16x32_bf16 v[24:27], v[52:55], v[116:119], v[24:27]
    ds_read_b64 v[84:85], v232 offset:576
    v_mfma_f32_16x16x32_bf16 v[24:27], v[56:59], v[112:115], v[24:27]
    ds_read_b64 v[86:87], v232 offset:584
    v_mfma_f32_16x16x32_bf16 v[28:31], v[48:51], v[124:127], v[28:31]
    ds_read_b128 v[152:155], v233 offset:2624
    v_mfma_f32_16x16x32_bf16 v[28:31], v[52:55], v[120:123], v[28:31]
    ds_read_b64 v[88:89], v232 offset:1088
    v_mfma_f32_16x16x32_bf16 v[28:31], v[56:59], v[116:119], v[28:31]
    ds_read_b64 v[90:91], v232 offset:1096
    v_mfma_f32_16x16x32_bf16 v[28:31], v[60:63], v[112:115], v[28:31]
    ds_read_b128 v[156:159], v233 offset:2112
    v_mfma_f32_16x16x32_bf16 v[32:35], v[48:51], v[128:131], v[32:35]
    ds_read_b64 v[92:93], v232 offset:1600
    v_mfma_f32_16x16x32_bf16 v[32:35], v[52:55], v[124:127], v[32:35]
    ds_read_b64 v[94:95], v232 offset:1608
    v_mfma_f32_16x16x32_bf16 v[32:35], v[56:59], v[120:123], v[32:35]
    ds_read_b128 v[160:163], v233 offset:1600
    v_mfma_f32_16x16x32_bf16 v[32:35], v[60:63], v[116:119], v[32:35]
    ds_read_b64 v[96:97], v232 offset:2112
    v_mfma_f32_16x16x32_bf16 v[32:35], v[64:67], v[112:115], v[32:35]
    ds_read_b64 v[98:99], v232 offset:2120
    v_mfma_f32_16x16x32_bf16 v[36:39], v[48:51], v[132:135], v[36:39]
    ds_read_b128 v[164:167], v233 offset:1088
    v_mfma_f32_16x16x32_bf16 v[36:39], v[52:55], v[128:131], v[36:39]
    ds_read_b64 v[100:101], v232 offset:2624
    v_mfma_f32_16x16x32_bf16 v[36:39], v[56:59], v[124:127], v[36:39]
    ds_read_b64 v[102:103], v232 offset:2632
    v_mfma_f32_16x16x32_bf16 v[36:39], v[60:63], v[120:123], v[36:39]
    ds_read_b128 v[168:171], v233 offset:576
    v_mfma_f32_16x16x32_bf16 v[36:39], v[64:67], v[116:119], v[36:39]
    ds_read_b64 v[104:105], v232 offset:3136
    v_mfma_f32_16x16x32_bf16 v[36:39], v[68:71], v[112:115], v[36:39]
    ds_read_b64 v[106:107], v232 offset:3144
    v_mfma_f32_16x16x32_bf16 v[40:43], v[48:51], v[136:139], v[40:43]
    ds_read_b128 v[172:175], v233 offset:64
    v_mfma_f32_16x16x32_bf16 v[40:43], v[52:55], v[132:135], v[40:43]
    ds_read_b64 v[108:109], v232 offset:3648
    v_mfma_f32_16x16x32_bf16 v[40:43], v[56:59], v[128:131], v[40:43]
    ds_read_b64 v[110:111], v232 offset:3656
    v_mfma_f32_16x16x32_bf16 v[40:43], v[60:63], v[124:127], v[40:43]
    v_mfma_f32_16x16x32_bf16 v[40:43], v[64:67], v[120:123], v[40:43]
    v_mfma_f32_16x16x32_bf16 v[40:43], v[68:71], v[116:119], v[40:43]
    v_mfma_f32_16x16x32_bf16 v[40:43], v[72:75], v[112:115], v[40:43]
    v_mfma_f32_16x16x32_bf16 v[44:47], v[48:51], v[140:143], v[44:47]
    v_mfma_f32_16x16x32_bf16 v[44:47], v[52:55], v[136:139], v[44:47]
    v_mfma_f32_16x16x32_bf16 v[44:47], v[56:59], v[132:135], v[44:47]
    v_mfma_f32_16x16x32_bf16 v[44:47], v[60:63], v[128:131], v[44:47]
    v_mfma_f32_16x16x32_bf16 v[44:47], v[64:67], v[124:127], v[44:47]
    v_mfma_f32_16x16x32_bf16 v[44:47], v[68:71], v[120:123], v[44:47]
    v_mfma_f32_16x16x32_bf16 v[44:47], v[72:75], v[116:119], v[44:47]
    v_mfma_f32_16x16x32_bf16 v[44:47], v[76:79], v[112:115], v[44:47]
    s_waitcnt lgkmcnt(0)
    v_mfma_f32_16x16x32_bf16 v[16:19], v[80:83], v[144:147], v[16:19]
    ds_read_b128 v[112:115], v233 offset:3712
    v_mfma_f32_16x16x32_bf16 v[20:23], v[80:83], v[148:151], v[20:23]
    ds_read_b64 v[48:49], v232 offset:128
    v_mfma_f32_16x16x32_bf16 v[20:23], v[84:87], v[144:147], v[20:23]
    ds_read_b64 v[50:51], v232 offset:136
    v_mfma_f32_16x16x32_bf16 v[24:27], v[80:83], v[152:155], v[24:27]
    ds_read_b128 v[116:119], v233 offset:3200
    v_mfma_f32_16x16x32_bf16 v[24:27], v[84:87], v[148:151], v[24:27]
    ds_read_b64 v[52:53], v232 offset:640
    v_mfma_f32_16x16x32_bf16 v[24:27], v[88:91], v[144:147], v[24:27]
    ds_read_b64 v[54:55], v232 offset:648
    v_mfma_f32_16x16x32_bf16 v[28:31], v[80:83], v[156:159], v[28:31]
    ds_read_b128 v[120:123], v233 offset:2688
    v_mfma_f32_16x16x32_bf16 v[28:31], v[84:87], v[152:155], v[28:31]
    ds_read_b64 v[56:57], v232 offset:1152
    v_mfma_f32_16x16x32_bf16 v[28:31], v[88:91], v[148:151], v[28:31]
    ds_read_b64 v[58:59], v232 offset:1160
    v_mfma_f32_16x16x32_bf16 v[28:31], v[92:95], v[144:147], v[28:31]
    ds_read_b128 v[124:127], v233 offset:2176
    v_mfma_f32_16x16x32_bf16 v[32:35], v[80:83], v[160:163], v[32:35]
    ds_read_b64 v[60:61], v232 offset:1664
    v_mfma_f32_16x16x32_bf16 v[32:35], v[84:87], v[156:159], v[32:35]
    ds_read_b64 v[62:63], v232 offset:1672
    v_mfma_f32_16x16x32_bf16 v[32:35], v[88:91], v[152:155], v[32:35]
    ds_read_b128 v[128:131], v233 offset:1664
    v_mfma_f32_16x16x32_bf16 v[32:35], v[92:95], v[148:151], v[32:35]
    ds_read_b64 v[64:65], v232 offset:2176
    v_mfma_f32_16x16x32_bf16 v[32:35], v[96:99], v[144:147], v[32:35]
    ds_read_b64 v[66:67], v232 offset:2184
    v_mfma_f32_16x16x32_bf16 v[36:39], v[80:83], v[164:167], v[36:39]
    ds_read_b128 v[132:135], v233 offset:1152
    v_mfma_f32_16x16x32_bf16 v[36:39], v[84:87], v[160:163], v[36:39]
    ds_read_b64 v[68:69], v232 offset:2688
    v_mfma_f32_16x16x32_bf16 v[36:39], v[88:91], v[156:159], v[36:39]
    ds_read_b64 v[70:71], v232 offset:2696
    v_mfma_f32_16x16x32_bf16 v[36:39], v[92:95], v[152:155], v[36:39]
    ds_read_b128 v[136:139], v233 offset:640
    v_mfma_f32_16x16x32_bf16 v[36:39], v[96:99], v[148:151], v[36:39]
    ds_read_b64 v[72:73], v232 offset:3200
    v_mfma_f32_16x16x32_bf16 v[36:39], v[100:103], v[144:147], v[36:39]
    ds_read_b64 v[74:75], v232 offset:3208
    v_mfma_f32_16x16x32_bf16 v[40:43], v[80:83], v[168:171], v[40:43]
    ds_read_b128 v[140:143], v233 offset:128
    v_mfma_f32_16x16x32_bf16 v[40:43], v[84:87], v[164:167], v[40:43]
    ds_read_b64 v[76:77], v232 offset:3712
    v_mfma_f32_16x16x32_bf16 v[40:43], v[88:91], v[160:163], v[40:43]
    ds_read_b64 v[78:79], v232 offset:3720
    v_mfma_f32_16x16x32_bf16 v[40:43], v[92:95], v[156:159], v[40:43]
    v_add_u32 v232, 128, v232
    v_mfma_f32_16x16x32_bf16 v[40:43], v[96:99], v[152:155], v[40:43]
    v_add_u32 v233, 128, v233
    v_mfma_f32_16x16x32_bf16 v[40:43], v[100:103], v[148:151], v[40:43]
    s_sub_u32 s74, s74, 1
    v_mfma_f32_16x16x32_bf16 v[40:43], v[104:107], v[144:147], v[40:43]
    s_cmp_lg_u32 s74, 0
    v_mfma_f32_16x16x32_bf16 v[44:47], v[80:83], v[172:175], v[44:47]
    v_mfma_f32_16x16x32_bf16 v[44:47], v[84:87], v[168:171], v[44:47]
    v_mfma_f32_16x16x32_bf16 v[44:47], v[88:91], v[164:167], v[44:47]
    v_mfma_f32_16x16x32_bf16 v[44:47], v[92:95], v[160:163], v[44:47]
    v_mfma_f32_16x16x32_bf16 v[44:47], v[96:99], v[156:159], v[44:47]
    v_mfma_f32_16x16x32_bf16 v[44:47], v[100:103], v[152:155], v[44:47]
    v_mfma_f32_16x16x32_bf16 v[44:47], v[104:107], v[148:151], v[44:47]
    v_mfma_f32_16x16x32_bf16 v[44:47], v[108:111], v[144:147], v[44:47]
    s_waitcnt lgkmcnt(0)
    s_cbranch_scc1 L_conv
    v_mfma_f32_16x16x32_bf16 v[16:19], v[48:51], v[112:115], v[16:19]
    ds_read_b128 v[144:147], v233 offset:3648
    v_mfma_f32_16x16x32_bf16 v[20:23], v[48:51], v[116:119], v[20:23]
    ds_read_b64 v[80:81], v232 offset:64
    v_mfma_f32_16x16x32_bf16 v[20:23], v[52:55], v[112:115], v[20:23]
    ds_read_b64 v[82:83], v232 offset:72
    v_mfma_f32_16x16x32_bf16 v[24:27], v[48:51], v[120:123], v[24:27]
    ds_read_b128 v[148:151], v233 offset:3136
    v_mfma_f32_16x16x32_bf16 v[24:27], v[52:55], v[116:119], v[24:27]
    ds_read_b64 v[84:85], v232 offset:576
    v_mfma_f32_16x16x32_bf16 v[24:27], v[56:59], v[112:115], v[24:27]
    ds_read_b64 v[86:87], v232 offset:584
    v_mfma_f32_16x16x32_bf16 v[28:31], v[48:51], v[124:127], v[28:31]
    ds_read_b128 v[152:155], v233 offset:2624
    v_mfma_f32_16x16x32_bf16 v[28:31], v[52:55], v[120:123], v[28:31]
    ds_read_b64 v[88:89], v232 offset:1088
    v_mfma_f32_16x16x32_bf16 v[28:31], v[56:59], v[116:119], v[28:31]
    ds_read_b64 v[90:91], v232 offset:1096
    v_mfma_f32_16x16x32_bf16 v[28:31], v[60:63], v[112:115], v[28:31]
    ds_read_b128 v[156:159], v233 offset:2112
    v_mfma_f32_16x16x32_bf16 v[32:35], v[48:51], v[128:131], v[32:35]
    ds_read_b64 v[92:93], v232 offset:1600
    v_mfma_f32_16x16x32_bf16 v[32:35], v[52:55], v[124:127], v[32:35]
    ds_read_b64 v[94:95], v232 offset:1608
    v_mfma_f32_16x16x32_bf16 v[32:35], v[56:59], v[120:123], v[32:35]
    ds_read_b128 v[160:163], v233 offset:1600
    v_mfma_f32_16x16x32_bf16 v[32:35], v[60:63], v[116:119], v[32:35]
    ds_read_b64 v[96:97], v232 offset:2112
    v_mfma_f32_16x16x32_bf16 v[32:35], v[64:67], v[112:115], v[32:35]
    ds_read_b64 v[98:99], v232 offset:2120
    v_mfma_f32_16x16x32_bf16 v[36:39], v[48:51], v[132:135], v[36:39]
    ds_read_b128 v[164:167], v233 offset:1088
    v_mfma_f32_16x16x32_bf16 v[36:39], v[52:55], v[128:131], v[36:39]
    ds_read_b64 v[100:101], v232 offset:2624
    v_mfma_f32_16x16x32_bf16 v[36:39], v[56:59], v[124:127], v[36:39]
    ds_read_b64 v[102:103], v232 offset:2632
    v_mfma_f32_16x16x32_bf16 v[36:39], v[60:63], v[120:123], v[36:39]
    ds_read_b128 v[168:171], v233 offset:576
    v_mfma_f32_16x16x32_bf16 v[36:39], v[64:67], v[116:119], v[36:39]
    ds_read_b64 v[104:105], v232 offset:3136
    v_mfma_f32_16x16x32_bf16 v[36:39], v[68:71], v[112:115], v[36:39]
    ds_read_b64 v[106:107], v232 offset:3144
    v_mfma_f32_16x16x32_bf16 v[40:43], v[48:51], v[136:139], v[40:43]
    ds_read_b128 v[172:175], v233 offset:64
    v_mfma_f32_16x16x32_bf16 v[40:43], v[52:55], v[132:135], v[40:43]
    ds_read_b64 v[108:109], v232 offset:3648
    v_mfma_f32_16x16x32_bf16 v[40:43], v[56:59], v[128:131], v[40:43]
    ds_read_b64 v[110:111], v232 offset:3656
    v_mfma_f32_16x16x32_bf16 v[40:43], v[60:63], v[124:127], v[40:43]
    s_mul_i32 s74, s68, 4224
    v_mfma_f32_16x16x32_bf16 v[40:43], v[64:67], v[120:123], v[40:43]
    s_and_b32 s75, s71, 63
    v_mfma_f32_16x16x32_bf16 v[40:43], v[68:71], v[116:119], v[40:43]
    s_add_u32 s74, s74, s75
    v_mfma_f32_16x16x32_bf16 v[40:43], v[72:75], v[112:115], v[40:43]
    s_lshl_b32 s74, s74, 6
    v_mfma_f32_16x16x32_bf16 v[44:47], v[48:51], v[140:143], v[44:47]
    v_and_b32 v234, 3, v0
    v_mfma_f32_16x16x32_bf16 v[44:47], v[52:55], v[136:139], v[44:47]
    v_lshl_add_u32 v234, v234, 4, s74
    v_mfma_f32_16x16x32_bf16 v[44:47], v[56:59], v[132:135], v[44:47]
    v_and_b32 v235, 12, v0
    v_mfma_f32_16x16x32_bf16 v[44:47], v[60:63], v[128:131], v[44:47]
    v_lshrrev_b32 v236, 4, v0
    v_mfma_f32_16x16x32_bf16 v[44:47], v[64:67], v[124:127], v[44:47]
    v_add_u32 v235, v235, v236
    v_mfma_f32_16x16x32_bf16 v[44:47], v[68:71], v[120:123], v[44:47]
    v_mul_u32_u24 v235, 4224, v235
    v_mfma_f32_16x16x32_bf16 v[44:47], v[72:75], v[116:119], v[44:47]
    v_add_u32 v234, v234, v235
    v_mfma_f32_16x16x32_bf16 v[44:47], v[76:79], v[112:115], v[44:47]
    s_waitcnt lgkmcnt(0)
    v_mfma_f32_16x16x32_bf16 v[16:19], v[80:83], v[144:147], v[16:19]
    s_bfe_u32 s86, s2, 0x10002
    s_lshr_b32 s74, s2, 5
    v_mfma_f32_16x16x32_bf16 v[20:23], v[80:83], v[148:151], v[20:23]
    s_lshl3_add_u32 s86, s86, s74
    v_lshrrev_b32 v236, 4, v0
    v_mfma_f32_16x16x32_bf16 v[20:23], v[84:87], v[144:147], v[20:23]
    v_lshlrev_b32 v236, 1, v236
    v_xor_b32 v236, v0, v236
    v_mfma_f32_16x16x32_bf16 v[24:27], v[80:83], v[152:155], v[24:27]
    v_and_b32 v236, 7, v236
    s_lshl_b32 s74, s86, 7
    v_cvt_pk_bf16_f32 v48, v16, v17
    v_cvt_pk_bf16_f32 v49, v18, v19
    v_mfma_f32_16x16x32_bf16 v[24:27], v[84:87], v[148:151], v[24:27]
    v_lshl_add_u32 v236, v236, 4, s74
    v_lshrrev_b32 v235, 3, v0
    v_cvt_pk_bf16_f32 v50, v20, v21
    v_cvt_pk_bf16_f32 v51, v22, v23
    v_mfma_f32_16x16x32_bf16 v[24:27], v[88:91], v[144:147], v[24:27]
    v_lshl_add_u32 v235, v235, 11, v236
    s_mov_b32 s56, s24
    s_mov_b32 s76, 0
    buffer_store_dwordx4 v[48:51], v234, s[64:67], s76 offen sc1
    v_mfma_f32_16x16x32_bf16 v[28:31], v[80:83], v[156:159], v[28:31]
    s_mov_b32 s57, s25
    s_mov_b32 s58, 0x200000
    v_mfma_f32_16x16x32_bf16 v[28:31], v[84:87], v[152:155], v[28:31]
    s_mov_b32 s59, 0x20000
    s_mul_i32 s74, s86, 4
    v_cvt_pk_bf16_f32 v52, v24, v25
    v_cvt_pk_bf16_f32 v53, v26, v27
    v_mfma_f32_16x16x32_bf16 v[28:31], v[88:91], v[148:151], v[28:31]
    s_and_b32 s74, s74, 7
    s_lshl1_add_u32 s82, s74, s70
    v_mfma_f32_16x16x32_bf16 v[28:31], v[92:95], v[144:147], v[28:31]
    s_lshl_b32 s82, s82, 17
    s_lshl4_add_u32 s73, s68, 512
    v_mfma_f32_16x16x32_bf16 v[32:35], v[80:83], v[160:163], v[32:35]
    s_add_u32 s45, s73, s69
    s_lshl_b32 s73, s73, 8
    v_mfma_f32_16x16x32_bf16 v[32:35], v[84:87], v[156:159], v[32:35]
    s_lshl_b32 s45, s45, 8
    v_mfma_f32_16x16x32_bf16 v[32:35], v[88:91], v[152:155], v[32:35]
    v_mfma_f32_16x16x32_bf16 v[32:35], v[92:95], v[148:151], v[32:35]
    v_mfma_f32_16x16x32_bf16 v[32:35], v[96:99], v[144:147], v[32:35]
    v_cvt_pk_bf16_f32 v54, v28, v29
    v_cvt_pk_bf16_f32 v55, v30, v31
    v_mfma_f32_16x16x32_bf16 v[36:39], v[80:83], v[164:167], v[36:39]
    s_mov_b32 s76, 67584
    buffer_store_dwordx4 v[52:55], v234, s[64:67], s76 offen sc1
    v_mfma_f32_16x16x32_bf16 v[36:39], v[84:87], v[160:163], v[36:39]
    v_mfma_f32_16x16x32_bf16 v[36:39], v[88:91], v[156:159], v[36:39]
    v_mfma_f32_16x16x32_bf16 v[36:39], v[92:95], v[152:155], v[36:39]
    v_cvt_pk_bf16_f32 v56, v32, v33
    v_cvt_pk_bf16_f32 v57, v34, v35
    v_mfma_f32_16x16x32_bf16 v[36:39], v[96:99], v[148:151], v[36:39]
    v_mfma_f32_16x16x32_bf16 v[36:39], v[100:103], v[144:147], v[36:39]
    v_mfma_f32_16x16x32_bf16 v[40:43], v[80:83], v[168:171], v[40:43]
    v_mfma_f32_16x16x32_bf16 v[40:43], v[84:87], v[164:167], v[40:43]
    v_mfma_f32_16x16x32_bf16 v[40:43], v[88:91], v[160:163], v[40:43]
    v_mfma_f32_16x16x32_bf16 v[40:43], v[92:95], v[156:159], v[40:43]
    v_mfma_f32_16x16x32_bf16 v[40:43], v[96:99], v[152:155], v[40:43]
    v_mfma_f32_16x16x32_bf16 v[40:43], v[100:103], v[148:151], v[40:43]
    v_mfma_f32_16x16x32_bf16 v[40:43], v[104:107], v[144:147], v[40:43]
    v_mfma_f32_16x16x32_bf16 v[44:47], v[80:83], v[172:175], v[44:47]
    v_cvt_pk_bf16_f32 v58, v36, v37
    v_cvt_pk_bf16_f32 v59, v38, v39
    v_mfma_f32_16x16x32_bf16 v[44:47], v[84:87], v[168:171], v[44:47]
    s_mov_b32 s76, 135168
    buffer_store_dwordx4 v[56:59], v234, s[64:67], s76 offen sc1
    v_mfma_f32_16x16x32_bf16 v[44:47], v[88:91], v[164:167], v[44:47]
    v_mfma_f32_16x16x32_bf16 v[44:47], v[92:95], v[160:163], v[44:47]
    v_cvt_pk_bf16_f32 v60, v40, v41
    v_cvt_pk_bf16_f32 v61, v42, v43
    v_mfma_f32_16x16x32_bf16 v[44:47], v[96:99], v[156:159], v[44:47]
    v_mfma_f32_16x16x32_bf16 v[44:47], v[100:103], v[152:155], v[44:47]
    v_mfma_f32_16x16x32_bf16 v[44:47], v[104:107], v[148:151], v[44:47]
    v_mfma_f32_16x16x32_bf16 v[44:47], v[108:111], v[144:147], v[44:47]
    s_nop 7
    v_cvt_pk_bf16_f32 v62, v44, v45
    v_cvt_pk_bf16_f32 v63, v46, v47
    s_mov_b32 s76, 202752
    buffer_store_dwordx4 v[60:63], v234, s[64:67], s76 offen sc1
    s_setprio 1
    s_add_u32 m0, s80, 0
    s_add_u32 s83, s82, 1310720
    s_and_b32 s83, s83, 0x1fffff
    buffer_load_dwordx4 v235, s[56:59], s83 offen lds
    s_add_u32 m0, s80, 1024
    s_add_u32 s83, s82, 1327104
    s_and_b32 s83, s83, 0x1fffff
    buffer_load_dwordx4 v235, s[56:59], s83 offen lds
    s_add_u32 m0, s80, 2048
    s_add_u32 s83, s82, 1343488
    s_and_b32 s83, s83, 0x1fffff
    buffer_load_dwordx4 v235, s[56:59], s83 offen lds
    s_add_u32 m0, s80, 3072
    s_add_u32 s83, s82, 1359872
    s_and_b32 s83, s83, 0x1fffff
    buffer_load_dwordx4 v235, s[56:59], s83 offen lds
    s_add_u32 m0, s80, 4096
    s_add_u32 s83, s82, 1376256
    s_and_b32 s83, s83, 0x1fffff
    buffer_load_dwordx4 v235, s[56:59], s83 offen lds
    s_add_u32 m0, s80, 5120
    s_add_u32 s83, s82, 1392640
    s_and_b32 s83, s83, 0x1fffff
    buffer_load_dwordx4 v235, s[56:59], s83 offen lds
    s_add_u32 m0, s80, 6144
    s_add_u32 s83, s82, 1409024
    s_and_b32 s83, s83, 0x1fffff
    buffer_load_dwordx4 v235, s[56:59], s83 offen lds
    s_add_u32 m0, s80, 7168
    s_add_u32 s83, s82, 1425408
    s_and_b32 s83, s83, 0x1fffff
    buffer_load_dwordx4 v235, s[56:59], s83 offen lds
    s_waitcnt vmcnt(8)
    v_mov_b32 v238, 1
    s_mov_b64 exec, 1
    ds_add_rtn_u32 v237, v227, v238 offset:8
    s_waitcnt lgkmcnt(0)
    v_readfirstlane_b32 s76, v237
    s_nop 0
    s_cmp_eq_u32 s76, 3
    s_cbranch_scc0 L_jo_30a
    s_mov_b64 exec, 0xffff
    v_lshlrev_b32 v237, 8, v0
    buffer_atomic_add v238, v237, s[52:55], s73 offen sc1
L_jo_30a:
    s_mov_b64 exec, -1
    s_cmp_ge_u32 s70, 2
    s_cbranch_scc1 L_nowo3
    s_add_u32 m0, s81, 0
    s_add_u32 s83, s82, 1835008
    s_and_b32 s83, s83, 0x1fffff
    buffer_load_dwordx4 v235, s[56:59], s83 offen lds
    s_add_u32 m0, s81, 1024
    s_add_u32 s83, s82, 1851392
    s_and_b32 s83, s83, 0x1fffff
    buffer_load_dwordx4 v235, s[56:59], s83 offen lds
    s_add_u32 m0, s81, 2048
    s_add_u32 s83, s82, 1867776
    s_and_b32 s83, s83, 0x1fffff
    buffer_load_dwordx4 v235, s[56:59], s83 offen lds
    s_add_u32 m0, s81, 3072
    s_add_u32 s83, s82, 1884160
    s_and_b32 s83, s83, 0x1fffff
    buffer_load_dwordx4 v235, s[56:59], s83 offen lds
    s_add_u32 m0, s81, 4096
    s_add_u32 s83, s82, 1900544
    s_and_b32 s83, s83, 0x1fffff
    buffer_load_dwordx4 v235, s[56:59], s83 offen lds
    s_add_u32 m0, s81, 5120
    s_add_u32 s83, s82, 1916928
    s_and_b32 s83, s83, 0x1fffff
    buffer_load_dwordx4 v235, s[56:59], s83 offen lds
    s_add_u32 m0, s81, 6144
    s_add_u32 s83, s82, 1933312
    s_and_b32 s83, s83, 0x1fffff
    buffer_load_dwordx4 v235, s[56:59], s83 offen lds
    s_add_u32 m0, s81, 7168
    s_add_u32 s83, s82, 1949696
    s_and_b32 s83, s83, 0x1fffff
    buffer_load_dwordx4 v235, s[56:59], s83 offen lds
L_nowo3:
    v_lshlrev_b32 v112, 16, v208
    v_and_b32 v113, 0xffff0000, v208
    v_lshlrev_b32 v114, 16, v209
    v_and_b32 v115, 0xffff0000, v209
    v_lshlrev_b32 v116, 16, v210
    v_and_b32 v117, 0xffff0000, v210
    v_lshlrev_b32 v118, 16, v211
    v_and_b32 v119, 0xffff0000, v211
    v_lshlrev_b32 v120, 16, v212
    v_and_b32 v121, 0xffff0000, v212
    v_lshlrev_b32 v122, 16, v213
    v_and_b32 v123, 0xffff0000, v213
    v_lshlrev_b32 v124, 16, v214
    v_and_b32 v125, 0xffff0000, v214
    v_lshlrev_b32 v126, 16, v215
    v_and_b32 v127, 0xffff0000, v215
    v_lshlrev_b32 v128, 16, v216
    v_and_b32 v129, 0xffff0000, v216
    v_lshlrev_b32 v130, 16, v217
    v_and_b32 v131, 0xffff0000, v217
    v_lshlrev_b32 v132, 16, v218
    v_and_b32 v133, 0xffff0000, v218
    v_lshlrev_b32 v134, 16, v219
    v_and_b32 v135, 0xffff0000, v219
    v_lshlrev_b32 v136, 16, v220
    v_and_b32 v137, 0xffff0000, v220
    v_lshlrev_b32 v138, 16, v221
    v_and_b32 v139, 0xffff0000, v221
    v_lshlrev_b32 v140, 16, v222
    v_and_b32 v141, 0xffff0000, v222
    v_lshlrev_b32 v142, 16, v223
    v_and_b32 v143, 0xffff0000, v223
    s_mul_i32 s77, s70, 4352
    s_add_u32 s77, s77, 60416
    v_lshrrev_b32 v234, 5, v0
    v_lshl_add_u32 v234, v234, 1, v0
    v_lshl_add_u32 v234, v234, 4, s77
    v_and_b32 v235, 7, v0
    v_mul_u32_u24 v235, 544, v235
    v_lshrrev_b32 v236, 3, v0
    v_lshl_add_u32 v235, v236, 3, v235
    v_add_u32 v235, s77, v235
    s_mul_i32 s77, s71, 4224
    s_mov_b32 s60, s26
    s_mov_b32 s61, s27
    s_mov_b32 s62, 0x800000
    s_mov_b32 s63, 0x20000
    s_waitcnt vmcnt(0)
    s_mov_b64 exec, 1
    ds_add_u32 v227, v244 offset:12
    s_mov_b64 exec, -1
    s_cmp_eq_u32 s76, 3
    s_cbranch_scc0 L_jo_30
    s_mov_b32 s75, 131072
L_sg_loop_33:
    s_load_dword s74, s[52:53], s45 glc
L_sg_chk_34:
    s_waitcnt lgkmcnt(0)
    s_cmp_ge_u32 s74, 16
    s_cbranch_scc1 L_sg_done_32
    s_sub_u32 s75, s75, 1
    s_cbranch_scc0 L_sg_loop_33
L_sg_done_32:
    v_mov_b32 v237, 16
    s_mov_b64 exec, 1
    ds_add_u32 v227, v237 offset:16
    s_mov_b64 exec, -1
    s_branch L_jd_31
L_jo_30:
    s_mov_b32 s75, 1048576
L_sl_loop_36:
    ds_read_b32 v237, v227 offset:16
    s_waitcnt lgkmcnt(0)
    v_readfirstlane_b32 s74, v237
    s_nop 0
    s_cmp_ge_u32 s74, 16
    s_cbranch_scc1 L_sl_done_35
    s_sleep 1
    s_sub_u32 s75, s75, 1
    s_cbranch_scc0 L_sl_loop_36
L_sl_done_35:
L_jd_31:
    buffer_load_dwordx4 v[48:51], v224, s[64:67], s77 offen offset:0 sc1
    buffer_load_dwordx4 v[52:55], v224, s[64:67], s77 offen offset:1024 sc1
    buffer_load_dwordx4 v[56:59], v224, s[64:67], s77 offen offset:2048 sc1
    buffer_load_dwordx4 v[60:63], v224, s[64:67], s77 offen offset:3072 sc1
    s_waitcnt vmcnt(3)
    ds_write_b128 v234, v[48:51] offset:0
    s_waitcnt vmcnt(2)
    ds_write_b128 v234, v[52:55] offset:1088
    s_waitcnt vmcnt(1)
    ds_write_b128 v234, v[56:59] offset:2176
    s_waitcnt vmcnt(0)
    ds_write_b128 v234, v[60:63] offset:3264
    ds_read_b64 v[64:65], v235 offset:0
    ds_read_b64 v[66:67], v235 offset:64
    ds_read_b64 v[68:69], v235 offset:128
    ds_read_b64 v[70:71], v235 offset:192
    ds_read_b64 v[72:73], v235 offset:256
    ds_read_b64 v[74:75], v235 offset:320
    ds_read_b64 v[76:77], v235 offset:384
    ds_read_b64 v[78:79], v235 offset:448
    s_waitcnt lgkmcnt(7)
    v_lshlrev_b32 v16, 16, v64
    v_and_b32 v24, 0xffff0000, v64
    v_lshlrev_b32 v32, 16, v65
    v_and_b32 v40, 0xffff0000, v65
    s_waitcnt lgkmcnt(6)
    v_lshlrev_b32 v17, 16, v66
    v_and_b32 v25, 0xffff0000, v66
    v_lshlrev_b32 v33, 16, v67
    v_and_b32 v41, 0xffff0000, v67
    s_waitcnt lgkmcnt(5)
    v_lshlrev_b32 v18, 16, v68
    v_and_b32 v26, 0xffff0000, v68
    v_lshlrev_b32 v34, 16, v69
    v_and_b32 v42, 0xffff0000, v69
    s_waitcnt lgkmcnt(4)
    v_lshlrev_b32 v19, 16, v70
    v_and_b32 v27, 0xffff0000, v70
    v_lshlrev_b32 v35, 16, v71
    v_and_b32 v43, 0xffff0000, v71
    s_waitcnt lgkmcnt(3)
    v_lshlrev_b32 v20, 16, v72
    v_and_b32 v28, 0xffff0000, v72
    v_lshlrev_b32 v36, 16, v73
    v_and_b32 v44, 0xffff0000, v73
    s_waitcnt lgkmcnt(2)
    v_lshlrev_b32 v21, 16, v74
    v_and_b32 v29, 0xffff0000, v74
    v_lshlrev_b32 v37, 16, v75
    v_and_b32 v45, 0xffff0000, v75
    s_waitcnt lgkmcnt(1)
    v_lshlrev_b32 v22, 16, v76
    v_and_b32 v30, 0xffff0000, v76
    v_lshlrev_b32 v38, 16, v77
    v_and_b32 v46, 0xffff0000, v77
    s_waitcnt lgkmcnt(0)
    v_lshlrev_b32 v23, 16, v78
    v_and_b32 v31, 0xffff0000, v78
    v_lshlrev_b32 v39, 16, v79
    v_and_b32 v47, 0xffff0000, v79
    v_mul_f32 v16, v16, v112
    v_mul_f32 v17, v17, v113
    v_mul_f32 v18, v18, v114
    v_mul_f32 v19, v19, v115
    v_mul_f32 v20, v20, v116
    v_mul_f32 v21, v21, v117
    v_mul_f32 v22, v22, v118
    v_mul_f32 v23, v23, v119
    v_cvt_pk_bf16_f32 v48, v16, v17
    v_cvt_pk_bf16_f32 v49, v18, v19
    v_cvt_pk_bf16_f32 v50, v20, v21
    v_cvt_pk_bf16_f32 v51, v22, v23
    s_mov_b32 s74, 0
    buffer_store_dwordx4 v[48:51], v226, s[60:63], s74 offen nt
    v_mul_f32 v24, v24, v120
    v_mul_f32 v25, v25, v121
    v_mul_f32 v26, v26, v122
    v_mul_f32 v27, v27, v123
    v_mul_f32 v28, v28, v124
    v_mul_f32 v29, v29, v125
    v_mul_f32 v30, v30, v126
    v_mul_f32 v31, v31, v127
    v_cvt_pk_bf16_f32 v52, v24, v25
    v_cvt_pk_bf16_f32 v53, v26, v27
    v_cvt_pk_bf16_f32 v54, v28, v29
    v_cvt_pk_bf16_f32 v55, v30, v31
    s_mov_b32 s74, 4096
    buffer_store_dwordx4 v[52:55], v226, s[60:63], s74 offen nt
    v_mul_f32 v32, v32, v128
    v_mul_f32 v33, v33, v129
    v_mul_f32 v34, v34, v130
    v_mul_f32 v35, v35, v131
    v_mul_f32 v36, v36, v132
    v_mul_f32 v37, v37, v133
    v_mul_f32 v38, v38, v134
    v_mul_f32 v39, v39, v135
    v_cvt_pk_bf16_f32 v56, v32, v33
    v_cvt_pk_bf16_f32 v57, v34, v35
    v_cvt_pk_bf16_f32 v58, v36, v37
    v_cvt_pk_bf16_f32 v59, v38, v39
    s_mov_b32 s74, 16384
    buffer_store_dwordx4 v[56:59], v226, s[60:63], s74 offen nt
    v_mul_f32 v40, v40, v136
    v_mul_f32 v41, v41, v137
    v_mul_f32 v42, v42, v138
    v_mul_f32 v43, v43, v139
    v_mul_f32 v44, v44, v140
    v_mul_f32 v45, v45, v141
    v_mul_f32 v46, v46, v142
    v_mul_f32 v47, v47, v143
    v_cvt_pk_bf16_f32 v60, v40, v41
    v_cvt_pk_bf16_f32 v61, v42, v43
    v_cvt_pk_bf16_f32 v62, v44, v45
    v_cvt_pk_bf16_f32 v63, v46, v47
    s_mov_b32 s74, 20480
    buffer_store_dwordx4 v[60:63], v226, s[60:63], s74 offen nt
    s_endpgm
L_grole:
    s_setprio 2
    s_add_u32 s52, s30, 0xe00000
    s_addc_u32 s53, s31, 0
    s_mov_b32 s54, 0x30000
    s_mov_b32 s55, 0x20000
    s_lshr_b32 s32, s3, 1
    s_and_b32 s33, s3, 1
    v_and_b32 v1, 15, v0
    v_lshrrev_b32 v2, 4, v0
    v_lshrrev_b32 v3, 1, v1
    v_xor_b32 v3, v2, v3
    v_lshlrev_b32 v3, 4, v3
    v_lshl_add_u32 v3, v1, 7, v3
    s_lshl_b32 s37, s33, 13
    v_add_u32 v196, s37, v3
    v_xor_b32 v197, 64, v196
    v_and_b32 v3, 6, v1
    v_xor_b32 v3, v2, v3
    v_lshlrev_b32 v3, 4, v3
    v_and_b32 v198, 7, v1
    v_lshl_add_u32 v3, v198, 7, v3
    v_add_u32 v198, 16384, v3
    v_xor_b32 v199, 64, v198
    v_bfe_u32 v3, v0, 2, 2
    v_lshl_add_u32 v200, v2, 3, v3
    v_lshlrev_b32 v200, 7, v200
    v_bfe_u32 v3, v0, 3, 2
    v_xor_b32 v3, s3, v3
    v_lshl_add_u32 v200, v3, 5, v200
    v_and_b32 v3, 3, v0
    v_lshl_add_u32 v200, v3, 3, v200
    v_add_u32 v200, 17408, v200
    v_xor_b32 v201, 32, v200
    v_mov_b64 v[52:53], 0
    v_mov_b64 v[54:55], 0
    v_mov_b64 v[56:57], 0
    v_mov_b64 v[58:59], 0
    v_mov_b64 v[60:61], 0
    v_mov_b64 v[62:63], 0
    v_mov_b64 v[64:65], 0
    v_mov_b64 v[66:67], 0
    v_mov_b64 v[68:69], 0
    v_mov_b64 v[70:71], 0
    v_mov_b64 v[72:73], 0
    v_mov_b64 v[74:75], 0
    v_mov_b64 v[76:77], 0
    v_mov_b64 v[78:79], 0
    v_mov_b64 v[80:81], 0
    v_mov_b64 v[82:83], 0
    v_mov_b64 v[84:85], 0
    v_mov_b64 v[86:87], 0
    v_mov_b64 v[88:89], 0
    v_mov_b64 v[90:91], 0
    v_mov_b64 v[92:93], 0
    v_mov_b64 v[94:95], 0
    v_mov_b64 v[96:97], 0
    v_mov_b64 v[98:99], 0
    v_mov_b64 v[100:101], 0
    v_mov_b64 v[102:103], 0
    v_mov_b64 v[104:105], 0
    v_mov_b64 v[106:107], 0
    s_mov_b32 s34, 0
    v_mov_b32 v228, 134352
    v_and_b32 v1, 15, v0
    v_lshrrev_b32 v2, 4, v0
    v_lshlrev_b32 v2, 2, v2
    v_sub_u32 v1, v1, v2
    s_mov_b32 s37, 0xf149f2ca
    v_mov_b32 v3, s37
    s_or_b32 s38, s5, s33
    s_cmp_eq_u32 s38, 0
    s_cselect_b32 s38, s37, 0
    v_subrev_u32 v2, 0, v1
    v_cmp_gt_u32 vcc, 8, v2
    v_cmp_gt_i32 s[64:65], -8, v2
    v_ashrrev_i32 v2, 31, v2
    v_cndmask_b32 v204, v3, 0, vcc
    v_cndmask_b32 v208, v3, 0, s[64:65]
    v_mov_b32 v216, v2
    v_min_f32 v212, s38, v208
    v_subrev_u32 v2, 1, v1
    v_cmp_gt_u32 vcc, 8, v2
    v_cmp_gt_i32 s[64:65], -8, v2
    v_ashrrev_i32 v2, 31, v2
    v_cndmask_b32 v205, v3, 0, vcc
    v_cndmask_b32 v209, v3, 0, s[64:65]
    v_alignbit_b32 v216, v2, v216, 16
    v_min_f32 v213, s38, v209
    v_subrev_u32 v2, 2, v1
    v_cmp_gt_u32 vcc, 8, v2
    v_cmp_gt_i32 s[64:65], -8, v2
    v_ashrrev_i32 v2, 31, v2
    v_cndmask_b32 v206, v3, 0, vcc
    v_cndmask_b32 v210, v3, 0, s[64:65]
    v_mov_b32 v217, v2
    v_min_f32 v214, s38, v210
    v_subrev_u32 v2, 3, v1
    v_cmp_gt_u32 vcc, 8, v2
    v_cmp_gt_i32 s[64:65], -8, v2
    v_ashrrev_i32 v2, 31, v2
    v_cndmask_b32 v207, v3, 0, vcc
    v_cndmask_b32 v211, v3, 0, s[64:65]
    v_alignbit_b32 v217, v2, v217, 16
    v_min_f32 v215, s38, v211
    s_mul_i32 s37, s32, 80896
    s_add_u32 s37, s37, 78848
    v_lshl_add_u32 v220, v0, 3, s37
    s_lshl_b32 s38, s33, 9
    v_add_u32 v219, s38, v220
    s_mul_i32 s38, s33, 2560
    v_add_u32 v221, s38, v220
    v_xor_b32 v222, 512, v221
    s_lshl3_add_u32 s37, s4, s5
    s_lshl1_add_u32 s37, s37, s33
    s_lshl_b32 s37, s37, 7
    s_lshl1_add_u32 s38, s6, s32
    s_add_u32 s37, s37, s38
    s_lshl_b32 s37, s37, 10
    v_lshl_add_u32 v218, v0, 4, s37
    s_mov_b32 s40, s30
    s_mov_b32 s41, s31
    s_mov_b32 s42, 0x400000
    s_mov_b32 s43, 0x20000
    s_and_b32 s58, s2, 3
    s_bfe_u32 s37, s2, 0x20003
    s_lshl2_add_u32 s58, s58, s37
    s_bfe_u32 s59, s2, 0x10002
    s_lshr_b32 s37, s2, 5
    s_lshl3_add_u32 s59, s59, s37
    s_mov_b32 s44, s24
    s_mov_b32 s45, s25
    s_mov_b32 s46, 0x200000
    s_mov_b32 s47, 0x20000
    s_mov_b32 s48, s26
    s_mov_b32 s49, s27
    s_mov_b32 s50, 0x800000
    s_mov_b32 s51, 0x20000
    s_lshl3_add_u32 s56, s4, s5
    s_lshl4_add_u32 s56, s56, 256
    s_lshl_b32 s56, s56, 8
    s_lshl4_add_u32 s57, s58, 256
    s_add_u32 s57, s57, s59
    s_lshl_b32 s57, s57, 8
    s_lshl2_add_u32 s37, s58, s3
    s_lshl_b32 s38, s37, 16
    v_lshl_add_u32 v224, v0, 4, s38
    v_add_u32 v225, 0x8000, v224
    s_and_b32 s37, s37, 31
    s_lshl_b32 s37, s37, 6
    s_lshr_b32 s38, s58, 3
    s_add_u32 s37, s37, s38
    s_lshl_b32 s37, s37, 5
    s_add_u32 s37, s37, s59
    s_add_u32 s37, s37, 16
    s_lshl_b32 s37, s37, 7
    v_lshrrev_b32 v1, 3, v0
    v_lshl_add_u32 v1, v1, 13, s37
    v_and_b32 v2, 7, v0
    v_lshl_add_u32 v226, v2, 4, v1
    v_lshrrev_b32 v1, 4, v0
    v_lshlrev_b32 v1, 1, v1
    v_xor_b32 v1, v0, v1
    v_and_b32 v1, 7, v1
    s_lshl_b32 s37, s59, 7
    v_lshl_add_u32 v1, v1, 4, s37
    v_lshrrev_b32 v227, 3, v0
    v_lshl_add_u32 v227, v227, 11, v1
    s_lshl_b32 s60, s3, 11
    s_mul_i32 s61, s59, 4
    s_and_b32 s61, s61, 7
    s_lshl3_add_u32 s62, s61, s3
    s_lshl_b32 s62, s62, 15
    v_lshrrev_b32 v1, 2, v0
    v_lshlrev_b32 v1, 7, v1
    v_bfe_u32 v2, v0, 3, 2
    v_lshl_add_u32 v1, v2, 5, v1
    v_and_b32 v2, 3, v0
    v_lshl_add_u32 v229, v2, 3, v1
    v_and_b32 v231, 7, v0
    v_lshl_add_u32 v230, v231, 6, s86
    v_mul_u32_u24 v231, 528, v231
    v_lshrrev_b32 v232, 3, v0
    v_xor_b32 v232, 7, v232
    v_lshl_add_u32 v231, v232, 3, v231
    v_add_u32 v231, s86, v231
    v_lshrrev_b32 v232, 5, v0
    v_add_u32 v232, v0, v232
    v_lshl_add_u32 v232, v232, 4, s86
    s_mul_i32 s87, s84, 4224
    s_sub_u32 s87, s87, s85
    s_lshl_b32 s87, s87, 6
    s_add_u32 s87, s87, 4032
    v_and_b32 v233, 3, v0
    v_lshl_add_u32 v233, v233, 4, s87
    v_lshrrev_b32 v234, 2, v0
    v_mul_u32_u24 v234, 4224, v234
    v_add_u32 v233, v233, v234
    s_add_u32 s80, s30, 0x400000
    s_addc_u32 s81, s31, 0
    s_mov_b32 s82, 0x420000
    s_mov_b32 s83, 0x20000
    s_waitcnt vmcnt(14)
    ds_read_b128 v[36:39], v230 offset:4224
    ds_read_b128 v[40:43], v230 offset:4240
    ds_read_b128 v[44:47], v230 offset:4256
    ds_read_b128 v[48:51], v230 offset:4272
    s_waitcnt lgkmcnt(3)
    v_lshlrev_b32 v152, 16, v36
    v_and_b32 v154, 0xffff0000, v36
    v_lshlrev_b32 v156, 16, v37
    v_and_b32 v158, 0xffff0000, v37
    v_lshlrev_b32 v153, 16, v38
    v_and_b32 v155, 0xffff0000, v38
    v_lshlrev_b32 v157, 16, v39
    v_and_b32 v159, 0xffff0000, v39
    s_waitcnt lgkmcnt(2)
    v_lshlrev_b32 v160, 16, v40
    v_and_b32 v162, 0xffff0000, v40
    v_lshlrev_b32 v164, 16, v41
    v_and_b32 v166, 0xffff0000, v41
    v_lshlrev_b32 v161, 16, v42
    v_and_b32 v163, 0xffff0000, v42
    v_lshlrev_b32 v165, 16, v43
    v_and_b32 v167, 0xffff0000, v43
    s_waitcnt lgkmcnt(1)
    v_lshlrev_b32 v168, 16, v44
    v_and_b32 v170, 0xffff0000, v44
    v_lshlrev_b32 v172, 16, v45
    v_and_b32 v174, 0xffff0000, v45
    v_lshlrev_b32 v169, 16, v46
    v_and_b32 v171, 0xffff0000, v46
    v_lshlrev_b32 v173, 16, v47
    v_and_b32 v175, 0xffff0000, v47
    s_waitcnt lgkmcnt(0)
    v_lshlrev_b32 v176, 16, v48
    v_and_b32 v178, 0xffff0000, v48
    v_lshlrev_b32 v180, 16, v49
    v_and_b32 v182, 0xffff0000, v49
    v_lshlrev_b32 v177, 16, v50
    v_and_b32 v179, 0xffff0000, v50
    v_lshlrev_b32 v181, 16, v51
    v_and_b32 v183, 0xffff0000, v51
    v_mov_b64 v[36:37], 0
    v_mov_b64 v[38:39], 0
    v_mov_b64 v[40:41], 0
    v_mov_b64 v[42:43], 0
    v_mov_b64 v[44:45], 0
    v_mov_b64 v[46:47], 0
    v_mov_b64 v[48:49], 0
    v_mov_b64 v[50:51], 0
    s_waitcnt vmcnt(13)
    v_lshlrev_b32 v184, 16, v108
    v_and_b32 v185, 0xffff0000, v108
    v_lshlrev_b32 v186, 16, v109
    v_and_b32 v187, 0xffff0000, v109
    v_lshlrev_b32 v188, 16, v110
    v_and_b32 v189, 0xffff0000, v110
    v_lshlrev_b32 v190, 16, v111
    v_and_b32 v191, 0xffff0000, v111
    v_pk_mul_f32 v[4:5], v[184:185], v[158:159]
    v_pk_mul_f32 v[12:13], v[186:187], v[166:167]
    v_pk_mul_f32 v[20:21], v[188:189], v[174:175]
    v_pk_mul_f32 v[28:29], v[190:191], v[182:183]
    s_waitcnt vmcnt(12)
    v_lshlrev_b32 v184, 16, v112
    v_and_b32 v185, 0xffff0000, v112
    v_lshlrev_b32 v186, 16, v113
    v_and_b32 v187, 0xffff0000, v113
    v_lshlrev_b32 v188, 16, v114
    v_and_b32 v189, 0xffff0000, v114
    v_lshlrev_b32 v190, 16, v115
    v_and_b32 v191, 0xffff0000, v115
    v_pk_fma_f32 v[4:5], v[184:185], v[156:157], v[4:5]
    v_pk_fma_f32 v[12:13], v[186:187], v[164:165], v[12:13]
    v_pk_fma_f32 v[20:21], v[188:189], v[172:173], v[20:21]
    v_pk_fma_f32 v[28:29], v[190:191], v[180:181], v[28:29]
    v_pk_mul_f32 v[6:7], v[184:185], v[158:159]
    v_pk_mul_f32 v[14:15], v[186:187], v[166:167]
    v_pk_mul_f32 v[22:23], v[188:189], v[174:175]
    v_pk_mul_f32 v[30:31], v[190:191], v[182:183]
    s_waitcnt vmcnt(11)
    v_lshlrev_b32 v184, 16, v116
    v_and_b32 v185, 0xffff0000, v116
    v_lshlrev_b32 v186, 16, v117
    v_and_b32 v187, 0xffff0000, v117
    v_lshlrev_b32 v188, 16, v118
    v_and_b32 v189, 0xffff0000, v118
    v_lshlrev_b32 v190, 16, v119
    v_and_b32 v191, 0xffff0000, v119
    v_pk_fma_f32 v[4:5], v[184:185], v[154:155], v[4:5]
    v_pk_fma_f32 v[12:13], v[186:187], v[162:163], v[12:13]
    v_pk_fma_f32 v[20:21], v[188:189], v[170:171], v[20:21]
    v_pk_fma_f32 v[28:29], v[190:191], v[178:179], v[28:29]
    v_pk_fma_f32 v[6:7], v[184:185], v[156:157], v[6:7]
    v_pk_fma_f32 v[14:15], v[186:187], v[164:165], v[14:15]
    v_pk_fma_f32 v[22:23], v[188:189], v[172:173], v[22:23]
    v_pk_fma_f32 v[30:31], v[190:191], v[180:181], v[30:31]
    v_pk_mul_f32 v[8:9], v[184:185], v[158:159]
    v_pk_mul_f32 v[16:17], v[186:187], v[166:167]
    v_pk_mul_f32 v[24:25], v[188:189], v[174:175]
    v_pk_mul_f32 v[32:33], v[190:191], v[182:183]
    s_waitcnt vmcnt(10)
    v_lshlrev_b32 v184, 16, v120
    v_and_b32 v185, 0xffff0000, v120
    v_lshlrev_b32 v186, 16, v121
    v_and_b32 v187, 0xffff0000, v121
    v_lshlrev_b32 v188, 16, v122
    v_and_b32 v189, 0xffff0000, v122
    v_lshlrev_b32 v190, 16, v123
    v_and_b32 v191, 0xffff0000, v123
    v_pk_fma_f32 v[4:5], v[184:185], v[152:153], v[4:5]
    v_pk_fma_f32 v[12:13], v[186:187], v[160:161], v[12:13]
    v_pk_fma_f32 v[20:21], v[188:189], v[168:169], v[20:21]
    v_pk_fma_f32 v[28:29], v[190:191], v[176:177], v[28:29]
    v_pk_fma_f32 v[6:7], v[184:185], v[154:155], v[6:7]
    v_pk_fma_f32 v[14:15], v[186:187], v[162:163], v[14:15]
    v_pk_fma_f32 v[22:23], v[188:189], v[170:171], v[22:23]
    v_pk_fma_f32 v[30:31], v[190:191], v[178:179], v[30:31]
    v_pk_fma_f32 v[8:9], v[184:185], v[156:157], v[8:9]
    v_pk_fma_f32 v[16:17], v[186:187], v[164:165], v[16:17]
    v_pk_fma_f32 v[24:25], v[188:189], v[172:173], v[24:25]
    v_pk_fma_f32 v[32:33], v[190:191], v[180:181], v[32:33]
    v_pk_mul_f32 v[10:11], v[184:185], v[158:159]
    v_pk_mul_f32 v[18:19], v[186:187], v[166:167]
    v_pk_mul_f32 v[26:27], v[188:189], v[174:175]
    v_pk_mul_f32 v[34:35], v[190:191], v[182:183]
    s_waitcnt vmcnt(9)
    v_lshlrev_b32 v184, 16, v124
    v_and_b32 v185, 0xffff0000, v124
    v_lshlrev_b32 v186, 16, v125
    v_and_b32 v187, 0xffff0000, v125
    v_lshlrev_b32 v188, 16, v126
    v_and_b32 v189, 0xffff0000, v126
    v_lshlrev_b32 v190, 16, v127
    v_and_b32 v191, 0xffff0000, v127
    v_pk_fma_f32 v[6:7], v[184:185], v[152:153], v[6:7]
    v_pk_fma_f32 v[14:15], v[186:187], v[160:161], v[14:15]
    v_pk_fma_f32 v[22:23], v[188:189], v[168:169], v[22:23]
    v_pk_fma_f32 v[30:31], v[190:191], v[176:177], v[30:31]
    v_pk_fma_f32 v[8:9], v[184:185], v[154:155], v[8:9]
    v_pk_fma_f32 v[16:17], v[186:187], v[162:163], v[16:17]
    v_pk_fma_f32 v[24:25], v[188:189], v[170:171], v[24:25]
    v_pk_fma_f32 v[32:33], v[190:191], v[178:179], v[32:33]
    v_pk_fma_f32 v[10:11], v[184:185], v[156:157], v[10:11]
    v_pk_fma_f32 v[18:19], v[186:187], v[164:165], v[18:19]
    v_pk_fma_f32 v[26:27], v[188:189], v[172:173], v[26:27]
    v_pk_fma_f32 v[34:35], v[190:191], v[180:181], v[34:35]
    s_waitcnt vmcnt(8)
    v_lshlrev_b32 v184, 16, v128
    v_and_b32 v185, 0xffff0000, v128
    v_lshlrev_b32 v186, 16, v129
    v_and_b32 v187, 0xffff0000, v129
    v_lshlrev_b32 v188, 16, v130
    v_and_b32 v189, 0xffff0000, v130
    v_lshlrev_b32 v190, 16, v131
    v_and_b32 v191, 0xffff0000, v131
    v_pk_fma_f32 v[8:9], v[184:185], v[152:153], v[8:9]
    v_pk_fma_f32 v[16:17], v[186:187], v[160:161], v[16:17]
    v_pk_fma_f32 v[24:25], v[188:189], v[168:169], v[24:25]
    v_pk_fma_f32 v[32:33], v[190:191], v[176:177], v[32:33]
    v_pk_fma_f32 v[10:11], v[184:185], v[154:155], v[10:11]
    v_pk_fma_f32 v[18:19], v[186:187], v[162:163], v[18:19]
    v_pk_fma_f32 v[26:27], v[188:189], v[170:171], v[26:27]
    v_pk_fma_f32 v[34:35], v[190:191], v[178:179], v[34:35]
    s_waitcnt vmcnt(7)
    v_lshlrev_b32 v184, 16, v132
    v_and_b32 v185, 0xffff0000, v132
    v_lshlrev_b32 v186, 16, v133
    v_and_b32 v187, 0xffff0000, v133
    v_lshlrev_b32 v188, 16, v134
    v_and_b32 v189, 0xffff0000, v134
    v_lshlrev_b32 v190, 16, v135
    v_and_b32 v191, 0xffff0000, v135
    v_pk_fma_f32 v[10:11], v[184:185], v[152:153], v[10:11]
    v_pk_fma_f32 v[18:19], v[186:187], v[160:161], v[18:19]
    v_pk_fma_f32 v[26:27], v[188:189], v[168:169], v[26:27]
    v_pk_fma_f32 v[34:35], v[190:191], v[176:177], v[34:35]
    s_waitcnt vmcnt(6)
    v_lshlrev_b32 v184, 16, v136
    v_and_b32 v185, 0xffff0000, v136
    v_lshlrev_b32 v186, 16, v137
    v_and_b32 v187, 0xffff0000, v137
    v_lshlrev_b32 v188, 16, v138
    v_and_b32 v189, 0xffff0000, v138
    v_lshlrev_b32 v190, 16, v139
    v_and_b32 v191, 0xffff0000, v139
    v_pk_mul_f32 v[4:5], v[4:5], v[184:185]
    v_pk_mul_f32 v[12:13], v[12:13], v[186:187]
    v_pk_mul_f32 v[20:21], v[20:21], v[188:189]
    v_pk_mul_f32 v[28:29], v[28:29], v[190:191]
    s_waitcnt vmcnt(5)
    v_lshlrev_b32 v184, 16, v140
    v_and_b32 v185, 0xffff0000, v140
    v_lshlrev_b32 v186, 16, v141
    v_and_b32 v187, 0xffff0000, v141
    v_lshlrev_b32 v188, 16, v142
    v_and_b32 v189, 0xffff0000, v142
    v_lshlrev_b32 v190, 16, v143
    v_and_b32 v191, 0xffff0000, v143
    v_pk_mul_f32 v[6:7], v[6:7], v[184:185]
    v_pk_mul_f32 v[14:15], v[14:15], v[186:187]
    v_pk_mul_f32 v[22:23], v[22:23], v[188:189]
    v_pk_mul_f32 v[30:31], v[30:31], v[190:191]
    s_waitcnt vmcnt(4)
    v_lshlrev_b32 v184, 16, v144
    v_and_b32 v185, 0xffff0000, v144
    v_lshlrev_b32 v186, 16, v145
    v_and_b32 v187, 0xffff0000, v145
    v_lshlrev_b32 v188, 16, v146
    v_and_b32 v189, 0xffff0000, v146
    v_lshlrev_b32 v190, 16, v147
    v_and_b32 v191, 0xffff0000, v147
    v_pk_mul_f32 v[8:9], v[8:9], v[184:185]
    v_pk_mul_f32 v[16:17], v[16:17], v[186:187]
    v_pk_mul_f32 v[24:25], v[24:25], v[188:189]
    v_pk_mul_f32 v[32:33], v[32:33], v[190:191]
    s_waitcnt vmcnt(3)
    v_lshlrev_b32 v184, 16, v148
    v_and_b32 v185, 0xffff0000, v148
    v_lshlrev_b32 v186, 16, v149
    v_and_b32 v187, 0xffff0000, v149
    v_lshlrev_b32 v188, 16, v150
    v_and_b32 v189, 0xffff0000, v150
    v_lshlrev_b32 v190, 16, v151
    v_and_b32 v191, 0xffff0000, v151
    v_pk_mul_f32 v[10:11], v[10:11], v[184:185]
    v_pk_mul_f32 v[18:19], v[18:19], v[186:187]
    v_pk_mul_f32 v[26:27], v[26:27], v[188:189]
    v_pk_mul_f32 v[34:35], v[34:35], v[190:191]
    v_cvt_pk_bf16_f32 v108, v10, v8
    v_cvt_pk_bf16_f32 v109, v6, v4
    ds_write_b64 v231, v[108:109] offset:0
    v_cvt_pk_bf16_f32 v110, v11, v9
    v_cvt_pk_bf16_f32 v111, v7, v5
    ds_write_b64 v231, v[110:111] offset:64
    v_cvt_pk_bf16_f32 v112, v18, v16
    v_cvt_pk_bf16_f32 v113, v14, v12
    ds_write_b64 v231, v[112:113] offset:128
    v_cvt_pk_bf16_f32 v114, v19, v17
    v_cvt_pk_bf16_f32 v115, v15, v13
    ds_write_b64 v231, v[114:115] offset:192
    v_cvt_pk_bf16_f32 v116, v26, v24
    v_cvt_pk_bf16_f32 v117, v22, v20
    ds_write_b64 v231, v[116:117] offset:256
    v_cvt_pk_bf16_f32 v118, v27, v25
    v_cvt_pk_bf16_f32 v119, v23, v21
    ds_write_b64 v231, v[118:119] offset:320
    v_cvt_pk_bf16_f32 v120, v34, v32
    v_cvt_pk_bf16_f32 v121, v30, v28
    ds_write_b64 v231, v[120:121] offset:384
    v_cvt_pk_bf16_f32 v122, v35, v33
    v_cvt_pk_bf16_f32 v123, v31, v29
    ds_write_b64 v231, v[122:123] offset:448
    ds_read_b128 v[152:155], v232 offset:0
    ds_read_b128 v[156:159], v232 offset:1056
    ds_read_b128 v[160:163], v232 offset:2112
    ds_read_b128 v[164:167], v232 offset:3168
    v_mov_b64 v[4:5], 0
    v_mov_b64 v[6:7], 0
    v_mov_b64 v[8:9], 0
    v_mov_b64 v[10:11], 0
    v_mov_b64 v[12:13], 0
    v_mov_b64 v[14:15], 0
    v_mov_b64 v[16:17], 0
    v_mov_b64 v[18:19], 0
    v_mov_b64 v[20:21], 0
    v_mov_b64 v[22:23], 0
    v_mov_b64 v[24:25], 0
    v_mov_b64 v[26:27], 0
    v_mov_b64 v[28:29], 0
    v_mov_b64 v[30:31], 0
    v_mov_b64 v[32:33], 0
    v_mov_b64 v[34:35], 0
    s_waitcnt lgkmcnt(0)
    s_mov_b32 s87, 0
    buffer_store_dwordx4 v[152:155], v233, s[80:83], s87 offen sc1
    s_mov_b32 s87, 67584
    buffer_store_dwordx4 v[156:159], v233, s[80:83], s87 offen sc1
    s_mov_b32 s87, 135168
    buffer_store_dwordx4 v[160:163], v233, s[80:83], s87 offen sc1
    s_mov_b32 s87, 202752
    buffer_store_dwordx4 v[164:167], v233, s[80:83], s87 offen sc1
    s_mov_b32 s37, 41984
    s_mov_b32 s36, 15
    s_barrier
    ds_read_b128 v[108:111], v196 offset:0
    ds_read_b64_tr_b16 v[128:129], v200 offset:0
    ds_read_b64_tr_b16 v[130:131], v200 offset:512
    ds_read_b128 v[112:115], v196 offset:2048
    ds_read_b64_tr_b16 v[132:133], v201 offset:0
    ds_read_b64_tr_b16 v[134:135], v201 offset:512
    ds_read_b128 v[116:119], v196 offset:4096
    ds_read_b64_tr_b16 v[136:137], v200 offset:8192
    ds_read_b64_tr_b16 v[138:139], v200 offset:8704
    ds_read_b128 v[120:123], v196 offset:6144
    ds_read_b64_tr_b16 v[140:141], v201 offset:8192
    ds_read_b64_tr_b16 v[142:143], v201 offset:8704
    ds_read_b128 v[124:127], v198
    ds_read_b64_tr_b16 v[144:145], v200 offset:16384
    ds_read_b64_tr_b16 v[146:147], v200 offset:16896
    ds_read_b64_tr_b16 v[148:149], v201 offset:16384
    ds_read_b64_tr_b16 v[150:151], v201 offset:16896
    s_waitcnt lgkmcnt(0)
L_g1_loop:
    v_mfma_f32_16x16x32_bf16 v[4:7], v[128:131], v[108:111], v[4:7]
    ds_read_b128 v[152:155], v197 offset:0
    v_mfma_f32_16x16x32_bf16 v[12:15], v[128:131], v[112:115], v[12:15]
    ds_read_b64_tr_b16 v[172:173], v200 offset:4096
    v_mfma_f32_16x16x32_bf16 v[20:23], v[128:131], v[116:119], v[20:23]
    ds_read_b64_tr_b16 v[174:175], v200 offset:4608
    v_mfma_f32_16x16x32_bf16 v[28:31], v[128:131], v[120:123], v[28:31]
    ds_read_b128 v[156:159], v197 offset:2048
    v_mfma_f32_16x16x32_bf16 v[8:11], v[132:135], v[108:111], v[8:11]
    ds_read_b64_tr_b16 v[176:177], v201 offset:4096
    v_mfma_f32_16x16x32_bf16 v[16:19], v[132:135], v[112:115], v[16:19]
    ds_read_b64_tr_b16 v[178:179], v201 offset:4608
    v_mfma_f32_16x16x32_bf16 v[24:27], v[132:135], v[116:119], v[24:27]
    ds_read_b128 v[160:163], v197 offset:4096
    v_mfma_f32_16x16x32_bf16 v[32:35], v[132:135], v[120:123], v[32:35]
    ds_read_b64_tr_b16 v[180:181], v200 offset:12288
    v_mfma_f32_16x16x32_bf16 v[36:39], v[136:139], v[108:111], v[36:39]
    ds_read_b64_tr_b16 v[182:183], v200 offset:12800
    v_mfma_f32_16x16x32_bf16 v[44:47], v[136:139], v[112:115], v[44:47]
    ds_read_b128 v[164:167], v197 offset:6144
    v_mfma_f32_16x16x32_bf16 v[52:55], v[136:139], v[116:119], v[52:55]
    ds_read_b64_tr_b16 v[184:185], v201 offset:12288
    v_mfma_f32_16x16x32_bf16 v[60:63], v[136:139], v[120:123], v[60:63]
    ds_read_b64_tr_b16 v[186:187], v201 offset:12800
    v_mfma_f32_16x16x32_bf16 v[100:103], v[136:139], v[124:127], v[100:103]
    ds_read_b128 v[168:171], v199
    v_mfma_f32_16x16x32_bf16 v[40:43], v[140:143], v[108:111], v[40:43]
    ds_read_b64_tr_b16 v[188:189], v200 offset:20480
    v_mfma_f32_16x16x32_bf16 v[48:51], v[140:143], v[112:115], v[48:51]
    ds_read_b64_tr_b16 v[190:191], v200 offset:20992
    v_mfma_f32_16x16x32_bf16 v[56:59], v[140:143], v[116:119], v[56:59]
    ds_read_b64_tr_b16 v[192:193], v201 offset:20480
    v_mfma_f32_16x16x32_bf16 v[64:67], v[140:143], v[120:123], v[64:67]
    ds_read_b64_tr_b16 v[194:195], v201 offset:20992
    v_mfma_f32_16x16x32_bf16 v[68:71], v[108:111], v[144:147], v[68:71]
    ds_read_b32 v1, v228 offset:24
    v_mfma_f32_16x16x32_bf16 v[76:79], v[112:115], v[144:147], v[76:79]
    s_add_u32 s34, s34, 41984
    v_mfma_f32_16x16x32_bf16 v[84:87], v[116:119], v[144:147], v[84:87]
    s_cmp_eq_u32 s34, 125952
    v_mfma_f32_16x16x32_bf16 v[92:95], v[120:123], v[144:147], v[92:95]
    s_cselect_b32 s35, -83968, s37
    v_mfma_f32_16x16x32_bf16 v[104:107], v[124:127], v[144:147], v[104:107]
    s_cselect_b32 s34, 0, s34
    v_mfma_f32_16x16x32_bf16 v[72:75], v[108:111], v[148:151], v[72:75]
    s_bitcmp1_b32 0x1002, s36
    s_waitcnt lgkmcnt(0)
    v_mfma_f32_16x16x32_bf16 v[80:83], v[112:115], v[148:151], v[80:83]
    v_add_u32 v196, s35, v196
    v_add_u32 v197, s35, v197
    v_mfma_f32_16x16x32_bf16 v[88:91], v[116:119], v[148:151], v[88:91]
    v_add_u32 v198, s35, v198
    v_add_u32 v199, s35, v199
    v_mfma_f32_16x16x32_bf16 v[96:99], v[120:123], v[148:151], v[96:99]
    v_add_u32 v200, s35, v200
    v_add_u32 v201, s35, v201
    s_cbranch_scc1 L_g1_rare
L_g1_bar:
    s_barrier
L_g1_nobar:
    v_mfma_f32_16x16x32_bf16 v[4:7], v[172:175], v[152:155], v[4:7]
    ds_read_b128 v[108:111], v196 offset:0
    v_mfma_f32_16x16x32_bf16 v[12:15], v[172:175], v[156:159], v[12:15]
    ds_read_b64_tr_b16 v[128:129], v200 offset:0
    v_mfma_f32_16x16x32_bf16 v[20:23], v[172:175], v[160:163], v[20:23]
    ds_read_b64_tr_b16 v[130:131], v200 offset:512
    v_mfma_f32_16x16x32_bf16 v[28:31], v[172:175], v[164:167], v[28:31]
    ds_read_b128 v[112:115], v196 offset:2048
    v_mfma_f32_16x16x32_bf16 v[8:11], v[176:179], v[152:155], v[8:11]
    ds_read_b64_tr_b16 v[132:133], v201 offset:0
    v_mfma_f32_16x16x32_bf16 v[16:19], v[176:179], v[156:159], v[16:19]
    ds_read_b64_tr_b16 v[134:135], v201 offset:512
    v_mfma_f32_16x16x32_bf16 v[24:27], v[176:179], v[160:163], v[24:27]
    ds_read_b128 v[116:119], v196 offset:4096
    v_mfma_f32_16x16x32_bf16 v[32:35], v[176:179], v[164:167], v[32:35]
    ds_read_b64_tr_b16 v[136:137], v200 offset:8192
    v_mfma_f32_16x16x32_bf16 v[36:39], v[180:183], v[152:155], v[36:39]
    ds_read_b64_tr_b16 v[138:139], v200 offset:8704
    v_mfma_f32_16x16x32_bf16 v[44:47], v[180:183], v[156:159], v[44:47]
    ds_read_b128 v[120:123], v196 offset:6144
    v_mfma_f32_16x16x32_bf16 v[52:55], v[180:183], v[160:163], v[52:55]
    ds_read_b64_tr_b16 v[140:141], v201 offset:8192
    v_mfma_f32_16x16x32_bf16 v[60:63], v[180:183], v[164:167], v[60:63]
    ds_read_b64_tr_b16 v[142:143], v201 offset:8704
    v_mfma_f32_16x16x32_bf16 v[100:103], v[180:183], v[168:171], v[100:103]
    ds_read_b128 v[124:127], v198
    v_mfma_f32_16x16x32_bf16 v[40:43], v[184:187], v[152:155], v[40:43]
    ds_read_b64_tr_b16 v[144:145], v200 offset:16384
    v_mfma_f32_16x16x32_bf16 v[48:51], v[184:187], v[156:159], v[48:51]
    ds_read_b64_tr_b16 v[146:147], v200 offset:16896
    v_mfma_f32_16x16x32_bf16 v[56:59], v[184:187], v[160:163], v[56:59]
    ds_read_b64_tr_b16 v[148:149], v201 offset:16384
    v_mfma_f32_16x16x32_bf16 v[64:67], v[184:187], v[164:167], v[64:67]
    ds_read_b64_tr_b16 v[150:151], v201 offset:16896
    v_mfma_f32_16x16x32_bf16 v[68:71], v[152:155], v[188:191], v[68:71]
    s_sub_u32 s36, s36, 1
    v_mfma_f32_16x16x32_bf16 v[76:79], v[156:159], v[188:191], v[76:79]
    s_cmp_lg_u32 s36, 0
    v_mfma_f32_16x16x32_bf16 v[84:87], v[160:163], v[188:191], v[84:87]
    v_mfma_f32_16x16x32_bf16 v[92:95], v[164:167], v[188:191], v[92:95]
    v_mfma_f32_16x16x32_bf16 v[104:107], v[168:171], v[188:191], v[104:107]
    v_mfma_f32_16x16x32_bf16 v[72:75], v[152:155], v[192:195], v[72:75]
    v_mfma_f32_16x16x32_bf16 v[80:83], v[156:159], v[192:195], v[80:83]
    v_mfma_f32_16x16x32_bf16 v[88:91], v[160:163], v[192:195], v[88:91]
    v_mfma_f32_16x16x32_bf16 v[96:99], v[164:167], v[192:195], v[96:99]
    s_waitcnt lgkmcnt(0)
    s_cbranch_scc1 L_g1_loop
    v_mfma_f32_16x16x32_bf16 v[4:7], v[128:131], v[108:111], v[4:7]
    ds_read_b128 v[152:155], v197 offset:0
    v_mfma_f32_16x16x32_bf16 v[12:15], v[128:131], v[112:115], v[12:15]
    ds_read_b64_tr_b16 v[172:173], v200 offset:4096
    v_mfma_f32_16x16x32_bf16 v[20:23], v[128:131], v[116:119], v[20:23]
    ds_read_b64_tr_b16 v[174:175], v200 offset:4608
    v_mfma_f32_16x16x32_bf16 v[28:31], v[128:131], v[120:123], v[28:31]
    ds_read_b128 v[156:159], v197 offset:2048
    v_mfma_f32_16x16x32_bf16 v[8:11], v[132:135], v[108:111], v[8:11]
    ds_read_b64_tr_b16 v[176:177], v201 offset:4096
    v_mfma_f32_16x16x32_bf16 v[16:19], v[132:135], v[112:115], v[16:19]
    ds_read_b64_tr_b16 v[178:179], v201 offset:4608
    v_mfma_f32_16x16x32_bf16 v[24:27], v[132:135], v[116:119], v[24:27]
    ds_read_b128 v[160:163], v197 offset:4096
    v_mfma_f32_16x16x32_bf16 v[32:35], v[132:135], v[120:123], v[32:35]
    ds_read_b64_tr_b16 v[180:181], v200 offset:12288
    v_mfma_f32_16x16x32_bf16 v[36:39], v[136:139], v[108:111], v[36:39]
    ds_read_b64_tr_b16 v[182:183], v200 offset:12800
    v_mfma_f32_16x16x32_bf16 v[44:47], v[136:139], v[112:115], v[44:47]
    ds_read_b128 v[164:167], v197 offset:6144
    v_mfma_f32_16x16x32_bf16 v[52:55], v[136:139], v[116:119], v[52:55]
    ds_read_b64_tr_b16 v[184:185], v201 offset:12288
    v_mfma_f32_16x16x32_bf16 v[60:63], v[136:139], v[120:123], v[60:63]
    ds_read_b64_tr_b16 v[186:187], v201 offset:12800
    v_mfma_f32_16x16x32_bf16 v[100:103], v[136:139], v[124:127], v[100:103]
    ds_read_b128 v[168:171], v199
    v_mfma_f32_16x16x32_bf16 v[40:43], v[140:143], v[108:111], v[40:43]
    ds_read_b64_tr_b16 v[188:189], v200 offset:20480
    v_mfma_f32_16x16x32_bf16 v[48:51], v[140:143], v[112:115], v[48:51]
    ds_read_b64_tr_b16 v[190:191], v200 offset:20992
    v_mfma_f32_16x16x32_bf16 v[56:59], v[140:143], v[116:119], v[56:59]
    ds_read_b64_tr_b16 v[192:193], v201 offset:20480
    v_mfma_f32_16x16x32_bf16 v[64:67], v[140:143], v[120:123], v[64:67]
    ds_read_b64_tr_b16 v[194:195], v201 offset:20992
    v_mfma_f32_16x16x32_bf16 v[68:71], v[108:111], v[144:147], v[68:71]
    v_mfma_f32_16x16x32_bf16 v[76:79], v[112:115], v[144:147], v[76:79]
    v_mfma_f32_16x16x32_bf16 v[84:87], v[116:119], v[144:147], v[84:87]
    v_mfma_f32_16x16x32_bf16 v[92:95], v[120:123], v[144:147], v[92:95]
    v_mfma_f32_16x16x32_bf16 v[104:107], v[124:127], v[144:147], v[104:107]
    v_mfma_f32_16x16x32_bf16 v[72:75], v[108:111], v[148:151], v[72:75]
    v_mfma_f32_16x16x32_bf16 v[80:83], v[112:115], v[148:151], v[80:83]
    v_mfma_f32_16x16x32_bf16 v[88:91], v[116:119], v[148:151], v[88:91]
    v_mfma_f32_16x16x32_bf16 v[96:99], v[120:123], v[148:151], v[96:99]
    s_waitcnt lgkmcnt(0)
    s_setprio 2
    v_mov_b32 v2, 1
    v_mfma_f32_16x16x32_bf16 v[100:103], v[180:183], v[168:171], v[100:103]
    v_mfma_f32_16x16x32_bf16 v[104:107], v[168:171], v[188:191], v[104:107]
    v_mfma_f32_16x16x32_bf16 v[60:63], v[180:183], v[164:167], v[60:63]
    v_mfma_f32_16x16x32_bf16 v[64:67], v[184:187], v[164:167], v[64:67]
    v_mfma_f32_16x16x32_bf16 v[92:95], v[164:167], v[188:191], v[92:95]
    v_mfma_f32_16x16x32_bf16 v[96:99], v[164:167], v[192:195], v[96:99]
    v_mfma_f32_16x16x32_bf16 v[28:31], v[172:175], v[164:167], v[28:31]
    v_mfma_f32_16x16x32_bf16 v[32:35], v[176:179], v[164:167], v[32:35]
    v_mfma_f32_16x16x32_bf16 v[52:55], v[180:183], v[160:163], v[52:55]
    v_cvt_pk_bf16_f32 v144, v100, v101
    v_cvt_pk_bf16_f32 v145, v102, v103
    v_mfma_f32_16x16x32_bf16 v[56:59], v[184:187], v[160:163], v[56:59]
    ds_write_b64 v219, v[144:145]
    v_cvt_pk_bf16_f32 v146, v104, v105
    v_mfma_f32_16x16x32_bf16 v[20:23], v[172:175], v[160:163], v[20:23]
    v_cvt_pk_bf16_f32 v147, v106, v107
    ds_write_b64 v219, v[146:147] offset:1024
    v_mfma_f32_16x16x32_bf16 v[24:27], v[176:179], v[160:163], v[24:27]
    v_cvt_pk_bf16_f32 v140, v60, v61
    v_cvt_pk_bf16_f32 v141, v62, v63
    v_mfma_f32_16x16x32_bf16 v[44:47], v[180:183], v[156:159], v[44:47]
    v_cvt_pk_bf16_f32 v142, v64, v65
    v_cvt_pk_bf16_f32 v143, v66, v67
    v_mfma_f32_16x16x32_bf16 v[48:51], v[184:187], v[156:159], v[48:51]
    v_cvt_pk_bf16_f32 v238, v92, v93
    v_cvt_pk_bf16_f32 v239, v94, v95
    v_mfma_f32_16x16x32_bf16 v[12:15], v[172:175], v[156:159], v[12:15]
    v_cvt_pk_bf16_f32 v248, v96, v97
    v_cvt_pk_bf16_f32 v249, v98, v99
    v_mfma_f32_16x16x32_bf16 v[16:19], v[176:179], v[156:159], v[16:19]
    s_cmp_eq_u32 s33, 0
    s_cbranch_scc0 L_at_nopub
    ds_write_b64 v220, v[140:141] offset:2048
    ds_write_b64 v220, v[238:239] offset:3072
    ds_write_b64 v220, v[142:143] offset:2560
    ds_write_b64 v220, v[248:249] offset:3584
L_at_nopub:
    s_mov_b64 exec, 1
    ds_add_u32 v228, v2 offset:20
    s_mov_b64 exec, -1
    v_cvt_pk_bf16_f32 v120, v28, v29
    v_mfma_f32_16x16x32_bf16 v[36:39], v[180:183], v[152:155], v[36:39]
    v_cvt_pk_bf16_f32 v121, v30, v31
    v_cvt_pk_bf16_f32 v122, v32, v33
    v_mfma_f32_16x16x32_bf16 v[40:43], v[184:187], v[152:155], v[40:43]
    v_cvt_pk_bf16_f32 v123, v34, v35
    v_cvt_pk_bf16_f32 v136, v52, v53
    v_mfma_f32_16x16x32_bf16 v[4:7], v[172:175], v[152:155], v[4:7]
    v_cvt_pk_bf16_f32 v137, v54, v55
    v_cvt_pk_bf16_f32 v138, v56, v57
    v_mfma_f32_16x16x32_bf16 v[8:11], v[176:179], v[152:155], v[8:11]
    v_cvt_pk_bf16_f32 v139, v58, v59
    v_cvt_pk_bf16_f32 v116, v20, v21
    v_mfma_f32_16x16x32_bf16 v[84:87], v[160:163], v[188:191], v[84:87]
    v_cvt_pk_bf16_f32 v117, v22, v23
    v_cvt_pk_bf16_f32 v118, v24, v25
    v_mfma_f32_16x16x32_bf16 v[88:91], v[160:163], v[192:195], v[88:91]
    v_cvt_pk_bf16_f32 v119, v26, v27
    v_cvt_pk_bf16_f32 v132, v44, v45
    v_mfma_f32_16x16x32_bf16 v[76:79], v[156:159], v[188:191], v[76:79]
    v_cvt_pk_bf16_f32 v133, v46, v47
    v_cvt_pk_bf16_f32 v134, v48, v49
    v_mfma_f32_16x16x32_bf16 v[80:83], v[156:159], v[192:195], v[80:83]
    v_cvt_pk_bf16_f32 v135, v50, v51
    v_cvt_pk_bf16_f32 v112, v12, v13
    v_mfma_f32_16x16x32_bf16 v[68:71], v[152:155], v[188:191], v[68:71]
    v_cvt_pk_bf16_f32 v113, v14, v15
    v_cvt_pk_bf16_f32 v114, v16, v17
    v_mfma_f32_16x16x32_bf16 v[72:75], v[152:155], v[192:195], v[72:75]
    v_cvt_pk_bf16_f32 v115, v18, v19
    v_cvt_pk_bf16_f32 v128, v36, v37
    v_mfma_f32_16x16x32_bf16 v[28:31], v[140:143], v[120:123], v[204:207]
    v_cvt_pk_bf16_f32 v129, v38, v39
    v_cvt_pk_bf16_f32 v130, v40, v41
    v_mfma_f32_16x16x32_bf16 v[32:35], v[136:139], v[120:123], v[208:211]
    v_cvt_pk_bf16_f32 v131, v42, v43
    v_cvt_pk_bf16_f32 v108, v4, v5
    v_mfma_f32_16x16x32_bf16 v[20:23], v[136:139], v[116:119], v[204:207]
    v_cvt_pk_bf16_f32 v109, v6, v7
    v_cvt_pk_bf16_f32 v110, v8, v9
    v_mfma_f32_16x16x32_bf16 v[24:27], v[132:135], v[116:119], v[208:211]
    v_cvt_pk_bf16_f32 v111, v10, v11
    v_cvt_pk_bf16_f32 v236, v84, v85
    v_mfma_f32_16x16x32_bf16 v[12:15], v[132:135], v[112:115], v[204:207]
    v_cvt_pk_bf16_f32 v237, v86, v87
    v_cvt_pk_bf16_f32 v246, v88, v89
    v_mfma_f32_16x16x32_bf16 v[16:19], v[128:131], v[112:115], v[208:211]
    v_cvt_pk_bf16_f32 v247, v90, v91
    v_cvt_pk_bf16_f32 v234, v76, v77
    v_mfma_f32_16x16x32_bf16 v[4:7], v[128:131], v[108:111], v[204:207]
    v_cvt_pk_bf16_f32 v235, v78, v79
    ds_read_b32 v1, v228 offset:20
    v_cvt_pk_bf16_f32 v244, v80, v81
    v_cvt_pk_bf16_f32 v245, v82, v83
    v_cvt_pk_bf16_f32 v232, v68, v69
    v_cvt_pk_bf16_f32 v233, v70, v71
    v_cvt_pk_bf16_f32 v242, v72, v73
    v_cvt_pk_bf16_f32 v243, v74, v75
    s_waitcnt lgkmcnt(0)
    v_readfirstlane_b32 s37, v1
    s_nop 0
    s_cmp_ge_u32 s37, 4
    s_cbranch_scc1 L_sl_done_37
    s_mov_b32 s38, 1048576
L_sl_loop_38:
    ds_read_b32 v1, v228 offset:20
    s_waitcnt lgkmcnt(0)
    v_readfirstlane_b32 s37, v1
    s_nop 0
    s_cmp_ge_u32 s37, 4
    s_cbranch_scc1 L_sl_done_37
    s_sleep 1
    s_sub_u32 s38, s38, 1
    s_cbranch_scc0 L_sl_loop_38
L_sl_done_37:
    ds_read_b64 v[124:125], v221
    ds_read_b64 v[126:127], v222
    ds_read_b64 v[230:231], v221 offset:1024
    ds_read_b64 v[240:241], v222 offset:1024
    v_max_f32 v28, v28, v32
    v_max_f32 v29, v29, v33
    v_max_f32 v30, v30, v34
    v_max_f32 v31, v31, v35
    v_max3_f32 v39, v28, v29, v30
    v_max_f32 v39, v39, v31
    v_max_f32 v20, v20, v24
    v_max_f32 v21, v21, v25
    v_max_f32 v22, v22, v26
    v_max_f32 v23, v23, v27
    v_max3_f32 v38, v20, v21, v22
    v_max_f32 v38, v38, v23
    s_waitcnt lgkmcnt(2)
    v_mfma_f32_16x16x32_bf16 v[8:11], v[124:127], v[108:111], v[212:215]
    s_mov_b32 s37, 0x3e8293ee
    v_max_f32 v12, v12, v16
    v_max_f32 v13, v13, v17
    v_max_f32 v14, v14, v18
    v_max_f32 v15, v15, v19
    v_max3_f32 v37, v12, v13, v14
    v_max_f32 v37, v37, v15
    s_nop 0
    v_max_f32 v4, v4, v8
    v_max_f32 v5, v5, v9
    v_max_f32 v6, v6, v10
    v_max_f32 v7, v7, v11
    v_max3_f32 v36, v4, v5, v6
    v_max_f32 v36, v36, v7
    v_permlane32_swap_b32 v38, v39
    s_nop 0
    v_permlane32_swap_b32 v36, v37
    v_max_f32 v38, v38, v39
    v_max_f32 v36, v36, v37
    s_nop 1
    v_permlane16_swap_b32 v36, v38
    v_max_f32 v36, v36, v38
    v_mul_f32 v38, s37, v36
    v_mul_f32 v36, s37, v36
    s_nop 1
    v_permlane16_swap_b32 v36, v38
    v_mov_b32 v37, v36
    v_mov_b32 v39, v38
    s_nop 0
    v_permlane32_swap_b32 v36, v37
    v_permlane32_swap_b32 v38, v39
    v_fma_f32 v4, v4, s37, -v36
    v_fma_f32 v5, v5, s37, -v36
    v_fma_f32 v6, v6, s37, -v36
    v_fma_f32 v7, v7, s37, -v36
    v_fma_f32 v12, v12, s37, -v37
    v_fma_f32 v13, v13, s37, -v37
    v_fma_f32 v14, v14, s37, -v37
    v_fma_f32 v15, v15, s37, -v37
    v_fma_f32 v20, v20, s37, -v38
    v_fma_f32 v21, v21, s37, -v38
    v_fma_f32 v22, v22, s37, -v38
    v_fma_f32 v23, v23, s37, -v38
    v_fma_f32 v28, v28, s37, -v39
    v_fma_f32 v29, v29, s37, -v39
    v_fma_f32 v30, v30, s37, -v39
    v_fma_f32 v31, v31, s37, -v39
    v_exp_f32 v28, v28
    v_exp_f32 v29, v29
    v_exp_f32 v30, v30
    v_exp_f32 v31, v31
    v_exp_f32 v20, v20
    v_exp_f32 v21, v21
    v_exp_f32 v22, v22
    v_exp_f32 v23, v23
    v_exp_f32 v12, v12
    v_exp_f32 v13, v13
    v_exp_f32 v14, v14
    v_exp_f32 v15, v15
    v_exp_f32 v4, v4
    v_exp_f32 v5, v5
    v_exp_f32 v6, v6
    v_exp_f32 v7, v7
    v_add_f32 v39, v28, v29
    v_add_f32 v32, v30, v31
    v_add_f32 v39, v39, v32
    v_add_f32 v38, v20, v21
    v_add_f32 v24, v22, v23
    v_add_f32 v38, v38, v24
    v_add_f32 v37, v12, v13
    v_add_f32 v16, v14, v15
    v_add_f32 v37, v37, v16
    v_add_f32 v36, v4, v5
    v_add_f32 v8, v6, v7
    v_add_f32 v36, v36, v8
    v_permlane32_swap_b32 v38, v39
    s_nop 0
    v_permlane32_swap_b32 v36, v37
    v_add_f32 v38, v38, v39
    v_add_f32 v36, v36, v37
    s_nop 1
    v_permlane16_swap_b32 v36, v38
    v_add_f32 v36, v36, v38
    v_rcp_f32 v38, v36
    v_rcp_f32 v36, v36
    s_nop 1
    v_permlane16_swap_b32 v36, v38
    v_mov_b32 v37, v36
    v_mov_b32 v39, v38
    s_nop 0
    v_permlane32_swap_b32 v36, v37
    v_permlane32_swap_b32 v38, v39
    s_waitcnt lgkmcnt(0)
    s_cmp_eq_u32 s33, 0
    v_mul_f32 v4, v4, v36
    v_mul_f32 v5, v5, v36
    v_mul_f32 v6, v6, v36
    v_mul_f32 v7, v7, v36
    v_cvt_pk_bf16_f32 v10, v4, v5
    v_cvt_pk_bf16_f32 v11, v6, v7
    v_and_b32 v8, v216, v10
    v_and_b32 v9, v217, v11
    v_xor_b32 v10, v8, v10
    v_xor_b32 v11, v9, v11
    s_nop 1
    v_mfma_f32_16x16x32_bf16 v[68:71], v[230:233], v[8:11], 0
    v_mfma_f32_16x16x32_bf16 v[72:75], v[240:243], v[8:11], 0
    v_mul_f32 v12, v12, v37
    v_mul_f32 v13, v13, v37
    v_mul_f32 v14, v14, v37
    v_mul_f32 v15, v15, v37
    v_cvt_pk_bf16_f32 v18, v12, v13
    v_cvt_pk_bf16_f32 v19, v14, v15
    v_and_b32 v16, v216, v18
    v_and_b32 v17, v217, v19
    v_xor_b32 v18, v16, v18
    v_xor_b32 v19, v17, v19
    v_cvt_pk_bf16_f32 v108, v68, v69
    v_cvt_pk_bf16_f32 v109, v70, v71
    v_cvt_pk_bf16_f32 v110, v72, v73
    v_cvt_pk_bf16_f32 v111, v74, v75
    s_cbranch_scc1 L_at_noswap0
    v_swap_b32 v108, v110
    v_swap_b32 v109, v111
L_at_noswap0:
    s_mov_b32 s37, 0
    buffer_store_dwordx4 v[108:111], v218, s[40:43], s37 offen sc1
    v_mfma_f32_16x16x32_bf16 v[76:79], v[232:235], v[16:19], 0
    v_mfma_f32_16x16x32_bf16 v[80:83], v[242:245], v[16:19], 0
    v_mul_f32 v20, v20, v38
    v_mul_f32 v21, v21, v38
    v_mul_f32 v22, v22, v38
    v_mul_f32 v23, v23, v38
    v_cvt_pk_bf16_f32 v26, v20, v21
    v_cvt_pk_bf16_f32 v27, v22, v23
    v_and_b32 v24, v216, v26
    v_and_b32 v25, v217, v27
    v_xor_b32 v26, v24, v26
    v_xor_b32 v27, v25, v27
    v_cvt_pk_bf16_f32 v112, v76, v77
    v_cvt_pk_bf16_f32 v113, v78, v79
    v_cvt_pk_bf16_f32 v114, v80, v81
    v_cvt_pk_bf16_f32 v115, v82, v83
    s_cbranch_scc1 L_at_noswap1
    v_swap_b32 v112, v114
    v_swap_b32 v113, v115
L_at_noswap1:
    s_mov_b32 s37, 32768
    buffer_store_dwordx4 v[112:115], v218, s[40:43], s37 offen sc1
    v_mfma_f32_16x16x32_bf16 v[84:87], v[234:237], v[24:27], 0
    v_mfma_f32_16x16x32_bf16 v[88:91], v[244:247], v[24:27], 0
    v_mul_f32 v28, v28, v39
    v_mul_f32 v29, v29, v39
    v_mul_f32 v30, v30, v39
    v_mul_f32 v31, v31, v39
    v_cvt_pk_bf16_f32 v34, v28, v29
    v_cvt_pk_bf16_f32 v35, v30, v31
    v_and_b32 v32, v216, v34
    v_and_b32 v33, v217, v35
    v_xor_b32 v34, v32, v34
    v_xor_b32 v35, v33, v35
    v_cvt_pk_bf16_f32 v116, v84, v85
    v_cvt_pk_bf16_f32 v117, v86, v87
    v_cvt_pk_bf16_f32 v118, v88, v89
    v_cvt_pk_bf16_f32 v119, v90, v91
    s_cbranch_scc1 L_at_noswap2
    v_swap_b32 v116, v118
    v_swap_b32 v117, v119
L_at_noswap2:
    s_mov_b32 s37, 65536
    buffer_store_dwordx4 v[116:119], v218, s[40:43], s37 offen sc1
    v_mfma_f32_16x16x32_bf16 v[92:95], v[236:239], v[32:35], 0
    v_mfma_f32_16x16x32_bf16 v[96:99], v[246:249], v[32:35], 0
    s_nop 6
    v_cvt_pk_bf16_f32 v120, v92, v93
    v_cvt_pk_bf16_f32 v121, v94, v95
    v_cvt_pk_bf16_f32 v122, v96, v97
    v_cvt_pk_bf16_f32 v123, v98, v99
    s_cbranch_scc1 L_at_noswap3
    v_swap_b32 v120, v122
    v_swap_b32 v121, v123
L_at_noswap3:
    s_mov_b32 s37, 98304
    buffer_store_dwordx4 v[120:123], v218, s[40:43], s37 offen sc1
    s_setprio 0
    s_add_u32 m0, s60, 0
    s_add_u32 s63, s62, 0
    s_and_b32 s63, s63, 0x1fffff
    buffer_load_dwordx4 v227, s[44:47], s63 offen lds
    s_add_u32 m0, s60, 1024
    s_add_u32 s63, s62, 16384
    s_and_b32 s63, s63, 0x1fffff
    buffer_load_dwordx4 v227, s[44:47], s63 offen lds
    s_add_u32 m0, s60, 8192
    s_add_u32 s63, s62, 131072
    s_and_b32 s63, s63, 0x1fffff
    buffer_load_dwordx4 v227, s[44:47], s63 offen lds
    s_add_u32 m0, s60, 9216
    s_add_u32 s63, s62, 147456
    s_and_b32 s63, s63, 0x1fffff
    buffer_load_dwordx4 v227, s[44:47], s63 offen lds
    s_add_u32 m0, s60, 16384
    s_add_u32 s63, s62, 262144
    s_and_b32 s63, s63, 0x1fffff
    buffer_load_dwordx4 v227, s[44:47], s63 offen lds
    s_add_u32 m0, s60, 17408
    s_add_u32 s63, s62, 278528
    s_and_b32 s63, s63, 0x1fffff
    buffer_load_dwordx4 v227, s[44:47], s63 offen lds
    v_xor_b32 v72, 0, v229
    v_xor_b32 v73, 32, v229
    v_xor_b32 v74, 64, v229
    v_xor_b32 v75, 96, v229
    v_add_u32 v76, 83968, v72
    v_add_u32 v77, 83968, v73
    v_add_u32 v78, 83968, v74
    v_add_u32 v79, 83968, v75
    v_add_u32 v80, 125952, v72
    v_add_u32 v81, 125952, v73
    v_add_u32 v82, 125952, v74
    v_add_u32 v83, 125952, v75
    s_add_u32 s64, s61, 0
    s_and_b32 s64, s64, 7
    s_lshl_b32 s64, s64, 12
    s_add_u32 s65, s61, 1
    s_and_b32 s65, s65, 7
    s_lshl_b32 s65, s65, 12
    s_add_u32 s66, s61, 2
    s_and_b32 s66, s66, 7
    s_lshl_b32 s66, s66, 12
    s_add_u32 s67, s61, 3
    s_and_b32 s67, s67, 7
    s_lshl_b32 s67, s67, 12
    s_add_u32 s68, s61, 4
    s_and_b32 s68, s68, 7
    s_lshl_b32 s68, s68, 12
    s_add_u32 s69, s61, 5
    s_and_b32 s69, s69, 7
    s_lshl_b32 s69, s69, 12
    s_add_u32 s70, s61, 6
    s_and_b32 s70, s70, 7
    s_lshl_b32 s70, s70, 12
    s_add_u32 s71, s61, 7
    s_and_b32 s71, s71, 7
    s_lshl_b32 s71, s71, 12
    s_waitcnt vmcnt(6)
    s_setprio 2
    v_mov_b32 v2, 1
    s_mov_b64 exec, 1
    ds_add_rtn_u32 v1, v228, v2 offset:0
    s_waitcnt lgkmcnt(0)
    v_readfirstlane_b32 s39, v1
    s_nop 0
    s_cmp_eq_u32 s39, 3
    s_cbranch_scc0 L_jo_39a
    s_mov_b64 exec, 0xffff
    v_lshlrev_b32 v1, 8, v0
    buffer_atomic_add v2, v1, s[52:55], s56 offen sc1
L_jo_39a:
    s_mov_b64 exec, -1
    s_setprio 0
    s_add_u32 m0, s60, 24576
    s_add_u32 s63, s62, 393216
    s_and_b32 s63, s63, 0x1fffff
    buffer_load_dwordx4 v227, s[44:47], s63 offen lds
    s_add_u32 m0, s60, 25600
    s_add_u32 s63, s62, 409600
    s_and_b32 s63, s63, 0x1fffff
    buffer_load_dwordx4 v227, s[44:47], s63 offen lds
    s_add_u32 m0, s60, 32768
    s_add_u32 s63, s62, 524288
    s_and_b32 s63, s63, 0x1fffff
    buffer_load_dwordx4 v227, s[44:47], s63 offen lds
    s_add_u32 m0, s60, 33792
    s_add_u32 s63, s62, 540672
    s_and_b32 s63, s63, 0x1fffff
    buffer_load_dwordx4 v227, s[44:47], s63 offen lds
    s_add_u32 m0, s60, 83968
    s_add_u32 s63, s62, 655360
    s_and_b32 s63, s63, 0x1fffff
    buffer_load_dwordx4 v227, s[44:47], s63 offen lds
    s_add_u32 m0, s60, 84992
    s_add_u32 s63, s62, 671744
    s_and_b32 s63, s63, 0x1fffff
    buffer_load_dwordx4 v227, s[44:47], s63 offen lds
    s_add_u32 m0, s60, 92160
    s_add_u32 s63, s62, 786432
    s_and_b32 s63, s63, 0x1fffff
    buffer_load_dwordx4 v227, s[44:47], s63 offen lds
    s_add_u32 m0, s60, 93184
    s_add_u32 s63, s62, 802816
    s_and_b32 s63, s63, 0x1fffff
    buffer_load_dwordx4 v227, s[44:47], s63 offen lds
    s_add_u32 m0, s60, 100352
    s_add_u32 s63, s62, 917504
    s_and_b32 s63, s63, 0x1fffff
    buffer_load_dwordx4 v227, s[44:47], s63 offen lds
    s_add_u32 m0, s60, 101376
    s_add_u32 s63, s62, 933888
    s_and_b32 s63, s63, 0x1fffff
    buffer_load_dwordx4 v227, s[44:47], s63 offen lds
    s_add_u32 m0, s60, 108544
    s_add_u32 s63, s62, 1048576
    s_and_b32 s63, s63, 0x1fffff
    buffer_load_dwordx4 v227, s[44:47], s63 offen lds
    s_add_u32 m0, s60, 109568
    s_add_u32 s63, s62, 1064960
    s_and_b32 s63, s63, 0x1fffff
    buffer_load_dwordx4 v227, s[44:47], s63 offen lds
    s_add_u32 m0, s60, 116736
    s_add_u32 s63, s62, 1179648
    s_and_b32 s63, s63, 0x1fffff
    buffer_load_dwordx4 v227, s[44:47], s63 offen lds
    s_add_u32 m0, s60, 117760
    s_add_u32 s63, s62, 1196032
    s_and_b32 s63, s63, 0x1fffff
    buffer_load_dwordx4 v227, s[44:47], s63 offen lds
    s_setprio 0
    s_cmp_eq_u32 s39, 3
    s_cbranch_scc0 L_jo_39
    s_mov_b32 s38, 131072
L_sg_loop_42:
    s_load_dword s37, s[52:53], s57 glc
L_sg_chk_43:
    s_waitcnt lgkmcnt(0)
    s_cmp_ge_u32 s37, 16
    s_cbranch_scc1 L_sg_done_41
    s_sub_u32 s38, s38, 1
    s_cbranch_scc0 L_sg_loop_42
L_sg_done_41:
    v_mov_b32 v1, 16
    s_mov_b64 exec, 1
    ds_add_u32 v228, v1 offset:4
    s_mov_b64 exec, -1
L_jo_39:
    s_waitcnt vmcnt(0)
    s_mov_b64 exec, 1
    ds_add_u32 v228, v2 offset:4
    s_mov_b64 exec, -1
    s_mov_b32 s38, 1048576
L_sl_loop_45:
    ds_read_b32 v1, v228 offset:4
    s_waitcnt lgkmcnt(0)
    v_readfirstlane_b32 s37, v1
    s_nop 0
    s_cmp_ge_u32 s37, 20
    s_cbranch_scc1 L_sl_done_44
    s_sleep 1
    s_sub_u32 s38, s38, 1
    s_cbranch_scc0 L_sl_loop_45
L_sl_done_44:
L_jd_40:
    buffer_load_dwordx4 v[84:87], v224, s[40:43], s64 offen offset:0 sc1
    buffer_load_dwordx4 v[88:91], v225, s[40:43], s64 offen offset:0 sc1
    ds_read_b64_tr_b16 v[36:37], v72 offset:0
    ds_read_b64_tr_b16 v[38:39], v72 offset:2048
    buffer_load_dwordx4 v[92:95], v224, s[40:43], s64 offen offset:1024 sc1
    buffer_load_dwordx4 v[96:99], v225, s[40:43], s64 offen offset:1024 sc1
    ds_read_b64_tr_b16 v[40:41], v73 offset:0
    ds_read_b64_tr_b16 v[42:43], v73 offset:2048
    buffer_load_dwordx4 v[100:103], v224, s[40:43], s64 offen offset:2048 sc1
    buffer_load_dwordx4 v[104:107], v225, s[40:43], s64 offen offset:2048 sc1
    ds_read_b64_tr_b16 v[44:45], v74 offset:0
    ds_read_b64_tr_b16 v[46:47], v74 offset:2048
    buffer_load_dwordx4 v[108:111], v224, s[40:43], s64 offen offset:3072 sc1
    buffer_load_dwordx4 v[112:115], v225, s[40:43], s64 offen offset:3072 sc1
    ds_read_b64_tr_b16 v[48:49], v75 offset:0
    ds_read_b64_tr_b16 v[50:51], v75 offset:2048
    buffer_load_dwordx4 v[116:119], v224, s[40:43], s65 offen offset:0 sc1
    buffer_load_dwordx4 v[120:123], v225, s[40:43], s65 offen offset:0 sc1
    ds_read_b64_tr_b16 v[52:53], v72 offset:4096
    ds_read_b64_tr_b16 v[54:55], v72 offset:6144
    buffer_load_dwordx4 v[124:127], v224, s[40:43], s65 offen offset:1024 sc1
    buffer_load_dwordx4 v[128:131], v225, s[40:43], s65 offen offset:1024 sc1
    ds_read_b64_tr_b16 v[56:57], v73 offset:4096
    ds_read_b64_tr_b16 v[58:59], v73 offset:6144
    buffer_load_dwordx4 v[132:135], v224, s[40:43], s65 offen offset:2048 sc1
    buffer_load_dwordx4 v[136:139], v225, s[40:43], s65 offen offset:2048 sc1
    ds_read_b64_tr_b16 v[60:61], v74 offset:4096
    ds_read_b64_tr_b16 v[62:63], v74 offset:6144
    buffer_load_dwordx4 v[140:143], v224, s[40:43], s65 offen offset:3072 sc1
    buffer_load_dwordx4 v[144:147], v225, s[40:43], s65 offen offset:3072 sc1
    s_waitcnt lgkmcnt(12)
    ds_read_b64_tr_b16 v[64:65], v75 offset:4096
    ds_read_b64_tr_b16 v[66:67], v75 offset:6144
    s_waitcnt vmcnt(14) lgkmcnt(8)
    v_mfma_f32_16x16x32_bf16 v[4:7], v[36:39], v[84:87], 0
    ds_read_b64_tr_b16 v[68:69], v72 offset:8192
    v_mfma_f32_16x16x32_bf16 v[20:23], v[36:39], v[88:91], 0
    ds_read_b64_tr_b16 v[70:71], v72 offset:10240
    v_mfma_f32_16x16x32_bf16 v[8:11], v[40:43], v[84:87], 0
    ds_read_b64_tr_b16 v[36:37], v73 offset:8192
    v_mfma_f32_16x16x32_bf16 v[24:27], v[40:43], v[88:91], 0
    ds_read_b64_tr_b16 v[38:39], v73 offset:10240
    buffer_load_dwordx4 v[148:151], v224, s[40:43], s66 offen offset:0 sc1
    v_mfma_f32_16x16x32_bf16 v[12:15], v[44:47], v[84:87], 0
    ds_read_b64_tr_b16 v[40:41], v74 offset:8192
    v_mfma_f32_16x16x32_bf16 v[28:31], v[44:47], v[88:91], 0
    ds_read_b64_tr_b16 v[42:43], v74 offset:10240
    v_mfma_f32_16x16x32_bf16 v[16:19], v[48:51], v[84:87], 0
    ds_read_b64_tr_b16 v[44:45], v75 offset:8192
    v_mfma_f32_16x16x32_bf16 v[32:35], v[48:51], v[88:91], 0
    ds_read_b64_tr_b16 v[46:47], v75 offset:10240
    buffer_load_dwordx4 v[152:155], v225, s[40:43], s66 offen offset:0 sc1
    s_waitcnt vmcnt(14) lgkmcnt(8)
    v_mfma_f32_16x16x32_bf16 v[4:7], v[52:55], v[92:95], v[4:7]
    ds_read_b64_tr_b16 v[48:49], v72 offset:12288
    v_mfma_f32_16x16x32_bf16 v[20:23], v[52:55], v[96:99], v[20:23]
    ds_read_b64_tr_b16 v[50:51], v72 offset:14336
    v_mfma_f32_16x16x32_bf16 v[8:11], v[56:59], v[92:95], v[8:11]
    ds_read_b64_tr_b16 v[52:53], v73 offset:12288
    v_mfma_f32_16x16x32_bf16 v[24:27], v[56:59], v[96:99], v[24:27]
    ds_read_b64_tr_b16 v[54:55], v73 offset:14336
    buffer_load_dwordx4 v[84:87], v224, s[40:43], s66 offen offset:1024 sc1
    v_mfma_f32_16x16x32_bf16 v[12:15], v[60:63], v[92:95], v[12:15]
    ds_read_b64_tr_b16 v[56:57], v74 offset:12288
    v_mfma_f32_16x16x32_bf16 v[28:31], v[60:63], v[96:99], v[28:31]
    ds_read_b64_tr_b16 v[58:59], v74 offset:14336
    v_mfma_f32_16x16x32_bf16 v[16:19], v[64:67], v[92:95], v[16:19]
    ds_read_b64_tr_b16 v[60:61], v75 offset:12288
    v_mfma_f32_16x16x32_bf16 v[32:35], v[64:67], v[96:99], v[32:35]
    ds_read_b64_tr_b16 v[62:63], v75 offset:14336
    buffer_load_dwordx4 v[88:91], v225, s[40:43], s66 offen offset:1024 sc1
    s_waitcnt vmcnt(14) lgkmcnt(8)
    v_mfma_f32_16x16x32_bf16 v[4:7], v[68:71], v[100:103], v[4:7]
    ds_read_b64_tr_b16 v[64:65], v72 offset:16384
    v_mfma_f32_16x16x32_bf16 v[20:23], v[68:71], v[104:107], v[20:23]
    ds_read_b64_tr_b16 v[66:67], v72 offset:18432
    v_mfma_f32_16x16x32_bf16 v[8:11], v[36:39], v[100:103], v[8:11]
    ds_read_b64_tr_b16 v[68:69], v73 offset:16384
    v_mfma_f32_16x16x32_bf16 v[24:27], v[36:39], v[104:107], v[24:27]
    ds_read_b64_tr_b16 v[70:71], v73 offset:18432
    buffer_load_dwordx4 v[92:95], v224, s[40:43], s66 offen offset:2048 sc1
    v_mfma_f32_16x16x32_bf16 v[12:15], v[40:43], v[100:103], v[12:15]
    ds_read_b64_tr_b16 v[36:37], v74 offset:16384
    v_mfma_f32_16x16x32_bf16 v[28:31], v[40:43], v[104:107], v[28:31]
    ds_read_b64_tr_b16 v[38:39], v74 offset:18432
    v_mfma_f32_16x16x32_bf16 v[16:19], v[44:47], v[100:103], v[16:19]
    ds_read_b64_tr_b16 v[40:41], v75 offset:16384
    v_mfma_f32_16x16x32_bf16 v[32:35], v[44:47], v[104:107], v[32:35]
    ds_read_b64_tr_b16 v[42:43], v75 offset:18432
    buffer_load_dwordx4 v[96:99], v225, s[40:43], s66 offen offset:2048 sc1
    s_waitcnt vmcnt(14) lgkmcnt(8)
    v_mfma_f32_16x16x32_bf16 v[4:7], v[48:51], v[108:111], v[4:7]
    ds_read_b64_tr_b16 v[44:45], v72 offset:20480
    v_mfma_f32_16x16x32_bf16 v[20:23], v[48:51], v[112:115], v[20:23]
    ds_read_b64_tr_b16 v[46:47], v72 offset:22528
    v_mfma_f32_16x16x32_bf16 v[8:11], v[52:55], v[108:111], v[8:11]
    ds_read_b64_tr_b16 v[48:49], v73 offset:20480
    v_mfma_f32_16x16x32_bf16 v[24:27], v[52:55], v[112:115], v[24:27]
    ds_read_b64_tr_b16 v[50:51], v73 offset:22528
    buffer_load_dwordx4 v[100:103], v224, s[40:43], s66 offen offset:3072 sc1
    v_mfma_f32_16x16x32_bf16 v[12:15], v[56:59], v[108:111], v[12:15]
    ds_read_b64_tr_b16 v[52:53], v74 offset:20480
    v_mfma_f32_16x16x32_bf16 v[28:31], v[56:59], v[112:115], v[28:31]
    ds_read_b64_tr_b16 v[54:55], v74 offset:22528
    v_mfma_f32_16x16x32_bf16 v[16:19], v[60:63], v[108:111], v[16:19]
    ds_read_b64_tr_b16 v[56:57], v75 offset:20480
    v_mfma_f32_16x16x32_bf16 v[32:35], v[60:63], v[112:115], v[32:35]
    ds_read_b64_tr_b16 v[58:59], v75 offset:22528
    buffer_load_dwordx4 v[104:107], v225, s[40:43], s66 offen offset:3072 sc1
    s_waitcnt vmcnt(14) lgkmcnt(8)
    v_mfma_f32_16x16x32_bf16 v[4:7], v[64:67], v[116:119], v[4:7]
    ds_read_b64_tr_b16 v[60:61], v72 offset:24576
    v_mfma_f32_16x16x32_bf16 v[20:23], v[64:67], v[120:123], v[20:23]
    ds_read_b64_tr_b16 v[62:63], v72 offset:26624
    v_mfma_f32_16x16x32_bf16 v[8:11], v[68:71], v[116:119], v[8:11]
    ds_read_b64_tr_b16 v[64:65], v73 offset:24576
    v_mfma_f32_16x16x32_bf16 v[24:27], v[68:71], v[120:123], v[24:27]
    ds_read_b64_tr_b16 v[66:67], v73 offset:26624
    buffer_load_dwordx4 v[108:111], v224, s[40:43], s67 offen offset:0 sc1
    v_mfma_f32_16x16x32_bf16 v[12:15], v[36:39], v[116:119], v[12:15]
    ds_read_b64_tr_b16 v[68:69], v74 offset:24576
    v_mfma_f32_16x16x32_bf16 v[28:31], v[36:39], v[120:123], v[28:31]
    ds_read_b64_tr_b16 v[70:71], v74 offset:26624
    v_mfma_f32_16x16x32_bf16 v[16:19], v[40:43], v[116:119], v[16:19]
    ds_read_b64_tr_b16 v[36:37], v75 offset:24576
    v_mfma_f32_16x16x32_bf16 v[32:35], v[40:43], v[120:123], v[32:35]
    ds_read_b64_tr_b16 v[38:39], v75 offset:26624
    buffer_load_dwordx4 v[112:115], v225, s[40:43], s67 offen offset:0 sc1
    s_waitcnt vmcnt(14) lgkmcnt(8)
    v_mfma_f32_16x16x32_bf16 v[4:7], v[44:47], v[124:127], v[4:7]
    ds_read_b64_tr_b16 v[40:41], v72 offset:28672
    v_mfma_f32_16x16x32_bf16 v[20:23], v[44:47], v[128:131], v[20:23]
    ds_read_b64_tr_b16 v[42:43], v72 offset:30720
    v_mfma_f32_16x16x32_bf16 v[8:11], v[48:51], v[124:127], v[8:11]
    ds_read_b64_tr_b16 v[44:45], v73 offset:28672
    v_mfma_f32_16x16x32_bf16 v[24:27], v[48:51], v[128:131], v[24:27]
    ds_read_b64_tr_b16 v[46:47], v73 offset:30720
    buffer_load_dwordx4 v[116:119], v224, s[40:43], s67 offen offset:1024 sc1
    v_mfma_f32_16x16x32_bf16 v[12:15], v[52:55], v[124:127], v[12:15]
    ds_read_b64_tr_b16 v[48:49], v74 offset:28672
    v_mfma_f32_16x16x32_bf16 v[28:31], v[52:55], v[128:131], v[28:31]
    ds_read_b64_tr_b16 v[50:51], v74 offset:30720
    v_mfma_f32_16x16x32_bf16 v[16:19], v[56:59], v[124:127], v[16:19]
    ds_read_b64_tr_b16 v[52:53], v75 offset:28672
    v_mfma_f32_16x16x32_bf16 v[32:35], v[56:59], v[128:131], v[32:35]
    ds_read_b64_tr_b16 v[54:55], v75 offset:30720
    buffer_load_dwordx4 v[120:123], v225, s[40:43], s67 offen offset:1024 sc1
    s_waitcnt vmcnt(14) lgkmcnt(8)
    v_mfma_f32_16x16x32_bf16 v[4:7], v[60:63], v[132:135], v[4:7]
    ds_read_b64_tr_b16 v[56:57], v72 offset:32768
    v_mfma_f32_16x16x32_bf16 v[20:23], v[60:63], v[136:139], v[20:23]
    ds_read_b64_tr_b16 v[58:59], v72 offset:34816
    v_mfma_f32_16x16x32_bf16 v[8:11], v[64:67], v[132:135], v[8:11]
    ds_read_b64_tr_b16 v[60:61], v73 offset:32768
    v_mfma_f32_16x16x32_bf16 v[24:27], v[64:67], v[136:139], v[24:27]
    ds_read_b64_tr_b16 v[62:63], v73 offset:34816
    buffer_load_dwordx4 v[124:127], v224, s[40:43], s67 offen offset:2048 sc1
    v_mfma_f32_16x16x32_bf16 v[12:15], v[68:71], v[132:135], v[12:15]
    ds_read_b64_tr_b16 v[64:65], v74 offset:32768
    v_mfma_f32_16x16x32_bf16 v[28:31], v[68:71], v[136:139], v[28:31]
    ds_read_b64_tr_b16 v[66:67], v74 offset:34816
    v_mfma_f32_16x16x32_bf16 v[16:19], v[36:39], v[132:135], v[16:19]
    ds_read_b64_tr_b16 v[68:69], v75 offset:32768
    v_mfma_f32_16x16x32_bf16 v[32:35], v[36:39], v[136:139], v[32:35]
    ds_read_b64_tr_b16 v[70:71], v75 offset:34816
    buffer_load_dwordx4 v[128:131], v225, s[40:43], s67 offen offset:2048 sc1
    s_waitcnt vmcnt(14) lgkmcnt(8)
    v_mfma_f32_16x16x32_bf16 v[4:7], v[40:43], v[140:143], v[4:7]
    ds_read_b64_tr_b16 v[36:37], v72 offset:36864
    v_mfma_f32_16x16x32_bf16 v[20:23], v[40:43], v[144:147], v[20:23]
    ds_read_b64_tr_b16 v[38:39], v72 offset:38912
    v_mfma_f32_16x16x32_bf16 v[8:11], v[44:47], v[140:143], v[8:11]
    ds_read_b64_tr_b16 v[40:41], v73 offset:36864
    v_mfma_f32_16x16x32_bf16 v[24:27], v[44:47], v[144:147], v[24:27]
    ds_read_b64_tr_b16 v[42:43], v73 offset:38912
    buffer_load_dwordx4 v[132:135], v224, s[40:43], s67 offen offset:3072 sc1
    v_mfma_f32_16x16x32_bf16 v[12:15], v[48:51], v[140:143], v[12:15]
    ds_read_b64_tr_b16 v[44:45], v74 offset:36864
    v_mfma_f32_16x16x32_bf16 v[28:31], v[48:51], v[144:147], v[28:31]
    ds_read_b64_tr_b16 v[46:47], v74 offset:38912
    v_mfma_f32_16x16x32_bf16 v[16:19], v[52:55], v[140:143], v[16:19]
    ds_read_b64_tr_b16 v[48:49], v75 offset:36864
    v_mfma_f32_16x16x32_bf16 v[32:35], v[52:55], v[144:147], v[32:35]
    ds_read_b64_tr_b16 v[50:51], v75 offset:38912
    buffer_load_dwordx4 v[136:139], v225, s[40:43], s67 offen offset:3072 sc1
    s_waitcnt vmcnt(14) lgkmcnt(8)
    v_mfma_f32_16x16x32_bf16 v[4:7], v[56:59], v[148:151], v[4:7]
    ds_read_b64_tr_b16 v[52:53], v76 offset:0
    v_mfma_f32_16x16x32_bf16 v[20:23], v[56:59], v[152:155], v[20:23]
    ds_read_b64_tr_b16 v[54:55], v76 offset:2048
    v_mfma_f32_16x16x32_bf16 v[8:11], v[60:63], v[148:151], v[8:11]
    ds_read_b64_tr_b16 v[56:57], v77 offset:0
    v_mfma_f32_16x16x32_bf16 v[24:27], v[60:63], v[152:155], v[24:27]
    ds_read_b64_tr_b16 v[58:59], v77 offset:2048
    buffer_load_dwordx4 v[140:143], v224, s[40:43], s68 offen offset:0 sc1
    v_mfma_f32_16x16x32_bf16 v[12:15], v[64:67], v[148:151], v[12:15]
    ds_read_b64_tr_b16 v[60:61], v78 offset:0
    v_mfma_f32_16x16x32_bf16 v[28:31], v[64:67], v[152:155], v[28:31]
    ds_read_b64_tr_b16 v[62:63], v78 offset:2048
    v_mfma_f32_16x16x32_bf16 v[16:19], v[68:71], v[148:151], v[16:19]
    ds_read_b64_tr_b16 v[64:65], v79 offset:0
    v_mfma_f32_16x16x32_bf16 v[32:35], v[68:71], v[152:155], v[32:35]
    ds_read_b64_tr_b16 v[66:67], v79 offset:2048
    buffer_load_dwordx4 v[144:147], v225, s[40:43], s68 offen offset:0 sc1
    s_waitcnt vmcnt(14) lgkmcnt(8)
    v_mfma_f32_16x16x32_bf16 v[4:7], v[36:39], v[84:87], v[4:7]
    ds_read_b64_tr_b16 v[68:69], v76 offset:4096
    v_mfma_f32_16x16x32_bf16 v[20:23], v[36:39], v[88:91], v[20:23]
    ds_read_b64_tr_b16 v[70:71], v76 offset:6144
    v_mfma_f32_16x16x32_bf16 v[8:11], v[40:43], v[84:87], v[8:11]
    ds_read_b64_tr_b16 v[36:37], v77 offset:4096
    v_mfma_f32_16x16x32_bf16 v[24:27], v[40:43], v[88:91], v[24:27]
    ds_read_b64_tr_b16 v[38:39], v77 offset:6144
    buffer_load_dwordx4 v[148:151], v224, s[40:43], s68 offen offset:1024 sc1
    v_mfma_f32_16x16x32_bf16 v[12:15], v[44:47], v[84:87], v[12:15]
    ds_read_b64_tr_b16 v[40:41], v78 offset:4096
    v_mfma_f32_16x16x32_bf16 v[28:31], v[44:47], v[88:91], v[28:31]
    ds_read_b64_tr_b16 v[42:43], v78 offset:6144
    v_mfma_f32_16x16x32_bf16 v[16:19], v[48:51], v[84:87], v[16:19]
    ds_read_b64_tr_b16 v[44:45], v79 offset:4096
    v_mfma_f32_16x16x32_bf16 v[32:35], v[48:51], v[88:91], v[32:35]
    ds_read_b64_tr_b16 v[46:47], v79 offset:6144
    buffer_load_dwordx4 v[152:155], v225, s[40:43], s68 offen offset:1024 sc1
    s_waitcnt vmcnt(14) lgkmcnt(8)
    v_mfma_f32_16x16x32_bf16 v[4:7], v[52:55], v[92:95], v[4:7]
    ds_read_b64_tr_b16 v[48:49], v76 offset:8192
    v_mfma_f32_16x16x32_bf16 v[20:23], v[52:55], v[96:99], v[20:23]
    ds_read_b64_tr_b16 v[50:51], v76 offset:10240
    v_mfma_f32_16x16x32_bf16 v[8:11], v[56:59], v[92:95], v[8:11]
    ds_read_b64_tr_b16 v[52:53], v77 offset:8192
    v_mfma_f32_16x16x32_bf16 v[24:27], v[56:59], v[96:99], v[24:27]
    ds_read_b64_tr_b16 v[54:55], v77 offset:10240
    buffer_load_dwordx4 v[84:87], v224, s[40:43], s68 offen offset:2048 sc1
    v_mfma_f32_16x16x32_bf16 v[12:15], v[60:63], v[92:95], v[12:15]
    ds_read_b64_tr_b16 v[56:57], v78 offset:8192
    v_mfma_f32_16x16x32_bf16 v[28:31], v[60:63], v[96:99], v[28:31]
    ds_read_b64_tr_b16 v[58:59], v78 offset:10240
    v_mfma_f32_16x16x32_bf16 v[16:19], v[64:67], v[92:95], v[16:19]
    ds_read_b64_tr_b16 v[60:61], v79 offset:8192
    v_mfma_f32_16x16x32_bf16 v[32:35], v[64:67], v[96:99], v[32:35]
    ds_read_b64_tr_b16 v[62:63], v79 offset:10240
    buffer_load_dwordx4 v[88:91], v225, s[40:43], s68 offen offset:2048 sc1
    s_waitcnt vmcnt(14) lgkmcnt(8)
    v_mfma_f32_16x16x32_bf16 v[4:7], v[68:71], v[100:103], v[4:7]
    ds_read_b64_tr_b16 v[64:65], v76 offset:12288
    v_mfma_f32_16x16x32_bf16 v[20:23], v[68:71], v[104:107], v[20:23]
    ds_read_b64_tr_b16 v[66:67], v76 offset:14336
    v_mfma_f32_16x16x32_bf16 v[8:11], v[36:39], v[100:103], v[8:11]
    ds_read_b64_tr_b16 v[68:69], v77 offset:12288
    v_mfma_f32_16x16x32_bf16 v[24:27], v[36:39], v[104:107], v[24:27]
    ds_read_b64_tr_b16 v[70:71], v77 offset:14336
    buffer_load_dwordx4 v[92:95], v224, s[40:43], s68 offen offset:3072 sc1
    v_mfma_f32_16x16x32_bf16 v[12:15], v[40:43], v[100:103], v[12:15]
    ds_read_b64_tr_b16 v[36:37], v78 offset:12288
    v_mfma_f32_16x16x32_bf16 v[28:31], v[40:43], v[104:107], v[28:31]
    ds_read_b64_tr_b16 v[38:39], v78 offset:14336
    v_mfma_f32_16x16x32_bf16 v[16:19], v[44:47], v[100:103], v[16:19]
    ds_read_b64_tr_b16 v[40:41], v79 offset:12288
    v_mfma_f32_16x16x32_bf16 v[32:35], v[44:47], v[104:107], v[32:35]
    ds_read_b64_tr_b16 v[42:43], v79 offset:14336
    buffer_load_dwordx4 v[96:99], v225, s[40:43], s68 offen offset:3072 sc1
    s_waitcnt vmcnt(14) lgkmcnt(8)
    v_mfma_f32_16x16x32_bf16 v[4:7], v[48:51], v[108:111], v[4:7]
    ds_read_b64_tr_b16 v[44:45], v76 offset:16384
    v_mfma_f32_16x16x32_bf16 v[20:23], v[48:51], v[112:115], v[20:23]
    ds_read_b64_tr_b16 v[46:47], v76 offset:18432
    v_mfma_f32_16x16x32_bf16 v[8:11], v[52:55], v[108:111], v[8:11]
    ds_read_b64_tr_b16 v[48:49], v77 offset:16384
    v_mfma_f32_16x16x32_bf16 v[24:27], v[52:55], v[112:115], v[24:27]
    ds_read_b64_tr_b16 v[50:51], v77 offset:18432
    buffer_load_dwordx4 v[100:103], v224, s[40:43], s69 offen offset:0 sc1
    v_mfma_f32_16x16x32_bf16 v[12:15], v[56:59], v[108:111], v[12:15]
    ds_read_b64_tr_b16 v[52:53], v78 offset:16384
    v_mfma_f32_16x16x32_bf16 v[28:31], v[56:59], v[112:115], v[28:31]
    ds_read_b64_tr_b16 v[54:55], v78 offset:18432
    v_mfma_f32_16x16x32_bf16 v[16:19], v[60:63], v[108:111], v[16:19]
    ds_read_b64_tr_b16 v[56:57], v79 offset:16384
    v_mfma_f32_16x16x32_bf16 v[32:35], v[60:63], v[112:115], v[32:35]
    ds_read_b64_tr_b16 v[58:59], v79 offset:18432
    buffer_load_dwordx4 v[104:107], v225, s[40:43], s69 offen offset:0 sc1
    s_waitcnt vmcnt(14) lgkmcnt(8)
    v_mfma_f32_16x16x32_bf16 v[4:7], v[64:67], v[116:119], v[4:7]
    ds_read_b64_tr_b16 v[60:61], v76 offset:20480
    v_mfma_f32_16x16x32_bf16 v[20:23], v[64:67], v[120:123], v[20:23]
    ds_read_b64_tr_b16 v[62:63], v76 offset:22528
    v_mfma_f32_16x16x32_bf16 v[8:11], v[68:71], v[116:119], v[8:11]
    ds_read_b64_tr_b16 v[64:65], v77 offset:20480
    v_mfma_f32_16x16x32_bf16 v[24:27], v[68:71], v[120:123], v[24:27]
    ds_read_b64_tr_b16 v[66:67], v77 offset:22528
    buffer_load_dwordx4 v[108:111], v224, s[40:43], s69 offen offset:1024 sc1
    v_mfma_f32_16x16x32_bf16 v[12:15], v[36:39], v[116:119], v[12:15]
    ds_read_b64_tr_b16 v[68:69], v78 offset:20480
    v_mfma_f32_16x16x32_bf16 v[28:31], v[36:39], v[120:123], v[28:31]
    ds_read_b64_tr_b16 v[70:71], v78 offset:22528
    v_mfma_f32_16x16x32_bf16 v[16:19], v[40:43], v[116:119], v[16:19]
    ds_read_b64_tr_b16 v[36:37], v79 offset:20480
    v_mfma_f32_16x16x32_bf16 v[32:35], v[40:43], v[120:123], v[32:35]
    ds_read_b64_tr_b16 v[38:39], v79 offset:22528
    buffer_load_dwordx4 v[112:115], v225, s[40:43], s69 offen offset:1024 sc1
    s_waitcnt vmcnt(14) lgkmcnt(8)
    v_mfma_f32_16x16x32_bf16 v[4:7], v[44:47], v[124:127], v[4:7]
    ds_read_b64_tr_b16 v[40:41], v76 offset:24576
    v_mfma_f32_16x16x32_bf16 v[20:23], v[44:47], v[128:131], v[20:23]
    ds_read_b64_tr_b16 v[42:43], v76 offset:26624
    v_mfma_f32_16x16x32_bf16 v[8:11], v[48:51], v[124:127], v[8:11]
    ds_read_b64_tr_b16 v[44:45], v77 offset:24576
    v_mfma_f32_16x16x32_bf16 v[24:27], v[48:51], v[128:131], v[24:27]
    ds_read_b64_tr_b16 v[46:47], v77 offset:26624
    buffer_load_dwordx4 v[116:119], v224, s[40:43], s69 offen offset:2048 sc1
    v_mfma_f32_16x16x32_bf16 v[12:15], v[52:55], v[124:127], v[12:15]
    ds_read_b64_tr_b16 v[48:49], v78 offset:24576
    v_mfma_f32_16x16x32_bf16 v[28:31], v[52:55], v[128:131], v[28:31]
    ds_read_b64_tr_b16 v[50:51], v78 offset:26624
    v_mfma_f32_16x16x32_bf16 v[16:19], v[56:59], v[124:127], v[16:19]
    ds_read_b64_tr_b16 v[52:53], v79 offset:24576
    v_mfma_f32_16x16x32_bf16 v[32:35], v[56:59], v[128:131], v[32:35]
    ds_read_b64_tr_b16 v[54:55], v79 offset:26624
    buffer_load_dwordx4 v[120:123], v225, s[40:43], s69 offen offset:2048 sc1
    s_waitcnt vmcnt(14) lgkmcnt(8)
    v_mfma_f32_16x16x32_bf16 v[4:7], v[60:63], v[132:135], v[4:7]
    ds_read_b64_tr_b16 v[56:57], v76 offset:28672
    v_mfma_f32_16x16x32_bf16 v[20:23], v[60:63], v[136:139], v[20:23]
    ds_read_b64_tr_b16 v[58:59], v76 offset:30720
    v_mfma_f32_16x16x32_bf16 v[8:11], v[64:67], v[132:135], v[8:11]
    ds_read_b64_tr_b16 v[60:61], v77 offset:28672
    v_mfma_f32_16x16x32_bf16 v[24:27], v[64:67], v[136:139], v[24:27]
    ds_read_b64_tr_b16 v[62:63], v77 offset:30720
    buffer_load_dwordx4 v[124:127], v224, s[40:43], s69 offen offset:3072 sc1
    v_mfma_f32_16x16x32_bf16 v[12:15], v[68:71], v[132:135], v[12:15]
    ds_read_b64_tr_b16 v[64:65], v78 offset:28672
    v_mfma_f32_16x16x32_bf16 v[28:31], v[68:71], v[136:139], v[28:31]
    ds_read_b64_tr_b16 v[66:67], v78 offset:30720
    v_mfma_f32_16x16x32_bf16 v[16:19], v[36:39], v[132:135], v[16:19]
    ds_read_b64_tr_b16 v[68:69], v79 offset:28672
    v_mfma_f32_16x16x32_bf16 v[32:35], v[36:39], v[136:139], v[32:35]
    ds_read_b64_tr_b16 v[70:71], v79 offset:30720
    buffer_load_dwordx4 v[128:131], v225, s[40:43], s69 offen offset:3072 sc1
    s_waitcnt vmcnt(14) lgkmcnt(8)
    v_mfma_f32_16x16x32_bf16 v[4:7], v[40:43], v[140:143], v[4:7]
    ds_read_b64_tr_b16 v[36:37], v76 offset:32768
    v_mfma_f32_16x16x32_bf16 v[20:23], v[40:43], v[144:147], v[20:23]
    ds_read_b64_tr_b16 v[38:39], v76 offset:34816
    v_mfma_f32_16x16x32_bf16 v[8:11], v[44:47], v[140:143], v[8:11]
    ds_read_b64_tr_b16 v[40:41], v77 offset:32768
    v_mfma_f32_16x16x32_bf16 v[24:27], v[44:47], v[144:147], v[24:27]
    ds_read_b64_tr_b16 v[42:43], v77 offset:34816
    buffer_load_dwordx4 v[132:135], v224, s[40:43], s70 offen offset:0 sc1
    v_mfma_f32_16x16x32_bf16 v[12:15], v[48:51], v[140:143], v[12:15]
    ds_read_b64_tr_b16 v[44:45], v78 offset:32768
    v_mfma_f32_16x16x32_bf16 v[28:31], v[48:51], v[144:147], v[28:31]
    ds_read_b64_tr_b16 v[46:47], v78 offset:34816
    v_mfma_f32_16x16x32_bf16 v[16:19], v[52:55], v[140:143], v[16:19]
    ds_read_b64_tr_b16 v[48:49], v79 offset:32768
    v_mfma_f32_16x16x32_bf16 v[32:35], v[52:55], v[144:147], v[32:35]
    ds_read_b64_tr_b16 v[50:51], v79 offset:34816
    buffer_load_dwordx4 v[136:139], v225, s[40:43], s70 offen offset:0 sc1
    ds_read_b32 v1, v228 offset:12
    s_waitcnt vmcnt(14) lgkmcnt(9)
    v_mfma_f32_16x16x32_bf16 v[4:7], v[56:59], v[148:151], v[4:7]
    ds_read_b64_tr_b16 v[52:53], v76 offset:36864
    v_mfma_f32_16x16x32_bf16 v[20:23], v[56:59], v[152:155], v[20:23]
    ds_read_b64_tr_b16 v[54:55], v76 offset:38912
    v_mfma_f32_16x16x32_bf16 v[8:11], v[60:63], v[148:151], v[8:11]
    ds_read_b64_tr_b16 v[56:57], v77 offset:36864
    v_mfma_f32_16x16x32_bf16 v[24:27], v[60:63], v[152:155], v[24:27]
    ds_read_b64_tr_b16 v[58:59], v77 offset:38912
    buffer_load_dwordx4 v[140:143], v224, s[40:43], s70 offen offset:1024 sc1
    v_mfma_f32_16x16x32_bf16 v[12:15], v[64:67], v[148:151], v[12:15]
    ds_read_b64_tr_b16 v[60:61], v78 offset:36864
    v_mfma_f32_16x16x32_bf16 v[28:31], v[64:67], v[152:155], v[28:31]
    ds_read_b64_tr_b16 v[62:63], v78 offset:38912
    v_mfma_f32_16x16x32_bf16 v[16:19], v[68:71], v[148:151], v[16:19]
    ds_read_b64_tr_b16 v[64:65], v79 offset:36864
    v_mfma_f32_16x16x32_bf16 v[32:35], v[68:71], v[152:155], v[32:35]
    ds_read_b64_tr_b16 v[66:67], v79 offset:38912
    buffer_load_dwordx4 v[144:147], v225, s[40:43], s70 offen offset:1024 sc1
    s_waitcnt lgkmcnt(8)
    v_readfirstlane_b32 s37, v1
    s_nop 0
    s_cmp_ge_u32 s37, 4
    s_cbranch_scc1 L_sl_done_46
    s_mov_b32 s38, 1048576
L_sl_loop_47:
    ds_read_b32 v1, v228 offset:12
    s_waitcnt lgkmcnt(0)
    v_readfirstlane_b32 s37, v1
    s_nop 0
    s_cmp_ge_u32 s37, 4
    s_cbranch_scc1 L_sl_done_46
    s_sleep 1
    s_sub_u32 s38, s38, 1
    s_cbranch_scc0 L_sl_loop_47
L_sl_done_46:
    s_waitcnt vmcnt(14)
    v_mfma_f32_16x16x32_bf16 v[4:7], v[36:39], v[84:87], v[4:7]
    ds_read_b64_tr_b16 v[68:69], v80 offset:0
    v_mfma_f32_16x16x32_bf16 v[20:23], v[36:39], v[88:91], v[20:23]
    ds_read_b64_tr_b16 v[70:71], v80 offset:2048
    v_mfma_f32_16x16x32_bf16 v[8:11], v[40:43], v[84:87], v[8:11]
    ds_read_b64_tr_b16 v[36:37], v81 offset:0
    v_mfma_f32_16x16x32_bf16 v[24:27], v[40:43], v[88:91], v[24:27]
    ds_read_b64_tr_b16 v[38:39], v81 offset:2048
    buffer_load_dwordx4 v[148:151], v224, s[40:43], s70 offen offset:2048 sc1
    v_mfma_f32_16x16x32_bf16 v[12:15], v[44:47], v[84:87], v[12:15]
    ds_read_b64_tr_b16 v[40:41], v82 offset:0
    v_mfma_f32_16x16x32_bf16 v[28:31], v[44:47], v[88:91], v[28:31]
    ds_read_b64_tr_b16 v[42:43], v82 offset:2048
    v_mfma_f32_16x16x32_bf16 v[16:19], v[48:51], v[84:87], v[16:19]
    ds_read_b64_tr_b16 v[44:45], v83 offset:0
    v_mfma_f32_16x16x32_bf16 v[32:35], v[48:51], v[88:91], v[32:35]
    ds_read_b64_tr_b16 v[46:47], v83 offset:2048
    buffer_load_dwordx4 v[152:155], v225, s[40:43], s70 offen offset:2048 sc1
    s_waitcnt vmcnt(14) lgkmcnt(8)
    v_mfma_f32_16x16x32_bf16 v[4:7], v[52:55], v[92:95], v[4:7]
    ds_read_b64_tr_b16 v[48:49], v80 offset:4096
    v_mfma_f32_16x16x32_bf16 v[20:23], v[52:55], v[96:99], v[20:23]
    ds_read_b64_tr_b16 v[50:51], v80 offset:6144
    v_mfma_f32_16x16x32_bf16 v[8:11], v[56:59], v[92:95], v[8:11]
    ds_read_b64_tr_b16 v[52:53], v81 offset:4096
    v_mfma_f32_16x16x32_bf16 v[24:27], v[56:59], v[96:99], v[24:27]
    ds_read_b64_tr_b16 v[54:55], v81 offset:6144
    buffer_load_dwordx4 v[84:87], v224, s[40:43], s70 offen offset:3072 sc1
    v_mfma_f32_16x16x32_bf16 v[12:15], v[60:63], v[92:95], v[12:15]
    ds_read_b64_tr_b16 v[56:57], v82 offset:4096
    v_mfma_f32_16x16x32_bf16 v[28:31], v[60:63], v[96:99], v[28:31]
    ds_read_b64_tr_b16 v[58:59], v82 offset:6144
    v_mfma_f32_16x16x32_bf16 v[16:19], v[64:67], v[92:95], v[16:19]
    ds_read_b64_tr_b16 v[60:61], v83 offset:4096
    v_mfma_f32_16x16x32_bf16 v[32:35], v[64:67], v[96:99], v[32:35]
    ds_read_b64_tr_b16 v[62:63], v83 offset:6144
    buffer_load_dwordx4 v[88:91], v225, s[40:43], s70 offen offset:3072 sc1
    s_waitcnt vmcnt(14) lgkmcnt(8)
    v_mfma_f32_16x16x32_bf16 v[4:7], v[68:71], v[100:103], v[4:7]
    ds_read_b64_tr_b16 v[64:65], v80 offset:8448
    v_mfma_f32_16x16x32_bf16 v[20:23], v[68:71], v[104:107], v[20:23]
    ds_read_b64_tr_b16 v[66:67], v80 offset:10496
    v_mfma_f32_16x16x32_bf16 v[8:11], v[36:39], v[100:103], v[8:11]
    ds_read_b64_tr_b16 v[68:69], v81 offset:8448
    v_mfma_f32_16x16x32_bf16 v[24:27], v[36:39], v[104:107], v[24:27]
    ds_read_b64_tr_b16 v[70:71], v81 offset:10496
    buffer_load_dwordx4 v[92:95], v224, s[40:43], s71 offen offset:0 sc1
    v_mfma_f32_16x16x32_bf16 v[12:15], v[40:43], v[100:103], v[12:15]
    ds_read_b64_tr_b16 v[36:37], v82 offset:8448
    v_mfma_f32_16x16x32_bf16 v[28:31], v[40:43], v[104:107], v[28:31]
    ds_read_b64_tr_b16 v[38:39], v82 offset:10496
    v_mfma_f32_16x16x32_bf16 v[16:19], v[44:47], v[100:103], v[16:19]
    ds_read_b64_tr_b16 v[40:41], v83 offset:8448
    v_mfma_f32_16x16x32_bf16 v[32:35], v[44:47], v[104:107], v[32:35]
    ds_read_b64_tr_b16 v[42:43], v83 offset:10496
    buffer_load_dwordx4 v[96:99], v225, s[40:43], s71 offen offset:0 sc1
    s_waitcnt vmcnt(14) lgkmcnt(8)
    v_mfma_f32_16x16x32_bf16 v[4:7], v[48:51], v[108:111], v[4:7]
    ds_read_b64_tr_b16 v[44:45], v80 offset:12544
    v_mfma_f32_16x16x32_bf16 v[20:23], v[48:51], v[112:115], v[20:23]
    ds_read_b64_tr_b16 v[46:47], v80 offset:14592
    v_mfma_f32_16x16x32_bf16 v[8:11], v[52:55], v[108:111], v[8:11]
    ds_read_b64_tr_b16 v[48:49], v81 offset:12544
    v_mfma_f32_16x16x32_bf16 v[24:27], v[52:55], v[112:115], v[24:27]
    ds_read_b64_tr_b16 v[50:51], v81 offset:14592
    buffer_load_dwordx4 v[100:103], v224, s[40:43], s71 offen offset:1024 sc1
    v_mfma_f32_16x16x32_bf16 v[12:15], v[56:59], v[108:111], v[12:15]
    ds_read_b64_tr_b16 v[52:53], v82 offset:12544
    v_mfma_f32_16x16x32_bf16 v[28:31], v[56:59], v[112:115], v[28:31]
    ds_read_b64_tr_b16 v[54:55], v82 offset:14592
    v_mfma_f32_16x16x32_bf16 v[16:19], v[60:63], v[108:111], v[16:19]
    ds_read_b64_tr_b16 v[56:57], v83 offset:12544
    v_mfma_f32_16x16x32_bf16 v[32:35], v[60:63], v[112:115], v[32:35]
    ds_read_b64_tr_b16 v[58:59], v83 offset:14592
    buffer_load_dwordx4 v[104:107], v225, s[40:43], s71 offen offset:1024 sc1
    s_waitcnt vmcnt(14) lgkmcnt(8)
    v_mfma_f32_16x16x32_bf16 v[4:7], v[64:67], v[116:119], v[4:7]
    ds_read_b64_tr_b16 v[60:61], v80 offset:16896
    v_mfma_f32_16x16x32_bf16 v[20:23], v[64:67], v[120:123], v[20:23]
    ds_read_b64_tr_b16 v[62:63], v80 offset:18944
    v_mfma_f32_16x16x32_bf16 v[8:11], v[68:71], v[116:119], v[8:11]
    ds_read_b64_tr_b16 v[64:65], v81 offset:16896
    v_mfma_f32_16x16x32_bf16 v[24:27], v[68:71], v[120:123], v[24:27]
    ds_read_b64_tr_b16 v[66:67], v81 offset:18944
    buffer_load_dwordx4 v[108:111], v224, s[40:43], s71 offen offset:2048 sc1
    v_mfma_f32_16x16x32_bf16 v[12:15], v[36:39], v[116:119], v[12:15]
    ds_read_b64_tr_b16 v[68:69], v82 offset:16896
    v_mfma_f32_16x16x32_bf16 v[28:31], v[36:39], v[120:123], v[28:31]
    ds_read_b64_tr_b16 v[70:71], v82 offset:18944
    v_mfma_f32_16x16x32_bf16 v[16:19], v[40:43], v[116:119], v[16:19]
    ds_read_b64_tr_b16 v[36:37], v83 offset:16896
    v_mfma_f32_16x16x32_bf16 v[32:35], v[40:43], v[120:123], v[32:35]
    ds_read_b64_tr_b16 v[38:39], v83 offset:18944
    buffer_load_dwordx4 v[112:115], v225, s[40:43], s71 offen offset:2048 sc1
    s_waitcnt vmcnt(14) lgkmcnt(8)
    v_mfma_f32_16x16x32_bf16 v[4:7], v[44:47], v[124:127], v[4:7]
    ds_read_b64_tr_b16 v[40:41], v80 offset:20992
    v_mfma_f32_16x16x32_bf16 v[20:23], v[44:47], v[128:131], v[20:23]
    ds_read_b64_tr_b16 v[42:43], v80 offset:23040
    v_mfma_f32_16x16x32_bf16 v[8:11], v[48:51], v[124:127], v[8:11]
    ds_read_b64_tr_b16 v[44:45], v81 offset:20992
    v_mfma_f32_16x16x32_bf16 v[24:27], v[48:51], v[128:131], v[24:27]
    ds_read_b64_tr_b16 v[46:47], v81 offset:23040
    buffer_load_dwordx4 v[116:119], v224, s[40:43], s71 offen offset:3072 sc1
    v_mfma_f32_16x16x32_bf16 v[12:15], v[52:55], v[124:127], v[12:15]
    ds_read_b64_tr_b16 v[48:49], v82 offset:20992
    v_mfma_f32_16x16x32_bf16 v[28:31], v[52:55], v[128:131], v[28:31]
    ds_read_b64_tr_b16 v[50:51], v82 offset:23040
    v_mfma_f32_16x16x32_bf16 v[16:19], v[56:59], v[124:127], v[16:19]
    ds_read_b64_tr_b16 v[52:53], v83 offset:20992
    v_mfma_f32_16x16x32_bf16 v[32:35], v[56:59], v[128:131], v[32:35]
    ds_read_b64_tr_b16 v[54:55], v83 offset:23040
    buffer_load_dwordx4 v[120:123], v225, s[40:43], s71 offen offset:3072 sc1
    s_waitcnt vmcnt(14) lgkmcnt(8)
    v_mfma_f32_16x16x32_bf16 v[4:7], v[60:63], v[132:135], v[4:7]
    ds_read_b64_tr_b16 v[56:57], v80 offset:25344
    v_mfma_f32_16x16x32_bf16 v[20:23], v[60:63], v[136:139], v[20:23]
    ds_read_b64_tr_b16 v[58:59], v80 offset:27392
    v_mfma_f32_16x16x32_bf16 v[8:11], v[64:67], v[132:135], v[8:11]
    ds_read_b64_tr_b16 v[60:61], v81 offset:25344
    v_mfma_f32_16x16x32_bf16 v[24:27], v[64:67], v[136:139], v[24:27]
    ds_read_b64_tr_b16 v[62:63], v81 offset:27392
    v_mfma_f32_16x16x32_bf16 v[12:15], v[68:71], v[132:135], v[12:15]
    ds_read_b64_tr_b16 v[64:65], v82 offset:25344
    v_mfma_f32_16x16x32_bf16 v[28:31], v[68:71], v[136:139], v[28:31]
    ds_read_b64_tr_b16 v[66:67], v82 offset:27392
    v_mfma_f32_16x16x32_bf16 v[16:19], v[36:39], v[132:135], v[16:19]
    ds_read_b64_tr_b16 v[68:69], v83 offset:25344
    v_mfma_f32_16x16x32_bf16 v[32:35], v[36:39], v[136:139], v[32:35]
    ds_read_b64_tr_b16 v[70:71], v83 offset:27392
    s_waitcnt vmcnt(12) lgkmcnt(8)
    v_mfma_f32_16x16x32_bf16 v[4:7], v[40:43], v[140:143], v[4:7]
    ds_read_b64_tr_b16 v[36:37], v80 offset:29440
    v_mfma_f32_16x16x32_bf16 v[20:23], v[40:43], v[144:147], v[20:23]
    ds_read_b64_tr_b16 v[38:39], v80 offset:31488
    v_mfma_f32_16x16x32_bf16 v[8:11], v[44:47], v[140:143], v[8:11]
    ds_read_b64_tr_b16 v[40:41], v81 offset:29440
    v_mfma_f32_16x16x32_bf16 v[24:27], v[44:47], v[144:147], v[24:27]
    ds_read_b64_tr_b16 v[42:43], v81 offset:31488
    v_mfma_f32_16x16x32_bf16 v[12:15], v[48:51], v[140:143], v[12:15]
    ds_read_b64_tr_b16 v[44:45], v82 offset:29440
    v_mfma_f32_16x16x32_bf16 v[28:31], v[48:51], v[144:147], v[28:31]
    ds_read_b64_tr_b16 v[46:47], v82 offset:31488
    v_mfma_f32_16x16x32_bf16 v[16:19], v[52:55], v[140:143], v[16:19]
    ds_read_b64_tr_b16 v[48:49], v83 offset:29440
    v_mfma_f32_16x16x32_bf16 v[32:35], v[52:55], v[144:147], v[32:35]
    ds_read_b64_tr_b16 v[50:51], v83 offset:31488
    s_waitcnt vmcnt(10) lgkmcnt(8)
    v_mfma_f32_16x16x32_bf16 v[4:7], v[56:59], v[148:151], v[4:7]
    ds_read_b64_tr_b16 v[52:53], v72 offset:41984
    v_mfma_f32_16x16x32_bf16 v[20:23], v[56:59], v[152:155], v[20:23]
    ds_read_b64_tr_b16 v[54:55], v72 offset:44032
    v_mfma_f32_16x16x32_bf16 v[8:11], v[60:63], v[148:151], v[8:11]
    ds_read_b64_tr_b16 v[56:57], v73 offset:41984
    v_mfma_f32_16x16x32_bf16 v[24:27], v[60:63], v[152:155], v[24:27]
    ds_read_b64_tr_b16 v[58:59], v73 offset:44032
    v_mfma_f32_16x16x32_bf16 v[12:15], v[64:67], v[148:151], v[12:15]
    ds_read_b64_tr_b16 v[60:61], v74 offset:41984
    v_mfma_f32_16x16x32_bf16 v[28:31], v[64:67], v[152:155], v[28:31]
    ds_read_b64_tr_b16 v[62:63], v74 offset:44032
    v_mfma_f32_16x16x32_bf16 v[16:19], v[68:71], v[148:151], v[16:19]
    ds_read_b64_tr_b16 v[64:65], v75 offset:41984
    v_mfma_f32_16x16x32_bf16 v[32:35], v[68:71], v[152:155], v[32:35]
    ds_read_b64_tr_b16 v[66:67], v75 offset:44032
    s_waitcnt vmcnt(8) lgkmcnt(8)
    v_mfma_f32_16x16x32_bf16 v[4:7], v[36:39], v[84:87], v[4:7]
    ds_read_b64_tr_b16 v[68:69], v72 offset:46080
    v_mfma_f32_16x16x32_bf16 v[20:23], v[36:39], v[88:91], v[20:23]
    ds_read_b64_tr_b16 v[70:71], v72 offset:48128
    v_mfma_f32_16x16x32_bf16 v[8:11], v[40:43], v[84:87], v[8:11]
    ds_read_b64_tr_b16 v[36:37], v73 offset:46080
    v_mfma_f32_16x16x32_bf16 v[24:27], v[40:43], v[88:91], v[24:27]
    ds_read_b64_tr_b16 v[38:39], v73 offset:48128
    v_mfma_f32_16x16x32_bf16 v[12:15], v[44:47], v[84:87], v[12:15]
    ds_read_b64_tr_b16 v[40:41], v74 offset:46080
    v_mfma_f32_16x16x32_bf16 v[28:31], v[44:47], v[88:91], v[28:31]
    ds_read_b64_tr_b16 v[42:43], v74 offset:48128
    v_mfma_f32_16x16x32_bf16 v[16:19], v[48:51], v[84:87], v[16:19]
    ds_read_b64_tr_b16 v[44:45], v75 offset:46080
    v_mfma_f32_16x16x32_bf16 v[32:35], v[48:51], v[88:91], v[32:35]
    ds_read_b64_tr_b16 v[46:47], v75 offset:48128
    s_waitcnt vmcnt(6) lgkmcnt(8)
    v_mfma_f32_16x16x32_bf16 v[4:7], v[52:55], v[92:95], v[4:7]
    ds_read_b64_tr_b16 v[48:49], v72 offset:51200
    v_mfma_f32_16x16x32_bf16 v[20:23], v[52:55], v[96:99], v[20:23]
    ds_read_b64_tr_b16 v[50:51], v72 offset:53248
    v_mfma_f32_16x16x32_bf16 v[8:11], v[56:59], v[92:95], v[8:11]
    ds_read_b64_tr_b16 v[52:53], v73 offset:51200
    v_mfma_f32_16x16x32_bf16 v[24:27], v[56:59], v[96:99], v[24:27]
    ds_read_b64_tr_b16 v[54:55], v73 offset:53248
    v_mfma_f32_16x16x32_bf16 v[12:15], v[60:63], v[92:95], v[12:15]
    ds_read_b64_tr_b16 v[56:57], v74 offset:51200
    v_mfma_f32_16x16x32_bf16 v[28:31], v[60:63], v[96:99], v[28:31]
    ds_read_b64_tr_b16 v[58:59], v74 offset:53248
    v_mfma_f32_16x16x32_bf16 v[16:19], v[64:67], v[92:95], v[16:19]
    ds_read_b64_tr_b16 v[60:61], v75 offset:51200
    v_mfma_f32_16x16x32_bf16 v[32:35], v[64:67], v[96:99], v[32:35]
    ds_read_b64_tr_b16 v[62:63], v75 offset:53248
    s_waitcnt vmcnt(4) lgkmcnt(8)
    v_mfma_f32_16x16x32_bf16 v[4:7], v[68:71], v[100:103], v[4:7]
    ds_read_b64_tr_b16 v[64:65], v72 offset:55296
    v_mfma_f32_16x16x32_bf16 v[20:23], v[68:71], v[104:107], v[20:23]
    ds_read_b64_tr_b16 v[66:67], v72 offset:57344
    v_mfma_f32_16x16x32_bf16 v[8:11], v[36:39], v[100:103], v[8:11]
    ds_read_b64_tr_b16 v[68:69], v73 offset:55296
    v_mfma_f32_16x16x32_bf16 v[24:27], v[36:39], v[104:107], v[24:27]
    ds_read_b64_tr_b16 v[70:71], v73 offset:57344
    v_mfma_f32_16x16x32_bf16 v[12:15], v[40:43], v[100:103], v[12:15]
    ds_read_b64_tr_b16 v[36:37], v74 offset:55296
    v_mfma_f32_16x16x32_bf16 v[28:31], v[40:43], v[104:107], v[28:31]
    ds_read_b64_tr_b16 v[38:39], v74 offset:57344
    v_mfma_f32_16x16x32_bf16 v[16:19], v[44:47], v[100:103], v[16:19]
    ds_read_b64_tr_b16 v[40:41], v75 offset:55296
    v_mfma_f32_16x16x32_bf16 v[32:35], v[44:47], v[104:107], v[32:35]
    ds_read_b64_tr_b16 v[42:43], v75 offset:57344
    s_waitcnt vmcnt(2) lgkmcnt(8)
    v_mfma_f32_16x16x32_bf16 v[4:7], v[48:51], v[108:111], v[4:7]
    s_mul_i32 s37, s32, 80896
    s_lshl_b32 s38, s33, 11
    v_mfma_f32_16x16x32_bf16 v[20:23], v[48:51], v[112:115], v[20:23]
    s_add_u32 s37, s37, s38
    s_add_u32 s37, s37, 78848
    v_mfma_f32_16x16x32_bf16 v[8:11], v[52:55], v[108:111], v[8:11]
    v_lshrrev_b32 v1, 5, v0
    v_xor_b32 v1, v1, v0
    v_mfma_f32_16x16x32_bf16 v[24:27], v[52:55], v[112:115], v[24:27]
    v_and_b32 v1, 7, v1
    v_lshl_add_u32 v1, v1, 4, s37
    v_mfma_f32_16x16x32_bf16 v[12:15], v[56:59], v[108:111], v[12:15]
    v_bfe_u32 v2, v0, 4, 1
    v_lshl_add_u32 v1, v2, 3, v1
    v_mfma_f32_16x16x32_bf16 v[28:31], v[56:59], v[112:115], v[28:31]
    v_and_b32 v2, 15, v0
    v_lshl_add_u32 v72, v2, 7, v1
    v_mfma_f32_16x16x32_bf16 v[16:19], v[60:63], v[108:111], v[16:19]
    v_xor_b32 v73, 32, v72
    v_xor_b32 v74, 64, v72
    v_mfma_f32_16x16x32_bf16 v[32:35], v[60:63], v[112:115], v[32:35]
    v_xor_b32 v75, 96, v72
    v_lshrrev_b32 v1, 3, v0
    s_waitcnt vmcnt(0) lgkmcnt(0)
    v_mfma_f32_16x16x32_bf16 v[4:7], v[64:67], v[116:119], v[4:7]
    v_xor_b32 v1, v1, v0
    v_and_b32 v1, 7, v1
    v_mfma_f32_16x16x32_bf16 v[20:23], v[64:67], v[120:123], v[20:23]
    v_and_b32 v2, 56, v0
    v_add_u32 v1, v1, v2
    v_mfma_f32_16x16x32_bf16 v[8:11], v[68:71], v[116:119], v[8:11]
    v_lshl_add_u32 v76, v1, 4, s37
    v_mfma_f32_16x16x32_bf16 v[24:27], v[68:71], v[120:123], v[24:27]
    v_mfma_f32_16x16x32_bf16 v[12:15], v[36:39], v[116:119], v[12:15]
    v_mfma_f32_16x16x32_bf16 v[28:31], v[36:39], v[120:123], v[28:31]
    v_mfma_f32_16x16x32_bf16 v[16:19], v[40:43], v[116:119], v[16:19]
    v_mfma_f32_16x16x32_bf16 v[32:35], v[40:43], v[120:123], v[32:35]
    v_cvt_pk_bf16_f32 v36, v4, v5
    v_cvt_pk_bf16_f32 v37, v6, v7
    ds_write_b64 v72, v[36:37]
    v_cvt_pk_bf16_f32 v38, v8, v9
    v_cvt_pk_bf16_f32 v39, v10, v11
    ds_write_b64 v73, v[38:39]
    v_cvt_pk_bf16_f32 v40, v12, v13
    v_cvt_pk_bf16_f32 v41, v14, v15
    ds_write_b64 v74, v[40:41]
    v_cvt_pk_bf16_f32 v42, v16, v17
    v_cvt_pk_bf16_f32 v43, v18, v19
    ds_write_b64 v75, v[42:43]
    ds_read_b128 v[52:55], v76 offset:0
    ds_read_b128 v[56:59], v76 offset:1024
    v_cvt_pk_bf16_f32 v44, v20, v21
    v_cvt_pk_bf16_f32 v45, v22, v23
    ds_write_b64 v72, v[44:45]
    v_cvt_pk_bf16_f32 v46, v24, v25
    v_cvt_pk_bf16_f32 v47, v26, v27
    ds_write_b64 v73, v[46:47]
    v_cvt_pk_bf16_f32 v48, v28, v29
    v_cvt_pk_bf16_f32 v49, v30, v31
    ds_write_b64 v74, v[48:49]
    v_cvt_pk_bf16_f32 v50, v32, v33
    v_cvt_pk_bf16_f32 v51, v34, v35
    ds_write_b64 v75, v[50:51]
    ds_read_b128 v[60:63], v76 offset:0
    ds_read_b128 v[64:67], v76 offset:1024
    s_mov_b32 s37, 0
    s_waitcnt lgkmcnt(7)
    buffer_store_dwordx4 v[52:55], v226, s[48:51], s37 offen nt
    s_mov_b32 s37, 65536
    s_waitcnt lgkmcnt(6)
    buffer_store_dwordx4 v[56:59], v226, s[48:51], s37 offen nt
    s_mov_b32 s37, 131072
    s_waitcnt lgkmcnt(1)
    buffer_store_dwordx4 v[60:63], v226, s[48:51], s37 offen nt
    s_mov_b32 s37, 196608
    s_waitcnt lgkmcnt(0)
    buffer_store_dwordx4 v[64:67], v226, s[48:51], s37 offen nt
    s_endpgm
L_g1_rare:
    s_waitcnt vmcnt(0)
    s_cmp_lg_u32 s36, 1
    s_cbranch_scc1 L_g1_bar
    v_readfirstlane_b32 s38, v1
    s_nop 0
    s_cmp_ge_u32 s38, 4
    s_cbranch_scc1 L_sl_done_48
    s_mov_b32 s39, 1048576
L_sl_loop_49:
    ds_read_b32 v1, v228 offset:24
    s_waitcnt lgkmcnt(0)
    v_readfirstlane_b32 s38, v1
    s_nop 0
    s_cmp_ge_u32 s38, 4
    s_cbranch_scc1 L_sl_done_48
    s_sleep 1
    s_sub_u32 s39, s39, 1
    s_cbranch_scc0 L_sl_loop_49
L_sl_done_48:
    s_branch L_g1_nobar
L_end:
    s_endpgm
.section .rodata,"a"
.p2align 6
.amdhsa_kernel concat_heads__ssm_conv_h3__sliding_local_dilated__prompt_kernel
  .amdhsa_next_free_vgpr 256
  .amdhsa_next_free_sgpr 102
  .amdhsa_accum_offset 256
  .amdhsa_group_segment_fixed_size 0
  .amdhsa_kernarg_size 96
  .amdhsa_user_sgpr_count 2
  .amdhsa_user_sgpr_kernarg_segment_ptr 1
  .amdhsa_system_sgpr_workgroup_id_x 1
  .amdhsa_float_denorm_mode_32 3
.end_amdhsa_kernel
```

```asm
; @launch grid=(256,1,1) block=(512,1,1) lds=163840
.amdgcn_target "amdgcn-amd-amdhsa--gfx950"
.text
.globl concat_heads__ssm_conv_h3__sliding_local_dilated__prompt_kernel
.p2align 8
.type concat_heads__ssm_conv_h3__sliding_local_dilated__prompt_kernel,@function
concat_heads__ssm_conv_h3__sliding_local_dilated__prompt_kernel:
L_entry:
    s_getpc_b64 s[32:33]
    s_cmp_ge_u32 s2, 256
    s_cbranch_scc1 L_end
    s_load_dwordx16 s[8:23], s[0:1], 0
    s_load_dwordx8 s[24:31], s[0:1], 64
    v_lshrrev_b32 v1, 6, v0
    s_and_b32 s4, s2, 1
    v_readfirstlane_b32 s3, v1
    v_and_b32 v0, 63, v0
    s_bfe_u32 s5, s2, 0x30003
    s_bfe_u32 s6, s2, 0x20001
    s_lshr_b32 s7, s2, 6
    s_lshl2_add_u32 s6, s6, s7
    s_cmp_ge_u32 s3, 4
    s_cbranch_scc1 L_crole
    s_bfe_u32 s34, s2, 0x20003
    s_lshl2_add_u32 s34, s34, s3
    s_lshl_b32 s34, s34, 7
    v_lshl_add_u32 v1, v0, 11, s34
    v_min_u32 v1, L_end-L_entry-8, v1
    s_mov_b64 exec, 0xffff
    global_load_dword v249, v1, s[32:33]
    s_mov_b64 exec, -1
    s_and_b32 s84, s2, 3
    s_lshl2_add_u32 s84, s84, s3
    s_lshr_b32 s85, s2, 2
    s_mul_i32 s86, s3, 8448
    s_add_u32 s86, s86, 125952
    s_lshl_b32 s87, s85, 9
    s_add_u32 s87, s87, s84
    s_lshl_b32 s87, s87, 7
    v_and_b32 v231, 7, v0
    v_lshl_add_u32 v231, v231, 4, s87
    v_lshrrev_b32 v230, 3, v0
    v_lshl_add_u32 v230, v230, 13, v231
    v_subrev_u32 v231, 6144, v230
    v_subrev_u32 v232, 4096, v230
    v_subrev_u32 v233, 2048, v230
    v_add_u32 v234, 4096, v230
    v_lshlrev_b32 v235, 4, v0
    s_lshl_b32 s87, s84, 9
    s_add_u32 m0, s86, 4224
    s_waitcnt lgkmcnt(0)
    s_mov_b32 s80, s14
    s_mov_b32 s81, s15
    s_mov_b32 s82, 0x2000
    s_mov_b32 s83, 0x20000
    s_mov_b32 s72, s10
    s_mov_b32 s73, s11
    s_mov_b32 s74, 0x400000
    s_mov_b32 s75, 0x20000
    s_mov_b32 exec_hi, 0
    buffer_load_dwordx4 v235, s[80:83], s87 offen lds
    s_mov_b64 exec, -1
    buffer_load_dwordx4 v[108:111], v231, s[72:75], 0 offen offset:0 nt
    buffer_load_dwordx4 v[112:115], v232, s[72:75], 0 offen offset:0 nt
    buffer_load_dwordx4 v[116:119], v233, s[72:75], 0 offen offset:0 nt
    buffer_load_dwordx4 v[120:123], v230, s[72:75], 0 offen offset:0 nt
    buffer_load_dwordx4 v[124:127], v230, s[72:75], 0 offen offset:2048 nt
    buffer_load_dwordx4 v[128:131], v234, s[72:75], 0 offen offset:0 nt
    buffer_load_dwordx4 v[132:135], v234, s[72:75], 0 offen offset:2048 nt
    s_mov_b32 s76, s12
    s_mov_b32 s77, s13
    s_mov_b32 s78, 0x400000
    s_mov_b32 s79, 0x20000
    buffer_load_dwordx4 v[136:139], v230, s[76:79], 0 offen offset:0 nt
    buffer_load_dwordx4 v[140:143], v230, s[76:79], 0 offen offset:2048 nt
    buffer_load_dwordx4 v[144:147], v234, s[76:79], 0 offen offset:0 nt
    buffer_load_dwordx4 v[148:151], v234, s[76:79], 0 offen offset:2048 nt
    s_lshr_b32 s90, s2, 3
    s_and_b32 s91, s3, 3
    s_lshl2_add_u32 s90, s90, s91
    s_and_b32 s91, s2, 6
    s_lshl3_add_u32 s88, s90, s91
    s_lshl1_add_u32 s88, s88, s4
    s_lshl_b32 s88, s88, 11
    s_and_b32 s89, s2, 7
    s_and_b32 s91, s90, 1
    s_lshl1_add_u32 s89, s89, s91
    s_lshr_b32 s90, s90, 1
    s_mul_i32 s90, s90, 48
    s_add_u32 s89, s89, s90
    s_lshl_b32 s89, s89, 7
    v_and_b32 v251, 1, v0
    v_lshlrev_b32 v251, 12, v251
    v_lshrrev_b32 v252, 1, v0
    v_lshl_add_u32 v251, v252, 7, v251
    v_lshrrev_b32 v250, 2, v0
    v_mul_u32_u24 v250, 393216, v250
    v_and_b32 v252, 3, v0
    v_lshl_add_u32 v252, v252, 11, v250
    s_mov_b32 s64, s20
    s_mov_b32 s65, s21
    s_mov_b32 s66, 0x400000
    s_mov_b32 s67, 0x20000
    s_mov_b32 s68, s22
    s_mov_b32 s69, s23
    s_mov_b32 s70, 0x600000
    s_mov_b32 s71, 0x20000
    s_mov_b32 exec_lo, 0x777
    s_mov_b32 exec_hi, 0x0
    buffer_load_dword v250, v252, s[68:71], s89 offen
    s_xor_b32 s89, s89, 256
    buffer_load_dword v250, v252, s[68:71], s89 offen
    s_xor_b32 s89, s89, 256
    s_mov_b32 exec_lo, 0x3f
    s_mov_b32 exec_hi, 0
    buffer_load_dword v250, v251, s[64:67], s88 offen
    s_mov_b64 exec, -1
    s_barrier
    s_branch L_grole
L_crole:
    s_sub_u32 s70, s3, 4
    s_lshl_b32 s43, s70, 12
    s_lshl_b32 s44, s70, 11
    s_add_u32 s44, s44, 17408
    s_lshl_b32 s49, s70, 4
    s_lshl_b64 s[46:47], 0xffff, s49
    v_lshrrev_b32 v13, 3, v0
    v_and_b32 v14, 7, v0
    v_lshrrev_b32 v15, 4, v0
    s_lshl2_add_u32 s50, s5, s70
    s_lshl_b32 s50, s50, 6
    s_add_u32 s50, s50, s4
    s_lshl_b32 s50, s50, 11
    v_lshl_add_u32 v16, v13, 12, s50
    v_xor_b32 v17, v14, v15
    v_lshl_add_u32 v2, v17, 4, v16
    v_xor_b32 v3, 64, v2
    v_add_u32 v3, 31744, v3
    v_add_u32 v4, 63488, v2
    v_add_u32 v5, 63488, v3
    s_lshl_b32 s49, s5, 7
    s_sub_u32 s49, s49, 8
    s_max_i32 s49, s49, 0
    s_lshl1_add_u32 s49, s49, s4
    s_lshl_b32 s49, s49, 11
    v_lshl_add_u32 v16, v13, 12, s49
    v_lshlrev_b32 v17, 1, v15
    v_xor_b32 v18, v14, v17
    v_lshl_add_u32 v6, v18, 4, v16
    s_mul_i32 s49, s70, 768
    s_add_u32 s49, s49, s6
    s_lshl_b32 s49, s49, 7
    v_mul_u32_u24 v16, 6144, v13
    v_and_b32 v17, 2, v17
    v_xor_b32 v17, v14, v17
    v_lshlrev_b32 v17, 4, v17
    v_add3_u32 v7, v17, v16, s49
    v_xor_b32 v8, 64, v7
    v_add_u32 v8, 48128, v8
    v_add_u32 v9, 2048, v7
    v_add_u32 v10, 2048, v8
    v_add_u32 v11, 4096, v7
    v_add_u32 v12, 4096, v8
    s_mov_b32 s40, 0
    s_mov_b32 s41, 0
    s_lshr_b32 s90, s2, 3
    s_and_b32 s91, s3, 3
    s_lshl2_add_u32 s90, s90, s91
    s_and_b32 s91, s2, 6
    s_lshl3_add_u32 s88, s90, s91
    s_lshl1_add_u32 s88, s88, s4
    s_lshl_b32 s88, s88, 11
    s_and_b32 s89, s2, 7
    s_and_b32 s91, s90, 1
    s_lshl1_add_u32 s89, s89, s91
    s_lshr_b32 s90, s90, 1
    s_mul_i32 s90, s90, 48
    s_add_u32 s89, s89, s90
    s_lshl_b32 s89, s89, 7
    v_and_b32 v251, 1, v0
    v_lshlrev_b32 v251, 12, v251
    v_lshrrev_b32 v252, 1, v0
    v_lshl_add_u32 v251, v252, 7, v251
    v_lshrrev_b32 v250, 2, v0
    v_mul_u32_u24 v250, 393216, v250
    v_and_b32 v252, 3, v0
    v_lshl_add_u32 v252, v252, 11, v250
    s_waitcnt lgkmcnt(0)
    s_mov_b32 s32, s20
    s_mov_b32 s33, s21
    s_mov_b32 s34, 0x400000
    s_mov_b32 s35, 0x20000
    s_mov_b32 s36, s22
    s_mov_b32 s37, s23
    s_mov_b32 s38, 0x600000
    s_mov_b32 s39, 0x20000
    s_setprio 0
    s_and_b32 s73, s2, 7
    s_xor_b32 s73, s73, 2
    s_lshr_b32 s74, s2, 7
    s_lshl1_add_u32 s68, s73, s74
    s_bfe_u32 s69, s2, 0x40003
    s_lshl4_add_u32 s71, s68, s69
    s_lshl2_add_u32 s71, s71, s70
    s_mul_i32 s80, s70, 8448
    s_add_u32 s80, s80, 125952
    s_mul_i32 s81, s70, 9216
    s_add_u32 s81, s81, 41984
    s_add_u32 s52, s30, 0xe00000
    s_addc_u32 s53, s31, 0
    s_mov_b32 s54, 0x20000
    s_mov_b32 s55, 0x20000
    s_add_u32 s64, s30, 0x900000
    s_addc_u32 s65, s31, 0
    s_mov_b32 s66, 0x420000
    s_mov_b32 s67, 0x20000
    s_lshl_b32 s84, s71, 12
    s_mul_i32 s85, s71, 4224
    s_add_u32 s85, s85, 4194304
    s_lshr_b32 s72, s71, 1
    s_lshl_b32 s72, s72, 2
    s_load_dword s72, s[18:19], s72
    v_lshlrev_b32 v224, 4, v0
    v_mov_b32 v228, 0
    v_mov_b32 v229, 0
    v_mov_b32 v230, 0
    v_mov_b32 v231, 0
    v_mov_b32 v227, 134352
    v_mov_b32 v244, 1
    s_bfe_u32 s87, s2, 0x10003
    s_mov_b64 exec, 1
    ds_write_b128 v227, v[228:231]
    ds_write_b128 v227, v[228:231] offset:16
    ds_write_b128 v227, v[228:231] offset:32
    s_mov_b64 exec, -1
    s_lshr_b32 s74, s69, 2
    s_and_b32 s75, s69, 3
    s_lshl3_add_u32 s74, s74, s75
    s_lshl3_add_u32 s74, s74, s70
    s_lshl_b32 s74, s74, 3
    v_bfe_u32 v234, v0, 3, 1
    v_lshl_add_u32 v225, v234, 8, s74
    v_bfe_u32 v234, v0, 4, 1
    v_lshl_add_u32 v225, v234, 1, v225
    v_lshrrev_b32 v234, 5, v0
    v_lshl_add_u32 v225, v234, 5, v225
    s_lshl_b32 s74, s68, 7
    v_and_b32 v234, 7, v0
    v_lshl_add_u32 v234, v234, 4, s74
    v_lshl_add_u32 v226, v225, 12, v234
    v_lshl_add_u32 v225, v225, 11, v234
    v_and_b32 v234, 1, v0
    v_xor_b32 v234, 1, v234
    v_mul_u32_u24 v232, 4224, v234
    v_mul_u32_u24 v233, 4576, v234
    v_bfe_u32 v234, v0, 1, 3
    v_lshl_add_u32 v232, v234, 3, v232
    v_xor_b32 v234, 7, v234
    v_lshl_add_u32 v233, v234, 6, v233
    v_lshrrev_b32 v234, 4, v0
    v_lshl_add_u32 v232, v234, 4, v232
    v_lshl_add_u32 v233, v234, 4, v233
    v_add3_u32 v232, v232, s80, 8
    v_add_u32 v233, s81, v233
    s_waitcnt lgkmcnt(0)
    s_bitcmp1_b32 s71, 0
    s_cselect_b32 s74, 0, 16
    s_lshl_b32 s72, s72, s74
    s_and_b32 s72, s72, 0xffff0000
    v_and_b32 v235, 1, v0
    v_lshlrev_b32 v235, 4, v235
    v_lshrrev_b32 v235, v235, s72
    v_bfe_u32 v236, v0, 1, 3
    v_lshl_add_u32 v236, v234, 1, v236
    v_cmp_eq_u32 vcc, 7, v236
    v_mov_b32 v241, 0
    v_mov_b32 v243, 0
    v_cndmask_b32 v240, 0, v235, vcc
    v_cmp_eq_u32 vcc, 6, v236
    s_nop 1
    v_cndmask_b32 v242, 0, v235, vcc
    s_barrier
    s_add_u32 m0, s43, 0
    s_nop 0
    buffer_load_dwordx4 v2, s[32:35], s40 offen offset:0 lds
    s_add_u32 m0, s44, 0
    s_nop 0
    buffer_load_dwordx4 v7, s[36:39], s41 offen offset:0 lds
    buffer_load_dwordx4 v8, s[36:39], s41 offen offset:1024 lds
    s_add_u32 m0, s43, 0
    s_nop 0
    buffer_load_dwordx4 v3, s[32:35], s40 offen offset:1024 lds
    s_add_u32 m0, s44, 8192
    s_nop 0
    buffer_load_dwordx4 v9, s[36:39], s41 offen offset:0 lds
    buffer_load_dwordx4 v10, s[36:39], s41 offen offset:1024 lds
    s_add_u32 m0, s43, 0
    s_nop 0
    buffer_load_dwordx4 v4, s[32:35], s40 offen offset:2048 lds
    s_add_u32 m0, s44, 16384
    s_nop 0
    buffer_load_dwordx4 v11, s[36:39], s41 offen offset:0 lds
    buffer_load_dwordx4 v12, s[36:39], s41 offen offset:1024 lds
    s_add_u32 m0, s43, 0
    s_nop 0
    buffer_load_dwordx4 v5, s[32:35], s40 offen offset:3072 lds
    s_mov_b32 m0, 16384
    s_mov_b64 exec, s[46:47]
    buffer_load_dwordx4 v6, s[32:35], s40 offen lds
    s_mov_b64 exec, -1
    s_movk_i32 s40, 128
    s_mov_b32 s41, 393216
    s_add_u32 m0, s43, 41984
    s_nop 0
    buffer_load_dwordx4 v2, s[32:35], s40 offen offset:0 lds
    s_add_u32 m0, s44, 41984
    s_nop 0
    buffer_load_dwordx4 v7, s[36:39], s41 offen offset:0 lds
    buffer_load_dwordx4 v8, s[36:39], s41 offen offset:1024 lds
    s_add_u32 m0, s43, 41984
    s_nop 0
    buffer_load_dwordx4 v3, s[32:35], s40 offen offset:1024 lds
    s_add_u32 m0, s44, 50176
    s_nop 0
    buffer_load_dwordx4 v9, s[36:39], s41 offen offset:0 lds
    buffer_load_dwordx4 v10, s[36:39], s41 offen offset:1024 lds
    s_add_u32 m0, s43, 41984
    s_nop 0
    buffer_load_dwordx4 v4, s[32:35], s40 offen offset:2048 lds
    s_add_u32 m0, s44, 58368
    s_nop 0
    buffer_load_dwordx4 v11, s[36:39], s41 offen offset:0 lds
    buffer_load_dwordx4 v12, s[36:39], s41 offen offset:1024 lds
    s_add_u32 m0, s43, 41984
    s_nop 0
    buffer_load_dwordx4 v5, s[32:35], s40 offen offset:3072 lds
    s_mov_b32 m0, 58368
    s_mov_b64 exec, s[46:47]
    buffer_load_dwordx4 v6, s[32:35], s40 offen lds
    s_mov_b64 exec, -1
    s_movk_i32 s40, 256
    s_mov_b32 s41, 786432
    s_waitcnt vmcnt(11)
    s_barrier
    s_add_u32 m0, s43, 83968
    s_nop 0
    buffer_load_dwordx4 v2, s[32:35], s40 offen offset:0 lds
    s_add_u32 m0, s44, 83968
    s_nop 0
    buffer_load_dwordx4 v7, s[36:39], s41 offen offset:0 lds
    buffer_load_dwordx4 v8, s[36:39], s41 offen offset:1024 lds
    s_add_u32 m0, s43, 83968
    s_nop 0
    buffer_load_dwordx4 v3, s[32:35], s40 offen offset:1024 lds
    s_add_u32 m0, s44, 92160
    s_nop 0
    buffer_load_dwordx4 v9, s[36:39], s41 offen offset:0 lds
    buffer_load_dwordx4 v10, s[36:39], s41 offen offset:1024 lds
    s_add_u32 m0, s43, 83968
    s_nop 0
    buffer_load_dwordx4 v4, s[32:35], s40 offen offset:2048 lds
    s_add_u32 m0, s44, 100352
    s_nop 0
    buffer_load_dwordx4 v11, s[36:39], s41 offen offset:0 lds
    buffer_load_dwordx4 v12, s[36:39], s41 offen offset:1024 lds
    s_add_u32 m0, s43, 83968
    s_nop 0
    buffer_load_dwordx4 v5, s[32:35], s40 offen offset:3072 lds
    s_mov_b32 m0, 100352
    s_mov_b64 exec, s[46:47]
    buffer_load_dwordx4 v6, s[32:35], s40 offen lds
    s_mov_b64 exec, -1
    s_movk_i32 s40, 384
    s_mov_b32 s41, 1179648
    s_mov_b32 exec_lo, 0x7777000
    s_mov_b32 exec_hi, 0x0
    buffer_load_dword v250, v252, s[36:39], s89 offen
    s_xor_b32 s89, s89, 256
    buffer_load_dword v250, v252, s[36:39], s89 offen
    s_xor_b32 s89, s89, 256
    s_mov_b32 exec_lo, 0x3fc0
    s_mov_b32 exec_hi, 0
    buffer_load_dword v250, v251, s[32:35], s88 offen
    s_mov_b64 exec, -1
    s_waitcnt vmcnt(14)
    s_barrier
    s_add_u32 m0, s43, 0
    s_nop 0
    buffer_load_dwordx4 v2, s[32:35], s40 offen offset:0 lds
    s_add_u32 m0, s44, 0
    s_nop 0
    buffer_load_dwordx4 v7, s[36:39], s41 offen offset:0 lds
    buffer_load_dwordx4 v8, s[36:39], s41 offen offset:1024 lds
    s_add_u32 m0, s43, 0
    s_nop 0
    buffer_load_dwordx4 v3, s[32:35], s40 offen offset:1024 lds
    s_add_u32 m0, s44, 8192
    s_nop 0
    buffer_load_dwordx4 v9, s[36:39], s41 offen offset:0 lds
    buffer_load_dwordx4 v10, s[36:39], s41 offen offset:1024 lds
    s_add_u32 m0, s43, 0
    s_nop 0
    buffer_load_dwordx4 v4, s[32:35], s40 offen offset:2048 lds
    s_add_u32 m0, s44, 16384
    s_nop 0
    buffer_load_dwordx4 v11, s[36:39], s41 offen offset:0 lds
    buffer_load_dwordx4 v12, s[36:39], s41 offen offset:1024 lds
    s_add_u32 m0, s43, 0
    s_nop 0
    buffer_load_dwordx4 v5, s[32:35], s40 offen offset:3072 lds
    s_mov_b32 m0, 16384
    s_mov_b64 exec, s[46:47]
    buffer_load_dwordx4 v6, s[32:35], s40 offen lds
    s_mov_b64 exec, -1
    s_movk_i32 s40, 512
    s_mov_b32 s41, 1572864
    s_waitcnt vmcnt(14)
    s_barrier
    s_add_u32 m0, s43, 41984
    s_nop 0
    buffer_load_dwordx4 v2, s[32:35], s40 offen offset:0 lds
    s_add_u32 m0, s44, 41984
    s_nop 0
    buffer_load_dwordx4 v7, s[36:39], s41 offen offset:0 lds
    buffer_load_dwordx4 v8, s[36:39], s41 offen offset:1024 lds
    s_add_u32 m0, s43, 41984
    s_nop 0
    buffer_load_dwordx4 v3, s[32:35], s40 offen offset:1024 lds
    s_add_u32 m0, s44, 50176
    s_nop 0
    buffer_load_dwordx4 v9, s[36:39], s41 offen offset:0 lds
    buffer_load_dwordx4 v10, s[36:39], s41 offen offset:1024 lds
    s_add_u32 m0, s43, 41984
    s_nop 0
    buffer_load_dwordx4 v4, s[32:35], s40 offen offset:2048 lds
    s_add_u32 m0, s44, 58368
    s_nop 0
    buffer_load_dwordx4 v11, s[36:39], s41 offen offset:0 lds
    buffer_load_dwordx4 v12, s[36:39], s41 offen offset:1024 lds
    s_add_u32 m0, s43, 41984
    s_nop 0
    buffer_load_dwordx4 v5, s[32:35], s40 offen offset:3072 lds
    s_mov_b32 m0, 58368
    s_mov_b64 exec, s[46:47]
    buffer_load_dwordx4 v6, s[32:35], s40 offen lds
    s_mov_b64 exec, -1
    s_movk_i32 s40, 640
    s_mov_b32 s41, 1966080
    s_cmp_lg_u32 s87, 0
    s_cbranch_scc1 L_stg_4
    s_mov_b32 exec_lo, 0x70000000
    s_mov_b32 exec_hi, 0x777
    buffer_load_dword v250, v252, s[36:39], s89 offen
    s_xor_b32 s89, s89, 256
    buffer_load_dword v250, v252, s[36:39], s89 offen
    s_xor_b32 s89, s89, 256
    s_mov_b32 exec_lo, 0x3fc000
    s_mov_b32 exec_hi, 0
    buffer_load_dword v250, v251, s[32:35], s88 offen
    s_mov_b64 exec, -1
L_stg_4:
    s_waitcnt vmcnt(14)
    s_bitcmp1_b32 1, s87
    s_cbranch_scc1 L_mw_5
    s_waitcnt vmcnt(11)
L_mw_5:
    s_barrier
    s_add_u32 m0, s43, 83968
    s_nop 0
    buffer_load_dwordx4 v2, s[32:35], s40 offen offset:0 lds
    s_add_u32 m0, s44, 83968
    s_nop 0
    buffer_load_dwordx4 v7, s[36:39], s41 offen offset:0 lds
    buffer_load_dwordx4 v8, s[36:39], s41 offen offset:1024 lds
    s_add_u32 m0, s43, 83968
    s_nop 0
    buffer_load_dwordx4 v3, s[32:35], s40 offen offset:1024 lds
    s_add_u32 m0, s44, 92160
    s_nop 0
    buffer_load_dwordx4 v9, s[36:39], s41 offen offset:0 lds
    buffer_load_dwordx4 v10, s[36:39], s41 offen offset:1024 lds
    s_add_u32 m0, s43, 83968
    s_nop 0
    buffer_load_dwordx4 v4, s[32:35], s40 offen offset:2048 lds
    s_add_u32 m0, s44, 100352
    s_nop 0
    buffer_load_dwordx4 v11, s[36:39], s41 offen offset:0 lds
    buffer_load_dwordx4 v12, s[36:39], s41 offen offset:1024 lds
    s_add_u32 m0, s43, 83968
    s_nop 0
    buffer_load_dwordx4 v5, s[32:35], s40 offen offset:3072 lds
    s_mov_b32 m0, 100352
    s_mov_b64 exec, s[46:47]
    buffer_load_dwordx4 v6, s[32:35], s40 offen lds
    s_mov_b64 exec, -1
    s_movk_i32 s40, 768
    s_mov_b32 s41, 2359296
    s_cmp_lg_u32 s87, 1
    s_cbranch_scc1 L_stg_6
    s_mov_b32 exec_lo, 0x70000000
    s_mov_b32 exec_hi, 0x777
    buffer_load_dword v250, v252, s[36:39], s89 offen
    s_xor_b32 s89, s89, 256
    buffer_load_dword v250, v252, s[36:39], s89 offen
    s_xor_b32 s89, s89, 256
    s_mov_b32 exec_lo, 0x3fc000
    s_mov_b32 exec_hi, 0
    buffer_load_dword v250, v251, s[32:35], s88 offen
    s_mov_b64 exec, -1
L_stg_6:
    s_waitcnt vmcnt(14)
    s_barrier
    s_add_u32 m0, s43, 0
    s_nop 0
    buffer_load_dwordx4 v2, s[32:35], s40 offen offset:0 lds
    s_add_u32 m0, s44, 0
    s_nop 0
    buffer_load_dwordx4 v7, s[36:39], s41 offen offset:0 lds
    buffer_load_dwordx4 v8, s[36:39], s41 offen offset:1024 lds
    s_add_u32 m0, s43, 0
    s_nop 0
    buffer_load_dwordx4 v3, s[32:35], s40 offen offset:1024 lds
    s_add_u32 m0, s44, 8192
    s_nop 0
    buffer_load_dwordx4 v9, s[36:39], s41 offen offset:0 lds
    buffer_load_dwordx4 v10, s[36:39], s41 offen offset:1024 lds
    s_add_u32 m0, s43, 0
    s_nop 0
    buffer_load_dwordx4 v4, s[32:35], s40 offen offset:2048 lds
    s_add_u32 m0, s44, 16384
    s_nop 0
    buffer_load_dwordx4 v11, s[36:39], s41 offen offset:0 lds
    buffer_load_dwordx4 v12, s[36:39], s41 offen offset:1024 lds
    s_add_u32 m0, s43, 0
    s_nop 0
    buffer_load_dwordx4 v5, s[32:35], s40 offen offset:3072 lds
    s_mov_b32 m0, 16384
    s_mov_b64 exec, s[46:47]
    buffer_load_dwordx4 v6, s[32:35], s40 offen lds
    s_mov_b64 exec, -1
    s_movk_i32 s40, 896
    s_mov_b32 s41, 2752512
    s_bfe_u32 s74, s2, 0x20003
    s_lshl2_add_u32 s74, s74, s70
    s_cmp_lg_u32 s74, 0
    s_cbranch_scc1 L_sig_8
    s_mov_b32 s60, s28
    s_mov_b32 s61, s29
    s_mov_b32 s62, 0x100
    s_mov_b32 s63, 0x20000
    s_and_b32 s74, s2, 3
    s_lshl_b32 s74, s74, 6
    s_mov_b64 exec, 1
    buffer_atomic_add v244, off, s[60:63], s74 sc1
    s_mov_b64 exec, -1
L_sig_8:
    s_load_dwordx2 s[90:91], s[16:17], s84 offset:60
    s_load_dwordx2 s[90:91], s[16:17], s84 offset:188
    s_load_dwordx2 s[90:91], s[16:17], s84 offset:316
    s_load_dwordx2 s[90:91], s[16:17], s84 offset:444
    s_waitcnt vmcnt(14)
    s_bitcmp1_b32 2, s87
    s_cbranch_scc1 L_mw_9
    s_waitcnt vmcnt(11)
L_mw_9:
    s_barrier
    s_add_u32 m0, s43, 41984
    s_nop 0
    buffer_load_dwordx4 v2, s[32:35], s40 offen offset:0 lds
    s_add_u32 m0, s44, 41984
    s_nop 0
    buffer_load_dwordx4 v7, s[36:39], s41 offen offset:0 lds
    buffer_load_dwordx4 v8, s[36:39], s41 offen offset:1024 lds
    s_add_u32 m0, s43, 41984
    s_nop 0
    buffer_load_dwordx4 v3, s[32:35], s40 offen offset:1024 lds
    s_add_u32 m0, s44, 50176
    s_nop 0
    buffer_load_dwordx4 v9, s[36:39], s41 offen offset:0 lds
    buffer_load_dwordx4 v10, s[36:39], s41 offen offset:1024 lds
    s_add_u32 m0, s43, 41984
    s_nop 0
    buffer_load_dwordx4 v4, s[32:35], s40 offen offset:2048 lds
    s_add_u32 m0, s44, 58368
    s_nop 0
    buffer_load_dwordx4 v11, s[36:39], s41 offen offset:0 lds
    buffer_load_dwordx4 v12, s[36:39], s41 offen offset:1024 lds
    s_add_u32 m0, s43, 41984
    s_nop 0
    buffer_load_dwordx4 v5, s[32:35], s40 offen offset:3072 lds
    s_mov_b32 m0, 58368
    s_mov_b64 exec, s[46:47]
    buffer_load_dwordx4 v6, s[32:35], s40 offen lds
    s_mov_b64 exec, -1
    s_movk_i32 s40, 1024
    s_mov_b32 s41, 3145728
    s_bfe_u32 s74, s2, 0x20003
    s_lshl2_add_u32 s74, s74, s70
    s_cmp_lg_u32 s74, 4
    s_cbranch_scc1 L_sig_10
    s_mov_b32 s60, s28
    s_mov_b32 s61, s29
    s_mov_b32 s62, 0x100
    s_mov_b32 s63, 0x20000
    s_and_b32 s74, s2, 3
    s_lshl_b32 s74, s74, 6
    s_mov_b64 exec, 1
    buffer_atomic_add v244, off, s[60:63], s74 sc1
    s_mov_b64 exec, -1
L_sig_10:
    s_load_dwordx2 s[90:91], s[16:17], s84 offset:572
    s_load_dwordx2 s[90:91], s[16:17], s84 offset:700
    s_load_dwordx2 s[90:91], s[16:17], s84 offset:828
    s_load_dwordx2 s[90:91], s[16:17], s84 offset:956
    s_waitcnt vmcnt(11)
    s_barrier
    s_add_u32 m0, s43, 83968
    s_nop 0
    buffer_load_dwordx4 v2, s[32:35], s40 offen offset:0 lds
    s_add_u32 m0, s44, 83968
    s_nop 0
    buffer_load_dwordx4 v7, s[36:39], s41 offen offset:0 lds
    buffer_load_dwordx4 v8, s[36:39], s41 offen offset:1024 lds
    s_add_u32 m0, s43, 83968
    s_nop 0
    buffer_load_dwordx4 v3, s[32:35], s40 offen offset:1024 lds
    s_add_u32 m0, s44, 92160
    s_nop 0
    buffer_load_dwordx4 v9, s[36:39], s41 offen offset:0 lds
    buffer_load_dwordx4 v10, s[36:39], s41 offen offset:1024 lds
    s_add_u32 m0, s43, 83968
    s_nop 0
    buffer_load_dwordx4 v4, s[32:35], s40 offen offset:2048 lds
    s_add_u32 m0, s44, 100352
    s_nop 0
    buffer_load_dwordx4 v11, s[36:39], s41 offen offset:0 lds
    buffer_load_dwordx4 v12, s[36:39], s41 offen offset:1024 lds
    s_add_u32 m0, s43, 83968
    s_nop 0
    buffer_load_dwordx4 v5, s[32:35], s40 offen offset:3072 lds
    s_mov_b32 m0, 100352
    s_mov_b64 exec, s[46:47]
    buffer_load_dwordx4 v6, s[32:35], s40 offen lds
    s_mov_b64 exec, -1
    s_movk_i32 s40, 1152
    s_mov_b32 s41, 3538944
    s_cmp_lg_u32 s87, 0
    s_cbranch_scc1 L_stg_12
    s_mov_b32 exec_lo, 0x0
    s_mov_b32 exec_hi, 0x77777000
    buffer_load_dword v250, v252, s[36:39], s89 offen
    s_xor_b32 s89, s89, 256
    buffer_load_dword v250, v252, s[36:39], s89 offen
    s_xor_b32 s89, s89, 256
    s_mov_b32 exec_lo, 0xffc00000
    s_mov_b32 exec_hi, 0
    buffer_load_dword v250, v251, s[32:35], s88 offen
    s_mov_b64 exec, -1
L_stg_12:
    s_bfe_u32 s74, s2, 0x20003
    s_lshl2_add_u32 s74, s74, s70
    s_cmp_lg_u32 s74, 8
    s_cbranch_scc1 L_sig_13
    s_mov_b32 s60, s28
    s_mov_b32 s61, s29
    s_mov_b32 s62, 0x100
    s_mov_b32 s63, 0x20000
    s_and_b32 s74, s2, 3
    s_lshl_b32 s74, s74, 6
    s_mov_b64 exec, 1
    buffer_atomic_add v244, off, s[60:63], s74 sc1
    s_mov_b64 exec, -1
L_sig_13:
    s_load_dwordx2 s[90:91], s[16:17], s84 offset:1084
    s_load_dwordx2 s[90:91], s[16:17], s84 offset:1212
    s_load_dwordx2 s[90:91], s[16:17], s84 offset:1340
    s_load_dwordx2 s[90:91], s[16:17], s84 offset:1468
    s_waitcnt vmcnt(14)
    s_bitcmp1_b32 1, s87
    s_cbranch_scc1 L_mw_14
    s_waitcnt vmcnt(11)
L_mw_14:
    s_barrier
    s_add_u32 m0, s43, 0
    s_nop 0
    buffer_load_dwordx4 v2, s[32:35], s40 offen offset:0 lds
    s_add_u32 m0, s44, 0
    s_nop 0
    buffer_load_dwordx4 v7, s[36:39], s41 offen offset:0 lds
    buffer_load_dwordx4 v8, s[36:39], s41 offen offset:1024 lds
    s_add_u32 m0, s43, 0
    s_nop 0
    buffer_load_dwordx4 v3, s[32:35], s40 offen offset:1024 lds
    s_add_u32 m0, s44, 8192
    s_nop 0
    buffer_load_dwordx4 v9, s[36:39], s41 offen offset:0 lds
    buffer_load_dwordx4 v10, s[36:39], s41 offen offset:1024 lds
    s_add_u32 m0, s43, 0
    s_nop 0
    buffer_load_dwordx4 v4, s[32:35], s40 offen offset:2048 lds
    s_add_u32 m0, s44, 16384
    s_nop 0
    buffer_load_dwordx4 v11, s[36:39], s41 offen offset:0 lds
    buffer_load_dwordx4 v12, s[36:39], s41 offen offset:1024 lds
    s_add_u32 m0, s43, 0
    s_nop 0
    buffer_load_dwordx4 v5, s[32:35], s40 offen offset:3072 lds
    s_mov_b32 m0, 16384
    s_mov_b64 exec, s[46:47]
    buffer_load_dwordx4 v6, s[32:35], s40 offen lds
    s_mov_b64 exec, -1
    s_movk_i32 s40, 1280
    s_mov_b32 s41, 3932160
    s_cmp_lg_u32 s87, 1
    s_cbranch_scc1 L_stg_15
    s_mov_b32 exec_lo, 0x0
    s_mov_b32 exec_hi, 0x77777000
    buffer_load_dword v250, v252, s[36:39], s89 offen
    s_xor_b32 s89, s89, 256
    buffer_load_dword v250, v252, s[36:39], s89 offen
    s_xor_b32 s89, s89, 256
    s_mov_b32 exec_lo, 0xffc00000
    s_mov_b32 exec_hi, 0
    buffer_load_dword v250, v251, s[32:35], s88 offen
    s_mov_b64 exec, -1
L_stg_15:
    s_bfe_u32 s74, s2, 0x20003
    s_lshl2_add_u32 s74, s74, s70
    s_cmp_lg_u32 s74, 12
    s_cbranch_scc1 L_sig_16
    s_mov_b32 s60, s28
    s_mov_b32 s61, s29
    s_mov_b32 s62, 0x100
    s_mov_b32 s63, 0x20000
    s_and_b32 s74, s2, 3
    s_lshl_b32 s74, s74, 6
    s_mov_b64 exec, 1
    buffer_atomic_add v244, off, s[60:63], s74 sc1
    s_mov_b64 exec, -1
L_sig_16:
    s_load_dwordx2 s[90:91], s[16:17], s84 offset:1596
    s_load_dwordx2 s[90:91], s[16:17], s84 offset:1724
    s_load_dwordx2 s[90:91], s[16:17], s84 offset:1852
    s_load_dwordx2 s[90:91], s[16:17], s84 offset:1980
    s_waitcnt vmcnt(14)
    s_barrier
    s_add_u32 m0, s43, 41984
    s_nop 0
    buffer_load_dwordx4 v2, s[32:35], s40 offen offset:0 lds
    s_add_u32 m0, s44, 41984
    s_nop 0
    buffer_load_dwordx4 v7, s[36:39], s41 offen offset:0 lds
    buffer_load_dwordx4 v8, s[36:39], s41 offen offset:1024 lds
    s_add_u32 m0, s43, 41984
    s_nop 0
    buffer_load_dwordx4 v3, s[32:35], s40 offen offset:1024 lds
    s_add_u32 m0, s44, 50176
    s_nop 0
    buffer_load_dwordx4 v9, s[36:39], s41 offen offset:0 lds
    buffer_load_dwordx4 v10, s[36:39], s41 offen offset:1024 lds
    s_add_u32 m0, s43, 41984
    s_nop 0
    buffer_load_dwordx4 v4, s[32:35], s40 offen offset:2048 lds
    s_add_u32 m0, s44, 58368
    s_nop 0
    buffer_load_dwordx4 v11, s[36:39], s41 offen offset:0 lds
    buffer_load_dwordx4 v12, s[36:39], s41 offen offset:1024 lds
    s_add_u32 m0, s43, 41984
    s_nop 0
    buffer_load_dwordx4 v5, s[32:35], s40 offen offset:3072 lds
    s_mov_b32 m0, 58368
    s_mov_b64 exec, s[46:47]
    buffer_load_dwordx4 v6, s[32:35], s40 offen lds
    s_mov_b64 exec, -1
    s_movk_i32 s40, 1408
    s_mov_b32 s41, 4325376
    s_load_dwordx2 s[90:91], s[16:17], s84 offset:2108
    s_load_dwordx2 s[90:91], s[16:17], s84 offset:2236
    s_load_dwordx2 s[90:91], s[16:17], s84 offset:2364
    s_load_dwordx2 s[90:91], s[16:17], s84 offset:2492
    s_waitcnt vmcnt(14)
    s_bitcmp1_b32 2, s87
    s_cbranch_scc1 L_mw_18
    s_waitcnt vmcnt(11)
L_mw_18:
    s_barrier
    s_add_u32 m0, s43, 83968
    s_nop 0
    buffer_load_dwordx4 v2, s[32:35], s40 offen offset:0 lds
    s_add_u32 m0, s44, 83968
    s_nop 0
    buffer_load_dwordx4 v7, s[36:39], s41 offen offset:0 lds
    buffer_load_dwordx4 v8, s[36:39], s41 offen offset:1024 lds
    s_add_u32 m0, s43, 83968
    s_nop 0
    buffer_load_dwordx4 v3, s[32:35], s40 offen offset:1024 lds
    s_add_u32 m0, s44, 92160
    s_nop 0
    buffer_load_dwordx4 v9, s[36:39], s41 offen offset:0 lds
    buffer_load_dwordx4 v10, s[36:39], s41 offen offset:1024 lds
    s_add_u32 m0, s43, 83968
    s_nop 0
    buffer_load_dwordx4 v4, s[32:35], s40 offen offset:2048 lds
    s_add_u32 m0, s44, 100352
    s_nop 0
    buffer_load_dwordx4 v11, s[36:39], s41 offen offset:0 lds
    buffer_load_dwordx4 v12, s[36:39], s41 offen offset:1024 lds
    s_add_u32 m0, s43, 83968
    s_nop 0
    buffer_load_dwordx4 v5, s[32:35], s40 offen offset:3072 lds
    s_mov_b32 m0, 100352
    s_mov_b64 exec, s[46:47]
    buffer_load_dwordx4 v6, s[32:35], s40 offen lds
    s_mov_b64 exec, -1
    s_movk_i32 s40, 1536
    s_mov_b32 s41, 4718592
    s_load_dwordx2 s[90:91], s[16:17], s84 offset:2620
    s_load_dwordx2 s[90:91], s[16:17], s84 offset:2748
    s_load_dwordx2 s[90:91], s[16:17], s84 offset:2876
    s_load_dwordx2 s[90:91], s[16:17], s84 offset:3004
    s_waitcnt vmcnt(11)
    s_barrier
    s_add_u32 m0, s43, 0
    s_nop 0
    buffer_load_dwordx4 v2, s[32:35], s40 offen offset:0 lds
    s_add_u32 m0, s44, 0
    s_nop 0
    buffer_load_dwordx4 v7, s[36:39], s41 offen offset:0 lds
    buffer_load_dwordx4 v8, s[36:39], s41 offen offset:1024 lds
    s_add_u32 m0, s43, 0
    s_nop 0
    buffer_load_dwordx4 v3, s[32:35], s40 offen offset:1024 lds
    s_add_u32 m0, s44, 8192
    s_nop 0
    buffer_load_dwordx4 v9, s[36:39], s41 offen offset:0 lds
    buffer_load_dwordx4 v10, s[36:39], s41 offen offset:1024 lds
    s_add_u32 m0, s43, 0
    s_nop 0
    buffer_load_dwordx4 v4, s[32:35], s40 offen offset:2048 lds
    s_add_u32 m0, s44, 16384
    s_nop 0
    buffer_load_dwordx4 v11, s[36:39], s41 offen offset:0 lds
    buffer_load_dwordx4 v12, s[36:39], s41 offen offset:1024 lds
    s_add_u32 m0, s43, 0
    s_nop 0
    buffer_load_dwordx4 v5, s[32:35], s40 offen offset:3072 lds
    s_mov_b32 m0, 16384
    s_mov_b64 exec, s[46:47]
    buffer_load_dwordx4 v6, s[32:35], s40 offen lds
    s_mov_b64 exec, -1
    s_movk_i32 s40, 1664
    s_mov_b32 s41, 5111808
    s_load_dwordx2 s[90:91], s[16:17], s84 offset:3132
    s_load_dwordx2 s[90:91], s[16:17], s84 offset:3260
    s_load_dwordx2 s[90:91], s[16:17], s84 offset:3388
    s_load_dwordx2 s[90:91], s[16:17], s84 offset:3516
    s_waitcnt vmcnt(11)
    s_barrier
    s_add_u32 m0, s43, 41984
    s_nop 0
    buffer_load_dwordx4 v2, s[32:35], s40 offen offset:0 lds
    s_add_u32 m0, s44, 41984
    s_nop 0
    buffer_load_dwordx4 v7, s[36:39], s41 offen offset:0 lds
    buffer_load_dwordx4 v8, s[36:39], s41 offen offset:1024 lds
    s_add_u32 m0, s43, 41984
    s_nop 0
    buffer_load_dwordx4 v3, s[32:35], s40 offen offset:1024 lds
    s_add_u32 m0, s44, 50176
    s_nop 0
    buffer_load_dwordx4 v9, s[36:39], s41 offen offset:0 lds
    buffer_load_dwordx4 v10, s[36:39], s41 offen offset:1024 lds
    s_add_u32 m0, s43, 41984
    s_nop 0
    buffer_load_dwordx4 v4, s[32:35], s40 offen offset:2048 lds
    s_add_u32 m0, s44, 58368
    s_nop 0
    buffer_load_dwordx4 v11, s[36:39], s41 offen offset:0 lds
    buffer_load_dwordx4 v12, s[36:39], s41 offen offset:1024 lds
    s_add_u32 m0, s43, 41984
    s_nop 0
    buffer_load_dwordx4 v5, s[32:35], s40 offen offset:3072 lds
    s_mov_b32 m0, 58368
    s_mov_b64 exec, s[46:47]
    buffer_load_dwordx4 v6, s[32:35], s40 offen lds
    s_mov_b64 exec, -1
    s_movk_i32 s40, 1792
    s_mov_b32 s41, 5505024
    s_load_dwordx2 s[90:91], s[16:17], s84 offset:3644
    s_load_dwordx2 s[90:91], s[16:17], s84 offset:3772
    s_load_dwordx2 s[90:91], s[16:17], s84 offset:3900
    s_load_dwordx2 s[90:91], s[16:17], s84 offset:4028
    s_waitcnt vmcnt(11)
    s_barrier
    s_add_u32 m0, s43, 83968
    s_nop 0
    buffer_load_dwordx4 v2, s[32:35], s40 offen offset:0 lds
    s_add_u32 m0, s44, 83968
    s_nop 0
    buffer_load_dwordx4 v7, s[36:39], s41 offen offset:0 lds
    buffer_load_dwordx4 v8, s[36:39], s41 offen offset:1024 lds
    s_add_u32 m0, s43, 83968
    s_nop 0
    buffer_load_dwordx4 v3, s[32:35], s40 offen offset:1024 lds
    s_add_u32 m0, s44, 92160
    s_nop 0
    buffer_load_dwordx4 v9, s[36:39], s41 offen offset:0 lds
    buffer_load_dwordx4 v10, s[36:39], s41 offen offset:1024 lds
    s_add_u32 m0, s43, 83968
    s_nop 0
    buffer_load_dwordx4 v4, s[32:35], s40 offen offset:2048 lds
    s_add_u32 m0, s44, 100352
    s_nop 0
    buffer_load_dwordx4 v11, s[36:39], s41 offen offset:0 lds
    buffer_load_dwordx4 v12, s[36:39], s41 offen offset:1024 lds
    s_add_u32 m0, s43, 83968
    s_nop 0
    buffer_load_dwordx4 v5, s[32:35], s40 offen offset:3072 lds
    s_mov_b32 m0, 100352
    s_mov_b64 exec, s[46:47]
    buffer_load_dwordx4 v6, s[32:35], s40 offen lds
    s_mov_b64 exec, -1
    s_movk_i32 s40, 1920
    s_mov_b32 s41, 5898240
    s_waitcnt vmcnt(11)
    s_barrier
    s_load_dword s76, s[28:29], 0
    s_load_dword s77, s[28:29], 64
    s_load_dword s78, s[28:29], 128
    s_load_dword s79, s[28:29], 192
    s_add_u32 m0, s43, 0
    s_nop 0
    buffer_load_dwordx4 v2, s[32:35], s40 offen offset:0 lds
    s_add_u32 m0, s44, 0
    s_nop 0
    buffer_load_dwordx4 v7, s[36:39], s41 offen offset:0 lds
    buffer_load_dwordx4 v8, s[36:39], s41 offen offset:1024 lds
    s_add_u32 m0, s43, 0
    s_nop 0
    buffer_load_dwordx4 v3, s[32:35], s40 offen offset:1024 lds
    s_add_u32 m0, s44, 8192
    s_nop 0
    buffer_load_dwordx4 v9, s[36:39], s41 offen offset:0 lds
    buffer_load_dwordx4 v10, s[36:39], s41 offen offset:1024 lds
    s_add_u32 m0, s43, 0
    s_nop 0
    buffer_load_dwordx4 v4, s[32:35], s40 offen offset:2048 lds
    s_add_u32 m0, s44, 16384
    s_nop 0
    buffer_load_dwordx4 v11, s[36:39], s41 offen offset:0 lds
    buffer_load_dwordx4 v12, s[36:39], s41 offen offset:1024 lds
    s_add_u32 m0, s43, 0
    s_nop 0
    buffer_load_dwordx4 v5, s[32:35], s40 offen offset:3072 lds
    s_mov_b32 m0, 16384
    s_mov_b64 exec, s[46:47]
    buffer_load_dwordx4 v6, s[32:35], s40 offen lds
    s_mov_b64 exec, -1
    s_movk_i32 s40, 2048
    s_mov_b32 s41, 6291456
    s_cmp_lg_u32 s70, 0
    s_cbranch_scc1 L_pc_done_23
    s_waitcnt lgkmcnt(0)
    s_min_u32 s76, s76, s77
    s_min_u32 s78, s78, s79
    s_min_u32 s76, s76, s78
    s_cmp_ge_u32 s76, 64
    s_cbranch_scc1 L_pc_done_23
    s_mov_b32 s60, s28
    s_mov_b32 s61, s29
    s_mov_b32 s62, 0x100
    s_mov_b32 s63, 0x20000
    v_lshlrev_b32 v20, 6, v0
    s_mov_b32 s74, 131072
    s_mov_b64 exec, 0xf
L_pc_loop_24:
    buffer_load_dword v21, v20, s[60:63], 0 offen sc1
    s_waitcnt vmcnt(0)
    v_cmp_gt_u32 vcc, 64, v21
    s_cbranch_vccz L_pc_done_23
    s_sleep 4
    s_sub_u32 s74, s74, 1
    s_cbranch_scc0 L_pc_loop_24
L_pc_done_23:
    s_mov_b64 exec, -1
    s_waitcnt vmcnt(11)
    s_barrier
    s_add_u32 s56, s30, s85
    s_addc_u32 s57, s31, 0
    s_movk_i32 s58, 4096
    s_mov_b32 s59, 0x20000
    s_add_u32 m0, s81, 0
    s_nop 0
    buffer_load_dwordx4 v224, s[56:59], 0 offen offset:0 sc1 lds
    buffer_load_dwordx4 v224, s[56:59], 0 offen offset:1024 sc1 lds
    buffer_load_dwordx4 v224, s[56:59], 0 offen offset:2048 sc1 lds
    buffer_load_dwordx4 v224, s[56:59], 0 offen offset:3072 sc1 lds
    s_add_u32 m0, s81, 4572
    s_nop 0
    buffer_load_dwordx4 v224, s[56:59], 0 offen offset:0 sc1 lds
    buffer_load_dwordx4 v224, s[56:59], 0 offen offset:1024 sc1 lds
    buffer_load_dwordx4 v224, s[56:59], 0 offen offset:2048 sc1 lds
    buffer_load_dwordx4 v224, s[56:59], 0 offen offset:3072 sc1 lds
    s_waitcnt vmcnt(8)
    s_mov_b64 exec, 1
    ds_add_u32 v227, v244 offset:24
    s_mov_b64 exec, -1
    s_add_u32 s56, s16, s84
    s_addc_u32 s57, s17, 0
    s_movk_i32 s58, 4096
    s_mov_b32 s59, 0x20000
    s_add_u32 m0, s80, 64
    v_mov_b32 v132, 0
    v_mov_b32 v133, 0
    v_mov_b32 v134, 0
    v_mov_b32 v135, 0
    buffer_load_dwordx4 v224, s[56:59], 0 offen offset:0 lds
    buffer_load_dwordx4 v224, s[56:59], 0 offen offset:1024 lds
    buffer_load_dwordx4 v224, s[56:59], 0 offen offset:2048 lds
    buffer_load_dwordx4 v224, s[56:59], 0 offen offset:3072 lds
    s_add_u32 m0, s80, 4304
    s_mov_b64 exec, 0x100
    buffer_load_dwordx4 v[132:135], off, s[56:59], 0
    s_mov_b64 exec, -1
    buffer_load_dwordx4 v224, s[56:59], 14 offen offset:0 lds
    buffer_load_dwordx4 v224, s[56:59], 14 offen offset:1024 lds
    buffer_load_dwordx4 v224, s[56:59], 14 offen offset:2048 lds
    buffer_load_dwordx4 v224, s[56:59], 14 offen offset:3072 lds
    v_lshrrev_b32 v234, 5, v0
    v_mul_u32_u24 v234, 4064, v234
    v_add3_u32 v234, v234, v224, s81
    s_mov_b32 exec_lo, 0xfffffff
    s_mov_b32 exec_hi, 0xfffffff
    ds_write_b128 v234, v[228:231] offset:4096
    s_mov_b64 exec, 1
    ds_write_b32 v234, v228 offset:8668
    s_mov_b64 exec, -1
    s_setprio 3
    s_mov_b32 s60, s24
    s_mov_b32 s61, s25
    s_mov_b32 s62, 0x200000
    s_mov_b32 s63, 0x20000
    s_lshr_b32 s74, s2, 3
    s_lshl2_add_u32 s74, s74, s70
    s_bfe_u32 s75, s2, 0x10002
    s_lshl4_add_u32 s74, s74, s75
    s_lshl_b32 s74, s74, 10
    v_lshrrev_b32 v234, 3, v0
    v_and_b32 v235, 7, v0
    v_lshlrev_b32 v235, 7, v235
    v_lshl_add_u32 v234, v234, 11, v235
    buffer_load_dword v250, v234, s[60:63], s74 offen
    s_mov_b32 s60, s8
    s_mov_b32 s61, s9
    s_mov_b32 s62, 0x400000
    s_mov_b32 s63, 0x20000
    s_movk_i32 s75, 8192
    buffer_load_dwordx4 v[208:211], v225, s[60:63], 0 offen offset:0 nt
    buffer_load_dwordx4 v[212:215], v225, s[60:63], 0 offen offset:2048 nt
    buffer_load_dwordx4 v[216:219], v225, s[60:63], s75 offen offset:0 nt
    buffer_load_dwordx4 v[220:223], v225, s[60:63], s75 offen offset:2048 nt
    s_waitcnt vmcnt(14)
    s_waitcnt vmcnt(5)
    v_cmp_lt_u32 vcc, 3, v0
    v_mov_b32 v140, 4160
    v_lshlrev_b32 v136, 16, v132
    v_cndmask_b32 v140, 0, v140, vcc
    v_alignbit_b32 v137, v133, v132, 16
    v_alignbit_b32 v138, v134, v133, 16
    v_alignbit_b32 v139, v135, v134, 16
    v_add3_u32 v140, v140, v224, s80
    s_mov_b64 exec, 0x1ff
    ds_write_b128 v140, v[136:139]
    s_mov_b64 exec, -1
    ds_read_b128 v[112:115], v233 offset:3584
    ds_read_b64 v[48:49], v232 offset:0
    ds_read_b64 v[50:51], v232 offset:8
    ds_read_b128 v[116:119], v233 offset:3072
    ds_read_b64 v[52:53], v232 offset:512
    ds_read_b64 v[54:55], v232 offset:520
    ds_read_b128 v[120:123], v233 offset:2560
    ds_read_b64 v[56:57], v232 offset:1024
    ds_read_b64 v[58:59], v232 offset:1032
    ds_read_b128 v[124:127], v233 offset:2048
    ds_read_b64 v[60:61], v232 offset:1536
    ds_read_b64 v[62:63], v232 offset:1544
    ds_read_b128 v[128:131], v233 offset:1536
    ds_read_b64 v[64:65], v232 offset:2048
    ds_read_b64 v[66:67], v232 offset:2056
    ds_read_b128 v[132:135], v233 offset:1024
    ds_read_b64 v[68:69], v232 offset:2560
    ds_read_b64 v[70:71], v232 offset:2568
    ds_read_b128 v[136:139], v233 offset:512
    ds_read_b64 v[72:73], v232 offset:3072
    ds_read_b64 v[74:75], v232 offset:3080
    ds_read_b128 v[140:143], v233 offset:0
    ds_read_b64 v[76:77], v232 offset:3584
    ds_read_b64 v[78:79], v232 offset:3592
    s_setprio 1
    s_mov_b32 s74, 3
    s_waitcnt lgkmcnt(0)
    v_mfma_f32_16x16x32_bf16 v[16:19], v[240:243], v[112:115], 0
    v_mfma_f32_16x16x32_bf16 v[20:23], v[240:243], v[116:119], 0
    v_mfma_f32_16x16x32_bf16 v[24:27], v[240:243], v[120:123], 0
    v_mfma_f32_16x16x32_bf16 v[28:31], v[240:243], v[124:127], 0
    v_mfma_f32_16x16x32_bf16 v[32:35], v[240:243], v[128:131], 0
    v_mfma_f32_16x16x32_bf16 v[36:39], v[240:243], v[132:135], 0
    v_mfma_f32_16x16x32_bf16 v[40:43], v[240:243], v[136:139], 0
    v_mfma_f32_16x16x32_bf16 v[44:47], v[240:243], v[140:143], 0
L_conv:
    v_mfma_f32_16x16x32_bf16 v[16:19], v[48:51], v[112:115], v[16:19]
    ds_read_b128 v[144:147], v233 offset:3648
    v_mfma_f32_16x16x32_bf16 v[20:23], v[48:51], v[116:119], v[20:23]
    ds_read_b64 v[80:81], v232 offset:64
    v_mfma_f32_16x16x32_bf16 v[20:23], v[52:55], v[112:115], v[20:23]
    ds_read_b64 v[82:83], v232 offset:72
    v_mfma_f32_16x16x32_bf16 v[24:27], v[48:51], v[120:123], v[24:27]
    ds_read_b128 v[148:151], v233 offset:3136
    v_mfma_f32_16x16x32_bf16 v[24:27], v[52:55], v[116:119], v[24:27]
    ds_read_b64 v[84:85], v232 offset:576
    v_mfma_f32_16x16x32_bf16 v[24:27], v[56:59], v[112:115], v[24:27]
    ds_read_b64 v[86:87], v232 offset:584
    v_mfma_f32_16x16x32_bf16 v[28:31], v[48:51], v[124:127], v[28:31]
    ds_read_b128 v[152:155], v233 offset:2624
    v_mfma_f32_16x16x32_bf16 v[28:31], v[52:55], v[120:123], v[28:31]
    ds_read_b64 v[88:89], v232 offset:1088
    v_mfma_f32_16x16x32_bf16 v[28:31], v[56:59], v[116:119], v[28:31]
    ds_read_b64 v[90:91], v232 offset:1096
    v_mfma_f32_16x16x32_bf16 v[28:31], v[60:63], v[112:115], v[28:31]
    ds_read_b128 v[156:159], v233 offset:2112
    v_mfma_f32_16x16x32_bf16 v[32:35], v[48:51], v[128:131], v[32:35]
    ds_read_b64 v[92:93], v232 offset:1600
    v_mfma_f32_16x16x32_bf16 v[32:35], v[52:55], v[124:127], v[32:35]
    ds_read_b64 v[94:95], v232 offset:1608
    v_mfma_f32_16x16x32_bf16 v[32:35], v[56:59], v[120:123], v[32:35]
    ds_read_b128 v[160:163], v233 offset:1600
    v_mfma_f32_16x16x32_bf16 v[32:35], v[60:63], v[116:119], v[32:35]
    ds_read_b64 v[96:97], v232 offset:2112
    v_mfma_f32_16x16x32_bf16 v[32:35], v[64:67], v[112:115], v[32:35]
    ds_read_b64 v[98:99], v232 offset:2120
    v_mfma_f32_16x16x32_bf16 v[36:39], v[48:51], v[132:135], v[36:39]
    ds_read_b128 v[164:167], v233 offset:1088
    v_mfma_f32_16x16x32_bf16 v[36:39], v[52:55], v[128:131], v[36:39]
    ds_read_b64 v[100:101], v232 offset:2624
    v_mfma_f32_16x16x32_bf16 v[36:39], v[56:59], v[124:127], v[36:39]
    ds_read_b64 v[102:103], v232 offset:2632
    v_mfma_f32_16x16x32_bf16 v[36:39], v[60:63], v[120:123], v[36:39]
    ds_read_b128 v[168:171], v233 offset:576
    v_mfma_f32_16x16x32_bf16 v[36:39], v[64:67], v[116:119], v[36:39]
    ds_read_b64 v[104:105], v232 offset:3136
    v_mfma_f32_16x16x32_bf16 v[36:39], v[68:71], v[112:115], v[36:39]
    ds_read_b64 v[106:107], v232 offset:3144
    v_mfma_f32_16x16x32_bf16 v[40:43], v[48:51], v[136:139], v[40:43]
    ds_read_b128 v[172:175], v233 offset:64
    v_mfma_f32_16x16x32_bf16 v[40:43], v[52:55], v[132:135], v[40:43]
    ds_read_b64 v[108:109], v232 offset:3648
    v_mfma_f32_16x16x32_bf16 v[40:43], v[56:59], v[128:131], v[40:43]
    ds_read_b64 v[110:111], v232 offset:3656
    v_mfma_f32_16x16x32_bf16 v[40:43], v[60:63], v[124:127], v[40:43]
    v_mfma_f32_16x16x32_bf16 v[40:43], v[64:67], v[120:123], v[40:43]
    v_mfma_f32_16x16x32_bf16 v[40:43], v[68:71], v[116:119], v[40:43]
    v_mfma_f32_16x16x32_bf16 v[40:43], v[72:75], v[112:115], v[40:43]
    v_mfma_f32_16x16x32_bf16 v[44:47], v[48:51], v[140:143], v[44:47]
    v_mfma_f32_16x16x32_bf16 v[44:47], v[52:55], v[136:139], v[44:47]
    v_mfma_f32_16x16x32_bf16 v[44:47], v[56:59], v[132:135], v[44:47]
    v_mfma_f32_16x16x32_bf16 v[44:47], v[60:63], v[128:131], v[44:47]
    v_mfma_f32_16x16x32_bf16 v[44:47], v[64:67], v[124:127], v[44:47]
    v_mfma_f32_16x16x32_bf16 v[44:47], v[68:71], v[120:123], v[44:47]
    v_mfma_f32_16x16x32_bf16 v[44:47], v[72:75], v[116:119], v[44:47]
    v_mfma_f32_16x16x32_bf16 v[44:47], v[76:79], v[112:115], v[44:47]
    s_waitcnt lgkmcnt(0)
    v_mfma_f32_16x16x32_bf16 v[16:19], v[80:83], v[144:147], v[16:19]
    ds_read_b128 v[112:115], v233 offset:3712
    v_mfma_f32_16x16x32_bf16 v[20:23], v[80:83], v[148:151], v[20:23]
    ds_read_b64 v[48:49], v232 offset:128
    v_mfma_f32_16x16x32_bf16 v[20:23], v[84:87], v[144:147], v[20:23]
    ds_read_b64 v[50:51], v232 offset:136
    v_mfma_f32_16x16x32_bf16 v[24:27], v[80:83], v[152:155], v[24:27]
    ds_read_b128 v[116:119], v233 offset:3200
    v_mfma_f32_16x16x32_bf16 v[24:27], v[84:87], v[148:151], v[24:27]
    ds_read_b64 v[52:53], v232 offset:640
    v_mfma_f32_16x16x32_bf16 v[24:27], v[88:91], v[144:147], v[24:27]
    ds_read_b64 v[54:55], v232 offset:648
    v_mfma_f32_16x16x32_bf16 v[28:31], v[80:83], v[156:159], v[28:31]
    ds_read_b128 v[120:123], v233 offset:2688
    v_mfma_f32_16x16x32_bf16 v[28:31], v[84:87], v[152:155], v[28:31]
    ds_read_b64 v[56:57], v232 offset:1152
    v_mfma_f32_16x16x32_bf16 v[28:31], v[88:91], v[148:151], v[28:31]
    ds_read_b64 v[58:59], v232 offset:1160
    v_mfma_f32_16x16x32_bf16 v[28:31], v[92:95], v[144:147], v[28:31]
    ds_read_b128 v[124:127], v233 offset:2176
    v_mfma_f32_16x16x32_bf16 v[32:35], v[80:83], v[160:163], v[32:35]
    ds_read_b64 v[60:61], v232 offset:1664
    v_mfma_f32_16x16x32_bf16 v[32:35], v[84:87], v[156:159], v[32:35]
    ds_read_b64 v[62:63], v232 offset:1672
    v_mfma_f32_16x16x32_bf16 v[32:35], v[88:91], v[152:155], v[32:35]
    ds_read_b128 v[128:131], v233 offset:1664
    v_mfma_f32_16x16x32_bf16 v[32:35], v[92:95], v[148:151], v[32:35]
    ds_read_b64 v[64:65], v232 offset:2176
    v_mfma_f32_16x16x32_bf16 v[32:35], v[96:99], v[144:147], v[32:35]
    ds_read_b64 v[66:67], v232 offset:2184
    v_mfma_f32_16x16x32_bf16 v[36:39], v[80:83], v[164:167], v[36:39]
    ds_read_b128 v[132:135], v233 offset:1152
    v_mfma_f32_16x16x32_bf16 v[36:39], v[84:87], v[160:163], v[36:39]
    ds_read_b64 v[68:69], v232 offset:2688
    v_mfma_f32_16x16x32_bf16 v[36:39], v[88:91], v[156:159], v[36:39]
    ds_read_b64 v[70:71], v232 offset:2696
    v_mfma_f32_16x16x32_bf16 v[36:39], v[92:95], v[152:155], v[36:39]
    ds_read_b128 v[136:139], v233 offset:640
    v_mfma_f32_16x16x32_bf16 v[36:39], v[96:99], v[148:151], v[36:39]
    ds_read_b64 v[72:73], v232 offset:3200
    v_mfma_f32_16x16x32_bf16 v[36:39], v[100:103], v[144:147], v[36:39]
    ds_read_b64 v[74:75], v232 offset:3208
    v_mfma_f32_16x16x32_bf16 v[40:43], v[80:83], v[168:171], v[40:43]
    ds_read_b128 v[140:143], v233 offset:128
    v_mfma_f32_16x16x32_bf16 v[40:43], v[84:87], v[164:167], v[40:43]
    ds_read_b64 v[76:77], v232 offset:3712
    v_mfma_f32_16x16x32_bf16 v[40:43], v[88:91], v[160:163], v[40:43]
    ds_read_b64 v[78:79], v232 offset:3720
    v_mfma_f32_16x16x32_bf16 v[40:43], v[92:95], v[156:159], v[40:43]
    v_add_u32 v232, 128, v232
    v_mfma_f32_16x16x32_bf16 v[40:43], v[96:99], v[152:155], v[40:43]
    v_add_u32 v233, 128, v233
    v_mfma_f32_16x16x32_bf16 v[40:43], v[100:103], v[148:151], v[40:43]
    s_sub_u32 s74, s74, 1
    v_mfma_f32_16x16x32_bf16 v[40:43], v[104:107], v[144:147], v[40:43]
    s_cmp_lg_u32 s74, 0
    v_mfma_f32_16x16x32_bf16 v[44:47], v[80:83], v[172:175], v[44:47]
    v_mfma_f32_16x16x32_bf16 v[44:47], v[84:87], v[168:171], v[44:47]
    v_mfma_f32_16x16x32_bf16 v[44:47], v[88:91], v[164:167], v[44:47]
    v_mfma_f32_16x16x32_bf16 v[44:47], v[92:95], v[160:163], v[44:47]
    v_mfma_f32_16x16x32_bf16 v[44:47], v[96:99], v[156:159], v[44:47]
    v_mfma_f32_16x16x32_bf16 v[44:47], v[100:103], v[152:155], v[44:47]
    v_mfma_f32_16x16x32_bf16 v[44:47], v[104:107], v[148:151], v[44:47]
    v_mfma_f32_16x16x32_bf16 v[44:47], v[108:111], v[144:147], v[44:47]
    s_waitcnt lgkmcnt(0)
    s_cbranch_scc1 L_conv
    v_mfma_f32_16x16x32_bf16 v[16:19], v[48:51], v[112:115], v[16:19]
    ds_read_b128 v[144:147], v233 offset:3648
    v_mfma_f32_16x16x32_bf16 v[20:23], v[48:51], v[116:119], v[20:23]
    ds_read_b64 v[80:81], v232 offset:64
    v_mfma_f32_16x16x32_bf16 v[20:23], v[52:55], v[112:115], v[20:23]
    ds_read_b64 v[82:83], v232 offset:72
    v_mfma_f32_16x16x32_bf16 v[24:27], v[48:51], v[120:123], v[24:27]
    ds_read_b128 v[148:151], v233 offset:3136
    v_mfma_f32_16x16x32_bf16 v[24:27], v[52:55], v[116:119], v[24:27]
    ds_read_b64 v[84:85], v232 offset:576
    v_mfma_f32_16x16x32_bf16 v[24:27], v[56:59], v[112:115], v[24:27]
    ds_read_b64 v[86:87], v232 offset:584
    v_mfma_f32_16x16x32_bf16 v[28:31], v[48:51], v[124:127], v[28:31]
    ds_read_b128 v[152:155], v233 offset:2624
    v_mfma_f32_16x16x32_bf16 v[28:31], v[52:55], v[120:123], v[28:31]
    ds_read_b64 v[88:89], v232 offset:1088
    v_mfma_f32_16x16x32_bf16 v[28:31], v[56:59], v[116:119], v[28:31]
    ds_read_b64 v[90:91], v232 offset:1096
    v_mfma_f32_16x16x32_bf16 v[28:31], v[60:63], v[112:115], v[28:31]
    ds_read_b128 v[156:159], v233 offset:2112
    v_mfma_f32_16x16x32_bf16 v[32:35], v[48:51], v[128:131], v[32:35]
    ds_read_b64 v[92:93], v232 offset:1600
    v_mfma_f32_16x16x32_bf16 v[32:35], v[52:55], v[124:127], v[32:35]
    ds_read_b64 v[94:95], v232 offset:1608
    v_mfma_f32_16x16x32_bf16 v[32:35], v[56:59], v[120:123], v[32:35]
    ds_read_b128 v[160:163], v233 offset:1600
    v_mfma_f32_16x16x32_bf16 v[32:35], v[60:63], v[116:119], v[32:35]
    ds_read_b64 v[96:97], v232 offset:2112
    v_mfma_f32_16x16x32_bf16 v[32:35], v[64:67], v[112:115], v[32:35]
    ds_read_b64 v[98:99], v232 offset:2120
    v_mfma_f32_16x16x32_bf16 v[36:39], v[48:51], v[132:135], v[36:39]
    ds_read_b128 v[164:167], v233 offset:1088
    v_mfma_f32_16x16x32_bf16 v[36:39], v[52:55], v[128:131], v[36:39]
    ds_read_b64 v[100:101], v232 offset:2624
    v_mfma_f32_16x16x32_bf16 v[36:39], v[56:59], v[124:127], v[36:39]
    ds_read_b64 v[102:103], v232 offset:2632
    v_mfma_f32_16x16x32_bf16 v[36:39], v[60:63], v[120:123], v[36:39]
    ds_read_b128 v[168:171], v233 offset:576
    v_mfma_f32_16x16x32_bf16 v[36:39], v[64:67], v[116:119], v[36:39]
    ds_read_b64 v[104:105], v232 offset:3136
    v_mfma_f32_16x16x32_bf16 v[36:39], v[68:71], v[112:115], v[36:39]
    ds_read_b64 v[106:107], v232 offset:3144
    v_mfma_f32_16x16x32_bf16 v[40:43], v[48:51], v[136:139], v[40:43]
    ds_read_b128 v[172:175], v233 offset:64
    v_mfma_f32_16x16x32_bf16 v[40:43], v[52:55], v[132:135], v[40:43]
    ds_read_b64 v[108:109], v232 offset:3648
    v_mfma_f32_16x16x32_bf16 v[40:43], v[56:59], v[128:131], v[40:43]
    ds_read_b64 v[110:111], v232 offset:3656
    v_mfma_f32_16x16x32_bf16 v[40:43], v[60:63], v[124:127], v[40:43]
    s_mul_i32 s74, s68, 4224
    v_mfma_f32_16x16x32_bf16 v[40:43], v[64:67], v[120:123], v[40:43]
    s_and_b32 s75, s71, 63
    v_mfma_f32_16x16x32_bf16 v[40:43], v[68:71], v[116:119], v[40:43]
    s_add_u32 s74, s74, s75
    v_mfma_f32_16x16x32_bf16 v[40:43], v[72:75], v[112:115], v[40:43]
    s_lshl_b32 s74, s74, 6
    v_mfma_f32_16x16x32_bf16 v[44:47], v[48:51], v[140:143], v[44:47]
    v_and_b32 v234, 3, v0
    v_mfma_f32_16x16x32_bf16 v[44:47], v[52:55], v[136:139], v[44:47]
    v_lshl_add_u32 v234, v234, 4, s74
    v_mfma_f32_16x16x32_bf16 v[44:47], v[56:59], v[132:135], v[44:47]
    v_and_b32 v235, 12, v0
    v_mfma_f32_16x16x32_bf16 v[44:47], v[60:63], v[128:131], v[44:47]
    v_lshrrev_b32 v236, 4, v0
    v_mfma_f32_16x16x32_bf16 v[44:47], v[64:67], v[124:127], v[44:47]
    v_add_u32 v235, v235, v236
    v_mfma_f32_16x16x32_bf16 v[44:47], v[68:71], v[120:123], v[44:47]
    v_mul_u32_u24 v235, 4224, v235
    v_mfma_f32_16x16x32_bf16 v[44:47], v[72:75], v[116:119], v[44:47]
    v_add_u32 v234, v234, v235
    v_mfma_f32_16x16x32_bf16 v[44:47], v[76:79], v[112:115], v[44:47]
    s_waitcnt lgkmcnt(0)
    v_mfma_f32_16x16x32_bf16 v[16:19], v[80:83], v[144:147], v[16:19]
    s_bfe_u32 s86, s2, 0x10002
    s_lshr_b32 s74, s2, 5
    v_mfma_f32_16x16x32_bf16 v[20:23], v[80:83], v[148:151], v[20:23]
    s_lshl3_add_u32 s86, s86, s74
    v_lshrrev_b32 v236, 4, v0
    v_mfma_f32_16x16x32_bf16 v[20:23], v[84:87], v[144:147], v[20:23]
    v_lshlrev_b32 v236, 1, v236
    v_xor_b32 v236, v0, v236
    v_mfma_f32_16x16x32_bf16 v[24:27], v[80:83], v[152:155], v[24:27]
    v_and_b32 v236, 7, v236
    s_lshl_b32 s74, s86, 7
    v_cvt_pk_bf16_f32 v48, v16, v17
    v_cvt_pk_bf16_f32 v49, v18, v19
    v_mfma_f32_16x16x32_bf16 v[24:27], v[84:87], v[148:151], v[24:27]
    v_lshl_add_u32 v236, v236, 4, s74
    v_lshrrev_b32 v235, 3, v0
    v_cvt_pk_bf16_f32 v50, v20, v21
    v_cvt_pk_bf16_f32 v51, v22, v23
    v_mfma_f32_16x16x32_bf16 v[24:27], v[88:91], v[144:147], v[24:27]
    v_lshl_add_u32 v235, v235, 11, v236
    s_mov_b32 s56, s24
    s_mov_b32 s76, 0
    buffer_store_dwordx4 v[48:51], v234, s[64:67], s76 offen sc1
    v_mfma_f32_16x16x32_bf16 v[28:31], v[80:83], v[156:159], v[28:31]
    s_mov_b32 s57, s25
    s_mov_b32 s58, 0x200000
    v_mfma_f32_16x16x32_bf16 v[28:31], v[84:87], v[152:155], v[28:31]
    s_mov_b32 s59, 0x20000
    s_mul_i32 s74, s86, 4
    v_cvt_pk_bf16_f32 v52, v24, v25
    v_cvt_pk_bf16_f32 v53, v26, v27
    v_mfma_f32_16x16x32_bf16 v[28:31], v[88:91], v[148:151], v[28:31]
    s_and_b32 s74, s74, 7
    s_lshl1_add_u32 s82, s74, s70
    v_mfma_f32_16x16x32_bf16 v[28:31], v[92:95], v[144:147], v[28:31]
    s_lshl_b32 s82, s82, 17
    s_lshl4_add_u32 s73, s68, 256
    v_mfma_f32_16x16x32_bf16 v[32:35], v[80:83], v[160:163], v[32:35]
    s_add_u32 s45, s73, s69
    s_lshl_b32 s73, s73, 8
    v_mfma_f32_16x16x32_bf16 v[32:35], v[84:87], v[156:159], v[32:35]
    s_lshl_b32 s45, s45, 8
    v_mfma_f32_16x16x32_bf16 v[32:35], v[88:91], v[152:155], v[32:35]
    v_mfma_f32_16x16x32_bf16 v[32:35], v[92:95], v[148:151], v[32:35]
    v_mfma_f32_16x16x32_bf16 v[32:35], v[96:99], v[144:147], v[32:35]
    v_cvt_pk_bf16_f32 v54, v28, v29
    v_cvt_pk_bf16_f32 v55, v30, v31
    v_mfma_f32_16x16x32_bf16 v[36:39], v[80:83], v[164:167], v[36:39]
    s_mov_b32 s76, 67584
    buffer_store_dwordx4 v[52:55], v234, s[64:67], s76 offen sc1
    v_mfma_f32_16x16x32_bf16 v[36:39], v[84:87], v[160:163], v[36:39]
    v_mfma_f32_16x16x32_bf16 v[36:39], v[88:91], v[156:159], v[36:39]
    v_mfma_f32_16x16x32_bf16 v[36:39], v[92:95], v[152:155], v[36:39]
    v_cvt_pk_bf16_f32 v56, v32, v33
    v_cvt_pk_bf16_f32 v57, v34, v35
    v_mfma_f32_16x16x32_bf16 v[36:39], v[96:99], v[148:151], v[36:39]
    v_mfma_f32_16x16x32_bf16 v[36:39], v[100:103], v[144:147], v[36:39]
    v_mfma_f32_16x16x32_bf16 v[40:43], v[80:83], v[168:171], v[40:43]
    v_mfma_f32_16x16x32_bf16 v[40:43], v[84:87], v[164:167], v[40:43]
    v_mfma_f32_16x16x32_bf16 v[40:43], v[88:91], v[160:163], v[40:43]
    v_mfma_f32_16x16x32_bf16 v[40:43], v[92:95], v[156:159], v[40:43]
    v_mfma_f32_16x16x32_bf16 v[40:43], v[96:99], v[152:155], v[40:43]
    v_mfma_f32_16x16x32_bf16 v[40:43], v[100:103], v[148:151], v[40:43]
    v_mfma_f32_16x16x32_bf16 v[40:43], v[104:107], v[144:147], v[40:43]
    v_mfma_f32_16x16x32_bf16 v[44:47], v[80:83], v[172:175], v[44:47]
    v_cvt_pk_bf16_f32 v58, v36, v37
    v_cvt_pk_bf16_f32 v59, v38, v39
    v_mfma_f32_16x16x32_bf16 v[44:47], v[84:87], v[168:171], v[44:47]
    s_mov_b32 s76, 135168
    buffer_store_dwordx4 v[56:59], v234, s[64:67], s76 offen sc1
    v_mfma_f32_16x16x32_bf16 v[44:47], v[88:91], v[164:167], v[44:47]
    v_mfma_f32_16x16x32_bf16 v[44:47], v[92:95], v[160:163], v[44:47]
    v_cvt_pk_bf16_f32 v60, v40, v41
    v_cvt_pk_bf16_f32 v61, v42, v43
    v_mfma_f32_16x16x32_bf16 v[44:47], v[96:99], v[156:159], v[44:47]
    v_mfma_f32_16x16x32_bf16 v[44:47], v[100:103], v[152:155], v[44:47]
    v_mfma_f32_16x16x32_bf16 v[44:47], v[104:107], v[148:151], v[44:47]
    v_mfma_f32_16x16x32_bf16 v[44:47], v[108:111], v[144:147], v[44:47]
    s_nop 7
    v_cvt_pk_bf16_f32 v62, v44, v45
    v_cvt_pk_bf16_f32 v63, v46, v47
    s_mov_b32 s76, 202752
    buffer_store_dwordx4 v[60:63], v234, s[64:67], s76 offen sc1
    s_setprio 1
    s_waitcnt vmcnt(0)
    v_mov_b32 v238, 1
    s_mov_b64 exec, 1
    ds_add_rtn_u32 v237, v227, v238 offset:8
    s_waitcnt lgkmcnt(0)
    v_readfirstlane_b32 s76, v237
    s_nop 0
    s_cmp_eq_u32 s76, 3
    s_cbranch_scc0 L_jo_29a
    s_mov_b64 exec, 0xffff
    v_lshlrev_b32 v237, 8, v0
    buffer_atomic_add v238, v237, s[52:55], s73 offen sc1
L_jo_29a:
    s_mov_b64 exec, -1
    v_lshlrev_b32 v112, 16, v208
    v_and_b32 v113, 0xffff0000, v208
    v_lshlrev_b32 v114, 16, v209
    v_and_b32 v115, 0xffff0000, v209
    v_lshlrev_b32 v116, 16, v210
    v_and_b32 v117, 0xffff0000, v210
    v_lshlrev_b32 v118, 16, v211
    v_and_b32 v119, 0xffff0000, v211
    v_lshlrev_b32 v120, 16, v212
    v_and_b32 v121, 0xffff0000, v212
    v_lshlrev_b32 v122, 16, v213
    v_and_b32 v123, 0xffff0000, v213
    v_lshlrev_b32 v124, 16, v214
    v_and_b32 v125, 0xffff0000, v214
    v_lshlrev_b32 v126, 16, v215
    v_and_b32 v127, 0xffff0000, v215
    v_lshlrev_b32 v128, 16, v216
    v_and_b32 v129, 0xffff0000, v216
    v_lshlrev_b32 v130, 16, v217
    v_and_b32 v131, 0xffff0000, v217
    v_lshlrev_b32 v132, 16, v218
    v_and_b32 v133, 0xffff0000, v218
    v_lshlrev_b32 v134, 16, v219
    v_and_b32 v135, 0xffff0000, v219
    v_lshlrev_b32 v136, 16, v220
    v_and_b32 v137, 0xffff0000, v220
    v_lshlrev_b32 v138, 16, v221
    v_and_b32 v139, 0xffff0000, v221
    v_lshlrev_b32 v140, 16, v222
    v_and_b32 v141, 0xffff0000, v222
    v_lshlrev_b32 v142, 16, v223
    v_and_b32 v143, 0xffff0000, v223
    s_setprio 1
    s_add_u32 m0, s80, 0
    s_add_u32 s83, s82, 1310720
    s_and_b32 s83, s83, 0x1fffff
    buffer_load_dwordx4 v235, s[56:59], s83 offen lds
    s_add_u32 m0, s80, 1024
    s_add_u32 s83, s82, 1327104
    s_and_b32 s83, s83, 0x1fffff
    buffer_load_dwordx4 v235, s[56:59], s83 offen lds
    s_add_u32 m0, s80, 2048
    s_add_u32 s83, s82, 1343488
    s_and_b32 s83, s83, 0x1fffff
    buffer_load_dwordx4 v235, s[56:59], s83 offen lds
    s_add_u32 m0, s80, 3072
    s_add_u32 s83, s82, 1359872
    s_and_b32 s83, s83, 0x1fffff
    buffer_load_dwordx4 v235, s[56:59], s83 offen lds
    s_add_u32 m0, s80, 4096
    s_add_u32 s83, s82, 1376256
    s_and_b32 s83, s83, 0x1fffff
    buffer_load_dwordx4 v235, s[56:59], s83 offen lds
    s_add_u32 m0, s80, 5120
    s_add_u32 s83, s82, 1392640
    s_and_b32 s83, s83, 0x1fffff
    buffer_load_dwordx4 v235, s[56:59], s83 offen lds
    s_add_u32 m0, s80, 6144
    s_add_u32 s83, s82, 1409024
    s_and_b32 s83, s83, 0x1fffff
    buffer_load_dwordx4 v235, s[56:59], s83 offen lds
    s_add_u32 m0, s80, 7168
    s_add_u32 s83, s82, 1425408
    s_and_b32 s83, s83, 0x1fffff
    buffer_load_dwordx4 v235, s[56:59], s83 offen lds
    s_cmp_ge_u32 s70, 2
    s_cbranch_scc1 L_nowo3
    s_add_u32 m0, s81, 0
    s_add_u32 s83, s82, 1835008
    s_and_b32 s83, s83, 0x1fffff
    buffer_load_dwordx4 v235, s[56:59], s83 offen lds
    s_add_u32 m0, s81, 1024
    s_add_u32 s83, s82, 1851392
    s_and_b32 s83, s83, 0x1fffff
    buffer_load_dwordx4 v235, s[56:59], s83 offen lds
    s_add_u32 m0, s81, 2048
    s_add_u32 s83, s82, 1867776
    s_and_b32 s83, s83, 0x1fffff
    buffer_load_dwordx4 v235, s[56:59], s83 offen lds
    s_add_u32 m0, s81, 3072
    s_add_u32 s83, s82, 1884160
    s_and_b32 s83, s83, 0x1fffff
    buffer_load_dwordx4 v235, s[56:59], s83 offen lds
    s_add_u32 m0, s81, 4096
    s_add_u32 s83, s82, 1900544
    s_and_b32 s83, s83, 0x1fffff
    buffer_load_dwordx4 v235, s[56:59], s83 offen lds
    s_add_u32 m0, s81, 5120
    s_add_u32 s83, s82, 1916928
    s_and_b32 s83, s83, 0x1fffff
    buffer_load_dwordx4 v235, s[56:59], s83 offen lds
    s_add_u32 m0, s81, 6144
    s_add_u32 s83, s82, 1933312
    s_and_b32 s83, s83, 0x1fffff
    buffer_load_dwordx4 v235, s[56:59], s83 offen lds
    s_add_u32 m0, s81, 7168
    s_add_u32 s83, s82, 1949696
    s_and_b32 s83, s83, 0x1fffff
    buffer_load_dwordx4 v235, s[56:59], s83 offen lds
L_nowo3:
    s_setprio 1
    s_mul_i32 s77, s70, 4352
    s_add_u32 s77, s77, 60416
    v_lshrrev_b32 v234, 5, v0
    v_lshl_add_u32 v234, v234, 1, v0
    v_lshl_add_u32 v234, v234, 4, s77
    v_and_b32 v235, 7, v0
    v_mul_u32_u24 v235, 544, v235
    v_lshrrev_b32 v236, 3, v0
    v_lshl_add_u32 v235, v236, 3, v235
    v_add_u32 v235, s77, v235
    s_mul_i32 s77, s71, 4224
    s_mov_b32 s60, s26
    s_mov_b32 s61, s27
    s_mov_b32 s62, 0x800000
    s_mov_b32 s63, 0x20000
    s_waitcnt vmcnt(0)
    s_mov_b64 exec, 1
    ds_add_u32 v227, v244 offset:12
    s_mov_b64 exec, -1
    s_cmp_eq_u32 s76, 3
    s_cbranch_scc0 L_jo_29
    s_mov_b32 s75, 131072
L_sg_loop_32:
    s_load_dword s74, s[52:53], s45 glc
L_sg_chk_33:
    s_waitcnt lgkmcnt(0)
    s_cmp_ge_u32 s74, 16
    s_cbranch_scc1 L_sg_done_31
    s_sub_u32 s75, s75, 1
    s_cbranch_scc0 L_sg_loop_32
L_sg_done_31:
    v_mov_b32 v237, 16
    s_mov_b64 exec, 1
    ds_add_u32 v227, v237 offset:16
    s_mov_b64 exec, -1
    s_branch L_jd_30
L_jo_29:
    s_mov_b32 s75, 1048576
L_sl_loop_35:
    ds_read_b32 v237, v227 offset:16
    s_waitcnt lgkmcnt(0)
    v_readfirstlane_b32 s74, v237
    s_nop 0
    s_cmp_ge_u32 s74, 16
    s_cbranch_scc1 L_sl_done_34
    s_sleep 1
    s_sub_u32 s75, s75, 1
    s_cbranch_scc0 L_sl_loop_35
L_sl_done_34:
L_jd_30:
    buffer_load_dwordx4 v[48:51], v224, s[64:67], s77 offen offset:0 sc1
    buffer_load_dwordx4 v[52:55], v224, s[64:67], s77 offen offset:1024 sc1
    buffer_load_dwordx4 v[56:59], v224, s[64:67], s77 offen offset:2048 sc1
    buffer_load_dwordx4 v[60:63], v224, s[64:67], s77 offen offset:3072 sc1
    s_waitcnt vmcnt(3)
    ds_write_b128 v234, v[48:51] offset:0
    s_waitcnt vmcnt(2)
    ds_write_b128 v234, v[52:55] offset:1088
    s_waitcnt vmcnt(1)
    ds_write_b128 v234, v[56:59] offset:2176
    s_waitcnt vmcnt(0)
    ds_write_b128 v234, v[60:63] offset:3264
    ds_read_b64 v[64:65], v235 offset:0
    ds_read_b64 v[66:67], v235 offset:64
    ds_read_b64 v[68:69], v235 offset:128
    ds_read_b64 v[70:71], v235 offset:192
    ds_read_b64 v[72:73], v235 offset:256
    ds_read_b64 v[74:75], v235 offset:320
    ds_read_b64 v[76:77], v235 offset:384
    ds_read_b64 v[78:79], v235 offset:448
    s_waitcnt lgkmcnt(7)
    v_lshlrev_b32 v16, 16, v64
    v_and_b32 v24, 0xffff0000, v64
    v_lshlrev_b32 v32, 16, v65
    v_and_b32 v40, 0xffff0000, v65
    s_waitcnt lgkmcnt(6)
    v_lshlrev_b32 v17, 16, v66
    v_and_b32 v25, 0xffff0000, v66
    v_lshlrev_b32 v33, 16, v67
    v_and_b32 v41, 0xffff0000, v67
    s_waitcnt lgkmcnt(5)
    v_lshlrev_b32 v18, 16, v68
    v_and_b32 v26, 0xffff0000, v68
    v_lshlrev_b32 v34, 16, v69
    v_and_b32 v42, 0xffff0000, v69
    s_waitcnt lgkmcnt(4)
    v_lshlrev_b32 v19, 16, v70
    v_and_b32 v27, 0xffff0000, v70
    v_lshlrev_b32 v35, 16, v71
    v_and_b32 v43, 0xffff0000, v71
    s_waitcnt lgkmcnt(3)
    v_lshlrev_b32 v20, 16, v72
    v_and_b32 v28, 0xffff0000, v72
    v_lshlrev_b32 v36, 16, v73
    v_and_b32 v44, 0xffff0000, v73
    s_waitcnt lgkmcnt(2)
    v_lshlrev_b32 v21, 16, v74
    v_and_b32 v29, 0xffff0000, v74
    v_lshlrev_b32 v37, 16, v75
    v_and_b32 v45, 0xffff0000, v75
    s_waitcnt lgkmcnt(1)
    v_lshlrev_b32 v22, 16, v76
    v_and_b32 v30, 0xffff0000, v76
    v_lshlrev_b32 v38, 16, v77
    v_and_b32 v46, 0xffff0000, v77
    s_waitcnt lgkmcnt(0)
    v_lshlrev_b32 v23, 16, v78
    v_and_b32 v31, 0xffff0000, v78
    v_lshlrev_b32 v39, 16, v79
    v_and_b32 v47, 0xffff0000, v79
    v_mul_f32 v16, v16, v112
    v_mul_f32 v17, v17, v113
    v_mul_f32 v18, v18, v114
    v_mul_f32 v19, v19, v115
    v_mul_f32 v20, v20, v116
    v_mul_f32 v21, v21, v117
    v_mul_f32 v22, v22, v118
    v_mul_f32 v23, v23, v119
    v_cvt_pk_bf16_f32 v48, v16, v17
    v_cvt_pk_bf16_f32 v49, v18, v19
    v_cvt_pk_bf16_f32 v50, v20, v21
    v_cvt_pk_bf16_f32 v51, v22, v23
    s_mov_b32 s74, 0
    buffer_store_dwordx4 v[48:51], v226, s[60:63], s74 offen nt
    v_mul_f32 v24, v24, v120
    v_mul_f32 v25, v25, v121
    v_mul_f32 v26, v26, v122
    v_mul_f32 v27, v27, v123
    v_mul_f32 v28, v28, v124
    v_mul_f32 v29, v29, v125
    v_mul_f32 v30, v30, v126
    v_mul_f32 v31, v31, v127
    v_cvt_pk_bf16_f32 v52, v24, v25
    v_cvt_pk_bf16_f32 v53, v26, v27
    v_cvt_pk_bf16_f32 v54, v28, v29
    v_cvt_pk_bf16_f32 v55, v30, v31
    s_mov_b32 s74, 4096
    buffer_store_dwordx4 v[52:55], v226, s[60:63], s74 offen nt
    v_mul_f32 v32, v32, v128
    v_mul_f32 v33, v33, v129
    v_mul_f32 v34, v34, v130
    v_mul_f32 v35, v35, v131
    v_mul_f32 v36, v36, v132
    v_mul_f32 v37, v37, v133
    v_mul_f32 v38, v38, v134
    v_mul_f32 v39, v39, v135
    v_cvt_pk_bf16_f32 v56, v32, v33
    v_cvt_pk_bf16_f32 v57, v34, v35
    v_cvt_pk_bf16_f32 v58, v36, v37
    v_cvt_pk_bf16_f32 v59, v38, v39
    s_mov_b32 s74, 16384
    buffer_store_dwordx4 v[56:59], v226, s[60:63], s74 offen nt
    v_mul_f32 v40, v40, v136
    v_mul_f32 v41, v41, v137
    v_mul_f32 v42, v42, v138
    v_mul_f32 v43, v43, v139
    v_mul_f32 v44, v44, v140
    v_mul_f32 v45, v45, v141
    v_mul_f32 v46, v46, v142
    v_mul_f32 v47, v47, v143
    v_cvt_pk_bf16_f32 v60, v40, v41
    v_cvt_pk_bf16_f32 v61, v42, v43
    v_cvt_pk_bf16_f32 v62, v44, v45
    v_cvt_pk_bf16_f32 v63, v46, v47
    s_mov_b32 s74, 20480
    buffer_store_dwordx4 v[60:63], v226, s[60:63], s74 offen nt
    s_endpgm
L_grole:
    s_setprio 2
    s_add_u32 s52, s30, 0xe00000
    s_addc_u32 s53, s31, 0
    s_mov_b32 s54, 0x20000
    s_mov_b32 s55, 0x20000
    s_lshr_b32 s32, s3, 1
    s_and_b32 s33, s3, 1
    v_and_b32 v1, 15, v0
    v_lshrrev_b32 v2, 4, v0
    v_lshrrev_b32 v3, 1, v1
    v_xor_b32 v3, v2, v3
    v_lshlrev_b32 v3, 4, v3
    v_lshl_add_u32 v3, v1, 7, v3
    s_lshl_b32 s37, s33, 13
    v_add_u32 v196, s37, v3
    v_xor_b32 v197, 64, v196
    v_and_b32 v3, 6, v1
    v_xor_b32 v3, v2, v3
    v_lshlrev_b32 v3, 4, v3
    v_and_b32 v198, 7, v1
    v_lshl_add_u32 v3, v198, 7, v3
    v_add_u32 v198, 16384, v3
    v_xor_b32 v199, 64, v198
    v_bfe_u32 v3, v0, 2, 2
    v_lshl_add_u32 v200, v2, 3, v3
    v_lshlrev_b32 v200, 7, v200
    v_bfe_u32 v3, v0, 3, 2
    v_xor_b32 v3, s3, v3
    v_lshl_add_u32 v200, v3, 5, v200
    v_and_b32 v3, 3, v0
    v_lshl_add_u32 v200, v3, 3, v200
    v_add_u32 v200, 17408, v200
    v_xor_b32 v201, 32, v200
    v_mov_b64 v[52:53], 0
    v_mov_b64 v[54:55], 0
    v_mov_b64 v[56:57], 0
    v_mov_b64 v[58:59], 0
    v_mov_b64 v[60:61], 0
    v_mov_b64 v[62:63], 0
    v_mov_b64 v[64:65], 0
    v_mov_b64 v[66:67], 0
    v_mov_b64 v[68:69], 0
    v_mov_b64 v[70:71], 0
    v_mov_b64 v[72:73], 0
    v_mov_b64 v[74:75], 0
    v_mov_b64 v[76:77], 0
    v_mov_b64 v[78:79], 0
    v_mov_b64 v[80:81], 0
    v_mov_b64 v[82:83], 0
    v_mov_b64 v[84:85], 0
    v_mov_b64 v[86:87], 0
    v_mov_b64 v[88:89], 0
    v_mov_b64 v[90:91], 0
    v_mov_b64 v[92:93], 0
    v_mov_b64 v[94:95], 0
    v_mov_b64 v[96:97], 0
    v_mov_b64 v[98:99], 0
    v_mov_b64 v[100:101], 0
    v_mov_b64 v[102:103], 0
    v_mov_b64 v[104:105], 0
    v_mov_b64 v[106:107], 0
    s_mov_b32 s34, 0
    v_mov_b32 v228, 134352
    v_and_b32 v1, 15, v0
    v_lshrrev_b32 v2, 4, v0
    v_lshlrev_b32 v2, 2, v2
    v_sub_u32 v1, v1, v2
    s_mov_b32 s37, 0xf149f2ca
    v_mov_b32 v3, s37
    s_or_b32 s38, s5, s33
    s_cmp_eq_u32 s38, 0
    s_cselect_b32 s38, s37, 0
    v_subrev_u32 v2, 0, v1
    v_cmp_gt_u32 vcc, 8, v2
    v_cmp_gt_i32 s[64:65], -8, v2
    v_ashrrev_i32 v2, 31, v2
    v_cndmask_b32 v204, v3, 0, vcc
    v_cndmask_b32 v208, v3, 0, s[64:65]
    v_mov_b32 v216, v2
    v_min_f32 v212, s38, v208
    v_subrev_u32 v2, 1, v1
    v_cmp_gt_u32 vcc, 8, v2
    v_cmp_gt_i32 s[64:65], -8, v2
    v_ashrrev_i32 v2, 31, v2
    v_cndmask_b32 v205, v3, 0, vcc
    v_cndmask_b32 v209, v3, 0, s[64:65]
    v_alignbit_b32 v216, v2, v216, 16
    v_min_f32 v213, s38, v209
    v_subrev_u32 v2, 2, v1
    v_cmp_gt_u32 vcc, 8, v2
    v_cmp_gt_i32 s[64:65], -8, v2
    v_ashrrev_i32 v2, 31, v2
    v_cndmask_b32 v206, v3, 0, vcc
    v_cndmask_b32 v210, v3, 0, s[64:65]
    v_mov_b32 v217, v2
    v_min_f32 v214, s38, v210
    v_subrev_u32 v2, 3, v1
    v_cmp_gt_u32 vcc, 8, v2
    v_cmp_gt_i32 s[64:65], -8, v2
    v_ashrrev_i32 v2, 31, v2
    v_cndmask_b32 v207, v3, 0, vcc
    v_cndmask_b32 v211, v3, 0, s[64:65]
    v_alignbit_b32 v217, v2, v217, 16
    v_min_f32 v215, s38, v211
    s_mul_i32 s37, s32, 80896
    s_add_u32 s37, s37, 78848
    v_lshl_add_u32 v220, v0, 3, s37
    s_lshl_b32 s38, s33, 9
    v_add_u32 v219, s38, v220
    s_mul_i32 s38, s33, 2560
    v_add_u32 v221, s38, v220
    v_xor_b32 v222, 512, v221
    s_lshl3_add_u32 s37, s4, s5
    s_lshl1_add_u32 s37, s37, s33
    s_lshl_b32 s37, s37, 7
    s_lshl1_add_u32 s38, s6, s32
    s_add_u32 s37, s37, s38
    s_lshl_b32 s37, s37, 10
    v_lshl_add_u32 v218, v0, 4, s37
    s_mov_b32 s40, s30
    s_mov_b32 s41, s31
    s_mov_b32 s42, 0x400000
    s_mov_b32 s43, 0x20000
    s_and_b32 s58, s2, 3
    s_bfe_u32 s37, s2, 0x20003
    s_lshl2_add_u32 s58, s58, s37
    s_bfe_u32 s59, s2, 0x10002
    s_lshr_b32 s37, s2, 5
    s_lshl3_add_u32 s59, s59, s37
    s_mov_b32 s44, s24
    s_mov_b32 s45, s25
    s_mov_b32 s46, 0x200000
    s_mov_b32 s47, 0x20000
    s_mov_b32 s48, s26
    s_mov_b32 s49, s27
    s_mov_b32 s50, 0x800000
    s_mov_b32 s51, 0x20000
    s_lshl3_add_u32 s56, s4, s5
    s_lshl4_add_u32 s56, s56, 0
    s_lshl_b32 s56, s56, 8
    s_lshl4_add_u32 s57, s58, 0
    s_add_u32 s57, s57, s59
    s_lshl_b32 s57, s57, 8
    s_lshl2_add_u32 s37, s58, s3
    s_lshl_b32 s38, s37, 16
    v_lshl_add_u32 v224, v0, 4, s38
    v_add_u32 v225, 0x8000, v224
    s_and_b32 s37, s37, 31
    s_lshl_b32 s37, s37, 6
    s_lshr_b32 s38, s58, 3
    s_add_u32 s37, s37, s38
    s_lshl_b32 s37, s37, 5
    s_add_u32 s37, s37, s59
    s_add_u32 s37, s37, 16
    s_lshl_b32 s37, s37, 7
    v_lshrrev_b32 v1, 3, v0
    v_lshl_add_u32 v1, v1, 13, s37
    v_and_b32 v2, 7, v0
    v_lshl_add_u32 v226, v2, 4, v1
    v_lshrrev_b32 v1, 4, v0
    v_lshlrev_b32 v1, 1, v1
    v_xor_b32 v1, v0, v1
    v_and_b32 v1, 7, v1
    s_lshl_b32 s37, s59, 7
    v_lshl_add_u32 v1, v1, 4, s37
    v_lshrrev_b32 v227, 3, v0
    v_lshl_add_u32 v227, v227, 11, v1
    s_lshl_b32 s60, s3, 11
    s_mul_i32 s61, s59, 4
    s_and_b32 s61, s61, 7
    s_lshl3_add_u32 s62, s61, s3
    s_lshl_b32 s62, s62, 15
    v_lshrrev_b32 v1, 2, v0
    v_lshlrev_b32 v1, 7, v1
    v_bfe_u32 v2, v0, 3, 2
    v_lshl_add_u32 v1, v2, 5, v1
    v_and_b32 v2, 3, v0
    v_lshl_add_u32 v229, v2, 3, v1
    v_and_b32 v231, 7, v0
    v_lshl_add_u32 v230, v231, 6, s86
    v_mul_u32_u24 v231, 528, v231
    v_lshrrev_b32 v232, 3, v0
    v_xor_b32 v232, 7, v232
    v_lshl_add_u32 v231, v232, 3, v231
    v_add_u32 v231, s86, v231
    v_lshrrev_b32 v232, 5, v0
    v_add_u32 v232, v0, v232
    v_lshl_add_u32 v232, v232, 4, s86
    s_mul_i32 s87, s84, 4224
    s_sub_u32 s87, s87, s85
    s_lshl_b32 s87, s87, 6
    s_add_u32 s87, s87, 4032
    v_and_b32 v233, 3, v0
    v_lshl_add_u32 v233, v233, 4, s87
    v_lshrrev_b32 v234, 2, v0
    v_mul_u32_u24 v234, 4224, v234
    v_add_u32 v233, v233, v234
    s_add_u32 s80, s30, 0x400000
    s_addc_u32 s81, s31, 0
    s_mov_b32 s82, 0x420000
    s_mov_b32 s83, 0x20000
    s_waitcnt vmcnt(14)
    ds_read_b128 v[36:39], v230 offset:4224
    ds_read_b128 v[40:43], v230 offset:4240
    ds_read_b128 v[44:47], v230 offset:4256
    ds_read_b128 v[48:51], v230 offset:4272
    s_waitcnt lgkmcnt(3)
    v_lshlrev_b32 v152, 16, v36
    v_and_b32 v154, 0xffff0000, v36
    v_lshlrev_b32 v156, 16, v37
    v_and_b32 v158, 0xffff0000, v37
    v_lshlrev_b32 v153, 16, v38
    v_and_b32 v155, 0xffff0000, v38
    v_lshlrev_b32 v157, 16, v39
    v_and_b32 v159, 0xffff0000, v39
    s_waitcnt lgkmcnt(2)
    v_lshlrev_b32 v160, 16, v40
    v_and_b32 v162, 0xffff0000, v40
    v_lshlrev_b32 v164, 16, v41
    v_and_b32 v166, 0xffff0000, v41
    v_lshlrev_b32 v161, 16, v42
    v_and_b32 v163, 0xffff0000, v42
    v_lshlrev_b32 v165, 16, v43
    v_and_b32 v167, 0xffff0000, v43
    s_waitcnt lgkmcnt(1)
    v_lshlrev_b32 v168, 16, v44
    v_and_b32 v170, 0xffff0000, v44
    v_lshlrev_b32 v172, 16, v45
    v_and_b32 v174, 0xffff0000, v45
    v_lshlrev_b32 v169, 16, v46
    v_and_b32 v171, 0xffff0000, v46
    v_lshlrev_b32 v173, 16, v47
    v_and_b32 v175, 0xffff0000, v47
    s_waitcnt lgkmcnt(0)
    v_lshlrev_b32 v176, 16, v48
    v_and_b32 v178, 0xffff0000, v48
    v_lshlrev_b32 v180, 16, v49
    v_and_b32 v182, 0xffff0000, v49
    v_lshlrev_b32 v177, 16, v50
    v_and_b32 v179, 0xffff0000, v50
    v_lshlrev_b32 v181, 16, v51
    v_and_b32 v183, 0xffff0000, v51
    v_mov_b64 v[36:37], 0
    v_mov_b64 v[38:39], 0
    v_mov_b64 v[40:41], 0
    v_mov_b64 v[42:43], 0
    v_mov_b64 v[44:45], 0
    v_mov_b64 v[46:47], 0
    v_mov_b64 v[48:49], 0
    v_mov_b64 v[50:51], 0
    s_waitcnt vmcnt(13)
    v_lshlrev_b32 v184, 16, v108
    v_and_b32 v185, 0xffff0000, v108
    v_lshlrev_b32 v186, 16, v109
    v_and_b32 v187, 0xffff0000, v109
    v_lshlrev_b32 v188, 16, v110
    v_and_b32 v189, 0xffff0000, v110
    v_lshlrev_b32 v190, 16, v111
    v_and_b32 v191, 0xffff0000, v111
    v_pk_mul_f32 v[4:5], v[184:185], v[158:159]
    v_pk_mul_f32 v[12:13], v[186:187], v[166:167]
    v_pk_mul_f32 v[20:21], v[188:189], v[174:175]
    v_pk_mul_f32 v[28:29], v[190:191], v[182:183]
    s_waitcnt vmcnt(12)
    v_lshlrev_b32 v184, 16, v112
    v_and_b32 v185, 0xffff0000, v112
    v_lshlrev_b32 v186, 16, v113
    v_and_b32 v187, 0xffff0000, v113
    v_lshlrev_b32 v188, 16, v114
    v_and_b32 v189, 0xffff0000, v114
    v_lshlrev_b32 v190, 16, v115
    v_and_b32 v191, 0xffff0000, v115
    v_pk_fma_f32 v[4:5], v[184:185], v[156:157], v[4:5]
    v_pk_fma_f32 v[12:13], v[186:187], v[164:165], v[12:13]
    v_pk_fma_f32 v[20:21], v[188:189], v[172:173], v[20:21]
    v_pk_fma_f32 v[28:29], v[190:191], v[180:181], v[28:29]
    v_pk_mul_f32 v[6:7], v[184:185], v[158:159]
    v_pk_mul_f32 v[14:15], v[186:187], v[166:167]
    v_pk_mul_f32 v[22:23], v[188:189], v[174:175]
    v_pk_mul_f32 v[30:31], v[190:191], v[182:183]
    s_waitcnt vmcnt(11)
    v_lshlrev_b32 v184, 16, v116
    v_and_b32 v185, 0xffff0000, v116
    v_lshlrev_b32 v186, 16, v117
    v_and_b32 v187, 0xffff0000, v117
    v_lshlrev_b32 v188, 16, v118
    v_and_b32 v189, 0xffff0000, v118
    v_lshlrev_b32 v190, 16, v119
    v_and_b32 v191, 0xffff0000, v119
    v_pk_fma_f32 v[4:5], v[184:185], v[154:155], v[4:5]
    v_pk_fma_f32 v[12:13], v[186:187], v[162:163], v[12:13]
    v_pk_fma_f32 v[20:21], v[188:189], v[170:171], v[20:21]
    v_pk_fma_f32 v[28:29], v[190:191], v[178:179], v[28:29]
    v_pk_fma_f32 v[6:7], v[184:185], v[156:157], v[6:7]
    v_pk_fma_f32 v[14:15], v[186:187], v[164:165], v[14:15]
    v_pk_fma_f32 v[22:23], v[188:189], v[172:173], v[22:23]
    v_pk_fma_f32 v[30:31], v[190:191], v[180:181], v[30:31]
    v_pk_mul_f32 v[8:9], v[184:185], v[158:159]
    v_pk_mul_f32 v[16:17], v[186:187], v[166:167]
    v_pk_mul_f32 v[24:25], v[188:189], v[174:175]
    v_pk_mul_f32 v[32:33], v[190:191], v[182:183]
    s_waitcnt vmcnt(10)
    v_lshlrev_b32 v184, 16, v120
    v_and_b32 v185, 0xffff0000, v120
    v_lshlrev_b32 v186, 16, v121
    v_and_b32 v187, 0xffff0000, v121
    v_lshlrev_b32 v188, 16, v122
    v_and_b32 v189, 0xffff0000, v122
    v_lshlrev_b32 v190, 16, v123
    v_and_b32 v191, 0xffff0000, v123
    v_pk_fma_f32 v[4:5], v[184:185], v[152:153], v[4:5]
    v_pk_fma_f32 v[12:13], v[186:187], v[160:161], v[12:13]
    v_pk_fma_f32 v[20:21], v[188:189], v[168:169], v[20:21]
    v_pk_fma_f32 v[28:29], v[190:191], v[176:177], v[28:29]
    v_pk_fma_f32 v[6:7], v[184:185], v[154:155], v[6:7]
    v_pk_fma_f32 v[14:15], v[186:187], v[162:163], v[14:15]
    v_pk_fma_f32 v[22:23], v[188:189], v[170:171], v[22:23]
    v_pk_fma_f32 v[30:31], v[190:191], v[178:179], v[30:31]
    v_pk_fma_f32 v[8:9], v[184:185], v[156:157], v[8:9]
    v_pk_fma_f32 v[16:17], v[186:187], v[164:165], v[16:17]
    v_pk_fma_f32 v[24:25], v[188:189], v[172:173], v[24:25]
    v_pk_fma_f32 v[32:33], v[190:191], v[180:181], v[32:33]
    v_pk_mul_f32 v[10:11], v[184:185], v[158:159]
    v_pk_mul_f32 v[18:19], v[186:187], v[166:167]
    v_pk_mul_f32 v[26:27], v[188:189], v[174:175]
    v_pk_mul_f32 v[34:35], v[190:191], v[182:183]
    s_waitcnt vmcnt(9)
    v_lshlrev_b32 v184, 16, v124
    v_and_b32 v185, 0xffff0000, v124
    v_lshlrev_b32 v186, 16, v125
    v_and_b32 v187, 0xffff0000, v125
    v_lshlrev_b32 v188, 16, v126
    v_and_b32 v189, 0xffff0000, v126
    v_lshlrev_b32 v190, 16, v127
    v_and_b32 v191, 0xffff0000, v127
    v_pk_fma_f32 v[6:7], v[184:185], v[152:153], v[6:7]
    v_pk_fma_f32 v[14:15], v[186:187], v[160:161], v[14:15]
    v_pk_fma_f32 v[22:23], v[188:189], v[168:169], v[22:23]
    v_pk_fma_f32 v[30:31], v[190:191], v[176:177], v[30:31]
    v_pk_fma_f32 v[8:9], v[184:185], v[154:155], v[8:9]
    v_pk_fma_f32 v[16:17], v[186:187], v[162:163], v[16:17]
    v_pk_fma_f32 v[24:25], v[188:189], v[170:171], v[24:25]
    v_pk_fma_f32 v[32:33], v[190:191], v[178:179], v[32:33]
    v_pk_fma_f32 v[10:11], v[184:185], v[156:157], v[10:11]
    v_pk_fma_f32 v[18:19], v[186:187], v[164:165], v[18:19]
    v_pk_fma_f32 v[26:27], v[188:189], v[172:173], v[26:27]
    v_pk_fma_f32 v[34:35], v[190:191], v[180:181], v[34:35]
    s_waitcnt vmcnt(8)
    v_lshlrev_b32 v184, 16, v128
    v_and_b32 v185, 0xffff0000, v128
    v_lshlrev_b32 v186, 16, v129
    v_and_b32 v187, 0xffff0000, v129
    v_lshlrev_b32 v188, 16, v130
    v_and_b32 v189, 0xffff0000, v130
    v_lshlrev_b32 v190, 16, v131
    v_and_b32 v191, 0xffff0000, v131
    v_pk_fma_f32 v[8:9], v[184:185], v[152:153], v[8:9]
    v_pk_fma_f32 v[16:17], v[186:187], v[160:161], v[16:17]
    v_pk_fma_f32 v[24:25], v[188:189], v[168:169], v[24:25]
    v_pk_fma_f32 v[32:33], v[190:191], v[176:177], v[32:33]
    v_pk_fma_f32 v[10:11], v[184:185], v[154:155], v[10:11]
    v_pk_fma_f32 v[18:19], v[186:187], v[162:163], v[18:19]
    v_pk_fma_f32 v[26:27], v[188:189], v[170:171], v[26:27]
    v_pk_fma_f32 v[34:35], v[190:191], v[178:179], v[34:35]
    s_waitcnt vmcnt(7)
    v_lshlrev_b32 v184, 16, v132
    v_and_b32 v185, 0xffff0000, v132
    v_lshlrev_b32 v186, 16, v133
    v_and_b32 v187, 0xffff0000, v133
    v_lshlrev_b32 v188, 16, v134
    v_and_b32 v189, 0xffff0000, v134
    v_lshlrev_b32 v190, 16, v135
    v_and_b32 v191, 0xffff0000, v135
    v_pk_fma_f32 v[10:11], v[184:185], v[152:153], v[10:11]
    v_pk_fma_f32 v[18:19], v[186:187], v[160:161], v[18:19]
    v_pk_fma_f32 v[26:27], v[188:189], v[168:169], v[26:27]
    v_pk_fma_f32 v[34:35], v[190:191], v[176:177], v[34:35]
    s_waitcnt vmcnt(6)
    v_lshlrev_b32 v184, 16, v136
    v_and_b32 v185, 0xffff0000, v136
    v_lshlrev_b32 v186, 16, v137
    v_and_b32 v187, 0xffff0000, v137
    v_lshlrev_b32 v188, 16, v138
    v_and_b32 v189, 0xffff0000, v138
    v_lshlrev_b32 v190, 16, v139
    v_and_b32 v191, 0xffff0000, v139
    v_pk_mul_f32 v[4:5], v[4:5], v[184:185]
    v_pk_mul_f32 v[12:13], v[12:13], v[186:187]
    v_pk_mul_f32 v[20:21], v[20:21], v[188:189]
    v_pk_mul_f32 v[28:29], v[28:29], v[190:191]
    s_waitcnt vmcnt(5)
    v_lshlrev_b32 v184, 16, v140
    v_and_b32 v185, 0xffff0000, v140
    v_lshlrev_b32 v186, 16, v141
    v_and_b32 v187, 0xffff0000, v141
    v_lshlrev_b32 v188, 16, v142
    v_and_b32 v189, 0xffff0000, v142
    v_lshlrev_b32 v190, 16, v143
    v_and_b32 v191, 0xffff0000, v143
    v_pk_mul_f32 v[6:7], v[6:7], v[184:185]
    v_pk_mul_f32 v[14:15], v[14:15], v[186:187]
    v_pk_mul_f32 v[22:23], v[22:23], v[188:189]
    v_pk_mul_f32 v[30:31], v[30:31], v[190:191]
    s_waitcnt vmcnt(4)
    v_lshlrev_b32 v184, 16, v144
    v_and_b32 v185, 0xffff0000, v144
    v_lshlrev_b32 v186, 16, v145
    v_and_b32 v187, 0xffff0000, v145
    v_lshlrev_b32 v188, 16, v146
    v_and_b32 v189, 0xffff0000, v146
    v_lshlrev_b32 v190, 16, v147
    v_and_b32 v191, 0xffff0000, v147
    v_pk_mul_f32 v[8:9], v[8:9], v[184:185]
    v_pk_mul_f32 v[16:17], v[16:17], v[186:187]
    v_pk_mul_f32 v[24:25], v[24:25], v[188:189]
    v_pk_mul_f32 v[32:33], v[32:33], v[190:191]
    s_waitcnt vmcnt(3)
    v_lshlrev_b32 v184, 16, v148
    v_and_b32 v185, 0xffff0000, v148
    v_lshlrev_b32 v186, 16, v149
    v_and_b32 v187, 0xffff0000, v149
    v_lshlrev_b32 v188, 16, v150
    v_and_b32 v189, 0xffff0000, v150
    v_lshlrev_b32 v190, 16, v151
    v_and_b32 v191, 0xffff0000, v151
    v_pk_mul_f32 v[10:11], v[10:11], v[184:185]
    v_pk_mul_f32 v[18:19], v[18:19], v[186:187]
    v_pk_mul_f32 v[26:27], v[26:27], v[188:189]
    v_pk_mul_f32 v[34:35], v[34:35], v[190:191]
    v_cvt_pk_bf16_f32 v108, v10, v8
    v_cvt_pk_bf16_f32 v109, v6, v4
    ds_write_b64 v231, v[108:109] offset:0
    v_cvt_pk_bf16_f32 v110, v11, v9
    v_cvt_pk_bf16_f32 v111, v7, v5
    ds_write_b64 v231, v[110:111] offset:64
    v_cvt_pk_bf16_f32 v112, v18, v16
    v_cvt_pk_bf16_f32 v113, v14, v12
    ds_write_b64 v231, v[112:113] offset:128
    v_cvt_pk_bf16_f32 v114, v19, v17
    v_cvt_pk_bf16_f32 v115, v15, v13
    ds_write_b64 v231, v[114:115] offset:192
    v_cvt_pk_bf16_f32 v116, v26, v24
    v_cvt_pk_bf16_f32 v117, v22, v20
    ds_write_b64 v231, v[116:117] offset:256
    v_cvt_pk_bf16_f32 v118, v27, v25
    v_cvt_pk_bf16_f32 v119, v23, v21
    ds_write_b64 v231, v[118:119] offset:320
    v_cvt_pk_bf16_f32 v120, v34, v32
    v_cvt_pk_bf16_f32 v121, v30, v28
    ds_write_b64 v231, v[120:121] offset:384
    v_cvt_pk_bf16_f32 v122, v35, v33
    v_cvt_pk_bf16_f32 v123, v31, v29
    ds_write_b64 v231, v[122:123] offset:448
    ds_read_b128 v[152:155], v232 offset:0
    ds_read_b128 v[156:159], v232 offset:1056
    ds_read_b128 v[160:163], v232 offset:2112
    ds_read_b128 v[164:167], v232 offset:3168
    v_mov_b64 v[4:5], 0
    v_mov_b64 v[6:7], 0
    v_mov_b64 v[8:9], 0
    v_mov_b64 v[10:11], 0
    v_mov_b64 v[12:13], 0
    v_mov_b64 v[14:15], 0
    v_mov_b64 v[16:17], 0
    v_mov_b64 v[18:19], 0
    v_mov_b64 v[20:21], 0
    v_mov_b64 v[22:23], 0
    v_mov_b64 v[24:25], 0
    v_mov_b64 v[26:27], 0
    v_mov_b64 v[28:29], 0
    v_mov_b64 v[30:31], 0
    v_mov_b64 v[32:33], 0
    v_mov_b64 v[34:35], 0
    s_waitcnt lgkmcnt(0)
    s_mov_b32 s87, 0
    buffer_store_dwordx4 v[152:155], v233, s[80:83], s87 offen sc1
    s_mov_b32 s87, 67584
    buffer_store_dwordx4 v[156:159], v233, s[80:83], s87 offen sc1
    s_mov_b32 s87, 135168
    buffer_store_dwordx4 v[160:163], v233, s[80:83], s87 offen sc1
    s_mov_b32 s87, 202752
    buffer_store_dwordx4 v[164:167], v233, s[80:83], s87 offen sc1
    s_and_b32 s37, s2, 7
    s_xor_b32 s37, s37, 2
    s_lshl_b32 s37, s37, 5
    s_lshr_b32 s38, s2, 3
    s_add_u32 s37, s37, s38
    s_add_u32 s37, s37, 256
    s_lshl_b32 s37, s37, 8
    s_cmp_eq_u32 s33, 0
    s_cselect_b32 s37, s37, s57
    s_cmp_eq_u32 s32, 0
    s_cbranch_scc0 L_noclear
    s_mov_b64 exec, 1
    buffer_store_dword v4, off, s[52:55], s37 sc1
    s_mov_b64 exec, -1
L_noclear:
    s_mov_b32 s37, 41984
    s_mov_b32 s36, 15
    s_barrier
    ds_read_b128 v[108:111], v196 offset:0
    ds_read_b64_tr_b16 v[128:129], v200 offset:0
    ds_read_b64_tr_b16 v[130:131], v200 offset:512
    ds_read_b128 v[112:115], v196 offset:2048
    ds_read_b64_tr_b16 v[132:133], v201 offset:0
    ds_read_b64_tr_b16 v[134:135], v201 offset:512
    ds_read_b128 v[116:119], v196 offset:4096
    ds_read_b64_tr_b16 v[136:137], v200 offset:8192
    ds_read_b64_tr_b16 v[138:139], v200 offset:8704
    ds_read_b128 v[120:123], v196 offset:6144
    ds_read_b64_tr_b16 v[140:141], v201 offset:8192
    ds_read_b64_tr_b16 v[142:143], v201 offset:8704
    ds_read_b128 v[124:127], v198
    ds_read_b64_tr_b16 v[144:145], v200 offset:16384
    ds_read_b64_tr_b16 v[146:147], v200 offset:16896
    ds_read_b64_tr_b16 v[148:149], v201 offset:16384
    ds_read_b64_tr_b16 v[150:151], v201 offset:16896
    s_waitcnt lgkmcnt(0)
L_g1_loop:
    v_mfma_f32_16x16x32_bf16 v[4:7], v[128:131], v[108:111], v[4:7]
    ds_read_b128 v[152:155], v197 offset:0
    v_mfma_f32_16x16x32_bf16 v[12:15], v[128:131], v[112:115], v[12:15]
    ds_read_b64_tr_b16 v[172:173], v200 offset:4096
    v_mfma_f32_16x16x32_bf16 v[20:23], v[128:131], v[116:119], v[20:23]
    ds_read_b64_tr_b16 v[174:175], v200 offset:4608
    v_mfma_f32_16x16x32_bf16 v[28:31], v[128:131], v[120:123], v[28:31]
    ds_read_b128 v[156:159], v197 offset:2048
    v_mfma_f32_16x16x32_bf16 v[8:11], v[132:135], v[108:111], v[8:11]
    ds_read_b64_tr_b16 v[176:177], v201 offset:4096
    v_mfma_f32_16x16x32_bf16 v[16:19], v[132:135], v[112:115], v[16:19]
    ds_read_b64_tr_b16 v[178:179], v201 offset:4608
    v_mfma_f32_16x16x32_bf16 v[24:27], v[132:135], v[116:119], v[24:27]
    ds_read_b128 v[160:163], v197 offset:4096
    v_mfma_f32_16x16x32_bf16 v[32:35], v[132:135], v[120:123], v[32:35]
    ds_read_b64_tr_b16 v[180:181], v200 offset:12288
    v_mfma_f32_16x16x32_bf16 v[36:39], v[136:139], v[108:111], v[36:39]
    ds_read_b64_tr_b16 v[182:183], v200 offset:12800
    v_mfma_f32_16x16x32_bf16 v[44:47], v[136:139], v[112:115], v[44:47]
    ds_read_b128 v[164:167], v197 offset:6144
    v_mfma_f32_16x16x32_bf16 v[52:55], v[136:139], v[116:119], v[52:55]
    ds_read_b64_tr_b16 v[184:185], v201 offset:12288
    v_mfma_f32_16x16x32_bf16 v[60:63], v[136:139], v[120:123], v[60:63]
    ds_read_b64_tr_b16 v[186:187], v201 offset:12800
    v_mfma_f32_16x16x32_bf16 v[100:103], v[136:139], v[124:127], v[100:103]
    ds_read_b128 v[168:171], v199
    v_mfma_f32_16x16x32_bf16 v[40:43], v[140:143], v[108:111], v[40:43]
    ds_read_b64_tr_b16 v[188:189], v200 offset:20480
    v_mfma_f32_16x16x32_bf16 v[48:51], v[140:143], v[112:115], v[48:51]
    ds_read_b64_tr_b16 v[190:191], v200 offset:20992
    v_mfma_f32_16x16x32_bf16 v[56:59], v[140:143], v[116:119], v[56:59]
    ds_read_b64_tr_b16 v[192:193], v201 offset:20480
    v_mfma_f32_16x16x32_bf16 v[64:67], v[140:143], v[120:123], v[64:67]
    ds_read_b64_tr_b16 v[194:195], v201 offset:20992
    v_mfma_f32_16x16x32_bf16 v[68:71], v[108:111], v[144:147], v[68:71]
    ds_read_b32 v1, v228 offset:24
    v_mfma_f32_16x16x32_bf16 v[76:79], v[112:115], v[144:147], v[76:79]
    s_add_u32 s34, s34, 41984
    s_cmp_eq_u32 s34, 125952
    v_mfma_f32_16x16x32_bf16 v[84:87], v[116:119], v[144:147], v[84:87]
    s_cselect_b32 s35, -83968, s37
    s_cselect_b32 s34, 0, s34
    v_mfma_f32_16x16x32_bf16 v[92:95], v[120:123], v[144:147], v[92:95]
    s_bitcmp1_b32 0x1002, s36
    v_add_u32 v196, s35, v196
    v_mfma_f32_16x16x32_bf16 v[104:107], v[124:127], v[144:147], v[104:107]
    v_add_u32 v197, s35, v197
    v_add_u32 v198, s35, v198
    v_mfma_f32_16x16x32_bf16 v[72:75], v[108:111], v[148:151], v[72:75]
    v_add_u32 v199, s35, v199
    v_add_u32 v200, s35, v200
    v_mfma_f32_16x16x32_bf16 v[80:83], v[112:115], v[148:151], v[80:83]
    v_add_u32 v201, s35, v201
    v_mfma_f32_16x16x32_bf16 v[88:91], v[116:119], v[148:151], v[88:91]
    s_waitcnt lgkmcnt(0)
    v_mfma_f32_16x16x32_bf16 v[96:99], v[120:123], v[148:151], v[96:99]
    s_cbranch_scc1 L_g1_rare
L_g1_bar:
    s_barrier
L_g1_nobar:
    v_mfma_f32_16x16x32_bf16 v[4:7], v[172:175], v[152:155], v[4:7]
    ds_read_b128 v[108:111], v196 offset:0
    v_mfma_f32_16x16x32_bf16 v[12:15], v[172:175], v[156:159], v[12:15]
    ds_read_b64_tr_b16 v[128:129], v200 offset:0
    v_mfma_f32_16x16x32_bf16 v[20:23], v[172:175], v[160:163], v[20:23]
    ds_read_b64_tr_b16 v[130:131], v200 offset:512
    v_mfma_f32_16x16x32_bf16 v[28:31], v[172:175], v[164:167], v[28:31]
    ds_read_b128 v[112:115], v196 offset:2048
    v_mfma_f32_16x16x32_bf16 v[8:11], v[176:179], v[152:155], v[8:11]
    ds_read_b64_tr_b16 v[132:133], v201 offset:0
    v_mfma_f32_16x16x32_bf16 v[16:19], v[176:179], v[156:159], v[16:19]
    ds_read_b64_tr_b16 v[134:135], v201 offset:512
    v_mfma_f32_16x16x32_bf16 v[24:27], v[176:179], v[160:163], v[24:27]
    ds_read_b128 v[116:119], v196 offset:4096
    v_mfma_f32_16x16x32_bf16 v[32:35], v[176:179], v[164:167], v[32:35]
    ds_read_b64_tr_b16 v[136:137], v200 offset:8192
    v_mfma_f32_16x16x32_bf16 v[36:39], v[180:183], v[152:155], v[36:39]
    ds_read_b64_tr_b16 v[138:139], v200 offset:8704
    v_mfma_f32_16x16x32_bf16 v[44:47], v[180:183], v[156:159], v[44:47]
    ds_read_b128 v[120:123], v196 offset:6144
    v_mfma_f32_16x16x32_bf16 v[52:55], v[180:183], v[160:163], v[52:55]
    ds_read_b64_tr_b16 v[140:141], v201 offset:8192
    v_mfma_f32_16x16x32_bf16 v[60:63], v[180:183], v[164:167], v[60:63]
    ds_read_b64_tr_b16 v[142:143], v201 offset:8704
    v_mfma_f32_16x16x32_bf16 v[100:103], v[180:183], v[168:171], v[100:103]
    ds_read_b128 v[124:127], v198
    v_mfma_f32_16x16x32_bf16 v[40:43], v[184:187], v[152:155], v[40:43]
    ds_read_b64_tr_b16 v[144:145], v200 offset:16384
    v_mfma_f32_16x16x32_bf16 v[48:51], v[184:187], v[156:159], v[48:51]
    ds_read_b64_tr_b16 v[146:147], v200 offset:16896
    v_mfma_f32_16x16x32_bf16 v[56:59], v[184:187], v[160:163], v[56:59]
    ds_read_b64_tr_b16 v[148:149], v201 offset:16384
    v_mfma_f32_16x16x32_bf16 v[64:67], v[184:187], v[164:167], v[64:67]
    ds_read_b64_tr_b16 v[150:151], v201 offset:16896
    v_mfma_f32_16x16x32_bf16 v[68:71], v[152:155], v[188:191], v[68:71]
    s_sub_u32 s36, s36, 1
    v_mfma_f32_16x16x32_bf16 v[76:79], v[156:159], v[188:191], v[76:79]
    s_cmp_lg_u32 s36, 0
    v_mfma_f32_16x16x32_bf16 v[84:87], v[160:163], v[188:191], v[84:87]
    v_mfma_f32_16x16x32_bf16 v[92:95], v[164:167], v[188:191], v[92:95]
    v_mfma_f32_16x16x32_bf16 v[104:107], v[168:171], v[188:191], v[104:107]
    v_mfma_f32_16x16x32_bf16 v[72:75], v[152:155], v[192:195], v[72:75]
    v_mfma_f32_16x16x32_bf16 v[80:83], v[156:159], v[192:195], v[80:83]
    v_mfma_f32_16x16x32_bf16 v[88:91], v[160:163], v[192:195], v[88:91]
    s_waitcnt lgkmcnt(0)
    v_mfma_f32_16x16x32_bf16 v[96:99], v[164:167], v[192:195], v[96:99]
    s_cbranch_scc1 L_g1_loop
    v_mfma_f32_16x16x32_bf16 v[4:7], v[128:131], v[108:111], v[4:7]
    ds_read_b128 v[152:155], v197 offset:0
    v_mfma_f32_16x16x32_bf16 v[12:15], v[128:131], v[112:115], v[12:15]
    ds_read_b64_tr_b16 v[172:173], v200 offset:4096
    v_mfma_f32_16x16x32_bf16 v[20:23], v[128:131], v[116:119], v[20:23]
    ds_read_b64_tr_b16 v[174:175], v200 offset:4608
    v_mfma_f32_16x16x32_bf16 v[28:31], v[128:131], v[120:123], v[28:31]
    ds_read_b128 v[156:159], v197 offset:2048
    v_mfma_f32_16x16x32_bf16 v[8:11], v[132:135], v[108:111], v[8:11]
    ds_read_b64_tr_b16 v[176:177], v201 offset:4096
    v_mfma_f32_16x16x32_bf16 v[16:19], v[132:135], v[112:115], v[16:19]
    ds_read_b64_tr_b16 v[178:179], v201 offset:4608
    v_mfma_f32_16x16x32_bf16 v[24:27], v[132:135], v[116:119], v[24:27]
    ds_read_b128 v[160:163], v197 offset:4096
    v_mfma_f32_16x16x32_bf16 v[32:35], v[132:135], v[120:123], v[32:35]
    ds_read_b64_tr_b16 v[180:181], v200 offset:12288
    v_mfma_f32_16x16x32_bf16 v[36:39], v[136:139], v[108:111], v[36:39]
    ds_read_b64_tr_b16 v[182:183], v200 offset:12800
    v_mfma_f32_16x16x32_bf16 v[44:47], v[136:139], v[112:115], v[44:47]
    ds_read_b128 v[164:167], v197 offset:6144
    v_mfma_f32_16x16x32_bf16 v[52:55], v[136:139], v[116:119], v[52:55]
    ds_read_b64_tr_b16 v[184:185], v201 offset:12288
    v_mfma_f32_16x16x32_bf16 v[60:63], v[136:139], v[120:123], v[60:63]
    ds_read_b64_tr_b16 v[186:187], v201 offset:12800
    v_mfma_f32_16x16x32_bf16 v[100:103], v[136:139], v[124:127], v[100:103]
    ds_read_b128 v[168:171], v199
    v_mfma_f32_16x16x32_bf16 v[40:43], v[140:143], v[108:111], v[40:43]
    ds_read_b64_tr_b16 v[188:189], v200 offset:20480
    v_mfma_f32_16x16x32_bf16 v[48:51], v[140:143], v[112:115], v[48:51]
    ds_read_b64_tr_b16 v[190:191], v200 offset:20992
    v_mfma_f32_16x16x32_bf16 v[56:59], v[140:143], v[116:119], v[56:59]
    ds_read_b64_tr_b16 v[192:193], v201 offset:20480
    v_mfma_f32_16x16x32_bf16 v[64:67], v[140:143], v[120:123], v[64:67]
    ds_read_b64_tr_b16 v[194:195], v201 offset:20992
    v_mfma_f32_16x16x32_bf16 v[68:71], v[108:111], v[144:147], v[68:71]
    v_mfma_f32_16x16x32_bf16 v[76:79], v[112:115], v[144:147], v[76:79]
    v_mfma_f32_16x16x32_bf16 v[84:87], v[116:119], v[144:147], v[84:87]
    v_mfma_f32_16x16x32_bf16 v[92:95], v[120:123], v[144:147], v[92:95]
    v_mfma_f32_16x16x32_bf16 v[104:107], v[124:127], v[144:147], v[104:107]
    v_mfma_f32_16x16x32_bf16 v[72:75], v[108:111], v[148:151], v[72:75]
    v_mfma_f32_16x16x32_bf16 v[80:83], v[112:115], v[148:151], v[80:83]
    v_mfma_f32_16x16x32_bf16 v[88:91], v[116:119], v[148:151], v[88:91]
    v_mfma_f32_16x16x32_bf16 v[96:99], v[120:123], v[148:151], v[96:99]
    s_waitcnt lgkmcnt(0)
    s_setprio 2
    v_mov_b32 v2, 1
    v_mfma_f32_16x16x32_bf16 v[100:103], v[180:183], v[168:171], v[100:103]
    v_mfma_f32_16x16x32_bf16 v[104:107], v[168:171], v[188:191], v[104:107]
    v_mfma_f32_16x16x32_bf16 v[60:63], v[180:183], v[164:167], v[60:63]
    v_mfma_f32_16x16x32_bf16 v[64:67], v[184:187], v[164:167], v[64:67]
    v_mfma_f32_16x16x32_bf16 v[92:95], v[164:167], v[188:191], v[92:95]
    v_mfma_f32_16x16x32_bf16 v[96:99], v[164:167], v[192:195], v[96:99]
    v_mfma_f32_16x16x32_bf16 v[28:31], v[172:175], v[164:167], v[28:31]
    v_mfma_f32_16x16x32_bf16 v[32:35], v[176:179], v[164:167], v[32:35]
    v_mfma_f32_16x16x32_bf16 v[52:55], v[180:183], v[160:163], v[52:55]
    v_cvt_pk_bf16_f32 v144, v100, v101
    v_cvt_pk_bf16_f32 v145, v102, v103
    v_mfma_f32_16x16x32_bf16 v[56:59], v[184:187], v[160:163], v[56:59]
    ds_write_b64 v219, v[144:145]
    v_cvt_pk_bf16_f32 v146, v104, v105
    v_mfma_f32_16x16x32_bf16 v[20:23], v[172:175], v[160:163], v[20:23]
    v_cvt_pk_bf16_f32 v147, v106, v107
    ds_write_b64 v219, v[146:147] offset:1024
    v_mfma_f32_16x16x32_bf16 v[24:27], v[176:179], v[160:163], v[24:27]
    v_cvt_pk_bf16_f32 v140, v60, v61
    v_cvt_pk_bf16_f32 v141, v62, v63
    v_mfma_f32_16x16x32_bf16 v[44:47], v[180:183], v[156:159], v[44:47]
    v_cvt_pk_bf16_f32 v142, v64, v65
    v_cvt_pk_bf16_f32 v143, v66, v67
    v_mfma_f32_16x16x32_bf16 v[48:51], v[184:187], v[156:159], v[48:51]
    v_cvt_pk_bf16_f32 v238, v92, v93
    v_cvt_pk_bf16_f32 v239, v94, v95
    v_mfma_f32_16x16x32_bf16 v[12:15], v[172:175], v[156:159], v[12:15]
    v_cvt_pk_bf16_f32 v248, v96, v97
    v_cvt_pk_bf16_f32 v249, v98, v99
    v_mfma_f32_16x16x32_bf16 v[16:19], v[176:179], v[156:159], v[16:19]
    s_cmp_eq_u32 s33, 0
    s_cbranch_scc0 L_at_nopub
    ds_write_b64 v220, v[140:141] offset:2048
    ds_write_b64 v220, v[238:239] offset:3072
    ds_write_b64 v220, v[142:143] offset:2560
    ds_write_b64 v220, v[248:249] offset:3584
L_at_nopub:
    s_mov_b64 exec, 1
    ds_add_u32 v228, v2 offset:20
    s_mov_b64 exec, -1
    v_cvt_pk_bf16_f32 v120, v28, v29
    v_mfma_f32_16x16x32_bf16 v[36:39], v[180:183], v[152:155], v[36:39]
    v_cvt_pk_bf16_f32 v121, v30, v31
    v_cvt_pk_bf16_f32 v122, v32, v33
    v_mfma_f32_16x16x32_bf16 v[40:43], v[184:187], v[152:155], v[40:43]
    v_cvt_pk_bf16_f32 v123, v34, v35
    v_cvt_pk_bf16_f32 v136, v52, v53
    v_mfma_f32_16x16x32_bf16 v[4:7], v[172:175], v[152:155], v[4:7]
    v_cvt_pk_bf16_f32 v137, v54, v55
    v_cvt_pk_bf16_f32 v138, v56, v57
    v_mfma_f32_16x16x32_bf16 v[8:11], v[176:179], v[152:155], v[8:11]
    v_cvt_pk_bf16_f32 v139, v58, v59
    v_cvt_pk_bf16_f32 v116, v20, v21
    v_mfma_f32_16x16x32_bf16 v[84:87], v[160:163], v[188:191], v[84:87]
    v_cvt_pk_bf16_f32 v117, v22, v23
    v_cvt_pk_bf16_f32 v118, v24, v25
    v_mfma_f32_16x16x32_bf16 v[88:91], v[160:163], v[192:195], v[88:91]
    v_cvt_pk_bf16_f32 v119, v26, v27
    v_cvt_pk_bf16_f32 v132, v44, v45
    v_mfma_f32_16x16x32_bf16 v[76:79], v[156:159], v[188:191], v[76:79]
    v_cvt_pk_bf16_f32 v133, v46, v47
    v_cvt_pk_bf16_f32 v134, v48, v49
    v_mfma_f32_16x16x32_bf16 v[80:83], v[156:159], v[192:195], v[80:83]
    v_cvt_pk_bf16_f32 v135, v50, v51
    v_cvt_pk_bf16_f32 v112, v12, v13
    v_mfma_f32_16x16x32_bf16 v[68:71], v[152:155], v[188:191], v[68:71]
    v_cvt_pk_bf16_f32 v113, v14, v15
    v_cvt_pk_bf16_f32 v114, v16, v17
    v_mfma_f32_16x16x32_bf16 v[72:75], v[152:155], v[192:195], v[72:75]
    v_cvt_pk_bf16_f32 v115, v18, v19
    v_cvt_pk_bf16_f32 v128, v36, v37
    v_mfma_f32_16x16x32_bf16 v[28:31], v[140:143], v[120:123], v[204:207]
    v_cvt_pk_bf16_f32 v129, v38, v39
    v_cvt_pk_bf16_f32 v130, v40, v41
    v_mfma_f32_16x16x32_bf16 v[32:35], v[136:139], v[120:123], v[208:211]
    v_cvt_pk_bf16_f32 v131, v42, v43
    v_cvt_pk_bf16_f32 v108, v4, v5
    v_mfma_f32_16x16x32_bf16 v[20:23], v[136:139], v[116:119], v[204:207]
    v_cvt_pk_bf16_f32 v109, v6, v7
    v_cvt_pk_bf16_f32 v110, v8, v9
    v_mfma_f32_16x16x32_bf16 v[24:27], v[132:135], v[116:119], v[208:211]
    v_cvt_pk_bf16_f32 v111, v10, v11
    v_cvt_pk_bf16_f32 v236, v84, v85
    v_mfma_f32_16x16x32_bf16 v[12:15], v[132:135], v[112:115], v[204:207]
    v_cvt_pk_bf16_f32 v237, v86, v87
    v_cvt_pk_bf16_f32 v246, v88, v89
    v_mfma_f32_16x16x32_bf16 v[16:19], v[128:131], v[112:115], v[208:211]
    v_cvt_pk_bf16_f32 v247, v90, v91
    v_cvt_pk_bf16_f32 v234, v76, v77
    v_mfma_f32_16x16x32_bf16 v[4:7], v[128:131], v[108:111], v[204:207]
    v_cvt_pk_bf16_f32 v235, v78, v79
    ds_read_b32 v1, v228 offset:20
    v_cvt_pk_bf16_f32 v244, v80, v81
    v_cvt_pk_bf16_f32 v245, v82, v83
    v_cvt_pk_bf16_f32 v232, v68, v69
    v_cvt_pk_bf16_f32 v233, v70, v71
    v_cvt_pk_bf16_f32 v242, v72, v73
    v_cvt_pk_bf16_f32 v243, v74, v75
    s_waitcnt lgkmcnt(0)
    v_readfirstlane_b32 s37, v1
    s_nop 0
    s_cmp_ge_u32 s37, 4
    s_cbranch_scc1 L_sl_done_36
    s_mov_b32 s38, 1048576
L_sl_loop_37:
    ds_read_b32 v1, v228 offset:20
    s_waitcnt lgkmcnt(0)
    v_readfirstlane_b32 s37, v1
    s_nop 0
    s_cmp_ge_u32 s37, 4
    s_cbranch_scc1 L_sl_done_36
    s_sleep 1
    s_sub_u32 s38, s38, 1
    s_cbranch_scc0 L_sl_loop_37
L_sl_done_36:
    ds_read_b64 v[124:125], v221
    ds_read_b64 v[126:127], v222
    ds_read_b64 v[230:231], v221 offset:1024
    ds_read_b64 v[240:241], v222 offset:1024
    v_max_f32 v28, v28, v32
    v_max_f32 v29, v29, v33
    v_max_f32 v30, v30, v34
    v_max_f32 v31, v31, v35
    v_max3_f32 v39, v28, v29, v30
    v_max_f32 v39, v39, v31
    v_max_f32 v20, v20, v24
    v_max_f32 v21, v21, v25
    v_max_f32 v22, v22, v26
    v_max_f32 v23, v23, v27
    v_max3_f32 v38, v20, v21, v22
    v_max_f32 v38, v38, v23
    s_waitcnt lgkmcnt(2)
    v_mfma_f32_16x16x32_bf16 v[8:11], v[124:127], v[108:111], v[212:215]
    s_setprio 2
    s_mov_b32 s37, 0x3e8293ee
    v_max_f32 v12, v12, v16
    v_max_f32 v13, v13, v17
    v_max_f32 v14, v14, v18
    v_max_f32 v15, v15, v19
    v_max3_f32 v37, v12, v13, v14
    v_max_f32 v37, v37, v15
    v_max_f32 v4, v4, v8
    v_max_f32 v5, v5, v9
    v_max_f32 v6, v6, v10
    v_max_f32 v7, v7, v11
    v_max3_f32 v36, v4, v5, v6
    v_max_f32 v36, v36, v7
    v_permlane32_swap_b32 v38, v39
    s_nop 0
    v_permlane32_swap_b32 v36, v37
    v_max_f32 v38, v38, v39
    v_max_f32 v36, v36, v37
    s_nop 1
    v_permlane16_swap_b32 v36, v38
    v_max_f32 v36, v36, v38
    v_mul_f32 v38, s37, v36
    v_mul_f32 v36, s37, v36
    s_nop 1
    v_permlane16_swap_b32 v36, v38
    v_mov_b32 v37, v36
    v_mov_b32 v39, v38
    s_nop 0
    v_permlane32_swap_b32 v36, v37
    v_permlane32_swap_b32 v38, v39
    v_fma_f32 v4, v4, s37, -v36
    v_fma_f32 v5, v5, s37, -v36
    v_fma_f32 v6, v6, s37, -v36
    v_fma_f32 v7, v7, s37, -v36
    v_fma_f32 v12, v12, s37, -v37
    v_fma_f32 v13, v13, s37, -v37
    v_fma_f32 v14, v14, s37, -v37
    v_fma_f32 v15, v15, s37, -v37
    v_fma_f32 v20, v20, s37, -v38
    v_fma_f32 v21, v21, s37, -v38
    v_fma_f32 v22, v22, s37, -v38
    v_fma_f32 v23, v23, s37, -v38
    v_fma_f32 v28, v28, s37, -v39
    v_fma_f32 v29, v29, s37, -v39
    v_fma_f32 v30, v30, s37, -v39
    v_fma_f32 v31, v31, s37, -v39
    v_exp_f32 v28, v28
    v_exp_f32 v29, v29
    v_exp_f32 v30, v30
    v_exp_f32 v31, v31
    v_exp_f32 v20, v20
    v_exp_f32 v21, v21
    v_exp_f32 v22, v22
    v_exp_f32 v23, v23
    v_exp_f32 v12, v12
    v_exp_f32 v13, v13
    v_exp_f32 v14, v14
    v_exp_f32 v15, v15
    v_exp_f32 v4, v4
    v_exp_f32 v5, v5
    v_exp_f32 v6, v6
    v_exp_f32 v7, v7
    v_add_f32 v39, v28, v29
    v_add_f32 v32, v30, v31
    v_add_f32 v39, v39, v32
    v_add_f32 v38, v20, v21
    v_add_f32 v24, v22, v23
    v_add_f32 v38, v38, v24
    v_add_f32 v37, v12, v13
    v_add_f32 v16, v14, v15
    v_add_f32 v37, v37, v16
    v_add_f32 v36, v4, v5
    v_add_f32 v8, v6, v7
    v_add_f32 v36, v36, v8
    v_permlane32_swap_b32 v38, v39
    s_nop 0
    v_permlane32_swap_b32 v36, v37
    v_add_f32 v38, v38, v39
    v_add_f32 v36, v36, v37
    s_nop 1
    v_permlane16_swap_b32 v36, v38
    v_add_f32 v36, v36, v38
    v_rcp_f32 v38, v36
    v_rcp_f32 v36, v36
    s_nop 1
    v_permlane16_swap_b32 v36, v38
    v_mov_b32 v37, v36
    v_mov_b32 v39, v38
    s_nop 0
    v_permlane32_swap_b32 v36, v37
    v_permlane32_swap_b32 v38, v39
    s_waitcnt lgkmcnt(0)
    s_cmp_eq_u32 s33, 0
    v_mul_f32 v4, v4, v36
    v_mul_f32 v5, v5, v36
    v_mul_f32 v6, v6, v36
    v_mul_f32 v7, v7, v36
    v_cvt_pk_bf16_f32 v10, v4, v5
    v_cvt_pk_bf16_f32 v11, v6, v7
    v_and_b32 v8, v216, v10
    v_and_b32 v9, v217, v11
    v_xor_b32 v10, v8, v10
    v_xor_b32 v11, v9, v11
    s_setprio 2
    s_nop 0
    v_mfma_f32_16x16x32_bf16 v[68:71], v[230:233], v[8:11], 0
    v_mfma_f32_16x16x32_bf16 v[72:75], v[240:243], v[8:11], 0
    s_setprio 2
    v_mul_f32 v12, v12, v37
    v_mul_f32 v13, v13, v37
    v_mul_f32 v14, v14, v37
    v_mul_f32 v15, v15, v37
    v_cvt_pk_bf16_f32 v18, v12, v13
    v_cvt_pk_bf16_f32 v19, v14, v15
    v_and_b32 v16, v216, v18
    v_and_b32 v17, v217, v19
    v_xor_b32 v18, v16, v18
    v_xor_b32 v19, v17, v19
    v_cvt_pk_bf16_f32 v108, v68, v69
    v_cvt_pk_bf16_f32 v109, v70, v71
    v_cvt_pk_bf16_f32 v110, v72, v73
    v_cvt_pk_bf16_f32 v111, v74, v75
    s_cbranch_scc1 L_at_noswap0
    v_swap_b32 v108, v110
    v_swap_b32 v109, v111
L_at_noswap0:
    s_mov_b32 s37, 0
    buffer_store_dwordx4 v[108:111], v218, s[40:43], s37 offen sc1
    s_setprio 2
    v_mfma_f32_16x16x32_bf16 v[76:79], v[232:235], v[16:19], 0
    v_mfma_f32_16x16x32_bf16 v[80:83], v[242:245], v[16:19], 0
    s_setprio 2
    v_mul_f32 v20, v20, v38
    v_mul_f32 v21, v21, v38
    v_mul_f32 v22, v22, v38
    v_mul_f32 v23, v23, v38
    v_cvt_pk_bf16_f32 v26, v20, v21
    v_cvt_pk_bf16_f32 v27, v22, v23
    v_and_b32 v24, v216, v26
    v_and_b32 v25, v217, v27
    v_xor_b32 v26, v24, v26
    v_xor_b32 v27, v25, v27
    v_cvt_pk_bf16_f32 v112, v76, v77
    v_cvt_pk_bf16_f32 v113, v78, v79
    v_cvt_pk_bf16_f32 v114, v80, v81
    v_cvt_pk_bf16_f32 v115, v82, v83
    s_cbranch_scc1 L_at_noswap1
    v_swap_b32 v112, v114
    v_swap_b32 v113, v115
L_at_noswap1:
    s_mov_b32 s37, 32768
    buffer_store_dwordx4 v[112:115], v218, s[40:43], s37 offen sc1
    s_setprio 2
    v_mfma_f32_16x16x32_bf16 v[84:87], v[234:237], v[24:27], 0
    v_mfma_f32_16x16x32_bf16 v[88:91], v[244:247], v[24:27], 0
    s_setprio 2
    v_mul_f32 v28, v28, v39
    v_mul_f32 v29, v29, v39
    v_mul_f32 v30, v30, v39
    v_mul_f32 v31, v31, v39
    v_cvt_pk_bf16_f32 v34, v28, v29
    v_cvt_pk_bf16_f32 v35, v30, v31
    v_and_b32 v32, v216, v34
    v_and_b32 v33, v217, v35
    v_xor_b32 v34, v32, v34
    v_xor_b32 v35, v33, v35
    v_cvt_pk_bf16_f32 v116, v84, v85
    v_cvt_pk_bf16_f32 v117, v86, v87
    v_cvt_pk_bf16_f32 v118, v88, v89
    v_cvt_pk_bf16_f32 v119, v90, v91
    s_cbranch_scc1 L_at_noswap2
    v_swap_b32 v116, v118
    v_swap_b32 v117, v119
L_at_noswap2:
    s_mov_b32 s37, 65536
    buffer_store_dwordx4 v[116:119], v218, s[40:43], s37 offen sc1
    s_setprio 2
    v_mfma_f32_16x16x32_bf16 v[92:95], v[236:239], v[32:35], 0
    v_mfma_f32_16x16x32_bf16 v[96:99], v[246:249], v[32:35], 0
    s_setprio 2
    s_nop 5
    v_cvt_pk_bf16_f32 v120, v92, v93
    v_cvt_pk_bf16_f32 v121, v94, v95
    v_cvt_pk_bf16_f32 v122, v96, v97
    v_cvt_pk_bf16_f32 v123, v98, v99
    s_cbranch_scc1 L_at_noswap3
    v_swap_b32 v120, v122
    v_swap_b32 v121, v123
L_at_noswap3:
    s_mov_b32 s37, 98304
    buffer_store_dwordx4 v[120:123], v218, s[40:43], s37 offen sc1
    s_setprio 0
    s_add_u32 m0, s60, 0
    s_add_u32 s63, s62, 0
    s_and_b32 s63, s63, 0x1fffff
    buffer_load_dwordx4 v227, s[44:47], s63 offen lds
    s_add_u32 m0, s60, 1024
    s_add_u32 s63, s62, 16384
    s_and_b32 s63, s63, 0x1fffff
    buffer_load_dwordx4 v227, s[44:47], s63 offen lds
    s_add_u32 m0, s60, 8192
    s_add_u32 s63, s62, 131072
    s_and_b32 s63, s63, 0x1fffff
    buffer_load_dwordx4 v227, s[44:47], s63 offen lds
    s_add_u32 m0, s60, 9216
    s_add_u32 s63, s62, 147456
    s_and_b32 s63, s63, 0x1fffff
    buffer_load_dwordx4 v227, s[44:47], s63 offen lds
    s_add_u32 m0, s60, 16384
    s_add_u32 s63, s62, 262144
    s_and_b32 s63, s63, 0x1fffff
    buffer_load_dwordx4 v227, s[44:47], s63 offen lds
    s_add_u32 m0, s60, 17408
    s_add_u32 s63, s62, 278528
    s_and_b32 s63, s63, 0x1fffff
    buffer_load_dwordx4 v227, s[44:47], s63 offen lds
    v_xor_b32 v84, 0, v229
    v_xor_b32 v85, 32, v229
    v_xor_b32 v86, 64, v229
    v_xor_b32 v87, 96, v229
    v_add_u32 v88, 83968, v84
    v_add_u32 v89, 83968, v85
    v_add_u32 v90, 83968, v86
    v_add_u32 v91, 83968, v87
    v_add_u32 v92, 125952, v84
    v_add_u32 v93, 125952, v85
    v_add_u32 v94, 125952, v86
    v_add_u32 v95, 125952, v87
    s_add_u32 s64, s61, 0
    s_and_b32 s64, s64, 7
    s_lshl_b32 s64, s64, 12
    s_add_u32 s65, s61, 1
    s_and_b32 s65, s65, 7
    s_lshl_b32 s65, s65, 12
    s_add_u32 s66, s61, 2
    s_and_b32 s66, s66, 7
    s_lshl_b32 s66, s66, 12
    s_add_u32 s67, s61, 3
    s_and_b32 s67, s67, 7
    s_lshl_b32 s67, s67, 12
    s_add_u32 s68, s61, 4
    s_and_b32 s68, s68, 7
    s_lshl_b32 s68, s68, 12
    s_add_u32 s69, s61, 5
    s_and_b32 s69, s69, 7
    s_lshl_b32 s69, s69, 12
    s_add_u32 s70, s61, 6
    s_and_b32 s70, s70, 7
    s_lshl_b32 s70, s70, 12
    s_add_u32 s71, s61, 7
    s_and_b32 s71, s71, 7
    s_lshl_b32 s71, s71, 12
    s_waitcnt vmcnt(6)
    s_setprio 2
    v_mov_b32 v2, 1
    s_mov_b64 exec, 1
    ds_add_rtn_u32 v1, v228, v2 offset:0
    s_waitcnt lgkmcnt(0)
    v_readfirstlane_b32 s39, v1
    s_nop 0
    s_cmp_eq_u32 s39, 3
    s_cbranch_scc0 L_jo_38a
    s_mov_b64 exec, 0xffff
    v_lshlrev_b32 v1, 8, v0
    buffer_atomic_add v2, v1, s[52:55], s56 offen sc1
L_jo_38a:
    s_mov_b64 exec, -1
    s_setprio 0
    s_add_u32 m0, s60, 24576
    s_add_u32 s63, s62, 393216
    s_and_b32 s63, s63, 0x1fffff
    buffer_load_dwordx4 v227, s[44:47], s63 offen lds
    s_add_u32 m0, s60, 25600
    s_add_u32 s63, s62, 409600
    s_and_b32 s63, s63, 0x1fffff
    buffer_load_dwordx4 v227, s[44:47], s63 offen lds
    s_add_u32 m0, s60, 32768
    s_add_u32 s63, s62, 524288
    s_and_b32 s63, s63, 0x1fffff
    buffer_load_dwordx4 v227, s[44:47], s63 offen lds
    s_add_u32 m0, s60, 33792
    s_add_u32 s63, s62, 540672
    s_and_b32 s63, s63, 0x1fffff
    buffer_load_dwordx4 v227, s[44:47], s63 offen lds
    s_add_u32 m0, s60, 83968
    s_add_u32 s63, s62, 655360
    s_and_b32 s63, s63, 0x1fffff
    buffer_load_dwordx4 v227, s[44:47], s63 offen lds
    s_add_u32 m0, s60, 84992
    s_add_u32 s63, s62, 671744
    s_and_b32 s63, s63, 0x1fffff
    buffer_load_dwordx4 v227, s[44:47], s63 offen lds
    s_add_u32 m0, s60, 92160
    s_add_u32 s63, s62, 786432
    s_and_b32 s63, s63, 0x1fffff
    buffer_load_dwordx4 v227, s[44:47], s63 offen lds
    s_add_u32 m0, s60, 93184
    s_add_u32 s63, s62, 802816
    s_and_b32 s63, s63, 0x1fffff
    buffer_load_dwordx4 v227, s[44:47], s63 offen lds
    s_add_u32 m0, s60, 100352
    s_add_u32 s63, s62, 917504
    s_and_b32 s63, s63, 0x1fffff
    buffer_load_dwordx4 v227, s[44:47], s63 offen lds
    s_add_u32 m0, s60, 101376
    s_add_u32 s63, s62, 933888
    s_and_b32 s63, s63, 0x1fffff
    buffer_load_dwordx4 v227, s[44:47], s63 offen lds
    s_add_u32 m0, s60, 108544
    s_add_u32 s63, s62, 1048576
    s_and_b32 s63, s63, 0x1fffff
    buffer_load_dwordx4 v227, s[44:47], s63 offen lds
    s_add_u32 m0, s60, 109568
    s_add_u32 s63, s62, 1064960
    s_and_b32 s63, s63, 0x1fffff
    buffer_load_dwordx4 v227, s[44:47], s63 offen lds
    s_add_u32 m0, s60, 116736
    s_add_u32 s63, s62, 1179648
    s_and_b32 s63, s63, 0x1fffff
    buffer_load_dwordx4 v227, s[44:47], s63 offen lds
    s_add_u32 m0, s60, 117760
    s_add_u32 s63, s62, 1196032
    s_and_b32 s63, s63, 0x1fffff
    buffer_load_dwordx4 v227, s[44:47], s63 offen lds
    s_setprio 0
    s_cmp_eq_u32 s39, 3
    s_cbranch_scc0 L_jo_38
    s_mov_b32 s38, 131072
L_sg_loop_41:
    s_load_dword s37, s[52:53], s57 glc
L_sg_chk_42:
    s_waitcnt lgkmcnt(0)
    s_cmp_ge_u32 s37, 16
    s_cbranch_scc1 L_sg_done_40
    s_sub_u32 s38, s38, 1
    s_cbranch_scc0 L_sg_loop_41
L_sg_done_40:
    v_mov_b32 v1, 16
    s_mov_b64 exec, 1
    ds_add_u32 v228, v1 offset:4
    s_mov_b64 exec, -1
L_jo_38:
    s_waitcnt vmcnt(0)
    s_mov_b64 exec, 1
    ds_add_u32 v228, v2 offset:4
    s_mov_b64 exec, -1
    s_mov_b32 s38, 1048576
L_sl_loop_44:
    ds_read_b32 v1, v228 offset:4
    s_waitcnt lgkmcnt(0)
    v_readfirstlane_b32 s37, v1
    s_nop 0
    s_cmp_ge_u32 s37, 20
    s_cbranch_scc1 L_sl_done_43
    s_sleep 1
    s_sub_u32 s38, s38, 1
    s_cbranch_scc0 L_sl_loop_44
L_sl_done_43:
L_jd_39:
    buffer_load_dwordx4 v[96:99], v224, s[40:43], s64 offen offset:0 sc1
    buffer_load_dwordx4 v[100:103], v225, s[40:43], s64 offen offset:0 sc1
    ds_read_b64_tr_b16 v[36:37], v84 offset:0
    ds_read_b64_tr_b16 v[38:39], v84 offset:2048
    buffer_load_dwordx4 v[104:107], v224, s[40:43], s64 offen offset:1024 sc1
    buffer_load_dwordx4 v[108:111], v225, s[40:43], s64 offen offset:1024 sc1
    ds_read_b64_tr_b16 v[40:41], v85 offset:0
    ds_read_b64_tr_b16 v[42:43], v85 offset:2048
    buffer_load_dwordx4 v[112:115], v224, s[40:43], s64 offen offset:2048 sc1
    buffer_load_dwordx4 v[116:119], v225, s[40:43], s64 offen offset:2048 sc1
    ds_read_b64_tr_b16 v[44:45], v86 offset:0
    ds_read_b64_tr_b16 v[46:47], v86 offset:2048
    buffer_load_dwordx4 v[120:123], v224, s[40:43], s64 offen offset:3072 sc1
    buffer_load_dwordx4 v[124:127], v225, s[40:43], s64 offen offset:3072 sc1
    ds_read_b64_tr_b16 v[48:49], v87 offset:0
    ds_read_b64_tr_b16 v[50:51], v87 offset:2048
    buffer_load_dwordx4 v[128:131], v224, s[40:43], s65 offen offset:0 sc1
    buffer_load_dwordx4 v[132:135], v225, s[40:43], s65 offen offset:0 sc1
    ds_read_b64_tr_b16 v[52:53], v84 offset:4096
    ds_read_b64_tr_b16 v[54:55], v84 offset:6144
    buffer_load_dwordx4 v[136:139], v224, s[40:43], s65 offen offset:1024 sc1
    buffer_load_dwordx4 v[140:143], v225, s[40:43], s65 offen offset:1024 sc1
    ds_read_b64_tr_b16 v[56:57], v85 offset:4096
    ds_read_b64_tr_b16 v[58:59], v85 offset:6144
    buffer_load_dwordx4 v[144:147], v224, s[40:43], s65 offen offset:2048 sc1
    buffer_load_dwordx4 v[148:151], v225, s[40:43], s65 offen offset:2048 sc1
    ds_read_b64_tr_b16 v[60:61], v86 offset:4096
    ds_read_b64_tr_b16 v[62:63], v86 offset:6144
    buffer_load_dwordx4 v[152:155], v224, s[40:43], s65 offen offset:3072 sc1
    buffer_load_dwordx4 v[156:159], v225, s[40:43], s65 offen offset:3072 sc1
    s_waitcnt lgkmcnt(12)
    ds_read_b64_tr_b16 v[64:65], v87 offset:4096
    ds_read_b64_tr_b16 v[66:67], v87 offset:6144
    s_waitcnt vmcnt(14) lgkmcnt(8)
    v_mfma_f32_16x16x32_bf16 v[4:7], v[36:39], v[96:99], 0
    ds_read_b64_tr_b16 v[68:69], v84 offset:8192
    v_mfma_f32_16x16x32_bf16 v[20:23], v[36:39], v[100:103], 0
    ds_read_b64_tr_b16 v[70:71], v84 offset:10240
    v_mfma_f32_16x16x32_bf16 v[8:11], v[40:43], v[96:99], 0
    ds_read_b64_tr_b16 v[36:37], v85 offset:8192
    v_mfma_f32_16x16x32_bf16 v[24:27], v[40:43], v[100:103], 0
    ds_read_b64_tr_b16 v[38:39], v85 offset:10240
    buffer_load_dwordx4 v[160:163], v224, s[40:43], s66 offen offset:0 sc1
    v_mfma_f32_16x16x32_bf16 v[12:15], v[44:47], v[96:99], 0
    ds_read_b64_tr_b16 v[40:41], v86 offset:8192
    v_mfma_f32_16x16x32_bf16 v[28:31], v[44:47], v[100:103], 0
    ds_read_b64_tr_b16 v[42:43], v86 offset:10240
    v_mfma_f32_16x16x32_bf16 v[16:19], v[48:51], v[96:99], 0
    ds_read_b64_tr_b16 v[44:45], v87 offset:8192
    v_mfma_f32_16x16x32_bf16 v[32:35], v[48:51], v[100:103], 0
    ds_read_b64_tr_b16 v[46:47], v87 offset:10240
    buffer_load_dwordx4 v[164:167], v225, s[40:43], s66 offen offset:0 sc1
    s_waitcnt vmcnt(14) lgkmcnt(8)
    v_mfma_f32_16x16x32_bf16 v[4:7], v[52:55], v[104:107], v[4:7]
    ds_read_b64_tr_b16 v[48:49], v84 offset:12288
    v_mfma_f32_16x16x32_bf16 v[20:23], v[52:55], v[108:111], v[20:23]
    ds_read_b64_tr_b16 v[50:51], v84 offset:14336
    v_mfma_f32_16x16x32_bf16 v[8:11], v[56:59], v[104:107], v[8:11]
    ds_read_b64_tr_b16 v[52:53], v85 offset:12288
    v_mfma_f32_16x16x32_bf16 v[24:27], v[56:59], v[108:111], v[24:27]
    ds_read_b64_tr_b16 v[54:55], v85 offset:14336
    buffer_load_dwordx4 v[96:99], v224, s[40:43], s66 offen offset:1024 sc1
    v_mfma_f32_16x16x32_bf16 v[12:15], v[60:63], v[104:107], v[12:15]
    ds_read_b64_tr_b16 v[56:57], v86 offset:12288
    v_mfma_f32_16x16x32_bf16 v[28:31], v[60:63], v[108:111], v[28:31]
    ds_read_b64_tr_b16 v[58:59], v86 offset:14336
    v_mfma_f32_16x16x32_bf16 v[16:19], v[64:67], v[104:107], v[16:19]
    ds_read_b64_tr_b16 v[60:61], v87 offset:12288
    v_mfma_f32_16x16x32_bf16 v[32:35], v[64:67], v[108:111], v[32:35]
    ds_read_b64_tr_b16 v[62:63], v87 offset:14336
    buffer_load_dwordx4 v[100:103], v225, s[40:43], s66 offen offset:1024 sc1
    s_waitcnt vmcnt(14) lgkmcnt(8)
    v_mfma_f32_16x16x32_bf16 v[4:7], v[68:71], v[112:115], v[4:7]
    ds_read_b64_tr_b16 v[64:65], v84 offset:16384
    v_mfma_f32_16x16x32_bf16 v[20:23], v[68:71], v[116:119], v[20:23]
    ds_read_b64_tr_b16 v[66:67], v84 offset:18432
    v_mfma_f32_16x16x32_bf16 v[8:11], v[36:39], v[112:115], v[8:11]
    ds_read_b64_tr_b16 v[68:69], v85 offset:16384
    v_mfma_f32_16x16x32_bf16 v[24:27], v[36:39], v[116:119], v[24:27]
    ds_read_b64_tr_b16 v[70:71], v85 offset:18432
    buffer_load_dwordx4 v[104:107], v224, s[40:43], s66 offen offset:2048 sc1
    v_mfma_f32_16x16x32_bf16 v[12:15], v[40:43], v[112:115], v[12:15]
    ds_read_b64_tr_b16 v[36:37], v86 offset:16384
    v_mfma_f32_16x16x32_bf16 v[28:31], v[40:43], v[116:119], v[28:31]
    ds_read_b64_tr_b16 v[38:39], v86 offset:18432
    v_mfma_f32_16x16x32_bf16 v[16:19], v[44:47], v[112:115], v[16:19]
    ds_read_b64_tr_b16 v[40:41], v87 offset:16384
    v_mfma_f32_16x16x32_bf16 v[32:35], v[44:47], v[116:119], v[32:35]
    ds_read_b64_tr_b16 v[42:43], v87 offset:18432
    buffer_load_dwordx4 v[108:111], v225, s[40:43], s66 offen offset:2048 sc1
    s_waitcnt vmcnt(14) lgkmcnt(8)
    v_mfma_f32_16x16x32_bf16 v[4:7], v[48:51], v[120:123], v[4:7]
    ds_read_b64_tr_b16 v[44:45], v84 offset:20480
    v_mfma_f32_16x16x32_bf16 v[20:23], v[48:51], v[124:127], v[20:23]
    ds_read_b64_tr_b16 v[46:47], v84 offset:22528
    v_mfma_f32_16x16x32_bf16 v[8:11], v[52:55], v[120:123], v[8:11]
    ds_read_b64_tr_b16 v[48:49], v85 offset:20480
    v_mfma_f32_16x16x32_bf16 v[24:27], v[52:55], v[124:127], v[24:27]
    ds_read_b64_tr_b16 v[50:51], v85 offset:22528
    buffer_load_dwordx4 v[112:115], v224, s[40:43], s66 offen offset:3072 sc1
    v_mfma_f32_16x16x32_bf16 v[12:15], v[56:59], v[120:123], v[12:15]
    ds_read_b64_tr_b16 v[52:53], v86 offset:20480
    v_mfma_f32_16x16x32_bf16 v[28:31], v[56:59], v[124:127], v[28:31]
    ds_read_b64_tr_b16 v[54:55], v86 offset:22528
    v_mfma_f32_16x16x32_bf16 v[16:19], v[60:63], v[120:123], v[16:19]
    ds_read_b64_tr_b16 v[56:57], v87 offset:20480
    v_mfma_f32_16x16x32_bf16 v[32:35], v[60:63], v[124:127], v[32:35]
    ds_read_b64_tr_b16 v[58:59], v87 offset:22528
    buffer_load_dwordx4 v[116:119], v225, s[40:43], s66 offen offset:3072 sc1
    s_waitcnt vmcnt(14) lgkmcnt(8)
    v_mfma_f32_16x16x32_bf16 v[4:7], v[64:67], v[128:131], v[4:7]
    ds_read_b64_tr_b16 v[60:61], v84 offset:24576
    v_mfma_f32_16x16x32_bf16 v[20:23], v[64:67], v[132:135], v[20:23]
    ds_read_b64_tr_b16 v[62:63], v84 offset:26624
    v_mfma_f32_16x16x32_bf16 v[8:11], v[68:71], v[128:131], v[8:11]
    ds_read_b64_tr_b16 v[64:65], v85 offset:24576
    v_mfma_f32_16x16x32_bf16 v[24:27], v[68:71], v[132:135], v[24:27]
    ds_read_b64_tr_b16 v[66:67], v85 offset:26624
    buffer_load_dwordx4 v[120:123], v224, s[40:43], s67 offen offset:0 sc1
    v_mfma_f32_16x16x32_bf16 v[12:15], v[36:39], v[128:131], v[12:15]
    ds_read_b64_tr_b16 v[68:69], v86 offset:24576
    v_mfma_f32_16x16x32_bf16 v[28:31], v[36:39], v[132:135], v[28:31]
    ds_read_b64_tr_b16 v[70:71], v86 offset:26624
    v_mfma_f32_16x16x32_bf16 v[16:19], v[40:43], v[128:131], v[16:19]
    ds_read_b64_tr_b16 v[36:37], v87 offset:24576
    v_mfma_f32_16x16x32_bf16 v[32:35], v[40:43], v[132:135], v[32:35]
    ds_read_b64_tr_b16 v[38:39], v87 offset:26624
    buffer_load_dwordx4 v[124:127], v225, s[40:43], s67 offen offset:0 sc1
    s_waitcnt vmcnt(14) lgkmcnt(8)
    v_mfma_f32_16x16x32_bf16 v[4:7], v[44:47], v[136:139], v[4:7]
    ds_read_b64_tr_b16 v[40:41], v84 offset:28672
    v_mfma_f32_16x16x32_bf16 v[20:23], v[44:47], v[140:143], v[20:23]
    ds_read_b64_tr_b16 v[42:43], v84 offset:30720
    v_mfma_f32_16x16x32_bf16 v[8:11], v[48:51], v[136:139], v[8:11]
    ds_read_b64_tr_b16 v[44:45], v85 offset:28672
    v_mfma_f32_16x16x32_bf16 v[24:27], v[48:51], v[140:143], v[24:27]
    ds_read_b64_tr_b16 v[46:47], v85 offset:30720
    buffer_load_dwordx4 v[128:131], v224, s[40:43], s67 offen offset:1024 sc1
    v_mfma_f32_16x16x32_bf16 v[12:15], v[52:55], v[136:139], v[12:15]
    ds_read_b64_tr_b16 v[48:49], v86 offset:28672
    v_mfma_f32_16x16x32_bf16 v[28:31], v[52:55], v[140:143], v[28:31]
    ds_read_b64_tr_b16 v[50:51], v86 offset:30720
    v_mfma_f32_16x16x32_bf16 v[16:19], v[56:59], v[136:139], v[16:19]
    ds_read_b64_tr_b16 v[52:53], v87 offset:28672
    v_mfma_f32_16x16x32_bf16 v[32:35], v[56:59], v[140:143], v[32:35]
    ds_read_b64_tr_b16 v[54:55], v87 offset:30720
    buffer_load_dwordx4 v[132:135], v225, s[40:43], s67 offen offset:1024 sc1
    s_waitcnt vmcnt(14) lgkmcnt(8)
    v_mfma_f32_16x16x32_bf16 v[4:7], v[60:63], v[144:147], v[4:7]
    ds_read_b64_tr_b16 v[56:57], v84 offset:32768
    v_mfma_f32_16x16x32_bf16 v[20:23], v[60:63], v[148:151], v[20:23]
    ds_read_b64_tr_b16 v[58:59], v84 offset:34816
    v_mfma_f32_16x16x32_bf16 v[8:11], v[64:67], v[144:147], v[8:11]
    ds_read_b64_tr_b16 v[60:61], v85 offset:32768
    v_mfma_f32_16x16x32_bf16 v[24:27], v[64:67], v[148:151], v[24:27]
    ds_read_b64_tr_b16 v[62:63], v85 offset:34816
    buffer_load_dwordx4 v[136:139], v224, s[40:43], s67 offen offset:2048 sc1
    v_mfma_f32_16x16x32_bf16 v[12:15], v[68:71], v[144:147], v[12:15]
    ds_read_b64_tr_b16 v[64:65], v86 offset:32768
    v_mfma_f32_16x16x32_bf16 v[28:31], v[68:71], v[148:151], v[28:31]
    ds_read_b64_tr_b16 v[66:67], v86 offset:34816
    v_mfma_f32_16x16x32_bf16 v[16:19], v[36:39], v[144:147], v[16:19]
    ds_read_b64_tr_b16 v[68:69], v87 offset:32768
    v_mfma_f32_16x16x32_bf16 v[32:35], v[36:39], v[148:151], v[32:35]
    ds_read_b64_tr_b16 v[70:71], v87 offset:34816
    buffer_load_dwordx4 v[140:143], v225, s[40:43], s67 offen offset:2048 sc1
    s_waitcnt vmcnt(14) lgkmcnt(8)
    v_mfma_f32_16x16x32_bf16 v[4:7], v[40:43], v[152:155], v[4:7]
    ds_read_b64_tr_b16 v[36:37], v84 offset:36864
    v_mfma_f32_16x16x32_bf16 v[20:23], v[40:43], v[156:159], v[20:23]
    ds_read_b64_tr_b16 v[38:39], v84 offset:38912
    v_mfma_f32_16x16x32_bf16 v[8:11], v[44:47], v[152:155], v[8:11]
    ds_read_b64_tr_b16 v[40:41], v85 offset:36864
    v_mfma_f32_16x16x32_bf16 v[24:27], v[44:47], v[156:159], v[24:27]
    ds_read_b64_tr_b16 v[42:43], v85 offset:38912
    buffer_load_dwordx4 v[144:147], v224, s[40:43], s67 offen offset:3072 sc1
    v_mfma_f32_16x16x32_bf16 v[12:15], v[48:51], v[152:155], v[12:15]
    ds_read_b64_tr_b16 v[44:45], v86 offset:36864
    v_mfma_f32_16x16x32_bf16 v[28:31], v[48:51], v[156:159], v[28:31]
    ds_read_b64_tr_b16 v[46:47], v86 offset:38912
    v_mfma_f32_16x16x32_bf16 v[16:19], v[52:55], v[152:155], v[16:19]
    ds_read_b64_tr_b16 v[48:49], v87 offset:36864
    v_mfma_f32_16x16x32_bf16 v[32:35], v[52:55], v[156:159], v[32:35]
    ds_read_b64_tr_b16 v[50:51], v87 offset:38912
    buffer_load_dwordx4 v[148:151], v225, s[40:43], s67 offen offset:3072 sc1
    s_waitcnt vmcnt(14) lgkmcnt(8)
    v_mfma_f32_16x16x32_bf16 v[4:7], v[56:59], v[160:163], v[4:7]
    ds_read_b64_tr_b16 v[52:53], v88 offset:0
    v_mfma_f32_16x16x32_bf16 v[20:23], v[56:59], v[164:167], v[20:23]
    ds_read_b64_tr_b16 v[54:55], v88 offset:2048
    v_mfma_f32_16x16x32_bf16 v[8:11], v[60:63], v[160:163], v[8:11]
    ds_read_b64_tr_b16 v[56:57], v89 offset:0
    v_mfma_f32_16x16x32_bf16 v[24:27], v[60:63], v[164:167], v[24:27]
    ds_read_b64_tr_b16 v[58:59], v89 offset:2048
    buffer_load_dwordx4 v[152:155], v224, s[40:43], s68 offen offset:0 sc1
    v_mfma_f32_16x16x32_bf16 v[12:15], v[64:67], v[160:163], v[12:15]
    ds_read_b64_tr_b16 v[60:61], v90 offset:0
    v_mfma_f32_16x16x32_bf16 v[28:31], v[64:67], v[164:167], v[28:31]
    ds_read_b64_tr_b16 v[62:63], v90 offset:2048
    v_mfma_f32_16x16x32_bf16 v[16:19], v[68:71], v[160:163], v[16:19]
    ds_read_b64_tr_b16 v[64:65], v91 offset:0
    v_mfma_f32_16x16x32_bf16 v[32:35], v[68:71], v[164:167], v[32:35]
    ds_read_b64_tr_b16 v[66:67], v91 offset:2048
    buffer_load_dwordx4 v[156:159], v225, s[40:43], s68 offen offset:0 sc1
    s_waitcnt vmcnt(14) lgkmcnt(8)
    v_mfma_f32_16x16x32_bf16 v[4:7], v[36:39], v[96:99], v[4:7]
    ds_read_b64_tr_b16 v[68:69], v88 offset:4096
    v_mfma_f32_16x16x32_bf16 v[20:23], v[36:39], v[100:103], v[20:23]
    ds_read_b64_tr_b16 v[70:71], v88 offset:6144
    v_mfma_f32_16x16x32_bf16 v[8:11], v[40:43], v[96:99], v[8:11]
    ds_read_b64_tr_b16 v[36:37], v89 offset:4096
    v_mfma_f32_16x16x32_bf16 v[24:27], v[40:43], v[100:103], v[24:27]
    ds_read_b64_tr_b16 v[38:39], v89 offset:6144
    buffer_load_dwordx4 v[160:163], v224, s[40:43], s68 offen offset:1024 sc1
    v_mfma_f32_16x16x32_bf16 v[12:15], v[44:47], v[96:99], v[12:15]
    ds_read_b64_tr_b16 v[40:41], v90 offset:4096
    v_mfma_f32_16x16x32_bf16 v[28:31], v[44:47], v[100:103], v[28:31]
    ds_read_b64_tr_b16 v[42:43], v90 offset:6144
    v_mfma_f32_16x16x32_bf16 v[16:19], v[48:51], v[96:99], v[16:19]
    ds_read_b64_tr_b16 v[44:45], v91 offset:4096
    v_mfma_f32_16x16x32_bf16 v[32:35], v[48:51], v[100:103], v[32:35]
    ds_read_b64_tr_b16 v[46:47], v91 offset:6144
    buffer_load_dwordx4 v[164:167], v225, s[40:43], s68 offen offset:1024 sc1
    s_waitcnt vmcnt(14) lgkmcnt(8)
    v_mfma_f32_16x16x32_bf16 v[4:7], v[52:55], v[104:107], v[4:7]
    ds_read_b64_tr_b16 v[48:49], v88 offset:8192
    v_mfma_f32_16x16x32_bf16 v[20:23], v[52:55], v[108:111], v[20:23]
    ds_read_b64_tr_b16 v[50:51], v88 offset:10240
    v_mfma_f32_16x16x32_bf16 v[8:11], v[56:59], v[104:107], v[8:11]
    ds_read_b64_tr_b16 v[52:53], v89 offset:8192
    v_mfma_f32_16x16x32_bf16 v[24:27], v[56:59], v[108:111], v[24:27]
    ds_read_b64_tr_b16 v[54:55], v89 offset:10240
    buffer_load_dwordx4 v[96:99], v224, s[40:43], s68 offen offset:2048 sc1
    v_mfma_f32_16x16x32_bf16 v[12:15], v[60:63], v[104:107], v[12:15]
    ds_read_b64_tr_b16 v[56:57], v90 offset:8192
    v_mfma_f32_16x16x32_bf16 v[28:31], v[60:63], v[108:111], v[28:31]
    ds_read_b64_tr_b16 v[58:59], v90 offset:10240
    v_mfma_f32_16x16x32_bf16 v[16:19], v[64:67], v[104:107], v[16:19]
    ds_read_b64_tr_b16 v[60:61], v91 offset:8192
    v_mfma_f32_16x16x32_bf16 v[32:35], v[64:67], v[108:111], v[32:35]
    ds_read_b64_tr_b16 v[62:63], v91 offset:10240
    buffer_load_dwordx4 v[100:103], v225, s[40:43], s68 offen offset:2048 sc1
    s_waitcnt vmcnt(14) lgkmcnt(8)
    v_mfma_f32_16x16x32_bf16 v[4:7], v[68:71], v[112:115], v[4:7]
    ds_read_b64_tr_b16 v[64:65], v88 offset:12288
    v_mfma_f32_16x16x32_bf16 v[20:23], v[68:71], v[116:119], v[20:23]
    ds_read_b64_tr_b16 v[66:67], v88 offset:14336
    v_mfma_f32_16x16x32_bf16 v[8:11], v[36:39], v[112:115], v[8:11]
    ds_read_b64_tr_b16 v[68:69], v89 offset:12288
    v_mfma_f32_16x16x32_bf16 v[24:27], v[36:39], v[116:119], v[24:27]
    ds_read_b64_tr_b16 v[70:71], v89 offset:14336
    buffer_load_dwordx4 v[104:107], v224, s[40:43], s68 offen offset:3072 sc1
    v_mfma_f32_16x16x32_bf16 v[12:15], v[40:43], v[112:115], v[12:15]
    ds_read_b64_tr_b16 v[36:37], v90 offset:12288
    v_mfma_f32_16x16x32_bf16 v[28:31], v[40:43], v[116:119], v[28:31]
    ds_read_b64_tr_b16 v[38:39], v90 offset:14336
    v_mfma_f32_16x16x32_bf16 v[16:19], v[44:47], v[112:115], v[16:19]
    ds_read_b64_tr_b16 v[40:41], v91 offset:12288
    v_mfma_f32_16x16x32_bf16 v[32:35], v[44:47], v[116:119], v[32:35]
    ds_read_b64_tr_b16 v[42:43], v91 offset:14336
    buffer_load_dwordx4 v[108:111], v225, s[40:43], s68 offen offset:3072 sc1
    s_waitcnt vmcnt(14) lgkmcnt(8)
    v_mfma_f32_16x16x32_bf16 v[4:7], v[48:51], v[120:123], v[4:7]
    ds_read_b64_tr_b16 v[44:45], v88 offset:16384
    v_mfma_f32_16x16x32_bf16 v[20:23], v[48:51], v[124:127], v[20:23]
    ds_read_b64_tr_b16 v[46:47], v88 offset:18432
    v_mfma_f32_16x16x32_bf16 v[8:11], v[52:55], v[120:123], v[8:11]
    ds_read_b64_tr_b16 v[48:49], v89 offset:16384
    v_mfma_f32_16x16x32_bf16 v[24:27], v[52:55], v[124:127], v[24:27]
    ds_read_b64_tr_b16 v[50:51], v89 offset:18432
    buffer_load_dwordx4 v[112:115], v224, s[40:43], s69 offen offset:0 sc1
    v_mfma_f32_16x16x32_bf16 v[12:15], v[56:59], v[120:123], v[12:15]
    ds_read_b64_tr_b16 v[52:53], v90 offset:16384
    v_mfma_f32_16x16x32_bf16 v[28:31], v[56:59], v[124:127], v[28:31]
    ds_read_b64_tr_b16 v[54:55], v90 offset:18432
    v_mfma_f32_16x16x32_bf16 v[16:19], v[60:63], v[120:123], v[16:19]
    ds_read_b64_tr_b16 v[56:57], v91 offset:16384
    v_mfma_f32_16x16x32_bf16 v[32:35], v[60:63], v[124:127], v[32:35]
    ds_read_b64_tr_b16 v[58:59], v91 offset:18432
    buffer_load_dwordx4 v[116:119], v225, s[40:43], s69 offen offset:0 sc1
    s_waitcnt vmcnt(14) lgkmcnt(8)
    v_mfma_f32_16x16x32_bf16 v[4:7], v[64:67], v[128:131], v[4:7]
    ds_read_b64_tr_b16 v[60:61], v88 offset:20480
    v_mfma_f32_16x16x32_bf16 v[20:23], v[64:67], v[132:135], v[20:23]
    ds_read_b64_tr_b16 v[62:63], v88 offset:22528
    v_mfma_f32_16x16x32_bf16 v[8:11], v[68:71], v[128:131], v[8:11]
    ds_read_b64_tr_b16 v[64:65], v89 offset:20480
    v_mfma_f32_16x16x32_bf16 v[24:27], v[68:71], v[132:135], v[24:27]
    ds_read_b64_tr_b16 v[66:67], v89 offset:22528
    buffer_load_dwordx4 v[120:123], v224, s[40:43], s69 offen offset:1024 sc1
    v_mfma_f32_16x16x32_bf16 v[12:15], v[36:39], v[128:131], v[12:15]
    ds_read_b64_tr_b16 v[68:69], v90 offset:20480
    v_mfma_f32_16x16x32_bf16 v[28:31], v[36:39], v[132:135], v[28:31]
    ds_read_b64_tr_b16 v[70:71], v90 offset:22528
    v_mfma_f32_16x16x32_bf16 v[16:19], v[40:43], v[128:131], v[16:19]
    ds_read_b64_tr_b16 v[36:37], v91 offset:20480
    v_mfma_f32_16x16x32_bf16 v[32:35], v[40:43], v[132:135], v[32:35]
    ds_read_b64_tr_b16 v[38:39], v91 offset:22528
    buffer_load_dwordx4 v[124:127], v225, s[40:43], s69 offen offset:1024 sc1
    s_waitcnt vmcnt(14) lgkmcnt(8)
    v_mfma_f32_16x16x32_bf16 v[4:7], v[44:47], v[136:139], v[4:7]
    ds_read_b64_tr_b16 v[40:41], v88 offset:24576
    v_mfma_f32_16x16x32_bf16 v[20:23], v[44:47], v[140:143], v[20:23]
    ds_read_b64_tr_b16 v[42:43], v88 offset:26624
    v_mfma_f32_16x16x32_bf16 v[8:11], v[48:51], v[136:139], v[8:11]
    ds_read_b64_tr_b16 v[44:45], v89 offset:24576
    v_mfma_f32_16x16x32_bf16 v[24:27], v[48:51], v[140:143], v[24:27]
    ds_read_b64_tr_b16 v[46:47], v89 offset:26624
    buffer_load_dwordx4 v[128:131], v224, s[40:43], s69 offen offset:2048 sc1
    v_mfma_f32_16x16x32_bf16 v[12:15], v[52:55], v[136:139], v[12:15]
    ds_read_b64_tr_b16 v[48:49], v90 offset:24576
    v_mfma_f32_16x16x32_bf16 v[28:31], v[52:55], v[140:143], v[28:31]
    ds_read_b64_tr_b16 v[50:51], v90 offset:26624
    v_mfma_f32_16x16x32_bf16 v[16:19], v[56:59], v[136:139], v[16:19]
    ds_read_b64_tr_b16 v[52:53], v91 offset:24576
    v_mfma_f32_16x16x32_bf16 v[32:35], v[56:59], v[140:143], v[32:35]
    ds_read_b64_tr_b16 v[54:55], v91 offset:26624
    buffer_load_dwordx4 v[132:135], v225, s[40:43], s69 offen offset:2048 sc1
    s_waitcnt vmcnt(14) lgkmcnt(8)
    v_mfma_f32_16x16x32_bf16 v[4:7], v[60:63], v[144:147], v[4:7]
    ds_read_b64_tr_b16 v[56:57], v88 offset:28672
    v_mfma_f32_16x16x32_bf16 v[20:23], v[60:63], v[148:151], v[20:23]
    ds_read_b64_tr_b16 v[58:59], v88 offset:30720
    v_mfma_f32_16x16x32_bf16 v[8:11], v[64:67], v[144:147], v[8:11]
    ds_read_b64_tr_b16 v[60:61], v89 offset:28672
    v_mfma_f32_16x16x32_bf16 v[24:27], v[64:67], v[148:151], v[24:27]
    ds_read_b64_tr_b16 v[62:63], v89 offset:30720
    buffer_load_dwordx4 v[136:139], v224, s[40:43], s69 offen offset:3072 sc1
    v_mfma_f32_16x16x32_bf16 v[12:15], v[68:71], v[144:147], v[12:15]
    ds_read_b64_tr_b16 v[64:65], v90 offset:28672
    v_mfma_f32_16x16x32_bf16 v[28:31], v[68:71], v[148:151], v[28:31]
    ds_read_b64_tr_b16 v[66:67], v90 offset:30720
    v_mfma_f32_16x16x32_bf16 v[16:19], v[36:39], v[144:147], v[16:19]
    ds_read_b64_tr_b16 v[68:69], v91 offset:28672
    v_mfma_f32_16x16x32_bf16 v[32:35], v[36:39], v[148:151], v[32:35]
    ds_read_b64_tr_b16 v[70:71], v91 offset:30720
    buffer_load_dwordx4 v[140:143], v225, s[40:43], s69 offen offset:3072 sc1
    s_waitcnt vmcnt(14) lgkmcnt(8)
    v_mfma_f32_16x16x32_bf16 v[4:7], v[40:43], v[152:155], v[4:7]
    ds_read_b64_tr_b16 v[36:37], v88 offset:32768
    v_mfma_f32_16x16x32_bf16 v[20:23], v[40:43], v[156:159], v[20:23]
    ds_read_b64_tr_b16 v[38:39], v88 offset:34816
    v_mfma_f32_16x16x32_bf16 v[8:11], v[44:47], v[152:155], v[8:11]
    ds_read_b64_tr_b16 v[40:41], v89 offset:32768
    v_mfma_f32_16x16x32_bf16 v[24:27], v[44:47], v[156:159], v[24:27]
    ds_read_b64_tr_b16 v[42:43], v89 offset:34816
    buffer_load_dwordx4 v[144:147], v224, s[40:43], s70 offen offset:0 sc1
    v_mfma_f32_16x16x32_bf16 v[12:15], v[48:51], v[152:155], v[12:15]
    ds_read_b64_tr_b16 v[44:45], v90 offset:32768
    v_mfma_f32_16x16x32_bf16 v[28:31], v[48:51], v[156:159], v[28:31]
    ds_read_b64_tr_b16 v[46:47], v90 offset:34816
    v_mfma_f32_16x16x32_bf16 v[16:19], v[52:55], v[152:155], v[16:19]
    ds_read_b64_tr_b16 v[48:49], v91 offset:32768
    v_mfma_f32_16x16x32_bf16 v[32:35], v[52:55], v[156:159], v[32:35]
    ds_read_b64_tr_b16 v[50:51], v91 offset:34816
    buffer_load_dwordx4 v[148:151], v225, s[40:43], s70 offen offset:0 sc1
    ds_read_b32 v1, v228 offset:12
    s_waitcnt vmcnt(14) lgkmcnt(9)
    v_mfma_f32_16x16x32_bf16 v[4:7], v[56:59], v[160:163], v[4:7]
    ds_read_b64_tr_b16 v[52:53], v88 offset:36864
    v_mfma_f32_16x16x32_bf16 v[20:23], v[56:59], v[164:167], v[20:23]
    ds_read_b64_tr_b16 v[54:55], v88 offset:38912
    v_mfma_f32_16x16x32_bf16 v[8:11], v[60:63], v[160:163], v[8:11]
    ds_read_b64_tr_b16 v[56:57], v89 offset:36864
    v_mfma_f32_16x16x32_bf16 v[24:27], v[60:63], v[164:167], v[24:27]
    ds_read_b64_tr_b16 v[58:59], v89 offset:38912
    buffer_load_dwordx4 v[152:155], v224, s[40:43], s70 offen offset:1024 sc1
    v_mfma_f32_16x16x32_bf16 v[12:15], v[64:67], v[160:163], v[12:15]
    ds_read_b64_tr_b16 v[60:61], v90 offset:36864
    v_mfma_f32_16x16x32_bf16 v[28:31], v[64:67], v[164:167], v[28:31]
    ds_read_b64_tr_b16 v[62:63], v90 offset:38912
    v_mfma_f32_16x16x32_bf16 v[16:19], v[68:71], v[160:163], v[16:19]
    ds_read_b64_tr_b16 v[64:65], v91 offset:36864
    v_mfma_f32_16x16x32_bf16 v[32:35], v[68:71], v[164:167], v[32:35]
    ds_read_b64_tr_b16 v[66:67], v91 offset:38912
    buffer_load_dwordx4 v[156:159], v225, s[40:43], s70 offen offset:1024 sc1
    s_waitcnt lgkmcnt(8)
    v_readfirstlane_b32 s37, v1
    s_nop 0
    s_cmp_ge_u32 s37, 4
    s_cbranch_scc1 L_sl_done_45
    s_mov_b32 s38, 1048576
L_sl_loop_46:
    ds_read_b32 v1, v228 offset:12
    s_waitcnt lgkmcnt(0)
    v_readfirstlane_b32 s37, v1
    s_nop 0
    s_cmp_ge_u32 s37, 4
    s_cbranch_scc1 L_sl_done_45
    s_sleep 1
    s_sub_u32 s38, s38, 1
    s_cbranch_scc0 L_sl_loop_46
L_sl_done_45:
    s_waitcnt vmcnt(14)
    v_mfma_f32_16x16x32_bf16 v[4:7], v[36:39], v[96:99], v[4:7]
    ds_read_b64_tr_b16 v[68:69], v92 offset:0
    v_mfma_f32_16x16x32_bf16 v[20:23], v[36:39], v[100:103], v[20:23]
    ds_read_b64_tr_b16 v[70:71], v92 offset:2048
    v_mfma_f32_16x16x32_bf16 v[8:11], v[40:43], v[96:99], v[8:11]
    ds_read_b64_tr_b16 v[36:37], v93 offset:0
    v_mfma_f32_16x16x32_bf16 v[24:27], v[40:43], v[100:103], v[24:27]
    ds_read_b64_tr_b16 v[38:39], v93 offset:2048
    buffer_load_dwordx4 v[160:163], v224, s[40:43], s70 offen offset:2048 sc1
    v_mfma_f32_16x16x32_bf16 v[12:15], v[44:47], v[96:99], v[12:15]
    ds_read_b64_tr_b16 v[40:41], v94 offset:0
    v_mfma_f32_16x16x32_bf16 v[28:31], v[44:47], v[100:103], v[28:31]
    ds_read_b64_tr_b16 v[42:43], v94 offset:2048
    v_mfma_f32_16x16x32_bf16 v[16:19], v[48:51], v[96:99], v[16:19]
    ds_read_b64_tr_b16 v[44:45], v95 offset:0
    v_mfma_f32_16x16x32_bf16 v[32:35], v[48:51], v[100:103], v[32:35]
    ds_read_b64_tr_b16 v[46:47], v95 offset:2048
    buffer_load_dwordx4 v[164:167], v225, s[40:43], s70 offen offset:2048 sc1
    s_waitcnt vmcnt(14) lgkmcnt(8)
    v_mfma_f32_16x16x32_bf16 v[4:7], v[52:55], v[104:107], v[4:7]
    ds_read_b64_tr_b16 v[48:49], v92 offset:4096
    v_mfma_f32_16x16x32_bf16 v[20:23], v[52:55], v[108:111], v[20:23]
    ds_read_b64_tr_b16 v[50:51], v92 offset:6144
    v_mfma_f32_16x16x32_bf16 v[8:11], v[56:59], v[104:107], v[8:11]
    ds_read_b64_tr_b16 v[52:53], v93 offset:4096
    v_mfma_f32_16x16x32_bf16 v[24:27], v[56:59], v[108:111], v[24:27]
    ds_read_b64_tr_b16 v[54:55], v93 offset:6144
    buffer_load_dwordx4 v[96:99], v224, s[40:43], s70 offen offset:3072 sc1
    v_mfma_f32_16x16x32_bf16 v[12:15], v[60:63], v[104:107], v[12:15]
    ds_read_b64_tr_b16 v[56:57], v94 offset:4096
    v_mfma_f32_16x16x32_bf16 v[28:31], v[60:63], v[108:111], v[28:31]
    ds_read_b64_tr_b16 v[58:59], v94 offset:6144
    v_mfma_f32_16x16x32_bf16 v[16:19], v[64:67], v[104:107], v[16:19]
    ds_read_b64_tr_b16 v[60:61], v95 offset:4096
    v_mfma_f32_16x16x32_bf16 v[32:35], v[64:67], v[108:111], v[32:35]
    ds_read_b64_tr_b16 v[62:63], v95 offset:6144
    buffer_load_dwordx4 v[100:103], v225, s[40:43], s70 offen offset:3072 sc1
    s_waitcnt vmcnt(14) lgkmcnt(8)
    v_mfma_f32_16x16x32_bf16 v[4:7], v[68:71], v[112:115], v[4:7]
    ds_read_b64_tr_b16 v[64:65], v92 offset:8448
    v_mfma_f32_16x16x32_bf16 v[20:23], v[68:71], v[116:119], v[20:23]
    ds_read_b64_tr_b16 v[66:67], v92 offset:10496
    v_mfma_f32_16x16x32_bf16 v[8:11], v[36:39], v[112:115], v[8:11]
    ds_read_b64_tr_b16 v[68:69], v93 offset:8448
    v_mfma_f32_16x16x32_bf16 v[24:27], v[36:39], v[116:119], v[24:27]
    ds_read_b64_tr_b16 v[70:71], v93 offset:10496
    buffer_load_dwordx4 v[104:107], v224, s[40:43], s71 offen offset:0 sc1
    v_mfma_f32_16x16x32_bf16 v[12:15], v[40:43], v[112:115], v[12:15]
    ds_read_b64_tr_b16 v[36:37], v94 offset:8448
    v_mfma_f32_16x16x32_bf16 v[28:31], v[40:43], v[116:119], v[28:31]
    ds_read_b64_tr_b16 v[38:39], v94 offset:10496
    v_mfma_f32_16x16x32_bf16 v[16:19], v[44:47], v[112:115], v[16:19]
    ds_read_b64_tr_b16 v[40:41], v95 offset:8448
    v_mfma_f32_16x16x32_bf16 v[32:35], v[44:47], v[116:119], v[32:35]
    ds_read_b64_tr_b16 v[42:43], v95 offset:10496
    buffer_load_dwordx4 v[108:111], v225, s[40:43], s71 offen offset:0 sc1
    s_waitcnt vmcnt(14) lgkmcnt(8)
    v_mfma_f32_16x16x32_bf16 v[4:7], v[48:51], v[120:123], v[4:7]
    ds_read_b64_tr_b16 v[44:45], v92 offset:12544
    v_mfma_f32_16x16x32_bf16 v[20:23], v[48:51], v[124:127], v[20:23]
    ds_read_b64_tr_b16 v[46:47], v92 offset:14592
    v_mfma_f32_16x16x32_bf16 v[8:11], v[52:55], v[120:123], v[8:11]
    ds_read_b64_tr_b16 v[48:49], v93 offset:12544
    v_mfma_f32_16x16x32_bf16 v[24:27], v[52:55], v[124:127], v[24:27]
    ds_read_b64_tr_b16 v[50:51], v93 offset:14592
    buffer_load_dwordx4 v[112:115], v224, s[40:43], s71 offen offset:1024 sc1
    v_mfma_f32_16x16x32_bf16 v[12:15], v[56:59], v[120:123], v[12:15]
    ds_read_b64_tr_b16 v[52:53], v94 offset:12544
    v_mfma_f32_16x16x32_bf16 v[28:31], v[56:59], v[124:127], v[28:31]
    ds_read_b64_tr_b16 v[54:55], v94 offset:14592
    v_mfma_f32_16x16x32_bf16 v[16:19], v[60:63], v[120:123], v[16:19]
    ds_read_b64_tr_b16 v[56:57], v95 offset:12544
    v_mfma_f32_16x16x32_bf16 v[32:35], v[60:63], v[124:127], v[32:35]
    ds_read_b64_tr_b16 v[58:59], v95 offset:14592
    buffer_load_dwordx4 v[116:119], v225, s[40:43], s71 offen offset:1024 sc1
    s_waitcnt vmcnt(14) lgkmcnt(8)
    v_mfma_f32_16x16x32_bf16 v[4:7], v[64:67], v[128:131], v[4:7]
    ds_read_b64_tr_b16 v[60:61], v92 offset:16896
    v_mfma_f32_16x16x32_bf16 v[20:23], v[64:67], v[132:135], v[20:23]
    ds_read_b64_tr_b16 v[62:63], v92 offset:18944
    v_mfma_f32_16x16x32_bf16 v[8:11], v[68:71], v[128:131], v[8:11]
    ds_read_b64_tr_b16 v[64:65], v93 offset:16896
    v_mfma_f32_16x16x32_bf16 v[24:27], v[68:71], v[132:135], v[24:27]
    ds_read_b64_tr_b16 v[66:67], v93 offset:18944
    buffer_load_dwordx4 v[120:123], v224, s[40:43], s71 offen offset:2048 sc1
    v_mfma_f32_16x16x32_bf16 v[12:15], v[36:39], v[128:131], v[12:15]
    ds_read_b64_tr_b16 v[68:69], v94 offset:16896
    v_mfma_f32_16x16x32_bf16 v[28:31], v[36:39], v[132:135], v[28:31]
    ds_read_b64_tr_b16 v[70:71], v94 offset:18944
    v_mfma_f32_16x16x32_bf16 v[16:19], v[40:43], v[128:131], v[16:19]
    ds_read_b64_tr_b16 v[36:37], v95 offset:16896
    v_mfma_f32_16x16x32_bf16 v[32:35], v[40:43], v[132:135], v[32:35]
    ds_read_b64_tr_b16 v[38:39], v95 offset:18944
    buffer_load_dwordx4 v[124:127], v225, s[40:43], s71 offen offset:2048 sc1
    s_waitcnt vmcnt(14) lgkmcnt(8)
    v_mfma_f32_16x16x32_bf16 v[4:7], v[44:47], v[136:139], v[4:7]
    ds_read_b64_tr_b16 v[40:41], v92 offset:20992
    v_mfma_f32_16x16x32_bf16 v[20:23], v[44:47], v[140:143], v[20:23]
    ds_read_b64_tr_b16 v[42:43], v92 offset:23040
    v_mfma_f32_16x16x32_bf16 v[8:11], v[48:51], v[136:139], v[8:11]
    ds_read_b64_tr_b16 v[44:45], v93 offset:20992
    v_mfma_f32_16x16x32_bf16 v[24:27], v[48:51], v[140:143], v[24:27]
    ds_read_b64_tr_b16 v[46:47], v93 offset:23040
    buffer_load_dwordx4 v[128:131], v224, s[40:43], s71 offen offset:3072 sc1
    v_mfma_f32_16x16x32_bf16 v[12:15], v[52:55], v[136:139], v[12:15]
    ds_read_b64_tr_b16 v[48:49], v94 offset:20992
    v_mfma_f32_16x16x32_bf16 v[28:31], v[52:55], v[140:143], v[28:31]
    ds_read_b64_tr_b16 v[50:51], v94 offset:23040
    v_mfma_f32_16x16x32_bf16 v[16:19], v[56:59], v[136:139], v[16:19]
    ds_read_b64_tr_b16 v[52:53], v95 offset:20992
    v_mfma_f32_16x16x32_bf16 v[32:35], v[56:59], v[140:143], v[32:35]
    ds_read_b64_tr_b16 v[54:55], v95 offset:23040
    buffer_load_dwordx4 v[132:135], v225, s[40:43], s71 offen offset:3072 sc1
    s_waitcnt vmcnt(14) lgkmcnt(8)
    v_mfma_f32_16x16x32_bf16 v[4:7], v[60:63], v[144:147], v[4:7]
    ds_read_b64_tr_b16 v[56:57], v92 offset:25344
    v_mfma_f32_16x16x32_bf16 v[20:23], v[60:63], v[148:151], v[20:23]
    ds_read_b64_tr_b16 v[58:59], v92 offset:27392
    v_mfma_f32_16x16x32_bf16 v[8:11], v[64:67], v[144:147], v[8:11]
    ds_read_b64_tr_b16 v[60:61], v93 offset:25344
    v_mfma_f32_16x16x32_bf16 v[24:27], v[64:67], v[148:151], v[24:27]
    ds_read_b64_tr_b16 v[62:63], v93 offset:27392
    v_mfma_f32_16x16x32_bf16 v[12:15], v[68:71], v[144:147], v[12:15]
    ds_read_b64_tr_b16 v[64:65], v94 offset:25344
    v_mfma_f32_16x16x32_bf16 v[28:31], v[68:71], v[148:151], v[28:31]
    ds_read_b64_tr_b16 v[66:67], v94 offset:27392
    v_mfma_f32_16x16x32_bf16 v[16:19], v[36:39], v[144:147], v[16:19]
    ds_read_b64_tr_b16 v[68:69], v95 offset:25344
    v_mfma_f32_16x16x32_bf16 v[32:35], v[36:39], v[148:151], v[32:35]
    ds_read_b64_tr_b16 v[70:71], v95 offset:27392
    s_waitcnt vmcnt(12) lgkmcnt(8)
    v_mfma_f32_16x16x32_bf16 v[4:7], v[40:43], v[152:155], v[4:7]
    ds_read_b64_tr_b16 v[36:37], v92 offset:29440
    v_mfma_f32_16x16x32_bf16 v[20:23], v[40:43], v[156:159], v[20:23]
    ds_read_b64_tr_b16 v[38:39], v92 offset:31488
    v_mfma_f32_16x16x32_bf16 v[8:11], v[44:47], v[152:155], v[8:11]
    ds_read_b64_tr_b16 v[40:41], v93 offset:29440
    v_mfma_f32_16x16x32_bf16 v[24:27], v[44:47], v[156:159], v[24:27]
    ds_read_b64_tr_b16 v[42:43], v93 offset:31488
    v_mfma_f32_16x16x32_bf16 v[12:15], v[48:51], v[152:155], v[12:15]
    ds_read_b64_tr_b16 v[44:45], v94 offset:29440
    v_mfma_f32_16x16x32_bf16 v[28:31], v[48:51], v[156:159], v[28:31]
    ds_read_b64_tr_b16 v[46:47], v94 offset:31488
    v_mfma_f32_16x16x32_bf16 v[16:19], v[52:55], v[152:155], v[16:19]
    ds_read_b64_tr_b16 v[48:49], v95 offset:29440
    v_mfma_f32_16x16x32_bf16 v[32:35], v[52:55], v[156:159], v[32:35]
    ds_read_b64_tr_b16 v[50:51], v95 offset:31488
    s_waitcnt vmcnt(10) lgkmcnt(8)
    v_mfma_f32_16x16x32_bf16 v[4:7], v[56:59], v[160:163], v[4:7]
    ds_read_b64_tr_b16 v[52:53], v84 offset:41984
    v_mfma_f32_16x16x32_bf16 v[20:23], v[56:59], v[164:167], v[20:23]
    ds_read_b64_tr_b16 v[54:55], v84 offset:44032
    v_mfma_f32_16x16x32_bf16 v[8:11], v[60:63], v[160:163], v[8:11]
    ds_read_b64_tr_b16 v[56:57], v85 offset:41984
    v_mfma_f32_16x16x32_bf16 v[24:27], v[60:63], v[164:167], v[24:27]
    ds_read_b64_tr_b16 v[58:59], v85 offset:44032
    v_mfma_f32_16x16x32_bf16 v[12:15], v[64:67], v[160:163], v[12:15]
    ds_read_b64_tr_b16 v[60:61], v86 offset:41984
    v_mfma_f32_16x16x32_bf16 v[28:31], v[64:67], v[164:167], v[28:31]
    ds_read_b64_tr_b16 v[62:63], v86 offset:44032
    v_mfma_f32_16x16x32_bf16 v[16:19], v[68:71], v[160:163], v[16:19]
    ds_read_b64_tr_b16 v[64:65], v87 offset:41984
    v_mfma_f32_16x16x32_bf16 v[32:35], v[68:71], v[164:167], v[32:35]
    ds_read_b64_tr_b16 v[66:67], v87 offset:44032
    s_waitcnt vmcnt(8) lgkmcnt(8)
    v_mfma_f32_16x16x32_bf16 v[4:7], v[36:39], v[96:99], v[4:7]
    ds_read_b64_tr_b16 v[68:69], v84 offset:46080
    v_mfma_f32_16x16x32_bf16 v[20:23], v[36:39], v[100:103], v[20:23]
    ds_read_b64_tr_b16 v[70:71], v84 offset:48128
    v_mfma_f32_16x16x32_bf16 v[8:11], v[40:43], v[96:99], v[8:11]
    ds_read_b64_tr_b16 v[36:37], v85 offset:46080
    v_mfma_f32_16x16x32_bf16 v[24:27], v[40:43], v[100:103], v[24:27]
    ds_read_b64_tr_b16 v[38:39], v85 offset:48128
    v_mfma_f32_16x16x32_bf16 v[12:15], v[44:47], v[96:99], v[12:15]
    ds_read_b64_tr_b16 v[40:41], v86 offset:46080
    v_mfma_f32_16x16x32_bf16 v[28:31], v[44:47], v[100:103], v[28:31]
    ds_read_b64_tr_b16 v[42:43], v86 offset:48128
    v_mfma_f32_16x16x32_bf16 v[16:19], v[48:51], v[96:99], v[16:19]
    ds_read_b64_tr_b16 v[44:45], v87 offset:46080
    v_mfma_f32_16x16x32_bf16 v[32:35], v[48:51], v[100:103], v[32:35]
    ds_read_b64_tr_b16 v[46:47], v87 offset:48128
    s_waitcnt vmcnt(6) lgkmcnt(8)
    v_mfma_f32_16x16x32_bf16 v[4:7], v[52:55], v[104:107], v[4:7]
    ds_read_b64_tr_b16 v[48:49], v84 offset:51200
    v_mfma_f32_16x16x32_bf16 v[20:23], v[52:55], v[108:111], v[20:23]
    ds_read_b64_tr_b16 v[50:51], v84 offset:53248
    v_mfma_f32_16x16x32_bf16 v[8:11], v[56:59], v[104:107], v[8:11]
    ds_read_b64_tr_b16 v[52:53], v85 offset:51200
    v_mfma_f32_16x16x32_bf16 v[24:27], v[56:59], v[108:111], v[24:27]
    ds_read_b64_tr_b16 v[54:55], v85 offset:53248
    v_mfma_f32_16x16x32_bf16 v[12:15], v[60:63], v[104:107], v[12:15]
    ds_read_b64_tr_b16 v[56:57], v86 offset:51200
    v_mfma_f32_16x16x32_bf16 v[28:31], v[60:63], v[108:111], v[28:31]
    ds_read_b64_tr_b16 v[58:59], v86 offset:53248
    v_mfma_f32_16x16x32_bf16 v[16:19], v[64:67], v[104:107], v[16:19]
    ds_read_b64_tr_b16 v[60:61], v87 offset:51200
    v_mfma_f32_16x16x32_bf16 v[32:35], v[64:67], v[108:111], v[32:35]
    ds_read_b64_tr_b16 v[62:63], v87 offset:53248
    s_waitcnt vmcnt(4) lgkmcnt(8)
    v_mfma_f32_16x16x32_bf16 v[4:7], v[68:71], v[112:115], v[4:7]
    ds_read_b64_tr_b16 v[64:65], v84 offset:55296
    v_mfma_f32_16x16x32_bf16 v[20:23], v[68:71], v[116:119], v[20:23]
    ds_read_b64_tr_b16 v[66:67], v84 offset:57344
    v_mfma_f32_16x16x32_bf16 v[8:11], v[36:39], v[112:115], v[8:11]
    ds_read_b64_tr_b16 v[68:69], v85 offset:55296
    v_mfma_f32_16x16x32_bf16 v[24:27], v[36:39], v[116:119], v[24:27]
    ds_read_b64_tr_b16 v[70:71], v85 offset:57344
    v_mfma_f32_16x16x32_bf16 v[12:15], v[40:43], v[112:115], v[12:15]
    ds_read_b64_tr_b16 v[36:37], v86 offset:55296
    v_mfma_f32_16x16x32_bf16 v[28:31], v[40:43], v[116:119], v[28:31]
    ds_read_b64_tr_b16 v[38:39], v86 offset:57344
    v_mfma_f32_16x16x32_bf16 v[16:19], v[44:47], v[112:115], v[16:19]
    ds_read_b64_tr_b16 v[40:41], v87 offset:55296
    v_mfma_f32_16x16x32_bf16 v[32:35], v[44:47], v[116:119], v[32:35]
    ds_read_b64_tr_b16 v[42:43], v87 offset:57344
    s_waitcnt vmcnt(2) lgkmcnt(8)
    v_mfma_f32_16x16x32_bf16 v[4:7], v[48:51], v[120:123], v[4:7]
    s_mul_i32 s37, s32, 80896
    s_lshl_b32 s38, s33, 11
    v_mfma_f32_16x16x32_bf16 v[20:23], v[48:51], v[124:127], v[20:23]
    s_add_u32 s37, s37, s38
    s_add_u32 s37, s37, 78848
    v_mfma_f32_16x16x32_bf16 v[8:11], v[52:55], v[120:123], v[8:11]
    v_lshrrev_b32 v1, 5, v0
    v_xor_b32 v1, v1, v0
    v_mfma_f32_16x16x32_bf16 v[24:27], v[52:55], v[124:127], v[24:27]
    v_and_b32 v1, 7, v1
    v_lshl_add_u32 v1, v1, 4, s37
    v_mfma_f32_16x16x32_bf16 v[12:15], v[56:59], v[120:123], v[12:15]
    v_bfe_u32 v2, v0, 4, 1
    v_lshl_add_u32 v1, v2, 3, v1
    v_mfma_f32_16x16x32_bf16 v[28:31], v[56:59], v[124:127], v[28:31]
    v_and_b32 v2, 15, v0
    v_lshl_add_u32 v84, v2, 7, v1
    v_mfma_f32_16x16x32_bf16 v[16:19], v[60:63], v[120:123], v[16:19]
    v_xor_b32 v85, 32, v84
    v_xor_b32 v86, 64, v84
    v_mfma_f32_16x16x32_bf16 v[32:35], v[60:63], v[124:127], v[32:35]
    v_xor_b32 v87, 96, v84
    v_lshrrev_b32 v1, 3, v0
    s_waitcnt vmcnt(0) lgkmcnt(0)
    v_mfma_f32_16x16x32_bf16 v[4:7], v[64:67], v[128:131], v[4:7]
    v_xor_b32 v1, v1, v0
    v_and_b32 v1, 7, v1
    v_mfma_f32_16x16x32_bf16 v[20:23], v[64:67], v[132:135], v[20:23]
    v_and_b32 v2, 56, v0
    v_add_u32 v1, v1, v2
    v_mfma_f32_16x16x32_bf16 v[8:11], v[68:71], v[128:131], v[8:11]
    v_lshl_add_u32 v88, v1, 4, s37
    v_mfma_f32_16x16x32_bf16 v[24:27], v[68:71], v[132:135], v[24:27]
    v_mfma_f32_16x16x32_bf16 v[12:15], v[36:39], v[128:131], v[12:15]
    v_mfma_f32_16x16x32_bf16 v[28:31], v[36:39], v[132:135], v[28:31]
    v_mfma_f32_16x16x32_bf16 v[16:19], v[40:43], v[128:131], v[16:19]
    v_mfma_f32_16x16x32_bf16 v[32:35], v[40:43], v[132:135], v[32:35]
    v_cvt_pk_bf16_f32 v36, v4, v5
    v_cvt_pk_bf16_f32 v37, v6, v7
    ds_write_b64 v84, v[36:37]
    v_cvt_pk_bf16_f32 v38, v8, v9
    v_cvt_pk_bf16_f32 v39, v10, v11
    ds_write_b64 v85, v[38:39]
    v_cvt_pk_bf16_f32 v40, v12, v13
    v_cvt_pk_bf16_f32 v41, v14, v15
    ds_write_b64 v86, v[40:41]
    v_cvt_pk_bf16_f32 v42, v16, v17
    v_cvt_pk_bf16_f32 v43, v18, v19
    ds_write_b64 v87, v[42:43]
    ds_read_b128 v[52:55], v88 offset:0
    ds_read_b128 v[56:59], v88 offset:1024
    v_cvt_pk_bf16_f32 v44, v20, v21
    v_cvt_pk_bf16_f32 v45, v22, v23
    ds_write_b64 v84, v[44:45]
    v_cvt_pk_bf16_f32 v46, v24, v25
    v_cvt_pk_bf16_f32 v47, v26, v27
    ds_write_b64 v85, v[46:47]
    v_cvt_pk_bf16_f32 v48, v28, v29
    v_cvt_pk_bf16_f32 v49, v30, v31
    ds_write_b64 v86, v[48:49]
    v_cvt_pk_bf16_f32 v50, v32, v33
    v_cvt_pk_bf16_f32 v51, v34, v35
    ds_write_b64 v87, v[50:51]
    ds_read_b128 v[60:63], v88 offset:0
    ds_read_b128 v[64:67], v88 offset:1024
    s_mov_b32 s37, 0
    s_waitcnt lgkmcnt(7)
    buffer_store_dwordx4 v[52:55], v226, s[48:51], s37 offen nt
    s_mov_b32 s37, 65536
    s_waitcnt lgkmcnt(6)
    buffer_store_dwordx4 v[56:59], v226, s[48:51], s37 offen nt
    s_mov_b32 s37, 131072
    s_waitcnt lgkmcnt(1)
    buffer_store_dwordx4 v[60:63], v226, s[48:51], s37 offen nt
    s_mov_b32 s37, 196608
    s_waitcnt lgkmcnt(0)
    buffer_store_dwordx4 v[64:67], v226, s[48:51], s37 offen nt
    s_endpgm
L_g1_rare:
    s_waitcnt vmcnt(0)
    s_cmp_lg_u32 s36, 1
    s_cbranch_scc1 L_g1_bar
    v_readfirstlane_b32 s38, v1
    s_nop 0
    s_cmp_ge_u32 s38, 4
    s_cbranch_scc1 L_sl_done_47
    s_mov_b32 s39, 1048576
L_sl_loop_48:
    ds_read_b32 v1, v228 offset:24
    s_waitcnt lgkmcnt(0)
    v_readfirstlane_b32 s38, v1
    s_nop 0
    s_cmp_ge_u32 s38, 4
    s_cbranch_scc1 L_sl_done_47
    s_sleep 1
    s_sub_u32 s39, s39, 1
    s_cbranch_scc0 L_sl_loop_48
L_sl_done_47:
    s_branch L_g1_nobar
L_end:
    s_endpgm
.section .rodata,"a"
.p2align 6
.amdhsa_kernel concat_heads__ssm_conv_h3__sliding_local_dilated__prompt_kernel
  .amdhsa_next_free_vgpr 256
  .amdhsa_next_free_sgpr 102
  .amdhsa_accum_offset 256
  .amdhsa_group_segment_fixed_size 0
  .amdhsa_kernarg_size 96
  .amdhsa_user_sgpr_count 2
  .amdhsa_user_sgpr_kernarg_segment_ptr 1
  .amdhsa_system_sgpr_workgroup_id_x 1
  .amdhsa_float_denorm_mode_32 3
.end_amdhsa_kernel
```

```asm
; @launch grid=(256,1,1) block=(512,1,1) lds=163840
.amdgcn_target "amdgcn-amd-amdhsa--gfx950"
.text
.globl concat_heads__ssm_conv_h3__sliding_local_dilated__prompt_kernel
.p2align 8
.type concat_heads__ssm_conv_h3__sliding_local_dilated__prompt_kernel,@function
concat_heads__ssm_conv_h3__sliding_local_dilated__prompt_kernel:
L_entry:
    s_getpc_b64 s[32:33]
    s_cmp_ge_u32 s2, 256
    s_cbranch_scc1 L_end
    s_load_dwordx16 s[8:23], s[0:1], 0
    s_load_dwordx8 s[24:31], s[0:1], 64
    v_lshrrev_b32 v1, 6, v0
    s_and_b32 s4, s2, 1
    v_readfirstlane_b32 s3, v1
    v_and_b32 v0, 63, v0
    s_bfe_u32 s5, s2, 0x30003
    s_bfe_u32 s6, s2, 0x20001
    s_lshr_b32 s7, s2, 6
    s_lshl2_add_u32 s6, s6, s7
    s_cmp_ge_u32 s3, 4
    s_cbranch_scc1 L_crole
    s_bfe_u32 s34, s2, 0x20003
    s_lshl2_add_u32 s34, s34, s3
    s_lshl_b32 s34, s34, 7
    v_lshl_add_u32 v1, v0, 11, s34
    v_min_u32 v1, L_end-L_entry-8, v1
    s_mov_b64 exec, 0xffff
    global_load_dword v249, v1, s[32:33]
    s_mov_b64 exec, -1
    s_and_b32 s84, s2, 3
    s_lshl2_add_u32 s84, s84, s3
    s_lshr_b32 s85, s2, 2
    s_mul_i32 s86, s3, 8448
    s_add_u32 s86, s86, 125952
    s_lshl_b32 s87, s85, 9
    s_add_u32 s87, s87, s84
    s_lshl_b32 s87, s87, 7
    v_and_b32 v231, 7, v0
    v_lshl_add_u32 v231, v231, 4, s87
    v_lshrrev_b32 v230, 3, v0
    v_lshl_add_u32 v230, v230, 13, v231
    v_subrev_u32 v231, 6144, v230
    v_subrev_u32 v232, 4096, v230
    v_subrev_u32 v233, 2048, v230
    v_add_u32 v234, 4096, v230
    v_lshlrev_b32 v235, 4, v0
    s_lshl_b32 s87, s84, 9
    s_add_u32 m0, s86, 4224
    s_waitcnt lgkmcnt(0)
    s_mov_b32 s80, s14
    s_mov_b32 s81, s15
    s_mov_b32 s82, 0x2000
    s_mov_b32 s83, 0x20000
    s_mov_b32 s72, s10
    s_mov_b32 s73, s11
    s_mov_b32 s74, 0x400000
    s_mov_b32 s75, 0x20000
    s_mov_b32 exec_hi, 0
    buffer_load_dwordx4 v235, s[80:83], s87 offen lds
    s_mov_b64 exec, -1
    buffer_load_dwordx4 v[108:111], v231, s[72:75], 0 offen offset:0 nt
    buffer_load_dwordx4 v[112:115], v232, s[72:75], 0 offen offset:0 nt
    buffer_load_dwordx4 v[116:119], v233, s[72:75], 0 offen offset:0 nt
    buffer_load_dwordx4 v[120:123], v230, s[72:75], 0 offen offset:0 nt
    buffer_load_dwordx4 v[124:127], v230, s[72:75], 0 offen offset:2048 nt
    buffer_load_dwordx4 v[128:131], v234, s[72:75], 0 offen offset:0 nt
    buffer_load_dwordx4 v[132:135], v234, s[72:75], 0 offen offset:2048 nt
    s_mov_b32 s76, s12
    s_mov_b32 s77, s13
    s_mov_b32 s78, 0x400000
    s_mov_b32 s79, 0x20000
    buffer_load_dwordx4 v[136:139], v230, s[76:79], 0 offen offset:0 nt
    buffer_load_dwordx4 v[140:143], v230, s[76:79], 0 offen offset:2048 nt
    buffer_load_dwordx4 v[144:147], v234, s[76:79], 0 offen offset:0 nt
    buffer_load_dwordx4 v[148:151], v234, s[76:79], 0 offen offset:2048 nt
    s_lshr_b32 s90, s2, 3
    s_and_b32 s91, s3, 3
    s_lshl2_add_u32 s90, s90, s91
    s_and_b32 s91, s2, 6
    s_lshl3_add_u32 s88, s90, s91
    s_lshl1_add_u32 s88, s88, s4
    s_lshl_b32 s88, s88, 11
    s_and_b32 s89, s2, 7
    s_and_b32 s91, s90, 1
    s_lshl1_add_u32 s89, s89, s91
    s_lshr_b32 s90, s90, 1
    s_mul_i32 s90, s90, 48
    s_add_u32 s89, s89, s90
    s_lshl_b32 s89, s89, 7
    v_and_b32 v251, 1, v0
    v_lshlrev_b32 v251, 12, v251
    v_lshrrev_b32 v252, 1, v0
    v_lshl_add_u32 v251, v252, 7, v251
    v_lshrrev_b32 v250, 2, v0
    v_mul_u32_u24 v250, 393216, v250
    v_and_b32 v252, 3, v0
    v_lshl_add_u32 v252, v252, 11, v250
    s_mov_b32 s64, s20
    s_mov_b32 s65, s21
    s_mov_b32 s66, 0x400000
    s_mov_b32 s67, 0x20000
    s_mov_b32 s68, s22
    s_mov_b32 s69, s23
    s_mov_b32 s70, 0x600000
    s_mov_b32 s71, 0x20000
    s_mov_b32 exec_lo, 0x777
    s_mov_b32 exec_hi, 0x0
    s_bfe_u32 s7, s89, 0x30007
    s_cmp_lg_u32 s7, 1
    s_cbranch_scc1 L_wx3_1
    buffer_load_dword v250, v252, s[68:71], s89 offen offset:256
L_wx3_1:
    buffer_load_dword v250, v252, s[68:71], s89 offen
    s_mov_b32 exec_lo, 0x3f
    s_mov_b32 exec_hi, 0
    buffer_load_dword v250, v251, s[64:67], s88 offen
    s_mov_b64 exec, -1
    s_barrier
    s_branch L_grole
L_crole:
    s_sub_u32 s70, s3, 4
    s_lshl_b32 s43, s70, 12
    s_lshl_b32 s44, s70, 11
    s_add_u32 s44, s44, 17408
    s_lshl_b32 s49, s70, 4
    s_lshl_b64 s[46:47], 0xffff, s49
    v_lshrrev_b32 v13, 3, v0
    v_and_b32 v14, 7, v0
    v_lshrrev_b32 v15, 4, v0
    s_lshl2_add_u32 s50, s5, s70
    s_lshl_b32 s50, s50, 6
    s_add_u32 s50, s50, s4
    s_lshl_b32 s50, s50, 11
    v_lshl_add_u32 v16, v13, 12, s50
    v_xor_b32 v17, v14, v15
    v_lshl_add_u32 v2, v17, 4, v16
    v_xor_b32 v3, 64, v2
    v_add_u32 v3, 31744, v3
    v_add_u32 v4, 63488, v2
    v_add_u32 v5, 63488, v3
    s_lshl_b32 s49, s5, 7
    s_sub_u32 s49, s49, 8
    s_max_i32 s49, s49, 0
    s_lshl1_add_u32 s49, s49, s4
    s_lshl_b32 s49, s49, 11
    v_lshl_add_u32 v16, v13, 12, s49
    v_lshlrev_b32 v17, 1, v15
    v_xor_b32 v18, v14, v17
    v_lshl_add_u32 v6, v18, 4, v16
    s_mul_i32 s49, s70, 768
    s_add_u32 s49, s49, s6
    s_lshl_b32 s49, s49, 7
    v_mul_u32_u24 v16, 6144, v13
    v_and_b32 v17, 2, v17
    v_xor_b32 v17, v14, v17
    v_lshlrev_b32 v17, 4, v17
    v_add3_u32 v7, v17, v16, s49
    v_xor_b32 v8, 64, v7
    v_add_u32 v8, 48128, v8
    v_add_u32 v9, 2048, v7
    v_add_u32 v10, 2048, v8
    v_add_u32 v11, 4096, v7
    v_add_u32 v12, 4096, v8
    s_mov_b32 s40, 0
    s_mov_b32 s41, 0
    s_lshr_b32 s90, s2, 3
    s_and_b32 s91, s3, 3
    s_lshl2_add_u32 s90, s90, s91
    s_and_b32 s91, s2, 6
    s_lshl3_add_u32 s88, s90, s91
    s_lshl1_add_u32 s88, s88, s4
    s_lshl_b32 s88, s88, 11
    s_and_b32 s89, s2, 7
    s_and_b32 s91, s90, 1
    s_lshl1_add_u32 s89, s89, s91
    s_lshr_b32 s90, s90, 1
    s_mul_i32 s90, s90, 48
    s_add_u32 s89, s89, s90
    s_lshl_b32 s89, s89, 7
    v_and_b32 v251, 1, v0
    v_lshlrev_b32 v251, 12, v251
    v_lshrrev_b32 v252, 1, v0
    v_lshl_add_u32 v251, v252, 7, v251
    v_lshrrev_b32 v250, 2, v0
    v_mul_u32_u24 v250, 393216, v250
    v_and_b32 v252, 3, v0
    v_lshl_add_u32 v252, v252, 11, v250
    s_waitcnt lgkmcnt(0)
    s_mov_b32 s32, s20
    s_mov_b32 s33, s21
    s_mov_b32 s34, 0x400000
    s_mov_b32 s35, 0x20000
    s_mov_b32 s36, s22
    s_mov_b32 s37, s23
    s_mov_b32 s38, 0x600000
    s_mov_b32 s39, 0x20000
    s_setprio 0
    s_and_b32 s73, s2, 7
    s_xor_b32 s73, s73, 2
    s_lshr_b32 s74, s2, 7
    s_lshl1_add_u32 s68, s73, s74
    s_bfe_u32 s69, s2, 0x40003
    s_lshl4_add_u32 s71, s68, s69
    s_lshl2_add_u32 s71, s71, s70
    s_mul_i32 s80, s70, 8448
    s_add_u32 s80, s80, 125952
    s_mul_i32 s81, s70, 9216
    s_add_u32 s81, s81, 41984
    s_add_u32 s52, s30, 0xe00000
    s_addc_u32 s53, s31, 0
    s_mov_b32 s54, 0x20000
    s_mov_b32 s55, 0x20000
    s_add_u32 s64, s30, 0x900000
    s_addc_u32 s65, s31, 0
    s_mov_b32 s66, 0x420000
    s_mov_b32 s67, 0x20000
    s_lshl_b32 s84, s71, 12
    s_mul_i32 s85, s71, 4224
    s_add_u32 s85, s85, 4194304
    s_lshr_b32 s72, s71, 1
    s_lshl_b32 s72, s72, 2
    s_load_dword s72, s[18:19], s72
    v_lshlrev_b32 v224, 4, v0
    v_mov_b32 v228, 0
    v_mov_b32 v229, 0
    v_mov_b32 v230, 0
    v_mov_b32 v231, 0
    v_mov_b32 v227, 134352
    v_mov_b32 v244, 1
    s_bfe_u32 s87, s2, 0x10003
    s_mov_b64 exec, 1
    ds_write_b128 v227, v[228:231]
    ds_write_b128 v227, v[228:231] offset:16
    ds_write_b128 v227, v[228:231] offset:32
    s_mov_b64 exec, -1
    s_lshr_b32 s74, s69, 2
    s_and_b32 s75, s69, 3
    s_lshl3_add_u32 s74, s74, s75
    s_lshl3_add_u32 s74, s74, s70
    s_lshl_b32 s74, s74, 3
    v_bfe_u32 v234, v0, 3, 1
    v_lshl_add_u32 v225, v234, 8, s74
    v_bfe_u32 v234, v0, 4, 1
    v_lshl_add_u32 v225, v234, 1, v225
    v_lshrrev_b32 v234, 5, v0
    v_lshl_add_u32 v225, v234, 5, v225
    s_lshl_b32 s74, s68, 7
    v_and_b32 v234, 7, v0
    v_lshl_add_u32 v234, v234, 4, s74
    v_lshl_add_u32 v226, v225, 12, v234
    v_lshl_add_u32 v225, v225, 11, v234
    v_and_b32 v234, 1, v0
    v_xor_b32 v234, 1, v234
    v_mul_u32_u24 v232, 4224, v234
    v_mul_u32_u24 v233, 4576, v234
    v_bfe_u32 v234, v0, 1, 3
    v_lshl_add_u32 v232, v234, 3, v232
    v_xor_b32 v234, 7, v234
    v_lshl_add_u32 v233, v234, 6, v233
    v_lshrrev_b32 v234, 4, v0
    v_lshl_add_u32 v232, v234, 4, v232
    v_lshl_add_u32 v233, v234, 4, v233
    v_add3_u32 v232, v232, s80, 8
    v_add_u32 v233, s81, v233
    s_waitcnt lgkmcnt(0)
    s_bitcmp1_b32 s71, 0
    s_cselect_b32 s74, 0, 16
    s_lshl_b32 s72, s72, s74
    s_and_b32 s72, s72, 0xffff0000
    v_and_b32 v235, 1, v0
    v_lshlrev_b32 v235, 4, v235
    v_lshrrev_b32 v235, v235, s72
    v_bfe_u32 v236, v0, 1, 3
    v_lshl_add_u32 v236, v234, 1, v236
    v_cmp_eq_u32 vcc, 7, v236
    v_mov_b32 v241, 0
    v_mov_b32 v243, 0
    v_cndmask_b32 v240, 0, v235, vcc
    v_cmp_eq_u32 vcc, 6, v236
    s_nop 1
    v_cndmask_b32 v242, 0, v235, vcc
    s_barrier
    s_add_u32 m0, s43, 0
    s_nop 0
    buffer_load_dwordx4 v2, s[32:35], s40 offen offset:0 lds
    s_add_u32 m0, s44, 0
    s_nop 0
    buffer_load_dwordx4 v7, s[36:39], s41 offen offset:0 lds
    buffer_load_dwordx4 v8, s[36:39], s41 offen offset:1024 lds
    s_add_u32 m0, s43, 0
    s_nop 0
    buffer_load_dwordx4 v3, s[32:35], s40 offen offset:1024 lds
    s_add_u32 m0, s44, 8192
    s_nop 0
    buffer_load_dwordx4 v9, s[36:39], s41 offen offset:0 lds
    buffer_load_dwordx4 v10, s[36:39], s41 offen offset:1024 lds
    s_add_u32 m0, s43, 0
    s_nop 0
    buffer_load_dwordx4 v4, s[32:35], s40 offen offset:2048 lds
    s_add_u32 m0, s44, 16384
    s_nop 0
    buffer_load_dwordx4 v11, s[36:39], s41 offen offset:0 lds
    buffer_load_dwordx4 v12, s[36:39], s41 offen offset:1024 lds
    s_add_u32 m0, s43, 0
    s_nop 0
    buffer_load_dwordx4 v5, s[32:35], s40 offen offset:3072 lds
    s_mov_b32 m0, 16384
    s_mov_b64 exec, s[46:47]
    buffer_load_dwordx4 v6, s[32:35], s40 offen lds
    s_mov_b64 exec, -1
    s_movk_i32 s40, 128
    s_mov_b32 s41, 393216
    s_add_u32 m0, s43, 41984
    s_nop 0
    buffer_load_dwordx4 v2, s[32:35], s40 offen offset:0 lds
    s_add_u32 m0, s44, 41984
    s_nop 0
    buffer_load_dwordx4 v7, s[36:39], s41 offen offset:0 lds
    buffer_load_dwordx4 v8, s[36:39], s41 offen offset:1024 lds
    s_add_u32 m0, s43, 41984
    s_nop 0
    buffer_load_dwordx4 v3, s[32:35], s40 offen offset:1024 lds
    s_add_u32 m0, s44, 50176
    s_nop 0
    buffer_load_dwordx4 v9, s[36:39], s41 offen offset:0 lds
    buffer_load_dwordx4 v10, s[36:39], s41 offen offset:1024 lds
    s_add_u32 m0, s43, 41984
    s_nop 0
    buffer_load_dwordx4 v4, s[32:35], s40 offen offset:2048 lds
    s_add_u32 m0, s44, 58368
    s_nop 0
    buffer_load_dwordx4 v11, s[36:39], s41 offen offset:0 lds
    buffer_load_dwordx4 v12, s[36:39], s41 offen offset:1024 lds
    s_add_u32 m0, s43, 41984
    s_nop 0
    buffer_load_dwordx4 v5, s[32:35], s40 offen offset:3072 lds
    s_mov_b32 m0, 58368
    s_mov_b64 exec, s[46:47]
    buffer_load_dwordx4 v6, s[32:35], s40 offen lds
    s_mov_b64 exec, -1
    s_movk_i32 s40, 256
    s_mov_b32 s41, 786432
    s_waitcnt vmcnt(11)
    s_barrier
    s_add_u32 m0, s43, 83968
    s_nop 0
    buffer_load_dwordx4 v2, s[32:35], s40 offen offset:0 lds
    s_add_u32 m0, s44, 83968
    s_nop 0
    buffer_load_dwordx4 v7, s[36:39], s41 offen offset:0 lds
    buffer_load_dwordx4 v8, s[36:39], s41 offen offset:1024 lds
    s_add_u32 m0, s43, 83968
    s_nop 0
    buffer_load_dwordx4 v3, s[32:35], s40 offen offset:1024 lds
    s_add_u32 m0, s44, 92160
    s_nop 0
    buffer_load_dwordx4 v9, s[36:39], s41 offen offset:0 lds
    buffer_load_dwordx4 v10, s[36:39], s41 offen offset:1024 lds
    s_add_u32 m0, s43, 83968
    s_nop 0
    buffer_load_dwordx4 v4, s[32:35], s40 offen offset:2048 lds
    s_add_u32 m0, s44, 100352
    s_nop 0
    buffer_load_dwordx4 v11, s[36:39], s41 offen offset:0 lds
    buffer_load_dwordx4 v12, s[36:39], s41 offen offset:1024 lds
    s_add_u32 m0, s43, 83968
    s_nop 0
    buffer_load_dwordx4 v5, s[32:35], s40 offen offset:3072 lds
    s_mov_b32 m0, 100352
    s_mov_b64 exec, s[46:47]
    buffer_load_dwordx4 v6, s[32:35], s40 offen lds
    s_mov_b64 exec, -1
    s_movk_i32 s40, 384
    s_mov_b32 s41, 1179648
    s_mov_b32 exec_lo, 0x7777000
    s_mov_b32 exec_hi, 0x0
    s_bfe_u32 s7, s89, 0x30007
    s_cmp_lg_u32 s7, 1
    s_cbranch_scc1 L_wx3_3
    buffer_load_dword v250, v252, s[36:39], s89 offen offset:256
L_wx3_3:
    buffer_load_dword v250, v252, s[36:39], s89 offen
    s_mov_b32 exec_lo, 0x3fc0
    s_mov_b32 exec_hi, 0
    buffer_load_dword v250, v251, s[32:35], s88 offen
    s_mov_b64 exec, -1
    s_waitcnt vmcnt(13)
    s_barrier
    s_add_u32 m0, s43, 0
    s_nop 0
    buffer_load_dwordx4 v2, s[32:35], s40 offen offset:0 lds
    s_add_u32 m0, s44, 0
    s_nop 0
    buffer_load_dwordx4 v7, s[36:39], s41 offen offset:0 lds
    buffer_load_dwordx4 v8, s[36:39], s41 offen offset:1024 lds
    s_add_u32 m0, s43, 0
    s_nop 0
    buffer_load_dwordx4 v3, s[32:35], s40 offen offset:1024 lds
    s_add_u32 m0, s44, 8192
    s_nop 0
    buffer_load_dwordx4 v9, s[36:39], s41 offen offset:0 lds
    buffer_load_dwordx4 v10, s[36:39], s41 offen offset:1024 lds
    s_add_u32 m0, s43, 0
    s_nop 0
    buffer_load_dwordx4 v4, s[32:35], s40 offen offset:2048 lds
    s_add_u32 m0, s44, 16384
    s_nop 0
    buffer_load_dwordx4 v11, s[36:39], s41 offen offset:0 lds
    buffer_load_dwordx4 v12, s[36:39], s41 offen offset:1024 lds
    s_add_u32 m0, s43, 0
    s_nop 0
    buffer_load_dwordx4 v5, s[32:35], s40 offen offset:3072 lds
    s_mov_b32 m0, 16384
    s_mov_b64 exec, s[46:47]
    buffer_load_dwordx4 v6, s[32:35], s40 offen lds
    s_mov_b64 exec, -1
    s_movk_i32 s40, 512
    s_mov_b32 s41, 1572864
    s_waitcnt vmcnt(13)
    s_barrier
    s_add_u32 m0, s43, 41984
    s_nop 0
    buffer_load_dwordx4 v2, s[32:35], s40 offen offset:0 lds
    s_add_u32 m0, s44, 41984
    s_nop 0
    buffer_load_dwordx4 v7, s[36:39], s41 offen offset:0 lds
    buffer_load_dwordx4 v8, s[36:39], s41 offen offset:1024 lds
    s_add_u32 m0, s43, 41984
    s_nop 0
    buffer_load_dwordx4 v3, s[32:35], s40 offen offset:1024 lds
    s_add_u32 m0, s44, 50176
    s_nop 0
    buffer_load_dwordx4 v9, s[36:39], s41 offen offset:0 lds
    buffer_load_dwordx4 v10, s[36:39], s41 offen offset:1024 lds
    s_add_u32 m0, s43, 41984
    s_nop 0
    buffer_load_dwordx4 v4, s[32:35], s40 offen offset:2048 lds
    s_add_u32 m0, s44, 58368
    s_nop 0
    buffer_load_dwordx4 v11, s[36:39], s41 offen offset:0 lds
    buffer_load_dwordx4 v12, s[36:39], s41 offen offset:1024 lds
    s_add_u32 m0, s43, 41984
    s_nop 0
    buffer_load_dwordx4 v5, s[32:35], s40 offen offset:3072 lds
    s_mov_b32 m0, 58368
    s_mov_b64 exec, s[46:47]
    buffer_load_dwordx4 v6, s[32:35], s40 offen lds
    s_mov_b64 exec, -1
    s_movk_i32 s40, 640
    s_mov_b32 s41, 1966080
    s_cmp_lg_u32 s87, 0
    s_cbranch_scc1 L_stg_6
    s_mov_b32 exec_lo, 0x70000000
    s_mov_b32 exec_hi, 0x777
    s_bfe_u32 s7, s89, 0x30007
    s_cmp_lg_u32 s7, 1
    s_cbranch_scc1 L_wx3_7
    buffer_load_dword v250, v252, s[36:39], s89 offen offset:256
L_wx3_7:
    buffer_load_dword v250, v252, s[36:39], s89 offen
    s_mov_b32 exec_lo, 0x3fc000
    s_mov_b32 exec_hi, 0
    buffer_load_dword v250, v251, s[32:35], s88 offen
    s_mov_b64 exec, -1
L_stg_6:
    s_waitcnt vmcnt(13)
    s_bitcmp1_b32 1, s87
    s_cbranch_scc1 L_mw_8
    s_waitcnt vmcnt(11)
L_mw_8:
    s_barrier
    s_add_u32 m0, s43, 83968
    s_nop 0
    buffer_load_dwordx4 v2, s[32:35], s40 offen offset:0 lds
    s_add_u32 m0, s44, 83968
    s_nop 0
    buffer_load_dwordx4 v7, s[36:39], s41 offen offset:0 lds
    buffer_load_dwordx4 v8, s[36:39], s41 offen offset:1024 lds
    s_add_u32 m0, s43, 83968
    s_nop 0
    buffer_load_dwordx4 v3, s[32:35], s40 offen offset:1024 lds
    s_add_u32 m0, s44, 92160
    s_nop 0
    buffer_load_dwordx4 v9, s[36:39], s41 offen offset:0 lds
    buffer_load_dwordx4 v10, s[36:39], s41 offen offset:1024 lds
    s_add_u32 m0, s43, 83968
    s_nop 0
    buffer_load_dwordx4 v4, s[32:35], s40 offen offset:2048 lds
    s_add_u32 m0, s44, 100352
    s_nop 0
    buffer_load_dwordx4 v11, s[36:39], s41 offen offset:0 lds
    buffer_load_dwordx4 v12, s[36:39], s41 offen offset:1024 lds
    s_add_u32 m0, s43, 83968
    s_nop 0
    buffer_load_dwordx4 v5, s[32:35], s40 offen offset:3072 lds
    s_mov_b32 m0, 100352
    s_mov_b64 exec, s[46:47]
    buffer_load_dwordx4 v6, s[32:35], s40 offen lds
    s_mov_b64 exec, -1
    s_movk_i32 s40, 768
    s_mov_b32 s41, 2359296
    s_cmp_lg_u32 s87, 1
    s_cbranch_scc1 L_stg_9
    s_mov_b32 exec_lo, 0x70000000
    s_mov_b32 exec_hi, 0x777
    s_bfe_u32 s7, s89, 0x30007
    s_cmp_lg_u32 s7, 1
    s_cbranch_scc1 L_wx3_10
    buffer_load_dword v250, v252, s[36:39], s89 offen offset:256
L_wx3_10:
    buffer_load_dword v250, v252, s[36:39], s89 offen
    s_mov_b32 exec_lo, 0x3fc000
    s_mov_b32 exec_hi, 0
    buffer_load_dword v250, v251, s[32:35], s88 offen
    s_mov_b64 exec, -1
L_stg_9:
    s_waitcnt vmcnt(13)
    s_barrier
    s_add_u32 m0, s43, 0
    s_nop 0
    buffer_load_dwordx4 v2, s[32:35], s40 offen offset:0 lds
    s_add_u32 m0, s44, 0
    s_nop 0
    buffer_load_dwordx4 v7, s[36:39], s41 offen offset:0 lds
    buffer_load_dwordx4 v8, s[36:39], s41 offen offset:1024 lds
    s_add_u32 m0, s43, 0
    s_nop 0
    buffer_load_dwordx4 v3, s[32:35], s40 offen offset:1024 lds
    s_add_u32 m0, s44, 8192
    s_nop 0
    buffer_load_dwordx4 v9, s[36:39], s41 offen offset:0 lds
    buffer_load_dwordx4 v10, s[36:39], s41 offen offset:1024 lds
    s_add_u32 m0, s43, 0
    s_nop 0
    buffer_load_dwordx4 v4, s[32:35], s40 offen offset:2048 lds
    s_add_u32 m0, s44, 16384
    s_nop 0
    buffer_load_dwordx4 v11, s[36:39], s41 offen offset:0 lds
    buffer_load_dwordx4 v12, s[36:39], s41 offen offset:1024 lds
    s_add_u32 m0, s43, 0
    s_nop 0
    buffer_load_dwordx4 v5, s[32:35], s40 offen offset:3072 lds
    s_mov_b32 m0, 16384
    s_mov_b64 exec, s[46:47]
    buffer_load_dwordx4 v6, s[32:35], s40 offen lds
    s_mov_b64 exec, -1
    s_movk_i32 s40, 896
    s_mov_b32 s41, 2752512
    s_bfe_u32 s74, s2, 0x20003
    s_lshl2_add_u32 s74, s74, s70
    s_cmp_lg_u32 s74, 0
    s_cbranch_scc1 L_sig_12
    s_mov_b32 s60, s28
    s_mov_b32 s61, s29
    s_mov_b32 s62, 0x100
    s_mov_b32 s63, 0x20000
    s_and_b32 s74, s2, 3
    s_lshl_b32 s74, s74, 6
    s_mov_b64 exec, 1
    buffer_atomic_add v244, off, s[60:63], s74 sc1
    s_mov_b64 exec, -1
L_sig_12:
    s_load_dwordx2 s[90:91], s[16:17], s84 offset:60
    s_load_dwordx2 s[90:91], s[16:17], s84 offset:188
    s_load_dwordx2 s[90:91], s[16:17], s84 offset:316
    s_load_dwordx2 s[90:91], s[16:17], s84 offset:444
    s_waitcnt vmcnt(13)
    s_bitcmp1_b32 2, s87
    s_cbranch_scc1 L_mw_13
    s_waitcnt vmcnt(11)
L_mw_13:
    s_barrier
    s_add_u32 m0, s43, 41984
    s_nop 0
    buffer_load_dwordx4 v2, s[32:35], s40 offen offset:0 lds
    s_add_u32 m0, s44, 41984
    s_nop 0
    buffer_load_dwordx4 v7, s[36:39], s41 offen offset:0 lds
    buffer_load_dwordx4 v8, s[36:39], s41 offen offset:1024 lds
    s_add_u32 m0, s43, 41984
    s_nop 0
    buffer_load_dwordx4 v3, s[32:35], s40 offen offset:1024 lds
    s_add_u32 m0, s44, 50176
    s_nop 0
    buffer_load_dwordx4 v9, s[36:39], s41 offen offset:0 lds
    buffer_load_dwordx4 v10, s[36:39], s41 offen offset:1024 lds
    s_add_u32 m0, s43, 41984
    s_nop 0
    buffer_load_dwordx4 v4, s[32:35], s40 offen offset:2048 lds
    s_add_u32 m0, s44, 58368
    s_nop 0
    buffer_load_dwordx4 v11, s[36:39], s41 offen offset:0 lds
    buffer_load_dwordx4 v12, s[36:39], s41 offen offset:1024 lds
    s_add_u32 m0, s43, 41984
    s_nop 0
    buffer_load_dwordx4 v5, s[32:35], s40 offen offset:3072 lds
    s_mov_b32 m0, 58368
    s_mov_b64 exec, s[46:47]
    buffer_load_dwordx4 v6, s[32:35], s40 offen lds
    s_mov_b64 exec, -1
    s_movk_i32 s40, 1024
    s_mov_b32 s41, 3145728
    s_bfe_u32 s74, s2, 0x20003
    s_lshl2_add_u32 s74, s74, s70
    s_cmp_lg_u32 s74, 4
    s_cbranch_scc1 L_sig_14
    s_mov_b32 s60, s28
    s_mov_b32 s61, s29
    s_mov_b32 s62, 0x100
    s_mov_b32 s63, 0x20000
    s_and_b32 s74, s2, 3
    s_lshl_b32 s74, s74, 6
    s_mov_b64 exec, 1
    buffer_atomic_add v244, off, s[60:63], s74 sc1
    s_mov_b64 exec, -1
L_sig_14:
    s_load_dwordx2 s[90:91], s[16:17], s84 offset:572
    s_load_dwordx2 s[90:91], s[16:17], s84 offset:700
    s_load_dwordx2 s[90:91], s[16:17], s84 offset:828
    s_load_dwordx2 s[90:91], s[16:17], s84 offset:956
    s_waitcnt vmcnt(11)
    s_barrier
    s_add_u32 m0, s43, 83968
    s_nop 0
    buffer_load_dwordx4 v2, s[32:35], s40 offen offset:0 lds
    s_add_u32 m0, s44, 83968
    s_nop 0
    buffer_load_dwordx4 v7, s[36:39], s41 offen offset:0 lds
    buffer_load_dwordx4 v8, s[36:39], s41 offen offset:1024 lds
    s_add_u32 m0, s43, 83968
    s_nop 0
    buffer_load_dwordx4 v3, s[32:35], s40 offen offset:1024 lds
    s_add_u32 m0, s44, 92160
    s_nop 0
    buffer_load_dwordx4 v9, s[36:39], s41 offen offset:0 lds
    buffer_load_dwordx4 v10, s[36:39], s41 offen offset:1024 lds
    s_add_u32 m0, s43, 83968
    s_nop 0
    buffer_load_dwordx4 v4, s[32:35], s40 offen offset:2048 lds
    s_add_u32 m0, s44, 100352
    s_nop 0
    buffer_load_dwordx4 v11, s[36:39], s41 offen offset:0 lds
    buffer_load_dwordx4 v12, s[36:39], s41 offen offset:1024 lds
    s_add_u32 m0, s43, 83968
    s_nop 0
    buffer_load_dwordx4 v5, s[32:35], s40 offen offset:3072 lds
    s_mov_b32 m0, 100352
    s_mov_b64 exec, s[46:47]
    buffer_load_dwordx4 v6, s[32:35], s40 offen lds
    s_mov_b64 exec, -1
    s_movk_i32 s40, 1152
    s_mov_b32 s41, 3538944
    s_cmp_lg_u32 s87, 0
    s_cbranch_scc1 L_stg_16
    s_mov_b32 exec_lo, 0x0
    s_mov_b32 exec_hi, 0x77777000
    s_bfe_u32 s7, s89, 0x30007
    s_cmp_lg_u32 s7, 1
    s_cbranch_scc1 L_wx3_17
    buffer_load_dword v250, v252, s[36:39], s89 offen offset:256
L_wx3_17:
    buffer_load_dword v250, v252, s[36:39], s89 offen
    s_mov_b32 exec_lo, 0xffc00000
    s_mov_b32 exec_hi, 0
    buffer_load_dword v250, v251, s[32:35], s88 offen
    s_mov_b64 exec, -1
L_stg_16:
    s_bfe_u32 s74, s2, 0x20003
    s_lshl2_add_u32 s74, s74, s70
    s_cmp_lg_u32 s74, 8
    s_cbranch_scc1 L_sig_18
    s_mov_b32 s60, s28
    s_mov_b32 s61, s29
    s_mov_b32 s62, 0x100
    s_mov_b32 s63, 0x20000
    s_and_b32 s74, s2, 3
    s_lshl_b32 s74, s74, 6
    s_mov_b64 exec, 1
    buffer_atomic_add v244, off, s[60:63], s74 sc1
    s_mov_b64 exec, -1
L_sig_18:
    s_load_dwordx2 s[90:91], s[16:17], s84 offset:1084
    s_load_dwordx2 s[90:91], s[16:17], s84 offset:1212
    s_load_dwordx2 s[90:91], s[16:17], s84 offset:1340
    s_load_dwordx2 s[90:91], s[16:17], s84 offset:1468
    s_waitcnt vmcnt(13)
    s_bitcmp1_b32 1, s87
    s_cbranch_scc1 L_mw_19
    s_waitcnt vmcnt(11)
L_mw_19:
    s_barrier
    s_add_u32 m0, s43, 0
    s_nop 0
    buffer_load_dwordx4 v2, s[32:35], s40 offen offset:0 lds
    s_add_u32 m0, s44, 0
    s_nop 0
    buffer_load_dwordx4 v7, s[36:39], s41 offen offset:0 lds
    buffer_load_dwordx4 v8, s[36:39], s41 offen offset:1024 lds
    s_add_u32 m0, s43, 0
    s_nop 0
    buffer_load_dwordx4 v3, s[32:35], s40 offen offset:1024 lds
    s_add_u32 m0, s44, 8192
    s_nop 0
    buffer_load_dwordx4 v9, s[36:39], s41 offen offset:0 lds
    buffer_load_dwordx4 v10, s[36:39], s41 offen offset:1024 lds
    s_add_u32 m0, s43, 0
    s_nop 0
    buffer_load_dwordx4 v4, s[32:35], s40 offen offset:2048 lds
    s_add_u32 m0, s44, 16384
    s_nop 0
    buffer_load_dwordx4 v11, s[36:39], s41 offen offset:0 lds
    buffer_load_dwordx4 v12, s[36:39], s41 offen offset:1024 lds
    s_add_u32 m0, s43, 0
    s_nop 0
    buffer_load_dwordx4 v5, s[32:35], s40 offen offset:3072 lds
    s_mov_b32 m0, 16384
    s_mov_b64 exec, s[46:47]
    buffer_load_dwordx4 v6, s[32:35], s40 offen lds
    s_mov_b64 exec, -1
    s_movk_i32 s40, 1280
    s_mov_b32 s41, 3932160
    s_cmp_lg_u32 s87, 1
    s_cbranch_scc1 L_stg_20
    s_mov_b32 exec_lo, 0x0
    s_mov_b32 exec_hi, 0x77777000
    s_bfe_u32 s7, s89, 0x30007
    s_cmp_lg_u32 s7, 1
    s_cbranch_scc1 L_wx3_21
    buffer_load_dword v250, v252, s[36:39], s89 offen offset:256
L_wx3_21:
    buffer_load_dword v250, v252, s[36:39], s89 offen
    s_mov_b32 exec_lo, 0xffc00000
    s_mov_b32 exec_hi, 0
    buffer_load_dword v250, v251, s[32:35], s88 offen
    s_mov_b64 exec, -1
L_stg_20:
    s_bfe_u32 s74, s2, 0x20003
    s_lshl2_add_u32 s74, s74, s70
    s_cmp_lg_u32 s74, 12
    s_cbranch_scc1 L_sig_22
    s_mov_b32 s60, s28
    s_mov_b32 s61, s29
    s_mov_b32 s62, 0x100
    s_mov_b32 s63, 0x20000
    s_and_b32 s74, s2, 3
    s_lshl_b32 s74, s74, 6
    s_mov_b64 exec, 1
    buffer_atomic_add v244, off, s[60:63], s74 sc1
    s_mov_b64 exec, -1
L_sig_22:
    s_load_dwordx2 s[90:91], s[16:17], s84 offset:1596
    s_load_dwordx2 s[90:91], s[16:17], s84 offset:1724
    s_load_dwordx2 s[90:91], s[16:17], s84 offset:1852
    s_load_dwordx2 s[90:91], s[16:17], s84 offset:1980
    s_waitcnt vmcnt(13)
    s_barrier
    s_add_u32 m0, s43, 41984
    s_nop 0
    buffer_load_dwordx4 v2, s[32:35], s40 offen offset:0 lds
    s_add_u32 m0, s44, 41984
    s_nop 0
    buffer_load_dwordx4 v7, s[36:39], s41 offen offset:0 lds
    buffer_load_dwordx4 v8, s[36:39], s41 offen offset:1024 lds
    s_add_u32 m0, s43, 41984
    s_nop 0
    buffer_load_dwordx4 v3, s[32:35], s40 offen offset:1024 lds
    s_add_u32 m0, s44, 50176
    s_nop 0
    buffer_load_dwordx4 v9, s[36:39], s41 offen offset:0 lds
    buffer_load_dwordx4 v10, s[36:39], s41 offen offset:1024 lds
    s_add_u32 m0, s43, 41984
    s_nop 0
    buffer_load_dwordx4 v4, s[32:35], s40 offen offset:2048 lds
    s_add_u32 m0, s44, 58368
    s_nop 0
    buffer_load_dwordx4 v11, s[36:39], s41 offen offset:0 lds
    buffer_load_dwordx4 v12, s[36:39], s41 offen offset:1024 lds
    s_add_u32 m0, s43, 41984
    s_nop 0
    buffer_load_dwordx4 v5, s[32:35], s40 offen offset:3072 lds
    s_mov_b32 m0, 58368
    s_mov_b64 exec, s[46:47]
    buffer_load_dwordx4 v6, s[32:35], s40 offen lds
    s_mov_b64 exec, -1
    s_movk_i32 s40, 1408
    s_mov_b32 s41, 4325376
    s_load_dwordx2 s[90:91], s[16:17], s84 offset:2108
    s_load_dwordx2 s[90:91], s[16:17], s84 offset:2236
    s_load_dwordx2 s[90:91], s[16:17], s84 offset:2364
    s_load_dwordx2 s[90:91], s[16:17], s84 offset:2492
    s_waitcnt vmcnt(13)
    s_bitcmp1_b32 2, s87
    s_cbranch_scc1 L_mw_24
    s_waitcnt vmcnt(11)
L_mw_24:
    s_barrier
    s_add_u32 m0, s43, 83968
    s_nop 0
    buffer_load_dwordx4 v2, s[32:35], s40 offen offset:0 lds
    s_add_u32 m0, s44, 83968
    s_nop 0
    buffer_load_dwordx4 v7, s[36:39], s41 offen offset:0 lds
    buffer_load_dwordx4 v8, s[36:39], s41 offen offset:1024 lds
    s_add_u32 m0, s43, 83968
    s_nop 0
    buffer_load_dwordx4 v3, s[32:35], s40 offen offset:1024 lds
    s_add_u32 m0, s44, 92160
    s_nop 0
    buffer_load_dwordx4 v9, s[36:39], s41 offen offset:0 lds
    buffer_load_dwordx4 v10, s[36:39], s41 offen offset:1024 lds
    s_add_u32 m0, s43, 83968
    s_nop 0
    buffer_load_dwordx4 v4, s[32:35], s40 offen offset:2048 lds
    s_add_u32 m0, s44, 100352
    s_nop 0
    buffer_load_dwordx4 v11, s[36:39], s41 offen offset:0 lds
    buffer_load_dwordx4 v12, s[36:39], s41 offen offset:1024 lds
    s_add_u32 m0, s43, 83968
    s_nop 0
    buffer_load_dwordx4 v5, s[32:35], s40 offen offset:3072 lds
    s_mov_b32 m0, 100352
    s_mov_b64 exec, s[46:47]
    buffer_load_dwordx4 v6, s[32:35], s40 offen lds
    s_mov_b64 exec, -1
    s_movk_i32 s40, 1536
    s_mov_b32 s41, 4718592
    s_load_dwordx2 s[90:91], s[16:17], s84 offset:2620
    s_load_dwordx2 s[90:91], s[16:17], s84 offset:2748
    s_load_dwordx2 s[90:91], s[16:17], s84 offset:2876
    s_load_dwordx2 s[90:91], s[16:17], s84 offset:3004
    s_waitcnt vmcnt(11)
    s_barrier
    s_add_u32 m0, s43, 0
    s_nop 0
    buffer_load_dwordx4 v2, s[32:35], s40 offen offset:0 lds
    s_add_u32 m0, s44, 0
    s_nop 0
    buffer_load_dwordx4 v7, s[36:39], s41 offen offset:0 lds
    buffer_load_dwordx4 v8, s[36:39], s41 offen offset:1024 lds
    s_add_u32 m0, s43, 0
    s_nop 0
    buffer_load_dwordx4 v3, s[32:35], s40 offen offset:1024 lds
    s_add_u32 m0, s44, 8192
    s_nop 0
    buffer_load_dwordx4 v9, s[36:39], s41 offen offset:0 lds
    buffer_load_dwordx4 v10, s[36:39], s41 offen offset:1024 lds
    s_add_u32 m0, s43, 0
    s_nop 0
    buffer_load_dwordx4 v4, s[32:35], s40 offen offset:2048 lds
    s_add_u32 m0, s44, 16384
    s_nop 0
    buffer_load_dwordx4 v11, s[36:39], s41 offen offset:0 lds
    buffer_load_dwordx4 v12, s[36:39], s41 offen offset:1024 lds
    s_add_u32 m0, s43, 0
    s_nop 0
    buffer_load_dwordx4 v5, s[32:35], s40 offen offset:3072 lds
    s_mov_b32 m0, 16384
    s_mov_b64 exec, s[46:47]
    buffer_load_dwordx4 v6, s[32:35], s40 offen lds
    s_mov_b64 exec, -1
    s_movk_i32 s40, 1664
    s_mov_b32 s41, 5111808
    s_load_dwordx2 s[90:91], s[16:17], s84 offset:3132
    s_load_dwordx2 s[90:91], s[16:17], s84 offset:3260
    s_load_dwordx2 s[90:91], s[16:17], s84 offset:3388
    s_load_dwordx2 s[90:91], s[16:17], s84 offset:3516
    s_waitcnt vmcnt(11)
    s_barrier
    s_add_u32 m0, s43, 41984
    s_nop 0
    buffer_load_dwordx4 v2, s[32:35], s40 offen offset:0 lds
    s_add_u32 m0, s44, 41984
    s_nop 0
    buffer_load_dwordx4 v7, s[36:39], s41 offen offset:0 lds
    buffer_load_dwordx4 v8, s[36:39], s41 offen offset:1024 lds
    s_add_u32 m0, s43, 41984
    s_nop 0
    buffer_load_dwordx4 v3, s[32:35], s40 offen offset:1024 lds
    s_add_u32 m0, s44, 50176
    s_nop 0
    buffer_load_dwordx4 v9, s[36:39], s41 offen offset:0 lds
    buffer_load_dwordx4 v10, s[36:39], s41 offen offset:1024 lds
    s_add_u32 m0, s43, 41984
    s_nop 0
    buffer_load_dwordx4 v4, s[32:35], s40 offen offset:2048 lds
    s_add_u32 m0, s44, 58368
    s_nop 0
    buffer_load_dwordx4 v11, s[36:39], s41 offen offset:0 lds
    buffer_load_dwordx4 v12, s[36:39], s41 offen offset:1024 lds
    s_add_u32 m0, s43, 41984
    s_nop 0
    buffer_load_dwordx4 v5, s[32:35], s40 offen offset:3072 lds
    s_mov_b32 m0, 58368
    s_mov_b64 exec, s[46:47]
    buffer_load_dwordx4 v6, s[32:35], s40 offen lds
    s_mov_b64 exec, -1
    s_movk_i32 s40, 1792
    s_mov_b32 s41, 5505024
    s_load_dwordx2 s[90:91], s[16:17], s84 offset:3644
    s_load_dwordx2 s[90:91], s[16:17], s84 offset:3772
    s_load_dwordx2 s[90:91], s[16:17], s84 offset:3900
    s_load_dwordx2 s[90:91], s[16:17], s84 offset:4028
    s_waitcnt vmcnt(11)
    s_barrier
    s_add_u32 m0, s43, 83968
    s_nop 0
    buffer_load_dwordx4 v2, s[32:35], s40 offen offset:0 lds
    s_add_u32 m0, s44, 83968
    s_nop 0
    buffer_load_dwordx4 v7, s[36:39], s41 offen offset:0 lds
    buffer_load_dwordx4 v8, s[36:39], s41 offen offset:1024 lds
    s_add_u32 m0, s43, 83968
    s_nop 0
    buffer_load_dwordx4 v3, s[32:35], s40 offen offset:1024 lds
    s_add_u32 m0, s44, 92160
    s_nop 0
    buffer_load_dwordx4 v9, s[36:39], s41 offen offset:0 lds
    buffer_load_dwordx4 v10, s[36:39], s41 offen offset:1024 lds
    s_add_u32 m0, s43, 83968
    s_nop 0
    buffer_load_dwordx4 v4, s[32:35], s40 offen offset:2048 lds
    s_add_u32 m0, s44, 100352
    s_nop 0
    buffer_load_dwordx4 v11, s[36:39], s41 offen offset:0 lds
    buffer_load_dwordx4 v12, s[36:39], s41 offen offset:1024 lds
    s_add_u32 m0, s43, 83968
    s_nop 0
    buffer_load_dwordx4 v5, s[32:35], s40 offen offset:3072 lds
    s_mov_b32 m0, 100352
    s_mov_b64 exec, s[46:47]
    buffer_load_dwordx4 v6, s[32:35], s40 offen lds
    s_mov_b64 exec, -1
    s_movk_i32 s40, 1920
    s_mov_b32 s41, 5898240
    s_waitcnt vmcnt(11)
    s_barrier
    s_load_dword s76, s[28:29], 0
    s_load_dword s77, s[28:29], 64
    s_load_dword s78, s[28:29], 128
    s_load_dword s79, s[28:29], 192
    s_add_u32 m0, s43, 0
    s_nop 0
    buffer_load_dwordx4 v2, s[32:35], s40 offen offset:0 lds
    s_add_u32 m0, s44, 0
    s_nop 0
    buffer_load_dwordx4 v7, s[36:39], s41 offen offset:0 lds
    buffer_load_dwordx4 v8, s[36:39], s41 offen offset:1024 lds
    s_add_u32 m0, s43, 0
    s_nop 0
    buffer_load_dwordx4 v3, s[32:35], s40 offen offset:1024 lds
    s_add_u32 m0, s44, 8192
    s_nop 0
    buffer_load_dwordx4 v9, s[36:39], s41 offen offset:0 lds
    buffer_load_dwordx4 v10, s[36:39], s41 offen offset:1024 lds
    s_add_u32 m0, s43, 0
    s_nop 0
    buffer_load_dwordx4 v4, s[32:35], s40 offen offset:2048 lds
    s_add_u32 m0, s44, 16384
    s_nop 0
    buffer_load_dwordx4 v11, s[36:39], s41 offen offset:0 lds
    buffer_load_dwordx4 v12, s[36:39], s41 offen offset:1024 lds
    s_add_u32 m0, s43, 0
    s_nop 0
    buffer_load_dwordx4 v5, s[32:35], s40 offen offset:3072 lds
    s_mov_b32 m0, 16384
    s_mov_b64 exec, s[46:47]
    buffer_load_dwordx4 v6, s[32:35], s40 offen lds
    s_mov_b64 exec, -1
    s_movk_i32 s40, 2048
    s_mov_b32 s41, 6291456
    s_cmp_lg_u32 s70, 0
    s_cbranch_scc1 L_pc_done_29
    s_waitcnt lgkmcnt(0)
    s_min_u32 s76, s76, s77
    s_min_u32 s78, s78, s79
    s_min_u32 s76, s76, s78
    s_cmp_ge_u32 s76, 64
    s_cbranch_scc1 L_pc_done_29
    s_mov_b32 s60, s28
    s_mov_b32 s61, s29
    s_mov_b32 s62, 0x100
    s_mov_b32 s63, 0x20000
    v_lshlrev_b32 v20, 6, v0
    s_mov_b32 s74, 131072
    s_mov_b64 exec, 0xf
L_pc_loop_30:
    buffer_load_dword v21, v20, s[60:63], 0 offen sc1
    s_waitcnt vmcnt(0)
    v_cmp_gt_u32 vcc, 64, v21
    s_cbranch_vccz L_pc_done_29
    s_sleep 4
    s_sub_u32 s74, s74, 1
    s_cbranch_scc0 L_pc_loop_30
L_pc_done_29:
    s_mov_b64 exec, -1
    s_waitcnt vmcnt(11)
    s_barrier
    s_add_u32 s56, s30, s85
    s_addc_u32 s57, s31, 0
    s_movk_i32 s58, 4096
    s_mov_b32 s59, 0x20000
    s_add_u32 m0, s81, 0
    s_nop 0
    buffer_load_dwordx4 v224, s[56:59], 0 offen offset:0 sc1 lds
    buffer_load_dwordx4 v224, s[56:59], 0 offen offset:1024 sc1 lds
    buffer_load_dwordx4 v224, s[56:59], 0 offen offset:2048 sc1 lds
    buffer_load_dwordx4 v224, s[56:59], 0 offen offset:3072 sc1 lds
    s_add_u32 m0, s81, 4572
    s_nop 0
    buffer_load_dwordx4 v224, s[56:59], 0 offen offset:0 sc1 lds
    buffer_load_dwordx4 v224, s[56:59], 0 offen offset:1024 sc1 lds
    buffer_load_dwordx4 v224, s[56:59], 0 offen offset:2048 sc1 lds
    buffer_load_dwordx4 v224, s[56:59], 0 offen offset:3072 sc1 lds
    s_waitcnt vmcnt(8)
    s_mov_b64 exec, 1
    ds_add_u32 v227, v244 offset:24
    s_mov_b64 exec, -1
    s_add_u32 s56, s16, s84
    s_addc_u32 s57, s17, 0
    s_movk_i32 s58, 4096
    s_mov_b32 s59, 0x20000
    s_add_u32 m0, s80, 64
    v_mov_b32 v132, 0
    v_mov_b32 v133, 0
    v_mov_b32 v134, 0
    v_mov_b32 v135, 0
    buffer_load_dwordx4 v224, s[56:59], 0 offen offset:0 lds
    buffer_load_dwordx4 v224, s[56:59], 0 offen offset:1024 lds
    buffer_load_dwordx4 v224, s[56:59], 0 offen offset:2048 lds
    buffer_load_dwordx4 v224, s[56:59], 0 offen offset:3072 lds
    s_add_u32 m0, s80, 4304
    s_mov_b64 exec, 0x100
    buffer_load_dwordx4 v[132:135], off, s[56:59], 0
    s_mov_b64 exec, -1
    buffer_load_dwordx4 v224, s[56:59], 14 offen offset:0 lds
    buffer_load_dwordx4 v224, s[56:59], 14 offen offset:1024 lds
    buffer_load_dwordx4 v224, s[56:59], 14 offen offset:2048 lds
    buffer_load_dwordx4 v224, s[56:59], 14 offen offset:3072 lds
    v_lshrrev_b32 v234, 5, v0
    v_mul_u32_u24 v234, 4064, v234
    v_add3_u32 v234, v234, v224, s81
    s_mov_b32 exec_lo, 0xfffffff
    s_mov_b32 exec_hi, 0xfffffff
    ds_write_b128 v234, v[228:231] offset:4096
    s_mov_b64 exec, 1
    ds_write_b32 v234, v228 offset:8668
    s_mov_b64 exec, -1
    s_setprio 3
    s_mov_b32 s60, s24
    s_mov_b32 s61, s25
    s_mov_b32 s62, 0x200000
    s_mov_b32 s63, 0x20000
    s_lshr_b32 s74, s2, 3
    s_lshl2_add_u32 s74, s74, s70
    s_bfe_u32 s75, s2, 0x10002
    s_lshl4_add_u32 s74, s74, s75
    s_lshl_b32 s74, s74, 10
    v_lshrrev_b32 v234, 3, v0
    v_and_b32 v235, 7, v0
    v_lshlrev_b32 v235, 7, v235
    v_lshl_add_u32 v234, v234, 11, v235
    buffer_load_dword v250, v234, s[60:63], s74 offen
    s_mov_b32 s60, s8
    s_mov_b32 s61, s9
    s_mov_b32 s62, 0x400000
    s_mov_b32 s63, 0x20000
    s_movk_i32 s75, 8192
    buffer_load_dwordx4 v[208:211], v225, s[60:63], 0 offen offset:0 nt
    buffer_load_dwordx4 v[212:215], v225, s[60:63], 0 offen offset:2048 nt
    buffer_load_dwordx4 v[216:219], v225, s[60:63], s75 offen offset:0 nt
    buffer_load_dwordx4 v[220:223], v225, s[60:63], s75 offen offset:2048 nt
    s_waitcnt vmcnt(14)
    s_waitcnt vmcnt(5)
    v_cmp_lt_u32 vcc, 3, v0
    v_mov_b32 v140, 4160
    v_lshlrev_b32 v136, 16, v132
    v_cndmask_b32 v140, 0, v140, vcc
    v_alignbit_b32 v137, v133, v132, 16
    v_alignbit_b32 v138, v134, v133, 16
    v_alignbit_b32 v139, v135, v134, 16
    v_add3_u32 v140, v140, v224, s80
    s_mov_b64 exec, 0x1ff
    ds_write_b128 v140, v[136:139]
    s_mov_b64 exec, -1
    ds_read_b128 v[112:115], v233 offset:3584
    ds_read_b64 v[48:49], v232 offset:0
    ds_read_b64 v[50:51], v232 offset:8
    ds_read_b128 v[116:119], v233 offset:3072
    ds_read_b64 v[52:53], v232 offset:512
    ds_read_b64 v[54:55], v232 offset:520
    ds_read_b128 v[120:123], v233 offset:2560
    ds_read_b64 v[56:57], v232 offset:1024
    ds_read_b64 v[58:59], v232 offset:1032
    ds_read_b128 v[124:127], v233 offset:2048
    ds_read_b64 v[60:61], v232 offset:1536
    ds_read_b64 v[62:63], v232 offset:1544
    ds_read_b128 v[128:131], v233 offset:1536
    ds_read_b64 v[64:65], v232 offset:2048
    ds_read_b64 v[66:67], v232 offset:2056
    ds_read_b128 v[132:135], v233 offset:1024
    ds_read_b64 v[68:69], v232 offset:2560
    ds_read_b64 v[70:71], v232 offset:2568
    ds_read_b128 v[136:139], v233 offset:512
    ds_read_b64 v[72:73], v232 offset:3072
    ds_read_b64 v[74:75], v232 offset:3080
    ds_read_b128 v[140:143], v233 offset:0
    ds_read_b64 v[76:77], v232 offset:3584
    ds_read_b64 v[78:79], v232 offset:3592
    s_setprio 1
    s_mov_b32 s74, 3
    s_waitcnt lgkmcnt(0)
    v_mfma_f32_16x16x32_bf16 v[16:19], v[240:243], v[112:115], 0
    v_mfma_f32_16x16x32_bf16 v[20:23], v[240:243], v[116:119], 0
    v_mfma_f32_16x16x32_bf16 v[24:27], v[240:243], v[120:123], 0
    v_mfma_f32_16x16x32_bf16 v[28:31], v[240:243], v[124:127], 0
    v_mfma_f32_16x16x32_bf16 v[32:35], v[240:243], v[128:131], 0
    v_mfma_f32_16x16x32_bf16 v[36:39], v[240:243], v[132:135], 0
    v_mfma_f32_16x16x32_bf16 v[40:43], v[240:243], v[136:139], 0
    v_mfma_f32_16x16x32_bf16 v[44:47], v[240:243], v[140:143], 0
L_conv:
    v_mfma_f32_16x16x32_bf16 v[16:19], v[48:51], v[112:115], v[16:19]
    ds_read_b128 v[144:147], v233 offset:3648
    v_mfma_f32_16x16x32_bf16 v[20:23], v[48:51], v[116:119], v[20:23]
    ds_read_b64 v[80:81], v232 offset:64
    v_mfma_f32_16x16x32_bf16 v[20:23], v[52:55], v[112:115], v[20:23]
    ds_read_b64 v[82:83], v232 offset:72
    v_mfma_f32_16x16x32_bf16 v[24:27], v[48:51], v[120:123], v[24:27]
    ds_read_b128 v[148:151], v233 offset:3136
    v_mfma_f32_16x16x32_bf16 v[24:27], v[52:55], v[116:119], v[24:27]
    ds_read_b64 v[84:85], v232 offset:576
    v_mfma_f32_16x16x32_bf16 v[24:27], v[56:59], v[112:115], v[24:27]
    ds_read_b64 v[86:87], v232 offset:584
    v_mfma_f32_16x16x32_bf16 v[28:31], v[48:51], v[124:127], v[28:31]
    ds_read_b128 v[152:155], v233 offset:2624
    v_mfma_f32_16x16x32_bf16 v[28:31], v[52:55], v[120:123], v[28:31]
    ds_read_b64 v[88:89], v232 offset:1088
    v_mfma_f32_16x16x32_bf16 v[28:31], v[56:59], v[116:119], v[28:31]
    ds_read_b64 v[90:91], v232 offset:1096
    v_mfma_f32_16x16x32_bf16 v[28:31], v[60:63], v[112:115], v[28:31]
    ds_read_b128 v[156:159], v233 offset:2112
    v_mfma_f32_16x16x32_bf16 v[32:35], v[48:51], v[128:131], v[32:35]
    ds_read_b64 v[92:93], v232 offset:1600
    v_mfma_f32_16x16x32_bf16 v[32:35], v[52:55], v[124:127], v[32:35]
    ds_read_b64 v[94:95], v232 offset:1608
    v_mfma_f32_16x16x32_bf16 v[32:35], v[56:59], v[120:123], v[32:35]
    ds_read_b128 v[160:163], v233 offset:1600
    v_mfma_f32_16x16x32_bf16 v[32:35], v[60:63], v[116:119], v[32:35]
    ds_read_b64 v[96:97], v232 offset:2112
    v_mfma_f32_16x16x32_bf16 v[32:35], v[64:67], v[112:115], v[32:35]
    ds_read_b64 v[98:99], v232 offset:2120
    v_mfma_f32_16x16x32_bf16 v[36:39], v[48:51], v[132:135], v[36:39]
    ds_read_b128 v[164:167], v233 offset:1088
    v_mfma_f32_16x16x32_bf16 v[36:39], v[52:55], v[128:131], v[36:39]
    ds_read_b64 v[100:101], v232 offset:2624
    v_mfma_f32_16x16x32_bf16 v[36:39], v[56:59], v[124:127], v[36:39]
    ds_read_b64 v[102:103], v232 offset:2632
    v_mfma_f32_16x16x32_bf16 v[36:39], v[60:63], v[120:123], v[36:39]
    ds_read_b128 v[168:171], v233 offset:576
    v_mfma_f32_16x16x32_bf16 v[36:39], v[64:67], v[116:119], v[36:39]
    ds_read_b64 v[104:105], v232 offset:3136
    v_mfma_f32_16x16x32_bf16 v[36:39], v[68:71], v[112:115], v[36:39]
    ds_read_b64 v[106:107], v232 offset:3144
    v_mfma_f32_16x16x32_bf16 v[40:43], v[48:51], v[136:139], v[40:43]
    ds_read_b128 v[172:175], v233 offset:64
    v_mfma_f32_16x16x32_bf16 v[40:43], v[52:55], v[132:135], v[40:43]
    ds_read_b64 v[108:109], v232 offset:3648
    v_mfma_f32_16x16x32_bf16 v[40:43], v[56:59], v[128:131], v[40:43]
    ds_read_b64 v[110:111], v232 offset:3656
    v_mfma_f32_16x16x32_bf16 v[40:43], v[60:63], v[124:127], v[40:43]
    v_mfma_f32_16x16x32_bf16 v[40:43], v[64:67], v[120:123], v[40:43]
    v_mfma_f32_16x16x32_bf16 v[40:43], v[68:71], v[116:119], v[40:43]
    v_mfma_f32_16x16x32_bf16 v[40:43], v[72:75], v[112:115], v[40:43]
    v_mfma_f32_16x16x32_bf16 v[44:47], v[48:51], v[140:143], v[44:47]
    v_mfma_f32_16x16x32_bf16 v[44:47], v[52:55], v[136:139], v[44:47]
    v_mfma_f32_16x16x32_bf16 v[44:47], v[56:59], v[132:135], v[44:47]
    v_mfma_f32_16x16x32_bf16 v[44:47], v[60:63], v[128:131], v[44:47]
    v_mfma_f32_16x16x32_bf16 v[44:47], v[64:67], v[124:127], v[44:47]
    v_mfma_f32_16x16x32_bf16 v[44:47], v[68:71], v[120:123], v[44:47]
    v_mfma_f32_16x16x32_bf16 v[44:47], v[72:75], v[116:119], v[44:47]
    v_mfma_f32_16x16x32_bf16 v[44:47], v[76:79], v[112:115], v[44:47]
    s_waitcnt lgkmcnt(0)
    v_mfma_f32_16x16x32_bf16 v[16:19], v[80:83], v[144:147], v[16:19]
    ds_read_b128 v[112:115], v233 offset:3712
    v_mfma_f32_16x16x32_bf16 v[20:23], v[80:83], v[148:151], v[20:23]
    ds_read_b64 v[48:49], v232 offset:128
    v_mfma_f32_16x16x32_bf16 v[20:23], v[84:87], v[144:147], v[20:23]
    ds_read_b64 v[50:51], v232 offset:136
    v_mfma_f32_16x16x32_bf16 v[24:27], v[80:83], v[152:155], v[24:27]
    ds_read_b128 v[116:119], v233 offset:3200
    v_mfma_f32_16x16x32_bf16 v[24:27], v[84:87], v[148:151], v[24:27]
    ds_read_b64 v[52:53], v232 offset:640
    v_mfma_f32_16x16x32_bf16 v[24:27], v[88:91], v[144:147], v[24:27]
    ds_read_b64 v[54:55], v232 offset:648
    v_mfma_f32_16x16x32_bf16 v[28:31], v[80:83], v[156:159], v[28:31]
    ds_read_b128 v[120:123], v233 offset:2688
    v_mfma_f32_16x16x32_bf16 v[28:31], v[84:87], v[152:155], v[28:31]
    ds_read_b64 v[56:57], v232 offset:1152
    v_mfma_f32_16x16x32_bf16 v[28:31], v[88:91], v[148:151], v[28:31]
    ds_read_b64 v[58:59], v232 offset:1160
    v_mfma_f32_16x16x32_bf16 v[28:31], v[92:95], v[144:147], v[28:31]
    ds_read_b128 v[124:127], v233 offset:2176
    v_mfma_f32_16x16x32_bf16 v[32:35], v[80:83], v[160:163], v[32:35]
    ds_read_b64 v[60:61], v232 offset:1664
    v_mfma_f32_16x16x32_bf16 v[32:35], v[84:87], v[156:159], v[32:35]
    ds_read_b64 v[62:63], v232 offset:1672
    v_mfma_f32_16x16x32_bf16 v[32:35], v[88:91], v[152:155], v[32:35]
    ds_read_b128 v[128:131], v233 offset:1664
    v_mfma_f32_16x16x32_bf16 v[32:35], v[92:95], v[148:151], v[32:35]
    ds_read_b64 v[64:65], v232 offset:2176
    v_mfma_f32_16x16x32_bf16 v[32:35], v[96:99], v[144:147], v[32:35]
    ds_read_b64 v[66:67], v232 offset:2184
    v_mfma_f32_16x16x32_bf16 v[36:39], v[80:83], v[164:167], v[36:39]
    ds_read_b128 v[132:135], v233 offset:1152
    v_mfma_f32_16x16x32_bf16 v[36:39], v[84:87], v[160:163], v[36:39]
    ds_read_b64 v[68:69], v232 offset:2688
    v_mfma_f32_16x16x32_bf16 v[36:39], v[88:91], v[156:159], v[36:39]
    ds_read_b64 v[70:71], v232 offset:2696
    v_mfma_f32_16x16x32_bf16 v[36:39], v[92:95], v[152:155], v[36:39]
    ds_read_b128 v[136:139], v233 offset:640
    v_mfma_f32_16x16x32_bf16 v[36:39], v[96:99], v[148:151], v[36:39]
    ds_read_b64 v[72:73], v232 offset:3200
    v_mfma_f32_16x16x32_bf16 v[36:39], v[100:103], v[144:147], v[36:39]
    ds_read_b64 v[74:75], v232 offset:3208
    v_mfma_f32_16x16x32_bf16 v[40:43], v[80:83], v[168:171], v[40:43]
    ds_read_b128 v[140:143], v233 offset:128
    v_mfma_f32_16x16x32_bf16 v[40:43], v[84:87], v[164:167], v[40:43]
    ds_read_b64 v[76:77], v232 offset:3712
    v_mfma_f32_16x16x32_bf16 v[40:43], v[88:91], v[160:163], v[40:43]
    ds_read_b64 v[78:79], v232 offset:3720
    v_mfma_f32_16x16x32_bf16 v[40:43], v[92:95], v[156:159], v[40:43]
    v_add_u32 v232, 128, v232
    v_mfma_f32_16x16x32_bf16 v[40:43], v[96:99], v[152:155], v[40:43]
    v_add_u32 v233, 128, v233
    v_mfma_f32_16x16x32_bf16 v[40:43], v[100:103], v[148:151], v[40:43]
    s_sub_u32 s74, s74, 1
    v_mfma_f32_16x16x32_bf16 v[40:43], v[104:107], v[144:147], v[40:43]
    s_cmp_lg_u32 s74, 0
    v_mfma_f32_16x16x32_bf16 v[44:47], v[80:83], v[172:175], v[44:47]
    v_mfma_f32_16x16x32_bf16 v[44:47], v[84:87], v[168:171], v[44:47]
    v_mfma_f32_16x16x32_bf16 v[44:47], v[88:91], v[164:167], v[44:47]
    v_mfma_f32_16x16x32_bf16 v[44:47], v[92:95], v[160:163], v[44:47]
    v_mfma_f32_16x16x32_bf16 v[44:47], v[96:99], v[156:159], v[44:47]
    v_mfma_f32_16x16x32_bf16 v[44:47], v[100:103], v[152:155], v[44:47]
    v_mfma_f32_16x16x32_bf16 v[44:47], v[104:107], v[148:151], v[44:47]
    v_mfma_f32_16x16x32_bf16 v[44:47], v[108:111], v[144:147], v[44:47]
    s_waitcnt lgkmcnt(0)
    s_cbranch_scc1 L_conv
    v_mfma_f32_16x16x32_bf16 v[16:19], v[48:51], v[112:115], v[16:19]
    ds_read_b128 v[144:147], v233 offset:3648
    v_mfma_f32_16x16x32_bf16 v[20:23], v[48:51], v[116:119], v[20:23]
    ds_read_b64 v[80:81], v232 offset:64
    v_mfma_f32_16x16x32_bf16 v[20:23], v[52:55], v[112:115], v[20:23]
    ds_read_b64 v[82:83], v232 offset:72
    v_mfma_f32_16x16x32_bf16 v[24:27], v[48:51], v[120:123], v[24:27]
    ds_read_b128 v[148:151], v233 offset:3136
    v_mfma_f32_16x16x32_bf16 v[24:27], v[52:55], v[116:119], v[24:27]
    ds_read_b64 v[84:85], v232 offset:576
    v_mfma_f32_16x16x32_bf16 v[24:27], v[56:59], v[112:115], v[24:27]
    ds_read_b64 v[86:87], v232 offset:584
    v_mfma_f32_16x16x32_bf16 v[28:31], v[48:51], v[124:127], v[28:31]
    ds_read_b128 v[152:155], v233 offset:2624
    v_mfma_f32_16x16x32_bf16 v[28:31], v[52:55], v[120:123], v[28:31]
    ds_read_b64 v[88:89], v232 offset:1088
    v_mfma_f32_16x16x32_bf16 v[28:31], v[56:59], v[116:119], v[28:31]
    ds_read_b64 v[90:91], v232 offset:1096
    v_mfma_f32_16x16x32_bf16 v[28:31], v[60:63], v[112:115], v[28:31]
    ds_read_b128 v[156:159], v233 offset:2112
    v_mfma_f32_16x16x32_bf16 v[32:35], v[48:51], v[128:131], v[32:35]
    ds_read_b64 v[92:93], v232 offset:1600
    v_mfma_f32_16x16x32_bf16 v[32:35], v[52:55], v[124:127], v[32:35]
    ds_read_b64 v[94:95], v232 offset:1608
    v_mfma_f32_16x16x32_bf16 v[32:35], v[56:59], v[120:123], v[32:35]
    ds_read_b128 v[160:163], v233 offset:1600
    v_mfma_f32_16x16x32_bf16 v[32:35], v[60:63], v[116:119], v[32:35]
    ds_read_b64 v[96:97], v232 offset:2112
    v_mfma_f32_16x16x32_bf16 v[32:35], v[64:67], v[112:115], v[32:35]
    ds_read_b64 v[98:99], v232 offset:2120
    v_mfma_f32_16x16x32_bf16 v[36:39], v[48:51], v[132:135], v[36:39]
    ds_read_b128 v[164:167], v233 offset:1088
    v_mfma_f32_16x16x32_bf16 v[36:39], v[52:55], v[128:131], v[36:39]
    ds_read_b64 v[100:101], v232 offset:2624
    v_mfma_f32_16x16x32_bf16 v[36:39], v[56:59], v[124:127], v[36:39]
    ds_read_b64 v[102:103], v232 offset:2632
    v_mfma_f32_16x16x32_bf16 v[36:39], v[60:63], v[120:123], v[36:39]
    ds_read_b128 v[168:171], v233 offset:576
    v_mfma_f32_16x16x32_bf16 v[36:39], v[64:67], v[116:119], v[36:39]
    ds_read_b64 v[104:105], v232 offset:3136
    v_mfma_f32_16x16x32_bf16 v[36:39], v[68:71], v[112:115], v[36:39]
    ds_read_b64 v[106:107], v232 offset:3144
    v_mfma_f32_16x16x32_bf16 v[40:43], v[48:51], v[136:139], v[40:43]
    ds_read_b128 v[172:175], v233 offset:64
    v_mfma_f32_16x16x32_bf16 v[40:43], v[52:55], v[132:135], v[40:43]
    ds_read_b64 v[108:109], v232 offset:3648
    v_mfma_f32_16x16x32_bf16 v[40:43], v[56:59], v[128:131], v[40:43]
    ds_read_b64 v[110:111], v232 offset:3656
    v_mfma_f32_16x16x32_bf16 v[40:43], v[60:63], v[124:127], v[40:43]
    s_mul_i32 s74, s68, 4224
    v_mfma_f32_16x16x32_bf16 v[40:43], v[64:67], v[120:123], v[40:43]
    s_and_b32 s75, s71, 63
    v_mfma_f32_16x16x32_bf16 v[40:43], v[68:71], v[116:119], v[40:43]
    s_add_u32 s74, s74, s75
    v_mfma_f32_16x16x32_bf16 v[40:43], v[72:75], v[112:115], v[40:43]
    s_lshl_b32 s74, s74, 6
    v_mfma_f32_16x16x32_bf16 v[44:47], v[48:51], v[140:143], v[44:47]
    v_and_b32 v234, 3, v0
    v_mfma_f32_16x16x32_bf16 v[44:47], v[52:55], v[136:139], v[44:47]
    v_lshl_add_u32 v234, v234, 4, s74
    v_mfma_f32_16x16x32_bf16 v[44:47], v[56:59], v[132:135], v[44:47]
    v_and_b32 v235, 12, v0
    v_mfma_f32_16x16x32_bf16 v[44:47], v[60:63], v[128:131], v[44:47]
    v_lshrrev_b32 v236, 4, v0
    v_mfma_f32_16x16x32_bf16 v[44:47], v[64:67], v[124:127], v[44:47]
    v_add_u32 v235, v235, v236
    v_mfma_f32_16x16x32_bf16 v[44:47], v[68:71], v[120:123], v[44:47]
    v_mul_u32_u24 v235, 4224, v235
    v_mfma_f32_16x16x32_bf16 v[44:47], v[72:75], v[116:119], v[44:47]
    v_add_u32 v234, v234, v235
    v_mfma_f32_16x16x32_bf16 v[44:47], v[76:79], v[112:115], v[44:47]
    s_waitcnt lgkmcnt(0)
    v_mfma_f32_16x16x32_bf16 v[16:19], v[80:83], v[144:147], v[16:19]
    s_bfe_u32 s86, s2, 0x10002
    s_lshr_b32 s74, s2, 5
    v_mfma_f32_16x16x32_bf16 v[20:23], v[80:83], v[148:151], v[20:23]
    s_lshl3_add_u32 s86, s86, s74
    v_lshrrev_b32 v236, 4, v0
    v_mfma_f32_16x16x32_bf16 v[20:23], v[84:87], v[144:147], v[20:23]
    v_lshlrev_b32 v236, 1, v236
    v_xor_b32 v236, v0, v236
    v_mfma_f32_16x16x32_bf16 v[24:27], v[80:83], v[152:155], v[24:27]
    v_and_b32 v236, 7, v236
    s_lshl_b32 s74, s86, 7
    v_cvt_pk_bf16_f32 v48, v16, v17
    v_cvt_pk_bf16_f32 v49, v18, v19
    v_mfma_f32_16x16x32_bf16 v[24:27], v[84:87], v[148:151], v[24:27]
    v_lshl_add_u32 v236, v236, 4, s74
    v_lshrrev_b32 v235, 3, v0
    v_cvt_pk_bf16_f32 v50, v20, v21
    v_cvt_pk_bf16_f32 v51, v22, v23
    v_mfma_f32_16x16x32_bf16 v[24:27], v[88:91], v[144:147], v[24:27]
    v_lshl_add_u32 v235, v235, 11, v236
    s_mov_b32 s56, s24
    s_mov_b32 s76, 0
    buffer_store_dwordx4 v[48:51], v234, s[64:67], s76 offen sc1
    v_mfma_f32_16x16x32_bf16 v[28:31], v[80:83], v[156:159], v[28:31]
    s_mov_b32 s57, s25
    s_mov_b32 s58, 0x200000
    v_mfma_f32_16x16x32_bf16 v[28:31], v[84:87], v[152:155], v[28:31]
    s_mov_b32 s59, 0x20000
    s_mul_i32 s74, s86, 4
    v_cvt_pk_bf16_f32 v52, v24, v25
    v_cvt_pk_bf16_f32 v53, v26, v27
    v_mfma_f32_16x16x32_bf16 v[28:31], v[88:91], v[148:151], v[28:31]
    s_and_b32 s74, s74, 7
    s_lshl1_add_u32 s82, s74, s70
    v_mfma_f32_16x16x32_bf16 v[28:31], v[92:95], v[144:147], v[28:31]
    s_lshl_b32 s82, s82, 17
    s_lshl4_add_u32 s73, s68, 256
    v_mfma_f32_16x16x32_bf16 v[32:35], v[80:83], v[160:163], v[32:35]
    s_add_u32 s45, s73, s69
    s_lshl_b32 s73, s73, 8
    v_mfma_f32_16x16x32_bf16 v[32:35], v[84:87], v[156:159], v[32:35]
    s_lshl_b32 s45, s45, 8
    v_mfma_f32_16x16x32_bf16 v[32:35], v[88:91], v[152:155], v[32:35]
    v_mfma_f32_16x16x32_bf16 v[32:35], v[92:95], v[148:151], v[32:35]
    v_mfma_f32_16x16x32_bf16 v[32:35], v[96:99], v[144:147], v[32:35]
    v_cvt_pk_bf16_f32 v54, v28, v29
    v_cvt_pk_bf16_f32 v55, v30, v31
    v_mfma_f32_16x16x32_bf16 v[36:39], v[80:83], v[164:167], v[36:39]
    s_mov_b32 s76, 67584
    buffer_store_dwordx4 v[52:55], v234, s[64:67], s76 offen sc1
    v_mfma_f32_16x16x32_bf16 v[36:39], v[84:87], v[160:163], v[36:39]
    v_mfma_f32_16x16x32_bf16 v[36:39], v[88:91], v[156:159], v[36:39]
    v_mfma_f32_16x16x32_bf16 v[36:39], v[92:95], v[152:155], v[36:39]
    v_cvt_pk_bf16_f32 v56, v32, v33
    v_cvt_pk_bf16_f32 v57, v34, v35
    v_mfma_f32_16x16x32_bf16 v[36:39], v[96:99], v[148:151], v[36:39]
    v_mfma_f32_16x16x32_bf16 v[36:39], v[100:103], v[144:147], v[36:39]
    v_mfma_f32_16x16x32_bf16 v[40:43], v[80:83], v[168:171], v[40:43]
    v_mfma_f32_16x16x32_bf16 v[40:43], v[84:87], v[164:167], v[40:43]
    v_mfma_f32_16x16x32_bf16 v[40:43], v[88:91], v[160:163], v[40:43]
    v_mfma_f32_16x16x32_bf16 v[40:43], v[92:95], v[156:159], v[40:43]
    v_mfma_f32_16x16x32_bf16 v[40:43], v[96:99], v[152:155], v[40:43]
    v_mfma_f32_16x16x32_bf16 v[40:43], v[100:103], v[148:151], v[40:43]
    v_mfma_f32_16x16x32_bf16 v[40:43], v[104:107], v[144:147], v[40:43]
    v_mfma_f32_16x16x32_bf16 v[44:47], v[80:83], v[172:175], v[44:47]
    v_cvt_pk_bf16_f32 v58, v36, v37
    v_cvt_pk_bf16_f32 v59, v38, v39
    v_mfma_f32_16x16x32_bf16 v[44:47], v[84:87], v[168:171], v[44:47]
    s_mov_b32 s76, 135168
    buffer_store_dwordx4 v[56:59], v234, s[64:67], s76 offen sc1
    v_mfma_f32_16x16x32_bf16 v[44:47], v[88:91], v[164:167], v[44:47]
    v_mfma_f32_16x16x32_bf16 v[44:47], v[92:95], v[160:163], v[44:47]
    v_cvt_pk_bf16_f32 v60, v40, v41
    v_cvt_pk_bf16_f32 v61, v42, v43
    v_mfma_f32_16x16x32_bf16 v[44:47], v[96:99], v[156:159], v[44:47]
    v_mfma_f32_16x16x32_bf16 v[44:47], v[100:103], v[152:155], v[44:47]
    v_mfma_f32_16x16x32_bf16 v[44:47], v[104:107], v[148:151], v[44:47]
    v_mfma_f32_16x16x32_bf16 v[44:47], v[108:111], v[144:147], v[44:47]
    s_nop 7
    v_cvt_pk_bf16_f32 v62, v44, v45
    v_cvt_pk_bf16_f32 v63, v46, v47
    s_mov_b32 s76, 202752
    buffer_store_dwordx4 v[60:63], v234, s[64:67], s76 offen sc1
    s_setprio 1
    s_waitcnt vmcnt(0)
    v_mov_b32 v238, 1
    s_mov_b64 exec, 1
    ds_add_rtn_u32 v237, v227, v238 offset:8
    s_waitcnt lgkmcnt(0)
    v_readfirstlane_b32 s76, v237
    s_nop 0
    s_cmp_eq_u32 s76, 3
    s_cbranch_scc0 L_jo_35a
    s_mov_b64 exec, 0xffff
    v_lshlrev_b32 v237, 8, v0
    buffer_atomic_add v238, v237, s[52:55], s73 offen sc1
L_jo_35a:
    s_mov_b64 exec, -1
    v_lshlrev_b32 v112, 16, v208
    v_and_b32 v113, 0xffff0000, v208
    v_lshlrev_b32 v114, 16, v209
    v_and_b32 v115, 0xffff0000, v209
    v_lshlrev_b32 v116, 16, v210
    v_and_b32 v117, 0xffff0000, v210
    v_lshlrev_b32 v118, 16, v211
    v_and_b32 v119, 0xffff0000, v211
    v_lshlrev_b32 v120, 16, v212
    v_and_b32 v121, 0xffff0000, v212
    v_lshlrev_b32 v122, 16, v213
    v_and_b32 v123, 0xffff0000, v213
    v_lshlrev_b32 v124, 16, v214
    v_and_b32 v125, 0xffff0000, v214
    v_lshlrev_b32 v126, 16, v215
    v_and_b32 v127, 0xffff0000, v215
    v_lshlrev_b32 v128, 16, v216
    v_and_b32 v129, 0xffff0000, v216
    v_lshlrev_b32 v130, 16, v217
    v_and_b32 v131, 0xffff0000, v217
    v_lshlrev_b32 v132, 16, v218
    v_and_b32 v133, 0xffff0000, v218
    v_lshlrev_b32 v134, 16, v219
    v_and_b32 v135, 0xffff0000, v219
    v_lshlrev_b32 v136, 16, v220
    v_and_b32 v137, 0xffff0000, v220
    v_lshlrev_b32 v138, 16, v221
    v_and_b32 v139, 0xffff0000, v221
    v_lshlrev_b32 v140, 16, v222
    v_and_b32 v141, 0xffff0000, v222
    v_lshlrev_b32 v142, 16, v223
    v_and_b32 v143, 0xffff0000, v223
    s_setprio 1
    s_add_u32 m0, s80, 0
    s_add_u32 s83, s82, 1310720
    s_and_b32 s83, s83, 0x1fffff
    buffer_load_dwordx4 v235, s[56:59], s83 offen lds
    s_add_u32 m0, s80, 1024
    s_add_u32 s83, s82, 1327104
    s_and_b32 s83, s83, 0x1fffff
    buffer_load_dwordx4 v235, s[56:59], s83 offen lds
    s_add_u32 m0, s80, 2048
    s_add_u32 s83, s82, 1343488
    s_and_b32 s83, s83, 0x1fffff
    buffer_load_dwordx4 v235, s[56:59], s83 offen lds
    s_add_u32 m0, s80, 3072
    s_add_u32 s83, s82, 1359872
    s_and_b32 s83, s83, 0x1fffff
    buffer_load_dwordx4 v235, s[56:59], s83 offen lds
    s_add_u32 m0, s80, 4096
    s_add_u32 s83, s82, 1376256
    s_and_b32 s83, s83, 0x1fffff
    buffer_load_dwordx4 v235, s[56:59], s83 offen lds
    s_add_u32 m0, s80, 5120
    s_add_u32 s83, s82, 1392640
    s_and_b32 s83, s83, 0x1fffff
    buffer_load_dwordx4 v235, s[56:59], s83 offen lds
    s_add_u32 m0, s80, 6144
    s_add_u32 s83, s82, 1409024
    s_and_b32 s83, s83, 0x1fffff
    buffer_load_dwordx4 v235, s[56:59], s83 offen lds
    s_add_u32 m0, s80, 7168
    s_add_u32 s83, s82, 1425408
    s_and_b32 s83, s83, 0x1fffff
    buffer_load_dwordx4 v235, s[56:59], s83 offen lds
    s_cmp_ge_u32 s70, 2
    s_cbranch_scc1 L_nowo3
    s_add_u32 m0, s81, 0
    s_add_u32 s83, s82, 1835008
    s_and_b32 s83, s83, 0x1fffff
    buffer_load_dwordx4 v235, s[56:59], s83 offen lds
    s_add_u32 m0, s81, 1024
    s_add_u32 s83, s82, 1851392
    s_and_b32 s83, s83, 0x1fffff
    buffer_load_dwordx4 v235, s[56:59], s83 offen lds
    s_add_u32 m0, s81, 2048
    s_add_u32 s83, s82, 1867776
    s_and_b32 s83, s83, 0x1fffff
    buffer_load_dwordx4 v235, s[56:59], s83 offen lds
    s_add_u32 m0, s81, 3072
    s_add_u32 s83, s82, 1884160
    s_and_b32 s83, s83, 0x1fffff
    buffer_load_dwordx4 v235, s[56:59], s83 offen lds
    s_add_u32 m0, s81, 4096
    s_add_u32 s83, s82, 1900544
    s_and_b32 s83, s83, 0x1fffff
    buffer_load_dwordx4 v235, s[56:59], s83 offen lds
    s_add_u32 m0, s81, 5120
    s_add_u32 s83, s82, 1916928
    s_and_b32 s83, s83, 0x1fffff
    buffer_load_dwordx4 v235, s[56:59], s83 offen lds
    s_add_u32 m0, s81, 6144
    s_add_u32 s83, s82, 1933312
    s_and_b32 s83, s83, 0x1fffff
    buffer_load_dwordx4 v235, s[56:59], s83 offen lds
    s_add_u32 m0, s81, 7168
    s_add_u32 s83, s82, 1949696
    s_and_b32 s83, s83, 0x1fffff
    buffer_load_dwordx4 v235, s[56:59], s83 offen lds
L_nowo3:
    s_setprio 1
    s_mul_i32 s77, s70, 4352
    s_add_u32 s77, s77, 60416
    v_lshrrev_b32 v234, 5, v0
    v_lshl_add_u32 v234, v234, 1, v0
    v_lshl_add_u32 v234, v234, 4, s77
    v_and_b32 v235, 7, v0
    v_mul_u32_u24 v235, 544, v235
    v_lshrrev_b32 v236, 3, v0
    v_lshl_add_u32 v235, v236, 3, v235
    v_add_u32 v235, s77, v235
    s_mul_i32 s77, s71, 4224
    s_mov_b32 s60, s26
    s_mov_b32 s61, s27
    s_mov_b32 s62, 0x800000
    s_mov_b32 s63, 0x20000
    s_waitcnt vmcnt(0)
    s_mov_b64 exec, 1
    ds_add_u32 v227, v244 offset:12
    s_mov_b64 exec, -1
    s_cmp_eq_u32 s76, 3
    s_cbranch_scc0 L_jo_35
    s_mov_b32 s75, 131072
L_sg_loop_38:
    s_load_dword s74, s[52:53], s45 glc
L_sg_chk_39:
    s_waitcnt lgkmcnt(0)
    s_cmp_ge_u32 s74, 16
    s_cbranch_scc1 L_sg_done_37
    s_sub_u32 s75, s75, 1
    s_cbranch_scc0 L_sg_loop_38
L_sg_done_37:
    v_mov_b32 v237, 16
    s_mov_b64 exec, 1
    ds_add_u32 v227, v237 offset:16
    s_mov_b64 exec, -1
    s_branch L_jd_36
L_jo_35:
    s_mov_b32 s75, 1048576
L_sl_loop_41:
    ds_read_b32 v237, v227 offset:16
    s_waitcnt lgkmcnt(0)
    v_readfirstlane_b32 s74, v237
    s_nop 0
    s_cmp_ge_u32 s74, 16
    s_cbranch_scc1 L_sl_done_40
    s_sleep 1
    s_sub_u32 s75, s75, 1
    s_cbranch_scc0 L_sl_loop_41
L_sl_done_40:
L_jd_36:
    buffer_load_dwordx4 v[48:51], v224, s[64:67], s77 offen offset:0 sc1
    buffer_load_dwordx4 v[52:55], v224, s[64:67], s77 offen offset:1024 sc1
    buffer_load_dwordx4 v[56:59], v224, s[64:67], s77 offen offset:2048 sc1
    buffer_load_dwordx4 v[60:63], v224, s[64:67], s77 offen offset:3072 sc1
    s_waitcnt vmcnt(3)
    ds_write_b128 v234, v[48:51] offset:0
    s_waitcnt vmcnt(2)
    ds_write_b128 v234, v[52:55] offset:1088
    s_waitcnt vmcnt(1)
    ds_write_b128 v234, v[56:59] offset:2176
    s_waitcnt vmcnt(0)
    ds_write_b128 v234, v[60:63] offset:3264
    ds_read_b64 v[64:65], v235 offset:0
    ds_read_b64 v[66:67], v235 offset:64
    ds_read_b64 v[68:69], v235 offset:128
    ds_read_b64 v[70:71], v235 offset:192
    ds_read_b64 v[72:73], v235 offset:256
    ds_read_b64 v[74:75], v235 offset:320
    ds_read_b64 v[76:77], v235 offset:384
    ds_read_b64 v[78:79], v235 offset:448
    s_waitcnt lgkmcnt(7)
    v_lshlrev_b32 v16, 16, v64
    v_and_b32 v24, 0xffff0000, v64
    v_lshlrev_b32 v32, 16, v65
    v_and_b32 v40, 0xffff0000, v65
    s_waitcnt lgkmcnt(6)
    v_lshlrev_b32 v17, 16, v66
    v_and_b32 v25, 0xffff0000, v66
    v_lshlrev_b32 v33, 16, v67
    v_and_b32 v41, 0xffff0000, v67
    s_waitcnt lgkmcnt(5)
    v_lshlrev_b32 v18, 16, v68
    v_and_b32 v26, 0xffff0000, v68
    v_lshlrev_b32 v34, 16, v69
    v_and_b32 v42, 0xffff0000, v69
    s_waitcnt lgkmcnt(4)
    v_lshlrev_b32 v19, 16, v70
    v_and_b32 v27, 0xffff0000, v70
    v_lshlrev_b32 v35, 16, v71
    v_and_b32 v43, 0xffff0000, v71
    s_waitcnt lgkmcnt(3)
    v_lshlrev_b32 v20, 16, v72
    v_and_b32 v28, 0xffff0000, v72
    v_lshlrev_b32 v36, 16, v73
    v_and_b32 v44, 0xffff0000, v73
    s_waitcnt lgkmcnt(2)
    v_lshlrev_b32 v21, 16, v74
    v_and_b32 v29, 0xffff0000, v74
    v_lshlrev_b32 v37, 16, v75
    v_and_b32 v45, 0xffff0000, v75
    s_waitcnt lgkmcnt(1)
    v_lshlrev_b32 v22, 16, v76
    v_and_b32 v30, 0xffff0000, v76
    v_lshlrev_b32 v38, 16, v77
    v_and_b32 v46, 0xffff0000, v77
    s_waitcnt lgkmcnt(0)
    v_lshlrev_b32 v23, 16, v78
    v_and_b32 v31, 0xffff0000, v78
    v_lshlrev_b32 v39, 16, v79
    v_and_b32 v47, 0xffff0000, v79
    v_mul_f32 v16, v16, v112
    v_mul_f32 v17, v17, v113
    v_mul_f32 v18, v18, v114
    v_mul_f32 v19, v19, v115
    v_mul_f32 v20, v20, v116
    v_mul_f32 v21, v21, v117
    v_mul_f32 v22, v22, v118
    v_mul_f32 v23, v23, v119
    v_cvt_pk_bf16_f32 v48, v16, v17
    v_cvt_pk_bf16_f32 v49, v18, v19
    v_cvt_pk_bf16_f32 v50, v20, v21
    v_cvt_pk_bf16_f32 v51, v22, v23
    s_mov_b32 s74, 0
    buffer_store_dwordx4 v[48:51], v226, s[60:63], s74 offen nt
    v_mul_f32 v24, v24, v120
    v_mul_f32 v25, v25, v121
    v_mul_f32 v26, v26, v122
    v_mul_f32 v27, v27, v123
    v_mul_f32 v28, v28, v124
    v_mul_f32 v29, v29, v125
    v_mul_f32 v30, v30, v126
    v_mul_f32 v31, v31, v127
    v_cvt_pk_bf16_f32 v52, v24, v25
    v_cvt_pk_bf16_f32 v53, v26, v27
    v_cvt_pk_bf16_f32 v54, v28, v29
    v_cvt_pk_bf16_f32 v55, v30, v31
    s_mov_b32 s74, 4096
    buffer_store_dwordx4 v[52:55], v226, s[60:63], s74 offen nt
    v_mul_f32 v32, v32, v128
    v_mul_f32 v33, v33, v129
    v_mul_f32 v34, v34, v130
    v_mul_f32 v35, v35, v131
    v_mul_f32 v36, v36, v132
    v_mul_f32 v37, v37, v133
    v_mul_f32 v38, v38, v134
    v_mul_f32 v39, v39, v135
    v_cvt_pk_bf16_f32 v56, v32, v33
    v_cvt_pk_bf16_f32 v57, v34, v35
    v_cvt_pk_bf16_f32 v58, v36, v37
    v_cvt_pk_bf16_f32 v59, v38, v39
    s_mov_b32 s74, 16384
    buffer_store_dwordx4 v[56:59], v226, s[60:63], s74 offen nt
    v_mul_f32 v40, v40, v136
    v_mul_f32 v41, v41, v137
    v_mul_f32 v42, v42, v138
    v_mul_f32 v43, v43, v139
    v_mul_f32 v44, v44, v140
    v_mul_f32 v45, v45, v141
    v_mul_f32 v46, v46, v142
    v_mul_f32 v47, v47, v143
    v_cvt_pk_bf16_f32 v60, v40, v41
    v_cvt_pk_bf16_f32 v61, v42, v43
    v_cvt_pk_bf16_f32 v62, v44, v45
    v_cvt_pk_bf16_f32 v63, v46, v47
    s_mov_b32 s74, 20480
    buffer_store_dwordx4 v[60:63], v226, s[60:63], s74 offen nt
    s_endpgm
L_grole:
    s_setprio 2
    s_add_u32 s52, s30, 0xe00000
    s_addc_u32 s53, s31, 0
    s_mov_b32 s54, 0x20000
    s_mov_b32 s55, 0x20000
    s_lshr_b32 s32, s3, 1
    s_and_b32 s33, s3, 1
    v_and_b32 v1, 15, v0
    v_lshrrev_b32 v2, 4, v0
    v_lshrrev_b32 v3, 1, v1
    v_xor_b32 v3, v2, v3
    v_lshlrev_b32 v3, 4, v3
    v_lshl_add_u32 v3, v1, 7, v3
    s_lshl_b32 s37, s33, 13
    v_add_u32 v196, s37, v3
    v_xor_b32 v197, 64, v196
    v_and_b32 v3, 6, v1
    v_xor_b32 v3, v2, v3
    v_lshlrev_b32 v3, 4, v3
    v_and_b32 v198, 7, v1
    v_lshl_add_u32 v3, v198, 7, v3
    v_add_u32 v198, 16384, v3
    v_xor_b32 v199, 64, v198
    v_bfe_u32 v3, v0, 2, 2
    v_lshl_add_u32 v200, v2, 3, v3
    v_lshlrev_b32 v200, 7, v200
    v_bfe_u32 v3, v0, 3, 2
    v_xor_b32 v3, s3, v3
    v_lshl_add_u32 v200, v3, 5, v200
    v_and_b32 v3, 3, v0
    v_lshl_add_u32 v200, v3, 3, v200
    v_add_u32 v200, 17408, v200
    v_xor_b32 v201, 32, v200
    v_mov_b64 v[52:53], 0
    v_mov_b64 v[54:55], 0
    v_mov_b64 v[56:57], 0
    v_mov_b64 v[58:59], 0
    v_mov_b64 v[60:61], 0
    v_mov_b64 v[62:63], 0
    v_mov_b64 v[64:65], 0
    v_mov_b64 v[66:67], 0
    v_mov_b64 v[68:69], 0
    v_mov_b64 v[70:71], 0
    v_mov_b64 v[72:73], 0
    v_mov_b64 v[74:75], 0
    v_mov_b64 v[76:77], 0
    v_mov_b64 v[78:79], 0
    v_mov_b64 v[80:81], 0
    v_mov_b64 v[82:83], 0
    v_mov_b64 v[84:85], 0
    v_mov_b64 v[86:87], 0
    v_mov_b64 v[88:89], 0
    v_mov_b64 v[90:91], 0
    v_mov_b64 v[92:93], 0
    v_mov_b64 v[94:95], 0
    v_mov_b64 v[96:97], 0
    v_mov_b64 v[98:99], 0
    v_mov_b64 v[100:101], 0
    v_mov_b64 v[102:103], 0
    v_mov_b64 v[104:105], 0
    v_mov_b64 v[106:107], 0
    s_mov_b32 s34, 0
    v_mov_b32 v228, 134352
    v_and_b32 v1, 15, v0
    v_lshrrev_b32 v2, 4, v0
    v_lshlrev_b32 v2, 2, v2
    v_sub_u32 v1, v1, v2
    s_mov_b32 s37, 0xf149f2ca
    v_mov_b32 v3, s37
    s_or_b32 s38, s5, s33
    s_cmp_eq_u32 s38, 0
    s_cselect_b32 s38, s37, 0
    v_subrev_u32 v2, 0, v1
    v_cmp_gt_u32 vcc, 8, v2
    v_cmp_gt_i32 s[64:65], -8, v2
    v_ashrrev_i32 v2, 31, v2
    v_cndmask_b32 v204, v3, 0, vcc
    v_cndmask_b32 v208, v3, 0, s[64:65]
    v_mov_b32 v216, v2
    v_min_f32 v212, s38, v208
    v_subrev_u32 v2, 1, v1
    v_cmp_gt_u32 vcc, 8, v2
    v_cmp_gt_i32 s[64:65], -8, v2
    v_ashrrev_i32 v2, 31, v2
    v_cndmask_b32 v205, v3, 0, vcc
    v_cndmask_b32 v209, v3, 0, s[64:65]
    v_alignbit_b32 v216, v2, v216, 16
    v_min_f32 v213, s38, v209
    v_subrev_u32 v2, 2, v1
    v_cmp_gt_u32 vcc, 8, v2
    v_cmp_gt_i32 s[64:65], -8, v2
    v_ashrrev_i32 v2, 31, v2
    v_cndmask_b32 v206, v3, 0, vcc
    v_cndmask_b32 v210, v3, 0, s[64:65]
    v_mov_b32 v217, v2
    v_min_f32 v214, s38, v210
    v_subrev_u32 v2, 3, v1
    v_cmp_gt_u32 vcc, 8, v2
    v_cmp_gt_i32 s[64:65], -8, v2
    v_ashrrev_i32 v2, 31, v2
    v_cndmask_b32 v207, v3, 0, vcc
    v_cndmask_b32 v211, v3, 0, s[64:65]
    v_alignbit_b32 v217, v2, v217, 16
    v_min_f32 v215, s38, v211
    s_mul_i32 s37, s32, 80896
    s_add_u32 s37, s37, 78848
    v_lshl_add_u32 v220, v0, 3, s37
    s_lshl_b32 s38, s33, 9
    v_add_u32 v219, s38, v220
    s_mul_i32 s38, s33, 2560
    v_add_u32 v221, s38, v220
    v_xor_b32 v222, 512, v221
    s_lshl3_add_u32 s37, s4, s5
    s_lshl1_add_u32 s37, s37, s33
    s_lshl_b32 s37, s37, 7
    s_lshl1_add_u32 s38, s6, s32
    s_add_u32 s37, s37, s38
    s_lshl_b32 s37, s37, 10
    v_lshl_add_u32 v218, v0, 4, s37
    s_mov_b32 s40, s30
    s_mov_b32 s41, s31
    s_mov_b32 s42, 0x400000
    s_mov_b32 s43, 0x20000
    s_and_b32 s58, s2, 3
    s_bfe_u32 s37, s2, 0x20003
    s_lshl2_add_u32 s58, s58, s37
    s_bfe_u32 s59, s2, 0x10002
    s_lshr_b32 s37, s2, 5
    s_lshl3_add_u32 s59, s59, s37
    s_mov_b32 s44, s24
    s_mov_b32 s45, s25
    s_mov_b32 s46, 0x200000
    s_mov_b32 s47, 0x20000
    s_mov_b32 s48, s26
    s_mov_b32 s49, s27
    s_mov_b32 s50, 0x800000
    s_mov_b32 s51, 0x20000
    s_lshl3_add_u32 s56, s4, s5
    s_lshl4_add_u32 s56, s56, 0
    s_lshl_b32 s56, s56, 8
    s_lshl4_add_u32 s57, s58, 0
    s_add_u32 s57, s57, s59
    s_lshl_b32 s57, s57, 8
    s_lshl2_add_u32 s37, s58, s3
    s_lshl_b32 s38, s37, 16
    v_lshl_add_u32 v224, v0, 4, s38
    v_add_u32 v225, 0x8000, v224
    s_and_b32 s37, s37, 31
    s_lshl_b32 s37, s37, 6
    s_lshr_b32 s38, s58, 3
    s_add_u32 s37, s37, s38
    s_lshl_b32 s37, s37, 5
    s_add_u32 s37, s37, s59
    s_add_u32 s37, s37, 16
    s_lshl_b32 s37, s37, 7
    v_lshrrev_b32 v1, 3, v0
    v_lshl_add_u32 v1, v1, 13, s37
    v_and_b32 v2, 7, v0
    v_lshl_add_u32 v226, v2, 4, v1
    v_lshrrev_b32 v1, 4, v0
    v_lshlrev_b32 v1, 1, v1
    v_xor_b32 v1, v0, v1
    v_and_b32 v1, 7, v1
    s_lshl_b32 s37, s59, 7
    v_lshl_add_u32 v1, v1, 4, s37
    v_lshrrev_b32 v227, 3, v0
    v_lshl_add_u32 v227, v227, 11, v1
    s_lshl_b32 s60, s3, 11
    s_mul_i32 s61, s59, 4
    s_and_b32 s61, s61, 7
    s_lshl3_add_u32 s62, s61, s3
    s_lshl_b32 s62, s62, 15
    v_lshrrev_b32 v1, 2, v0
    v_lshlrev_b32 v1, 7, v1
    v_bfe_u32 v2, v0, 3, 2
    v_lshl_add_u32 v1, v2, 5, v1
    v_and_b32 v2, 3, v0
    v_lshl_add_u32 v229, v2, 3, v1
    v_and_b32 v231, 7, v0
    v_lshl_add_u32 v230, v231, 6, s86
    v_mul_u32_u24 v231, 528, v231
    v_lshrrev_b32 v232, 3, v0
    v_xor_b32 v232, 7, v232
    v_lshl_add_u32 v231, v232, 3, v231
    v_add_u32 v231, s86, v231
    v_lshrrev_b32 v232, 5, v0
    v_add_u32 v232, v0, v232
    v_lshl_add_u32 v232, v232, 4, s86
    s_mul_i32 s87, s84, 4224
    s_sub_u32 s87, s87, s85
    s_lshl_b32 s87, s87, 6
    s_add_u32 s87, s87, 4032
    v_and_b32 v233, 3, v0
    v_lshl_add_u32 v233, v233, 4, s87
    v_lshrrev_b32 v234, 2, v0
    v_mul_u32_u24 v234, 4224, v234
    v_add_u32 v233, v233, v234
    s_add_u32 s80, s30, 0x400000
    s_addc_u32 s81, s31, 0
    s_mov_b32 s82, 0x420000
    s_mov_b32 s83, 0x20000
    s_waitcnt vmcnt(13)
    ds_read_b128 v[36:39], v230 offset:4224
    ds_read_b128 v[40:43], v230 offset:4240
    ds_read_b128 v[44:47], v230 offset:4256
    ds_read_b128 v[48:51], v230 offset:4272
    s_waitcnt lgkmcnt(3)
    v_lshlrev_b32 v152, 16, v36
    v_and_b32 v154, 0xffff0000, v36
    v_lshlrev_b32 v156, 16, v37
    v_and_b32 v158, 0xffff0000, v37
    v_lshlrev_b32 v153, 16, v38
    v_and_b32 v155, 0xffff0000, v38
    v_lshlrev_b32 v157, 16, v39
    v_and_b32 v159, 0xffff0000, v39
    s_waitcnt lgkmcnt(2)
    v_lshlrev_b32 v160, 16, v40
    v_and_b32 v162, 0xffff0000, v40
    v_lshlrev_b32 v164, 16, v41
    v_and_b32 v166, 0xffff0000, v41
    v_lshlrev_b32 v161, 16, v42
    v_and_b32 v163, 0xffff0000, v42
    v_lshlrev_b32 v165, 16, v43
    v_and_b32 v167, 0xffff0000, v43
    s_waitcnt lgkmcnt(1)
    v_lshlrev_b32 v168, 16, v44
    v_and_b32 v170, 0xffff0000, v44
    v_lshlrev_b32 v172, 16, v45
    v_and_b32 v174, 0xffff0000, v45
    v_lshlrev_b32 v169, 16, v46
    v_and_b32 v171, 0xffff0000, v46
    v_lshlrev_b32 v173, 16, v47
    v_and_b32 v175, 0xffff0000, v47
    s_waitcnt lgkmcnt(0)
    v_lshlrev_b32 v176, 16, v48
    v_and_b32 v178, 0xffff0000, v48
    v_lshlrev_b32 v180, 16, v49
    v_and_b32 v182, 0xffff0000, v49
    v_lshlrev_b32 v177, 16, v50
    v_and_b32 v179, 0xffff0000, v50
    v_lshlrev_b32 v181, 16, v51
    v_and_b32 v183, 0xffff0000, v51
    v_mov_b64 v[36:37], 0
    v_mov_b64 v[38:39], 0
    v_mov_b64 v[40:41], 0
    v_mov_b64 v[42:43], 0
    v_mov_b64 v[44:45], 0
    v_mov_b64 v[46:47], 0
    v_mov_b64 v[48:49], 0
    v_mov_b64 v[50:51], 0
    s_waitcnt vmcnt(12)
    v_lshlrev_b32 v184, 16, v108
    v_and_b32 v185, 0xffff0000, v108
    v_lshlrev_b32 v186, 16, v109
    v_and_b32 v187, 0xffff0000, v109
    v_lshlrev_b32 v188, 16, v110
    v_and_b32 v189, 0xffff0000, v110
    v_lshlrev_b32 v190, 16, v111
    v_and_b32 v191, 0xffff0000, v111
    v_pk_mul_f32 v[4:5], v[184:185], v[158:159]
    v_pk_mul_f32 v[12:13], v[186:187], v[166:167]
    v_pk_mul_f32 v[20:21], v[188:189], v[174:175]
    v_pk_mul_f32 v[28:29], v[190:191], v[182:183]
    s_waitcnt vmcnt(11)
    v_lshlrev_b32 v184, 16, v112
    v_and_b32 v185, 0xffff0000, v112
    v_lshlrev_b32 v186, 16, v113
    v_and_b32 v187, 0xffff0000, v113
    v_lshlrev_b32 v188, 16, v114
    v_and_b32 v189, 0xffff0000, v114
    v_lshlrev_b32 v190, 16, v115
    v_and_b32 v191, 0xffff0000, v115
    v_pk_fma_f32 v[4:5], v[184:185], v[156:157], v[4:5]
    v_pk_fma_f32 v[12:13], v[186:187], v[164:165], v[12:13]
    v_pk_fma_f32 v[20:21], v[188:189], v[172:173], v[20:21]
    v_pk_fma_f32 v[28:29], v[190:191], v[180:181], v[28:29]
    v_pk_mul_f32 v[6:7], v[184:185], v[158:159]
    v_pk_mul_f32 v[14:15], v[186:187], v[166:167]
    v_pk_mul_f32 v[22:23], v[188:189], v[174:175]
    v_pk_mul_f32 v[30:31], v[190:191], v[182:183]
    s_waitcnt vmcnt(10)
    v_lshlrev_b32 v184, 16, v116
    v_and_b32 v185, 0xffff0000, v116
    v_lshlrev_b32 v186, 16, v117
    v_and_b32 v187, 0xffff0000, v117
    v_lshlrev_b32 v188, 16, v118
    v_and_b32 v189, 0xffff0000, v118
    v_lshlrev_b32 v190, 16, v119
    v_and_b32 v191, 0xffff0000, v119
    v_pk_fma_f32 v[4:5], v[184:185], v[154:155], v[4:5]
    v_pk_fma_f32 v[12:13], v[186:187], v[162:163], v[12:13]
    v_pk_fma_f32 v[20:21], v[188:189], v[170:171], v[20:21]
    v_pk_fma_f32 v[28:29], v[190:191], v[178:179], v[28:29]
    v_pk_fma_f32 v[6:7], v[184:185], v[156:157], v[6:7]
    v_pk_fma_f32 v[14:15], v[186:187], v[164:165], v[14:15]
    v_pk_fma_f32 v[22:23], v[188:189], v[172:173], v[22:23]
    v_pk_fma_f32 v[30:31], v[190:191], v[180:181], v[30:31]
    v_pk_mul_f32 v[8:9], v[184:185], v[158:159]
    v_pk_mul_f32 v[16:17], v[186:187], v[166:167]
    v_pk_mul_f32 v[24:25], v[188:189], v[174:175]
    v_pk_mul_f32 v[32:33], v[190:191], v[182:183]
    s_waitcnt vmcnt(9)
    v_lshlrev_b32 v184, 16, v120
    v_and_b32 v185, 0xffff0000, v120
    v_lshlrev_b32 v186, 16, v121
    v_and_b32 v187, 0xffff0000, v121
    v_lshlrev_b32 v188, 16, v122
    v_and_b32 v189, 0xffff0000, v122
    v_lshlrev_b32 v190, 16, v123
    v_and_b32 v191, 0xffff0000, v123
    v_pk_fma_f32 v[4:5], v[184:185], v[152:153], v[4:5]
    v_pk_fma_f32 v[12:13], v[186:187], v[160:161], v[12:13]
    v_pk_fma_f32 v[20:21], v[188:189], v[168:169], v[20:21]
    v_pk_fma_f32 v[28:29], v[190:191], v[176:177], v[28:29]
    v_pk_fma_f32 v[6:7], v[184:185], v[154:155], v[6:7]
    v_pk_fma_f32 v[14:15], v[186:187], v[162:163], v[14:15]
    v_pk_fma_f32 v[22:23], v[188:189], v[170:171], v[22:23]
    v_pk_fma_f32 v[30:31], v[190:191], v[178:179], v[30:31]
    v_pk_fma_f32 v[8:9], v[184:185], v[156:157], v[8:9]
    v_pk_fma_f32 v[16:17], v[186:187], v[164:165], v[16:17]
    v_pk_fma_f32 v[24:25], v[188:189], v[172:173], v[24:25]
    v_pk_fma_f32 v[32:33], v[190:191], v[180:181], v[32:33]
    v_pk_mul_f32 v[10:11], v[184:185], v[158:159]
    v_pk_mul_f32 v[18:19], v[186:187], v[166:167]
    v_pk_mul_f32 v[26:27], v[188:189], v[174:175]
    v_pk_mul_f32 v[34:35], v[190:191], v[182:183]
    s_waitcnt vmcnt(8)
    v_lshlrev_b32 v184, 16, v124
    v_and_b32 v185, 0xffff0000, v124
    v_lshlrev_b32 v186, 16, v125
    v_and_b32 v187, 0xffff0000, v125
    v_lshlrev_b32 v188, 16, v126
    v_and_b32 v189, 0xffff0000, v126
    v_lshlrev_b32 v190, 16, v127
    v_and_b32 v191, 0xffff0000, v127
    v_pk_fma_f32 v[6:7], v[184:185], v[152:153], v[6:7]
    v_pk_fma_f32 v[14:15], v[186:187], v[160:161], v[14:15]
    v_pk_fma_f32 v[22:23], v[188:189], v[168:169], v[22:23]
    v_pk_fma_f32 v[30:31], v[190:191], v[176:177], v[30:31]
    v_pk_fma_f32 v[8:9], v[184:185], v[154:155], v[8:9]
    v_pk_fma_f32 v[16:17], v[186:187], v[162:163], v[16:17]
    v_pk_fma_f32 v[24:25], v[188:189], v[170:171], v[24:25]
    v_pk_fma_f32 v[32:33], v[190:191], v[178:179], v[32:33]
    v_pk_fma_f32 v[10:11], v[184:185], v[156:157], v[10:11]
    v_pk_fma_f32 v[18:19], v[186:187], v[164:165], v[18:19]
    v_pk_fma_f32 v[26:27], v[188:189], v[172:173], v[26:27]
    v_pk_fma_f32 v[34:35], v[190:191], v[180:181], v[34:35]
    s_waitcnt vmcnt(7)
    v_lshlrev_b32 v184, 16, v128
    v_and_b32 v185, 0xffff0000, v128
    v_lshlrev_b32 v186, 16, v129
    v_and_b32 v187, 0xffff0000, v129
    v_lshlrev_b32 v188, 16, v130
    v_and_b32 v189, 0xffff0000, v130
    v_lshlrev_b32 v190, 16, v131
    v_and_b32 v191, 0xffff0000, v131
    v_pk_fma_f32 v[8:9], v[184:185], v[152:153], v[8:9]
    v_pk_fma_f32 v[16:17], v[186:187], v[160:161], v[16:17]
    v_pk_fma_f32 v[24:25], v[188:189], v[168:169], v[24:25]
    v_pk_fma_f32 v[32:33], v[190:191], v[176:177], v[32:33]
    v_pk_fma_f32 v[10:11], v[184:185], v[154:155], v[10:11]
    v_pk_fma_f32 v[18:19], v[186:187], v[162:163], v[18:19]
    v_pk_fma_f32 v[26:27], v[188:189], v[170:171], v[26:27]
    v_pk_fma_f32 v[34:35], v[190:191], v[178:179], v[34:35]
    s_waitcnt vmcnt(6)
    v_lshlrev_b32 v184, 16, v132
    v_and_b32 v185, 0xffff0000, v132
    v_lshlrev_b32 v186, 16, v133
    v_and_b32 v187, 0xffff0000, v133
    v_lshlrev_b32 v188, 16, v134
    v_and_b32 v189, 0xffff0000, v134
    v_lshlrev_b32 v190, 16, v135
    v_and_b32 v191, 0xffff0000, v135
    v_pk_fma_f32 v[10:11], v[184:185], v[152:153], v[10:11]
    v_pk_fma_f32 v[18:19], v[186:187], v[160:161], v[18:19]
    v_pk_fma_f32 v[26:27], v[188:189], v[168:169], v[26:27]
    v_pk_fma_f32 v[34:35], v[190:191], v[176:177], v[34:35]
    s_waitcnt vmcnt(5)
    v_lshlrev_b32 v184, 16, v136
    v_and_b32 v185, 0xffff0000, v136
    v_lshlrev_b32 v186, 16, v137
    v_and_b32 v187, 0xffff0000, v137
    v_lshlrev_b32 v188, 16, v138
    v_and_b32 v189, 0xffff0000, v138
    v_lshlrev_b32 v190, 16, v139
    v_and_b32 v191, 0xffff0000, v139
    v_pk_mul_f32 v[4:5], v[4:5], v[184:185]
    v_pk_mul_f32 v[12:13], v[12:13], v[186:187]
    v_pk_mul_f32 v[20:21], v[20:21], v[188:189]
    v_pk_mul_f32 v[28:29], v[28:29], v[190:191]
    s_waitcnt vmcnt(4)
    v_lshlrev_b32 v184, 16, v140
    v_and_b32 v185, 0xffff0000, v140
    v_lshlrev_b32 v186, 16, v141
    v_and_b32 v187, 0xffff0000, v141
    v_lshlrev_b32 v188, 16, v142
    v_and_b32 v189, 0xffff0000, v142
    v_lshlrev_b32 v190, 16, v143
    v_and_b32 v191, 0xffff0000, v143
    v_pk_mul_f32 v[6:7], v[6:7], v[184:185]
    v_pk_mul_f32 v[14:15], v[14:15], v[186:187]
    v_pk_mul_f32 v[22:23], v[22:23], v[188:189]
    v_pk_mul_f32 v[30:31], v[30:31], v[190:191]
    s_waitcnt vmcnt(3)
    v_lshlrev_b32 v184, 16, v144
    v_and_b32 v185, 0xffff0000, v144
    v_lshlrev_b32 v186, 16, v145
    v_and_b32 v187, 0xffff0000, v145
    v_lshlrev_b32 v188, 16, v146
    v_and_b32 v189, 0xffff0000, v146
    v_lshlrev_b32 v190, 16, v147
    v_and_b32 v191, 0xffff0000, v147
    v_pk_mul_f32 v[8:9], v[8:9], v[184:185]
    v_pk_mul_f32 v[16:17], v[16:17], v[186:187]
    v_pk_mul_f32 v[24:25], v[24:25], v[188:189]
    v_pk_mul_f32 v[32:33], v[32:33], v[190:191]
    s_waitcnt vmcnt(2)
    v_lshlrev_b32 v184, 16, v148
    v_and_b32 v185, 0xffff0000, v148
    v_lshlrev_b32 v186, 16, v149
    v_and_b32 v187, 0xffff0000, v149
    v_lshlrev_b32 v188, 16, v150
    v_and_b32 v189, 0xffff0000, v150
    v_lshlrev_b32 v190, 16, v151
    v_and_b32 v191, 0xffff0000, v151
    v_pk_mul_f32 v[10:11], v[10:11], v[184:185]
    v_pk_mul_f32 v[18:19], v[18:19], v[186:187]
    v_pk_mul_f32 v[26:27], v[26:27], v[188:189]
    v_pk_mul_f32 v[34:35], v[34:35], v[190:191]
    v_cvt_pk_bf16_f32 v108, v10, v8
    v_cvt_pk_bf16_f32 v109, v6, v4
    ds_write_b64 v231, v[108:109] offset:0
    v_cvt_pk_bf16_f32 v110, v11, v9
    v_cvt_pk_bf16_f32 v111, v7, v5
    ds_write_b64 v231, v[110:111] offset:64
    v_cvt_pk_bf16_f32 v112, v18, v16
    v_cvt_pk_bf16_f32 v113, v14, v12
    ds_write_b64 v231, v[112:113] offset:128
    v_cvt_pk_bf16_f32 v114, v19, v17
    v_cvt_pk_bf16_f32 v115, v15, v13
    ds_write_b64 v231, v[114:115] offset:192
    v_cvt_pk_bf16_f32 v116, v26, v24
    v_cvt_pk_bf16_f32 v117, v22, v20
    ds_write_b64 v231, v[116:117] offset:256
    v_cvt_pk_bf16_f32 v118, v27, v25
    v_cvt_pk_bf16_f32 v119, v23, v21
    ds_write_b64 v231, v[118:119] offset:320
    v_cvt_pk_bf16_f32 v120, v34, v32
    v_cvt_pk_bf16_f32 v121, v30, v28
    ds_write_b64 v231, v[120:121] offset:384
    v_cvt_pk_bf16_f32 v122, v35, v33
    v_cvt_pk_bf16_f32 v123, v31, v29
    ds_write_b64 v231, v[122:123] offset:448
    ds_read_b128 v[152:155], v232 offset:0
    ds_read_b128 v[156:159], v232 offset:1056
    ds_read_b128 v[160:163], v232 offset:2112
    ds_read_b128 v[164:167], v232 offset:3168
    v_mov_b64 v[4:5], 0
    v_mov_b64 v[6:7], 0
    v_mov_b64 v[8:9], 0
    v_mov_b64 v[10:11], 0
    v_mov_b64 v[12:13], 0
    v_mov_b64 v[14:15], 0
    v_mov_b64 v[16:17], 0
    v_mov_b64 v[18:19], 0
    v_mov_b64 v[20:21], 0
    v_mov_b64 v[22:23], 0
    v_mov_b64 v[24:25], 0
    v_mov_b64 v[26:27], 0
    v_mov_b64 v[28:29], 0
    v_mov_b64 v[30:31], 0
    v_mov_b64 v[32:33], 0
    v_mov_b64 v[34:35], 0
    s_waitcnt lgkmcnt(0)
    s_mov_b32 s87, 0
    buffer_store_dwordx4 v[152:155], v233, s[80:83], s87 offen sc1
    s_mov_b32 s87, 67584
    buffer_store_dwordx4 v[156:159], v233, s[80:83], s87 offen sc1
    s_mov_b32 s87, 135168
    buffer_store_dwordx4 v[160:163], v233, s[80:83], s87 offen sc1
    s_mov_b32 s87, 202752
    buffer_store_dwordx4 v[164:167], v233, s[80:83], s87 offen sc1
    s_and_b32 s37, s2, 7
    s_xor_b32 s37, s37, 2
    s_lshl_b32 s37, s37, 5
    s_lshr_b32 s38, s2, 3
    s_add_u32 s37, s37, s38
    s_add_u32 s37, s37, 256
    s_lshl_b32 s37, s37, 8
    s_cmp_eq_u32 s33, 0
    s_cselect_b32 s37, s37, s57
    s_cmp_eq_u32 s32, 0
    s_cbranch_scc0 L_noclear
    s_mov_b64 exec, 1
    buffer_store_dword v4, off, s[52:55], s37 sc1
    s_mov_b64 exec, -1
L_noclear:
    s_mov_b32 s37, 41984
    s_mov_b32 s36, 15
    s_barrier
    ds_read_b128 v[108:111], v196 offset:0
    ds_read_b64_tr_b16 v[128:129], v200 offset:0
    ds_read_b64_tr_b16 v[130:131], v200 offset:512
    ds_read_b128 v[112:115], v196 offset:2048
    ds_read_b64_tr_b16 v[132:133], v201 offset:0
    ds_read_b64_tr_b16 v[134:135], v201 offset:512
    ds_read_b128 v[116:119], v196 offset:4096
    ds_read_b64_tr_b16 v[136:137], v200 offset:8192
    ds_read_b64_tr_b16 v[138:139], v200 offset:8704
    ds_read_b128 v[120:123], v196 offset:6144
    ds_read_b64_tr_b16 v[140:141], v201 offset:8192
    ds_read_b64_tr_b16 v[142:143], v201 offset:8704
    ds_read_b128 v[124:127], v198
    ds_read_b64_tr_b16 v[144:145], v200 offset:16384
    ds_read_b64_tr_b16 v[146:147], v200 offset:16896
    ds_read_b64_tr_b16 v[148:149], v201 offset:16384
    ds_read_b64_tr_b16 v[150:151], v201 offset:16896
    s_waitcnt lgkmcnt(0)
L_g1_loop:
    v_mfma_f32_16x16x32_bf16 v[4:7], v[128:131], v[108:111], v[4:7]
    ds_read_b128 v[152:155], v197 offset:0
    v_mfma_f32_16x16x32_bf16 v[12:15], v[128:131], v[112:115], v[12:15]
    ds_read_b64_tr_b16 v[172:173], v200 offset:4096
    v_mfma_f32_16x16x32_bf16 v[20:23], v[128:131], v[116:119], v[20:23]
    ds_read_b64_tr_b16 v[174:175], v200 offset:4608
    v_mfma_f32_16x16x32_bf16 v[28:31], v[128:131], v[120:123], v[28:31]
    ds_read_b128 v[156:159], v197 offset:2048
    v_mfma_f32_16x16x32_bf16 v[8:11], v[132:135], v[108:111], v[8:11]
    ds_read_b64_tr_b16 v[176:177], v201 offset:4096
    v_mfma_f32_16x16x32_bf16 v[16:19], v[132:135], v[112:115], v[16:19]
    ds_read_b64_tr_b16 v[178:179], v201 offset:4608
    v_mfma_f32_16x16x32_bf16 v[24:27], v[132:135], v[116:119], v[24:27]
    ds_read_b128 v[160:163], v197 offset:4096
    v_mfma_f32_16x16x32_bf16 v[32:35], v[132:135], v[120:123], v[32:35]
    ds_read_b64_tr_b16 v[180:181], v200 offset:12288
    v_mfma_f32_16x16x32_bf16 v[36:39], v[136:139], v[108:111], v[36:39]
    ds_read_b64_tr_b16 v[182:183], v200 offset:12800
    v_mfma_f32_16x16x32_bf16 v[44:47], v[136:139], v[112:115], v[44:47]
    ds_read_b128 v[164:167], v197 offset:6144
    v_mfma_f32_16x16x32_bf16 v[52:55], v[136:139], v[116:119], v[52:55]
    ds_read_b64_tr_b16 v[184:185], v201 offset:12288
    v_mfma_f32_16x16x32_bf16 v[60:63], v[136:139], v[120:123], v[60:63]
    ds_read_b64_tr_b16 v[186:187], v201 offset:12800
    v_mfma_f32_16x16x32_bf16 v[100:103], v[136:139], v[124:127], v[100:103]
    ds_read_b128 v[168:171], v199
    v_mfma_f32_16x16x32_bf16 v[40:43], v[140:143], v[108:111], v[40:43]
    ds_read_b64_tr_b16 v[188:189], v200 offset:20480
    v_mfma_f32_16x16x32_bf16 v[48:51], v[140:143], v[112:115], v[48:51]
    ds_read_b64_tr_b16 v[190:191], v200 offset:20992
    v_mfma_f32_16x16x32_bf16 v[56:59], v[140:143], v[116:119], v[56:59]
    ds_read_b64_tr_b16 v[192:193], v201 offset:20480
    v_mfma_f32_16x16x32_bf16 v[64:67], v[140:143], v[120:123], v[64:67]
    ds_read_b64_tr_b16 v[194:195], v201 offset:20992
    v_mfma_f32_16x16x32_bf16 v[68:71], v[108:111], v[144:147], v[68:71]
    ds_read_b32 v1, v228 offset:24
    v_mfma_f32_16x16x32_bf16 v[76:79], v[112:115], v[144:147], v[76:79]
    s_add_u32 s34, s34, 41984
    s_cmp_eq_u32 s34, 125952
    v_mfma_f32_16x16x32_bf16 v[84:87], v[116:119], v[144:147], v[84:87]
    s_cselect_b32 s35, -83968, s37
    s_cselect_b32 s34, 0, s34
    v_mfma_f32_16x16x32_bf16 v[92:95], v[120:123], v[144:147], v[92:95]
    s_bitcmp1_b32 0x1002, s36
    v_add_u32 v196, s35, v196
    v_mfma_f32_16x16x32_bf16 v[104:107], v[124:127], v[144:147], v[104:107]
    v_add_u32 v197, s35, v197
    v_add_u32 v198, s35, v198
    v_mfma_f32_16x16x32_bf16 v[72:75], v[108:111], v[148:151], v[72:75]
    v_add_u32 v199, s35, v199
    v_add_u32 v200, s35, v200
    v_mfma_f32_16x16x32_bf16 v[80:83], v[112:115], v[148:151], v[80:83]
    v_add_u32 v201, s35, v201
    v_mfma_f32_16x16x32_bf16 v[88:91], v[116:119], v[148:151], v[88:91]
    s_waitcnt lgkmcnt(0)
    v_mfma_f32_16x16x32_bf16 v[96:99], v[120:123], v[148:151], v[96:99]
    s_cbranch_scc1 L_g1_rare
L_g1_bar:
    s_barrier
L_g1_nobar:
    v_mfma_f32_16x16x32_bf16 v[4:7], v[172:175], v[152:155], v[4:7]
    ds_read_b128 v[108:111], v196 offset:0
    v_mfma_f32_16x16x32_bf16 v[12:15], v[172:175], v[156:159], v[12:15]
    ds_read_b64_tr_b16 v[128:129], v200 offset:0
    v_mfma_f32_16x16x32_bf16 v[20:23], v[172:175], v[160:163], v[20:23]
    ds_read_b64_tr_b16 v[130:131], v200 offset:512
    v_mfma_f32_16x16x32_bf16 v[28:31], v[172:175], v[164:167], v[28:31]
    ds_read_b128 v[112:115], v196 offset:2048
    v_mfma_f32_16x16x32_bf16 v[8:11], v[176:179], v[152:155], v[8:11]
    ds_read_b64_tr_b16 v[132:133], v201 offset:0
    v_mfma_f32_16x16x32_bf16 v[16:19], v[176:179], v[156:159], v[16:19]
    ds_read_b64_tr_b16 v[134:135], v201 offset:512
    v_mfma_f32_16x16x32_bf16 v[24:27], v[176:179], v[160:163], v[24:27]
    ds_read_b128 v[116:119], v196 offset:4096
    v_mfma_f32_16x16x32_bf16 v[32:35], v[176:179], v[164:167], v[32:35]
    ds_read_b64_tr_b16 v[136:137], v200 offset:8192
    v_mfma_f32_16x16x32_bf16 v[36:39], v[180:183], v[152:155], v[36:39]
    ds_read_b64_tr_b16 v[138:139], v200 offset:8704
    v_mfma_f32_16x16x32_bf16 v[44:47], v[180:183], v[156:159], v[44:47]
    ds_read_b128 v[120:123], v196 offset:6144
    v_mfma_f32_16x16x32_bf16 v[52:55], v[180:183], v[160:163], v[52:55]
    ds_read_b64_tr_b16 v[140:141], v201 offset:8192
    v_mfma_f32_16x16x32_bf16 v[60:63], v[180:183], v[164:167], v[60:63]
    ds_read_b64_tr_b16 v[142:143], v201 offset:8704
    v_mfma_f32_16x16x32_bf16 v[100:103], v[180:183], v[168:171], v[100:103]
    ds_read_b128 v[124:127], v198
    v_mfma_f32_16x16x32_bf16 v[40:43], v[184:187], v[152:155], v[40:43]
    ds_read_b64_tr_b16 v[144:145], v200 offset:16384
    v_mfma_f32_16x16x32_bf16 v[48:51], v[184:187], v[156:159], v[48:51]
    ds_read_b64_tr_b16 v[146:147], v200 offset:16896
    v_mfma_f32_16x16x32_bf16 v[56:59], v[184:187], v[160:163], v[56:59]
    ds_read_b64_tr_b16 v[148:149], v201 offset:16384
    v_mfma_f32_16x16x32_bf16 v[64:67], v[184:187], v[164:167], v[64:67]
    ds_read_b64_tr_b16 v[150:151], v201 offset:16896
    v_mfma_f32_16x16x32_bf16 v[68:71], v[152:155], v[188:191], v[68:71]
    s_sub_u32 s36, s36, 1
    v_mfma_f32_16x16x32_bf16 v[76:79], v[156:159], v[188:191], v[76:79]
    s_cmp_lg_u32 s36, 0
    v_mfma_f32_16x16x32_bf16 v[84:87], v[160:163], v[188:191], v[84:87]
    v_mfma_f32_16x16x32_bf16 v[92:95], v[164:167], v[188:191], v[92:95]
    v_mfma_f32_16x16x32_bf16 v[104:107], v[168:171], v[188:191], v[104:107]
    v_mfma_f32_16x16x32_bf16 v[72:75], v[152:155], v[192:195], v[72:75]
    v_mfma_f32_16x16x32_bf16 v[80:83], v[156:159], v[192:195], v[80:83]
    v_mfma_f32_16x16x32_bf16 v[88:91], v[160:163], v[192:195], v[88:91]
    s_waitcnt lgkmcnt(0)
    v_mfma_f32_16x16x32_bf16 v[96:99], v[164:167], v[192:195], v[96:99]
    s_cbranch_scc1 L_g1_loop
    v_mfma_f32_16x16x32_bf16 v[4:7], v[128:131], v[108:111], v[4:7]
    ds_read_b128 v[152:155], v197 offset:0
    v_mfma_f32_16x16x32_bf16 v[12:15], v[128:131], v[112:115], v[12:15]
    ds_read_b64_tr_b16 v[172:173], v200 offset:4096
    v_mfma_f32_16x16x32_bf16 v[20:23], v[128:131], v[116:119], v[20:23]
    ds_read_b64_tr_b16 v[174:175], v200 offset:4608
    v_mfma_f32_16x16x32_bf16 v[28:31], v[128:131], v[120:123], v[28:31]
    ds_read_b128 v[156:159], v197 offset:2048
    v_mfma_f32_16x16x32_bf16 v[8:11], v[132:135], v[108:111], v[8:11]
    ds_read_b64_tr_b16 v[176:177], v201 offset:4096
    v_mfma_f32_16x16x32_bf16 v[16:19], v[132:135], v[112:115], v[16:19]
    ds_read_b64_tr_b16 v[178:179], v201 offset:4608
    v_mfma_f32_16x16x32_bf16 v[24:27], v[132:135], v[116:119], v[24:27]
    ds_read_b128 v[160:163], v197 offset:4096
    v_mfma_f32_16x16x32_bf16 v[32:35], v[132:135], v[120:123], v[32:35]
    ds_read_b64_tr_b16 v[180:181], v200 offset:12288
    v_mfma_f32_16x16x32_bf16 v[36:39], v[136:139], v[108:111], v[36:39]
    ds_read_b64_tr_b16 v[182:183], v200 offset:12800
    v_mfma_f32_16x16x32_bf16 v[44:47], v[136:139], v[112:115], v[44:47]
    ds_read_b128 v[164:167], v197 offset:6144
    v_mfma_f32_16x16x32_bf16 v[52:55], v[136:139], v[116:119], v[52:55]
    ds_read_b64_tr_b16 v[184:185], v201 offset:12288
    v_mfma_f32_16x16x32_bf16 v[60:63], v[136:139], v[120:123], v[60:63]
    ds_read_b64_tr_b16 v[186:187], v201 offset:12800
    v_mfma_f32_16x16x32_bf16 v[100:103], v[136:139], v[124:127], v[100:103]
    ds_read_b128 v[168:171], v199
    v_mfma_f32_16x16x32_bf16 v[40:43], v[140:143], v[108:111], v[40:43]
    ds_read_b64_tr_b16 v[188:189], v200 offset:20480
    v_mfma_f32_16x16x32_bf16 v[48:51], v[140:143], v[112:115], v[48:51]
    ds_read_b64_tr_b16 v[190:191], v200 offset:20992
    v_mfma_f32_16x16x32_bf16 v[56:59], v[140:143], v[116:119], v[56:59]
    ds_read_b64_tr_b16 v[192:193], v201 offset:20480
    v_mfma_f32_16x16x32_bf16 v[64:67], v[140:143], v[120:123], v[64:67]
    ds_read_b64_tr_b16 v[194:195], v201 offset:20992
    v_mfma_f32_16x16x32_bf16 v[68:71], v[108:111], v[144:147], v[68:71]
    v_mfma_f32_16x16x32_bf16 v[76:79], v[112:115], v[144:147], v[76:79]
    v_mfma_f32_16x16x32_bf16 v[84:87], v[116:119], v[144:147], v[84:87]
    v_mfma_f32_16x16x32_bf16 v[92:95], v[120:123], v[144:147], v[92:95]
    v_mfma_f32_16x16x32_bf16 v[104:107], v[124:127], v[144:147], v[104:107]
    v_mfma_f32_16x16x32_bf16 v[72:75], v[108:111], v[148:151], v[72:75]
    v_mfma_f32_16x16x32_bf16 v[80:83], v[112:115], v[148:151], v[80:83]
    v_mfma_f32_16x16x32_bf16 v[88:91], v[116:119], v[148:151], v[88:91]
    v_mfma_f32_16x16x32_bf16 v[96:99], v[120:123], v[148:151], v[96:99]
    s_waitcnt lgkmcnt(0)
    s_setprio 2
    v_mov_b32 v2, 1
    v_mfma_f32_16x16x32_bf16 v[100:103], v[180:183], v[168:171], v[100:103]
    v_mfma_f32_16x16x32_bf16 v[104:107], v[168:171], v[188:191], v[104:107]
    v_mfma_f32_16x16x32_bf16 v[60:63], v[180:183], v[164:167], v[60:63]
    v_mfma_f32_16x16x32_bf16 v[64:67], v[184:187], v[164:167], v[64:67]
    v_mfma_f32_16x16x32_bf16 v[92:95], v[164:167], v[188:191], v[92:95]
    v_mfma_f32_16x16x32_bf16 v[96:99], v[164:167], v[192:195], v[96:99]
    v_mfma_f32_16x16x32_bf16 v[28:31], v[172:175], v[164:167], v[28:31]
    v_mfma_f32_16x16x32_bf16 v[32:35], v[176:179], v[164:167], v[32:35]
    v_mfma_f32_16x16x32_bf16 v[52:55], v[180:183], v[160:163], v[52:55]
    v_cvt_pk_bf16_f32 v144, v100, v101
    v_cvt_pk_bf16_f32 v145, v102, v103
    v_mfma_f32_16x16x32_bf16 v[56:59], v[184:187], v[160:163], v[56:59]
    ds_write_b64 v219, v[144:145]
    v_cvt_pk_bf16_f32 v146, v104, v105
    v_mfma_f32_16x16x32_bf16 v[20:23], v[172:175], v[160:163], v[20:23]
    v_cvt_pk_bf16_f32 v147, v106, v107
    ds_write_b64 v219, v[146:147] offset:1024
    v_mfma_f32_16x16x32_bf16 v[24:27], v[176:179], v[160:163], v[24:27]
    v_cvt_pk_bf16_f32 v140, v60, v61
    v_cvt_pk_bf16_f32 v141, v62, v63
    v_mfma_f32_16x16x32_bf16 v[44:47], v[180:183], v[156:159], v[44:47]
    v_cvt_pk_bf16_f32 v142, v64, v65
    v_cvt_pk_bf16_f32 v143, v66, v67
    v_mfma_f32_16x16x32_bf16 v[48:51], v[184:187], v[156:159], v[48:51]
    v_cvt_pk_bf16_f32 v238, v92, v93
    v_cvt_pk_bf16_f32 v239, v94, v95
    v_mfma_f32_16x16x32_bf16 v[12:15], v[172:175], v[156:159], v[12:15]
    v_cvt_pk_bf16_f32 v248, v96, v97
    v_cvt_pk_bf16_f32 v249, v98, v99
    v_mfma_f32_16x16x32_bf16 v[16:19], v[176:179], v[156:159], v[16:19]
    s_cmp_eq_u32 s33, 0
    s_cbranch_scc0 L_at_nopub
    ds_write_b64 v220, v[140:141] offset:2048
    ds_write_b64 v220, v[238:239] offset:3072
    ds_write_b64 v220, v[142:143] offset:2560
    ds_write_b64 v220, v[248:249] offset:3584
L_at_nopub:
    s_mov_b64 exec, 1
    ds_add_u32 v228, v2 offset:20
    s_mov_b64 exec, -1
    v_cvt_pk_bf16_f32 v120, v28, v29
    v_mfma_f32_16x16x32_bf16 v[36:39], v[180:183], v[152:155], v[36:39]
    v_cvt_pk_bf16_f32 v121, v30, v31
    v_cvt_pk_bf16_f32 v122, v32, v33
    v_mfma_f32_16x16x32_bf16 v[40:43], v[184:187], v[152:155], v[40:43]
    v_cvt_pk_bf16_f32 v123, v34, v35
    v_cvt_pk_bf16_f32 v136, v52, v53
    v_mfma_f32_16x16x32_bf16 v[4:7], v[172:175], v[152:155], v[4:7]
    v_cvt_pk_bf16_f32 v137, v54, v55
    v_cvt_pk_bf16_f32 v138, v56, v57
    v_mfma_f32_16x16x32_bf16 v[8:11], v[176:179], v[152:155], v[8:11]
    v_cvt_pk_bf16_f32 v139, v58, v59
    v_cvt_pk_bf16_f32 v116, v20, v21
    v_mfma_f32_16x16x32_bf16 v[84:87], v[160:163], v[188:191], v[84:87]
    v_cvt_pk_bf16_f32 v117, v22, v23
    v_cvt_pk_bf16_f32 v118, v24, v25
    v_mfma_f32_16x16x32_bf16 v[88:91], v[160:163], v[192:195], v[88:91]
    v_cvt_pk_bf16_f32 v119, v26, v27
    v_cvt_pk_bf16_f32 v132, v44, v45
    v_mfma_f32_16x16x32_bf16 v[76:79], v[156:159], v[188:191], v[76:79]
    v_cvt_pk_bf16_f32 v133, v46, v47
    v_cvt_pk_bf16_f32 v134, v48, v49
    v_mfma_f32_16x16x32_bf16 v[80:83], v[156:159], v[192:195], v[80:83]
    v_cvt_pk_bf16_f32 v135, v50, v51
    v_cvt_pk_bf16_f32 v112, v12, v13
    v_mfma_f32_16x16x32_bf16 v[68:71], v[152:155], v[188:191], v[68:71]
    v_cvt_pk_bf16_f32 v113, v14, v15
    v_cvt_pk_bf16_f32 v114, v16, v17
    v_mfma_f32_16x16x32_bf16 v[72:75], v[152:155], v[192:195], v[72:75]
    v_cvt_pk_bf16_f32 v115, v18, v19
    v_cvt_pk_bf16_f32 v128, v36, v37
    v_mfma_f32_16x16x32_bf16 v[28:31], v[140:143], v[120:123], v[204:207]
    v_cvt_pk_bf16_f32 v129, v38, v39
    v_cvt_pk_bf16_f32 v130, v40, v41
    v_mfma_f32_16x16x32_bf16 v[32:35], v[136:139], v[120:123], v[208:211]
    v_cvt_pk_bf16_f32 v131, v42, v43
    v_cvt_pk_bf16_f32 v108, v4, v5
    v_mfma_f32_16x16x32_bf16 v[20:23], v[136:139], v[116:119], v[204:207]
    v_cvt_pk_bf16_f32 v109, v6, v7
    v_cvt_pk_bf16_f32 v110, v8, v9
    v_mfma_f32_16x16x32_bf16 v[24:27], v[132:135], v[116:119], v[208:211]
    v_cvt_pk_bf16_f32 v111, v10, v11
    v_cvt_pk_bf16_f32 v236, v84, v85
    v_mfma_f32_16x16x32_bf16 v[12:15], v[132:135], v[112:115], v[204:207]
    v_cvt_pk_bf16_f32 v237, v86, v87
    v_cvt_pk_bf16_f32 v246, v88, v89
    v_mfma_f32_16x16x32_bf16 v[16:19], v[128:131], v[112:115], v[208:211]
    v_cvt_pk_bf16_f32 v247, v90, v91
    v_cvt_pk_bf16_f32 v234, v76, v77
    v_mfma_f32_16x16x32_bf16 v[4:7], v[128:131], v[108:111], v[204:207]
    v_cvt_pk_bf16_f32 v235, v78, v79
    ds_read_b32 v1, v228 offset:20
    v_cvt_pk_bf16_f32 v244, v80, v81
    v_cvt_pk_bf16_f32 v245, v82, v83
    v_cvt_pk_bf16_f32 v232, v68, v69
    v_cvt_pk_bf16_f32 v233, v70, v71
    v_cvt_pk_bf16_f32 v242, v72, v73
    v_cvt_pk_bf16_f32 v243, v74, v75
    s_waitcnt lgkmcnt(0)
    v_readfirstlane_b32 s37, v1
    s_nop 0
    s_cmp_ge_u32 s37, 4
    s_cbranch_scc1 L_sl_done_42
    s_mov_b32 s38, 1048576
L_sl_loop_43:
    ds_read_b32 v1, v228 offset:20
    s_waitcnt lgkmcnt(0)
    v_readfirstlane_b32 s37, v1
    s_nop 0
    s_cmp_ge_u32 s37, 4
    s_cbranch_scc1 L_sl_done_42
    s_sleep 1
    s_sub_u32 s38, s38, 1
    s_cbranch_scc0 L_sl_loop_43
L_sl_done_42:
    ds_read_b64 v[124:125], v221
    ds_read_b64 v[126:127], v222
    ds_read_b64 v[230:231], v221 offset:1024
    ds_read_b64 v[240:241], v222 offset:1024
    v_max_f32 v28, v28, v32
    v_max_f32 v29, v29, v33
    v_max_f32 v30, v30, v34
    v_max_f32 v31, v31, v35
    v_max3_f32 v39, v28, v29, v30
    v_max_f32 v39, v39, v31
    v_max_f32 v20, v20, v24
    v_max_f32 v21, v21, v25
    v_max_f32 v22, v22, v26
    v_max_f32 v23, v23, v27
    v_max3_f32 v38, v20, v21, v22
    v_max_f32 v38, v38, v23
    s_waitcnt lgkmcnt(2)
    v_mfma_f32_16x16x32_bf16 v[8:11], v[124:127], v[108:111], v[212:215]
    s_setprio 2
    s_mov_b32 s37, 0x3e8293ee
    v_max_f32 v12, v12, v16
    v_max_f32 v13, v13, v17
    v_max_f32 v14, v14, v18
    v_max_f32 v15, v15, v19
    v_max3_f32 v37, v12, v13, v14
    v_max_f32 v37, v37, v15
    v_max_f32 v4, v4, v8
    v_max_f32 v5, v5, v9
    v_max_f32 v6, v6, v10
    v_max_f32 v7, v7, v11
    v_max3_f32 v36, v4, v5, v6
    v_max_f32 v36, v36, v7
    v_permlane32_swap_b32 v38, v39
    s_nop 0
    v_permlane32_swap_b32 v36, v37
    v_max_f32 v38, v38, v39
    v_max_f32 v36, v36, v37
    s_nop 1
    v_permlane16_swap_b32 v36, v38
    v_max_f32 v36, v36, v38
    v_mul_f32 v38, s37, v36
    v_mul_f32 v36, s37, v36
    s_nop 1
    v_permlane16_swap_b32 v36, v38
    v_mov_b32 v37, v36
    v_mov_b32 v39, v38
    s_nop 0
    v_permlane32_swap_b32 v36, v37
    v_permlane32_swap_b32 v38, v39
    v_fma_f32 v4, v4, s37, -v36
    v_fma_f32 v5, v5, s37, -v36
    v_fma_f32 v6, v6, s37, -v36
    v_fma_f32 v7, v7, s37, -v36
    v_fma_f32 v12, v12, s37, -v37
    v_fma_f32 v13, v13, s37, -v37
    v_fma_f32 v14, v14, s37, -v37
    v_fma_f32 v15, v15, s37, -v37
    v_fma_f32 v20, v20, s37, -v38
    v_fma_f32 v21, v21, s37, -v38
    v_fma_f32 v22, v22, s37, -v38
    v_fma_f32 v23, v23, s37, -v38
    v_fma_f32 v28, v28, s37, -v39
    v_fma_f32 v29, v29, s37, -v39
    v_fma_f32 v30, v30, s37, -v39
    v_fma_f32 v31, v31, s37, -v39
    v_exp_f32 v28, v28
    v_exp_f32 v29, v29
    v_exp_f32 v30, v30
    v_exp_f32 v31, v31
    v_exp_f32 v20, v20
    v_exp_f32 v21, v21
    v_exp_f32 v22, v22
    v_exp_f32 v23, v23
    v_exp_f32 v12, v12
    v_exp_f32 v13, v13
    v_exp_f32 v14, v14
    v_exp_f32 v15, v15
    v_exp_f32 v4, v4
    v_exp_f32 v5, v5
    v_exp_f32 v6, v6
    v_exp_f32 v7, v7
    v_add_f32 v39, v28, v29
    v_add_f32 v32, v30, v31
    v_add_f32 v39, v39, v32
    v_add_f32 v38, v20, v21
    v_add_f32 v24, v22, v23
    v_add_f32 v38, v38, v24
    v_add_f32 v37, v12, v13
    v_add_f32 v16, v14, v15
    v_add_f32 v37, v37, v16
    v_add_f32 v36, v4, v5
    v_add_f32 v8, v6, v7
    v_add_f32 v36, v36, v8
    v_permlane32_swap_b32 v38, v39
    s_nop 0
    v_permlane32_swap_b32 v36, v37
    v_add_f32 v38, v38, v39
    v_add_f32 v36, v36, v37
    s_nop 1
    v_permlane16_swap_b32 v36, v38
    v_add_f32 v36, v36, v38
    v_rcp_f32 v38, v36
    v_rcp_f32 v36, v36
    s_nop 1
    v_permlane16_swap_b32 v36, v38
    v_mov_b32 v37, v36
    v_mov_b32 v39, v38
    s_nop 0
    v_permlane32_swap_b32 v36, v37
    v_permlane32_swap_b32 v38, v39
    s_waitcnt lgkmcnt(0)
    s_cmp_eq_u32 s33, 0
    v_mul_f32 v4, v4, v36
    v_mul_f32 v5, v5, v36
    v_mul_f32 v6, v6, v36
    v_mul_f32 v7, v7, v36
    v_cvt_pk_bf16_f32 v10, v4, v5
    v_cvt_pk_bf16_f32 v11, v6, v7
    v_and_b32 v8, v216, v10
    v_and_b32 v9, v217, v11
    v_xor_b32 v10, v8, v10
    v_xor_b32 v11, v9, v11
    s_setprio 2
    s_nop 0
    v_mfma_f32_16x16x32_bf16 v[68:71], v[230:233], v[8:11], 0
    v_mfma_f32_16x16x32_bf16 v[72:75], v[240:243], v[8:11], 0
    s_setprio 2
    v_mul_f32 v12, v12, v37
    v_mul_f32 v13, v13, v37
    v_mul_f32 v14, v14, v37
    v_mul_f32 v15, v15, v37
    v_cvt_pk_bf16_f32 v18, v12, v13
    v_cvt_pk_bf16_f32 v19, v14, v15
    v_and_b32 v16, v216, v18
    v_and_b32 v17, v217, v19
    v_xor_b32 v18, v16, v18
    v_xor_b32 v19, v17, v19
    v_cvt_pk_bf16_f32 v108, v68, v69
    v_cvt_pk_bf16_f32 v109, v70, v71
    v_cvt_pk_bf16_f32 v110, v72, v73
    v_cvt_pk_bf16_f32 v111, v74, v75
    s_cbranch_scc1 L_at_noswap0
    v_swap_b32 v108, v110
    v_swap_b32 v109, v111
L_at_noswap0:
    s_mov_b32 s37, 0
    buffer_store_dwordx4 v[108:111], v218, s[40:43], s37 offen sc1
    s_setprio 2
    v_mfma_f32_16x16x32_bf16 v[76:79], v[232:235], v[16:19], 0
    v_mfma_f32_16x16x32_bf16 v[80:83], v[242:245], v[16:19], 0
    s_setprio 2
    v_mul_f32 v20, v20, v38
    v_mul_f32 v21, v21, v38
    v_mul_f32 v22, v22, v38
    v_mul_f32 v23, v23, v38
    v_cvt_pk_bf16_f32 v26, v20, v21
    v_cvt_pk_bf16_f32 v27, v22, v23
    v_and_b32 v24, v216, v26
    v_and_b32 v25, v217, v27
    v_xor_b32 v26, v24, v26
    v_xor_b32 v27, v25, v27
    v_cvt_pk_bf16_f32 v112, v76, v77
    v_cvt_pk_bf16_f32 v113, v78, v79
    v_cvt_pk_bf16_f32 v114, v80, v81
    v_cvt_pk_bf16_f32 v115, v82, v83
    s_cbranch_scc1 L_at_noswap1
    v_swap_b32 v112, v114
    v_swap_b32 v113, v115
L_at_noswap1:
    s_mov_b32 s37, 32768
    buffer_store_dwordx4 v[112:115], v218, s[40:43], s37 offen sc1
    s_setprio 2
    v_mfma_f32_16x16x32_bf16 v[84:87], v[234:237], v[24:27], 0
    v_mfma_f32_16x16x32_bf16 v[88:91], v[244:247], v[24:27], 0
    s_setprio 2
    v_mul_f32 v28, v28, v39
    v_mul_f32 v29, v29, v39
    v_mul_f32 v30, v30, v39
    v_mul_f32 v31, v31, v39
    v_cvt_pk_bf16_f32 v34, v28, v29
    v_cvt_pk_bf16_f32 v35, v30, v31
    v_and_b32 v32, v216, v34
    v_and_b32 v33, v217, v35
    v_xor_b32 v34, v32, v34
    v_xor_b32 v35, v33, v35
    v_cvt_pk_bf16_f32 v116, v84, v85
    v_cvt_pk_bf16_f32 v117, v86, v87
    v_cvt_pk_bf16_f32 v118, v88, v89
    v_cvt_pk_bf16_f32 v119, v90, v91
    s_cbranch_scc1 L_at_noswap2
    v_swap_b32 v116, v118
    v_swap_b32 v117, v119
L_at_noswap2:
    s_mov_b32 s37, 65536
    buffer_store_dwordx4 v[116:119], v218, s[40:43], s37 offen sc1
    s_setprio 2
    v_mfma_f32_16x16x32_bf16 v[92:95], v[236:239], v[32:35], 0
    v_mfma_f32_16x16x32_bf16 v[96:99], v[246:249], v[32:35], 0
    s_setprio 2
    s_nop 5
    v_cvt_pk_bf16_f32 v120, v92, v93
    v_cvt_pk_bf16_f32 v121, v94, v95
    v_cvt_pk_bf16_f32 v122, v96, v97
    v_cvt_pk_bf16_f32 v123, v98, v99
    s_cbranch_scc1 L_at_noswap3
    v_swap_b32 v120, v122
    v_swap_b32 v121, v123
L_at_noswap3:
    s_mov_b32 s37, 98304
    buffer_store_dwordx4 v[120:123], v218, s[40:43], s37 offen sc1
    s_setprio 0
    s_add_u32 m0, s60, 0
    s_add_u32 s63, s62, 0
    s_and_b32 s63, s63, 0x1fffff
    buffer_load_dwordx4 v227, s[44:47], s63 offen lds
    s_add_u32 m0, s60, 1024
    s_add_u32 s63, s62, 16384
    s_and_b32 s63, s63, 0x1fffff
    buffer_load_dwordx4 v227, s[44:47], s63 offen lds
    s_add_u32 m0, s60, 8192
    s_add_u32 s63, s62, 131072
    s_and_b32 s63, s63, 0x1fffff
    buffer_load_dwordx4 v227, s[44:47], s63 offen lds
    s_add_u32 m0, s60, 9216
    s_add_u32 s63, s62, 147456
    s_and_b32 s63, s63, 0x1fffff
    buffer_load_dwordx4 v227, s[44:47], s63 offen lds
    s_add_u32 m0, s60, 16384
    s_add_u32 s63, s62, 262144
    s_and_b32 s63, s63, 0x1fffff
    buffer_load_dwordx4 v227, s[44:47], s63 offen lds
    s_add_u32 m0, s60, 17408
    s_add_u32 s63, s62, 278528
    s_and_b32 s63, s63, 0x1fffff
    buffer_load_dwordx4 v227, s[44:47], s63 offen lds
    v_xor_b32 v84, 0, v229
    v_xor_b32 v85, 32, v229
    v_xor_b32 v86, 64, v229
    v_xor_b32 v87, 96, v229
    v_add_u32 v88, 83968, v84
    v_add_u32 v89, 83968, v85
    v_add_u32 v90, 83968, v86
    v_add_u32 v91, 83968, v87
    v_add_u32 v92, 125952, v84
    v_add_u32 v93, 125952, v85
    v_add_u32 v94, 125952, v86
    v_add_u32 v95, 125952, v87
    s_add_u32 s64, s61, 0
    s_and_b32 s64, s64, 7
    s_lshl_b32 s64, s64, 12
    s_add_u32 s65, s61, 1
    s_and_b32 s65, s65, 7
    s_lshl_b32 s65, s65, 12
    s_add_u32 s66, s61, 2
    s_and_b32 s66, s66, 7
    s_lshl_b32 s66, s66, 12
    s_add_u32 s67, s61, 3
    s_and_b32 s67, s67, 7
    s_lshl_b32 s67, s67, 12
    s_add_u32 s68, s61, 4
    s_and_b32 s68, s68, 7
    s_lshl_b32 s68, s68, 12
    s_add_u32 s69, s61, 5
    s_and_b32 s69, s69, 7
    s_lshl_b32 s69, s69, 12
    s_add_u32 s70, s61, 6
    s_and_b32 s70, s70, 7
    s_lshl_b32 s70, s70, 12
    s_add_u32 s71, s61, 7
    s_and_b32 s71, s71, 7
    s_lshl_b32 s71, s71, 12
    s_waitcnt vmcnt(6)
    s_setprio 2
    v_mov_b32 v2, 1
    s_mov_b64 exec, 1
    ds_add_rtn_u32 v1, v228, v2 offset:0
    s_waitcnt lgkmcnt(0)
    v_readfirstlane_b32 s39, v1
    s_nop 0
    s_cmp_eq_u32 s39, 3
    s_cbranch_scc0 L_jo_44a
    s_mov_b64 exec, 0xffff
    v_lshlrev_b32 v1, 8, v0
    buffer_atomic_add v2, v1, s[52:55], s56 offen sc1
L_jo_44a:
    s_mov_b64 exec, -1
    s_setprio 0
    s_add_u32 m0, s60, 24576
    s_add_u32 s63, s62, 393216
    s_and_b32 s63, s63, 0x1fffff
    buffer_load_dwordx4 v227, s[44:47], s63 offen lds
    s_add_u32 m0, s60, 25600
    s_add_u32 s63, s62, 409600
    s_and_b32 s63, s63, 0x1fffff
    buffer_load_dwordx4 v227, s[44:47], s63 offen lds
    s_add_u32 m0, s60, 32768
    s_add_u32 s63, s62, 524288
    s_and_b32 s63, s63, 0x1fffff
    buffer_load_dwordx4 v227, s[44:47], s63 offen lds
    s_add_u32 m0, s60, 33792
    s_add_u32 s63, s62, 540672
    s_and_b32 s63, s63, 0x1fffff
    buffer_load_dwordx4 v227, s[44:47], s63 offen lds
    s_add_u32 m0, s60, 83968
    s_add_u32 s63, s62, 655360
    s_and_b32 s63, s63, 0x1fffff
    buffer_load_dwordx4 v227, s[44:47], s63 offen lds
    s_add_u32 m0, s60, 84992
    s_add_u32 s63, s62, 671744
    s_and_b32 s63, s63, 0x1fffff
    buffer_load_dwordx4 v227, s[44:47], s63 offen lds
    s_add_u32 m0, s60, 92160
    s_add_u32 s63, s62, 786432
    s_and_b32 s63, s63, 0x1fffff
    buffer_load_dwordx4 v227, s[44:47], s63 offen lds
    s_add_u32 m0, s60, 93184
    s_add_u32 s63, s62, 802816
    s_and_b32 s63, s63, 0x1fffff
    buffer_load_dwordx4 v227, s[44:47], s63 offen lds
    s_add_u32 m0, s60, 100352
    s_add_u32 s63, s62, 917504
    s_and_b32 s63, s63, 0x1fffff
    buffer_load_dwordx4 v227, s[44:47], s63 offen lds
    s_add_u32 m0, s60, 101376
    s_add_u32 s63, s62, 933888
    s_and_b32 s63, s63, 0x1fffff
    buffer_load_dwordx4 v227, s[44:47], s63 offen lds
    s_add_u32 m0, s60, 108544
    s_add_u32 s63, s62, 1048576
    s_and_b32 s63, s63, 0x1fffff
    buffer_load_dwordx4 v227, s[44:47], s63 offen lds
    s_add_u32 m0, s60, 109568
    s_add_u32 s63, s62, 1064960
    s_and_b32 s63, s63, 0x1fffff
    buffer_load_dwordx4 v227, s[44:47], s63 offen lds
    s_add_u32 m0, s60, 116736
    s_add_u32 s63, s62, 1179648
    s_and_b32 s63, s63, 0x1fffff
    buffer_load_dwordx4 v227, s[44:47], s63 offen lds
    s_add_u32 m0, s60, 117760
    s_add_u32 s63, s62, 1196032
    s_and_b32 s63, s63, 0x1fffff
    buffer_load_dwordx4 v227, s[44:47], s63 offen lds
    s_setprio 0
    s_cmp_eq_u32 s39, 3
    s_cbranch_scc0 L_jo_44
    s_mov_b32 s38, 131072
L_sg_loop_47:
    s_load_dword s37, s[52:53], s57 glc
L_sg_chk_48:
    s_waitcnt lgkmcnt(0)
    s_cmp_ge_u32 s37, 16
    s_cbranch_scc1 L_sg_done_46
    s_sub_u32 s38, s38, 1
    s_cbranch_scc0 L_sg_loop_47
L_sg_done_46:
    v_mov_b32 v1, 16
    s_mov_b64 exec, 1
    ds_add_u32 v228, v1 offset:4
    s_mov_b64 exec, -1
L_jo_44:
    s_waitcnt vmcnt(0)
    s_mov_b64 exec, 1
    ds_add_u32 v228, v2 offset:4
    s_mov_b64 exec, -1
    s_mov_b32 s38, 1048576
L_sl_loop_50:
    ds_read_b32 v1, v228 offset:4
    s_waitcnt lgkmcnt(0)
    v_readfirstlane_b32 s37, v1
    s_nop 0
    s_cmp_ge_u32 s37, 20
    s_cbranch_scc1 L_sl_done_49
    s_sleep 1
    s_sub_u32 s38, s38, 1
    s_cbranch_scc0 L_sl_loop_50
L_sl_done_49:
L_jd_45:
    buffer_load_dwordx4 v[96:99], v224, s[40:43], s64 offen offset:0 sc1
    buffer_load_dwordx4 v[100:103], v225, s[40:43], s64 offen offset:0 sc1
    ds_read_b64_tr_b16 v[36:37], v84 offset:0
    ds_read_b64_tr_b16 v[38:39], v84 offset:2048
    buffer_load_dwordx4 v[104:107], v224, s[40:43], s64 offen offset:1024 sc1
    buffer_load_dwordx4 v[108:111], v225, s[40:43], s64 offen offset:1024 sc1
    ds_read_b64_tr_b16 v[40:41], v85 offset:0
    ds_read_b64_tr_b16 v[42:43], v85 offset:2048
    buffer_load_dwordx4 v[112:115], v224, s[40:43], s64 offen offset:2048 sc1
    buffer_load_dwordx4 v[116:119], v225, s[40:43], s64 offen offset:2048 sc1
    ds_read_b64_tr_b16 v[44:45], v86 offset:0
    ds_read_b64_tr_b16 v[46:47], v86 offset:2048
    buffer_load_dwordx4 v[120:123], v224, s[40:43], s64 offen offset:3072 sc1
    buffer_load_dwordx4 v[124:127], v225, s[40:43], s64 offen offset:3072 sc1
    ds_read_b64_tr_b16 v[48:49], v87 offset:0
    ds_read_b64_tr_b16 v[50:51], v87 offset:2048
    buffer_load_dwordx4 v[128:131], v224, s[40:43], s65 offen offset:0 sc1
    buffer_load_dwordx4 v[132:135], v225, s[40:43], s65 offen offset:0 sc1
    ds_read_b64_tr_b16 v[52:53], v84 offset:4096
    ds_read_b64_tr_b16 v[54:55], v84 offset:6144
    buffer_load_dwordx4 v[136:139], v224, s[40:43], s65 offen offset:1024 sc1
    buffer_load_dwordx4 v[140:143], v225, s[40:43], s65 offen offset:1024 sc1
    ds_read_b64_tr_b16 v[56:57], v85 offset:4096
    ds_read_b64_tr_b16 v[58:59], v85 offset:6144
    buffer_load_dwordx4 v[144:147], v224, s[40:43], s65 offen offset:2048 sc1
    buffer_load_dwordx4 v[148:151], v225, s[40:43], s65 offen offset:2048 sc1
    ds_read_b64_tr_b16 v[60:61], v86 offset:4096
    ds_read_b64_tr_b16 v[62:63], v86 offset:6144
    buffer_load_dwordx4 v[152:155], v224, s[40:43], s65 offen offset:3072 sc1
    buffer_load_dwordx4 v[156:159], v225, s[40:43], s65 offen offset:3072 sc1
    s_waitcnt lgkmcnt(12)
    ds_read_b64_tr_b16 v[64:65], v87 offset:4096
    ds_read_b64_tr_b16 v[66:67], v87 offset:6144
    s_waitcnt vmcnt(14) lgkmcnt(8)
    v_mfma_f32_16x16x32_bf16 v[4:7], v[36:39], v[96:99], 0
    ds_read_b64_tr_b16 v[68:69], v84 offset:8192
    v_mfma_f32_16x16x32_bf16 v[20:23], v[36:39], v[100:103], 0
    ds_read_b64_tr_b16 v[70:71], v84 offset:10240
    v_mfma_f32_16x16x32_bf16 v[8:11], v[40:43], v[96:99], 0
    ds_read_b64_tr_b16 v[36:37], v85 offset:8192
    v_mfma_f32_16x16x32_bf16 v[24:27], v[40:43], v[100:103], 0
    ds_read_b64_tr_b16 v[38:39], v85 offset:10240
    buffer_load_dwordx4 v[160:163], v224, s[40:43], s66 offen offset:0 sc1
    v_mfma_f32_16x16x32_bf16 v[12:15], v[44:47], v[96:99], 0
    ds_read_b64_tr_b16 v[40:41], v86 offset:8192
    v_mfma_f32_16x16x32_bf16 v[28:31], v[44:47], v[100:103], 0
    ds_read_b64_tr_b16 v[42:43], v86 offset:10240
    v_mfma_f32_16x16x32_bf16 v[16:19], v[48:51], v[96:99], 0
    ds_read_b64_tr_b16 v[44:45], v87 offset:8192
    v_mfma_f32_16x16x32_bf16 v[32:35], v[48:51], v[100:103], 0
    ds_read_b64_tr_b16 v[46:47], v87 offset:10240
    buffer_load_dwordx4 v[164:167], v225, s[40:43], s66 offen offset:0 sc1
    s_waitcnt vmcnt(14) lgkmcnt(8)
    v_mfma_f32_16x16x32_bf16 v[4:7], v[52:55], v[104:107], v[4:7]
    ds_read_b64_tr_b16 v[48:49], v84 offset:12288
    v_mfma_f32_16x16x32_bf16 v[20:23], v[52:55], v[108:111], v[20:23]
    ds_read_b64_tr_b16 v[50:51], v84 offset:14336
    v_mfma_f32_16x16x32_bf16 v[8:11], v[56:59], v[104:107], v[8:11]
    ds_read_b64_tr_b16 v[52:53], v85 offset:12288
    v_mfma_f32_16x16x32_bf16 v[24:27], v[56:59], v[108:111], v[24:27]
    ds_read_b64_tr_b16 v[54:55], v85 offset:14336
    buffer_load_dwordx4 v[96:99], v224, s[40:43], s66 offen offset:1024 sc1
    v_mfma_f32_16x16x32_bf16 v[12:15], v[60:63], v[104:107], v[12:15]
    ds_read_b64_tr_b16 v[56:57], v86 offset:12288
    v_mfma_f32_16x16x32_bf16 v[28:31], v[60:63], v[108:111], v[28:31]
    ds_read_b64_tr_b16 v[58:59], v86 offset:14336
    v_mfma_f32_16x16x32_bf16 v[16:19], v[64:67], v[104:107], v[16:19]
    ds_read_b64_tr_b16 v[60:61], v87 offset:12288
    v_mfma_f32_16x16x32_bf16 v[32:35], v[64:67], v[108:111], v[32:35]
    ds_read_b64_tr_b16 v[62:63], v87 offset:14336
    buffer_load_dwordx4 v[100:103], v225, s[40:43], s66 offen offset:1024 sc1
    s_waitcnt vmcnt(14) lgkmcnt(8)
    v_mfma_f32_16x16x32_bf16 v[4:7], v[68:71], v[112:115], v[4:7]
    ds_read_b64_tr_b16 v[64:65], v84 offset:16384
    v_mfma_f32_16x16x32_bf16 v[20:23], v[68:71], v[116:119], v[20:23]
    ds_read_b64_tr_b16 v[66:67], v84 offset:18432
    v_mfma_f32_16x16x32_bf16 v[8:11], v[36:39], v[112:115], v[8:11]
    ds_read_b64_tr_b16 v[68:69], v85 offset:16384
    v_mfma_f32_16x16x32_bf16 v[24:27], v[36:39], v[116:119], v[24:27]
    ds_read_b64_tr_b16 v[70:71], v85 offset:18432
    buffer_load_dwordx4 v[104:107], v224, s[40:43], s66 offen offset:2048 sc1
    v_mfma_f32_16x16x32_bf16 v[12:15], v[40:43], v[112:115], v[12:15]
    ds_read_b64_tr_b16 v[36:37], v86 offset:16384
    v_mfma_f32_16x16x32_bf16 v[28:31], v[40:43], v[116:119], v[28:31]
    ds_read_b64_tr_b16 v[38:39], v86 offset:18432
    v_mfma_f32_16x16x32_bf16 v[16:19], v[44:47], v[112:115], v[16:19]
    ds_read_b64_tr_b16 v[40:41], v87 offset:16384
    v_mfma_f32_16x16x32_bf16 v[32:35], v[44:47], v[116:119], v[32:35]
    ds_read_b64_tr_b16 v[42:43], v87 offset:18432
    buffer_load_dwordx4 v[108:111], v225, s[40:43], s66 offen offset:2048 sc1
    s_waitcnt vmcnt(14) lgkmcnt(8)
    v_mfma_f32_16x16x32_bf16 v[4:7], v[48:51], v[120:123], v[4:7]
    ds_read_b64_tr_b16 v[44:45], v84 offset:20480
    v_mfma_f32_16x16x32_bf16 v[20:23], v[48:51], v[124:127], v[20:23]
    ds_read_b64_tr_b16 v[46:47], v84 offset:22528
    v_mfma_f32_16x16x32_bf16 v[8:11], v[52:55], v[120:123], v[8:11]
    ds_read_b64_tr_b16 v[48:49], v85 offset:20480
    v_mfma_f32_16x16x32_bf16 v[24:27], v[52:55], v[124:127], v[24:27]
    ds_read_b64_tr_b16 v[50:51], v85 offset:22528
    buffer_load_dwordx4 v[112:115], v224, s[40:43], s66 offen offset:3072 sc1
    v_mfma_f32_16x16x32_bf16 v[12:15], v[56:59], v[120:123], v[12:15]
    ds_read_b64_tr_b16 v[52:53], v86 offset:20480
    v_mfma_f32_16x16x32_bf16 v[28:31], v[56:59], v[124:127], v[28:31]
    ds_read_b64_tr_b16 v[54:55], v86 offset:22528
    v_mfma_f32_16x16x32_bf16 v[16:19], v[60:63], v[120:123], v[16:19]
    ds_read_b64_tr_b16 v[56:57], v87 offset:20480
    v_mfma_f32_16x16x32_bf16 v[32:35], v[60:63], v[124:127], v[32:35]
    ds_read_b64_tr_b16 v[58:59], v87 offset:22528
    buffer_load_dwordx4 v[116:119], v225, s[40:43], s66 offen offset:3072 sc1
    s_waitcnt vmcnt(14) lgkmcnt(8)
    v_mfma_f32_16x16x32_bf16 v[4:7], v[64:67], v[128:131], v[4:7]
    ds_read_b64_tr_b16 v[60:61], v84 offset:24576
    v_mfma_f32_16x16x32_bf16 v[20:23], v[64:67], v[132:135], v[20:23]
    ds_read_b64_tr_b16 v[62:63], v84 offset:26624
    v_mfma_f32_16x16x32_bf16 v[8:11], v[68:71], v[128:131], v[8:11]
    ds_read_b64_tr_b16 v[64:65], v85 offset:24576
    v_mfma_f32_16x16x32_bf16 v[24:27], v[68:71], v[132:135], v[24:27]
    ds_read_b64_tr_b16 v[66:67], v85 offset:26624
    buffer_load_dwordx4 v[120:123], v224, s[40:43], s67 offen offset:0 sc1
    v_mfma_f32_16x16x32_bf16 v[12:15], v[36:39], v[128:131], v[12:15]
    ds_read_b64_tr_b16 v[68:69], v86 offset:24576
    v_mfma_f32_16x16x32_bf16 v[28:31], v[36:39], v[132:135], v[28:31]
    ds_read_b64_tr_b16 v[70:71], v86 offset:26624
    v_mfma_f32_16x16x32_bf16 v[16:19], v[40:43], v[128:131], v[16:19]
    ds_read_b64_tr_b16 v[36:37], v87 offset:24576
    v_mfma_f32_16x16x32_bf16 v[32:35], v[40:43], v[132:135], v[32:35]
    ds_read_b64_tr_b16 v[38:39], v87 offset:26624
    buffer_load_dwordx4 v[124:127], v225, s[40:43], s67 offen offset:0 sc1
    s_waitcnt vmcnt(14) lgkmcnt(8)
    v_mfma_f32_16x16x32_bf16 v[4:7], v[44:47], v[136:139], v[4:7]
    ds_read_b64_tr_b16 v[40:41], v84 offset:28672
    v_mfma_f32_16x16x32_bf16 v[20:23], v[44:47], v[140:143], v[20:23]
    ds_read_b64_tr_b16 v[42:43], v84 offset:30720
    v_mfma_f32_16x16x32_bf16 v[8:11], v[48:51], v[136:139], v[8:11]
    ds_read_b64_tr_b16 v[44:45], v85 offset:28672
    v_mfma_f32_16x16x32_bf16 v[24:27], v[48:51], v[140:143], v[24:27]
    ds_read_b64_tr_b16 v[46:47], v85 offset:30720
    buffer_load_dwordx4 v[128:131], v224, s[40:43], s67 offen offset:1024 sc1
    v_mfma_f32_16x16x32_bf16 v[12:15], v[52:55], v[136:139], v[12:15]
    ds_read_b64_tr_b16 v[48:49], v86 offset:28672
    v_mfma_f32_16x16x32_bf16 v[28:31], v[52:55], v[140:143], v[28:31]
    ds_read_b64_tr_b16 v[50:51], v86 offset:30720
    v_mfma_f32_16x16x32_bf16 v[16:19], v[56:59], v[136:139], v[16:19]
    ds_read_b64_tr_b16 v[52:53], v87 offset:28672
    v_mfma_f32_16x16x32_bf16 v[32:35], v[56:59], v[140:143], v[32:35]
    ds_read_b64_tr_b16 v[54:55], v87 offset:30720
    buffer_load_dwordx4 v[132:135], v225, s[40:43], s67 offen offset:1024 sc1
    s_waitcnt vmcnt(14) lgkmcnt(8)
    v_mfma_f32_16x16x32_bf16 v[4:7], v[60:63], v[144:147], v[4:7]
    ds_read_b64_tr_b16 v[56:57], v84 offset:32768
    v_mfma_f32_16x16x32_bf16 v[20:23], v[60:63], v[148:151], v[20:23]
    ds_read_b64_tr_b16 v[58:59], v84 offset:34816
    v_mfma_f32_16x16x32_bf16 v[8:11], v[64:67], v[144:147], v[8:11]
    ds_read_b64_tr_b16 v[60:61], v85 offset:32768
    v_mfma_f32_16x16x32_bf16 v[24:27], v[64:67], v[148:151], v[24:27]
    ds_read_b64_tr_b16 v[62:63], v85 offset:34816
    buffer_load_dwordx4 v[136:139], v224, s[40:43], s67 offen offset:2048 sc1
    v_mfma_f32_16x16x32_bf16 v[12:15], v[68:71], v[144:147], v[12:15]
    ds_read_b64_tr_b16 v[64:65], v86 offset:32768
    v_mfma_f32_16x16x32_bf16 v[28:31], v[68:71], v[148:151], v[28:31]
    ds_read_b64_tr_b16 v[66:67], v86 offset:34816
    v_mfma_f32_16x16x32_bf16 v[16:19], v[36:39], v[144:147], v[16:19]
    ds_read_b64_tr_b16 v[68:69], v87 offset:32768
    v_mfma_f32_16x16x32_bf16 v[32:35], v[36:39], v[148:151], v[32:35]
    ds_read_b64_tr_b16 v[70:71], v87 offset:34816
    buffer_load_dwordx4 v[140:143], v225, s[40:43], s67 offen offset:2048 sc1
    s_waitcnt vmcnt(14) lgkmcnt(8)
    v_mfma_f32_16x16x32_bf16 v[4:7], v[40:43], v[152:155], v[4:7]
    ds_read_b64_tr_b16 v[36:37], v84 offset:36864
    v_mfma_f32_16x16x32_bf16 v[20:23], v[40:43], v[156:159], v[20:23]
    ds_read_b64_tr_b16 v[38:39], v84 offset:38912
    v_mfma_f32_16x16x32_bf16 v[8:11], v[44:47], v[152:155], v[8:11]
    ds_read_b64_tr_b16 v[40:41], v85 offset:36864
    v_mfma_f32_16x16x32_bf16 v[24:27], v[44:47], v[156:159], v[24:27]
    ds_read_b64_tr_b16 v[42:43], v85 offset:38912
    buffer_load_dwordx4 v[144:147], v224, s[40:43], s67 offen offset:3072 sc1
    v_mfma_f32_16x16x32_bf16 v[12:15], v[48:51], v[152:155], v[12:15]
    ds_read_b64_tr_b16 v[44:45], v86 offset:36864
    v_mfma_f32_16x16x32_bf16 v[28:31], v[48:51], v[156:159], v[28:31]
    ds_read_b64_tr_b16 v[46:47], v86 offset:38912
    v_mfma_f32_16x16x32_bf16 v[16:19], v[52:55], v[152:155], v[16:19]
    ds_read_b64_tr_b16 v[48:49], v87 offset:36864
    v_mfma_f32_16x16x32_bf16 v[32:35], v[52:55], v[156:159], v[32:35]
    ds_read_b64_tr_b16 v[50:51], v87 offset:38912
    buffer_load_dwordx4 v[148:151], v225, s[40:43], s67 offen offset:3072 sc1
    s_waitcnt vmcnt(14) lgkmcnt(8)
    v_mfma_f32_16x16x32_bf16 v[4:7], v[56:59], v[160:163], v[4:7]
    ds_read_b64_tr_b16 v[52:53], v88 offset:0
    v_mfma_f32_16x16x32_bf16 v[20:23], v[56:59], v[164:167], v[20:23]
    ds_read_b64_tr_b16 v[54:55], v88 offset:2048
    v_mfma_f32_16x16x32_bf16 v[8:11], v[60:63], v[160:163], v[8:11]
    ds_read_b64_tr_b16 v[56:57], v89 offset:0
    v_mfma_f32_16x16x32_bf16 v[24:27], v[60:63], v[164:167], v[24:27]
    ds_read_b64_tr_b16 v[58:59], v89 offset:2048
    buffer_load_dwordx4 v[152:155], v224, s[40:43], s68 offen offset:0 sc1
    v_mfma_f32_16x16x32_bf16 v[12:15], v[64:67], v[160:163], v[12:15]
    ds_read_b64_tr_b16 v[60:61], v90 offset:0
    v_mfma_f32_16x16x32_bf16 v[28:31], v[64:67], v[164:167], v[28:31]
    ds_read_b64_tr_b16 v[62:63], v90 offset:2048
    v_mfma_f32_16x16x32_bf16 v[16:19], v[68:71], v[160:163], v[16:19]
    ds_read_b64_tr_b16 v[64:65], v91 offset:0
    v_mfma_f32_16x16x32_bf16 v[32:35], v[68:71], v[164:167], v[32:35]
    ds_read_b64_tr_b16 v[66:67], v91 offset:2048
    buffer_load_dwordx4 v[156:159], v225, s[40:43], s68 offen offset:0 sc1
    s_waitcnt vmcnt(14) lgkmcnt(8)
    v_mfma_f32_16x16x32_bf16 v[4:7], v[36:39], v[96:99], v[4:7]
    ds_read_b64_tr_b16 v[68:69], v88 offset:4096
    v_mfma_f32_16x16x32_bf16 v[20:23], v[36:39], v[100:103], v[20:23]
    ds_read_b64_tr_b16 v[70:71], v88 offset:6144
    v_mfma_f32_16x16x32_bf16 v[8:11], v[40:43], v[96:99], v[8:11]
    ds_read_b64_tr_b16 v[36:37], v89 offset:4096
    v_mfma_f32_16x16x32_bf16 v[24:27], v[40:43], v[100:103], v[24:27]
    ds_read_b64_tr_b16 v[38:39], v89 offset:6144
    buffer_load_dwordx4 v[160:163], v224, s[40:43], s68 offen offset:1024 sc1
    v_mfma_f32_16x16x32_bf16 v[12:15], v[44:47], v[96:99], v[12:15]
    ds_read_b64_tr_b16 v[40:41], v90 offset:4096
    v_mfma_f32_16x16x32_bf16 v[28:31], v[44:47], v[100:103], v[28:31]
    ds_read_b64_tr_b16 v[42:43], v90 offset:6144
    v_mfma_f32_16x16x32_bf16 v[16:19], v[48:51], v[96:99], v[16:19]
    ds_read_b64_tr_b16 v[44:45], v91 offset:4096
    v_mfma_f32_16x16x32_bf16 v[32:35], v[48:51], v[100:103], v[32:35]
    ds_read_b64_tr_b16 v[46:47], v91 offset:6144
    buffer_load_dwordx4 v[164:167], v225, s[40:43], s68 offen offset:1024 sc1
    s_waitcnt vmcnt(14) lgkmcnt(8)
    v_mfma_f32_16x16x32_bf16 v[4:7], v[52:55], v[104:107], v[4:7]
    ds_read_b64_tr_b16 v[48:49], v88 offset:8192
    v_mfma_f32_16x16x32_bf16 v[20:23], v[52:55], v[108:111], v[20:23]
    ds_read_b64_tr_b16 v[50:51], v88 offset:10240
    v_mfma_f32_16x16x32_bf16 v[8:11], v[56:59], v[104:107], v[8:11]
    ds_read_b64_tr_b16 v[52:53], v89 offset:8192
    v_mfma_f32_16x16x32_bf16 v[24:27], v[56:59], v[108:111], v[24:27]
    ds_read_b64_tr_b16 v[54:55], v89 offset:10240
    buffer_load_dwordx4 v[96:99], v224, s[40:43], s68 offen offset:2048 sc1
    v_mfma_f32_16x16x32_bf16 v[12:15], v[60:63], v[104:107], v[12:15]
    ds_read_b64_tr_b16 v[56:57], v90 offset:8192
    v_mfma_f32_16x16x32_bf16 v[28:31], v[60:63], v[108:111], v[28:31]
    ds_read_b64_tr_b16 v[58:59], v90 offset:10240
    v_mfma_f32_16x16x32_bf16 v[16:19], v[64:67], v[104:107], v[16:19]
    ds_read_b64_tr_b16 v[60:61], v91 offset:8192
    v_mfma_f32_16x16x32_bf16 v[32:35], v[64:67], v[108:111], v[32:35]
    ds_read_b64_tr_b16 v[62:63], v91 offset:10240
    buffer_load_dwordx4 v[100:103], v225, s[40:43], s68 offen offset:2048 sc1
    s_waitcnt vmcnt(14) lgkmcnt(8)
    v_mfma_f32_16x16x32_bf16 v[4:7], v[68:71], v[112:115], v[4:7]
    ds_read_b64_tr_b16 v[64:65], v88 offset:12288
    v_mfma_f32_16x16x32_bf16 v[20:23], v[68:71], v[116:119], v[20:23]
    ds_read_b64_tr_b16 v[66:67], v88 offset:14336
    v_mfma_f32_16x16x32_bf16 v[8:11], v[36:39], v[112:115], v[8:11]
    ds_read_b64_tr_b16 v[68:69], v89 offset:12288
    v_mfma_f32_16x16x32_bf16 v[24:27], v[36:39], v[116:119], v[24:27]
    ds_read_b64_tr_b16 v[70:71], v89 offset:14336
    buffer_load_dwordx4 v[104:107], v224, s[40:43], s68 offen offset:3072 sc1
    v_mfma_f32_16x16x32_bf16 v[12:15], v[40:43], v[112:115], v[12:15]
    ds_read_b64_tr_b16 v[36:37], v90 offset:12288
    v_mfma_f32_16x16x32_bf16 v[28:31], v[40:43], v[116:119], v[28:31]
    ds_read_b64_tr_b16 v[38:39], v90 offset:14336
    v_mfma_f32_16x16x32_bf16 v[16:19], v[44:47], v[112:115], v[16:19]
    ds_read_b64_tr_b16 v[40:41], v91 offset:12288
    v_mfma_f32_16x16x32_bf16 v[32:35], v[44:47], v[116:119], v[32:35]
    ds_read_b64_tr_b16 v[42:43], v91 offset:14336
    buffer_load_dwordx4 v[108:111], v225, s[40:43], s68 offen offset:3072 sc1
    s_waitcnt vmcnt(14) lgkmcnt(8)
    v_mfma_f32_16x16x32_bf16 v[4:7], v[48:51], v[120:123], v[4:7]
    ds_read_b64_tr_b16 v[44:45], v88 offset:16384
    v_mfma_f32_16x16x32_bf16 v[20:23], v[48:51], v[124:127], v[20:23]
    ds_read_b64_tr_b16 v[46:47], v88 offset:18432
    v_mfma_f32_16x16x32_bf16 v[8:11], v[52:55], v[120:123], v[8:11]
    ds_read_b64_tr_b16 v[48:49], v89 offset:16384
    v_mfma_f32_16x16x32_bf16 v[24:27], v[52:55], v[124:127], v[24:27]
    ds_read_b64_tr_b16 v[50:51], v89 offset:18432
    buffer_load_dwordx4 v[112:115], v224, s[40:43], s69 offen offset:0 sc1
    v_mfma_f32_16x16x32_bf16 v[12:15], v[56:59], v[120:123], v[12:15]
    ds_read_b64_tr_b16 v[52:53], v90 offset:16384
    v_mfma_f32_16x16x32_bf16 v[28:31], v[56:59], v[124:127], v[28:31]
    ds_read_b64_tr_b16 v[54:55], v90 offset:18432
    v_mfma_f32_16x16x32_bf16 v[16:19], v[60:63], v[120:123], v[16:19]
    ds_read_b64_tr_b16 v[56:57], v91 offset:16384
    v_mfma_f32_16x16x32_bf16 v[32:35], v[60:63], v[124:127], v[32:35]
    ds_read_b64_tr_b16 v[58:59], v91 offset:18432
    buffer_load_dwordx4 v[116:119], v225, s[40:43], s69 offen offset:0 sc1
    s_waitcnt vmcnt(14) lgkmcnt(8)
    v_mfma_f32_16x16x32_bf16 v[4:7], v[64:67], v[128:131], v[4:7]
    ds_read_b64_tr_b16 v[60:61], v88 offset:20480
    v_mfma_f32_16x16x32_bf16 v[20:23], v[64:67], v[132:135], v[20:23]
    ds_read_b64_tr_b16 v[62:63], v88 offset:22528
    v_mfma_f32_16x16x32_bf16 v[8:11], v[68:71], v[128:131], v[8:11]
    ds_read_b64_tr_b16 v[64:65], v89 offset:20480
    v_mfma_f32_16x16x32_bf16 v[24:27], v[68:71], v[132:135], v[24:27]
    ds_read_b64_tr_b16 v[66:67], v89 offset:22528
    buffer_load_dwordx4 v[120:123], v224, s[40:43], s69 offen offset:1024 sc1
    v_mfma_f32_16x16x32_bf16 v[12:15], v[36:39], v[128:131], v[12:15]
    ds_read_b64_tr_b16 v[68:69], v90 offset:20480
    v_mfma_f32_16x16x32_bf16 v[28:31], v[36:39], v[132:135], v[28:31]
    ds_read_b64_tr_b16 v[70:71], v90 offset:22528
    v_mfma_f32_16x16x32_bf16 v[16:19], v[40:43], v[128:131], v[16:19]
    ds_read_b64_tr_b16 v[36:37], v91 offset:20480
    v_mfma_f32_16x16x32_bf16 v[32:35], v[40:43], v[132:135], v[32:35]
    ds_read_b64_tr_b16 v[38:39], v91 offset:22528
    buffer_load_dwordx4 v[124:127], v225, s[40:43], s69 offen offset:1024 sc1
    s_waitcnt vmcnt(14) lgkmcnt(8)
    v_mfma_f32_16x16x32_bf16 v[4:7], v[44:47], v[136:139], v[4:7]
    ds_read_b64_tr_b16 v[40:41], v88 offset:24576
    v_mfma_f32_16x16x32_bf16 v[20:23], v[44:47], v[140:143], v[20:23]
    ds_read_b64_tr_b16 v[42:43], v88 offset:26624
    v_mfma_f32_16x16x32_bf16 v[8:11], v[48:51], v[136:139], v[8:11]
    ds_read_b64_tr_b16 v[44:45], v89 offset:24576
    v_mfma_f32_16x16x32_bf16 v[24:27], v[48:51], v[140:143], v[24:27]
    ds_read_b64_tr_b16 v[46:47], v89 offset:26624
    buffer_load_dwordx4 v[128:131], v224, s[40:43], s69 offen offset:2048 sc1
    v_mfma_f32_16x16x32_bf16 v[12:15], v[52:55], v[136:139], v[12:15]
    ds_read_b64_tr_b16 v[48:49], v90 offset:24576
    v_mfma_f32_16x16x32_bf16 v[28:31], v[52:55], v[140:143], v[28:31]
    ds_read_b64_tr_b16 v[50:51], v90 offset:26624
    v_mfma_f32_16x16x32_bf16 v[16:19], v[56:59], v[136:139], v[16:19]
    ds_read_b64_tr_b16 v[52:53], v91 offset:24576
    v_mfma_f32_16x16x32_bf16 v[32:35], v[56:59], v[140:143], v[32:35]
    ds_read_b64_tr_b16 v[54:55], v91 offset:26624
    buffer_load_dwordx4 v[132:135], v225, s[40:43], s69 offen offset:2048 sc1
    s_waitcnt vmcnt(14) lgkmcnt(8)
    v_mfma_f32_16x16x32_bf16 v[4:7], v[60:63], v[144:147], v[4:7]
    ds_read_b64_tr_b16 v[56:57], v88 offset:28672
    v_mfma_f32_16x16x32_bf16 v[20:23], v[60:63], v[148:151], v[20:23]
    ds_read_b64_tr_b16 v[58:59], v88 offset:30720
    v_mfma_f32_16x16x32_bf16 v[8:11], v[64:67], v[144:147], v[8:11]
    ds_read_b64_tr_b16 v[60:61], v89 offset:28672
    v_mfma_f32_16x16x32_bf16 v[24:27], v[64:67], v[148:151], v[24:27]
    ds_read_b64_tr_b16 v[62:63], v89 offset:30720
    buffer_load_dwordx4 v[136:139], v224, s[40:43], s69 offen offset:3072 sc1
    v_mfma_f32_16x16x32_bf16 v[12:15], v[68:71], v[144:147], v[12:15]
    ds_read_b64_tr_b16 v[64:65], v90 offset:28672
    v_mfma_f32_16x16x32_bf16 v[28:31], v[68:71], v[148:151], v[28:31]
    ds_read_b64_tr_b16 v[66:67], v90 offset:30720
    v_mfma_f32_16x16x32_bf16 v[16:19], v[36:39], v[144:147], v[16:19]
    ds_read_b64_tr_b16 v[68:69], v91 offset:28672
    v_mfma_f32_16x16x32_bf16 v[32:35], v[36:39], v[148:151], v[32:35]
    ds_read_b64_tr_b16 v[70:71], v91 offset:30720
    buffer_load_dwordx4 v[140:143], v225, s[40:43], s69 offen offset:3072 sc1
    s_waitcnt vmcnt(14) lgkmcnt(8)
    v_mfma_f32_16x16x32_bf16 v[4:7], v[40:43], v[152:155], v[4:7]
    ds_read_b64_tr_b16 v[36:37], v88 offset:32768
    v_mfma_f32_16x16x32_bf16 v[20:23], v[40:43], v[156:159], v[20:23]
    ds_read_b64_tr_b16 v[38:39], v88 offset:34816
    v_mfma_f32_16x16x32_bf16 v[8:11], v[44:47], v[152:155], v[8:11]
    ds_read_b64_tr_b16 v[40:41], v89 offset:32768
    v_mfma_f32_16x16x32_bf16 v[24:27], v[44:47], v[156:159], v[24:27]
    ds_read_b64_tr_b16 v[42:43], v89 offset:34816
    buffer_load_dwordx4 v[144:147], v224, s[40:43], s70 offen offset:0 sc1
    v_mfma_f32_16x16x32_bf16 v[12:15], v[48:51], v[152:155], v[12:15]
    ds_read_b64_tr_b16 v[44:45], v90 offset:32768
    v_mfma_f32_16x16x32_bf16 v[28:31], v[48:51], v[156:159], v[28:31]
    ds_read_b64_tr_b16 v[46:47], v90 offset:34816
    v_mfma_f32_16x16x32_bf16 v[16:19], v[52:55], v[152:155], v[16:19]
    ds_read_b64_tr_b16 v[48:49], v91 offset:32768
    v_mfma_f32_16x16x32_bf16 v[32:35], v[52:55], v[156:159], v[32:35]
    ds_read_b64_tr_b16 v[50:51], v91 offset:34816
    buffer_load_dwordx4 v[148:151], v225, s[40:43], s70 offen offset:0 sc1
    ds_read_b32 v1, v228 offset:12
    s_waitcnt vmcnt(14) lgkmcnt(9)
    v_mfma_f32_16x16x32_bf16 v[4:7], v[56:59], v[160:163], v[4:7]
    ds_read_b64_tr_b16 v[52:53], v88 offset:36864
    v_mfma_f32_16x16x32_bf16 v[20:23], v[56:59], v[164:167], v[20:23]
    ds_read_b64_tr_b16 v[54:55], v88 offset:38912
    v_mfma_f32_16x16x32_bf16 v[8:11], v[60:63], v[160:163], v[8:11]
    ds_read_b64_tr_b16 v[56:57], v89 offset:36864
    v_mfma_f32_16x16x32_bf16 v[24:27], v[60:63], v[164:167], v[24:27]
    ds_read_b64_tr_b16 v[58:59], v89 offset:38912
    buffer_load_dwordx4 v[152:155], v224, s[40:43], s70 offen offset:1024 sc1
    v_mfma_f32_16x16x32_bf16 v[12:15], v[64:67], v[160:163], v[12:15]
    ds_read_b64_tr_b16 v[60:61], v90 offset:36864
    v_mfma_f32_16x16x32_bf16 v[28:31], v[64:67], v[164:167], v[28:31]
    ds_read_b64_tr_b16 v[62:63], v90 offset:38912
    v_mfma_f32_16x16x32_bf16 v[16:19], v[68:71], v[160:163], v[16:19]
    ds_read_b64_tr_b16 v[64:65], v91 offset:36864
    v_mfma_f32_16x16x32_bf16 v[32:35], v[68:71], v[164:167], v[32:35]
    ds_read_b64_tr_b16 v[66:67], v91 offset:38912
    buffer_load_dwordx4 v[156:159], v225, s[40:43], s70 offen offset:1024 sc1
    s_waitcnt lgkmcnt(8)
    v_readfirstlane_b32 s37, v1
    s_nop 0
    s_cmp_ge_u32 s37, 4
    s_cbranch_scc1 L_sl_done_51
    s_mov_b32 s38, 1048576
L_sl_loop_52:
    ds_read_b32 v1, v228 offset:12
    s_waitcnt lgkmcnt(0)
    v_readfirstlane_b32 s37, v1
    s_nop 0
    s_cmp_ge_u32 s37, 4
    s_cbranch_scc1 L_sl_done_51
    s_sleep 1
    s_sub_u32 s38, s38, 1
    s_cbranch_scc0 L_sl_loop_52
L_sl_done_51:
    s_waitcnt vmcnt(14)
    v_mfma_f32_16x16x32_bf16 v[4:7], v[36:39], v[96:99], v[4:7]
    ds_read_b64_tr_b16 v[68:69], v92 offset:0
    v_mfma_f32_16x16x32_bf16 v[20:23], v[36:39], v[100:103], v[20:23]
    ds_read_b64_tr_b16 v[70:71], v92 offset:2048
    v_mfma_f32_16x16x32_bf16 v[8:11], v[40:43], v[96:99], v[8:11]
    ds_read_b64_tr_b16 v[36:37], v93 offset:0
    v_mfma_f32_16x16x32_bf16 v[24:27], v[40:43], v[100:103], v[24:27]
    ds_read_b64_tr_b16 v[38:39], v93 offset:2048
    buffer_load_dwordx4 v[160:163], v224, s[40:43], s70 offen offset:2048 sc1
    v_mfma_f32_16x16x32_bf16 v[12:15], v[44:47], v[96:99], v[12:15]
    ds_read_b64_tr_b16 v[40:41], v94 offset:0
    v_mfma_f32_16x16x32_bf16 v[28:31], v[44:47], v[100:103], v[28:31]
    ds_read_b64_tr_b16 v[42:43], v94 offset:2048
    v_mfma_f32_16x16x32_bf16 v[16:19], v[48:51], v[96:99], v[16:19]
    ds_read_b64_tr_b16 v[44:45], v95 offset:0
    v_mfma_f32_16x16x32_bf16 v[32:35], v[48:51], v[100:103], v[32:35]
    ds_read_b64_tr_b16 v[46:47], v95 offset:2048
    buffer_load_dwordx4 v[164:167], v225, s[40:43], s70 offen offset:2048 sc1
    s_waitcnt vmcnt(14) lgkmcnt(8)
    v_mfma_f32_16x16x32_bf16 v[4:7], v[52:55], v[104:107], v[4:7]
    ds_read_b64_tr_b16 v[48:49], v92 offset:4096
    v_mfma_f32_16x16x32_bf16 v[20:23], v[52:55], v[108:111], v[20:23]
    ds_read_b64_tr_b16 v[50:51], v92 offset:6144
    v_mfma_f32_16x16x32_bf16 v[8:11], v[56:59], v[104:107], v[8:11]
    ds_read_b64_tr_b16 v[52:53], v93 offset:4096
    v_mfma_f32_16x16x32_bf16 v[24:27], v[56:59], v[108:111], v[24:27]
    ds_read_b64_tr_b16 v[54:55], v93 offset:6144
    buffer_load_dwordx4 v[96:99], v224, s[40:43], s70 offen offset:3072 sc1
    v_mfma_f32_16x16x32_bf16 v[12:15], v[60:63], v[104:107], v[12:15]
    ds_read_b64_tr_b16 v[56:57], v94 offset:4096
    v_mfma_f32_16x16x32_bf16 v[28:31], v[60:63], v[108:111], v[28:31]
    ds_read_b64_tr_b16 v[58:59], v94 offset:6144
    v_mfma_f32_16x16x32_bf16 v[16:19], v[64:67], v[104:107], v[16:19]
    ds_read_b64_tr_b16 v[60:61], v95 offset:4096
    v_mfma_f32_16x16x32_bf16 v[32:35], v[64:67], v[108:111], v[32:35]
    ds_read_b64_tr_b16 v[62:63], v95 offset:6144
    buffer_load_dwordx4 v[100:103], v225, s[40:43], s70 offen offset:3072 sc1
    s_waitcnt vmcnt(14) lgkmcnt(8)
    v_mfma_f32_16x16x32_bf16 v[4:7], v[68:71], v[112:115], v[4:7]
    ds_read_b64_tr_b16 v[64:65], v92 offset:8448
    v_mfma_f32_16x16x32_bf16 v[20:23], v[68:71], v[116:119], v[20:23]
    ds_read_b64_tr_b16 v[66:67], v92 offset:10496
    v_mfma_f32_16x16x32_bf16 v[8:11], v[36:39], v[112:115], v[8:11]
    ds_read_b64_tr_b16 v[68:69], v93 offset:8448
    v_mfma_f32_16x16x32_bf16 v[24:27], v[36:39], v[116:119], v[24:27]
    ds_read_b64_tr_b16 v[70:71], v93 offset:10496
    buffer_load_dwordx4 v[104:107], v224, s[40:43], s71 offen offset:0 sc1
    v_mfma_f32_16x16x32_bf16 v[12:15], v[40:43], v[112:115], v[12:15]
    ds_read_b64_tr_b16 v[36:37], v94 offset:8448
    v_mfma_f32_16x16x32_bf16 v[28:31], v[40:43], v[116:119], v[28:31]
    ds_read_b64_tr_b16 v[38:39], v94 offset:10496
    v_mfma_f32_16x16x32_bf16 v[16:19], v[44:47], v[112:115], v[16:19]
    ds_read_b64_tr_b16 v[40:41], v95 offset:8448
    v_mfma_f32_16x16x32_bf16 v[32:35], v[44:47], v[116:119], v[32:35]
    ds_read_b64_tr_b16 v[42:43], v95 offset:10496
    buffer_load_dwordx4 v[108:111], v225, s[40:43], s71 offen offset:0 sc1
    s_waitcnt vmcnt(14) lgkmcnt(8)
    v_mfma_f32_16x16x32_bf16 v[4:7], v[48:51], v[120:123], v[4:7]
    ds_read_b64_tr_b16 v[44:45], v92 offset:12544
    v_mfma_f32_16x16x32_bf16 v[20:23], v[48:51], v[124:127], v[20:23]
    ds_read_b64_tr_b16 v[46:47], v92 offset:14592
    v_mfma_f32_16x16x32_bf16 v[8:11], v[52:55], v[120:123], v[8:11]
    ds_read_b64_tr_b16 v[48:49], v93 offset:12544
    v_mfma_f32_16x16x32_bf16 v[24:27], v[52:55], v[124:127], v[24:27]
    ds_read_b64_tr_b16 v[50:51], v93 offset:14592
    buffer_load_dwordx4 v[112:115], v224, s[40:43], s71 offen offset:1024 sc1
    v_mfma_f32_16x16x32_bf16 v[12:15], v[56:59], v[120:123], v[12:15]
    ds_read_b64_tr_b16 v[52:53], v94 offset:12544
    v_mfma_f32_16x16x32_bf16 v[28:31], v[56:59], v[124:127], v[28:31]
    ds_read_b64_tr_b16 v[54:55], v94 offset:14592
    v_mfma_f32_16x16x32_bf16 v[16:19], v[60:63], v[120:123], v[16:19]
    ds_read_b64_tr_b16 v[56:57], v95 offset:12544
    v_mfma_f32_16x16x32_bf16 v[32:35], v[60:63], v[124:127], v[32:35]
    ds_read_b64_tr_b16 v[58:59], v95 offset:14592
    buffer_load_dwordx4 v[116:119], v225, s[40:43], s71 offen offset:1024 sc1
    s_waitcnt vmcnt(14) lgkmcnt(8)
    v_mfma_f32_16x16x32_bf16 v[4:7], v[64:67], v[128:131], v[4:7]
    ds_read_b64_tr_b16 v[60:61], v92 offset:16896
    v_mfma_f32_16x16x32_bf16 v[20:23], v[64:67], v[132:135], v[20:23]
    ds_read_b64_tr_b16 v[62:63], v92 offset:18944
    v_mfma_f32_16x16x32_bf16 v[8:11], v[68:71], v[128:131], v[8:11]
    ds_read_b64_tr_b16 v[64:65], v93 offset:16896
    v_mfma_f32_16x16x32_bf16 v[24:27], v[68:71], v[132:135], v[24:27]
    ds_read_b64_tr_b16 v[66:67], v93 offset:18944
    buffer_load_dwordx4 v[120:123], v224, s[40:43], s71 offen offset:2048 sc1
    v_mfma_f32_16x16x32_bf16 v[12:15], v[36:39], v[128:131], v[12:15]
    ds_read_b64_tr_b16 v[68:69], v94 offset:16896
    v_mfma_f32_16x16x32_bf16 v[28:31], v[36:39], v[132:135], v[28:31]
    ds_read_b64_tr_b16 v[70:71], v94 offset:18944
    v_mfma_f32_16x16x32_bf16 v[16:19], v[40:43], v[128:131], v[16:19]
    ds_read_b64_tr_b16 v[36:37], v95 offset:16896
    v_mfma_f32_16x16x32_bf16 v[32:35], v[40:43], v[132:135], v[32:35]
    ds_read_b64_tr_b16 v[38:39], v95 offset:18944
    buffer_load_dwordx4 v[124:127], v225, s[40:43], s71 offen offset:2048 sc1
    s_waitcnt vmcnt(14) lgkmcnt(8)
    v_mfma_f32_16x16x32_bf16 v[4:7], v[44:47], v[136:139], v[4:7]
    ds_read_b64_tr_b16 v[40:41], v92 offset:20992
    v_mfma_f32_16x16x32_bf16 v[20:23], v[44:47], v[140:143], v[20:23]
    ds_read_b64_tr_b16 v[42:43], v92 offset:23040
    v_mfma_f32_16x16x32_bf16 v[8:11], v[48:51], v[136:139], v[8:11]
    ds_read_b64_tr_b16 v[44:45], v93 offset:20992
    v_mfma_f32_16x16x32_bf16 v[24:27], v[48:51], v[140:143], v[24:27]
    ds_read_b64_tr_b16 v[46:47], v93 offset:23040
    buffer_load_dwordx4 v[128:131], v224, s[40:43], s71 offen offset:3072 sc1
    v_mfma_f32_16x16x32_bf16 v[12:15], v[52:55], v[136:139], v[12:15]
    ds_read_b64_tr_b16 v[48:49], v94 offset:20992
    v_mfma_f32_16x16x32_bf16 v[28:31], v[52:55], v[140:143], v[28:31]
    ds_read_b64_tr_b16 v[50:51], v94 offset:23040
    v_mfma_f32_16x16x32_bf16 v[16:19], v[56:59], v[136:139], v[16:19]
    ds_read_b64_tr_b16 v[52:53], v95 offset:20992
    v_mfma_f32_16x16x32_bf16 v[32:35], v[56:59], v[140:143], v[32:35]
    ds_read_b64_tr_b16 v[54:55], v95 offset:23040
    buffer_load_dwordx4 v[132:135], v225, s[40:43], s71 offen offset:3072 sc1
    s_waitcnt vmcnt(14) lgkmcnt(8)
    v_mfma_f32_16x16x32_bf16 v[4:7], v[60:63], v[144:147], v[4:7]
    ds_read_b64_tr_b16 v[56:57], v92 offset:25344
    v_mfma_f32_16x16x32_bf16 v[20:23], v[60:63], v[148:151], v[20:23]
    ds_read_b64_tr_b16 v[58:59], v92 offset:27392
    v_mfma_f32_16x16x32_bf16 v[8:11], v[64:67], v[144:147], v[8:11]
    ds_read_b64_tr_b16 v[60:61], v93 offset:25344
    v_mfma_f32_16x16x32_bf16 v[24:27], v[64:67], v[148:151], v[24:27]
    ds_read_b64_tr_b16 v[62:63], v93 offset:27392
    v_mfma_f32_16x16x32_bf16 v[12:15], v[68:71], v[144:147], v[12:15]
    ds_read_b64_tr_b16 v[64:65], v94 offset:25344
    v_mfma_f32_16x16x32_bf16 v[28:31], v[68:71], v[148:151], v[28:31]
    ds_read_b64_tr_b16 v[66:67], v94 offset:27392
    v_mfma_f32_16x16x32_bf16 v[16:19], v[36:39], v[144:147], v[16:19]
    ds_read_b64_tr_b16 v[68:69], v95 offset:25344
    v_mfma_f32_16x16x32_bf16 v[32:35], v[36:39], v[148:151], v[32:35]
    ds_read_b64_tr_b16 v[70:71], v95 offset:27392
    s_waitcnt vmcnt(12) lgkmcnt(8)
    v_mfma_f32_16x16x32_bf16 v[4:7], v[40:43], v[152:155], v[4:7]
    ds_read_b64_tr_b16 v[36:37], v92 offset:29440
    v_mfma_f32_16x16x32_bf16 v[20:23], v[40:43], v[156:159], v[20:23]
    ds_read_b64_tr_b16 v[38:39], v92 offset:31488
    v_mfma_f32_16x16x32_bf16 v[8:11], v[44:47], v[152:155], v[8:11]
    ds_read_b64_tr_b16 v[40:41], v93 offset:29440
    v_mfma_f32_16x16x32_bf16 v[24:27], v[44:47], v[156:159], v[24:27]
    ds_read_b64_tr_b16 v[42:43], v93 offset:31488
    v_mfma_f32_16x16x32_bf16 v[12:15], v[48:51], v[152:155], v[12:15]
    ds_read_b64_tr_b16 v[44:45], v94 offset:29440
    v_mfma_f32_16x16x32_bf16 v[28:31], v[48:51], v[156:159], v[28:31]
    ds_read_b64_tr_b16 v[46:47], v94 offset:31488
    v_mfma_f32_16x16x32_bf16 v[16:19], v[52:55], v[152:155], v[16:19]
    ds_read_b64_tr_b16 v[48:49], v95 offset:29440
    v_mfma_f32_16x16x32_bf16 v[32:35], v[52:55], v[156:159], v[32:35]
    ds_read_b64_tr_b16 v[50:51], v95 offset:31488
    s_waitcnt vmcnt(10) lgkmcnt(8)
    v_mfma_f32_16x16x32_bf16 v[4:7], v[56:59], v[160:163], v[4:7]
    ds_read_b64_tr_b16 v[52:53], v84 offset:41984
    v_mfma_f32_16x16x32_bf16 v[20:23], v[56:59], v[164:167], v[20:23]
    ds_read_b64_tr_b16 v[54:55], v84 offset:44032
    v_mfma_f32_16x16x32_bf16 v[8:11], v[60:63], v[160:163], v[8:11]
    ds_read_b64_tr_b16 v[56:57], v85 offset:41984
    v_mfma_f32_16x16x32_bf16 v[24:27], v[60:63], v[164:167], v[24:27]
    ds_read_b64_tr_b16 v[58:59], v85 offset:44032
    v_mfma_f32_16x16x32_bf16 v[12:15], v[64:67], v[160:163], v[12:15]
    ds_read_b64_tr_b16 v[60:61], v86 offset:41984
    v_mfma_f32_16x16x32_bf16 v[28:31], v[64:67], v[164:167], v[28:31]
    ds_read_b64_tr_b16 v[62:63], v86 offset:44032
    v_mfma_f32_16x16x32_bf16 v[16:19], v[68:71], v[160:163], v[16:19]
    ds_read_b64_tr_b16 v[64:65], v87 offset:41984
    v_mfma_f32_16x16x32_bf16 v[32:35], v[68:71], v[164:167], v[32:35]
    ds_read_b64_tr_b16 v[66:67], v87 offset:44032
    s_waitcnt vmcnt(8) lgkmcnt(8)
    v_mfma_f32_16x16x32_bf16 v[4:7], v[36:39], v[96:99], v[4:7]
    ds_read_b64_tr_b16 v[68:69], v84 offset:46080
    v_mfma_f32_16x16x32_bf16 v[20:23], v[36:39], v[100:103], v[20:23]
    ds_read_b64_tr_b16 v[70:71], v84 offset:48128
    v_mfma_f32_16x16x32_bf16 v[8:11], v[40:43], v[96:99], v[8:11]
    ds_read_b64_tr_b16 v[36:37], v85 offset:46080
    v_mfma_f32_16x16x32_bf16 v[24:27], v[40:43], v[100:103], v[24:27]
    ds_read_b64_tr_b16 v[38:39], v85 offset:48128
    v_mfma_f32_16x16x32_bf16 v[12:15], v[44:47], v[96:99], v[12:15]
    ds_read_b64_tr_b16 v[40:41], v86 offset:46080
    v_mfma_f32_16x16x32_bf16 v[28:31], v[44:47], v[100:103], v[28:31]
    ds_read_b64_tr_b16 v[42:43], v86 offset:48128
    v_mfma_f32_16x16x32_bf16 v[16:19], v[48:51], v[96:99], v[16:19]
    ds_read_b64_tr_b16 v[44:45], v87 offset:46080
    v_mfma_f32_16x16x32_bf16 v[32:35], v[48:51], v[100:103], v[32:35]
    ds_read_b64_tr_b16 v[46:47], v87 offset:48128
    s_waitcnt vmcnt(6) lgkmcnt(8)
    v_mfma_f32_16x16x32_bf16 v[4:7], v[52:55], v[104:107], v[4:7]
    ds_read_b64_tr_b16 v[48:49], v84 offset:51200
    v_mfma_f32_16x16x32_bf16 v[20:23], v[52:55], v[108:111], v[20:23]
    ds_read_b64_tr_b16 v[50:51], v84 offset:53248
    v_mfma_f32_16x16x32_bf16 v[8:11], v[56:59], v[104:107], v[8:11]
    ds_read_b64_tr_b16 v[52:53], v85 offset:51200
    v_mfma_f32_16x16x32_bf16 v[24:27], v[56:59], v[108:111], v[24:27]
    ds_read_b64_tr_b16 v[54:55], v85 offset:53248
    v_mfma_f32_16x16x32_bf16 v[12:15], v[60:63], v[104:107], v[12:15]
    ds_read_b64_tr_b16 v[56:57], v86 offset:51200
    v_mfma_f32_16x16x32_bf16 v[28:31], v[60:63], v[108:111], v[28:31]
    ds_read_b64_tr_b16 v[58:59], v86 offset:53248
    v_mfma_f32_16x16x32_bf16 v[16:19], v[64:67], v[104:107], v[16:19]
    ds_read_b64_tr_b16 v[60:61], v87 offset:51200
    v_mfma_f32_16x16x32_bf16 v[32:35], v[64:67], v[108:111], v[32:35]
    ds_read_b64_tr_b16 v[62:63], v87 offset:53248
    s_waitcnt vmcnt(4) lgkmcnt(8)
    v_mfma_f32_16x16x32_bf16 v[4:7], v[68:71], v[112:115], v[4:7]
    ds_read_b64_tr_b16 v[64:65], v84 offset:55296
    v_mfma_f32_16x16x32_bf16 v[20:23], v[68:71], v[116:119], v[20:23]
    ds_read_b64_tr_b16 v[66:67], v84 offset:57344
    v_mfma_f32_16x16x32_bf16 v[8:11], v[36:39], v[112:115], v[8:11]
    ds_read_b64_tr_b16 v[68:69], v85 offset:55296
    v_mfma_f32_16x16x32_bf16 v[24:27], v[36:39], v[116:119], v[24:27]
    ds_read_b64_tr_b16 v[70:71], v85 offset:57344
    v_mfma_f32_16x16x32_bf16 v[12:15], v[40:43], v[112:115], v[12:15]
    ds_read_b64_tr_b16 v[36:37], v86 offset:55296
    v_mfma_f32_16x16x32_bf16 v[28:31], v[40:43], v[116:119], v[28:31]
    ds_read_b64_tr_b16 v[38:39], v86 offset:57344
    v_mfma_f32_16x16x32_bf16 v[16:19], v[44:47], v[112:115], v[16:19]
    ds_read_b64_tr_b16 v[40:41], v87 offset:55296
    v_mfma_f32_16x16x32_bf16 v[32:35], v[44:47], v[116:119], v[32:35]
    ds_read_b64_tr_b16 v[42:43], v87 offset:57344
    s_waitcnt vmcnt(2) lgkmcnt(8)
    v_mfma_f32_16x16x32_bf16 v[4:7], v[48:51], v[120:123], v[4:7]
    s_mul_i32 s37, s32, 80896
    s_lshl_b32 s38, s33, 11
    v_mfma_f32_16x16x32_bf16 v[20:23], v[48:51], v[124:127], v[20:23]
    s_add_u32 s37, s37, s38
    s_add_u32 s37, s37, 78848
    v_mfma_f32_16x16x32_bf16 v[8:11], v[52:55], v[120:123], v[8:11]
    v_lshrrev_b32 v1, 5, v0
    v_xor_b32 v1, v1, v0
    v_mfma_f32_16x16x32_bf16 v[24:27], v[52:55], v[124:127], v[24:27]
    v_and_b32 v1, 7, v1
    v_lshl_add_u32 v1, v1, 4, s37
    v_mfma_f32_16x16x32_bf16 v[12:15], v[56:59], v[120:123], v[12:15]
    v_bfe_u32 v2, v0, 4, 1
    v_lshl_add_u32 v1, v2, 3, v1
    v_mfma_f32_16x16x32_bf16 v[28:31], v[56:59], v[124:127], v[28:31]
    v_and_b32 v2, 15, v0
    v_lshl_add_u32 v84, v2, 7, v1
    v_mfma_f32_16x16x32_bf16 v[16:19], v[60:63], v[120:123], v[16:19]
    v_xor_b32 v85, 32, v84
    v_xor_b32 v86, 64, v84
    v_mfma_f32_16x16x32_bf16 v[32:35], v[60:63], v[124:127], v[32:35]
    v_xor_b32 v87, 96, v84
    v_lshrrev_b32 v1, 3, v0
    s_waitcnt vmcnt(0) lgkmcnt(0)
    v_mfma_f32_16x16x32_bf16 v[4:7], v[64:67], v[128:131], v[4:7]
    v_xor_b32 v1, v1, v0
    v_and_b32 v1, 7, v1
    v_mfma_f32_16x16x32_bf16 v[20:23], v[64:67], v[132:135], v[20:23]
    v_and_b32 v2, 56, v0
    v_add_u32 v1, v1, v2
    v_mfma_f32_16x16x32_bf16 v[8:11], v[68:71], v[128:131], v[8:11]
    v_lshl_add_u32 v88, v1, 4, s37
    v_mfma_f32_16x16x32_bf16 v[24:27], v[68:71], v[132:135], v[24:27]
    v_mfma_f32_16x16x32_bf16 v[12:15], v[36:39], v[128:131], v[12:15]
    v_mfma_f32_16x16x32_bf16 v[28:31], v[36:39], v[132:135], v[28:31]
    v_mfma_f32_16x16x32_bf16 v[16:19], v[40:43], v[128:131], v[16:19]
    v_mfma_f32_16x16x32_bf16 v[32:35], v[40:43], v[132:135], v[32:35]
    v_cvt_pk_bf16_f32 v36, v4, v5
    v_cvt_pk_bf16_f32 v37, v6, v7
    ds_write_b64 v84, v[36:37]
    v_cvt_pk_bf16_f32 v38, v8, v9
    v_cvt_pk_bf16_f32 v39, v10, v11
    ds_write_b64 v85, v[38:39]
    v_cvt_pk_bf16_f32 v40, v12, v13
    v_cvt_pk_bf16_f32 v41, v14, v15
    ds_write_b64 v86, v[40:41]
    v_cvt_pk_bf16_f32 v42, v16, v17
    v_cvt_pk_bf16_f32 v43, v18, v19
    ds_write_b64 v87, v[42:43]
    ds_read_b128 v[52:55], v88 offset:0
    ds_read_b128 v[56:59], v88 offset:1024
    v_cvt_pk_bf16_f32 v44, v20, v21
    v_cvt_pk_bf16_f32 v45, v22, v23
    ds_write_b64 v84, v[44:45]
    v_cvt_pk_bf16_f32 v46, v24, v25
    v_cvt_pk_bf16_f32 v47, v26, v27
    ds_write_b64 v85, v[46:47]
    v_cvt_pk_bf16_f32 v48, v28, v29
    v_cvt_pk_bf16_f32 v49, v30, v31
    ds_write_b64 v86, v[48:49]
    v_cvt_pk_bf16_f32 v50, v32, v33
    v_cvt_pk_bf16_f32 v51, v34, v35
    ds_write_b64 v87, v[50:51]
    ds_read_b128 v[60:63], v88 offset:0
    ds_read_b128 v[64:67], v88 offset:1024
    s_mov_b32 s37, 0
    s_waitcnt lgkmcnt(7)
    buffer_store_dwordx4 v[52:55], v226, s[48:51], s37 offen nt
    s_mov_b32 s37, 65536
    s_waitcnt lgkmcnt(6)
    buffer_store_dwordx4 v[56:59], v226, s[48:51], s37 offen nt
    s_mov_b32 s37, 131072
    s_waitcnt lgkmcnt(1)
    buffer_store_dwordx4 v[60:63], v226, s[48:51], s37 offen nt
    s_mov_b32 s37, 196608
    s_waitcnt lgkmcnt(0)
    buffer_store_dwordx4 v[64:67], v226, s[48:51], s37 offen nt
    s_endpgm
L_g1_rare:
    s_waitcnt vmcnt(0)
    s_cmp_lg_u32 s36, 1
    s_cbranch_scc1 L_g1_bar
    v_readfirstlane_b32 s38, v1
    s_nop 0
    s_cmp_ge_u32 s38, 4
    s_cbranch_scc1 L_sl_done_53
    s_mov_b32 s39, 1048576
L_sl_loop_54:
    ds_read_b32 v1, v228 offset:24
    s_waitcnt lgkmcnt(0)
    v_readfirstlane_b32 s38, v1
    s_nop 0
    s_cmp_ge_u32 s38, 4
    s_cbranch_scc1 L_sl_done_53
    s_sleep 1
    s_sub_u32 s39, s39, 1
    s_cbranch_scc0 L_sl_loop_54
L_sl_done_53:
    s_branch L_g1_nobar
L_end:
    s_endpgm
.section .rodata,"a"
.p2align 6
.amdhsa_kernel concat_heads__ssm_conv_h3__sliding_local_dilated__prompt_kernel
  .amdhsa_next_free_vgpr 256
  .amdhsa_next_free_sgpr 102
  .amdhsa_accum_offset 256
  .amdhsa_group_segment_fixed_size 0
  .amdhsa_kernarg_size 96
  .amdhsa_user_sgpr_count 2
  .amdhsa_user_sgpr_kernarg_segment_ptr 1
  .amdhsa_system_sgpr_workgroup_id_x 1
  .amdhsa_float_denorm_mode_32 3
.end_amdhsa_kernel
```

```asm
; @launch grid=(256,1,1) block=(512,1,1) lds=163840
.amdgcn_target "amdgcn-amd-amdhsa--gfx950"
.text
.globl concat_heads__ssm_conv_h3__sliding_local_dilated__prompt_kernel
.p2align 8
.type concat_heads__ssm_conv_h3__sliding_local_dilated__prompt_kernel,@function
concat_heads__ssm_conv_h3__sliding_local_dilated__prompt_kernel:
L_entry:
    s_getpc_b64 s[32:33]
    s_cmp_ge_u32 s2, 256
    s_cbranch_scc1 L_end
    s_load_dwordx16 s[8:23], s[0:1], 0
    s_load_dwordx8 s[24:31], s[0:1], 64
    v_lshrrev_b32 v1, 6, v0
    s_and_b32 s4, s2, 1
    v_readfirstlane_b32 s3, v1
    v_and_b32 v0, 63, v0
    s_bfe_u32 s5, s2, 0x30003
    s_bfe_u32 s6, s2, 0x20001
    s_lshr_b32 s7, s2, 6
    s_lshl2_add_u32 s6, s6, s7
    s_cmp_ge_u32 s3, 4
    s_cbranch_scc1 L_crole
    s_bfe_u32 s34, s2, 0x20003
    s_lshl2_add_u32 s34, s34, s3
    s_lshl_b32 s34, s34, 7
    v_lshl_add_u32 v1, v0, 11, s34
    v_min_u32 v1, L_end-L_entry-8, v1
    s_mov_b64 exec, 0xffff
    global_load_dword v249, v1, s[32:33]
    s_mov_b64 exec, -1
    s_and_b32 s84, s2, 3
    s_lshl2_add_u32 s84, s84, s3
    s_lshr_b32 s85, s2, 2
    s_mul_i32 s86, s3, 8448
    s_add_u32 s86, s86, 125952
    s_lshl_b32 s87, s85, 9
    s_add_u32 s87, s87, s84
    s_lshl_b32 s87, s87, 7
    v_and_b32 v231, 7, v0
    v_lshl_add_u32 v231, v231, 4, s87
    v_lshrrev_b32 v230, 3, v0
    v_lshl_add_u32 v230, v230, 13, v231
    v_subrev_u32 v231, 6144, v230
    v_subrev_u32 v232, 4096, v230
    v_subrev_u32 v233, 2048, v230
    v_add_u32 v234, 4096, v230
    v_lshlrev_b32 v235, 4, v0
    s_lshl_b32 s87, s84, 9
    s_add_u32 m0, s86, 4224
    s_waitcnt lgkmcnt(0)
    s_mov_b32 s80, s14
    s_mov_b32 s81, s15
    s_mov_b32 s82, 0x2000
    s_mov_b32 s83, 0x20000
    s_mov_b32 s72, s10
    s_mov_b32 s73, s11
    s_mov_b32 s74, 0x400000
    s_mov_b32 s75, 0x20000
    s_mov_b32 exec_hi, 0
    buffer_load_dwordx4 v235, s[80:83], s87 offen lds
    s_mov_b64 exec, -1
    buffer_load_dwordx4 v[108:111], v231, s[72:75], 0 offen offset:0 nt
    buffer_load_dwordx4 v[112:115], v232, s[72:75], 0 offen offset:0 nt
    buffer_load_dwordx4 v[116:119], v233, s[72:75], 0 offen offset:0 nt
    buffer_load_dwordx4 v[120:123], v230, s[72:75], 0 offen offset:0 nt
    buffer_load_dwordx4 v[124:127], v230, s[72:75], 0 offen offset:2048 nt
    buffer_load_dwordx4 v[128:131], v234, s[72:75], 0 offen offset:0 nt
    buffer_load_dwordx4 v[132:135], v234, s[72:75], 0 offen offset:2048 nt
    s_mov_b32 s76, s12
    s_mov_b32 s77, s13
    s_mov_b32 s78, 0x400000
    s_mov_b32 s79, 0x20000
    buffer_load_dwordx4 v[136:139], v230, s[76:79], 0 offen offset:0 nt
    buffer_load_dwordx4 v[140:143], v230, s[76:79], 0 offen offset:2048 nt
    buffer_load_dwordx4 v[144:147], v234, s[76:79], 0 offen offset:0 nt
    buffer_load_dwordx4 v[148:151], v234, s[76:79], 0 offen offset:2048 nt
    s_lshr_b32 s90, s2, 3
    s_and_b32 s91, s3, 3
    s_lshl2_add_u32 s90, s90, s91
    s_and_b32 s91, s2, 6
    s_lshl3_add_u32 s88, s90, s91
    s_lshl1_add_u32 s88, s88, s4
    s_lshl_b32 s88, s88, 11
    s_and_b32 s89, s2, 7
    s_and_b32 s91, s90, 1
    s_lshl1_add_u32 s89, s89, s91
    s_lshr_b32 s90, s90, 1
    s_mul_i32 s90, s90, 48
    s_add_u32 s89, s89, s90
    s_lshl_b32 s89, s89, 7
    v_and_b32 v251, 1, v0
    v_lshlrev_b32 v251, 12, v251
    v_lshrrev_b32 v252, 1, v0
    v_lshl_add_u32 v251, v252, 7, v251
    v_lshrrev_b32 v250, 2, v0
    v_mul_u32_u24 v250, 393216, v250
    v_and_b32 v252, 3, v0
    v_lshl_add_u32 v252, v252, 11, v250
    s_mov_b32 s64, s20
    s_mov_b32 s65, s21
    s_mov_b32 s66, 0x400000
    s_mov_b32 s67, 0x20000
    s_mov_b32 s68, s22
    s_mov_b32 s69, s23
    s_mov_b32 s70, 0x600000
    s_mov_b32 s71, 0x20000
    s_mov_b32 exec_lo, 0x777
    s_mov_b32 exec_hi, 0x0
    s_bfe_u32 s7, s89, 0x30007
    s_cmp_lg_u32 s7, 1
    s_cbranch_scc1 L_wx3_1
    buffer_load_dword v250, v252, s[68:71], s89 offen offset:256
L_wx3_1:
    buffer_load_dword v250, v252, s[68:71], s89 offen
    s_mov_b32 exec_lo, 0x3f
    s_mov_b32 exec_hi, 0
    buffer_load_dword v250, v251, s[64:67], s88 offen
    s_mov_b64 exec, -1
    s_barrier
    s_branch L_grole
L_crole:
    s_sub_u32 s70, s3, 4
    s_lshl_b32 s43, s70, 12
    s_lshl_b32 s44, s70, 11
    s_add_u32 s44, s44, 17408
    s_lshl_b32 s49, s70, 4
    s_lshl_b64 s[46:47], 0xffff, s49
    v_lshrrev_b32 v13, 3, v0
    v_and_b32 v14, 7, v0
    v_lshrrev_b32 v15, 4, v0
    s_lshl2_add_u32 s50, s5, s70
    s_lshl_b32 s50, s50, 6
    s_add_u32 s50, s50, s4
    s_lshl_b32 s50, s50, 11
    v_lshl_add_u32 v16, v13, 12, s50
    v_xor_b32 v17, v14, v15
    v_lshl_add_u32 v2, v17, 4, v16
    v_xor_b32 v3, 64, v2
    v_add_u32 v3, 31744, v3
    v_add_u32 v4, 63488, v2
    v_add_u32 v5, 63488, v3
    s_lshl_b32 s49, s5, 7
    s_sub_u32 s49, s49, 8
    s_max_i32 s49, s49, 0
    s_lshl1_add_u32 s49, s49, s4
    s_lshl_b32 s49, s49, 11
    v_lshl_add_u32 v16, v13, 12, s49
    v_lshlrev_b32 v17, 1, v15
    v_xor_b32 v18, v14, v17
    v_lshl_add_u32 v6, v18, 4, v16
    s_mul_i32 s49, s70, 768
    s_add_u32 s49, s49, s6
    s_lshl_b32 s49, s49, 7
    v_mul_u32_u24 v16, 6144, v13
    v_and_b32 v17, 2, v17
    v_xor_b32 v17, v14, v17
    v_lshlrev_b32 v17, 4, v17
    v_add3_u32 v7, v17, v16, s49
    v_xor_b32 v8, 64, v7
    v_add_u32 v8, 48128, v8
    v_add_u32 v9, 2048, v7
    v_add_u32 v10, 2048, v8
    v_add_u32 v11, 4096, v7
    v_add_u32 v12, 4096, v8
    s_movk_i32 s40, 0
    s_mov_b32 s41, 0
    s_lshr_b32 s90, s2, 3
    s_and_b32 s91, s3, 3
    s_lshl2_add_u32 s90, s90, s91
    s_and_b32 s91, s2, 6
    s_lshl3_add_u32 s88, s90, s91
    s_lshl1_add_u32 s88, s88, s4
    s_lshl_b32 s88, s88, 11
    s_and_b32 s89, s2, 7
    s_and_b32 s91, s90, 1
    s_lshl1_add_u32 s89, s89, s91
    s_lshr_b32 s90, s90, 1
    s_mul_i32 s90, s90, 48
    s_add_u32 s89, s89, s90
    s_lshl_b32 s89, s89, 7
    v_and_b32 v251, 1, v0
    v_lshlrev_b32 v251, 12, v251
    v_lshrrev_b32 v252, 1, v0
    v_lshl_add_u32 v251, v252, 7, v251
    v_lshrrev_b32 v250, 2, v0
    v_mul_u32_u24 v250, 393216, v250
    v_and_b32 v252, 3, v0
    v_lshl_add_u32 v252, v252, 11, v250
    s_waitcnt lgkmcnt(0)
    s_mov_b32 s32, s20
    s_mov_b32 s33, s21
    s_mov_b32 s34, 0x400000
    s_mov_b32 s35, 0x20000
    s_mov_b32 s36, s22
    s_mov_b32 s37, s23
    s_mov_b32 s38, 0x600000
    s_mov_b32 s39, 0x20000
    s_setprio 0
    s_and_b32 s73, s2, 7
    s_xor_b32 s73, s73, 2
    s_lshr_b32 s74, s2, 7
    s_lshl1_add_u32 s68, s73, s74
    s_bfe_u32 s69, s2, 0x40003
    s_lshl4_add_u32 s71, s68, s69
    s_lshl2_add_u32 s71, s71, s70
    s_mul_i32 s80, s70, 8448
    s_add_u32 s80, s80, 125952
    s_mul_i32 s81, s70, 9216
    s_add_u32 s81, s81, 41984
    s_add_u32 s52, s30, 0xe00000
    s_addc_u32 s53, s31, 0
    s_mov_b32 s54, 0x20000
    s_mov_b32 s55, 0x20000
    s_add_u32 s64, s30, 0x900000
    s_addc_u32 s65, s31, 0
    s_mov_b32 s66, 0x420000
    s_mov_b32 s67, 0x20000
    s_lshl_b32 s84, s71, 12
    s_mul_i32 s85, s71, 4224
    s_add_u32 s85, s85, 4194304
    s_lshr_b32 s72, s71, 1
    s_lshl_b32 s72, s72, 2
    s_load_dword s72, s[18:19], s72
    v_lshlrev_b32 v224, 4, v0
    v_mov_b32 v228, 0
    v_mov_b32 v229, 0
    v_mov_b32 v230, 0
    v_mov_b32 v231, 0
    v_mov_b32 v227, 134352
    v_mov_b32 v244, 1
    s_bfe_u32 s87, s2, 0x10003
    s_mov_b64 exec, 1
    ds_write_b128 v227, v[228:231]
    ds_write_b128 v227, v[228:231] offset:16
    ds_write_b128 v227, v[228:231] offset:32
    s_mov_b64 exec, -1
    s_lshr_b32 s74, s69, 2
    s_and_b32 s75, s69, 3
    s_lshl3_add_u32 s74, s74, s75
    s_lshl3_add_u32 s74, s74, s70
    s_lshl_b32 s74, s74, 3
    v_bfe_u32 v234, v0, 3, 1
    v_lshl_add_u32 v225, v234, 8, s74
    v_bfe_u32 v234, v0, 4, 1
    v_lshl_add_u32 v225, v234, 1, v225
    v_lshrrev_b32 v234, 5, v0
    v_lshl_add_u32 v225, v234, 5, v225
    s_lshl_b32 s74, s68, 7
    v_and_b32 v234, 7, v0
    v_lshl_add_u32 v234, v234, 4, s74
    v_lshl_add_u32 v226, v225, 12, v234
    v_lshl_add_u32 v225, v225, 11, v234
    v_and_b32 v234, 1, v0
    v_xor_b32 v234, 1, v234
    v_mul_u32_u24 v232, 4224, v234
    v_mul_u32_u24 v233, 4576, v234
    v_bfe_u32 v234, v0, 1, 3
    v_lshl_add_u32 v232, v234, 3, v232
    v_xor_b32 v234, 7, v234
    v_lshl_add_u32 v233, v234, 6, v233
    v_lshrrev_b32 v234, 4, v0
    v_lshl_add_u32 v232, v234, 4, v232
    v_lshl_add_u32 v233, v234, 4, v233
    v_add3_u32 v232, v232, s80, 8
    v_add_u32 v233, s81, v233
    s_waitcnt lgkmcnt(0)
    s_bitcmp1_b32 s71, 0
    s_cselect_b32 s74, 0, 16
    s_lshl_b32 s72, s72, s74
    s_and_b32 s72, s72, 0xffff0000
    v_and_b32 v235, 1, v0
    v_lshlrev_b32 v235, 4, v235
    v_lshrrev_b32 v235, v235, s72
    v_bfe_u32 v236, v0, 1, 3
    v_lshl_add_u32 v236, v234, 1, v236
    v_cmp_eq_u32 vcc, 7, v236
    v_mov_b32 v241, 0
    v_mov_b32 v243, 0
    v_cndmask_b32 v240, 0, v235, vcc
    v_cmp_eq_u32 vcc, 6, v236
    s_nop 1
    v_cndmask_b32 v242, 0, v235, vcc
    s_barrier
    s_add_u32 m0, s43, 0
    s_nop 0
    buffer_load_dwordx4 v2, s[32:35], s40 offen offset:0 lds
    s_add_u32 m0, s44, 0
    s_nop 0
    buffer_load_dwordx4 v7, s[36:39], s41 offen offset:0 lds
    buffer_load_dwordx4 v8, s[36:39], s41 offen offset:1024 lds
    s_add_u32 m0, s43, 0
    s_nop 0
    buffer_load_dwordx4 v3, s[32:35], s40 offen offset:1024 lds
    s_add_u32 m0, s44, 8192
    s_nop 0
    buffer_load_dwordx4 v9, s[36:39], s41 offen offset:0 lds
    buffer_load_dwordx4 v10, s[36:39], s41 offen offset:1024 lds
    s_add_u32 m0, s43, 0
    s_nop 0
    buffer_load_dwordx4 v4, s[32:35], s40 offen offset:2048 lds
    s_add_u32 m0, s44, 16384
    s_nop 0
    buffer_load_dwordx4 v11, s[36:39], s41 offen offset:0 lds
    buffer_load_dwordx4 v12, s[36:39], s41 offen offset:1024 lds
    s_add_u32 m0, s43, 0
    s_nop 0
    buffer_load_dwordx4 v5, s[32:35], s40 offen offset:3072 lds
    s_mov_b32 m0, 16384
    s_mov_b64 exec, s[46:47]
    buffer_load_dwordx4 v6, s[32:35], s40 offen lds
    s_mov_b64 exec, -1
    s_movk_i32 s40, 128
    s_mov_b32 s41, 393216
    s_add_u32 m0, s43, 41984
    s_nop 0
    buffer_load_dwordx4 v2, s[32:35], s40 offen offset:0 lds
    s_add_u32 m0, s44, 41984
    s_nop 0
    buffer_load_dwordx4 v7, s[36:39], s41 offen offset:0 lds
    buffer_load_dwordx4 v8, s[36:39], s41 offen offset:1024 lds
    s_add_u32 m0, s43, 41984
    s_nop 0
    buffer_load_dwordx4 v3, s[32:35], s40 offen offset:1024 lds
    s_add_u32 m0, s44, 50176
    s_nop 0
    buffer_load_dwordx4 v9, s[36:39], s41 offen offset:0 lds
    buffer_load_dwordx4 v10, s[36:39], s41 offen offset:1024 lds
    s_add_u32 m0, s43, 41984
    s_nop 0
    buffer_load_dwordx4 v4, s[32:35], s40 offen offset:2048 lds
    s_add_u32 m0, s44, 58368
    s_nop 0
    buffer_load_dwordx4 v11, s[36:39], s41 offen offset:0 lds
    buffer_load_dwordx4 v12, s[36:39], s41 offen offset:1024 lds
    s_add_u32 m0, s43, 41984
    s_nop 0
    buffer_load_dwordx4 v5, s[32:35], s40 offen offset:3072 lds
    s_mov_b32 m0, 58368
    s_mov_b64 exec, s[46:47]
    buffer_load_dwordx4 v6, s[32:35], s40 offen lds
    s_mov_b64 exec, -1
    s_movk_i32 s40, 256
    s_mov_b32 s41, 786432
    s_waitcnt vmcnt(11)
    s_barrier
    s_add_u32 m0, s43, 83968
    s_nop 0
    buffer_load_dwordx4 v2, s[32:35], s40 offen offset:0 lds
    s_add_u32 m0, s44, 83968
    s_nop 0
    buffer_load_dwordx4 v7, s[36:39], s41 offen offset:0 lds
    buffer_load_dwordx4 v8, s[36:39], s41 offen offset:1024 lds
    s_add_u32 m0, s43, 83968
    s_nop 0
    buffer_load_dwordx4 v3, s[32:35], s40 offen offset:1024 lds
    s_add_u32 m0, s44, 92160
    s_nop 0
    buffer_load_dwordx4 v9, s[36:39], s41 offen offset:0 lds
    buffer_load_dwordx4 v10, s[36:39], s41 offen offset:1024 lds
    s_add_u32 m0, s43, 83968
    s_nop 0
    buffer_load_dwordx4 v4, s[32:35], s40 offen offset:2048 lds
    s_add_u32 m0, s44, 100352
    s_nop 0
    buffer_load_dwordx4 v11, s[36:39], s41 offen offset:0 lds
    buffer_load_dwordx4 v12, s[36:39], s41 offen offset:1024 lds
    s_add_u32 m0, s43, 83968
    s_nop 0
    buffer_load_dwordx4 v5, s[32:35], s40 offen offset:3072 lds
    s_mov_b32 m0, 100352
    s_mov_b64 exec, s[46:47]
    buffer_load_dwordx4 v6, s[32:35], s40 offen lds
    s_mov_b64 exec, -1
    s_movk_i32 s40, 384
    s_mov_b32 s41, 1179648
    s_mov_b32 exec_lo, 0x7777000
    s_mov_b32 exec_hi, 0x0
    s_bfe_u32 s7, s89, 0x30007
    s_cmp_lg_u32 s7, 1
    s_cbranch_scc1 L_wx3_3
    buffer_load_dword v250, v252, s[36:39], s89 offen offset:256
L_wx3_3:
    buffer_load_dword v250, v252, s[36:39], s89 offen
    s_mov_b32 exec_lo, 0x3fc0
    s_mov_b32 exec_hi, 0
    buffer_load_dword v250, v251, s[32:35], s88 offen
    s_mov_b64 exec, -1
    s_waitcnt vmcnt(13)
    s_barrier
    s_add_u32 m0, s43, 0
    s_nop 0
    buffer_load_dwordx4 v2, s[32:35], s40 offen offset:0 lds
    s_add_u32 m0, s44, 0
    s_nop 0
    buffer_load_dwordx4 v7, s[36:39], s41 offen offset:0 lds
    buffer_load_dwordx4 v8, s[36:39], s41 offen offset:1024 lds
    s_add_u32 m0, s43, 0
    s_nop 0
    buffer_load_dwordx4 v3, s[32:35], s40 offen offset:1024 lds
    s_add_u32 m0, s44, 8192
    s_nop 0
    buffer_load_dwordx4 v9, s[36:39], s41 offen offset:0 lds
    buffer_load_dwordx4 v10, s[36:39], s41 offen offset:1024 lds
    s_add_u32 m0, s43, 0
    s_nop 0
    buffer_load_dwordx4 v4, s[32:35], s40 offen offset:2048 lds
    s_add_u32 m0, s44, 16384
    s_nop 0
    buffer_load_dwordx4 v11, s[36:39], s41 offen offset:0 lds
    buffer_load_dwordx4 v12, s[36:39], s41 offen offset:1024 lds
    s_add_u32 m0, s43, 0
    s_nop 0
    buffer_load_dwordx4 v5, s[32:35], s40 offen offset:3072 lds
    s_mov_b32 m0, 16384
    s_mov_b64 exec, s[46:47]
    buffer_load_dwordx4 v6, s[32:35], s40 offen lds
    s_mov_b64 exec, -1
    s_movk_i32 s40, 512
    s_mov_b32 s41, 1572864
    s_waitcnt vmcnt(13)
    s_barrier
    s_add_u32 m0, s43, 41984
    s_nop 0
    buffer_load_dwordx4 v2, s[32:35], s40 offen offset:0 lds
    s_add_u32 m0, s44, 41984
    s_nop 0
    buffer_load_dwordx4 v7, s[36:39], s41 offen offset:0 lds
    buffer_load_dwordx4 v8, s[36:39], s41 offen offset:1024 lds
    s_add_u32 m0, s43, 41984
    s_nop 0
    buffer_load_dwordx4 v3, s[32:35], s40 offen offset:1024 lds
    s_add_u32 m0, s44, 50176
    s_nop 0
    buffer_load_dwordx4 v9, s[36:39], s41 offen offset:0 lds
    buffer_load_dwordx4 v10, s[36:39], s41 offen offset:1024 lds
    s_add_u32 m0, s43, 41984
    s_nop 0
    buffer_load_dwordx4 v4, s[32:35], s40 offen offset:2048 lds
    s_add_u32 m0, s44, 58368
    s_nop 0
    buffer_load_dwordx4 v11, s[36:39], s41 offen offset:0 lds
    buffer_load_dwordx4 v12, s[36:39], s41 offen offset:1024 lds
    s_add_u32 m0, s43, 41984
    s_nop 0
    buffer_load_dwordx4 v5, s[32:35], s40 offen offset:3072 lds
    s_mov_b32 m0, 58368
    s_mov_b64 exec, s[46:47]
    buffer_load_dwordx4 v6, s[32:35], s40 offen lds
    s_mov_b64 exec, -1
    s_movk_i32 s40, 640
    s_mov_b32 s41, 1966080
    s_cmp_lg_u32 s87, 0
    s_cbranch_scc1 L_stg_6
    s_mov_b32 exec_lo, 0x70000000
    s_mov_b32 exec_hi, 0x777
    s_bfe_u32 s7, s89, 0x30007
    s_cmp_lg_u32 s7, 1
    s_cbranch_scc1 L_wx3_7
    buffer_load_dword v250, v252, s[36:39], s89 offen offset:256
L_wx3_7:
    buffer_load_dword v250, v252, s[36:39], s89 offen
    s_mov_b32 exec_lo, 0x3fc000
    s_mov_b32 exec_hi, 0
    buffer_load_dword v250, v251, s[32:35], s88 offen
    s_mov_b64 exec, -1
L_stg_6:
    s_waitcnt vmcnt(13)
    s_bitcmp1_b32 1, s87
    s_cbranch_scc1 L_mw_8
    s_waitcnt vmcnt(11)
L_mw_8:
    s_barrier
    s_add_u32 m0, s43, 83968
    s_nop 0
    buffer_load_dwordx4 v2, s[32:35], s40 offen offset:0 lds
    s_add_u32 m0, s44, 83968
    s_nop 0
    buffer_load_dwordx4 v7, s[36:39], s41 offen offset:0 lds
    buffer_load_dwordx4 v8, s[36:39], s41 offen offset:1024 lds
    s_add_u32 m0, s43, 83968
    s_nop 0
    buffer_load_dwordx4 v3, s[32:35], s40 offen offset:1024 lds
    s_add_u32 m0, s44, 92160
    s_nop 0
    buffer_load_dwordx4 v9, s[36:39], s41 offen offset:0 lds
    buffer_load_dwordx4 v10, s[36:39], s41 offen offset:1024 lds
    s_add_u32 m0, s43, 83968
    s_nop 0
    buffer_load_dwordx4 v4, s[32:35], s40 offen offset:2048 lds
    s_add_u32 m0, s44, 100352
    s_nop 0
    buffer_load_dwordx4 v11, s[36:39], s41 offen offset:0 lds
    buffer_load_dwordx4 v12, s[36:39], s41 offen offset:1024 lds
    s_add_u32 m0, s43, 83968
    s_nop 0
    buffer_load_dwordx4 v5, s[32:35], s40 offen offset:3072 lds
    s_mov_b32 m0, 100352
    s_mov_b64 exec, s[46:47]
    buffer_load_dwordx4 v6, s[32:35], s40 offen lds
    s_mov_b64 exec, -1
    s_movk_i32 s40, 768
    s_mov_b32 s41, 2359296
    s_cmp_lg_u32 s87, 1
    s_cbranch_scc1 L_stg_9
    s_mov_b32 exec_lo, 0x70000000
    s_mov_b32 exec_hi, 0x777
    s_bfe_u32 s7, s89, 0x30007
    s_cmp_lg_u32 s7, 1
    s_cbranch_scc1 L_wx3_10
    buffer_load_dword v250, v252, s[36:39], s89 offen offset:256
L_wx3_10:
    buffer_load_dword v250, v252, s[36:39], s89 offen
    s_mov_b32 exec_lo, 0x3fc000
    s_mov_b32 exec_hi, 0
    buffer_load_dword v250, v251, s[32:35], s88 offen
    s_mov_b64 exec, -1
L_stg_9:
    s_waitcnt vmcnt(13)
    s_barrier
    s_add_u32 m0, s43, 0
    s_nop 0
    buffer_load_dwordx4 v2, s[32:35], s40 offen offset:0 lds
    s_add_u32 m0, s44, 0
    s_nop 0
    buffer_load_dwordx4 v7, s[36:39], s41 offen offset:0 lds
    buffer_load_dwordx4 v8, s[36:39], s41 offen offset:1024 lds
    s_add_u32 m0, s43, 0
    s_nop 0
    buffer_load_dwordx4 v3, s[32:35], s40 offen offset:1024 lds
    s_add_u32 m0, s44, 8192
    s_nop 0
    buffer_load_dwordx4 v9, s[36:39], s41 offen offset:0 lds
    buffer_load_dwordx4 v10, s[36:39], s41 offen offset:1024 lds
    s_add_u32 m0, s43, 0
    s_nop 0
    buffer_load_dwordx4 v4, s[32:35], s40 offen offset:2048 lds
    s_add_u32 m0, s44, 16384
    s_nop 0
    buffer_load_dwordx4 v11, s[36:39], s41 offen offset:0 lds
    buffer_load_dwordx4 v12, s[36:39], s41 offen offset:1024 lds
    s_add_u32 m0, s43, 0
    s_nop 0
    buffer_load_dwordx4 v5, s[32:35], s40 offen offset:3072 lds
    s_mov_b32 m0, 16384
    s_mov_b64 exec, s[46:47]
    buffer_load_dwordx4 v6, s[32:35], s40 offen lds
    s_mov_b64 exec, -1
    s_movk_i32 s40, 896
    s_mov_b32 s41, 2752512
    s_bfe_u32 s74, s2, 0x20003
    s_lshl2_add_u32 s74, s74, s70
    s_cmp_lg_u32 s74, 0
    s_cbranch_scc1 L_sig_12
    s_mov_b32 s60, s28
    s_mov_b32 s61, s29
    s_mov_b32 s62, 0x100
    s_mov_b32 s63, 0x20000
    s_and_b32 s74, s2, 3
    s_lshl_b32 s74, s74, 6
    s_mov_b64 exec, 1
    buffer_atomic_add v244, off, s[60:63], s74 sc1
    s_mov_b64 exec, -1
L_sig_12:
    s_load_dwordx2 s[90:91], s[16:17], s84 offset:60
    s_load_dwordx2 s[90:91], s[16:17], s84 offset:188
    s_load_dwordx2 s[90:91], s[16:17], s84 offset:316
    s_load_dwordx2 s[90:91], s[16:17], s84 offset:444
    s_waitcnt vmcnt(13)
    s_bitcmp1_b32 2, s87
    s_cbranch_scc1 L_mw_13
    s_waitcnt vmcnt(11)
L_mw_13:
    s_barrier
    s_add_u32 m0, s43, 41984
    s_nop 0
    buffer_load_dwordx4 v2, s[32:35], s40 offen offset:0 lds
    s_add_u32 m0, s44, 41984
    s_nop 0
    buffer_load_dwordx4 v7, s[36:39], s41 offen offset:0 lds
    buffer_load_dwordx4 v8, s[36:39], s41 offen offset:1024 lds
    s_add_u32 m0, s43, 41984
    s_nop 0
    buffer_load_dwordx4 v3, s[32:35], s40 offen offset:1024 lds
    s_add_u32 m0, s44, 50176
    s_nop 0
    buffer_load_dwordx4 v9, s[36:39], s41 offen offset:0 lds
    buffer_load_dwordx4 v10, s[36:39], s41 offen offset:1024 lds
    s_add_u32 m0, s43, 41984
    s_nop 0
    buffer_load_dwordx4 v4, s[32:35], s40 offen offset:2048 lds
    s_add_u32 m0, s44, 58368
    s_nop 0
    buffer_load_dwordx4 v11, s[36:39], s41 offen offset:0 lds
    buffer_load_dwordx4 v12, s[36:39], s41 offen offset:1024 lds
    s_add_u32 m0, s43, 41984
    s_nop 0
    buffer_load_dwordx4 v5, s[32:35], s40 offen offset:3072 lds
    s_mov_b32 m0, 58368
    s_mov_b64 exec, s[46:47]
    buffer_load_dwordx4 v6, s[32:35], s40 offen lds
    s_mov_b64 exec, -1
    s_movk_i32 s40, 1024
    s_mov_b32 s41, 3145728
    s_bfe_u32 s74, s2, 0x20003
    s_lshl2_add_u32 s74, s74, s70
    s_cmp_lg_u32 s74, 4
    s_cbranch_scc1 L_sig_14
    s_mov_b32 s60, s28
    s_mov_b32 s61, s29
    s_mov_b32 s62, 0x100
    s_mov_b32 s63, 0x20000
    s_and_b32 s74, s2, 3
    s_lshl_b32 s74, s74, 6
    s_mov_b64 exec, 1
    buffer_atomic_add v244, off, s[60:63], s74 sc1
    s_mov_b64 exec, -1
L_sig_14:
    s_load_dwordx2 s[90:91], s[16:17], s84 offset:572
    s_load_dwordx2 s[90:91], s[16:17], s84 offset:700
    s_load_dwordx2 s[90:91], s[16:17], s84 offset:828
    s_load_dwordx2 s[90:91], s[16:17], s84 offset:956
    s_waitcnt vmcnt(11)
    s_barrier
    s_add_u32 m0, s43, 83968
    s_nop 0
    buffer_load_dwordx4 v2, s[32:35], s40 offen offset:0 lds
    s_add_u32 m0, s44, 83968
    s_nop 0
    buffer_load_dwordx4 v7, s[36:39], s41 offen offset:0 lds
    buffer_load_dwordx4 v8, s[36:39], s41 offen offset:1024 lds
    s_add_u32 m0, s43, 83968
    s_nop 0
    buffer_load_dwordx4 v3, s[32:35], s40 offen offset:1024 lds
    s_add_u32 m0, s44, 92160
    s_nop 0
    buffer_load_dwordx4 v9, s[36:39], s41 offen offset:0 lds
    buffer_load_dwordx4 v10, s[36:39], s41 offen offset:1024 lds
    s_add_u32 m0, s43, 83968
    s_nop 0
    buffer_load_dwordx4 v4, s[32:35], s40 offen offset:2048 lds
    s_add_u32 m0, s44, 100352
    s_nop 0
    buffer_load_dwordx4 v11, s[36:39], s41 offen offset:0 lds
    buffer_load_dwordx4 v12, s[36:39], s41 offen offset:1024 lds
    s_add_u32 m0, s43, 83968
    s_nop 0
    buffer_load_dwordx4 v5, s[32:35], s40 offen offset:3072 lds
    s_mov_b32 m0, 100352
    s_mov_b64 exec, s[46:47]
    buffer_load_dwordx4 v6, s[32:35], s40 offen lds
    s_mov_b64 exec, -1
    s_movk_i32 s40, 1152
    s_mov_b32 s41, 3538944
    s_cmp_lg_u32 s87, 0
    s_cbranch_scc1 L_stg_16
    s_mov_b32 exec_lo, 0x0
    s_mov_b32 exec_hi, 0x77777000
    s_bfe_u32 s7, s89, 0x30007
    s_cmp_lg_u32 s7, 1
    s_cbranch_scc1 L_wx3_17
    buffer_load_dword v250, v252, s[36:39], s89 offen offset:256
L_wx3_17:
    buffer_load_dword v250, v252, s[36:39], s89 offen
    s_mov_b32 exec_lo, 0xffc00000
    s_mov_b32 exec_hi, 0
    buffer_load_dword v250, v251, s[32:35], s88 offen
    s_mov_b64 exec, -1
L_stg_16:
    s_bfe_u32 s74, s2, 0x20003
    s_lshl2_add_u32 s74, s74, s70
    s_cmp_lg_u32 s74, 8
    s_cbranch_scc1 L_sig_18
    s_mov_b32 s60, s28
    s_mov_b32 s61, s29
    s_mov_b32 s62, 0x100
    s_mov_b32 s63, 0x20000
    s_and_b32 s74, s2, 3
    s_lshl_b32 s74, s74, 6
    s_mov_b64 exec, 1
    buffer_atomic_add v244, off, s[60:63], s74 sc1
    s_mov_b64 exec, -1
L_sig_18:
    s_load_dwordx2 s[90:91], s[16:17], s84 offset:1084
    s_load_dwordx2 s[90:91], s[16:17], s84 offset:1212
    s_load_dwordx2 s[90:91], s[16:17], s84 offset:1340
    s_load_dwordx2 s[90:91], s[16:17], s84 offset:1468
    s_waitcnt vmcnt(13)
    s_bitcmp1_b32 1, s87
    s_cbranch_scc1 L_mw_19
    s_waitcnt vmcnt(11)
L_mw_19:
    s_barrier
    s_add_u32 m0, s43, 0
    s_nop 0
    buffer_load_dwordx4 v2, s[32:35], s40 offen offset:0 lds
    s_add_u32 m0, s44, 0
    s_nop 0
    buffer_load_dwordx4 v7, s[36:39], s41 offen offset:0 lds
    buffer_load_dwordx4 v8, s[36:39], s41 offen offset:1024 lds
    s_add_u32 m0, s43, 0
    s_nop 0
    buffer_load_dwordx4 v3, s[32:35], s40 offen offset:1024 lds
    s_add_u32 m0, s44, 8192
    s_nop 0
    buffer_load_dwordx4 v9, s[36:39], s41 offen offset:0 lds
    buffer_load_dwordx4 v10, s[36:39], s41 offen offset:1024 lds
    s_add_u32 m0, s43, 0
    s_nop 0
    buffer_load_dwordx4 v4, s[32:35], s40 offen offset:2048 lds
    s_add_u32 m0, s44, 16384
    s_nop 0
    buffer_load_dwordx4 v11, s[36:39], s41 offen offset:0 lds
    buffer_load_dwordx4 v12, s[36:39], s41 offen offset:1024 lds
    s_add_u32 m0, s43, 0
    s_nop 0
    buffer_load_dwordx4 v5, s[32:35], s40 offen offset:3072 lds
    s_mov_b32 m0, 16384
    s_mov_b64 exec, s[46:47]
    buffer_load_dwordx4 v6, s[32:35], s40 offen lds
    s_mov_b64 exec, -1
    s_movk_i32 s40, 1280
    s_mov_b32 s41, 3932160
    s_cmp_lg_u32 s87, 1
    s_cbranch_scc1 L_stg_20
    s_mov_b32 exec_lo, 0x0
    s_mov_b32 exec_hi, 0x77777000
    s_bfe_u32 s7, s89, 0x30007
    s_cmp_lg_u32 s7, 1
    s_cbranch_scc1 L_wx3_21
    buffer_load_dword v250, v252, s[36:39], s89 offen offset:256
L_wx3_21:
    buffer_load_dword v250, v252, s[36:39], s89 offen
    s_mov_b32 exec_lo, 0xffc00000
    s_mov_b32 exec_hi, 0
    buffer_load_dword v250, v251, s[32:35], s88 offen
    s_mov_b64 exec, -1
L_stg_20:
    s_bfe_u32 s74, s2, 0x20003
    s_lshl2_add_u32 s74, s74, s70
    s_cmp_lg_u32 s74, 12
    s_cbranch_scc1 L_sig_22
    s_mov_b32 s60, s28
    s_mov_b32 s61, s29
    s_mov_b32 s62, 0x100
    s_mov_b32 s63, 0x20000
    s_and_b32 s74, s2, 3
    s_lshl_b32 s74, s74, 6
    s_mov_b64 exec, 1
    buffer_atomic_add v244, off, s[60:63], s74 sc1
    s_mov_b64 exec, -1
L_sig_22:
    s_load_dwordx2 s[90:91], s[16:17], s84 offset:1596
    s_load_dwordx2 s[90:91], s[16:17], s84 offset:1724
    s_load_dwordx2 s[90:91], s[16:17], s84 offset:1852
    s_load_dwordx2 s[90:91], s[16:17], s84 offset:1980
    s_waitcnt vmcnt(13)
    s_barrier
    s_add_u32 m0, s43, 41984
    s_nop 0
    buffer_load_dwordx4 v2, s[32:35], s40 offen offset:0 lds
    s_add_u32 m0, s44, 41984
    s_nop 0
    buffer_load_dwordx4 v7, s[36:39], s41 offen offset:0 lds
    buffer_load_dwordx4 v8, s[36:39], s41 offen offset:1024 lds
    s_add_u32 m0, s43, 41984
    s_nop 0
    buffer_load_dwordx4 v3, s[32:35], s40 offen offset:1024 lds
    s_add_u32 m0, s44, 50176
    s_nop 0
    buffer_load_dwordx4 v9, s[36:39], s41 offen offset:0 lds
    buffer_load_dwordx4 v10, s[36:39], s41 offen offset:1024 lds
    s_add_u32 m0, s43, 41984
    s_nop 0
    buffer_load_dwordx4 v4, s[32:35], s40 offen offset:2048 lds
    s_add_u32 m0, s44, 58368
    s_nop 0
    buffer_load_dwordx4 v11, s[36:39], s41 offen offset:0 lds
    buffer_load_dwordx4 v12, s[36:39], s41 offen offset:1024 lds
    s_add_u32 m0, s43, 41984
    s_nop 0
    buffer_load_dwordx4 v5, s[32:35], s40 offen offset:3072 lds
    s_mov_b32 m0, 58368
    s_mov_b64 exec, s[46:47]
    buffer_load_dwordx4 v6, s[32:35], s40 offen lds
    s_mov_b64 exec, -1
    s_movk_i32 s40, 1408
    s_mov_b32 s41, 4325376
    s_load_dwordx2 s[90:91], s[16:17], s84 offset:2108
    s_load_dwordx2 s[90:91], s[16:17], s84 offset:2236
    s_load_dwordx2 s[90:91], s[16:17], s84 offset:2364
    s_load_dwordx2 s[90:91], s[16:17], s84 offset:2492
    s_waitcnt vmcnt(13)
    s_bitcmp1_b32 2, s87
    s_cbranch_scc1 L_mw_24
    s_waitcnt vmcnt(11)
L_mw_24:
    s_barrier
    s_add_u32 m0, s43, 83968
    s_nop 0
    buffer_load_dwordx4 v2, s[32:35], s40 offen offset:0 lds
    s_add_u32 m0, s44, 83968
    s_nop 0
    buffer_load_dwordx4 v7, s[36:39], s41 offen offset:0 lds
    buffer_load_dwordx4 v8, s[36:39], s41 offen offset:1024 lds
    s_add_u32 m0, s43, 83968
    s_nop 0
    buffer_load_dwordx4 v3, s[32:35], s40 offen offset:1024 lds
    s_add_u32 m0, s44, 92160
    s_nop 0
    buffer_load_dwordx4 v9, s[36:39], s41 offen offset:0 lds
    buffer_load_dwordx4 v10, s[36:39], s41 offen offset:1024 lds
    s_add_u32 m0, s43, 83968
    s_nop 0
    buffer_load_dwordx4 v4, s[32:35], s40 offen offset:2048 lds
    s_add_u32 m0, s44, 100352
    s_nop 0
    buffer_load_dwordx4 v11, s[36:39], s41 offen offset:0 lds
    buffer_load_dwordx4 v12, s[36:39], s41 offen offset:1024 lds
    s_add_u32 m0, s43, 83968
    s_nop 0
    buffer_load_dwordx4 v5, s[32:35], s40 offen offset:3072 lds
    s_mov_b32 m0, 100352
    s_mov_b64 exec, s[46:47]
    buffer_load_dwordx4 v6, s[32:35], s40 offen lds
    s_mov_b64 exec, -1
    s_movk_i32 s40, 1536
    s_mov_b32 s41, 4718592
    s_load_dwordx2 s[90:91], s[16:17], s84 offset:2620
    s_load_dwordx2 s[90:91], s[16:17], s84 offset:2748
    s_load_dwordx2 s[90:91], s[16:17], s84 offset:2876
    s_load_dwordx2 s[90:91], s[16:17], s84 offset:3004
    s_waitcnt vmcnt(11)
    s_barrier
    s_add_u32 m0, s43, 0
    s_nop 0
    buffer_load_dwordx4 v2, s[32:35], s40 offen offset:0 lds
    s_add_u32 m0, s44, 0
    s_nop 0
    buffer_load_dwordx4 v7, s[36:39], s41 offen offset:0 lds
    buffer_load_dwordx4 v8, s[36:39], s41 offen offset:1024 lds
    s_add_u32 m0, s43, 0
    s_nop 0
    buffer_load_dwordx4 v3, s[32:35], s40 offen offset:1024 lds
    s_add_u32 m0, s44, 8192
    s_nop 0
    buffer_load_dwordx4 v9, s[36:39], s41 offen offset:0 lds
    buffer_load_dwordx4 v10, s[36:39], s41 offen offset:1024 lds
    s_add_u32 m0, s43, 0
    s_nop 0
    buffer_load_dwordx4 v4, s[32:35], s40 offen offset:2048 lds
    s_add_u32 m0, s44, 16384
    s_nop 0
    buffer_load_dwordx4 v11, s[36:39], s41 offen offset:0 lds
    buffer_load_dwordx4 v12, s[36:39], s41 offen offset:1024 lds
    s_add_u32 m0, s43, 0
    s_nop 0
    buffer_load_dwordx4 v5, s[32:35], s40 offen offset:3072 lds
    s_mov_b32 m0, 16384
    s_mov_b64 exec, s[46:47]
    buffer_load_dwordx4 v6, s[32:35], s40 offen lds
    s_mov_b64 exec, -1
    s_movk_i32 s40, 1664
    s_mov_b32 s41, 5111808
    s_load_dwordx2 s[90:91], s[16:17], s84 offset:3132
    s_load_dwordx2 s[90:91], s[16:17], s84 offset:3260
    s_load_dwordx2 s[90:91], s[16:17], s84 offset:3388
    s_load_dwordx2 s[90:91], s[16:17], s84 offset:3516
    s_waitcnt vmcnt(11)
    s_barrier
    s_add_u32 m0, s43, 41984
    s_nop 0
    buffer_load_dwordx4 v2, s[32:35], s40 offen offset:0 lds
    s_add_u32 m0, s44, 41984
    s_nop 0
    buffer_load_dwordx4 v7, s[36:39], s41 offen offset:0 lds
    buffer_load_dwordx4 v8, s[36:39], s41 offen offset:1024 lds
    s_add_u32 m0, s43, 41984
    s_nop 0
    buffer_load_dwordx4 v3, s[32:35], s40 offen offset:1024 lds
    s_add_u32 m0, s44, 50176
    s_nop 0
    buffer_load_dwordx4 v9, s[36:39], s41 offen offset:0 lds
    buffer_load_dwordx4 v10, s[36:39], s41 offen offset:1024 lds
    s_add_u32 m0, s43, 41984
    s_nop 0
    buffer_load_dwordx4 v4, s[32:35], s40 offen offset:2048 lds
    s_add_u32 m0, s44, 58368
    s_nop 0
    buffer_load_dwordx4 v11, s[36:39], s41 offen offset:0 lds
    buffer_load_dwordx4 v12, s[36:39], s41 offen offset:1024 lds
    s_add_u32 m0, s43, 41984
    s_nop 0
    buffer_load_dwordx4 v5, s[32:35], s40 offen offset:3072 lds
    s_mov_b32 m0, 58368
    s_mov_b64 exec, s[46:47]
    buffer_load_dwordx4 v6, s[32:35], s40 offen lds
    s_mov_b64 exec, -1
    s_movk_i32 s40, 1792
    s_mov_b32 s41, 5505024
    s_load_dwordx2 s[90:91], s[16:17], s84 offset:3644
    s_load_dwordx2 s[90:91], s[16:17], s84 offset:3772
    s_load_dwordx2 s[90:91], s[16:17], s84 offset:3900
    s_load_dwordx2 s[90:91], s[16:17], s84 offset:4028
    s_waitcnt vmcnt(11)
    s_barrier
    s_add_u32 m0, s43, 83968
    s_nop 0
    buffer_load_dwordx4 v2, s[32:35], s40 offen offset:0 lds
    s_add_u32 m0, s44, 83968
    s_nop 0
    buffer_load_dwordx4 v7, s[36:39], s41 offen offset:0 lds
    buffer_load_dwordx4 v8, s[36:39], s41 offen offset:1024 lds
    s_add_u32 m0, s43, 83968
    s_nop 0
    buffer_load_dwordx4 v3, s[32:35], s40 offen offset:1024 lds
    s_add_u32 m0, s44, 92160
    s_nop 0
    buffer_load_dwordx4 v9, s[36:39], s41 offen offset:0 lds
    buffer_load_dwordx4 v10, s[36:39], s41 offen offset:1024 lds
    s_add_u32 m0, s43, 83968
    s_nop 0
    buffer_load_dwordx4 v4, s[32:35], s40 offen offset:2048 lds
    s_add_u32 m0, s44, 100352
    s_nop 0
    buffer_load_dwordx4 v11, s[36:39], s41 offen offset:0 lds
    buffer_load_dwordx4 v12, s[36:39], s41 offen offset:1024 lds
    s_add_u32 m0, s43, 83968
    s_nop 0
    buffer_load_dwordx4 v5, s[32:35], s40 offen offset:3072 lds
    s_mov_b32 m0, 100352
    s_mov_b64 exec, s[46:47]
    buffer_load_dwordx4 v6, s[32:35], s40 offen lds
    s_mov_b64 exec, -1
    s_movk_i32 s40, 1920
    s_mov_b32 s41, 5898240
    s_waitcnt vmcnt(11)
    s_barrier
    s_load_dword s76, s[28:29], 0
    s_load_dword s77, s[28:29], 64
    s_load_dword s78, s[28:29], 128
    s_load_dword s79, s[28:29], 192
    s_add_u32 m0, s43, 0
    s_nop 0
    buffer_load_dwordx4 v2, s[32:35], s40 offen offset:0 lds
    s_add_u32 m0, s44, 0
    s_nop 0
    buffer_load_dwordx4 v7, s[36:39], s41 offen offset:0 lds
    buffer_load_dwordx4 v8, s[36:39], s41 offen offset:1024 lds
    s_add_u32 m0, s43, 0
    s_nop 0
    buffer_load_dwordx4 v3, s[32:35], s40 offen offset:1024 lds
    s_add_u32 m0, s44, 8192
    s_nop 0
    buffer_load_dwordx4 v9, s[36:39], s41 offen offset:0 lds
    buffer_load_dwordx4 v10, s[36:39], s41 offen offset:1024 lds
    s_add_u32 m0, s43, 0
    s_nop 0
    buffer_load_dwordx4 v4, s[32:35], s40 offen offset:2048 lds
    s_add_u32 m0, s44, 16384
    s_nop 0
    buffer_load_dwordx4 v11, s[36:39], s41 offen offset:0 lds
    buffer_load_dwordx4 v12, s[36:39], s41 offen offset:1024 lds
    s_add_u32 m0, s43, 0
    s_nop 0
    buffer_load_dwordx4 v5, s[32:35], s40 offen offset:3072 lds
    s_mov_b32 m0, 16384
    s_mov_b64 exec, s[46:47]
    buffer_load_dwordx4 v6, s[32:35], s40 offen lds
    s_mov_b64 exec, -1
    s_movk_i32 s40, 2048
    s_mov_b32 s41, 6291456
    s_cmp_lg_u32 s70, 0
    s_cbranch_scc1 L_pc_done_29
    s_waitcnt lgkmcnt(0)
    s_min_u32 s76, s76, s77
    s_min_u32 s78, s78, s79
    s_min_u32 s76, s76, s78
    s_cmp_ge_u32 s76, 64
    s_cbranch_scc1 L_pc_done_29
    s_mov_b32 s60, s28
    s_mov_b32 s61, s29
    s_mov_b32 s62, 0x100
    s_mov_b32 s63, 0x20000
    v_lshlrev_b32 v20, 6, v0
    s_mov_b32 s74, 131072
    s_mov_b64 exec, 0xf
L_pc_loop_30:
    buffer_load_dword v21, v20, s[60:63], 0 offen sc1
    s_waitcnt vmcnt(0)
    v_cmp_gt_u32 vcc, 64, v21
    s_cbranch_vccz L_pc_done_29
    s_sleep 4
    s_sub_u32 s74, s74, 1
    s_cbranch_scc0 L_pc_loop_30
L_pc_done_29:
    s_mov_b64 exec, -1
    s_waitcnt vmcnt(11)
    s_barrier
    s_add_u32 s56, s30, s85
    s_addc_u32 s57, s31, 0
    s_movk_i32 s58, 4096
    s_mov_b32 s59, 0x20000
    s_add_u32 m0, s81, 0
    s_nop 0
    buffer_load_dwordx4 v224, s[56:59], 0 offen offset:0 sc1 lds
    buffer_load_dwordx4 v224, s[56:59], 0 offen offset:1024 sc1 lds
    buffer_load_dwordx4 v224, s[56:59], 0 offen offset:2048 sc1 lds
    buffer_load_dwordx4 v224, s[56:59], 0 offen offset:3072 sc1 lds
    s_add_u32 m0, s81, 4572
    s_nop 0
    buffer_load_dwordx4 v224, s[56:59], 0 offen offset:0 sc1 lds
    buffer_load_dwordx4 v224, s[56:59], 0 offen offset:1024 sc1 lds
    buffer_load_dwordx4 v224, s[56:59], 0 offen offset:2048 sc1 lds
    buffer_load_dwordx4 v224, s[56:59], 0 offen offset:3072 sc1 lds
    s_waitcnt vmcnt(8)
    s_mov_b64 exec, 1
    ds_add_u32 v227, v244 offset:24
    s_mov_b64 exec, -1
    s_add_u32 s56, s16, s84
    s_addc_u32 s57, s17, 0
    s_movk_i32 s58, 4096
    s_mov_b32 s59, 0x20000
    s_add_u32 m0, s80, 64
    v_mov_b32 v132, 0
    v_mov_b32 v133, 0
    v_mov_b32 v134, 0
    v_mov_b32 v135, 0
    buffer_load_dwordx4 v224, s[56:59], 0 offen offset:0 lds
    buffer_load_dwordx4 v224, s[56:59], 0 offen offset:1024 lds
    buffer_load_dwordx4 v224, s[56:59], 0 offen offset:2048 lds
    buffer_load_dwordx4 v224, s[56:59], 0 offen offset:3072 lds
    s_add_u32 m0, s80, 4304
    s_mov_b64 exec, 0x100
    buffer_load_dwordx4 v[132:135], off, s[56:59], 0
    s_mov_b64 exec, -1
    buffer_load_dwordx4 v224, s[56:59], 14 offen offset:0 lds
    buffer_load_dwordx4 v224, s[56:59], 14 offen offset:1024 lds
    buffer_load_dwordx4 v224, s[56:59], 14 offen offset:2048 lds
    buffer_load_dwordx4 v224, s[56:59], 14 offen offset:3072 lds
    v_lshrrev_b32 v234, 5, v0
    v_mul_u32_u24 v234, 4064, v234
    v_add3_u32 v234, v234, v224, s81
    s_mov_b32 exec_lo, 0xfffffff
    s_mov_b32 exec_hi, 0xfffffff
    ds_write_b128 v234, v[228:231] offset:4096
    s_mov_b64 exec, 1
    ds_write_b32 v234, v228 offset:8668
    s_mov_b64 exec, -1
    s_setprio 3
    s_mov_b32 s60, s24
    s_mov_b32 s61, s25
    s_mov_b32 s62, 0x200000
    s_mov_b32 s63, 0x20000
    s_lshr_b32 s74, s2, 3
    s_lshl2_add_u32 s74, s74, s70
    s_bfe_u32 s75, s2, 0x10002
    s_lshl4_add_u32 s74, s74, s75
    s_lshl_b32 s74, s74, 10
    v_lshrrev_b32 v234, 3, v0
    v_and_b32 v235, 7, v0
    v_lshlrev_b32 v235, 7, v235
    v_lshl_add_u32 v234, v234, 11, v235
    buffer_load_dword v250, v234, s[60:63], s74 offen
    s_mov_b32 s60, s8
    s_mov_b32 s61, s9
    s_mov_b32 s62, 0x400000
    s_mov_b32 s63, 0x20000
    s_movk_i32 s75, 8192
    buffer_load_dwordx4 v[208:211], v225, s[60:63], 0 offen offset:0 nt
    buffer_load_dwordx4 v[212:215], v225, s[60:63], 0 offen offset:2048 nt
    buffer_load_dwordx4 v[216:219], v225, s[60:63], s75 offen offset:0 nt
    buffer_load_dwordx4 v[220:223], v225, s[60:63], s75 offen offset:2048 nt
    s_waitcnt vmcnt(14)
    s_waitcnt vmcnt(5)
    v_cmp_lt_u32 vcc, 3, v0
    v_mov_b32 v140, 4160
    v_lshlrev_b32 v136, 16, v132
    v_cndmask_b32 v140, 0, v140, vcc
    v_alignbit_b32 v137, v133, v132, 16
    v_alignbit_b32 v138, v134, v133, 16
    v_alignbit_b32 v139, v135, v134, 16
    v_add3_u32 v140, v140, v224, s80
    s_mov_b64 exec, 0x1ff
    ds_write_b128 v140, v[136:139]
    s_mov_b64 exec, -1
    ds_read_b128 v[112:115], v233 offset:3584
    ds_read_b64 v[48:49], v232 offset:0
    ds_read_b64 v[50:51], v232 offset:8
    ds_read_b128 v[116:119], v233 offset:3072
    ds_read_b64 v[52:53], v232 offset:512
    ds_read_b64 v[54:55], v232 offset:520
    ds_read_b128 v[120:123], v233 offset:2560
    ds_read_b64 v[56:57], v232 offset:1024
    ds_read_b64 v[58:59], v232 offset:1032
    ds_read_b128 v[124:127], v233 offset:2048
    ds_read_b64 v[60:61], v232 offset:1536
    ds_read_b64 v[62:63], v232 offset:1544
    ds_read_b128 v[128:131], v233 offset:1536
    ds_read_b64 v[64:65], v232 offset:2048
    ds_read_b64 v[66:67], v232 offset:2056
    ds_read_b128 v[132:135], v233 offset:1024
    ds_read_b64 v[68:69], v232 offset:2560
    ds_read_b64 v[70:71], v232 offset:2568
    ds_read_b128 v[136:139], v233 offset:512
    ds_read_b64 v[72:73], v232 offset:3072
    ds_read_b64 v[74:75], v232 offset:3080
    ds_read_b128 v[140:143], v233 offset:0
    ds_read_b64 v[76:77], v232 offset:3584
    ds_read_b64 v[78:79], v232 offset:3592
    s_setprio 1
    s_mov_b32 s74, 3
    s_waitcnt lgkmcnt(0)
    v_mfma_f32_16x16x32_bf16 v[16:19], v[240:243], v[112:115], 0
    v_mfma_f32_16x16x32_bf16 v[20:23], v[240:243], v[116:119], 0
    v_mfma_f32_16x16x32_bf16 v[24:27], v[240:243], v[120:123], 0
    v_mfma_f32_16x16x32_bf16 v[28:31], v[240:243], v[124:127], 0
    v_mfma_f32_16x16x32_bf16 v[32:35], v[240:243], v[128:131], 0
    v_mfma_f32_16x16x32_bf16 v[36:39], v[240:243], v[132:135], 0
    v_mfma_f32_16x16x32_bf16 v[40:43], v[240:243], v[136:139], 0
    v_mfma_f32_16x16x32_bf16 v[44:47], v[240:243], v[140:143], 0
L_conv:
    v_mfma_f32_16x16x32_bf16 v[16:19], v[48:51], v[112:115], v[16:19]
    ds_read_b128 v[144:147], v233 offset:3648
    v_mfma_f32_16x16x32_bf16 v[20:23], v[48:51], v[116:119], v[20:23]
    ds_read_b64 v[80:81], v232 offset:64
    v_mfma_f32_16x16x32_bf16 v[20:23], v[52:55], v[112:115], v[20:23]
    ds_read_b64 v[82:83], v232 offset:72
    v_mfma_f32_16x16x32_bf16 v[24:27], v[48:51], v[120:123], v[24:27]
    ds_read_b128 v[148:151], v233 offset:3136
    v_mfma_f32_16x16x32_bf16 v[24:27], v[52:55], v[116:119], v[24:27]
    ds_read_b64 v[84:85], v232 offset:576
    v_mfma_f32_16x16x32_bf16 v[24:27], v[56:59], v[112:115], v[24:27]
    ds_read_b64 v[86:87], v232 offset:584
    v_mfma_f32_16x16x32_bf16 v[28:31], v[48:51], v[124:127], v[28:31]
    ds_read_b128 v[152:155], v233 offset:2624
    v_mfma_f32_16x16x32_bf16 v[28:31], v[52:55], v[120:123], v[28:31]
    ds_read_b64 v[88:89], v232 offset:1088
    v_mfma_f32_16x16x32_bf16 v[28:31], v[56:59], v[116:119], v[28:31]
    ds_read_b64 v[90:91], v232 offset:1096
    v_mfma_f32_16x16x32_bf16 v[28:31], v[60:63], v[112:115], v[28:31]
    ds_read_b128 v[156:159], v233 offset:2112
    v_mfma_f32_16x16x32_bf16 v[32:35], v[48:51], v[128:131], v[32:35]
    ds_read_b64 v[92:93], v232 offset:1600
    v_mfma_f32_16x16x32_bf16 v[32:35], v[52:55], v[124:127], v[32:35]
    ds_read_b64 v[94:95], v232 offset:1608
    v_mfma_f32_16x16x32_bf16 v[32:35], v[56:59], v[120:123], v[32:35]
    ds_read_b128 v[160:163], v233 offset:1600
    v_mfma_f32_16x16x32_bf16 v[32:35], v[60:63], v[116:119], v[32:35]
    ds_read_b64 v[96:97], v232 offset:2112
    v_mfma_f32_16x16x32_bf16 v[32:35], v[64:67], v[112:115], v[32:35]
    ds_read_b64 v[98:99], v232 offset:2120
    v_mfma_f32_16x16x32_bf16 v[36:39], v[48:51], v[132:135], v[36:39]
    ds_read_b128 v[164:167], v233 offset:1088
    v_mfma_f32_16x16x32_bf16 v[36:39], v[52:55], v[128:131], v[36:39]
    ds_read_b64 v[100:101], v232 offset:2624
    v_mfma_f32_16x16x32_bf16 v[36:39], v[56:59], v[124:127], v[36:39]
    ds_read_b64 v[102:103], v232 offset:2632
    v_mfma_f32_16x16x32_bf16 v[36:39], v[60:63], v[120:123], v[36:39]
    ds_read_b128 v[168:171], v233 offset:576
    v_mfma_f32_16x16x32_bf16 v[36:39], v[64:67], v[116:119], v[36:39]
    ds_read_b64 v[104:105], v232 offset:3136
    v_mfma_f32_16x16x32_bf16 v[36:39], v[68:71], v[112:115], v[36:39]
    ds_read_b64 v[106:107], v232 offset:3144
    v_mfma_f32_16x16x32_bf16 v[40:43], v[48:51], v[136:139], v[40:43]
    ds_read_b128 v[172:175], v233 offset:64
    v_mfma_f32_16x16x32_bf16 v[40:43], v[52:55], v[132:135], v[40:43]
    ds_read_b64 v[108:109], v232 offset:3648
    v_mfma_f32_16x16x32_bf16 v[40:43], v[56:59], v[128:131], v[40:43]
    ds_read_b64 v[110:111], v232 offset:3656
    v_mfma_f32_16x16x32_bf16 v[40:43], v[60:63], v[124:127], v[40:43]
    v_mfma_f32_16x16x32_bf16 v[40:43], v[64:67], v[120:123], v[40:43]
    v_mfma_f32_16x16x32_bf16 v[40:43], v[68:71], v[116:119], v[40:43]
    v_mfma_f32_16x16x32_bf16 v[40:43], v[72:75], v[112:115], v[40:43]
    v_mfma_f32_16x16x32_bf16 v[44:47], v[48:51], v[140:143], v[44:47]
    v_mfma_f32_16x16x32_bf16 v[44:47], v[52:55], v[136:139], v[44:47]
    v_mfma_f32_16x16x32_bf16 v[44:47], v[56:59], v[132:135], v[44:47]
    v_mfma_f32_16x16x32_bf16 v[44:47], v[60:63], v[128:131], v[44:47]
    v_mfma_f32_16x16x32_bf16 v[44:47], v[64:67], v[124:127], v[44:47]
    v_mfma_f32_16x16x32_bf16 v[44:47], v[68:71], v[120:123], v[44:47]
    v_mfma_f32_16x16x32_bf16 v[44:47], v[72:75], v[116:119], v[44:47]
    v_mfma_f32_16x16x32_bf16 v[44:47], v[76:79], v[112:115], v[44:47]
    s_waitcnt lgkmcnt(0)
    v_mfma_f32_16x16x32_bf16 v[16:19], v[80:83], v[144:147], v[16:19]
    ds_read_b128 v[112:115], v233 offset:3712
    v_mfma_f32_16x16x32_bf16 v[20:23], v[80:83], v[148:151], v[20:23]
    ds_read_b64 v[48:49], v232 offset:128
    v_mfma_f32_16x16x32_bf16 v[20:23], v[84:87], v[144:147], v[20:23]
    ds_read_b64 v[50:51], v232 offset:136
    v_mfma_f32_16x16x32_bf16 v[24:27], v[80:83], v[152:155], v[24:27]
    ds_read_b128 v[116:119], v233 offset:3200
    v_mfma_f32_16x16x32_bf16 v[24:27], v[84:87], v[148:151], v[24:27]
    ds_read_b64 v[52:53], v232 offset:640
    v_mfma_f32_16x16x32_bf16 v[24:27], v[88:91], v[144:147], v[24:27]
    ds_read_b64 v[54:55], v232 offset:648
    v_mfma_f32_16x16x32_bf16 v[28:31], v[80:83], v[156:159], v[28:31]
    ds_read_b128 v[120:123], v233 offset:2688
    v_mfma_f32_16x16x32_bf16 v[28:31], v[84:87], v[152:155], v[28:31]
    ds_read_b64 v[56:57], v232 offset:1152
    v_mfma_f32_16x16x32_bf16 v[28:31], v[88:91], v[148:151], v[28:31]
    ds_read_b64 v[58:59], v232 offset:1160
    v_mfma_f32_16x16x32_bf16 v[28:31], v[92:95], v[144:147], v[28:31]
    ds_read_b128 v[124:127], v233 offset:2176
    v_mfma_f32_16x16x32_bf16 v[32:35], v[80:83], v[160:163], v[32:35]
    ds_read_b64 v[60:61], v232 offset:1664
    v_mfma_f32_16x16x32_bf16 v[32:35], v[84:87], v[156:159], v[32:35]
    ds_read_b64 v[62:63], v232 offset:1672
    v_mfma_f32_16x16x32_bf16 v[32:35], v[88:91], v[152:155], v[32:35]
    ds_read_b128 v[128:131], v233 offset:1664
    v_mfma_f32_16x16x32_bf16 v[32:35], v[92:95], v[148:151], v[32:35]
    ds_read_b64 v[64:65], v232 offset:2176
    v_mfma_f32_16x16x32_bf16 v[32:35], v[96:99], v[144:147], v[32:35]
    ds_read_b64 v[66:67], v232 offset:2184
    v_mfma_f32_16x16x32_bf16 v[36:39], v[80:83], v[164:167], v[36:39]
    ds_read_b128 v[132:135], v233 offset:1152
    v_mfma_f32_16x16x32_bf16 v[36:39], v[84:87], v[160:163], v[36:39]
    ds_read_b64 v[68:69], v232 offset:2688
    v_mfma_f32_16x16x32_bf16 v[36:39], v[88:91], v[156:159], v[36:39]
    ds_read_b64 v[70:71], v232 offset:2696
    v_mfma_f32_16x16x32_bf16 v[36:39], v[92:95], v[152:155], v[36:39]
    ds_read_b128 v[136:139], v233 offset:640
    v_mfma_f32_16x16x32_bf16 v[36:39], v[96:99], v[148:151], v[36:39]
    ds_read_b64 v[72:73], v232 offset:3200
    v_mfma_f32_16x16x32_bf16 v[36:39], v[100:103], v[144:147], v[36:39]
    ds_read_b64 v[74:75], v232 offset:3208
    v_mfma_f32_16x16x32_bf16 v[40:43], v[80:83], v[168:171], v[40:43]
    ds_read_b128 v[140:143], v233 offset:128
    v_mfma_f32_16x16x32_bf16 v[40:43], v[84:87], v[164:167], v[40:43]
    ds_read_b64 v[76:77], v232 offset:3712
    v_mfma_f32_16x16x32_bf16 v[40:43], v[88:91], v[160:163], v[40:43]
    ds_read_b64 v[78:79], v232 offset:3720
    v_mfma_f32_16x16x32_bf16 v[40:43], v[92:95], v[156:159], v[40:43]
    v_add_u32 v232, 128, v232
    v_mfma_f32_16x16x32_bf16 v[40:43], v[96:99], v[152:155], v[40:43]
    v_add_u32 v233, 128, v233
    v_mfma_f32_16x16x32_bf16 v[40:43], v[100:103], v[148:151], v[40:43]
    s_sub_u32 s74, s74, 1
    v_mfma_f32_16x16x32_bf16 v[40:43], v[104:107], v[144:147], v[40:43]
    s_cmp_lg_u32 s74, 0
    v_mfma_f32_16x16x32_bf16 v[44:47], v[80:83], v[172:175], v[44:47]
    v_mfma_f32_16x16x32_bf16 v[44:47], v[84:87], v[168:171], v[44:47]
    v_mfma_f32_16x16x32_bf16 v[44:47], v[88:91], v[164:167], v[44:47]
    v_mfma_f32_16x16x32_bf16 v[44:47], v[92:95], v[160:163], v[44:47]
    v_mfma_f32_16x16x32_bf16 v[44:47], v[96:99], v[156:159], v[44:47]
    v_mfma_f32_16x16x32_bf16 v[44:47], v[100:103], v[152:155], v[44:47]
    v_mfma_f32_16x16x32_bf16 v[44:47], v[104:107], v[148:151], v[44:47]
    v_mfma_f32_16x16x32_bf16 v[44:47], v[108:111], v[144:147], v[44:47]
    s_waitcnt lgkmcnt(0)
    s_cbranch_scc1 L_conv
    v_mfma_f32_16x16x32_bf16 v[16:19], v[48:51], v[112:115], v[16:19]
    ds_read_b128 v[144:147], v233 offset:3648
    v_mfma_f32_16x16x32_bf16 v[20:23], v[48:51], v[116:119], v[20:23]
    ds_read_b64 v[80:81], v232 offset:64
    v_mfma_f32_16x16x32_bf16 v[20:23], v[52:55], v[112:115], v[20:23]
    ds_read_b64 v[82:83], v232 offset:72
    v_mfma_f32_16x16x32_bf16 v[24:27], v[48:51], v[120:123], v[24:27]
    ds_read_b128 v[148:151], v233 offset:3136
    v_mfma_f32_16x16x32_bf16 v[24:27], v[52:55], v[116:119], v[24:27]
    ds_read_b64 v[84:85], v232 offset:576
    v_mfma_f32_16x16x32_bf16 v[24:27], v[56:59], v[112:115], v[24:27]
    ds_read_b64 v[86:87], v232 offset:584
    v_mfma_f32_16x16x32_bf16 v[28:31], v[48:51], v[124:127], v[28:31]
    ds_read_b128 v[152:155], v233 offset:2624
    v_mfma_f32_16x16x32_bf16 v[28:31], v[52:55], v[120:123], v[28:31]
    ds_read_b64 v[88:89], v232 offset:1088
    v_mfma_f32_16x16x32_bf16 v[28:31], v[56:59], v[116:119], v[28:31]
    ds_read_b64 v[90:91], v232 offset:1096
    v_mfma_f32_16x16x32_bf16 v[28:31], v[60:63], v[112:115], v[28:31]
    ds_read_b128 v[156:159], v233 offset:2112
    v_mfma_f32_16x16x32_bf16 v[32:35], v[48:51], v[128:131], v[32:35]
    ds_read_b64 v[92:93], v232 offset:1600
    v_mfma_f32_16x16x32_bf16 v[32:35], v[52:55], v[124:127], v[32:35]
    ds_read_b64 v[94:95], v232 offset:1608
    v_mfma_f32_16x16x32_bf16 v[32:35], v[56:59], v[120:123], v[32:35]
    ds_read_b128 v[160:163], v233 offset:1600
    v_mfma_f32_16x16x32_bf16 v[32:35], v[60:63], v[116:119], v[32:35]
    ds_read_b64 v[96:97], v232 offset:2112
    v_mfma_f32_16x16x32_bf16 v[32:35], v[64:67], v[112:115], v[32:35]
    ds_read_b64 v[98:99], v232 offset:2120
    v_mfma_f32_16x16x32_bf16 v[36:39], v[48:51], v[132:135], v[36:39]
    ds_read_b128 v[164:167], v233 offset:1088
    v_mfma_f32_16x16x32_bf16 v[36:39], v[52:55], v[128:131], v[36:39]
    ds_read_b64 v[100:101], v232 offset:2624
    v_mfma_f32_16x16x32_bf16 v[36:39], v[56:59], v[124:127], v[36:39]
    ds_read_b64 v[102:103], v232 offset:2632
    v_mfma_f32_16x16x32_bf16 v[36:39], v[60:63], v[120:123], v[36:39]
    ds_read_b128 v[168:171], v233 offset:576
    v_mfma_f32_16x16x32_bf16 v[36:39], v[64:67], v[116:119], v[36:39]
    ds_read_b64 v[104:105], v232 offset:3136
    v_mfma_f32_16x16x32_bf16 v[36:39], v[68:71], v[112:115], v[36:39]
    ds_read_b64 v[106:107], v232 offset:3144
    v_mfma_f32_16x16x32_bf16 v[40:43], v[48:51], v[136:139], v[40:43]
    ds_read_b128 v[172:175], v233 offset:64
    v_mfma_f32_16x16x32_bf16 v[40:43], v[52:55], v[132:135], v[40:43]
    ds_read_b64 v[108:109], v232 offset:3648
    v_mfma_f32_16x16x32_bf16 v[40:43], v[56:59], v[128:131], v[40:43]
    ds_read_b64 v[110:111], v232 offset:3656
    v_mfma_f32_16x16x32_bf16 v[40:43], v[60:63], v[124:127], v[40:43]
    s_mul_i32 s74, s68, 4224
    v_mfma_f32_16x16x32_bf16 v[40:43], v[64:67], v[120:123], v[40:43]
    s_and_b32 s75, s71, 63
    v_mfma_f32_16x16x32_bf16 v[40:43], v[68:71], v[116:119], v[40:43]
    s_add_u32 s74, s74, s75
    v_mfma_f32_16x16x32_bf16 v[40:43], v[72:75], v[112:115], v[40:43]
    s_lshl_b32 s74, s74, 6
    v_mfma_f32_16x16x32_bf16 v[44:47], v[48:51], v[140:143], v[44:47]
    v_and_b32 v234, 3, v0
    v_mfma_f32_16x16x32_bf16 v[44:47], v[52:55], v[136:139], v[44:47]
    v_lshl_add_u32 v234, v234, 4, s74
    v_mfma_f32_16x16x32_bf16 v[44:47], v[56:59], v[132:135], v[44:47]
    v_and_b32 v235, 12, v0
    v_mfma_f32_16x16x32_bf16 v[44:47], v[60:63], v[128:131], v[44:47]
    v_lshrrev_b32 v236, 4, v0
    v_mfma_f32_16x16x32_bf16 v[44:47], v[64:67], v[124:127], v[44:47]
    v_add_u32 v235, v235, v236
    v_mfma_f32_16x16x32_bf16 v[44:47], v[68:71], v[120:123], v[44:47]
    v_mul_u32_u24 v235, 4224, v235
    v_mfma_f32_16x16x32_bf16 v[44:47], v[72:75], v[116:119], v[44:47]
    v_add_u32 v234, v234, v235
    v_mfma_f32_16x16x32_bf16 v[44:47], v[76:79], v[112:115], v[44:47]
    s_waitcnt lgkmcnt(0)
    v_mfma_f32_16x16x32_bf16 v[16:19], v[80:83], v[144:147], v[16:19]
    s_bfe_u32 s86, s2, 0x10002
    s_lshr_b32 s74, s2, 5
    v_mfma_f32_16x16x32_bf16 v[20:23], v[80:83], v[148:151], v[20:23]
    s_lshl3_add_u32 s86, s86, s74
    v_lshrrev_b32 v236, 4, v0
    v_mfma_f32_16x16x32_bf16 v[20:23], v[84:87], v[144:147], v[20:23]
    v_lshlrev_b32 v236, 1, v236
    v_xor_b32 v236, v0, v236
    v_mfma_f32_16x16x32_bf16 v[24:27], v[80:83], v[152:155], v[24:27]
    v_and_b32 v236, 7, v236
    s_lshl_b32 s74, s86, 7
    v_cvt_pk_bf16_f32 v48, v16, v17
    v_cvt_pk_bf16_f32 v49, v18, v19
    v_mfma_f32_16x16x32_bf16 v[24:27], v[84:87], v[148:151], v[24:27]
    v_lshl_add_u32 v236, v236, 4, s74
    v_lshrrev_b32 v235, 3, v0
    v_cvt_pk_bf16_f32 v50, v20, v21
    v_cvt_pk_bf16_f32 v51, v22, v23
    v_mfma_f32_16x16x32_bf16 v[24:27], v[88:91], v[144:147], v[24:27]
    v_lshl_add_u32 v235, v235, 11, v236
    s_mov_b32 s56, s24
    s_mov_b32 s76, 0
    buffer_store_dwordx4 v[48:51], v234, s[64:67], s76 offen sc1
    v_mfma_f32_16x16x32_bf16 v[28:31], v[80:83], v[156:159], v[28:31]
    s_mov_b32 s57, s25
    s_mov_b32 s58, 0x200000
    v_mfma_f32_16x16x32_bf16 v[28:31], v[84:87], v[152:155], v[28:31]
    s_mov_b32 s59, 0x20000
    s_mul_i32 s74, s86, 4
    v_cvt_pk_bf16_f32 v52, v24, v25
    v_cvt_pk_bf16_f32 v53, v26, v27
    v_mfma_f32_16x16x32_bf16 v[28:31], v[88:91], v[148:151], v[28:31]
    s_and_b32 s74, s74, 7
    s_lshl1_add_u32 s82, s74, s70
    v_mfma_f32_16x16x32_bf16 v[28:31], v[92:95], v[144:147], v[28:31]
    s_lshl_b32 s82, s82, 17
    s_lshl4_add_u32 s73, s68, 256
    v_mfma_f32_16x16x32_bf16 v[32:35], v[80:83], v[160:163], v[32:35]
    s_add_u32 s45, s73, s69
    s_lshl_b32 s73, s73, 8
    v_mfma_f32_16x16x32_bf16 v[32:35], v[84:87], v[156:159], v[32:35]
    s_lshl_b32 s45, s45, 8
    v_mfma_f32_16x16x32_bf16 v[32:35], v[88:91], v[152:155], v[32:35]
    v_mfma_f32_16x16x32_bf16 v[32:35], v[92:95], v[148:151], v[32:35]
    v_mfma_f32_16x16x32_bf16 v[32:35], v[96:99], v[144:147], v[32:35]
    v_cvt_pk_bf16_f32 v54, v28, v29
    v_cvt_pk_bf16_f32 v55, v30, v31
    v_mfma_f32_16x16x32_bf16 v[36:39], v[80:83], v[164:167], v[36:39]
    s_mov_b32 s76, 67584
    buffer_store_dwordx4 v[52:55], v234, s[64:67], s76 offen sc1
    v_mfma_f32_16x16x32_bf16 v[36:39], v[84:87], v[160:163], v[36:39]
    v_mfma_f32_16x16x32_bf16 v[36:39], v[88:91], v[156:159], v[36:39]
    v_mfma_f32_16x16x32_bf16 v[36:39], v[92:95], v[152:155], v[36:39]
    v_cvt_pk_bf16_f32 v56, v32, v33
    v_cvt_pk_bf16_f32 v57, v34, v35
    v_mfma_f32_16x16x32_bf16 v[36:39], v[96:99], v[148:151], v[36:39]
    v_mfma_f32_16x16x32_bf16 v[36:39], v[100:103], v[144:147], v[36:39]
    v_mfma_f32_16x16x32_bf16 v[40:43], v[80:83], v[168:171], v[40:43]
    v_mfma_f32_16x16x32_bf16 v[40:43], v[84:87], v[164:167], v[40:43]
    v_mfma_f32_16x16x32_bf16 v[40:43], v[88:91], v[160:163], v[40:43]
    v_mfma_f32_16x16x32_bf16 v[40:43], v[92:95], v[156:159], v[40:43]
    v_mfma_f32_16x16x32_bf16 v[40:43], v[96:99], v[152:155], v[40:43]
    v_mfma_f32_16x16x32_bf16 v[40:43], v[100:103], v[148:151], v[40:43]
    v_mfma_f32_16x16x32_bf16 v[40:43], v[104:107], v[144:147], v[40:43]
    v_mfma_f32_16x16x32_bf16 v[44:47], v[80:83], v[172:175], v[44:47]
    v_cvt_pk_bf16_f32 v58, v36, v37
    v_cvt_pk_bf16_f32 v59, v38, v39
    v_mfma_f32_16x16x32_bf16 v[44:47], v[84:87], v[168:171], v[44:47]
    s_mov_b32 s76, 135168
    buffer_store_dwordx4 v[56:59], v234, s[64:67], s76 offen sc1
    v_mfma_f32_16x16x32_bf16 v[44:47], v[88:91], v[164:167], v[44:47]
    v_mfma_f32_16x16x32_bf16 v[44:47], v[92:95], v[160:163], v[44:47]
    v_cvt_pk_bf16_f32 v60, v40, v41
    v_cvt_pk_bf16_f32 v61, v42, v43
    v_mfma_f32_16x16x32_bf16 v[44:47], v[96:99], v[156:159], v[44:47]
    v_mfma_f32_16x16x32_bf16 v[44:47], v[100:103], v[152:155], v[44:47]
    v_mfma_f32_16x16x32_bf16 v[44:47], v[104:107], v[148:151], v[44:47]
    v_mfma_f32_16x16x32_bf16 v[44:47], v[108:111], v[144:147], v[44:47]
    s_nop 7
    v_cvt_pk_bf16_f32 v62, v44, v45
    v_cvt_pk_bf16_f32 v63, v46, v47
    s_mov_b32 s76, 202752
    buffer_store_dwordx4 v[60:63], v234, s[64:67], s76 offen sc1
    s_setprio 1
    s_waitcnt vmcnt(0)
    v_mov_b32 v238, 1
    s_mov_b64 exec, 1
    ds_add_rtn_u32 v237, v227, v238 offset:8
    s_waitcnt lgkmcnt(0)
    v_readfirstlane_b32 s76, v237
    s_nop 0
    s_cmp_eq_u32 s76, 3
    s_cbranch_scc0 L_jo_35a
    s_mov_b64 exec, 0xffff
    v_lshlrev_b32 v237, 8, v0
    buffer_atomic_add v238, v237, s[52:55], s73 offen sc1
L_jo_35a:
    s_mov_b64 exec, -1
    v_lshlrev_b32 v112, 16, v208
    v_and_b32 v113, 0xffff0000, v208
    v_lshlrev_b32 v114, 16, v209
    v_and_b32 v115, 0xffff0000, v209
    v_lshlrev_b32 v116, 16, v210
    v_and_b32 v117, 0xffff0000, v210
    v_lshlrev_b32 v118, 16, v211
    v_and_b32 v119, 0xffff0000, v211
    v_lshlrev_b32 v120, 16, v212
    v_and_b32 v121, 0xffff0000, v212
    v_lshlrev_b32 v122, 16, v213
    v_and_b32 v123, 0xffff0000, v213
    v_lshlrev_b32 v124, 16, v214
    v_and_b32 v125, 0xffff0000, v214
    v_lshlrev_b32 v126, 16, v215
    v_and_b32 v127, 0xffff0000, v215
    v_lshlrev_b32 v128, 16, v216
    v_and_b32 v129, 0xffff0000, v216
    v_lshlrev_b32 v130, 16, v217
    v_and_b32 v131, 0xffff0000, v217
    v_lshlrev_b32 v132, 16, v218
    v_and_b32 v133, 0xffff0000, v218
    v_lshlrev_b32 v134, 16, v219
    v_and_b32 v135, 0xffff0000, v219
    v_lshlrev_b32 v136, 16, v220
    v_and_b32 v137, 0xffff0000, v220
    v_lshlrev_b32 v138, 16, v221
    v_and_b32 v139, 0xffff0000, v221
    v_lshlrev_b32 v140, 16, v222
    v_and_b32 v141, 0xffff0000, v222
    v_lshlrev_b32 v142, 16, v223
    v_and_b32 v143, 0xffff0000, v223
    s_setprio 1
    s_add_u32 m0, s80, 0
    s_add_u32 s83, s82, 1310720
    s_and_b32 s83, s83, 0x1fffff
    buffer_load_dwordx4 v235, s[56:59], s83 offen lds
    s_add_u32 m0, s80, 1024
    s_add_u32 s83, s82, 1327104
    s_and_b32 s83, s83, 0x1fffff
    buffer_load_dwordx4 v235, s[56:59], s83 offen lds
    s_add_u32 m0, s80, 2048
    s_add_u32 s83, s82, 1343488
    s_and_b32 s83, s83, 0x1fffff
    buffer_load_dwordx4 v235, s[56:59], s83 offen lds
    s_add_u32 m0, s80, 3072
    s_add_u32 s83, s82, 1359872
    s_and_b32 s83, s83, 0x1fffff
    buffer_load_dwordx4 v235, s[56:59], s83 offen lds
    s_add_u32 m0, s80, 4096
    s_add_u32 s83, s82, 1376256
    s_and_b32 s83, s83, 0x1fffff
    buffer_load_dwordx4 v235, s[56:59], s83 offen lds
    s_add_u32 m0, s80, 5120
    s_add_u32 s83, s82, 1392640
    s_and_b32 s83, s83, 0x1fffff
    buffer_load_dwordx4 v235, s[56:59], s83 offen lds
    s_add_u32 m0, s80, 6144
    s_add_u32 s83, s82, 1409024
    s_and_b32 s83, s83, 0x1fffff
    buffer_load_dwordx4 v235, s[56:59], s83 offen lds
    s_add_u32 m0, s80, 7168
    s_add_u32 s83, s82, 1425408
    s_and_b32 s83, s83, 0x1fffff
    buffer_load_dwordx4 v235, s[56:59], s83 offen lds
    s_cmp_ge_u32 s70, 2
    s_cbranch_scc1 L_nowo3
    s_add_u32 m0, s81, 0
    s_add_u32 s83, s82, 1835008
    s_and_b32 s83, s83, 0x1fffff
    buffer_load_dwordx4 v235, s[56:59], s83 offen lds
    s_add_u32 m0, s81, 1024
    s_add_u32 s83, s82, 1851392
    s_and_b32 s83, s83, 0x1fffff
    buffer_load_dwordx4 v235, s[56:59], s83 offen lds
    s_add_u32 m0, s81, 2048
    s_add_u32 s83, s82, 1867776
    s_and_b32 s83, s83, 0x1fffff
    buffer_load_dwordx4 v235, s[56:59], s83 offen lds
    s_add_u32 m0, s81, 3072
    s_add_u32 s83, s82, 1884160
    s_and_b32 s83, s83, 0x1fffff
    buffer_load_dwordx4 v235, s[56:59], s83 offen lds
    s_add_u32 m0, s81, 4096
    s_add_u32 s83, s82, 1900544
    s_and_b32 s83, s83, 0x1fffff
    buffer_load_dwordx4 v235, s[56:59], s83 offen lds
    s_add_u32 m0, s81, 5120
    s_add_u32 s83, s82, 1916928
    s_and_b32 s83, s83, 0x1fffff
    buffer_load_dwordx4 v235, s[56:59], s83 offen lds
    s_add_u32 m0, s81, 6144
    s_add_u32 s83, s82, 1933312
    s_and_b32 s83, s83, 0x1fffff
    buffer_load_dwordx4 v235, s[56:59], s83 offen lds
    s_add_u32 m0, s81, 7168
    s_add_u32 s83, s82, 1949696
    s_and_b32 s83, s83, 0x1fffff
    buffer_load_dwordx4 v235, s[56:59], s83 offen lds
L_nowo3:
    s_setprio 1
    s_mul_i32 s77, s70, 4352
    s_add_u32 s77, s77, 60416
    v_lshrrev_b32 v234, 5, v0
    v_lshl_add_u32 v234, v234, 1, v0
    v_lshl_add_u32 v234, v234, 4, s77
    v_and_b32 v235, 7, v0
    v_mul_u32_u24 v235, 544, v235
    v_lshrrev_b32 v236, 3, v0
    v_lshl_add_u32 v235, v236, 3, v235
    v_add_u32 v235, s77, v235
    s_mul_i32 s77, s71, 4224
    s_mov_b32 s60, s26
    s_mov_b32 s61, s27
    s_mov_b32 s62, 0x800000
    s_mov_b32 s63, 0x20000
    s_waitcnt vmcnt(0)
    s_mov_b64 exec, 1
    ds_add_u32 v227, v244 offset:12
    s_mov_b64 exec, -1
    s_cmp_eq_u32 s76, 3
    s_cbranch_scc0 L_jo_35
    s_mov_b32 s75, 131072
L_sg_loop_38:
    s_load_dword s74, s[52:53], s45 glc
L_sg_chk_39:
    s_waitcnt lgkmcnt(0)
    s_cmp_ge_u32 s74, 16
    s_cbranch_scc1 L_sg_done_37
    s_sub_u32 s75, s75, 1
    s_cbranch_scc0 L_sg_loop_38
L_sg_done_37:
    v_mov_b32 v237, 16
    s_mov_b64 exec, 1
    ds_add_u32 v227, v237 offset:16
    s_mov_b64 exec, -1
    s_branch L_jd_36
L_jo_35:
    s_mov_b32 s75, 1048576
L_sl_loop_41:
    ds_read_b32 v237, v227 offset:16
    s_waitcnt lgkmcnt(0)
    v_readfirstlane_b32 s74, v237
    s_nop 0
    s_cmp_ge_u32 s74, 16
    s_cbranch_scc1 L_sl_done_40
    s_sleep 1
    s_sub_u32 s75, s75, 1
    s_cbranch_scc0 L_sl_loop_41
L_sl_done_40:
L_jd_36:
    buffer_load_dwordx4 v[48:51], v224, s[64:67], s77 offen offset:0 sc1
    buffer_load_dwordx4 v[52:55], v224, s[64:67], s77 offen offset:1024 sc1
    buffer_load_dwordx4 v[56:59], v224, s[64:67], s77 offen offset:2048 sc1
    buffer_load_dwordx4 v[60:63], v224, s[64:67], s77 offen offset:3072 sc1
    s_waitcnt vmcnt(3)
    ds_write_b128 v234, v[48:51] offset:0
    s_waitcnt vmcnt(2)
    ds_write_b128 v234, v[52:55] offset:1088
    s_waitcnt vmcnt(1)
    ds_write_b128 v234, v[56:59] offset:2176
    s_waitcnt vmcnt(0)
    ds_write_b128 v234, v[60:63] offset:3264
    ds_read_b64 v[64:65], v235 offset:0
    ds_read_b64 v[66:67], v235 offset:64
    ds_read_b64 v[68:69], v235 offset:128
    ds_read_b64 v[70:71], v235 offset:192
    ds_read_b64 v[72:73], v235 offset:256
    ds_read_b64 v[74:75], v235 offset:320
    ds_read_b64 v[76:77], v235 offset:384
    ds_read_b64 v[78:79], v235 offset:448
    s_waitcnt lgkmcnt(7)
    v_lshlrev_b32 v16, 16, v64
    v_and_b32 v24, 0xffff0000, v64
    v_lshlrev_b32 v32, 16, v65
    v_and_b32 v40, 0xffff0000, v65
    s_waitcnt lgkmcnt(6)
    v_lshlrev_b32 v17, 16, v66
    v_and_b32 v25, 0xffff0000, v66
    v_lshlrev_b32 v33, 16, v67
    v_and_b32 v41, 0xffff0000, v67
    s_waitcnt lgkmcnt(5)
    v_lshlrev_b32 v18, 16, v68
    v_and_b32 v26, 0xffff0000, v68
    v_lshlrev_b32 v34, 16, v69
    v_and_b32 v42, 0xffff0000, v69
    s_waitcnt lgkmcnt(4)
    v_lshlrev_b32 v19, 16, v70
    v_and_b32 v27, 0xffff0000, v70
    v_lshlrev_b32 v35, 16, v71
    v_and_b32 v43, 0xffff0000, v71
    s_waitcnt lgkmcnt(3)
    v_lshlrev_b32 v20, 16, v72
    v_and_b32 v28, 0xffff0000, v72
    v_lshlrev_b32 v36, 16, v73
    v_and_b32 v44, 0xffff0000, v73
    s_waitcnt lgkmcnt(2)
    v_lshlrev_b32 v21, 16, v74
    v_and_b32 v29, 0xffff0000, v74
    v_lshlrev_b32 v37, 16, v75
    v_and_b32 v45, 0xffff0000, v75
    s_waitcnt lgkmcnt(1)
    v_lshlrev_b32 v22, 16, v76
    v_and_b32 v30, 0xffff0000, v76
    v_lshlrev_b32 v38, 16, v77
    v_and_b32 v46, 0xffff0000, v77
    s_waitcnt lgkmcnt(0)
    v_lshlrev_b32 v23, 16, v78
    v_and_b32 v31, 0xffff0000, v78
    v_lshlrev_b32 v39, 16, v79
    v_and_b32 v47, 0xffff0000, v79
    v_mul_f32 v16, v16, v112
    v_mul_f32 v17, v17, v113
    v_mul_f32 v18, v18, v114
    v_mul_f32 v19, v19, v115
    v_mul_f32 v20, v20, v116
    v_mul_f32 v21, v21, v117
    v_mul_f32 v22, v22, v118
    v_mul_f32 v23, v23, v119
    v_cvt_pk_bf16_f32 v48, v16, v17
    v_cvt_pk_bf16_f32 v49, v18, v19
    v_cvt_pk_bf16_f32 v50, v20, v21
    v_cvt_pk_bf16_f32 v51, v22, v23
    s_mov_b32 s74, 0
    buffer_store_dwordx4 v[48:51], v226, s[60:63], s74 offen nt
    v_mul_f32 v24, v24, v120
    v_mul_f32 v25, v25, v121
    v_mul_f32 v26, v26, v122
    v_mul_f32 v27, v27, v123
    v_mul_f32 v28, v28, v124
    v_mul_f32 v29, v29, v125
    v_mul_f32 v30, v30, v126
    v_mul_f32 v31, v31, v127
    v_cvt_pk_bf16_f32 v52, v24, v25
    v_cvt_pk_bf16_f32 v53, v26, v27
    v_cvt_pk_bf16_f32 v54, v28, v29
    v_cvt_pk_bf16_f32 v55, v30, v31
    s_mov_b32 s74, 4096
    buffer_store_dwordx4 v[52:55], v226, s[60:63], s74 offen nt
    v_mul_f32 v32, v32, v128
    v_mul_f32 v33, v33, v129
    v_mul_f32 v34, v34, v130
    v_mul_f32 v35, v35, v131
    v_mul_f32 v36, v36, v132
    v_mul_f32 v37, v37, v133
    v_mul_f32 v38, v38, v134
    v_mul_f32 v39, v39, v135
    v_cvt_pk_bf16_f32 v56, v32, v33
    v_cvt_pk_bf16_f32 v57, v34, v35
    v_cvt_pk_bf16_f32 v58, v36, v37
    v_cvt_pk_bf16_f32 v59, v38, v39
    s_mov_b32 s74, 16384
    buffer_store_dwordx4 v[56:59], v226, s[60:63], s74 offen nt
    v_mul_f32 v40, v40, v136
    v_mul_f32 v41, v41, v137
    v_mul_f32 v42, v42, v138
    v_mul_f32 v43, v43, v139
    v_mul_f32 v44, v44, v140
    v_mul_f32 v45, v45, v141
    v_mul_f32 v46, v46, v142
    v_mul_f32 v47, v47, v143
    v_cvt_pk_bf16_f32 v60, v40, v41
    v_cvt_pk_bf16_f32 v61, v42, v43
    v_cvt_pk_bf16_f32 v62, v44, v45
    v_cvt_pk_bf16_f32 v63, v46, v47
    s_mov_b32 s74, 20480
    buffer_store_dwordx4 v[60:63], v226, s[60:63], s74 offen nt
    s_endpgm
L_grole:
    s_setprio 2
    s_add_u32 s52, s30, 0xe00000
    s_addc_u32 s53, s31, 0
    s_mov_b32 s54, 0x20000
    s_mov_b32 s55, 0x20000
    s_lshr_b32 s32, s3, 1
    s_and_b32 s33, s3, 1
    v_and_b32 v1, 15, v0
    v_lshrrev_b32 v2, 4, v0
    v_lshrrev_b32 v3, 1, v1
    v_xor_b32 v3, v2, v3
    v_lshlrev_b32 v3, 4, v3
    v_lshl_add_u32 v3, v1, 7, v3
    s_lshl_b32 s37, s33, 13
    v_add_u32 v196, s37, v3
    v_xor_b32 v197, 64, v196
    v_and_b32 v3, 6, v1
    v_xor_b32 v3, v2, v3
    v_lshlrev_b32 v3, 4, v3
    v_and_b32 v198, 7, v1
    v_lshl_add_u32 v3, v198, 7, v3
    v_add_u32 v198, 16384, v3
    v_xor_b32 v199, 64, v198
    v_bfe_u32 v3, v0, 2, 2
    v_lshl_add_u32 v200, v2, 3, v3
    v_lshlrev_b32 v200, 7, v200
    v_bfe_u32 v3, v0, 3, 2
    v_xor_b32 v3, s3, v3
    v_lshl_add_u32 v200, v3, 5, v200
    v_and_b32 v3, 3, v0
    v_lshl_add_u32 v200, v3, 3, v200
    v_add_u32 v200, 17408, v200
    v_xor_b32 v201, 32, v200
    v_mov_b64 v[52:53], 0
    v_mov_b64 v[54:55], 0
    v_mov_b64 v[56:57], 0
    v_mov_b64 v[58:59], 0
    v_mov_b64 v[60:61], 0
    v_mov_b64 v[62:63], 0
    v_mov_b64 v[64:65], 0
    v_mov_b64 v[66:67], 0
    v_mov_b64 v[68:69], 0
    v_mov_b64 v[70:71], 0
    v_mov_b64 v[72:73], 0
    v_mov_b64 v[74:75], 0
    v_mov_b64 v[76:77], 0
    v_mov_b64 v[78:79], 0
    v_mov_b64 v[80:81], 0
    v_mov_b64 v[82:83], 0
    v_mov_b64 v[84:85], 0
    v_mov_b64 v[86:87], 0
    v_mov_b64 v[88:89], 0
    v_mov_b64 v[90:91], 0
    v_mov_b64 v[92:93], 0
    v_mov_b64 v[94:95], 0
    v_mov_b64 v[96:97], 0
    v_mov_b64 v[98:99], 0
    v_mov_b64 v[100:101], 0
    v_mov_b64 v[102:103], 0
    v_mov_b64 v[104:105], 0
    v_mov_b64 v[106:107], 0
    s_mov_b32 s34, 0
    v_mov_b32 v228, 134352
    v_and_b32 v1, 15, v0
    v_lshrrev_b32 v2, 4, v0
    v_lshlrev_b32 v2, 2, v2
    v_sub_u32 v1, v1, v2
    s_mov_b32 s37, 0xf149f2ca
    v_mov_b32 v3, s37
    s_or_b32 s38, s5, s33
    s_cmp_eq_u32 s38, 0
    s_cselect_b32 s38, s37, 0
    v_subrev_u32 v2, 0, v1
    v_cmp_gt_u32 vcc, 8, v2
    v_cmp_gt_i32 s[64:65], -8, v2
    v_ashrrev_i32 v2, 31, v2
    v_cndmask_b32 v204, v3, 0, vcc
    v_cndmask_b32 v208, v3, 0, s[64:65]
    v_mov_b32 v216, v2
    v_min_f32 v212, s38, v208
    v_subrev_u32 v2, 1, v1
    v_cmp_gt_u32 vcc, 8, v2
    v_cmp_gt_i32 s[64:65], -8, v2
    v_ashrrev_i32 v2, 31, v2
    v_cndmask_b32 v205, v3, 0, vcc
    v_cndmask_b32 v209, v3, 0, s[64:65]
    v_alignbit_b32 v216, v2, v216, 16
    v_min_f32 v213, s38, v209
    v_subrev_u32 v2, 2, v1
    v_cmp_gt_u32 vcc, 8, v2
    v_cmp_gt_i32 s[64:65], -8, v2
    v_ashrrev_i32 v2, 31, v2
    v_cndmask_b32 v206, v3, 0, vcc
    v_cndmask_b32 v210, v3, 0, s[64:65]
    v_mov_b32 v217, v2
    v_min_f32 v214, s38, v210
    v_subrev_u32 v2, 3, v1
    v_cmp_gt_u32 vcc, 8, v2
    v_cmp_gt_i32 s[64:65], -8, v2
    v_ashrrev_i32 v2, 31, v2
    v_cndmask_b32 v207, v3, 0, vcc
    v_cndmask_b32 v211, v3, 0, s[64:65]
    v_alignbit_b32 v217, v2, v217, 16
    v_min_f32 v215, s38, v211
    s_mul_i32 s37, s32, 80896
    s_add_u32 s37, s37, 78848
    v_lshl_add_u32 v220, v0, 3, s37
    s_lshl_b32 s38, s33, 9
    v_add_u32 v219, s38, v220
    s_mul_i32 s38, s33, 2560
    v_add_u32 v221, s38, v220
    v_xor_b32 v222, 512, v221
    s_lshl3_add_u32 s37, s4, s5
    s_lshl1_add_u32 s37, s37, s33
    s_lshl_b32 s37, s37, 7
    s_lshl1_add_u32 s38, s6, s32
    s_add_u32 s37, s37, s38
    s_lshl_b32 s37, s37, 10
    v_lshl_add_u32 v218, v0, 4, s37
    s_mov_b32 s40, s30
    s_mov_b32 s41, s31
    s_mov_b32 s42, 0x400000
    s_mov_b32 s43, 0x20000
    s_and_b32 s58, s2, 3
    s_bfe_u32 s37, s2, 0x20003
    s_lshl2_add_u32 s58, s58, s37
    s_bfe_u32 s59, s2, 0x10002
    s_lshr_b32 s37, s2, 5
    s_lshl3_add_u32 s59, s59, s37
    s_mov_b32 s44, s24
    s_mov_b32 s45, s25
    s_mov_b32 s46, 0x200000
    s_mov_b32 s47, 0x20000
    s_mov_b32 s48, s26
    s_mov_b32 s49, s27
    s_mov_b32 s50, 0x800000
    s_mov_b32 s51, 0x20000
    s_lshl3_add_u32 s56, s4, s5
    s_lshl4_add_u32 s56, s56, 0
    s_lshl_b32 s56, s56, 8
    s_lshl4_add_u32 s57, s58, 0
    s_add_u32 s57, s57, s59
    s_lshl_b32 s57, s57, 8
    s_lshl2_add_u32 s37, s58, s3
    s_lshl_b32 s38, s37, 16
    v_lshl_add_u32 v224, v0, 4, s38
    v_add_u32 v225, 0x8000, v224
    s_and_b32 s37, s37, 31
    s_lshl_b32 s37, s37, 6
    s_lshr_b32 s38, s58, 3
    s_add_u32 s37, s37, s38
    s_lshl_b32 s37, s37, 5
    s_add_u32 s37, s37, s59
    s_add_u32 s37, s37, 16
    s_lshl_b32 s37, s37, 7
    v_lshrrev_b32 v1, 3, v0
    v_lshl_add_u32 v1, v1, 13, s37
    v_and_b32 v2, 7, v0
    v_lshl_add_u32 v226, v2, 4, v1
    v_lshrrev_b32 v1, 4, v0
    v_lshlrev_b32 v1, 1, v1
    v_xor_b32 v1, v0, v1
    v_and_b32 v1, 7, v1
    s_lshl_b32 s37, s59, 7
    v_lshl_add_u32 v1, v1, 4, s37
    v_lshrrev_b32 v227, 3, v0
    v_lshl_add_u32 v227, v227, 11, v1
    s_lshl_b32 s60, s3, 11
    s_mul_i32 s61, s59, 4
    s_and_b32 s61, s61, 7
    s_lshl3_add_u32 s62, s61, s3
    s_lshl_b32 s62, s62, 15
    v_lshrrev_b32 v1, 2, v0
    v_lshlrev_b32 v1, 7, v1
    v_bfe_u32 v2, v0, 3, 2
    v_lshl_add_u32 v1, v2, 5, v1
    v_and_b32 v2, 3, v0
    v_lshl_add_u32 v229, v2, 3, v1
    v_and_b32 v231, 7, v0
    v_lshl_add_u32 v230, v231, 6, s86
    v_mul_u32_u24 v231, 528, v231
    v_lshrrev_b32 v232, 3, v0
    v_xor_b32 v232, 7, v232
    v_lshl_add_u32 v231, v232, 3, v231
    v_add_u32 v231, s86, v231
    v_lshrrev_b32 v232, 5, v0
    v_add_u32 v232, v0, v232
    v_lshl_add_u32 v232, v232, 4, s86
    s_mul_i32 s87, s84, 4224
    s_sub_u32 s87, s87, s85
    s_lshl_b32 s87, s87, 6
    s_add_u32 s87, s87, 4032
    v_and_b32 v233, 3, v0
    v_lshl_add_u32 v233, v233, 4, s87
    v_lshrrev_b32 v234, 2, v0
    v_mul_u32_u24 v234, 4224, v234
    v_add_u32 v233, v233, v234
    s_add_u32 s80, s30, 0x400000
    s_addc_u32 s81, s31, 0
    s_mov_b32 s82, 0x420000
    s_mov_b32 s83, 0x20000
    s_waitcnt vmcnt(13)
    ds_read_b128 v[36:39], v230 offset:4224
    ds_read_b128 v[40:43], v230 offset:4240
    ds_read_b128 v[44:47], v230 offset:4256
    ds_read_b128 v[48:51], v230 offset:4272
    s_waitcnt lgkmcnt(3)
    v_lshlrev_b32 v152, 16, v36
    v_and_b32 v154, 0xffff0000, v36
    v_lshlrev_b32 v156, 16, v37
    v_and_b32 v158, 0xffff0000, v37
    v_lshlrev_b32 v153, 16, v38
    v_and_b32 v155, 0xffff0000, v38
    v_lshlrev_b32 v157, 16, v39
    v_and_b32 v159, 0xffff0000, v39
    s_waitcnt lgkmcnt(2)
    v_lshlrev_b32 v160, 16, v40
    v_and_b32 v162, 0xffff0000, v40
    v_lshlrev_b32 v164, 16, v41
    v_and_b32 v166, 0xffff0000, v41
    v_lshlrev_b32 v161, 16, v42
    v_and_b32 v163, 0xffff0000, v42
    v_lshlrev_b32 v165, 16, v43
    v_and_b32 v167, 0xffff0000, v43
    s_waitcnt lgkmcnt(1)
    v_lshlrev_b32 v168, 16, v44
    v_and_b32 v170, 0xffff0000, v44
    v_lshlrev_b32 v172, 16, v45
    v_and_b32 v174, 0xffff0000, v45
    v_lshlrev_b32 v169, 16, v46
    v_and_b32 v171, 0xffff0000, v46
    v_lshlrev_b32 v173, 16, v47
    v_and_b32 v175, 0xffff0000, v47
    s_waitcnt lgkmcnt(0)
    v_lshlrev_b32 v176, 16, v48
    v_and_b32 v178, 0xffff0000, v48
    v_lshlrev_b32 v180, 16, v49
    v_and_b32 v182, 0xffff0000, v49
    v_lshlrev_b32 v177, 16, v50
    v_and_b32 v179, 0xffff0000, v50
    v_lshlrev_b32 v181, 16, v51
    v_and_b32 v183, 0xffff0000, v51
    v_mov_b64 v[36:37], 0
    v_mov_b64 v[38:39], 0
    v_mov_b64 v[40:41], 0
    v_mov_b64 v[42:43], 0
    v_mov_b64 v[44:45], 0
    v_mov_b64 v[46:47], 0
    v_mov_b64 v[48:49], 0
    v_mov_b64 v[50:51], 0
    s_waitcnt vmcnt(12)
    v_lshlrev_b32 v184, 16, v108
    v_and_b32 v185, 0xffff0000, v108
    v_lshlrev_b32 v186, 16, v109
    v_and_b32 v187, 0xffff0000, v109
    v_lshlrev_b32 v188, 16, v110
    v_and_b32 v189, 0xffff0000, v110
    v_lshlrev_b32 v190, 16, v111
    v_and_b32 v191, 0xffff0000, v111
    v_pk_mul_f32 v[4:5], v[184:185], v[158:159]
    v_pk_mul_f32 v[12:13], v[186:187], v[166:167]
    v_pk_mul_f32 v[20:21], v[188:189], v[174:175]
    v_pk_mul_f32 v[28:29], v[190:191], v[182:183]
    s_waitcnt vmcnt(11)
    v_lshlrev_b32 v184, 16, v112
    v_and_b32 v185, 0xffff0000, v112
    v_lshlrev_b32 v186, 16, v113
    v_and_b32 v187, 0xffff0000, v113
    v_lshlrev_b32 v188, 16, v114
    v_and_b32 v189, 0xffff0000, v114
    v_lshlrev_b32 v190, 16, v115
    v_and_b32 v191, 0xffff0000, v115
    v_pk_fma_f32 v[4:5], v[184:185], v[156:157], v[4:5]
    v_pk_fma_f32 v[12:13], v[186:187], v[164:165], v[12:13]
    v_pk_fma_f32 v[20:21], v[188:189], v[172:173], v[20:21]
    v_pk_fma_f32 v[28:29], v[190:191], v[180:181], v[28:29]
    v_pk_mul_f32 v[6:7], v[184:185], v[158:159]
    v_pk_mul_f32 v[14:15], v[186:187], v[166:167]
    v_pk_mul_f32 v[22:23], v[188:189], v[174:175]
    v_pk_mul_f32 v[30:31], v[190:191], v[182:183]
    s_waitcnt vmcnt(10)
    v_lshlrev_b32 v184, 16, v116
    v_and_b32 v185, 0xffff0000, v116
    v_lshlrev_b32 v186, 16, v117
    v_and_b32 v187, 0xffff0000, v117
    v_lshlrev_b32 v188, 16, v118
    v_and_b32 v189, 0xffff0000, v118
    v_lshlrev_b32 v190, 16, v119
    v_and_b32 v191, 0xffff0000, v119
    v_pk_fma_f32 v[4:5], v[184:185], v[154:155], v[4:5]
    v_pk_fma_f32 v[12:13], v[186:187], v[162:163], v[12:13]
    v_pk_fma_f32 v[20:21], v[188:189], v[170:171], v[20:21]
    v_pk_fma_f32 v[28:29], v[190:191], v[178:179], v[28:29]
    v_pk_fma_f32 v[6:7], v[184:185], v[156:157], v[6:7]
    v_pk_fma_f32 v[14:15], v[186:187], v[164:165], v[14:15]
    v_pk_fma_f32 v[22:23], v[188:189], v[172:173], v[22:23]
    v_pk_fma_f32 v[30:31], v[190:191], v[180:181], v[30:31]
    v_pk_mul_f32 v[8:9], v[184:185], v[158:159]
    v_pk_mul_f32 v[16:17], v[186:187], v[166:167]
    v_pk_mul_f32 v[24:25], v[188:189], v[174:175]
    v_pk_mul_f32 v[32:33], v[190:191], v[182:183]
    s_waitcnt vmcnt(9)
    v_lshlrev_b32 v184, 16, v120
    v_and_b32 v185, 0xffff0000, v120
    v_lshlrev_b32 v186, 16, v121
    v_and_b32 v187, 0xffff0000, v121
    v_lshlrev_b32 v188, 16, v122
    v_and_b32 v189, 0xffff0000, v122
    v_lshlrev_b32 v190, 16, v123
    v_and_b32 v191, 0xffff0000, v123
    v_pk_fma_f32 v[4:5], v[184:185], v[152:153], v[4:5]
    v_pk_fma_f32 v[12:13], v[186:187], v[160:161], v[12:13]
    v_pk_fma_f32 v[20:21], v[188:189], v[168:169], v[20:21]
    v_pk_fma_f32 v[28:29], v[190:191], v[176:177], v[28:29]
    v_pk_fma_f32 v[6:7], v[184:185], v[154:155], v[6:7]
    v_pk_fma_f32 v[14:15], v[186:187], v[162:163], v[14:15]
    v_pk_fma_f32 v[22:23], v[188:189], v[170:171], v[22:23]
    v_pk_fma_f32 v[30:31], v[190:191], v[178:179], v[30:31]
    v_pk_fma_f32 v[8:9], v[184:185], v[156:157], v[8:9]
    v_pk_fma_f32 v[16:17], v[186:187], v[164:165], v[16:17]
    v_pk_fma_f32 v[24:25], v[188:189], v[172:173], v[24:25]
    v_pk_fma_f32 v[32:33], v[190:191], v[180:181], v[32:33]
    v_pk_mul_f32 v[10:11], v[184:185], v[158:159]
    v_pk_mul_f32 v[18:19], v[186:187], v[166:167]
    v_pk_mul_f32 v[26:27], v[188:189], v[174:175]
    v_pk_mul_f32 v[34:35], v[190:191], v[182:183]
    s_waitcnt vmcnt(8)
    v_lshlrev_b32 v184, 16, v124
    v_and_b32 v185, 0xffff0000, v124
    v_lshlrev_b32 v186, 16, v125
    v_and_b32 v187, 0xffff0000, v125
    v_lshlrev_b32 v188, 16, v126
    v_and_b32 v189, 0xffff0000, v126
    v_lshlrev_b32 v190, 16, v127
    v_and_b32 v191, 0xffff0000, v127
    v_pk_fma_f32 v[6:7], v[184:185], v[152:153], v[6:7]
    v_pk_fma_f32 v[14:15], v[186:187], v[160:161], v[14:15]
    v_pk_fma_f32 v[22:23], v[188:189], v[168:169], v[22:23]
    v_pk_fma_f32 v[30:31], v[190:191], v[176:177], v[30:31]
    v_pk_fma_f32 v[8:9], v[184:185], v[154:155], v[8:9]
    v_pk_fma_f32 v[16:17], v[186:187], v[162:163], v[16:17]
    v_pk_fma_f32 v[24:25], v[188:189], v[170:171], v[24:25]
    v_pk_fma_f32 v[32:33], v[190:191], v[178:179], v[32:33]
    v_pk_fma_f32 v[10:11], v[184:185], v[156:157], v[10:11]
    v_pk_fma_f32 v[18:19], v[186:187], v[164:165], v[18:19]
    v_pk_fma_f32 v[26:27], v[188:189], v[172:173], v[26:27]
    v_pk_fma_f32 v[34:35], v[190:191], v[180:181], v[34:35]
    s_waitcnt vmcnt(7)
    v_lshlrev_b32 v184, 16, v128
    v_and_b32 v185, 0xffff0000, v128
    v_lshlrev_b32 v186, 16, v129
    v_and_b32 v187, 0xffff0000, v129
    v_lshlrev_b32 v188, 16, v130
    v_and_b32 v189, 0xffff0000, v130
    v_lshlrev_b32 v190, 16, v131
    v_and_b32 v191, 0xffff0000, v131
    v_pk_fma_f32 v[8:9], v[184:185], v[152:153], v[8:9]
    v_pk_fma_f32 v[16:17], v[186:187], v[160:161], v[16:17]
    v_pk_fma_f32 v[24:25], v[188:189], v[168:169], v[24:25]
    v_pk_fma_f32 v[32:33], v[190:191], v[176:177], v[32:33]
    v_pk_fma_f32 v[10:11], v[184:185], v[154:155], v[10:11]
    v_pk_fma_f32 v[18:19], v[186:187], v[162:163], v[18:19]
    v_pk_fma_f32 v[26:27], v[188:189], v[170:171], v[26:27]
    v_pk_fma_f32 v[34:35], v[190:191], v[178:179], v[34:35]
    s_waitcnt vmcnt(6)
    v_lshlrev_b32 v184, 16, v132
    v_and_b32 v185, 0xffff0000, v132
    v_lshlrev_b32 v186, 16, v133
    v_and_b32 v187, 0xffff0000, v133
    v_lshlrev_b32 v188, 16, v134
    v_and_b32 v189, 0xffff0000, v134
    v_lshlrev_b32 v190, 16, v135
    v_and_b32 v191, 0xffff0000, v135
    v_pk_fma_f32 v[10:11], v[184:185], v[152:153], v[10:11]
    v_pk_fma_f32 v[18:19], v[186:187], v[160:161], v[18:19]
    v_pk_fma_f32 v[26:27], v[188:189], v[168:169], v[26:27]
    v_pk_fma_f32 v[34:35], v[190:191], v[176:177], v[34:35]
    s_waitcnt vmcnt(5)
    v_lshlrev_b32 v184, 16, v136
    v_and_b32 v185, 0xffff0000, v136
    v_lshlrev_b32 v186, 16, v137
    v_and_b32 v187, 0xffff0000, v137
    v_lshlrev_b32 v188, 16, v138
    v_and_b32 v189, 0xffff0000, v138
    v_lshlrev_b32 v190, 16, v139
    v_and_b32 v191, 0xffff0000, v139
    v_pk_mul_f32 v[4:5], v[4:5], v[184:185]
    v_pk_mul_f32 v[12:13], v[12:13], v[186:187]
    v_pk_mul_f32 v[20:21], v[20:21], v[188:189]
    v_pk_mul_f32 v[28:29], v[28:29], v[190:191]
    s_waitcnt vmcnt(4)
    v_lshlrev_b32 v184, 16, v140
    v_and_b32 v185, 0xffff0000, v140
    v_lshlrev_b32 v186, 16, v141
    v_and_b32 v187, 0xffff0000, v141
    v_lshlrev_b32 v188, 16, v142
    v_and_b32 v189, 0xffff0000, v142
    v_lshlrev_b32 v190, 16, v143
    v_and_b32 v191, 0xffff0000, v143
    v_pk_mul_f32 v[6:7], v[6:7], v[184:185]
    v_pk_mul_f32 v[14:15], v[14:15], v[186:187]
    v_pk_mul_f32 v[22:23], v[22:23], v[188:189]
    v_pk_mul_f32 v[30:31], v[30:31], v[190:191]
    s_waitcnt vmcnt(3)
    v_lshlrev_b32 v184, 16, v144
    v_and_b32 v185, 0xffff0000, v144
    v_lshlrev_b32 v186, 16, v145
    v_and_b32 v187, 0xffff0000, v145
    v_lshlrev_b32 v188, 16, v146
    v_and_b32 v189, 0xffff0000, v146
    v_lshlrev_b32 v190, 16, v147
    v_and_b32 v191, 0xffff0000, v147
    v_pk_mul_f32 v[8:9], v[8:9], v[184:185]
    v_pk_mul_f32 v[16:17], v[16:17], v[186:187]
    v_pk_mul_f32 v[24:25], v[24:25], v[188:189]
    v_pk_mul_f32 v[32:33], v[32:33], v[190:191]
    s_waitcnt vmcnt(2)
    v_lshlrev_b32 v184, 16, v148
    v_and_b32 v185, 0xffff0000, v148
    v_lshlrev_b32 v186, 16, v149
    v_and_b32 v187, 0xffff0000, v149
    v_lshlrev_b32 v188, 16, v150
    v_and_b32 v189, 0xffff0000, v150
    v_lshlrev_b32 v190, 16, v151
    v_and_b32 v191, 0xffff0000, v151
    v_pk_mul_f32 v[10:11], v[10:11], v[184:185]
    v_pk_mul_f32 v[18:19], v[18:19], v[186:187]
    v_pk_mul_f32 v[26:27], v[26:27], v[188:189]
    v_pk_mul_f32 v[34:35], v[34:35], v[190:191]
    v_cvt_pk_bf16_f32 v108, v10, v8
    v_cvt_pk_bf16_f32 v109, v6, v4
    ds_write_b64 v231, v[108:109] offset:0
    v_cvt_pk_bf16_f32 v110, v11, v9
    v_cvt_pk_bf16_f32 v111, v7, v5
    ds_write_b64 v231, v[110:111] offset:64
    v_cvt_pk_bf16_f32 v112, v18, v16
    v_cvt_pk_bf16_f32 v113, v14, v12
    ds_write_b64 v231, v[112:113] offset:128
    v_cvt_pk_bf16_f32 v114, v19, v17
    v_cvt_pk_bf16_f32 v115, v15, v13
    ds_write_b64 v231, v[114:115] offset:192
    v_cvt_pk_bf16_f32 v116, v26, v24
    v_cvt_pk_bf16_f32 v117, v22, v20
    ds_write_b64 v231, v[116:117] offset:256
    v_cvt_pk_bf16_f32 v118, v27, v25
    v_cvt_pk_bf16_f32 v119, v23, v21
    ds_write_b64 v231, v[118:119] offset:320
    v_cvt_pk_bf16_f32 v120, v34, v32
    v_cvt_pk_bf16_f32 v121, v30, v28
    ds_write_b64 v231, v[120:121] offset:384
    v_cvt_pk_bf16_f32 v122, v35, v33
    v_cvt_pk_bf16_f32 v123, v31, v29
    ds_write_b64 v231, v[122:123] offset:448
    ds_read_b128 v[152:155], v232 offset:0
    ds_read_b128 v[156:159], v232 offset:1056
    ds_read_b128 v[160:163], v232 offset:2112
    ds_read_b128 v[164:167], v232 offset:3168
    v_mov_b64 v[4:5], 0
    v_mov_b64 v[6:7], 0
    v_mov_b64 v[8:9], 0
    v_mov_b64 v[10:11], 0
    v_mov_b64 v[12:13], 0
    v_mov_b64 v[14:15], 0
    v_mov_b64 v[16:17], 0
    v_mov_b64 v[18:19], 0
    v_mov_b64 v[20:21], 0
    v_mov_b64 v[22:23], 0
    v_mov_b64 v[24:25], 0
    v_mov_b64 v[26:27], 0
    v_mov_b64 v[28:29], 0
    v_mov_b64 v[30:31], 0
    v_mov_b64 v[32:33], 0
    v_mov_b64 v[34:35], 0
    s_waitcnt lgkmcnt(0)
    s_mov_b32 s87, 0
    buffer_store_dwordx4 v[152:155], v233, s[80:83], s87 offen sc1
    s_mov_b32 s87, 67584
    buffer_store_dwordx4 v[156:159], v233, s[80:83], s87 offen sc1
    s_mov_b32 s87, 135168
    buffer_store_dwordx4 v[160:163], v233, s[80:83], s87 offen sc1
    s_mov_b32 s87, 202752
    buffer_store_dwordx4 v[164:167], v233, s[80:83], s87 offen sc1
    s_and_b32 s37, s2, 7
    s_xor_b32 s37, s37, 2
    s_lshl_b32 s37, s37, 5
    s_lshr_b32 s38, s2, 3
    s_add_u32 s37, s37, s38
    s_add_u32 s37, s37, 256
    s_lshl_b32 s37, s37, 8
    s_cmp_eq_u32 s33, 0
    s_cselect_b32 s37, s37, s57
    s_cmp_eq_u32 s32, 0
    s_cbranch_scc0 L_noclear
    s_mov_b64 exec, 1
    buffer_store_dword v4, off, s[52:55], s37 sc1
    s_mov_b64 exec, -1
L_noclear:
    s_mov_b32 s37, 41984
    s_mov_b32 s36, 15
    s_barrier
    ds_read_b128 v[108:111], v196 offset:0
    ds_read_b64_tr_b16 v[128:129], v200 offset:0
    ds_read_b64_tr_b16 v[130:131], v200 offset:512
    ds_read_b128 v[112:115], v196 offset:2048
    ds_read_b64_tr_b16 v[132:133], v201 offset:0
    ds_read_b64_tr_b16 v[134:135], v201 offset:512
    ds_read_b128 v[116:119], v196 offset:4096
    ds_read_b64_tr_b16 v[136:137], v200 offset:8192
    ds_read_b64_tr_b16 v[138:139], v200 offset:8704
    ds_read_b128 v[120:123], v196 offset:6144
    ds_read_b64_tr_b16 v[140:141], v201 offset:8192
    ds_read_b64_tr_b16 v[142:143], v201 offset:8704
    ds_read_b128 v[124:127], v198
    ds_read_b64_tr_b16 v[144:145], v200 offset:16384
    ds_read_b64_tr_b16 v[146:147], v200 offset:16896
    ds_read_b64_tr_b16 v[148:149], v201 offset:16384
    ds_read_b64_tr_b16 v[150:151], v201 offset:16896
    s_waitcnt lgkmcnt(0)
L_g1_loop:
    v_mfma_f32_16x16x32_bf16 v[4:7], v[128:131], v[108:111], v[4:7]
    ds_read_b128 v[152:155], v197 offset:0
    v_mfma_f32_16x16x32_bf16 v[12:15], v[128:131], v[112:115], v[12:15]
    ds_read_b64_tr_b16 v[172:173], v200 offset:4096
    v_mfma_f32_16x16x32_bf16 v[20:23], v[128:131], v[116:119], v[20:23]
    ds_read_b64_tr_b16 v[174:175], v200 offset:4608
    v_mfma_f32_16x16x32_bf16 v[28:31], v[128:131], v[120:123], v[28:31]
    ds_read_b128 v[156:159], v197 offset:2048
    v_mfma_f32_16x16x32_bf16 v[32:35], v[132:135], v[120:123], v[32:35]
    ds_read_b64_tr_b16 v[176:177], v201 offset:4096
    v_mfma_f32_16x16x32_bf16 v[24:27], v[132:135], v[116:119], v[24:27]
    ds_read_b64_tr_b16 v[178:179], v201 offset:4608
    v_mfma_f32_16x16x32_bf16 v[16:19], v[132:135], v[112:115], v[16:19]
    ds_read_b128 v[160:163], v197 offset:4096
    v_mfma_f32_16x16x32_bf16 v[8:11], v[132:135], v[108:111], v[8:11]
    ds_read_b64_tr_b16 v[180:181], v200 offset:12288
    v_mfma_f32_16x16x32_bf16 v[40:43], v[140:143], v[108:111], v[40:43]
    ds_read_b64_tr_b16 v[182:183], v200 offset:12800
    v_mfma_f32_16x16x32_bf16 v[48:51], v[140:143], v[112:115], v[48:51]
    ds_read_b128 v[164:167], v197 offset:6144
    v_mfma_f32_16x16x32_bf16 v[56:59], v[140:143], v[116:119], v[56:59]
    ds_read_b64_tr_b16 v[184:185], v201 offset:12288
    v_mfma_f32_16x16x32_bf16 v[64:67], v[140:143], v[120:123], v[64:67]
    ds_read_b64_tr_b16 v[186:187], v201 offset:12800
    v_mfma_f32_16x16x32_bf16 v[60:63], v[136:139], v[120:123], v[60:63]
    ds_read_b128 v[168:171], v199
    v_mfma_f32_16x16x32_bf16 v[52:55], v[136:139], v[116:119], v[52:55]
    ds_read_b64_tr_b16 v[188:189], v200 offset:20480
    v_mfma_f32_16x16x32_bf16 v[44:47], v[136:139], v[112:115], v[44:47]
    ds_read_b64_tr_b16 v[190:191], v200 offset:20992
    v_mfma_f32_16x16x32_bf16 v[36:39], v[136:139], v[108:111], v[36:39]
    ds_read_b64_tr_b16 v[192:193], v201 offset:20480
    v_mfma_f32_16x16x32_bf16 v[100:103], v[136:139], v[124:127], v[100:103]
    ds_read_b64_tr_b16 v[194:195], v201 offset:20992
    v_mfma_f32_16x16x32_bf16 v[104:107], v[124:127], v[144:147], v[104:107]
    ds_read_b32 v1, v228 offset:24
    v_mfma_f32_16x16x32_bf16 v[68:71], v[108:111], v[144:147], v[68:71]
    s_add_u32 s34, s34, 41984
    s_cmp_eq_u32 s34, 125952
    v_mfma_f32_16x16x32_bf16 v[76:79], v[112:115], v[144:147], v[76:79]
    s_cselect_b32 s35, -83968, s37
    s_cselect_b32 s34, 0, s34
    v_mfma_f32_16x16x32_bf16 v[84:87], v[116:119], v[144:147], v[84:87]
    s_bitcmp1_b32 0x1002, s36
    v_add_u32 v196, s35, v196
    v_mfma_f32_16x16x32_bf16 v[92:95], v[120:123], v[144:147], v[92:95]
    v_add_u32 v197, s35, v197
    v_add_u32 v198, s35, v198
    v_mfma_f32_16x16x32_bf16 v[96:99], v[120:123], v[148:151], v[96:99]
    v_add_u32 v199, s35, v199
    v_add_u32 v200, s35, v200
    v_mfma_f32_16x16x32_bf16 v[88:91], v[116:119], v[148:151], v[88:91]
    v_add_u32 v201, s35, v201
    v_mfma_f32_16x16x32_bf16 v[80:83], v[112:115], v[148:151], v[80:83]
    s_waitcnt lgkmcnt(0)
    v_mfma_f32_16x16x32_bf16 v[72:75], v[108:111], v[148:151], v[72:75]
    s_cbranch_scc1 L_g1_rare
L_g1_bar:
    s_barrier
L_g1_nobar:
    v_mfma_f32_16x16x32_bf16 v[4:7], v[172:175], v[152:155], v[4:7]
    ds_read_b128 v[108:111], v196 offset:0
    v_mfma_f32_16x16x32_bf16 v[12:15], v[172:175], v[156:159], v[12:15]
    ds_read_b64_tr_b16 v[128:129], v200 offset:0
    v_mfma_f32_16x16x32_bf16 v[20:23], v[172:175], v[160:163], v[20:23]
    ds_read_b64_tr_b16 v[130:131], v200 offset:512
    v_mfma_f32_16x16x32_bf16 v[28:31], v[172:175], v[164:167], v[28:31]
    ds_read_b128 v[112:115], v196 offset:2048
    v_mfma_f32_16x16x32_bf16 v[32:35], v[176:179], v[164:167], v[32:35]
    ds_read_b64_tr_b16 v[132:133], v201 offset:0
    v_mfma_f32_16x16x32_bf16 v[24:27], v[176:179], v[160:163], v[24:27]
    ds_read_b64_tr_b16 v[134:135], v201 offset:512
    v_mfma_f32_16x16x32_bf16 v[16:19], v[176:179], v[156:159], v[16:19]
    ds_read_b128 v[116:119], v196 offset:4096
    v_mfma_f32_16x16x32_bf16 v[8:11], v[176:179], v[152:155], v[8:11]
    ds_read_b64_tr_b16 v[136:137], v200 offset:8192
    v_mfma_f32_16x16x32_bf16 v[40:43], v[184:187], v[152:155], v[40:43]
    ds_read_b64_tr_b16 v[138:139], v200 offset:8704
    v_mfma_f32_16x16x32_bf16 v[48:51], v[184:187], v[156:159], v[48:51]
    ds_read_b128 v[120:123], v196 offset:6144
    v_mfma_f32_16x16x32_bf16 v[56:59], v[184:187], v[160:163], v[56:59]
    ds_read_b64_tr_b16 v[140:141], v201 offset:8192
    v_mfma_f32_16x16x32_bf16 v[64:67], v[184:187], v[164:167], v[64:67]
    ds_read_b64_tr_b16 v[142:143], v201 offset:8704
    v_mfma_f32_16x16x32_bf16 v[60:63], v[180:183], v[164:167], v[60:63]
    ds_read_b128 v[124:127], v198
    v_mfma_f32_16x16x32_bf16 v[52:55], v[180:183], v[160:163], v[52:55]
    ds_read_b64_tr_b16 v[144:145], v200 offset:16384
    v_mfma_f32_16x16x32_bf16 v[44:47], v[180:183], v[156:159], v[44:47]
    ds_read_b64_tr_b16 v[146:147], v200 offset:16896
    v_mfma_f32_16x16x32_bf16 v[36:39], v[180:183], v[152:155], v[36:39]
    ds_read_b64_tr_b16 v[148:149], v201 offset:16384
    v_mfma_f32_16x16x32_bf16 v[100:103], v[180:183], v[168:171], v[100:103]
    ds_read_b64_tr_b16 v[150:151], v201 offset:16896
    v_mfma_f32_16x16x32_bf16 v[104:107], v[168:171], v[188:191], v[104:107]
    s_sub_u32 s36, s36, 1
    v_mfma_f32_16x16x32_bf16 v[68:71], v[152:155], v[188:191], v[68:71]
    s_cmp_lg_u32 s36, 0
    v_mfma_f32_16x16x32_bf16 v[76:79], v[156:159], v[188:191], v[76:79]
    v_mfma_f32_16x16x32_bf16 v[84:87], v[160:163], v[188:191], v[84:87]
    v_mfma_f32_16x16x32_bf16 v[92:95], v[164:167], v[188:191], v[92:95]
    v_mfma_f32_16x16x32_bf16 v[96:99], v[164:167], v[192:195], v[96:99]
    v_mfma_f32_16x16x32_bf16 v[88:91], v[160:163], v[192:195], v[88:91]
    v_mfma_f32_16x16x32_bf16 v[80:83], v[156:159], v[192:195], v[80:83]
    s_waitcnt lgkmcnt(0)
    v_mfma_f32_16x16x32_bf16 v[72:75], v[152:155], v[192:195], v[72:75]
    s_cbranch_scc1 L_g1_loop
    v_mfma_f32_16x16x32_bf16 v[4:7], v[128:131], v[108:111], v[4:7]
    ds_read_b128 v[152:155], v197 offset:0
    v_mfma_f32_16x16x32_bf16 v[12:15], v[128:131], v[112:115], v[12:15]
    ds_read_b64_tr_b16 v[172:173], v200 offset:4096
    v_mfma_f32_16x16x32_bf16 v[20:23], v[128:131], v[116:119], v[20:23]
    ds_read_b64_tr_b16 v[174:175], v200 offset:4608
    v_mfma_f32_16x16x32_bf16 v[28:31], v[128:131], v[120:123], v[28:31]
    ds_read_b128 v[156:159], v197 offset:2048
    v_mfma_f32_16x16x32_bf16 v[32:35], v[132:135], v[120:123], v[32:35]
    ds_read_b64_tr_b16 v[176:177], v201 offset:4096
    v_mfma_f32_16x16x32_bf16 v[24:27], v[132:135], v[116:119], v[24:27]
    ds_read_b64_tr_b16 v[178:179], v201 offset:4608
    v_mfma_f32_16x16x32_bf16 v[16:19], v[132:135], v[112:115], v[16:19]
    ds_read_b128 v[160:163], v197 offset:4096
    v_mfma_f32_16x16x32_bf16 v[8:11], v[132:135], v[108:111], v[8:11]
    ds_read_b64_tr_b16 v[180:181], v200 offset:12288
    v_mfma_f32_16x16x32_bf16 v[40:43], v[140:143], v[108:111], v[40:43]
    ds_read_b64_tr_b16 v[182:183], v200 offset:12800
    v_mfma_f32_16x16x32_bf16 v[48:51], v[140:143], v[112:115], v[48:51]
    ds_read_b128 v[164:167], v197 offset:6144
    v_mfma_f32_16x16x32_bf16 v[56:59], v[140:143], v[116:119], v[56:59]
    ds_read_b64_tr_b16 v[184:185], v201 offset:12288
    v_mfma_f32_16x16x32_bf16 v[64:67], v[140:143], v[120:123], v[64:67]
    ds_read_b64_tr_b16 v[186:187], v201 offset:12800
    v_mfma_f32_16x16x32_bf16 v[60:63], v[136:139], v[120:123], v[60:63]
    ds_read_b128 v[168:171], v199
    v_mfma_f32_16x16x32_bf16 v[52:55], v[136:139], v[116:119], v[52:55]
    ds_read_b64_tr_b16 v[188:189], v200 offset:20480
    v_mfma_f32_16x16x32_bf16 v[44:47], v[136:139], v[112:115], v[44:47]
    ds_read_b64_tr_b16 v[190:191], v200 offset:20992
    v_mfma_f32_16x16x32_bf16 v[36:39], v[136:139], v[108:111], v[36:39]
    ds_read_b64_tr_b16 v[192:193], v201 offset:20480
    v_mfma_f32_16x16x32_bf16 v[100:103], v[136:139], v[124:127], v[100:103]
    ds_read_b64_tr_b16 v[194:195], v201 offset:20992
    v_mfma_f32_16x16x32_bf16 v[104:107], v[124:127], v[144:147], v[104:107]
    v_mfma_f32_16x16x32_bf16 v[68:71], v[108:111], v[144:147], v[68:71]
    v_mfma_f32_16x16x32_bf16 v[76:79], v[112:115], v[144:147], v[76:79]
    v_mfma_f32_16x16x32_bf16 v[84:87], v[116:119], v[144:147], v[84:87]
    v_mfma_f32_16x16x32_bf16 v[92:95], v[120:123], v[144:147], v[92:95]
    v_mfma_f32_16x16x32_bf16 v[96:99], v[120:123], v[148:151], v[96:99]
    v_mfma_f32_16x16x32_bf16 v[88:91], v[116:119], v[148:151], v[88:91]
    v_mfma_f32_16x16x32_bf16 v[80:83], v[112:115], v[148:151], v[80:83]
    v_mfma_f32_16x16x32_bf16 v[72:75], v[108:111], v[148:151], v[72:75]
    s_waitcnt lgkmcnt(0)
    s_setprio 2
    v_mov_b32 v2, 1
    v_mfma_f32_16x16x32_bf16 v[100:103], v[180:183], v[168:171], v[100:103]
    v_mfma_f32_16x16x32_bf16 v[104:107], v[168:171], v[188:191], v[104:107]
    v_mfma_f32_16x16x32_bf16 v[60:63], v[180:183], v[164:167], v[60:63]
    v_mfma_f32_16x16x32_bf16 v[64:67], v[184:187], v[164:167], v[64:67]
    v_mfma_f32_16x16x32_bf16 v[92:95], v[164:167], v[188:191], v[92:95]
    v_mfma_f32_16x16x32_bf16 v[96:99], v[164:167], v[192:195], v[96:99]
    v_mfma_f32_16x16x32_bf16 v[28:31], v[172:175], v[164:167], v[28:31]
    v_mfma_f32_16x16x32_bf16 v[32:35], v[176:179], v[164:167], v[32:35]
    v_mfma_f32_16x16x32_bf16 v[52:55], v[180:183], v[160:163], v[52:55]
    v_cvt_pk_bf16_f32 v144, v100, v101
    v_cvt_pk_bf16_f32 v145, v102, v103
    v_mfma_f32_16x16x32_bf16 v[56:59], v[184:187], v[160:163], v[56:59]
    ds_write_b64 v219, v[144:145]
    v_cvt_pk_bf16_f32 v146, v104, v105
    v_mfma_f32_16x16x32_bf16 v[20:23], v[172:175], v[160:163], v[20:23]
    v_cvt_pk_bf16_f32 v147, v106, v107
    ds_write_b64 v219, v[146:147] offset:1024
    v_mfma_f32_16x16x32_bf16 v[24:27], v[176:179], v[160:163], v[24:27]
    v_cvt_pk_bf16_f32 v140, v60, v61
    v_cvt_pk_bf16_f32 v141, v62, v63
    v_mfma_f32_16x16x32_bf16 v[44:47], v[180:183], v[156:159], v[44:47]
    v_cvt_pk_bf16_f32 v142, v64, v65
    v_cvt_pk_bf16_f32 v143, v66, v67
    v_mfma_f32_16x16x32_bf16 v[48:51], v[184:187], v[156:159], v[48:51]
    v_cvt_pk_bf16_f32 v238, v92, v93
    v_cvt_pk_bf16_f32 v239, v94, v95
    v_mfma_f32_16x16x32_bf16 v[12:15], v[172:175], v[156:159], v[12:15]
    v_cvt_pk_bf16_f32 v248, v96, v97
    v_cvt_pk_bf16_f32 v249, v98, v99
    v_mfma_f32_16x16x32_bf16 v[16:19], v[176:179], v[156:159], v[16:19]
    s_cmp_eq_u32 s33, 0
    s_cbranch_scc0 L_at_nopub
    ds_write_b64 v220, v[140:141] offset:2048
    ds_write_b64 v220, v[238:239] offset:3072
    ds_write_b64 v220, v[142:143] offset:2560
    ds_write_b64 v220, v[248:249] offset:3584
L_at_nopub:
    s_mov_b64 exec, 1
    ds_add_u32 v228, v2 offset:20
    s_mov_b64 exec, -1
    v_cvt_pk_bf16_f32 v120, v28, v29
    v_mfma_f32_16x16x32_bf16 v[36:39], v[180:183], v[152:155], v[36:39]
    v_cvt_pk_bf16_f32 v121, v30, v31
    v_cvt_pk_bf16_f32 v122, v32, v33
    v_mfma_f32_16x16x32_bf16 v[40:43], v[184:187], v[152:155], v[40:43]
    v_cvt_pk_bf16_f32 v123, v34, v35
    v_cvt_pk_bf16_f32 v136, v52, v53
    v_mfma_f32_16x16x32_bf16 v[4:7], v[172:175], v[152:155], v[4:7]
    v_cvt_pk_bf16_f32 v137, v54, v55
    v_cvt_pk_bf16_f32 v138, v56, v57
    v_mfma_f32_16x16x32_bf16 v[8:11], v[176:179], v[152:155], v[8:11]
    v_cvt_pk_bf16_f32 v139, v58, v59
    v_cvt_pk_bf16_f32 v116, v20, v21
    v_mfma_f32_16x16x32_bf16 v[84:87], v[160:163], v[188:191], v[84:87]
    v_cvt_pk_bf16_f32 v117, v22, v23
    v_cvt_pk_bf16_f32 v118, v24, v25
    v_mfma_f32_16x16x32_bf16 v[88:91], v[160:163], v[192:195], v[88:91]
    v_cvt_pk_bf16_f32 v119, v26, v27
    v_cvt_pk_bf16_f32 v132, v44, v45
    v_mfma_f32_16x16x32_bf16 v[76:79], v[156:159], v[188:191], v[76:79]
    v_cvt_pk_bf16_f32 v133, v46, v47
    v_cvt_pk_bf16_f32 v134, v48, v49
    v_mfma_f32_16x16x32_bf16 v[80:83], v[156:159], v[192:195], v[80:83]
    v_cvt_pk_bf16_f32 v135, v50, v51
    v_cvt_pk_bf16_f32 v112, v12, v13
    v_mfma_f32_16x16x32_bf16 v[68:71], v[152:155], v[188:191], v[68:71]
    v_cvt_pk_bf16_f32 v113, v14, v15
    v_cvt_pk_bf16_f32 v114, v16, v17
    v_mfma_f32_16x16x32_bf16 v[72:75], v[152:155], v[192:195], v[72:75]
    v_cvt_pk_bf16_f32 v115, v18, v19
    v_cvt_pk_bf16_f32 v128, v36, v37
    v_mfma_f32_16x16x32_bf16 v[28:31], v[140:143], v[120:123], v[204:207]
    v_cvt_pk_bf16_f32 v129, v38, v39
    v_cvt_pk_bf16_f32 v130, v40, v41
    v_mfma_f32_16x16x32_bf16 v[32:35], v[136:139], v[120:123], v[208:211]
    v_cvt_pk_bf16_f32 v131, v42, v43
    v_cvt_pk_bf16_f32 v108, v4, v5
    v_mfma_f32_16x16x32_bf16 v[20:23], v[136:139], v[116:119], v[204:207]
    v_cvt_pk_bf16_f32 v109, v6, v7
    v_cvt_pk_bf16_f32 v110, v8, v9
    v_mfma_f32_16x16x32_bf16 v[24:27], v[132:135], v[116:119], v[208:211]
    v_cvt_pk_bf16_f32 v111, v10, v11
    v_cvt_pk_bf16_f32 v236, v84, v85
    v_mfma_f32_16x16x32_bf16 v[12:15], v[132:135], v[112:115], v[204:207]
    v_cvt_pk_bf16_f32 v237, v86, v87
    v_cvt_pk_bf16_f32 v246, v88, v89
    v_mfma_f32_16x16x32_bf16 v[16:19], v[128:131], v[112:115], v[208:211]
    v_cvt_pk_bf16_f32 v247, v90, v91
    v_cvt_pk_bf16_f32 v234, v76, v77
    v_mfma_f32_16x16x32_bf16 v[4:7], v[128:131], v[108:111], v[204:207]
    v_cvt_pk_bf16_f32 v235, v78, v79
    ds_read_b32 v1, v228 offset:20
    v_cvt_pk_bf16_f32 v244, v80, v81
    v_cvt_pk_bf16_f32 v245, v82, v83
    v_cvt_pk_bf16_f32 v232, v68, v69
    v_cvt_pk_bf16_f32 v233, v70, v71
    v_cvt_pk_bf16_f32 v242, v72, v73
    v_cvt_pk_bf16_f32 v243, v74, v75
    s_waitcnt lgkmcnt(0)
    v_readfirstlane_b32 s37, v1
    s_nop 0
    s_cmp_ge_u32 s37, 4
    s_cbranch_scc1 L_sl_done_42
    s_mov_b32 s38, 1048576
L_sl_loop_43:
    ds_read_b32 v1, v228 offset:20
    s_waitcnt lgkmcnt(0)
    v_readfirstlane_b32 s37, v1
    s_nop 0
    s_cmp_ge_u32 s37, 4
    s_cbranch_scc1 L_sl_done_42
    s_sleep 1
    s_sub_u32 s38, s38, 1
    s_cbranch_scc0 L_sl_loop_43
L_sl_done_42:
    ds_read_b64 v[124:125], v221
    ds_read_b64 v[126:127], v222
    ds_read_b64 v[230:231], v221 offset:1024
    ds_read_b64 v[240:241], v222 offset:1024
    v_max_f32 v28, v28, v32
    v_max_f32 v29, v29, v33
    v_max_f32 v30, v30, v34
    v_max_f32 v31, v31, v35
    v_max3_f32 v39, v28, v29, v30
    v_max_f32 v39, v39, v31
    v_max_f32 v20, v20, v24
    v_max_f32 v21, v21, v25
    v_max_f32 v22, v22, v26
    v_max_f32 v23, v23, v27
    v_max3_f32 v38, v20, v21, v22
    v_max_f32 v38, v38, v23
    s_waitcnt lgkmcnt(2)
    v_mfma_f32_16x16x32_bf16 v[8:11], v[124:127], v[108:111], v[212:215]
    s_setprio 2
    s_mov_b32 s37, 0x3e8293ee
    v_max_f32 v12, v12, v16
    v_max_f32 v13, v13, v17
    v_max_f32 v14, v14, v18
    v_max_f32 v15, v15, v19
    v_max3_f32 v37, v12, v13, v14
    v_max_f32 v37, v37, v15
    v_max_f32 v4, v4, v8
    v_max_f32 v5, v5, v9
    v_max_f32 v6, v6, v10
    v_max_f32 v7, v7, v11
    v_max3_f32 v36, v4, v5, v6
    v_max_f32 v36, v36, v7
    v_permlane32_swap_b32 v38, v39
    s_nop 0
    v_permlane32_swap_b32 v36, v37
    v_max_f32 v38, v38, v39
    v_max_f32 v36, v36, v37
    s_nop 1
    v_permlane16_swap_b32 v36, v38
    v_max_f32 v36, v36, v38
    v_mul_f32 v38, s37, v36
    v_mul_f32 v36, s37, v36
    s_nop 1
    v_permlane16_swap_b32 v36, v38
    v_mov_b32 v37, v36
    v_mov_b32 v39, v38
    s_nop 0
    v_permlane32_swap_b32 v36, v37
    v_permlane32_swap_b32 v38, v39
    v_fma_f32 v4, v4, s37, -v36
    v_fma_f32 v5, v5, s37, -v36
    v_fma_f32 v6, v6, s37, -v36
    v_fma_f32 v7, v7, s37, -v36
    v_fma_f32 v12, v12, s37, -v37
    v_fma_f32 v13, v13, s37, -v37
    v_fma_f32 v14, v14, s37, -v37
    v_fma_f32 v15, v15, s37, -v37
    v_fma_f32 v20, v20, s37, -v38
    v_fma_f32 v21, v21, s37, -v38
    v_fma_f32 v22, v22, s37, -v38
    v_fma_f32 v23, v23, s37, -v38
    v_fma_f32 v28, v28, s37, -v39
    v_fma_f32 v29, v29, s37, -v39
    v_fma_f32 v30, v30, s37, -v39
    v_fma_f32 v31, v31, s37, -v39
    v_exp_f32 v28, v28
    v_exp_f32 v29, v29
    v_exp_f32 v30, v30
    v_exp_f32 v31, v31
    v_exp_f32 v20, v20
    v_exp_f32 v21, v21
    v_exp_f32 v22, v22
    v_exp_f32 v23, v23
    v_exp_f32 v12, v12
    v_exp_f32 v13, v13
    v_exp_f32 v14, v14
    v_exp_f32 v15, v15
    v_exp_f32 v4, v4
    v_exp_f32 v5, v5
    v_exp_f32 v6, v6
    v_exp_f32 v7, v7
    v_add_f32 v39, v28, v29
    v_add_f32 v32, v30, v31
    v_add_f32 v39, v39, v32
    v_add_f32 v38, v20, v21
    v_add_f32 v24, v22, v23
    v_add_f32 v38, v38, v24
    v_add_f32 v37, v12, v13
    v_add_f32 v16, v14, v15
    v_add_f32 v37, v37, v16
    v_add_f32 v36, v4, v5
    v_add_f32 v8, v6, v7
    v_add_f32 v36, v36, v8
    v_permlane32_swap_b32 v38, v39
    s_nop 0
    v_permlane32_swap_b32 v36, v37
    v_add_f32 v38, v38, v39
    v_add_f32 v36, v36, v37
    s_nop 1
    v_permlane16_swap_b32 v36, v38
    v_add_f32 v36, v36, v38
    v_rcp_f32 v38, v36
    v_rcp_f32 v36, v36
    s_nop 1
    v_permlane16_swap_b32 v36, v38
    v_mov_b32 v37, v36
    v_mov_b32 v39, v38
    s_nop 0
    v_permlane32_swap_b32 v36, v37
    v_permlane32_swap_b32 v38, v39
    s_waitcnt lgkmcnt(0)
    s_cmp_eq_u32 s33, 0
    v_mul_f32 v4, v4, v36
    v_mul_f32 v5, v5, v36
    v_mul_f32 v6, v6, v36
    v_mul_f32 v7, v7, v36
    v_cvt_pk_bf16_f32 v10, v4, v5
    v_cvt_pk_bf16_f32 v11, v6, v7
    v_and_b32 v8, v216, v10
    v_and_b32 v9, v217, v11
    v_xor_b32 v10, v8, v10
    v_xor_b32 v11, v9, v11
    s_setprio 2
    s_nop 0
    v_mfma_f32_16x16x32_bf16 v[68:71], v[230:233], v[8:11], 0
    v_mfma_f32_16x16x32_bf16 v[72:75], v[240:243], v[8:11], 0
    s_setprio 2
    v_mul_f32 v12, v12, v37
    v_mul_f32 v13, v13, v37
    v_mul_f32 v14, v14, v37
    v_mul_f32 v15, v15, v37
    v_cvt_pk_bf16_f32 v18, v12, v13
    v_cvt_pk_bf16_f32 v19, v14, v15
    v_and_b32 v16, v216, v18
    v_and_b32 v17, v217, v19
    v_xor_b32 v18, v16, v18
    v_xor_b32 v19, v17, v19
    v_cvt_pk_bf16_f32 v108, v68, v69
    v_cvt_pk_bf16_f32 v109, v70, v71
    v_cvt_pk_bf16_f32 v110, v72, v73
    v_cvt_pk_bf16_f32 v111, v74, v75
    s_cbranch_scc1 L_at_noswap0
    v_swap_b32 v108, v110
    v_swap_b32 v109, v111
L_at_noswap0:
    s_mov_b32 s37, 0
    buffer_store_dwordx4 v[108:111], v218, s[40:43], s37 offen sc1
    s_setprio 2
    v_mfma_f32_16x16x32_bf16 v[76:79], v[232:235], v[16:19], 0
    v_mfma_f32_16x16x32_bf16 v[80:83], v[242:245], v[16:19], 0
    s_setprio 2
    v_mul_f32 v20, v20, v38
    v_mul_f32 v21, v21, v38
    v_mul_f32 v22, v22, v38
    v_mul_f32 v23, v23, v38
    v_cvt_pk_bf16_f32 v26, v20, v21
    v_cvt_pk_bf16_f32 v27, v22, v23
    v_and_b32 v24, v216, v26
    v_and_b32 v25, v217, v27
    v_xor_b32 v26, v24, v26
    v_xor_b32 v27, v25, v27
    v_cvt_pk_bf16_f32 v112, v76, v77
    v_cvt_pk_bf16_f32 v113, v78, v79
    v_cvt_pk_bf16_f32 v114, v80, v81
    v_cvt_pk_bf16_f32 v115, v82, v83
    s_cbranch_scc1 L_at_noswap1
    v_swap_b32 v112, v114
    v_swap_b32 v113, v115
L_at_noswap1:
    s_mov_b32 s37, 32768
    buffer_store_dwordx4 v[112:115], v218, s[40:43], s37 offen sc1
    s_setprio 2
    v_mfma_f32_16x16x32_bf16 v[84:87], v[234:237], v[24:27], 0
    v_mfma_f32_16x16x32_bf16 v[88:91], v[244:247], v[24:27], 0
    s_setprio 2
    v_mul_f32 v28, v28, v39
    v_mul_f32 v29, v29, v39
    v_mul_f32 v30, v30, v39
    v_mul_f32 v31, v31, v39
    v_cvt_pk_bf16_f32 v34, v28, v29
    v_cvt_pk_bf16_f32 v35, v30, v31
    v_and_b32 v32, v216, v34
    v_and_b32 v33, v217, v35
    v_xor_b32 v34, v32, v34
    v_xor_b32 v35, v33, v35
    v_cvt_pk_bf16_f32 v116, v84, v85
    v_cvt_pk_bf16_f32 v117, v86, v87
    v_cvt_pk_bf16_f32 v118, v88, v89
    v_cvt_pk_bf16_f32 v119, v90, v91
    s_cbranch_scc1 L_at_noswap2
    v_swap_b32 v116, v118
    v_swap_b32 v117, v119
L_at_noswap2:
    s_mov_b32 s37, 65536
    buffer_store_dwordx4 v[116:119], v218, s[40:43], s37 offen sc1
    s_setprio 2
    v_mfma_f32_16x16x32_bf16 v[92:95], v[236:239], v[32:35], 0
    v_mfma_f32_16x16x32_bf16 v[96:99], v[246:249], v[32:35], 0
    s_setprio 2
    s_nop 5
    v_cvt_pk_bf16_f32 v120, v92, v93
    v_cvt_pk_bf16_f32 v121, v94, v95
    v_cvt_pk_bf16_f32 v122, v96, v97
    v_cvt_pk_bf16_f32 v123, v98, v99
    s_cbranch_scc1 L_at_noswap3
    v_swap_b32 v120, v122
    v_swap_b32 v121, v123
L_at_noswap3:
    s_mov_b32 s37, 98304
    buffer_store_dwordx4 v[120:123], v218, s[40:43], s37 offen sc1
    s_setprio 0
    s_add_u32 m0, s60, 0
    s_add_u32 s63, s62, 0
    s_and_b32 s63, s63, 0x1fffff
    buffer_load_dwordx4 v227, s[44:47], s63 offen lds
    s_add_u32 m0, s60, 1024
    s_add_u32 s63, s62, 16384
    s_and_b32 s63, s63, 0x1fffff
    buffer_load_dwordx4 v227, s[44:47], s63 offen lds
    s_add_u32 m0, s60, 8192
    s_add_u32 s63, s62, 131072
    s_and_b32 s63, s63, 0x1fffff
    buffer_load_dwordx4 v227, s[44:47], s63 offen lds
    s_add_u32 m0, s60, 9216
    s_add_u32 s63, s62, 147456
    s_and_b32 s63, s63, 0x1fffff
    buffer_load_dwordx4 v227, s[44:47], s63 offen lds
    s_add_u32 m0, s60, 16384
    s_add_u32 s63, s62, 262144
    s_and_b32 s63, s63, 0x1fffff
    buffer_load_dwordx4 v227, s[44:47], s63 offen lds
    s_add_u32 m0, s60, 17408
    s_add_u32 s63, s62, 278528
    s_and_b32 s63, s63, 0x1fffff
    buffer_load_dwordx4 v227, s[44:47], s63 offen lds
    v_xor_b32 v84, 0, v229
    v_xor_b32 v85, 32, v229
    v_xor_b32 v86, 64, v229
    v_xor_b32 v87, 96, v229
    v_add_u32 v88, 83968, v84
    v_add_u32 v89, 83968, v85
    v_add_u32 v90, 83968, v86
    v_add_u32 v91, 83968, v87
    v_add_u32 v92, 125952, v84
    v_add_u32 v93, 125952, v85
    v_add_u32 v94, 125952, v86
    v_add_u32 v95, 125952, v87
    s_add_u32 s64, s61, 0
    s_and_b32 s64, s64, 7
    s_lshl_b32 s64, s64, 12
    s_add_u32 s65, s61, 1
    s_and_b32 s65, s65, 7
    s_lshl_b32 s65, s65, 12
    s_add_u32 s66, s61, 2
    s_and_b32 s66, s66, 7
    s_lshl_b32 s66, s66, 12
    s_add_u32 s67, s61, 3
    s_and_b32 s67, s67, 7
    s_lshl_b32 s67, s67, 12
    s_add_u32 s68, s61, 4
    s_and_b32 s68, s68, 7
    s_lshl_b32 s68, s68, 12
    s_add_u32 s69, s61, 5
    s_and_b32 s69, s69, 7
    s_lshl_b32 s69, s69, 12
    s_add_u32 s70, s61, 6
    s_and_b32 s70, s70, 7
    s_lshl_b32 s70, s70, 12
    s_add_u32 s71, s61, 7
    s_and_b32 s71, s71, 7
    s_lshl_b32 s71, s71, 12
    s_waitcnt vmcnt(6)
    s_setprio 2
    v_mov_b32 v2, 1
    s_mov_b64 exec, 1
    ds_add_rtn_u32 v1, v228, v2 offset:0
    s_waitcnt lgkmcnt(0)
    v_readfirstlane_b32 s39, v1
    s_nop 0
    s_cmp_eq_u32 s39, 3
    s_cbranch_scc0 L_jo_44a
    s_mov_b64 exec, 0xffff
    v_lshlrev_b32 v1, 8, v0
    buffer_atomic_add v2, v1, s[52:55], s56 offen sc1
L_jo_44a:
    s_mov_b64 exec, -1
    s_setprio 0
    s_add_u32 m0, s60, 24576
    s_add_u32 s63, s62, 393216
    s_and_b32 s63, s63, 0x1fffff
    buffer_load_dwordx4 v227, s[44:47], s63 offen lds
    s_add_u32 m0, s60, 25600
    s_add_u32 s63, s62, 409600
    s_and_b32 s63, s63, 0x1fffff
    buffer_load_dwordx4 v227, s[44:47], s63 offen lds
    s_add_u32 m0, s60, 32768
    s_add_u32 s63, s62, 524288
    s_and_b32 s63, s63, 0x1fffff
    buffer_load_dwordx4 v227, s[44:47], s63 offen lds
    s_add_u32 m0, s60, 33792
    s_add_u32 s63, s62, 540672
    s_and_b32 s63, s63, 0x1fffff
    buffer_load_dwordx4 v227, s[44:47], s63 offen lds
    s_add_u32 m0, s60, 83968
    s_add_u32 s63, s62, 655360
    s_and_b32 s63, s63, 0x1fffff
    buffer_load_dwordx4 v227, s[44:47], s63 offen lds
    s_add_u32 m0, s60, 84992
    s_add_u32 s63, s62, 671744
    s_and_b32 s63, s63, 0x1fffff
    buffer_load_dwordx4 v227, s[44:47], s63 offen lds
    s_add_u32 m0, s60, 92160
    s_add_u32 s63, s62, 786432
    s_and_b32 s63, s63, 0x1fffff
    buffer_load_dwordx4 v227, s[44:47], s63 offen lds
    s_add_u32 m0, s60, 93184
    s_add_u32 s63, s62, 802816
    s_and_b32 s63, s63, 0x1fffff
    buffer_load_dwordx4 v227, s[44:47], s63 offen lds
    s_add_u32 m0, s60, 100352
    s_add_u32 s63, s62, 917504
    s_and_b32 s63, s63, 0x1fffff
    buffer_load_dwordx4 v227, s[44:47], s63 offen lds
    s_add_u32 m0, s60, 101376
    s_add_u32 s63, s62, 933888
    s_and_b32 s63, s63, 0x1fffff
    buffer_load_dwordx4 v227, s[44:47], s63 offen lds
    s_add_u32 m0, s60, 108544
    s_add_u32 s63, s62, 1048576
    s_and_b32 s63, s63, 0x1fffff
    buffer_load_dwordx4 v227, s[44:47], s63 offen lds
    s_add_u32 m0, s60, 109568
    s_add_u32 s63, s62, 1064960
    s_and_b32 s63, s63, 0x1fffff
    buffer_load_dwordx4 v227, s[44:47], s63 offen lds
    s_add_u32 m0, s60, 116736
    s_add_u32 s63, s62, 1179648
    s_and_b32 s63, s63, 0x1fffff
    buffer_load_dwordx4 v227, s[44:47], s63 offen lds
    s_add_u32 m0, s60, 117760
    s_add_u32 s63, s62, 1196032
    s_and_b32 s63, s63, 0x1fffff
    buffer_load_dwordx4 v227, s[44:47], s63 offen lds
    s_setprio 0
    s_cmp_eq_u32 s39, 3
    s_cbranch_scc0 L_jo_44
    s_mov_b32 s38, 131072
L_sg_loop_47:
    s_load_dword s37, s[52:53], s57 glc
L_sg_chk_48:
    s_waitcnt lgkmcnt(0)
    s_cmp_ge_u32 s37, 16
    s_cbranch_scc1 L_sg_done_46
    s_sub_u32 s38, s38, 1
    s_cbranch_scc0 L_sg_loop_47
L_sg_done_46:
    v_mov_b32 v1, 16
    s_mov_b64 exec, 1
    ds_add_u32 v228, v1 offset:4
    s_mov_b64 exec, -1
L_jo_44:
    s_waitcnt vmcnt(0)
    s_mov_b64 exec, 1
    ds_add_u32 v228, v2 offset:4
    s_mov_b64 exec, -1
    s_mov_b32 s38, 1048576
L_sl_loop_50:
    ds_read_b32 v1, v228 offset:4
    s_waitcnt lgkmcnt(0)
    v_readfirstlane_b32 s37, v1
    s_nop 0
    s_cmp_ge_u32 s37, 20
    s_cbranch_scc1 L_sl_done_49
    s_sleep 1
    s_sub_u32 s38, s38, 1
    s_cbranch_scc0 L_sl_loop_50
L_sl_done_49:
L_jd_45:
    buffer_load_dwordx4 v[96:99], v224, s[40:43], s64 offen offset:0 sc1
    buffer_load_dwordx4 v[100:103], v225, s[40:43], s64 offen offset:0 sc1
    ds_read_b64_tr_b16 v[36:37], v84 offset:0
    ds_read_b64_tr_b16 v[38:39], v84 offset:2048
    buffer_load_dwordx4 v[104:107], v224, s[40:43], s64 offen offset:1024 sc1
    buffer_load_dwordx4 v[108:111], v225, s[40:43], s64 offen offset:1024 sc1
    ds_read_b64_tr_b16 v[40:41], v85 offset:0
    ds_read_b64_tr_b16 v[42:43], v85 offset:2048
    buffer_load_dwordx4 v[112:115], v224, s[40:43], s64 offen offset:2048 sc1
    buffer_load_dwordx4 v[116:119], v225, s[40:43], s64 offen offset:2048 sc1
    ds_read_b64_tr_b16 v[44:45], v86 offset:0
    ds_read_b64_tr_b16 v[46:47], v86 offset:2048
    buffer_load_dwordx4 v[120:123], v224, s[40:43], s64 offen offset:3072 sc1
    buffer_load_dwordx4 v[124:127], v225, s[40:43], s64 offen offset:3072 sc1
    ds_read_b64_tr_b16 v[48:49], v87 offset:0
    ds_read_b64_tr_b16 v[50:51], v87 offset:2048
    buffer_load_dwordx4 v[128:131], v224, s[40:43], s65 offen offset:0 sc1
    buffer_load_dwordx4 v[132:135], v225, s[40:43], s65 offen offset:0 sc1
    ds_read_b64_tr_b16 v[52:53], v84 offset:4096
    ds_read_b64_tr_b16 v[54:55], v84 offset:6144
    buffer_load_dwordx4 v[136:139], v224, s[40:43], s65 offen offset:1024 sc1
    buffer_load_dwordx4 v[140:143], v225, s[40:43], s65 offen offset:1024 sc1
    ds_read_b64_tr_b16 v[56:57], v85 offset:4096
    ds_read_b64_tr_b16 v[58:59], v85 offset:6144
    buffer_load_dwordx4 v[144:147], v224, s[40:43], s65 offen offset:2048 sc1
    buffer_load_dwordx4 v[148:151], v225, s[40:43], s65 offen offset:2048 sc1
    ds_read_b64_tr_b16 v[60:61], v86 offset:4096
    ds_read_b64_tr_b16 v[62:63], v86 offset:6144
    buffer_load_dwordx4 v[152:155], v224, s[40:43], s65 offen offset:3072 sc1
    buffer_load_dwordx4 v[156:159], v225, s[40:43], s65 offen offset:3072 sc1
    s_waitcnt lgkmcnt(12)
    ds_read_b64_tr_b16 v[64:65], v87 offset:4096
    ds_read_b64_tr_b16 v[66:67], v87 offset:6144
    s_waitcnt vmcnt(14) lgkmcnt(8)
    v_mfma_f32_16x16x32_bf16 v[4:7], v[36:39], v[96:99], 0
    ds_read_b64_tr_b16 v[68:69], v84 offset:8192
    v_mfma_f32_16x16x32_bf16 v[20:23], v[36:39], v[100:103], 0
    ds_read_b64_tr_b16 v[70:71], v84 offset:10240
    v_mfma_f32_16x16x32_bf16 v[8:11], v[40:43], v[96:99], 0
    ds_read_b64_tr_b16 v[36:37], v85 offset:8192
    v_mfma_f32_16x16x32_bf16 v[24:27], v[40:43], v[100:103], 0
    ds_read_b64_tr_b16 v[38:39], v85 offset:10240
    buffer_load_dwordx4 v[160:163], v224, s[40:43], s66 offen offset:0 sc1
    v_mfma_f32_16x16x32_bf16 v[12:15], v[44:47], v[96:99], 0
    ds_read_b64_tr_b16 v[40:41], v86 offset:8192
    v_mfma_f32_16x16x32_bf16 v[28:31], v[44:47], v[100:103], 0
    ds_read_b64_tr_b16 v[42:43], v86 offset:10240
    v_mfma_f32_16x16x32_bf16 v[16:19], v[48:51], v[96:99], 0
    ds_read_b64_tr_b16 v[44:45], v87 offset:8192
    v_mfma_f32_16x16x32_bf16 v[32:35], v[48:51], v[100:103], 0
    ds_read_b64_tr_b16 v[46:47], v87 offset:10240
    buffer_load_dwordx4 v[164:167], v225, s[40:43], s66 offen offset:0 sc1
    s_waitcnt vmcnt(14) lgkmcnt(8)
    v_mfma_f32_16x16x32_bf16 v[4:7], v[52:55], v[104:107], v[4:7]
    ds_read_b64_tr_b16 v[48:49], v84 offset:12288
    v_mfma_f32_16x16x32_bf16 v[20:23], v[52:55], v[108:111], v[20:23]
    ds_read_b64_tr_b16 v[50:51], v84 offset:14336
    v_mfma_f32_16x16x32_bf16 v[8:11], v[56:59], v[104:107], v[8:11]
    ds_read_b64_tr_b16 v[52:53], v85 offset:12288
    v_mfma_f32_16x16x32_bf16 v[24:27], v[56:59], v[108:111], v[24:27]
    ds_read_b64_tr_b16 v[54:55], v85 offset:14336
    buffer_load_dwordx4 v[96:99], v224, s[40:43], s66 offen offset:1024 sc1
    v_mfma_f32_16x16x32_bf16 v[12:15], v[60:63], v[104:107], v[12:15]
    ds_read_b64_tr_b16 v[56:57], v86 offset:12288
    v_mfma_f32_16x16x32_bf16 v[28:31], v[60:63], v[108:111], v[28:31]
    ds_read_b64_tr_b16 v[58:59], v86 offset:14336
    v_mfma_f32_16x16x32_bf16 v[16:19], v[64:67], v[104:107], v[16:19]
    ds_read_b64_tr_b16 v[60:61], v87 offset:12288
    v_mfma_f32_16x16x32_bf16 v[32:35], v[64:67], v[108:111], v[32:35]
    ds_read_b64_tr_b16 v[62:63], v87 offset:14336
    buffer_load_dwordx4 v[100:103], v225, s[40:43], s66 offen offset:1024 sc1
    s_waitcnt vmcnt(14) lgkmcnt(8)
    v_mfma_f32_16x16x32_bf16 v[4:7], v[68:71], v[112:115], v[4:7]
    ds_read_b64_tr_b16 v[64:65], v84 offset:16384
    v_mfma_f32_16x16x32_bf16 v[20:23], v[68:71], v[116:119], v[20:23]
    ds_read_b64_tr_b16 v[66:67], v84 offset:18432
    v_mfma_f32_16x16x32_bf16 v[8:11], v[36:39], v[112:115], v[8:11]
    ds_read_b64_tr_b16 v[68:69], v85 offset:16384
    v_mfma_f32_16x16x32_bf16 v[24:27], v[36:39], v[116:119], v[24:27]
    ds_read_b64_tr_b16 v[70:71], v85 offset:18432
    buffer_load_dwordx4 v[104:107], v224, s[40:43], s66 offen offset:2048 sc1
    v_mfma_f32_16x16x32_bf16 v[12:15], v[40:43], v[112:115], v[12:15]
    ds_read_b64_tr_b16 v[36:37], v86 offset:16384
    v_mfma_f32_16x16x32_bf16 v[28:31], v[40:43], v[116:119], v[28:31]
    ds_read_b64_tr_b16 v[38:39], v86 offset:18432
    v_mfma_f32_16x16x32_bf16 v[16:19], v[44:47], v[112:115], v[16:19]
    ds_read_b64_tr_b16 v[40:41], v87 offset:16384
    v_mfma_f32_16x16x32_bf16 v[32:35], v[44:47], v[116:119], v[32:35]
    ds_read_b64_tr_b16 v[42:43], v87 offset:18432
    buffer_load_dwordx4 v[108:111], v225, s[40:43], s66 offen offset:2048 sc1
    s_waitcnt vmcnt(14) lgkmcnt(8)
    v_mfma_f32_16x16x32_bf16 v[4:7], v[48:51], v[120:123], v[4:7]
    ds_read_b64_tr_b16 v[44:45], v84 offset:20480
    v_mfma_f32_16x16x32_bf16 v[20:23], v[48:51], v[124:127], v[20:23]
    ds_read_b64_tr_b16 v[46:47], v84 offset:22528
    v_mfma_f32_16x16x32_bf16 v[8:11], v[52:55], v[120:123], v[8:11]
    ds_read_b64_tr_b16 v[48:49], v85 offset:20480
    v_mfma_f32_16x16x32_bf16 v[24:27], v[52:55], v[124:127], v[24:27]
    ds_read_b64_tr_b16 v[50:51], v85 offset:22528
    buffer_load_dwordx4 v[112:115], v224, s[40:43], s66 offen offset:3072 sc1
    v_mfma_f32_16x16x32_bf16 v[12:15], v[56:59], v[120:123], v[12:15]
    ds_read_b64_tr_b16 v[52:53], v86 offset:20480
    v_mfma_f32_16x16x32_bf16 v[28:31], v[56:59], v[124:127], v[28:31]
    ds_read_b64_tr_b16 v[54:55], v86 offset:22528
    v_mfma_f32_16x16x32_bf16 v[16:19], v[60:63], v[120:123], v[16:19]
    ds_read_b64_tr_b16 v[56:57], v87 offset:20480
    v_mfma_f32_16x16x32_bf16 v[32:35], v[60:63], v[124:127], v[32:35]
    ds_read_b64_tr_b16 v[58:59], v87 offset:22528
    buffer_load_dwordx4 v[116:119], v225, s[40:43], s66 offen offset:3072 sc1
    s_waitcnt vmcnt(14) lgkmcnt(8)
    v_mfma_f32_16x16x32_bf16 v[4:7], v[64:67], v[128:131], v[4:7]
    ds_read_b64_tr_b16 v[60:61], v84 offset:24576
    v_mfma_f32_16x16x32_bf16 v[20:23], v[64:67], v[132:135], v[20:23]
    ds_read_b64_tr_b16 v[62:63], v84 offset:26624
    v_mfma_f32_16x16x32_bf16 v[8:11], v[68:71], v[128:131], v[8:11]
    ds_read_b64_tr_b16 v[64:65], v85 offset:24576
    v_mfma_f32_16x16x32_bf16 v[24:27], v[68:71], v[132:135], v[24:27]
    ds_read_b64_tr_b16 v[66:67], v85 offset:26624
    buffer_load_dwordx4 v[120:123], v224, s[40:43], s67 offen offset:0 sc1
    v_mfma_f32_16x16x32_bf16 v[12:15], v[36:39], v[128:131], v[12:15]
    ds_read_b64_tr_b16 v[68:69], v86 offset:24576
    v_mfma_f32_16x16x32_bf16 v[28:31], v[36:39], v[132:135], v[28:31]
    ds_read_b64_tr_b16 v[70:71], v86 offset:26624
    v_mfma_f32_16x16x32_bf16 v[16:19], v[40:43], v[128:131], v[16:19]
    ds_read_b64_tr_b16 v[36:37], v87 offset:24576
    v_mfma_f32_16x16x32_bf16 v[32:35], v[40:43], v[132:135], v[32:35]
    ds_read_b64_tr_b16 v[38:39], v87 offset:26624
    buffer_load_dwordx4 v[124:127], v225, s[40:43], s67 offen offset:0 sc1
    s_waitcnt vmcnt(14) lgkmcnt(8)
    v_mfma_f32_16x16x32_bf16 v[4:7], v[44:47], v[136:139], v[4:7]
    ds_read_b64_tr_b16 v[40:41], v84 offset:28672
    v_mfma_f32_16x16x32_bf16 v[20:23], v[44:47], v[140:143], v[20:23]
    ds_read_b64_tr_b16 v[42:43], v84 offset:30720
    v_mfma_f32_16x16x32_bf16 v[8:11], v[48:51], v[136:139], v[8:11]
    ds_read_b64_tr_b16 v[44:45], v85 offset:28672
    v_mfma_f32_16x16x32_bf16 v[24:27], v[48:51], v[140:143], v[24:27]
    ds_read_b64_tr_b16 v[46:47], v85 offset:30720
    buffer_load_dwordx4 v[128:131], v224, s[40:43], s67 offen offset:1024 sc1
    v_mfma_f32_16x16x32_bf16 v[12:15], v[52:55], v[136:139], v[12:15]
    ds_read_b64_tr_b16 v[48:49], v86 offset:28672
    v_mfma_f32_16x16x32_bf16 v[28:31], v[52:55], v[140:143], v[28:31]
    ds_read_b64_tr_b16 v[50:51], v86 offset:30720
    v_mfma_f32_16x16x32_bf16 v[16:19], v[56:59], v[136:139], v[16:19]
    ds_read_b64_tr_b16 v[52:53], v87 offset:28672
    v_mfma_f32_16x16x32_bf16 v[32:35], v[56:59], v[140:143], v[32:35]
    ds_read_b64_tr_b16 v[54:55], v87 offset:30720
    buffer_load_dwordx4 v[132:135], v225, s[40:43], s67 offen offset:1024 sc1
    s_waitcnt vmcnt(14) lgkmcnt(8)
    v_mfma_f32_16x16x32_bf16 v[4:7], v[60:63], v[144:147], v[4:7]
    ds_read_b64_tr_b16 v[56:57], v84 offset:32768
    v_mfma_f32_16x16x32_bf16 v[20:23], v[60:63], v[148:151], v[20:23]
    ds_read_b64_tr_b16 v[58:59], v84 offset:34816
    v_mfma_f32_16x16x32_bf16 v[8:11], v[64:67], v[144:147], v[8:11]
    ds_read_b64_tr_b16 v[60:61], v85 offset:32768
    v_mfma_f32_16x16x32_bf16 v[24:27], v[64:67], v[148:151], v[24:27]
    ds_read_b64_tr_b16 v[62:63], v85 offset:34816
    buffer_load_dwordx4 v[136:139], v224, s[40:43], s67 offen offset:2048 sc1
    v_mfma_f32_16x16x32_bf16 v[12:15], v[68:71], v[144:147], v[12:15]
    ds_read_b64_tr_b16 v[64:65], v86 offset:32768
    v_mfma_f32_16x16x32_bf16 v[28:31], v[68:71], v[148:151], v[28:31]
    ds_read_b64_tr_b16 v[66:67], v86 offset:34816
    v_mfma_f32_16x16x32_bf16 v[16:19], v[36:39], v[144:147], v[16:19]
    ds_read_b64_tr_b16 v[68:69], v87 offset:32768
    v_mfma_f32_16x16x32_bf16 v[32:35], v[36:39], v[148:151], v[32:35]
    ds_read_b64_tr_b16 v[70:71], v87 offset:34816
    buffer_load_dwordx4 v[140:143], v225, s[40:43], s67 offen offset:2048 sc1
    s_waitcnt vmcnt(14) lgkmcnt(8)
    v_mfma_f32_16x16x32_bf16 v[4:7], v[40:43], v[152:155], v[4:7]
    ds_read_b64_tr_b16 v[36:37], v84 offset:36864
    v_mfma_f32_16x16x32_bf16 v[20:23], v[40:43], v[156:159], v[20:23]
    ds_read_b64_tr_b16 v[38:39], v84 offset:38912
    v_mfma_f32_16x16x32_bf16 v[8:11], v[44:47], v[152:155], v[8:11]
    ds_read_b64_tr_b16 v[40:41], v85 offset:36864
    v_mfma_f32_16x16x32_bf16 v[24:27], v[44:47], v[156:159], v[24:27]
    ds_read_b64_tr_b16 v[42:43], v85 offset:38912
    buffer_load_dwordx4 v[144:147], v224, s[40:43], s67 offen offset:3072 sc1
    v_mfma_f32_16x16x32_bf16 v[12:15], v[48:51], v[152:155], v[12:15]
    ds_read_b64_tr_b16 v[44:45], v86 offset:36864
    v_mfma_f32_16x16x32_bf16 v[28:31], v[48:51], v[156:159], v[28:31]
    ds_read_b64_tr_b16 v[46:47], v86 offset:38912
    v_mfma_f32_16x16x32_bf16 v[16:19], v[52:55], v[152:155], v[16:19]
    ds_read_b64_tr_b16 v[48:49], v87 offset:36864
    v_mfma_f32_16x16x32_bf16 v[32:35], v[52:55], v[156:159], v[32:35]
    ds_read_b64_tr_b16 v[50:51], v87 offset:38912
    buffer_load_dwordx4 v[148:151], v225, s[40:43], s67 offen offset:3072 sc1
    s_waitcnt vmcnt(14) lgkmcnt(8)
    v_mfma_f32_16x16x32_bf16 v[4:7], v[56:59], v[160:163], v[4:7]
    ds_read_b64_tr_b16 v[52:53], v88 offset:0
    v_mfma_f32_16x16x32_bf16 v[20:23], v[56:59], v[164:167], v[20:23]
    ds_read_b64_tr_b16 v[54:55], v88 offset:2048
    v_mfma_f32_16x16x32_bf16 v[8:11], v[60:63], v[160:163], v[8:11]
    ds_read_b64_tr_b16 v[56:57], v89 offset:0
    v_mfma_f32_16x16x32_bf16 v[24:27], v[60:63], v[164:167], v[24:27]
    ds_read_b64_tr_b16 v[58:59], v89 offset:2048
    buffer_load_dwordx4 v[152:155], v224, s[40:43], s68 offen offset:0 sc1
    v_mfma_f32_16x16x32_bf16 v[12:15], v[64:67], v[160:163], v[12:15]
    ds_read_b64_tr_b16 v[60:61], v90 offset:0
    v_mfma_f32_16x16x32_bf16 v[28:31], v[64:67], v[164:167], v[28:31]
    ds_read_b64_tr_b16 v[62:63], v90 offset:2048
    v_mfma_f32_16x16x32_bf16 v[16:19], v[68:71], v[160:163], v[16:19]
    ds_read_b64_tr_b16 v[64:65], v91 offset:0
    v_mfma_f32_16x16x32_bf16 v[32:35], v[68:71], v[164:167], v[32:35]
    ds_read_b64_tr_b16 v[66:67], v91 offset:2048
    buffer_load_dwordx4 v[156:159], v225, s[40:43], s68 offen offset:0 sc1
    s_waitcnt vmcnt(14) lgkmcnt(8)
    v_mfma_f32_16x16x32_bf16 v[4:7], v[36:39], v[96:99], v[4:7]
    ds_read_b64_tr_b16 v[68:69], v88 offset:4096
    v_mfma_f32_16x16x32_bf16 v[20:23], v[36:39], v[100:103], v[20:23]
    ds_read_b64_tr_b16 v[70:71], v88 offset:6144
    v_mfma_f32_16x16x32_bf16 v[8:11], v[40:43], v[96:99], v[8:11]
    ds_read_b64_tr_b16 v[36:37], v89 offset:4096
    v_mfma_f32_16x16x32_bf16 v[24:27], v[40:43], v[100:103], v[24:27]
    ds_read_b64_tr_b16 v[38:39], v89 offset:6144
    buffer_load_dwordx4 v[160:163], v224, s[40:43], s68 offen offset:1024 sc1
    v_mfma_f32_16x16x32_bf16 v[12:15], v[44:47], v[96:99], v[12:15]
    ds_read_b64_tr_b16 v[40:41], v90 offset:4096
    v_mfma_f32_16x16x32_bf16 v[28:31], v[44:47], v[100:103], v[28:31]
    ds_read_b64_tr_b16 v[42:43], v90 offset:6144
    v_mfma_f32_16x16x32_bf16 v[16:19], v[48:51], v[96:99], v[16:19]
    ds_read_b64_tr_b16 v[44:45], v91 offset:4096
    v_mfma_f32_16x16x32_bf16 v[32:35], v[48:51], v[100:103], v[32:35]
    ds_read_b64_tr_b16 v[46:47], v91 offset:6144
    buffer_load_dwordx4 v[164:167], v225, s[40:43], s68 offen offset:1024 sc1
    s_waitcnt vmcnt(14) lgkmcnt(8)
    v_mfma_f32_16x16x32_bf16 v[4:7], v[52:55], v[104:107], v[4:7]
    ds_read_b64_tr_b16 v[48:49], v88 offset:8192
    v_mfma_f32_16x16x32_bf16 v[20:23], v[52:55], v[108:111], v[20:23]
    ds_read_b64_tr_b16 v[50:51], v88 offset:10240
    v_mfma_f32_16x16x32_bf16 v[8:11], v[56:59], v[104:107], v[8:11]
    ds_read_b64_tr_b16 v[52:53], v89 offset:8192
    v_mfma_f32_16x16x32_bf16 v[24:27], v[56:59], v[108:111], v[24:27]
    ds_read_b64_tr_b16 v[54:55], v89 offset:10240
    buffer_load_dwordx4 v[96:99], v224, s[40:43], s68 offen offset:2048 sc1
    v_mfma_f32_16x16x32_bf16 v[12:15], v[60:63], v[104:107], v[12:15]
    ds_read_b64_tr_b16 v[56:57], v90 offset:8192
    v_mfma_f32_16x16x32_bf16 v[28:31], v[60:63], v[108:111], v[28:31]
    ds_read_b64_tr_b16 v[58:59], v90 offset:10240
    v_mfma_f32_16x16x32_bf16 v[16:19], v[64:67], v[104:107], v[16:19]
    ds_read_b64_tr_b16 v[60:61], v91 offset:8192
    v_mfma_f32_16x16x32_bf16 v[32:35], v[64:67], v[108:111], v[32:35]
    ds_read_b64_tr_b16 v[62:63], v91 offset:10240
    buffer_load_dwordx4 v[100:103], v225, s[40:43], s68 offen offset:2048 sc1
    s_waitcnt vmcnt(14) lgkmcnt(8)
    v_mfma_f32_16x16x32_bf16 v[4:7], v[68:71], v[112:115], v[4:7]
    ds_read_b64_tr_b16 v[64:65], v88 offset:12288
    v_mfma_f32_16x16x32_bf16 v[20:23], v[68:71], v[116:119], v[20:23]
    ds_read_b64_tr_b16 v[66:67], v88 offset:14336
    v_mfma_f32_16x16x32_bf16 v[8:11], v[36:39], v[112:115], v[8:11]
    ds_read_b64_tr_b16 v[68:69], v89 offset:12288
    v_mfma_f32_16x16x32_bf16 v[24:27], v[36:39], v[116:119], v[24:27]
    ds_read_b64_tr_b16 v[70:71], v89 offset:14336
    buffer_load_dwordx4 v[104:107], v224, s[40:43], s68 offen offset:3072 sc1
    v_mfma_f32_16x16x32_bf16 v[12:15], v[40:43], v[112:115], v[12:15]
    ds_read_b64_tr_b16 v[36:37], v90 offset:12288
    v_mfma_f32_16x16x32_bf16 v[28:31], v[40:43], v[116:119], v[28:31]
    ds_read_b64_tr_b16 v[38:39], v90 offset:14336
    v_mfma_f32_16x16x32_bf16 v[16:19], v[44:47], v[112:115], v[16:19]
    ds_read_b64_tr_b16 v[40:41], v91 offset:12288
    v_mfma_f32_16x16x32_bf16 v[32:35], v[44:47], v[116:119], v[32:35]
    ds_read_b64_tr_b16 v[42:43], v91 offset:14336
    buffer_load_dwordx4 v[108:111], v225, s[40:43], s68 offen offset:3072 sc1
    s_waitcnt vmcnt(14) lgkmcnt(8)
    v_mfma_f32_16x16x32_bf16 v[4:7], v[48:51], v[120:123], v[4:7]
    ds_read_b64_tr_b16 v[44:45], v88 offset:16384
    v_mfma_f32_16x16x32_bf16 v[20:23], v[48:51], v[124:127], v[20:23]
    ds_read_b64_tr_b16 v[46:47], v88 offset:18432
    v_mfma_f32_16x16x32_bf16 v[8:11], v[52:55], v[120:123], v[8:11]
    ds_read_b64_tr_b16 v[48:49], v89 offset:16384
    v_mfma_f32_16x16x32_bf16 v[24:27], v[52:55], v[124:127], v[24:27]
    ds_read_b64_tr_b16 v[50:51], v89 offset:18432
    buffer_load_dwordx4 v[112:115], v224, s[40:43], s69 offen offset:0 sc1
    v_mfma_f32_16x16x32_bf16 v[12:15], v[56:59], v[120:123], v[12:15]
    ds_read_b64_tr_b16 v[52:53], v90 offset:16384
    v_mfma_f32_16x16x32_bf16 v[28:31], v[56:59], v[124:127], v[28:31]
    ds_read_b64_tr_b16 v[54:55], v90 offset:18432
    v_mfma_f32_16x16x32_bf16 v[16:19], v[60:63], v[120:123], v[16:19]
    ds_read_b64_tr_b16 v[56:57], v91 offset:16384
    v_mfma_f32_16x16x32_bf16 v[32:35], v[60:63], v[124:127], v[32:35]
    ds_read_b64_tr_b16 v[58:59], v91 offset:18432
    buffer_load_dwordx4 v[116:119], v225, s[40:43], s69 offen offset:0 sc1
    s_waitcnt vmcnt(14) lgkmcnt(8)
    v_mfma_f32_16x16x32_bf16 v[4:7], v[64:67], v[128:131], v[4:7]
    ds_read_b64_tr_b16 v[60:61], v88 offset:20480
    v_mfma_f32_16x16x32_bf16 v[20:23], v[64:67], v[132:135], v[20:23]
    ds_read_b64_tr_b16 v[62:63], v88 offset:22528
    v_mfma_f32_16x16x32_bf16 v[8:11], v[68:71], v[128:131], v[8:11]
    ds_read_b64_tr_b16 v[64:65], v89 offset:20480
    v_mfma_f32_16x16x32_bf16 v[24:27], v[68:71], v[132:135], v[24:27]
    ds_read_b64_tr_b16 v[66:67], v89 offset:22528
    buffer_load_dwordx4 v[120:123], v224, s[40:43], s69 offen offset:1024 sc1
    v_mfma_f32_16x16x32_bf16 v[12:15], v[36:39], v[128:131], v[12:15]
    ds_read_b64_tr_b16 v[68:69], v90 offset:20480
    v_mfma_f32_16x16x32_bf16 v[28:31], v[36:39], v[132:135], v[28:31]
    ds_read_b64_tr_b16 v[70:71], v90 offset:22528
    v_mfma_f32_16x16x32_bf16 v[16:19], v[40:43], v[128:131], v[16:19]
    ds_read_b64_tr_b16 v[36:37], v91 offset:20480
    v_mfma_f32_16x16x32_bf16 v[32:35], v[40:43], v[132:135], v[32:35]
    ds_read_b64_tr_b16 v[38:39], v91 offset:22528
    buffer_load_dwordx4 v[124:127], v225, s[40:43], s69 offen offset:1024 sc1
    s_waitcnt vmcnt(14) lgkmcnt(8)
    v_mfma_f32_16x16x32_bf16 v[4:7], v[44:47], v[136:139], v[4:7]
    ds_read_b64_tr_b16 v[40:41], v88 offset:24576
    v_mfma_f32_16x16x32_bf16 v[20:23], v[44:47], v[140:143], v[20:23]
    ds_read_b64_tr_b16 v[42:43], v88 offset:26624
    v_mfma_f32_16x16x32_bf16 v[8:11], v[48:51], v[136:139], v[8:11]
    ds_read_b64_tr_b16 v[44:45], v89 offset:24576
    v_mfma_f32_16x16x32_bf16 v[24:27], v[48:51], v[140:143], v[24:27]
    ds_read_b64_tr_b16 v[46:47], v89 offset:26624
    buffer_load_dwordx4 v[128:131], v224, s[40:43], s69 offen offset:2048 sc1
    v_mfma_f32_16x16x32_bf16 v[12:15], v[52:55], v[136:139], v[12:15]
    ds_read_b64_tr_b16 v[48:49], v90 offset:24576
    v_mfma_f32_16x16x32_bf16 v[28:31], v[52:55], v[140:143], v[28:31]
    ds_read_b64_tr_b16 v[50:51], v90 offset:26624
    v_mfma_f32_16x16x32_bf16 v[16:19], v[56:59], v[136:139], v[16:19]
    ds_read_b64_tr_b16 v[52:53], v91 offset:24576
    v_mfma_f32_16x16x32_bf16 v[32:35], v[56:59], v[140:143], v[32:35]
    ds_read_b64_tr_b16 v[54:55], v91 offset:26624
    buffer_load_dwordx4 v[132:135], v225, s[40:43], s69 offen offset:2048 sc1
    s_waitcnt vmcnt(14) lgkmcnt(8)
    v_mfma_f32_16x16x32_bf16 v[4:7], v[60:63], v[144:147], v[4:7]
    ds_read_b64_tr_b16 v[56:57], v88 offset:28672
    v_mfma_f32_16x16x32_bf16 v[20:23], v[60:63], v[148:151], v[20:23]
    ds_read_b64_tr_b16 v[58:59], v88 offset:30720
    v_mfma_f32_16x16x32_bf16 v[8:11], v[64:67], v[144:147], v[8:11]
    ds_read_b64_tr_b16 v[60:61], v89 offset:28672
    v_mfma_f32_16x16x32_bf16 v[24:27], v[64:67], v[148:151], v[24:27]
    ds_read_b64_tr_b16 v[62:63], v89 offset:30720
    buffer_load_dwordx4 v[136:139], v224, s[40:43], s69 offen offset:3072 sc1
    v_mfma_f32_16x16x32_bf16 v[12:15], v[68:71], v[144:147], v[12:15]
    ds_read_b64_tr_b16 v[64:65], v90 offset:28672
    v_mfma_f32_16x16x32_bf16 v[28:31], v[68:71], v[148:151], v[28:31]
    ds_read_b64_tr_b16 v[66:67], v90 offset:30720
    v_mfma_f32_16x16x32_bf16 v[16:19], v[36:39], v[144:147], v[16:19]
    ds_read_b64_tr_b16 v[68:69], v91 offset:28672
    v_mfma_f32_16x16x32_bf16 v[32:35], v[36:39], v[148:151], v[32:35]
    ds_read_b64_tr_b16 v[70:71], v91 offset:30720
    buffer_load_dwordx4 v[140:143], v225, s[40:43], s69 offen offset:3072 sc1
    s_waitcnt vmcnt(14) lgkmcnt(8)
    v_mfma_f32_16x16x32_bf16 v[4:7], v[40:43], v[152:155], v[4:7]
    ds_read_b64_tr_b16 v[36:37], v88 offset:32768
    v_mfma_f32_16x16x32_bf16 v[20:23], v[40:43], v[156:159], v[20:23]
    ds_read_b64_tr_b16 v[38:39], v88 offset:34816
    v_mfma_f32_16x16x32_bf16 v[8:11], v[44:47], v[152:155], v[8:11]
    ds_read_b64_tr_b16 v[40:41], v89 offset:32768
    v_mfma_f32_16x16x32_bf16 v[24:27], v[44:47], v[156:159], v[24:27]
    ds_read_b64_tr_b16 v[42:43], v89 offset:34816
    buffer_load_dwordx4 v[144:147], v224, s[40:43], s70 offen offset:0 sc1
    v_mfma_f32_16x16x32_bf16 v[12:15], v[48:51], v[152:155], v[12:15]
    ds_read_b64_tr_b16 v[44:45], v90 offset:32768
    v_mfma_f32_16x16x32_bf16 v[28:31], v[48:51], v[156:159], v[28:31]
    ds_read_b64_tr_b16 v[46:47], v90 offset:34816
    v_mfma_f32_16x16x32_bf16 v[16:19], v[52:55], v[152:155], v[16:19]
    ds_read_b64_tr_b16 v[48:49], v91 offset:32768
    v_mfma_f32_16x16x32_bf16 v[32:35], v[52:55], v[156:159], v[32:35]
    ds_read_b64_tr_b16 v[50:51], v91 offset:34816
    buffer_load_dwordx4 v[148:151], v225, s[40:43], s70 offen offset:0 sc1
    ds_read_b32 v1, v228 offset:12
    s_waitcnt vmcnt(14) lgkmcnt(9)
    v_mfma_f32_16x16x32_bf16 v[4:7], v[56:59], v[160:163], v[4:7]
    ds_read_b64_tr_b16 v[52:53], v88 offset:36864
    v_mfma_f32_16x16x32_bf16 v[20:23], v[56:59], v[164:167], v[20:23]
    ds_read_b64_tr_b16 v[54:55], v88 offset:38912
    v_mfma_f32_16x16x32_bf16 v[8:11], v[60:63], v[160:163], v[8:11]
    ds_read_b64_tr_b16 v[56:57], v89 offset:36864
    v_mfma_f32_16x16x32_bf16 v[24:27], v[60:63], v[164:167], v[24:27]
    ds_read_b64_tr_b16 v[58:59], v89 offset:38912
    buffer_load_dwordx4 v[152:155], v224, s[40:43], s70 offen offset:1024 sc1
    v_mfma_f32_16x16x32_bf16 v[12:15], v[64:67], v[160:163], v[12:15]
    ds_read_b64_tr_b16 v[60:61], v90 offset:36864
    v_mfma_f32_16x16x32_bf16 v[28:31], v[64:67], v[164:167], v[28:31]
    ds_read_b64_tr_b16 v[62:63], v90 offset:38912
    v_mfma_f32_16x16x32_bf16 v[16:19], v[68:71], v[160:163], v[16:19]
    ds_read_b64_tr_b16 v[64:65], v91 offset:36864
    v_mfma_f32_16x16x32_bf16 v[32:35], v[68:71], v[164:167], v[32:35]
    ds_read_b64_tr_b16 v[66:67], v91 offset:38912
    buffer_load_dwordx4 v[156:159], v225, s[40:43], s70 offen offset:1024 sc1
    s_waitcnt lgkmcnt(8)
    v_readfirstlane_b32 s37, v1
    s_nop 0
    s_cmp_ge_u32 s37, 4
    s_cbranch_scc1 L_sl_done_51
    s_mov_b32 s38, 1048576
L_sl_loop_52:
    ds_read_b32 v1, v228 offset:12
    s_waitcnt lgkmcnt(0)
    v_readfirstlane_b32 s37, v1
    s_nop 0
    s_cmp_ge_u32 s37, 4
    s_cbranch_scc1 L_sl_done_51
    s_sleep 1
    s_sub_u32 s38, s38, 1
    s_cbranch_scc0 L_sl_loop_52
L_sl_done_51:
    s_waitcnt vmcnt(14)
    v_mfma_f32_16x16x32_bf16 v[4:7], v[36:39], v[96:99], v[4:7]
    ds_read_b64_tr_b16 v[68:69], v92 offset:0
    v_mfma_f32_16x16x32_bf16 v[20:23], v[36:39], v[100:103], v[20:23]
    ds_read_b64_tr_b16 v[70:71], v92 offset:2048
    v_mfma_f32_16x16x32_bf16 v[8:11], v[40:43], v[96:99], v[8:11]
    ds_read_b64_tr_b16 v[36:37], v93 offset:0
    v_mfma_f32_16x16x32_bf16 v[24:27], v[40:43], v[100:103], v[24:27]
    ds_read_b64_tr_b16 v[38:39], v93 offset:2048
    buffer_load_dwordx4 v[160:163], v224, s[40:43], s70 offen offset:2048 sc1
    v_mfma_f32_16x16x32_bf16 v[12:15], v[44:47], v[96:99], v[12:15]
    ds_read_b64_tr_b16 v[40:41], v94 offset:0
    v_mfma_f32_16x16x32_bf16 v[28:31], v[44:47], v[100:103], v[28:31]
    ds_read_b64_tr_b16 v[42:43], v94 offset:2048
    v_mfma_f32_16x16x32_bf16 v[16:19], v[48:51], v[96:99], v[16:19]
    ds_read_b64_tr_b16 v[44:45], v95 offset:0
    v_mfma_f32_16x16x32_bf16 v[32:35], v[48:51], v[100:103], v[32:35]
    ds_read_b64_tr_b16 v[46:47], v95 offset:2048
    buffer_load_dwordx4 v[164:167], v225, s[40:43], s70 offen offset:2048 sc1
    s_waitcnt vmcnt(14) lgkmcnt(8)
    v_mfma_f32_16x16x32_bf16 v[4:7], v[52:55], v[104:107], v[4:7]
    ds_read_b64_tr_b16 v[48:49], v92 offset:4096
    v_mfma_f32_16x16x32_bf16 v[20:23], v[52:55], v[108:111], v[20:23]
    ds_read_b64_tr_b16 v[50:51], v92 offset:6144
    v_mfma_f32_16x16x32_bf16 v[8:11], v[56:59], v[104:107], v[8:11]
    ds_read_b64_tr_b16 v[52:53], v93 offset:4096
    v_mfma_f32_16x16x32_bf16 v[24:27], v[56:59], v[108:111], v[24:27]
    ds_read_b64_tr_b16 v[54:55], v93 offset:6144
    buffer_load_dwordx4 v[96:99], v224, s[40:43], s70 offen offset:3072 sc1
    v_mfma_f32_16x16x32_bf16 v[12:15], v[60:63], v[104:107], v[12:15]
    ds_read_b64_tr_b16 v[56:57], v94 offset:4096
    v_mfma_f32_16x16x32_bf16 v[28:31], v[60:63], v[108:111], v[28:31]
    ds_read_b64_tr_b16 v[58:59], v94 offset:6144
    v_mfma_f32_16x16x32_bf16 v[16:19], v[64:67], v[104:107], v[16:19]
    ds_read_b64_tr_b16 v[60:61], v95 offset:4096
    v_mfma_f32_16x16x32_bf16 v[32:35], v[64:67], v[108:111], v[32:35]
    ds_read_b64_tr_b16 v[62:63], v95 offset:6144
    buffer_load_dwordx4 v[100:103], v225, s[40:43], s70 offen offset:3072 sc1
    s_waitcnt vmcnt(14) lgkmcnt(8)
    v_mfma_f32_16x16x32_bf16 v[4:7], v[68:71], v[112:115], v[4:7]
    ds_read_b64_tr_b16 v[64:65], v92 offset:8448
    v_mfma_f32_16x16x32_bf16 v[20:23], v[68:71], v[116:119], v[20:23]
    ds_read_b64_tr_b16 v[66:67], v92 offset:10496
    v_mfma_f32_16x16x32_bf16 v[8:11], v[36:39], v[112:115], v[8:11]
    ds_read_b64_tr_b16 v[68:69], v93 offset:8448
    v_mfma_f32_16x16x32_bf16 v[24:27], v[36:39], v[116:119], v[24:27]
    ds_read_b64_tr_b16 v[70:71], v93 offset:10496
    buffer_load_dwordx4 v[104:107], v224, s[40:43], s71 offen offset:0 sc1
    v_mfma_f32_16x16x32_bf16 v[12:15], v[40:43], v[112:115], v[12:15]
    ds_read_b64_tr_b16 v[36:37], v94 offset:8448
    v_mfma_f32_16x16x32_bf16 v[28:31], v[40:43], v[116:119], v[28:31]
    ds_read_b64_tr_b16 v[38:39], v94 offset:10496
    v_mfma_f32_16x16x32_bf16 v[16:19], v[44:47], v[112:115], v[16:19]
    ds_read_b64_tr_b16 v[40:41], v95 offset:8448
    v_mfma_f32_16x16x32_bf16 v[32:35], v[44:47], v[116:119], v[32:35]
    ds_read_b64_tr_b16 v[42:43], v95 offset:10496
    buffer_load_dwordx4 v[108:111], v225, s[40:43], s71 offen offset:0 sc1
    s_waitcnt vmcnt(14) lgkmcnt(8)
    v_mfma_f32_16x16x32_bf16 v[4:7], v[48:51], v[120:123], v[4:7]
    ds_read_b64_tr_b16 v[44:45], v92 offset:12544
    v_mfma_f32_16x16x32_bf16 v[20:23], v[48:51], v[124:127], v[20:23]
    ds_read_b64_tr_b16 v[46:47], v92 offset:14592
    v_mfma_f32_16x16x32_bf16 v[8:11], v[52:55], v[120:123], v[8:11]
    ds_read_b64_tr_b16 v[48:49], v93 offset:12544
    v_mfma_f32_16x16x32_bf16 v[24:27], v[52:55], v[124:127], v[24:27]
    ds_read_b64_tr_b16 v[50:51], v93 offset:14592
    buffer_load_dwordx4 v[112:115], v224, s[40:43], s71 offen offset:1024 sc1
    v_mfma_f32_16x16x32_bf16 v[12:15], v[56:59], v[120:123], v[12:15]
    ds_read_b64_tr_b16 v[52:53], v94 offset:12544
    v_mfma_f32_16x16x32_bf16 v[28:31], v[56:59], v[124:127], v[28:31]
    ds_read_b64_tr_b16 v[54:55], v94 offset:14592
    v_mfma_f32_16x16x32_bf16 v[16:19], v[60:63], v[120:123], v[16:19]
    ds_read_b64_tr_b16 v[56:57], v95 offset:12544
    v_mfma_f32_16x16x32_bf16 v[32:35], v[60:63], v[124:127], v[32:35]
    ds_read_b64_tr_b16 v[58:59], v95 offset:14592
    buffer_load_dwordx4 v[116:119], v225, s[40:43], s71 offen offset:1024 sc1
    s_waitcnt vmcnt(14) lgkmcnt(8)
    v_mfma_f32_16x16x32_bf16 v[4:7], v[64:67], v[128:131], v[4:7]
    ds_read_b64_tr_b16 v[60:61], v92 offset:16896
    v_mfma_f32_16x16x32_bf16 v[20:23], v[64:67], v[132:135], v[20:23]
    ds_read_b64_tr_b16 v[62:63], v92 offset:18944
    v_mfma_f32_16x16x32_bf16 v[8:11], v[68:71], v[128:131], v[8:11]
    ds_read_b64_tr_b16 v[64:65], v93 offset:16896
    v_mfma_f32_16x16x32_bf16 v[24:27], v[68:71], v[132:135], v[24:27]
    ds_read_b64_tr_b16 v[66:67], v93 offset:18944
    buffer_load_dwordx4 v[120:123], v224, s[40:43], s71 offen offset:2048 sc1
    v_mfma_f32_16x16x32_bf16 v[12:15], v[36:39], v[128:131], v[12:15]
    ds_read_b64_tr_b16 v[68:69], v94 offset:16896
    v_mfma_f32_16x16x32_bf16 v[28:31], v[36:39], v[132:135], v[28:31]
    ds_read_b64_tr_b16 v[70:71], v94 offset:18944
    v_mfma_f32_16x16x32_bf16 v[16:19], v[40:43], v[128:131], v[16:19]
    ds_read_b64_tr_b16 v[36:37], v95 offset:16896
    v_mfma_f32_16x16x32_bf16 v[32:35], v[40:43], v[132:135], v[32:35]
    ds_read_b64_tr_b16 v[38:39], v95 offset:18944
    buffer_load_dwordx4 v[124:127], v225, s[40:43], s71 offen offset:2048 sc1
    s_waitcnt vmcnt(14) lgkmcnt(8)
    v_mfma_f32_16x16x32_bf16 v[4:7], v[44:47], v[136:139], v[4:7]
    ds_read_b64_tr_b16 v[40:41], v92 offset:20992
    v_mfma_f32_16x16x32_bf16 v[20:23], v[44:47], v[140:143], v[20:23]
    ds_read_b64_tr_b16 v[42:43], v92 offset:23040
    v_mfma_f32_16x16x32_bf16 v[8:11], v[48:51], v[136:139], v[8:11]
    ds_read_b64_tr_b16 v[44:45], v93 offset:20992
    v_mfma_f32_16x16x32_bf16 v[24:27], v[48:51], v[140:143], v[24:27]
    ds_read_b64_tr_b16 v[46:47], v93 offset:23040
    buffer_load_dwordx4 v[128:131], v224, s[40:43], s71 offen offset:3072 sc1
    v_mfma_f32_16x16x32_bf16 v[12:15], v[52:55], v[136:139], v[12:15]
    ds_read_b64_tr_b16 v[48:49], v94 offset:20992
    v_mfma_f32_16x16x32_bf16 v[28:31], v[52:55], v[140:143], v[28:31]
    ds_read_b64_tr_b16 v[50:51], v94 offset:23040
    v_mfma_f32_16x16x32_bf16 v[16:19], v[56:59], v[136:139], v[16:19]
    ds_read_b64_tr_b16 v[52:53], v95 offset:20992
    v_mfma_f32_16x16x32_bf16 v[32:35], v[56:59], v[140:143], v[32:35]
    ds_read_b64_tr_b16 v[54:55], v95 offset:23040
    buffer_load_dwordx4 v[132:135], v225, s[40:43], s71 offen offset:3072 sc1
    s_waitcnt vmcnt(14) lgkmcnt(8)
    v_mfma_f32_16x16x32_bf16 v[4:7], v[60:63], v[144:147], v[4:7]
    ds_read_b64_tr_b16 v[56:57], v92 offset:25344
    v_mfma_f32_16x16x32_bf16 v[20:23], v[60:63], v[148:151], v[20:23]
    ds_read_b64_tr_b16 v[58:59], v92 offset:27392
    v_mfma_f32_16x16x32_bf16 v[8:11], v[64:67], v[144:147], v[8:11]
    ds_read_b64_tr_b16 v[60:61], v93 offset:25344
    v_mfma_f32_16x16x32_bf16 v[24:27], v[64:67], v[148:151], v[24:27]
    ds_read_b64_tr_b16 v[62:63], v93 offset:27392
    v_mfma_f32_16x16x32_bf16 v[12:15], v[68:71], v[144:147], v[12:15]
    ds_read_b64_tr_b16 v[64:65], v94 offset:25344
    v_mfma_f32_16x16x32_bf16 v[28:31], v[68:71], v[148:151], v[28:31]
    ds_read_b64_tr_b16 v[66:67], v94 offset:27392
    v_mfma_f32_16x16x32_bf16 v[16:19], v[36:39], v[144:147], v[16:19]
    ds_read_b64_tr_b16 v[68:69], v95 offset:25344
    v_mfma_f32_16x16x32_bf16 v[32:35], v[36:39], v[148:151], v[32:35]
    ds_read_b64_tr_b16 v[70:71], v95 offset:27392
    s_waitcnt vmcnt(12) lgkmcnt(8)
    v_mfma_f32_16x16x32_bf16 v[4:7], v[40:43], v[152:155], v[4:7]
    ds_read_b64_tr_b16 v[36:37], v92 offset:29440
    v_mfma_f32_16x16x32_bf16 v[20:23], v[40:43], v[156:159], v[20:23]
    ds_read_b64_tr_b16 v[38:39], v92 offset:31488
    v_mfma_f32_16x16x32_bf16 v[8:11], v[44:47], v[152:155], v[8:11]
    ds_read_b64_tr_b16 v[40:41], v93 offset:29440
    v_mfma_f32_16x16x32_bf16 v[24:27], v[44:47], v[156:159], v[24:27]
    ds_read_b64_tr_b16 v[42:43], v93 offset:31488
    v_mfma_f32_16x16x32_bf16 v[12:15], v[48:51], v[152:155], v[12:15]
    ds_read_b64_tr_b16 v[44:45], v94 offset:29440
    v_mfma_f32_16x16x32_bf16 v[28:31], v[48:51], v[156:159], v[28:31]
    ds_read_b64_tr_b16 v[46:47], v94 offset:31488
    v_mfma_f32_16x16x32_bf16 v[16:19], v[52:55], v[152:155], v[16:19]
    ds_read_b64_tr_b16 v[48:49], v95 offset:29440
    v_mfma_f32_16x16x32_bf16 v[32:35], v[52:55], v[156:159], v[32:35]
    ds_read_b64_tr_b16 v[50:51], v95 offset:31488
    s_waitcnt vmcnt(10) lgkmcnt(8)
    v_mfma_f32_16x16x32_bf16 v[4:7], v[56:59], v[160:163], v[4:7]
    ds_read_b64_tr_b16 v[52:53], v84 offset:41984
    v_mfma_f32_16x16x32_bf16 v[20:23], v[56:59], v[164:167], v[20:23]
    ds_read_b64_tr_b16 v[54:55], v84 offset:44032
    v_mfma_f32_16x16x32_bf16 v[8:11], v[60:63], v[160:163], v[8:11]
    ds_read_b64_tr_b16 v[56:57], v85 offset:41984
    v_mfma_f32_16x16x32_bf16 v[24:27], v[60:63], v[164:167], v[24:27]
    ds_read_b64_tr_b16 v[58:59], v85 offset:44032
    v_mfma_f32_16x16x32_bf16 v[12:15], v[64:67], v[160:163], v[12:15]
    ds_read_b64_tr_b16 v[60:61], v86 offset:41984
    v_mfma_f32_16x16x32_bf16 v[28:31], v[64:67], v[164:167], v[28:31]
    ds_read_b64_tr_b16 v[62:63], v86 offset:44032
    v_mfma_f32_16x16x32_bf16 v[16:19], v[68:71], v[160:163], v[16:19]
    ds_read_b64_tr_b16 v[64:65], v87 offset:41984
    v_mfma_f32_16x16x32_bf16 v[32:35], v[68:71], v[164:167], v[32:35]
    ds_read_b64_tr_b16 v[66:67], v87 offset:44032
    s_waitcnt vmcnt(8) lgkmcnt(8)
    v_mfma_f32_16x16x32_bf16 v[4:7], v[36:39], v[96:99], v[4:7]
    ds_read_b64_tr_b16 v[68:69], v84 offset:46080
    v_mfma_f32_16x16x32_bf16 v[20:23], v[36:39], v[100:103], v[20:23]
    ds_read_b64_tr_b16 v[70:71], v84 offset:48128
    v_mfma_f32_16x16x32_bf16 v[8:11], v[40:43], v[96:99], v[8:11]
    ds_read_b64_tr_b16 v[36:37], v85 offset:46080
    v_mfma_f32_16x16x32_bf16 v[24:27], v[40:43], v[100:103], v[24:27]
    ds_read_b64_tr_b16 v[38:39], v85 offset:48128
    v_mfma_f32_16x16x32_bf16 v[12:15], v[44:47], v[96:99], v[12:15]
    ds_read_b64_tr_b16 v[40:41], v86 offset:46080
    v_mfma_f32_16x16x32_bf16 v[28:31], v[44:47], v[100:103], v[28:31]
    ds_read_b64_tr_b16 v[42:43], v86 offset:48128
    v_mfma_f32_16x16x32_bf16 v[16:19], v[48:51], v[96:99], v[16:19]
    ds_read_b64_tr_b16 v[44:45], v87 offset:46080
    v_mfma_f32_16x16x32_bf16 v[32:35], v[48:51], v[100:103], v[32:35]
    ds_read_b64_tr_b16 v[46:47], v87 offset:48128
    s_waitcnt vmcnt(6) lgkmcnt(8)
    v_mfma_f32_16x16x32_bf16 v[4:7], v[52:55], v[104:107], v[4:7]
    ds_read_b64_tr_b16 v[48:49], v84 offset:51200
    v_mfma_f32_16x16x32_bf16 v[20:23], v[52:55], v[108:111], v[20:23]
    ds_read_b64_tr_b16 v[50:51], v84 offset:53248
    v_mfma_f32_16x16x32_bf16 v[8:11], v[56:59], v[104:107], v[8:11]
    ds_read_b64_tr_b16 v[52:53], v85 offset:51200
    v_mfma_f32_16x16x32_bf16 v[24:27], v[56:59], v[108:111], v[24:27]
    ds_read_b64_tr_b16 v[54:55], v85 offset:53248
    v_mfma_f32_16x16x32_bf16 v[12:15], v[60:63], v[104:107], v[12:15]
    ds_read_b64_tr_b16 v[56:57], v86 offset:51200
    v_mfma_f32_16x16x32_bf16 v[28:31], v[60:63], v[108:111], v[28:31]
    ds_read_b64_tr_b16 v[58:59], v86 offset:53248
    v_mfma_f32_16x16x32_bf16 v[16:19], v[64:67], v[104:107], v[16:19]
    ds_read_b64_tr_b16 v[60:61], v87 offset:51200
    v_mfma_f32_16x16x32_bf16 v[32:35], v[64:67], v[108:111], v[32:35]
    ds_read_b64_tr_b16 v[62:63], v87 offset:53248
    s_waitcnt vmcnt(4) lgkmcnt(8)
    v_mfma_f32_16x16x32_bf16 v[4:7], v[68:71], v[112:115], v[4:7]
    ds_read_b64_tr_b16 v[64:65], v84 offset:55296
    v_mfma_f32_16x16x32_bf16 v[20:23], v[68:71], v[116:119], v[20:23]
    ds_read_b64_tr_b16 v[66:67], v84 offset:57344
    v_mfma_f32_16x16x32_bf16 v[8:11], v[36:39], v[112:115], v[8:11]
    ds_read_b64_tr_b16 v[68:69], v85 offset:55296
    v_mfma_f32_16x16x32_bf16 v[24:27], v[36:39], v[116:119], v[24:27]
    ds_read_b64_tr_b16 v[70:71], v85 offset:57344
    v_mfma_f32_16x16x32_bf16 v[12:15], v[40:43], v[112:115], v[12:15]
    ds_read_b64_tr_b16 v[36:37], v86 offset:55296
    v_mfma_f32_16x16x32_bf16 v[28:31], v[40:43], v[116:119], v[28:31]
    ds_read_b64_tr_b16 v[38:39], v86 offset:57344
    v_mfma_f32_16x16x32_bf16 v[16:19], v[44:47], v[112:115], v[16:19]
    ds_read_b64_tr_b16 v[40:41], v87 offset:55296
    v_mfma_f32_16x16x32_bf16 v[32:35], v[44:47], v[116:119], v[32:35]
    ds_read_b64_tr_b16 v[42:43], v87 offset:57344
    s_waitcnt vmcnt(2) lgkmcnt(8)
    v_mfma_f32_16x16x32_bf16 v[4:7], v[48:51], v[120:123], v[4:7]
    s_mul_i32 s37, s32, 80896
    s_lshl_b32 s38, s33, 11
    v_mfma_f32_16x16x32_bf16 v[20:23], v[48:51], v[124:127], v[20:23]
    s_add_u32 s37, s37, s38
    s_add_u32 s37, s37, 78848
    v_mfma_f32_16x16x32_bf16 v[8:11], v[52:55], v[120:123], v[8:11]
    v_lshrrev_b32 v1, 5, v0
    v_xor_b32 v1, v1, v0
    v_mfma_f32_16x16x32_bf16 v[24:27], v[52:55], v[124:127], v[24:27]
    v_and_b32 v1, 7, v1
    v_lshl_add_u32 v1, v1, 4, s37
    v_mfma_f32_16x16x32_bf16 v[12:15], v[56:59], v[120:123], v[12:15]
    v_bfe_u32 v2, v0, 4, 1
    v_lshl_add_u32 v1, v2, 3, v1
    v_mfma_f32_16x16x32_bf16 v[28:31], v[56:59], v[124:127], v[28:31]
    v_and_b32 v2, 15, v0
    v_lshl_add_u32 v84, v2, 7, v1
    v_mfma_f32_16x16x32_bf16 v[16:19], v[60:63], v[120:123], v[16:19]
    v_xor_b32 v85, 32, v84
    v_xor_b32 v86, 64, v84
    v_mfma_f32_16x16x32_bf16 v[32:35], v[60:63], v[124:127], v[32:35]
    v_xor_b32 v87, 96, v84
    v_lshrrev_b32 v1, 3, v0
    s_waitcnt vmcnt(0) lgkmcnt(0)
    v_mfma_f32_16x16x32_bf16 v[4:7], v[64:67], v[128:131], v[4:7]
    v_xor_b32 v1, v1, v0
    v_and_b32 v1, 7, v1
    v_mfma_f32_16x16x32_bf16 v[20:23], v[64:67], v[132:135], v[20:23]
    v_and_b32 v2, 56, v0
    v_add_u32 v1, v1, v2
    v_mfma_f32_16x16x32_bf16 v[8:11], v[68:71], v[128:131], v[8:11]
    v_lshl_add_u32 v88, v1, 4, s37
    v_mfma_f32_16x16x32_bf16 v[24:27], v[68:71], v[132:135], v[24:27]
    v_mfma_f32_16x16x32_bf16 v[12:15], v[36:39], v[128:131], v[12:15]
    v_mfma_f32_16x16x32_bf16 v[28:31], v[36:39], v[132:135], v[28:31]
    v_mfma_f32_16x16x32_bf16 v[16:19], v[40:43], v[128:131], v[16:19]
    v_mfma_f32_16x16x32_bf16 v[32:35], v[40:43], v[132:135], v[32:35]
    v_cvt_pk_bf16_f32 v36, v4, v5
    v_cvt_pk_bf16_f32 v37, v6, v7
    ds_write_b64 v84, v[36:37]
    v_cvt_pk_bf16_f32 v38, v8, v9
    v_cvt_pk_bf16_f32 v39, v10, v11
    ds_write_b64 v85, v[38:39]
    v_cvt_pk_bf16_f32 v40, v12, v13
    v_cvt_pk_bf16_f32 v41, v14, v15
    ds_write_b64 v86, v[40:41]
    v_cvt_pk_bf16_f32 v42, v16, v17
    v_cvt_pk_bf16_f32 v43, v18, v19
    ds_write_b64 v87, v[42:43]
    ds_read_b128 v[52:55], v88 offset:0
    ds_read_b128 v[56:59], v88 offset:1024
    v_cvt_pk_bf16_f32 v44, v20, v21
    v_cvt_pk_bf16_f32 v45, v22, v23
    ds_write_b64 v84, v[44:45]
    v_cvt_pk_bf16_f32 v46, v24, v25
    v_cvt_pk_bf16_f32 v47, v26, v27
    ds_write_b64 v85, v[46:47]
    v_cvt_pk_bf16_f32 v48, v28, v29
    v_cvt_pk_bf16_f32 v49, v30, v31
    ds_write_b64 v86, v[48:49]
    v_cvt_pk_bf16_f32 v50, v32, v33
    v_cvt_pk_bf16_f32 v51, v34, v35
    ds_write_b64 v87, v[50:51]
    ds_read_b128 v[60:63], v88 offset:0
    ds_read_b128 v[64:67], v88 offset:1024
    s_mov_b32 s37, 0
    s_waitcnt lgkmcnt(7)
    buffer_store_dwordx4 v[52:55], v226, s[48:51], s37 offen nt
    s_mov_b32 s37, 65536
    s_waitcnt lgkmcnt(6)
    buffer_store_dwordx4 v[56:59], v226, s[48:51], s37 offen nt
    s_mov_b32 s37, 131072
    s_waitcnt lgkmcnt(1)
    buffer_store_dwordx4 v[60:63], v226, s[48:51], s37 offen nt
    s_mov_b32 s37, 196608
    s_waitcnt lgkmcnt(0)
    buffer_store_dwordx4 v[64:67], v226, s[48:51], s37 offen nt
    s_endpgm
L_g1_rare:
    s_waitcnt vmcnt(0)
    s_cmp_lg_u32 s36, 1
    s_cbranch_scc1 L_g1_bar
    v_readfirstlane_b32 s38, v1
    s_nop 0
    s_cmp_ge_u32 s38, 4
    s_cbranch_scc1 L_sl_done_53
    s_mov_b32 s39, 1048576
L_sl_loop_54:
    ds_read_b32 v1, v228 offset:24
    s_waitcnt lgkmcnt(0)
    v_readfirstlane_b32 s38, v1
    s_nop 0
    s_cmp_ge_u32 s38, 4
    s_cbranch_scc1 L_sl_done_53
    s_sleep 1
    s_sub_u32 s39, s39, 1
    s_cbranch_scc0 L_sl_loop_54
L_sl_done_53:
    s_branch L_g1_nobar
L_end:
    s_endpgm
.section .rodata,"a"
.p2align 6
.amdhsa_kernel concat_heads__ssm_conv_h3__sliding_local_dilated__prompt_kernel
  .amdhsa_next_free_vgpr 256
  .amdhsa_next_free_sgpr 102
  .amdhsa_accum_offset 256
  .amdhsa_group_segment_fixed_size 0
  .amdhsa_kernarg_size 96
  .amdhsa_user_sgpr_count 2
  .amdhsa_user_sgpr_kernarg_segment_ptr 1
  .amdhsa_system_sgpr_workgroup_id_x 1
  .amdhsa_float_denorm_mode_32 3
.end_amdhsa_kernel
```

```asm
; @launch grid=(256,1,1) block=(512,1,1) lds=163840
.amdgcn_target "amdgcn-amd-amdhsa--gfx950"
.text
.globl concat_heads__ssm_conv_h3__sliding_local_dilated__prompt_kernel
.p2align 8
.type concat_heads__ssm_conv_h3__sliding_local_dilated__prompt_kernel,@function
concat_heads__ssm_conv_h3__sliding_local_dilated__prompt_kernel:
L_entry:
    s_getpc_b64 s[32:33]
    s_cmp_ge_u32 s2, 256
    s_cbranch_scc1 L_end
    s_load_dwordx16 s[8:23], s[0:1], 0
    s_load_dwordx8 s[24:31], s[0:1], 64
    v_lshrrev_b32 v1, 6, v0
    s_and_b32 s4, s2, 1
    v_readfirstlane_b32 s3, v1
    v_and_b32 v0, 63, v0
    s_bfe_u32 s5, s2, 0x30003
    s_bfe_u32 s6, s2, 0x20001
    s_lshr_b32 s7, s2, 6
    s_lshl2_add_u32 s6, s6, s7
    s_cmp_ge_u32 s3, 4
    s_cbranch_scc1 L_crole
    s_bfe_u32 s34, s2, 0x20003
    s_lshl2_add_u32 s34, s34, s3
    s_lshl_b32 s34, s34, 7
    v_lshl_add_u32 v1, v0, 11, s34
    v_min_u32 v1, L_end-L_entry-8, v1
    s_mov_b64 exec, 0xffff
    global_load_dword v249, v1, s[32:33]
    s_mov_b64 exec, -1
    s_and_b32 s84, s2, 3
    s_lshl2_add_u32 s84, s84, s3
    s_lshr_b32 s85, s2, 2
    s_mul_i32 s86, s3, 8448
    s_add_u32 s86, s86, 125952
    s_lshl_b32 s87, s85, 9
    s_add_u32 s87, s87, s84
    s_lshl_b32 s87, s87, 7
    v_and_b32 v231, 7, v0
    v_lshl_add_u32 v231, v231, 4, s87
    v_lshrrev_b32 v230, 3, v0
    v_lshl_add_u32 v230, v230, 13, v231
    v_subrev_u32 v231, 6144, v230
    v_subrev_u32 v232, 4096, v230
    v_subrev_u32 v233, 2048, v230
    v_add_u32 v234, 4096, v230
    v_lshlrev_b32 v235, 4, v0
    s_lshl_b32 s87, s84, 9
    s_add_u32 m0, s86, 4224
    s_waitcnt lgkmcnt(0)
    s_mov_b32 s80, s14
    s_mov_b32 s81, s15
    s_mov_b32 s82, 0x2000
    s_mov_b32 s83, 0x20000
    s_mov_b32 s72, s10
    s_mov_b32 s73, s11
    s_mov_b32 s74, 0x400000
    s_mov_b32 s75, 0x20000
    s_mov_b32 exec_hi, 0
    buffer_load_dwordx4 v235, s[80:83], s87 offen lds
    s_mov_b64 exec, -1
    buffer_load_dwordx4 v[108:111], v231, s[72:75], 0 offen offset:0 nt
    buffer_load_dwordx4 v[112:115], v232, s[72:75], 0 offen offset:0 nt
    buffer_load_dwordx4 v[116:119], v233, s[72:75], 0 offen offset:0 nt
    buffer_load_dwordx4 v[120:123], v230, s[72:75], 0 offen offset:0 nt
    buffer_load_dwordx4 v[124:127], v230, s[72:75], 0 offen offset:2048 nt
    buffer_load_dwordx4 v[128:131], v234, s[72:75], 0 offen offset:0 nt
    buffer_load_dwordx4 v[132:135], v234, s[72:75], 0 offen offset:2048 nt
    s_mov_b32 s76, s12
    s_mov_b32 s77, s13
    s_mov_b32 s78, 0x400000
    s_mov_b32 s79, 0x20000
    buffer_load_dwordx4 v[136:139], v230, s[76:79], 0 offen offset:0 nt
    buffer_load_dwordx4 v[140:143], v230, s[76:79], 0 offen offset:2048 nt
    buffer_load_dwordx4 v[144:147], v234, s[76:79], 0 offen offset:0 nt
    buffer_load_dwordx4 v[148:151], v234, s[76:79], 0 offen offset:2048 nt
    s_lshr_b32 s90, s2, 3
    s_and_b32 s91, s3, 3
    s_lshl2_add_u32 s90, s90, s91
    s_and_b32 s91, s2, 6
    s_lshl3_add_u32 s88, s90, s91
    s_lshl1_add_u32 s88, s88, s4
    s_lshl_b32 s88, s88, 11
    s_and_b32 s89, s2, 7
    s_and_b32 s91, s90, 1
    s_lshl1_add_u32 s89, s89, s91
    s_lshr_b32 s90, s90, 1
    s_mul_i32 s90, s90, 48
    s_add_u32 s89, s89, s90
    s_lshl_b32 s89, s89, 7
    v_and_b32 v251, 1, v0
    v_lshlrev_b32 v251, 12, v251
    v_lshrrev_b32 v252, 1, v0
    v_lshl_add_u32 v251, v252, 7, v251
    v_lshrrev_b32 v250, 2, v0
    v_mul_u32_u24 v250, 393216, v250
    v_and_b32 v252, 3, v0
    v_lshl_add_u32 v252, v252, 11, v250
    s_mov_b32 s64, s20
    s_mov_b32 s65, s21
    s_mov_b32 s66, 0x400000
    s_mov_b32 s67, 0x20000
    s_mov_b32 s68, s22
    s_mov_b32 s69, s23
    s_mov_b32 s70, 0x600000
    s_mov_b32 s71, 0x20000
    s_mov_b32 exec_lo, 0x777
    s_mov_b32 exec_hi, 0x0
    s_bfe_u32 s7, s89, 0x30007
    s_cmp_lg_u32 s7, 1
    s_cbranch_scc1 L_wx3_1
    buffer_load_dword v250, v252, s[68:71], s89 offen offset:256
L_wx3_1:
    buffer_load_dword v250, v252, s[68:71], s89 offen
    s_mov_b32 exec_lo, 0x3f
    s_mov_b32 exec_hi, 0
    buffer_load_dword v250, v251, s[64:67], s88 offen
    s_mov_b64 exec, -1
    s_barrier
    s_branch L_grole
L_crole:
    s_sub_u32 s70, s3, 4
    s_lshl_b32 s43, s70, 12
    s_lshl_b32 s44, s70, 11
    s_add_u32 s44, s44, 17408
    s_lshl_b32 s49, s70, 4
    s_lshl_b64 s[46:47], 0xffff, s49
    v_lshrrev_b32 v13, 3, v0
    v_and_b32 v14, 7, v0
    v_lshrrev_b32 v15, 4, v0
    s_lshl2_add_u32 s50, s5, s70
    s_lshl_b32 s50, s50, 6
    s_add_u32 s50, s50, s4
    s_lshl_b32 s50, s50, 11
    v_lshl_add_u32 v16, v13, 12, s50
    v_xor_b32 v17, v14, v15
    v_lshl_add_u32 v2, v17, 4, v16
    v_xor_b32 v3, 64, v2
    v_add_u32 v3, 31744, v3
    v_add_u32 v4, 63488, v2
    v_add_u32 v5, 63488, v3
    s_lshl_b32 s49, s5, 7
    s_sub_u32 s49, s49, 8
    s_max_i32 s49, s49, 0
    s_lshl1_add_u32 s49, s49, s4
    s_lshl_b32 s49, s49, 11
    v_lshl_add_u32 v16, v13, 12, s49
    v_lshlrev_b32 v17, 1, v15
    v_xor_b32 v18, v14, v17
    v_lshl_add_u32 v6, v18, 4, v16
    s_mul_i32 s49, s70, 768
    s_add_u32 s49, s49, s6
    s_lshl_b32 s49, s49, 7
    v_mul_u32_u24 v16, 6144, v13
    v_and_b32 v17, 2, v17
    v_xor_b32 v17, v14, v17
    v_lshlrev_b32 v17, 4, v17
    v_add3_u32 v7, v17, v16, s49
    v_xor_b32 v8, 64, v7
    v_add_u32 v8, 48128, v8
    v_add_u32 v9, 2048, v7
    v_add_u32 v10, 2048, v8
    v_add_u32 v11, 4096, v7
    v_add_u32 v12, 4096, v8
    s_movk_i32 s40, 0
    s_mov_b32 s41, 0
    s_lshr_b32 s90, s2, 3
    s_and_b32 s91, s3, 3
    s_lshl2_add_u32 s90, s90, s91
    s_and_b32 s91, s2, 6
    s_lshl3_add_u32 s88, s90, s91
    s_lshl1_add_u32 s88, s88, s4
    s_lshl_b32 s88, s88, 11
    s_and_b32 s89, s2, 7
    s_and_b32 s91, s90, 1
    s_lshl1_add_u32 s89, s89, s91
    s_lshr_b32 s90, s90, 1
    s_mul_i32 s90, s90, 48
    s_add_u32 s89, s89, s90
    s_lshl_b32 s89, s89, 7
    v_and_b32 v251, 1, v0
    v_lshlrev_b32 v251, 12, v251
    v_lshrrev_b32 v252, 1, v0
    v_lshl_add_u32 v251, v252, 7, v251
    v_lshrrev_b32 v250, 2, v0
    v_mul_u32_u24 v250, 393216, v250
    v_and_b32 v252, 3, v0
    v_lshl_add_u32 v252, v252, 11, v250
    s_waitcnt lgkmcnt(0)
    s_mov_b32 s32, s20
    s_mov_b32 s33, s21
    s_mov_b32 s34, 0x400000
    s_mov_b32 s35, 0x20000
    s_mov_b32 s36, s22
    s_mov_b32 s37, s23
    s_mov_b32 s38, 0x600000
    s_mov_b32 s39, 0x20000
    s_setprio 0
    s_and_b32 s73, s2, 7
    s_xor_b32 s73, s73, 2
    s_lshr_b32 s74, s2, 7
    s_lshl1_add_u32 s68, s73, s74
    s_bfe_u32 s69, s2, 0x40003
    s_lshl4_add_u32 s71, s68, s69
    s_lshl2_add_u32 s71, s71, s70
    s_mul_i32 s80, s70, 8448
    s_add_u32 s80, s80, 125952
    s_mul_i32 s81, s70, 9216
    s_add_u32 s81, s81, 41984
    s_add_u32 s52, s30, 0xe00000
    s_addc_u32 s53, s31, 0
    s_mov_b32 s54, 0x20000
    s_mov_b32 s55, 0x20000
    s_add_u32 s64, s30, 0x900000
    s_addc_u32 s65, s31, 0
    s_mov_b32 s66, 0x420000
    s_mov_b32 s67, 0x20000
    s_lshl_b32 s84, s71, 12
    s_mul_i32 s85, s71, 4224
    s_add_u32 s85, s85, 4194304
    s_lshr_b32 s72, s71, 1
    s_lshl_b32 s72, s72, 2
    s_load_dword s72, s[18:19], s72
    v_lshlrev_b32 v224, 4, v0
    v_mov_b32 v228, 0
    v_mov_b32 v229, 0
    v_mov_b32 v230, 0
    v_mov_b32 v231, 0
    v_mov_b32 v227, 134352
    v_mov_b32 v244, 1
    s_bfe_u32 s87, s2, 0x10003
    s_mov_b64 exec, 1
    ds_write_b128 v227, v[228:231]
    ds_write_b128 v227, v[228:231] offset:16
    ds_write_b128 v227, v[228:231] offset:32
    s_mov_b64 exec, -1
    s_lshr_b32 s74, s69, 2
    s_and_b32 s75, s69, 3
    s_lshl3_add_u32 s74, s74, s75
    s_lshl3_add_u32 s74, s74, s70
    s_lshl_b32 s74, s74, 3
    v_bfe_u32 v234, v0, 3, 1
    v_lshl_add_u32 v225, v234, 8, s74
    v_bfe_u32 v234, v0, 4, 1
    v_lshl_add_u32 v225, v234, 1, v225
    v_lshrrev_b32 v234, 5, v0
    v_lshl_add_u32 v225, v234, 5, v225
    s_lshl_b32 s74, s68, 7
    v_and_b32 v234, 7, v0
    v_lshl_add_u32 v234, v234, 4, s74
    v_lshl_add_u32 v226, v225, 12, v234
    v_lshl_add_u32 v225, v225, 11, v234
    v_and_b32 v234, 1, v0
    v_xor_b32 v234, 1, v234
    v_mul_u32_u24 v232, 4224, v234
    v_mul_u32_u24 v233, 4576, v234
    v_bfe_u32 v234, v0, 1, 3
    v_lshl_add_u32 v232, v234, 3, v232
    v_xor_b32 v234, 7, v234
    v_lshl_add_u32 v233, v234, 6, v233
    v_lshrrev_b32 v234, 4, v0
    v_lshl_add_u32 v232, v234, 4, v232
    v_lshl_add_u32 v233, v234, 4, v233
    v_add3_u32 v232, v232, s80, 8
    v_add_u32 v233, s81, v233
    s_waitcnt lgkmcnt(0)
    s_bitcmp1_b32 s71, 0
    s_cselect_b32 s74, 0, 16
    s_lshl_b32 s72, s72, s74
    s_and_b32 s72, s72, 0xffff0000
    v_and_b32 v235, 1, v0
    v_lshlrev_b32 v235, 4, v235
    v_lshrrev_b32 v235, v235, s72
    v_bfe_u32 v236, v0, 1, 3
    v_lshl_add_u32 v236, v234, 1, v236
    v_cmp_eq_u32 vcc, 7, v236
    v_mov_b32 v241, 0
    v_mov_b32 v243, 0
    v_cndmask_b32 v240, 0, v235, vcc
    v_cmp_eq_u32 vcc, 6, v236
    s_nop 1
    v_cndmask_b32 v242, 0, v235, vcc
    s_barrier
    s_add_u32 m0, s43, 0
    s_nop 0
    buffer_load_dwordx4 v2, s[32:35], s40 offen offset:0 lds
    s_add_u32 m0, s44, 0
    s_nop 0
    buffer_load_dwordx4 v7, s[36:39], s41 offen offset:0 lds
    buffer_load_dwordx4 v8, s[36:39], s41 offen offset:1024 lds
    s_add_u32 m0, s43, 0
    s_nop 0
    buffer_load_dwordx4 v3, s[32:35], s40 offen offset:1024 lds
    s_add_u32 m0, s44, 8192
    s_nop 0
    buffer_load_dwordx4 v9, s[36:39], s41 offen offset:0 lds
    buffer_load_dwordx4 v10, s[36:39], s41 offen offset:1024 lds
    s_add_u32 m0, s43, 0
    s_nop 0
    buffer_load_dwordx4 v4, s[32:35], s40 offen offset:2048 lds
    s_add_u32 m0, s44, 16384
    s_nop 0
    buffer_load_dwordx4 v11, s[36:39], s41 offen offset:0 lds
    buffer_load_dwordx4 v12, s[36:39], s41 offen offset:1024 lds
    s_add_u32 m0, s43, 0
    s_nop 0
    buffer_load_dwordx4 v5, s[32:35], s40 offen offset:3072 lds
    s_mov_b32 m0, 16384
    s_mov_b64 exec, s[46:47]
    buffer_load_dwordx4 v6, s[32:35], s40 offen lds
    s_mov_b64 exec, -1
    s_movk_i32 s40, 128
    s_mov_b32 s41, 393216
    s_add_u32 m0, s43, 41984
    s_nop 0
    buffer_load_dwordx4 v2, s[32:35], s40 offen offset:0 lds
    s_add_u32 m0, s44, 41984
    s_nop 0
    buffer_load_dwordx4 v7, s[36:39], s41 offen offset:0 lds
    buffer_load_dwordx4 v8, s[36:39], s41 offen offset:1024 lds
    s_add_u32 m0, s43, 41984
    s_nop 0
    buffer_load_dwordx4 v3, s[32:35], s40 offen offset:1024 lds
    s_add_u32 m0, s44, 50176
    s_nop 0
    buffer_load_dwordx4 v9, s[36:39], s41 offen offset:0 lds
    buffer_load_dwordx4 v10, s[36:39], s41 offen offset:1024 lds
    s_add_u32 m0, s43, 41984
    s_nop 0
    buffer_load_dwordx4 v4, s[32:35], s40 offen offset:2048 lds
    s_add_u32 m0, s44, 58368
    s_nop 0
    buffer_load_dwordx4 v11, s[36:39], s41 offen offset:0 lds
    buffer_load_dwordx4 v12, s[36:39], s41 offen offset:1024 lds
    s_add_u32 m0, s43, 41984
    s_nop 0
    buffer_load_dwordx4 v5, s[32:35], s40 offen offset:3072 lds
    s_mov_b32 m0, 58368
    s_mov_b64 exec, s[46:47]
    buffer_load_dwordx4 v6, s[32:35], s40 offen lds
    s_mov_b64 exec, -1
    s_movk_i32 s40, 256
    s_mov_b32 s41, 786432
    s_waitcnt vmcnt(11)
    s_barrier
    s_add_u32 m0, s43, 83968
    s_nop 0
    buffer_load_dwordx4 v2, s[32:35], s40 offen offset:0 lds
    s_add_u32 m0, s44, 83968
    s_nop 0
    buffer_load_dwordx4 v7, s[36:39], s41 offen offset:0 lds
    buffer_load_dwordx4 v8, s[36:39], s41 offen offset:1024 lds
    s_add_u32 m0, s43, 83968
    s_nop 0
    buffer_load_dwordx4 v3, s[32:35], s40 offen offset:1024 lds
    s_add_u32 m0, s44, 92160
    s_nop 0
    buffer_load_dwordx4 v9, s[36:39], s41 offen offset:0 lds
    buffer_load_dwordx4 v10, s[36:39], s41 offen offset:1024 lds
    s_add_u32 m0, s43, 83968
    s_nop 0
    buffer_load_dwordx4 v4, s[32:35], s40 offen offset:2048 lds
    s_add_u32 m0, s44, 100352
    s_nop 0
    buffer_load_dwordx4 v11, s[36:39], s41 offen offset:0 lds
    buffer_load_dwordx4 v12, s[36:39], s41 offen offset:1024 lds
    s_add_u32 m0, s43, 83968
    s_nop 0
    buffer_load_dwordx4 v5, s[32:35], s40 offen offset:3072 lds
    s_mov_b32 m0, 100352
    s_mov_b64 exec, s[46:47]
    buffer_load_dwordx4 v6, s[32:35], s40 offen lds
    s_mov_b64 exec, -1
    s_movk_i32 s40, 384
    s_mov_b32 s41, 1179648
    s_mov_b32 exec_lo, 0x7777000
    s_mov_b32 exec_hi, 0x0
    s_bfe_u32 s7, s89, 0x30007
    s_cmp_lg_u32 s7, 1
    s_cbranch_scc1 L_wx3_3
    buffer_load_dword v250, v252, s[36:39], s89 offen offset:256
L_wx3_3:
    buffer_load_dword v250, v252, s[36:39], s89 offen
    s_mov_b32 exec_lo, 0x3fc0
    s_mov_b32 exec_hi, 0
    buffer_load_dword v250, v251, s[32:35], s88 offen
    s_mov_b64 exec, -1
    s_waitcnt vmcnt(13)
    s_barrier
    s_add_u32 m0, s43, 0
    s_nop 0
    buffer_load_dwordx4 v2, s[32:35], s40 offen offset:0 lds
    s_add_u32 m0, s44, 0
    s_nop 0
    buffer_load_dwordx4 v7, s[36:39], s41 offen offset:0 lds
    buffer_load_dwordx4 v8, s[36:39], s41 offen offset:1024 lds
    s_add_u32 m0, s43, 0
    s_nop 0
    buffer_load_dwordx4 v3, s[32:35], s40 offen offset:1024 lds
    s_add_u32 m0, s44, 8192
    s_nop 0
    buffer_load_dwordx4 v9, s[36:39], s41 offen offset:0 lds
    buffer_load_dwordx4 v10, s[36:39], s41 offen offset:1024 lds
    s_add_u32 m0, s43, 0
    s_nop 0
    buffer_load_dwordx4 v4, s[32:35], s40 offen offset:2048 lds
    s_add_u32 m0, s44, 16384
    s_nop 0
    buffer_load_dwordx4 v11, s[36:39], s41 offen offset:0 lds
    buffer_load_dwordx4 v12, s[36:39], s41 offen offset:1024 lds
    s_add_u32 m0, s43, 0
    s_nop 0
    buffer_load_dwordx4 v5, s[32:35], s40 offen offset:3072 lds
    s_mov_b32 m0, 16384
    s_mov_b64 exec, s[46:47]
    buffer_load_dwordx4 v6, s[32:35], s40 offen lds
    s_mov_b64 exec, -1
    s_movk_i32 s40, 512
    s_mov_b32 s41, 1572864
    s_waitcnt vmcnt(13)
    s_barrier
    s_add_u32 m0, s43, 41984
    s_nop 0
    buffer_load_dwordx4 v2, s[32:35], s40 offen offset:0 lds
    s_add_u32 m0, s44, 41984
    s_nop 0
    buffer_load_dwordx4 v7, s[36:39], s41 offen offset:0 lds
    buffer_load_dwordx4 v8, s[36:39], s41 offen offset:1024 lds
    s_add_u32 m0, s43, 41984
    s_nop 0
    buffer_load_dwordx4 v3, s[32:35], s40 offen offset:1024 lds
    s_add_u32 m0, s44, 50176
    s_nop 0
    buffer_load_dwordx4 v9, s[36:39], s41 offen offset:0 lds
    buffer_load_dwordx4 v10, s[36:39], s41 offen offset:1024 lds
    s_add_u32 m0, s43, 41984
    s_nop 0
    buffer_load_dwordx4 v4, s[32:35], s40 offen offset:2048 lds
    s_add_u32 m0, s44, 58368
    s_nop 0
    buffer_load_dwordx4 v11, s[36:39], s41 offen offset:0 lds
    buffer_load_dwordx4 v12, s[36:39], s41 offen offset:1024 lds
    s_add_u32 m0, s43, 41984
    s_nop 0
    buffer_load_dwordx4 v5, s[32:35], s40 offen offset:3072 lds
    s_mov_b32 m0, 58368
    s_mov_b64 exec, s[46:47]
    buffer_load_dwordx4 v6, s[32:35], s40 offen lds
    s_mov_b64 exec, -1
    s_movk_i32 s40, 640
    s_mov_b32 s41, 1966080
    s_cmp_lg_u32 s87, 0
    s_cbranch_scc1 L_stg_6
    s_mov_b32 exec_lo, 0x70000000
    s_mov_b32 exec_hi, 0x777
    s_bfe_u32 s7, s89, 0x30007
    s_cmp_lg_u32 s7, 1
    s_cbranch_scc1 L_wx3_7
    buffer_load_dword v250, v252, s[36:39], s89 offen offset:256
L_wx3_7:
    buffer_load_dword v250, v252, s[36:39], s89 offen
    s_mov_b32 exec_lo, 0x3fc000
    s_mov_b32 exec_hi, 0
    buffer_load_dword v250, v251, s[32:35], s88 offen
    s_mov_b64 exec, -1
L_stg_6:
    s_waitcnt vmcnt(13)
    s_bitcmp1_b32 1, s87
    s_cbranch_scc1 L_mw_8
    s_waitcnt vmcnt(11)
L_mw_8:
    s_barrier
    s_add_u32 m0, s43, 83968
    s_nop 0
    buffer_load_dwordx4 v2, s[32:35], s40 offen offset:0 lds
    s_add_u32 m0, s44, 83968
    s_nop 0
    buffer_load_dwordx4 v7, s[36:39], s41 offen offset:0 lds
    buffer_load_dwordx4 v8, s[36:39], s41 offen offset:1024 lds
    s_add_u32 m0, s43, 83968
    s_nop 0
    buffer_load_dwordx4 v3, s[32:35], s40 offen offset:1024 lds
    s_add_u32 m0, s44, 92160
    s_nop 0
    buffer_load_dwordx4 v9, s[36:39], s41 offen offset:0 lds
    buffer_load_dwordx4 v10, s[36:39], s41 offen offset:1024 lds
    s_add_u32 m0, s43, 83968
    s_nop 0
    buffer_load_dwordx4 v4, s[32:35], s40 offen offset:2048 lds
    s_add_u32 m0, s44, 100352
    s_nop 0
    buffer_load_dwordx4 v11, s[36:39], s41 offen offset:0 lds
    buffer_load_dwordx4 v12, s[36:39], s41 offen offset:1024 lds
    s_add_u32 m0, s43, 83968
    s_nop 0
    buffer_load_dwordx4 v5, s[32:35], s40 offen offset:3072 lds
    s_mov_b32 m0, 100352
    s_mov_b64 exec, s[46:47]
    buffer_load_dwordx4 v6, s[32:35], s40 offen lds
    s_mov_b64 exec, -1
    s_movk_i32 s40, 768
    s_mov_b32 s41, 2359296
    s_cmp_lg_u32 s87, 1
    s_cbranch_scc1 L_stg_9
    s_mov_b32 exec_lo, 0x70000000
    s_mov_b32 exec_hi, 0x777
    s_bfe_u32 s7, s89, 0x30007
    s_cmp_lg_u32 s7, 1
    s_cbranch_scc1 L_wx3_10
    buffer_load_dword v250, v252, s[36:39], s89 offen offset:256
L_wx3_10:
    buffer_load_dword v250, v252, s[36:39], s89 offen
    s_mov_b32 exec_lo, 0x3fc000
    s_mov_b32 exec_hi, 0
    buffer_load_dword v250, v251, s[32:35], s88 offen
    s_mov_b64 exec, -1
L_stg_9:
    s_waitcnt vmcnt(13)
    s_barrier
    s_add_u32 m0, s43, 0
    s_nop 0
    buffer_load_dwordx4 v2, s[32:35], s40 offen offset:0 lds
    s_add_u32 m0, s44, 0
    s_nop 0
    buffer_load_dwordx4 v7, s[36:39], s41 offen offset:0 lds
    buffer_load_dwordx4 v8, s[36:39], s41 offen offset:1024 lds
    s_add_u32 m0, s43, 0
    s_nop 0
    buffer_load_dwordx4 v3, s[32:35], s40 offen offset:1024 lds
    s_add_u32 m0, s44, 8192
    s_nop 0
    buffer_load_dwordx4 v9, s[36:39], s41 offen offset:0 lds
    buffer_load_dwordx4 v10, s[36:39], s41 offen offset:1024 lds
    s_add_u32 m0, s43, 0
    s_nop 0
    buffer_load_dwordx4 v4, s[32:35], s40 offen offset:2048 lds
    s_add_u32 m0, s44, 16384
    s_nop 0
    buffer_load_dwordx4 v11, s[36:39], s41 offen offset:0 lds
    buffer_load_dwordx4 v12, s[36:39], s41 offen offset:1024 lds
    s_add_u32 m0, s43, 0
    s_nop 0
    buffer_load_dwordx4 v5, s[32:35], s40 offen offset:3072 lds
    s_mov_b32 m0, 16384
    s_mov_b64 exec, s[46:47]
    buffer_load_dwordx4 v6, s[32:35], s40 offen lds
    s_mov_b64 exec, -1
    s_movk_i32 s40, 896
    s_mov_b32 s41, 2752512
    s_bfe_u32 s74, s2, 0x20003
    s_lshl2_add_u32 s74, s74, s70
    s_cmp_lg_u32 s74, 0
    s_cbranch_scc1 L_sig_12
    s_mov_b32 s60, s28
    s_mov_b32 s61, s29
    s_mov_b32 s62, 0x100
    s_mov_b32 s63, 0x20000
    s_and_b32 s74, s2, 3
    s_lshl_b32 s74, s74, 6
    s_mov_b64 exec, 1
    buffer_atomic_add v244, off, s[60:63], s74 sc1
    s_mov_b64 exec, -1
L_sig_12:
    s_load_dwordx2 s[90:91], s[16:17], s84 offset:60
    s_load_dwordx2 s[90:91], s[16:17], s84 offset:188
    s_load_dwordx2 s[90:91], s[16:17], s84 offset:316
    s_load_dwordx2 s[90:91], s[16:17], s84 offset:444
    s_waitcnt vmcnt(13)
    s_bitcmp1_b32 2, s87
    s_cbranch_scc1 L_mw_13
    s_waitcnt vmcnt(11)
L_mw_13:
    s_barrier
    s_add_u32 m0, s43, 41984
    s_nop 0
    buffer_load_dwordx4 v2, s[32:35], s40 offen offset:0 lds
    s_add_u32 m0, s44, 41984
    s_nop 0
    buffer_load_dwordx4 v7, s[36:39], s41 offen offset:0 lds
    buffer_load_dwordx4 v8, s[36:39], s41 offen offset:1024 lds
    s_add_u32 m0, s43, 41984
    s_nop 0
    buffer_load_dwordx4 v3, s[32:35], s40 offen offset:1024 lds
    s_add_u32 m0, s44, 50176
    s_nop 0
    buffer_load_dwordx4 v9, s[36:39], s41 offen offset:0 lds
    buffer_load_dwordx4 v10, s[36:39], s41 offen offset:1024 lds
    s_add_u32 m0, s43, 41984
    s_nop 0
    buffer_load_dwordx4 v4, s[32:35], s40 offen offset:2048 lds
    s_add_u32 m0, s44, 58368
    s_nop 0
    buffer_load_dwordx4 v11, s[36:39], s41 offen offset:0 lds
    buffer_load_dwordx4 v12, s[36:39], s41 offen offset:1024 lds
    s_add_u32 m0, s43, 41984
    s_nop 0
    buffer_load_dwordx4 v5, s[32:35], s40 offen offset:3072 lds
    s_mov_b32 m0, 58368
    s_mov_b64 exec, s[46:47]
    buffer_load_dwordx4 v6, s[32:35], s40 offen lds
    s_mov_b64 exec, -1
    s_movk_i32 s40, 1024
    s_mov_b32 s41, 3145728
    s_bfe_u32 s74, s2, 0x20003
    s_lshl2_add_u32 s74, s74, s70
    s_cmp_lg_u32 s74, 4
    s_cbranch_scc1 L_sig_14
    s_mov_b32 s60, s28
    s_mov_b32 s61, s29
    s_mov_b32 s62, 0x100
    s_mov_b32 s63, 0x20000
    s_and_b32 s74, s2, 3
    s_lshl_b32 s74, s74, 6
    s_mov_b64 exec, 1
    buffer_atomic_add v244, off, s[60:63], s74 sc1
    s_mov_b64 exec, -1
L_sig_14:
    s_load_dwordx2 s[90:91], s[16:17], s84 offset:572
    s_load_dwordx2 s[90:91], s[16:17], s84 offset:700
    s_load_dwordx2 s[90:91], s[16:17], s84 offset:828
    s_load_dwordx2 s[90:91], s[16:17], s84 offset:956
    s_waitcnt vmcnt(11)
    s_barrier
    s_add_u32 m0, s43, 83968
    s_nop 0
    buffer_load_dwordx4 v2, s[32:35], s40 offen offset:0 lds
    s_add_u32 m0, s44, 83968
    s_nop 0
    buffer_load_dwordx4 v7, s[36:39], s41 offen offset:0 lds
    buffer_load_dwordx4 v8, s[36:39], s41 offen offset:1024 lds
    s_add_u32 m0, s43, 83968
    s_nop 0
    buffer_load_dwordx4 v3, s[32:35], s40 offen offset:1024 lds
    s_add_u32 m0, s44, 92160
    s_nop 0
    buffer_load_dwordx4 v9, s[36:39], s41 offen offset:0 lds
    buffer_load_dwordx4 v10, s[36:39], s41 offen offset:1024 lds
    s_add_u32 m0, s43, 83968
    s_nop 0
    buffer_load_dwordx4 v4, s[32:35], s40 offen offset:2048 lds
    s_add_u32 m0, s44, 100352
    s_nop 0
    buffer_load_dwordx4 v11, s[36:39], s41 offen offset:0 lds
    buffer_load_dwordx4 v12, s[36:39], s41 offen offset:1024 lds
    s_add_u32 m0, s43, 83968
    s_nop 0
    buffer_load_dwordx4 v5, s[32:35], s40 offen offset:3072 lds
    s_mov_b32 m0, 100352
    s_mov_b64 exec, s[46:47]
    buffer_load_dwordx4 v6, s[32:35], s40 offen lds
    s_mov_b64 exec, -1
    s_movk_i32 s40, 1152
    s_mov_b32 s41, 3538944
    s_cmp_lg_u32 s87, 0
    s_cbranch_scc1 L_stg_16
    s_mov_b32 exec_lo, 0x0
    s_mov_b32 exec_hi, 0x77777000
    s_bfe_u32 s7, s89, 0x30007
    s_cmp_lg_u32 s7, 1
    s_cbranch_scc1 L_wx3_17
    buffer_load_dword v250, v252, s[36:39], s89 offen offset:256
L_wx3_17:
    buffer_load_dword v250, v252, s[36:39], s89 offen
    s_mov_b32 exec_lo, 0xffc00000
    s_mov_b32 exec_hi, 0
    buffer_load_dword v250, v251, s[32:35], s88 offen
    s_mov_b64 exec, -1
L_stg_16:
    s_bfe_u32 s74, s2, 0x20003
    s_lshl2_add_u32 s74, s74, s70
    s_cmp_lg_u32 s74, 8
    s_cbranch_scc1 L_sig_18
    s_mov_b32 s60, s28
    s_mov_b32 s61, s29
    s_mov_b32 s62, 0x100
    s_mov_b32 s63, 0x20000
    s_and_b32 s74, s2, 3
    s_lshl_b32 s74, s74, 6
    s_mov_b64 exec, 1
    buffer_atomic_add v244, off, s[60:63], s74 sc1
    s_mov_b64 exec, -1
L_sig_18:
    s_load_dwordx2 s[90:91], s[16:17], s84 offset:1084
    s_load_dwordx2 s[90:91], s[16:17], s84 offset:1212
    s_load_dwordx2 s[90:91], s[16:17], s84 offset:1340
    s_load_dwordx2 s[90:91], s[16:17], s84 offset:1468
    s_waitcnt vmcnt(13)
    s_bitcmp1_b32 1, s87
    s_cbranch_scc1 L_mw_19
    s_waitcnt vmcnt(11)
L_mw_19:
    s_barrier
    s_add_u32 m0, s43, 0
    s_nop 0
    buffer_load_dwordx4 v2, s[32:35], s40 offen offset:0 lds
    s_add_u32 m0, s44, 0
    s_nop 0
    buffer_load_dwordx4 v7, s[36:39], s41 offen offset:0 lds
    buffer_load_dwordx4 v8, s[36:39], s41 offen offset:1024 lds
    s_add_u32 m0, s43, 0
    s_nop 0
    buffer_load_dwordx4 v3, s[32:35], s40 offen offset:1024 lds
    s_add_u32 m0, s44, 8192
    s_nop 0
    buffer_load_dwordx4 v9, s[36:39], s41 offen offset:0 lds
    buffer_load_dwordx4 v10, s[36:39], s41 offen offset:1024 lds
    s_add_u32 m0, s43, 0
    s_nop 0
    buffer_load_dwordx4 v4, s[32:35], s40 offen offset:2048 lds
    s_add_u32 m0, s44, 16384
    s_nop 0
    buffer_load_dwordx4 v11, s[36:39], s41 offen offset:0 lds
    buffer_load_dwordx4 v12, s[36:39], s41 offen offset:1024 lds
    s_add_u32 m0, s43, 0
    s_nop 0
    buffer_load_dwordx4 v5, s[32:35], s40 offen offset:3072 lds
    s_mov_b32 m0, 16384
    s_mov_b64 exec, s[46:47]
    buffer_load_dwordx4 v6, s[32:35], s40 offen lds
    s_mov_b64 exec, -1
    s_movk_i32 s40, 1280
    s_mov_b32 s41, 3932160
    s_cmp_lg_u32 s87, 1
    s_cbranch_scc1 L_stg_20
    s_mov_b32 exec_lo, 0x0
    s_mov_b32 exec_hi, 0x77777000
    s_bfe_u32 s7, s89, 0x30007
    s_cmp_lg_u32 s7, 1
    s_cbranch_scc1 L_wx3_21
    buffer_load_dword v250, v252, s[36:39], s89 offen offset:256
L_wx3_21:
    buffer_load_dword v250, v252, s[36:39], s89 offen
    s_mov_b32 exec_lo, 0xffc00000
    s_mov_b32 exec_hi, 0
    buffer_load_dword v250, v251, s[32:35], s88 offen
    s_mov_b64 exec, -1
L_stg_20:
    s_bfe_u32 s74, s2, 0x20003
    s_lshl2_add_u32 s74, s74, s70
    s_cmp_lg_u32 s74, 12
    s_cbranch_scc1 L_sig_22
    s_mov_b32 s60, s28
    s_mov_b32 s61, s29
    s_mov_b32 s62, 0x100
    s_mov_b32 s63, 0x20000
    s_and_b32 s74, s2, 3
    s_lshl_b32 s74, s74, 6
    s_mov_b64 exec, 1
    buffer_atomic_add v244, off, s[60:63], s74 sc1
    s_mov_b64 exec, -1
L_sig_22:
    s_load_dwordx2 s[90:91], s[16:17], s84 offset:1596
    s_load_dwordx2 s[90:91], s[16:17], s84 offset:1724
    s_load_dwordx2 s[90:91], s[16:17], s84 offset:1852
    s_load_dwordx2 s[90:91], s[16:17], s84 offset:1980
    s_waitcnt vmcnt(13)
    s_barrier
    s_add_u32 m0, s43, 41984
    s_nop 0
    buffer_load_dwordx4 v2, s[32:35], s40 offen offset:0 lds
    s_add_u32 m0, s44, 41984
    s_nop 0
    buffer_load_dwordx4 v7, s[36:39], s41 offen offset:0 lds
    buffer_load_dwordx4 v8, s[36:39], s41 offen offset:1024 lds
    s_add_u32 m0, s43, 41984
    s_nop 0
    buffer_load_dwordx4 v3, s[32:35], s40 offen offset:1024 lds
    s_add_u32 m0, s44, 50176
    s_nop 0
    buffer_load_dwordx4 v9, s[36:39], s41 offen offset:0 lds
    buffer_load_dwordx4 v10, s[36:39], s41 offen offset:1024 lds
    s_add_u32 m0, s43, 41984
    s_nop 0
    buffer_load_dwordx4 v4, s[32:35], s40 offen offset:2048 lds
    s_add_u32 m0, s44, 58368
    s_nop 0
    buffer_load_dwordx4 v11, s[36:39], s41 offen offset:0 lds
    buffer_load_dwordx4 v12, s[36:39], s41 offen offset:1024 lds
    s_add_u32 m0, s43, 41984
    s_nop 0
    buffer_load_dwordx4 v5, s[32:35], s40 offen offset:3072 lds
    s_mov_b32 m0, 58368
    s_mov_b64 exec, s[46:47]
    buffer_load_dwordx4 v6, s[32:35], s40 offen lds
    s_mov_b64 exec, -1
    s_movk_i32 s40, 1408
    s_mov_b32 s41, 4325376
    s_load_dwordx2 s[90:91], s[16:17], s84 offset:2108
    s_load_dwordx2 s[90:91], s[16:17], s84 offset:2236
    s_load_dwordx2 s[90:91], s[16:17], s84 offset:2364
    s_load_dwordx2 s[90:91], s[16:17], s84 offset:2492
    s_waitcnt vmcnt(13)
    s_bitcmp1_b32 2, s87
    s_cbranch_scc1 L_mw_24
    s_waitcnt vmcnt(11)
L_mw_24:
    s_barrier
    s_add_u32 m0, s43, 83968
    s_nop 0
    buffer_load_dwordx4 v2, s[32:35], s40 offen offset:0 lds
    s_add_u32 m0, s44, 83968
    s_nop 0
    buffer_load_dwordx4 v7, s[36:39], s41 offen offset:0 lds
    buffer_load_dwordx4 v8, s[36:39], s41 offen offset:1024 lds
    s_add_u32 m0, s43, 83968
    s_nop 0
    buffer_load_dwordx4 v3, s[32:35], s40 offen offset:1024 lds
    s_add_u32 m0, s44, 92160
    s_nop 0
    buffer_load_dwordx4 v9, s[36:39], s41 offen offset:0 lds
    buffer_load_dwordx4 v10, s[36:39], s41 offen offset:1024 lds
    s_add_u32 m0, s43, 83968
    s_nop 0
    buffer_load_dwordx4 v4, s[32:35], s40 offen offset:2048 lds
    s_add_u32 m0, s44, 100352
    s_nop 0
    buffer_load_dwordx4 v11, s[36:39], s41 offen offset:0 lds
    buffer_load_dwordx4 v12, s[36:39], s41 offen offset:1024 lds
    s_add_u32 m0, s43, 83968
    s_nop 0
    buffer_load_dwordx4 v5, s[32:35], s40 offen offset:3072 lds
    s_mov_b32 m0, 100352
    s_mov_b64 exec, s[46:47]
    buffer_load_dwordx4 v6, s[32:35], s40 offen lds
    s_mov_b64 exec, -1
    s_movk_i32 s40, 1536
    s_mov_b32 s41, 4718592
    s_load_dwordx2 s[90:91], s[16:17], s84 offset:2620
    s_load_dwordx2 s[90:91], s[16:17], s84 offset:2748
    s_load_dwordx2 s[90:91], s[16:17], s84 offset:2876
    s_load_dwordx2 s[90:91], s[16:17], s84 offset:3004
    s_waitcnt vmcnt(11)
    s_barrier
    s_add_u32 m0, s43, 0
    s_nop 0
    buffer_load_dwordx4 v2, s[32:35], s40 offen offset:0 lds
    s_add_u32 m0, s44, 0
    s_nop 0
    buffer_load_dwordx4 v7, s[36:39], s41 offen offset:0 lds
    buffer_load_dwordx4 v8, s[36:39], s41 offen offset:1024 lds
    s_add_u32 m0, s43, 0
    s_nop 0
    buffer_load_dwordx4 v3, s[32:35], s40 offen offset:1024 lds
    s_add_u32 m0, s44, 8192
    s_nop 0
    buffer_load_dwordx4 v9, s[36:39], s41 offen offset:0 lds
    buffer_load_dwordx4 v10, s[36:39], s41 offen offset:1024 lds
    s_add_u32 m0, s43, 0
    s_nop 0
    buffer_load_dwordx4 v4, s[32:35], s40 offen offset:2048 lds
    s_add_u32 m0, s44, 16384
    s_nop 0
    buffer_load_dwordx4 v11, s[36:39], s41 offen offset:0 lds
    buffer_load_dwordx4 v12, s[36:39], s41 offen offset:1024 lds
    s_add_u32 m0, s43, 0
    s_nop 0
    buffer_load_dwordx4 v5, s[32:35], s40 offen offset:3072 lds
    s_mov_b32 m0, 16384
    s_mov_b64 exec, s[46:47]
    buffer_load_dwordx4 v6, s[32:35], s40 offen lds
    s_mov_b64 exec, -1
    s_movk_i32 s40, 1664
    s_mov_b32 s41, 5111808
    s_load_dwordx2 s[90:91], s[16:17], s84 offset:3132
    s_load_dwordx2 s[90:91], s[16:17], s84 offset:3260
    s_load_dwordx2 s[90:91], s[16:17], s84 offset:3388
    s_load_dwordx2 s[90:91], s[16:17], s84 offset:3516
    s_waitcnt vmcnt(11)
    s_barrier
    s_add_u32 m0, s43, 41984
    s_nop 0
    buffer_load_dwordx4 v2, s[32:35], s40 offen offset:0 lds
    s_add_u32 m0, s44, 41984
    s_nop 0
    buffer_load_dwordx4 v7, s[36:39], s41 offen offset:0 lds
    buffer_load_dwordx4 v8, s[36:39], s41 offen offset:1024 lds
    s_add_u32 m0, s43, 41984
    s_nop 0
    buffer_load_dwordx4 v3, s[32:35], s40 offen offset:1024 lds
    s_add_u32 m0, s44, 50176
    s_nop 0
    buffer_load_dwordx4 v9, s[36:39], s41 offen offset:0 lds
    buffer_load_dwordx4 v10, s[36:39], s41 offen offset:1024 lds
    s_add_u32 m0, s43, 41984
    s_nop 0
    buffer_load_dwordx4 v4, s[32:35], s40 offen offset:2048 lds
    s_add_u32 m0, s44, 58368
    s_nop 0
    buffer_load_dwordx4 v11, s[36:39], s41 offen offset:0 lds
    buffer_load_dwordx4 v12, s[36:39], s41 offen offset:1024 lds
    s_add_u32 m0, s43, 41984
    s_nop 0
    buffer_load_dwordx4 v5, s[32:35], s40 offen offset:3072 lds
    s_mov_b32 m0, 58368
    s_mov_b64 exec, s[46:47]
    buffer_load_dwordx4 v6, s[32:35], s40 offen lds
    s_mov_b64 exec, -1
    s_movk_i32 s40, 1792
    s_mov_b32 s41, 5505024
    s_load_dwordx2 s[90:91], s[16:17], s84 offset:3644
    s_load_dwordx2 s[90:91], s[16:17], s84 offset:3772
    s_load_dwordx2 s[90:91], s[16:17], s84 offset:3900
    s_load_dwordx2 s[90:91], s[16:17], s84 offset:4028
    s_waitcnt vmcnt(11)
    s_barrier
    s_add_u32 m0, s43, 83968
    s_nop 0
    buffer_load_dwordx4 v2, s[32:35], s40 offen offset:0 lds
    s_add_u32 m0, s44, 83968
    s_nop 0
    buffer_load_dwordx4 v7, s[36:39], s41 offen offset:0 lds
    buffer_load_dwordx4 v8, s[36:39], s41 offen offset:1024 lds
    s_add_u32 m0, s43, 83968
    s_nop 0
    buffer_load_dwordx4 v3, s[32:35], s40 offen offset:1024 lds
    s_add_u32 m0, s44, 92160
    s_nop 0
    buffer_load_dwordx4 v9, s[36:39], s41 offen offset:0 lds
    buffer_load_dwordx4 v10, s[36:39], s41 offen offset:1024 lds
    s_add_u32 m0, s43, 83968
    s_nop 0
    buffer_load_dwordx4 v4, s[32:35], s40 offen offset:2048 lds
    s_add_u32 m0, s44, 100352
    s_nop 0
    buffer_load_dwordx4 v11, s[36:39], s41 offen offset:0 lds
    buffer_load_dwordx4 v12, s[36:39], s41 offen offset:1024 lds
    s_add_u32 m0, s43, 83968
    s_nop 0
    buffer_load_dwordx4 v5, s[32:35], s40 offen offset:3072 lds
    s_mov_b32 m0, 100352
    s_mov_b64 exec, s[46:47]
    buffer_load_dwordx4 v6, s[32:35], s40 offen lds
    s_mov_b64 exec, -1
    s_movk_i32 s40, 1920
    s_mov_b32 s41, 5898240
    s_waitcnt vmcnt(11)
    s_barrier
    s_load_dword s76, s[28:29], 0
    s_load_dword s77, s[28:29], 64
    s_load_dword s78, s[28:29], 128
    s_load_dword s79, s[28:29], 192
    s_add_u32 m0, s43, 0
    s_nop 0
    buffer_load_dwordx4 v2, s[32:35], s40 offen offset:0 lds
    s_add_u32 m0, s44, 0
    s_nop 0
    buffer_load_dwordx4 v7, s[36:39], s41 offen offset:0 lds
    buffer_load_dwordx4 v8, s[36:39], s41 offen offset:1024 lds
    s_add_u32 m0, s43, 0
    s_nop 0
    buffer_load_dwordx4 v3, s[32:35], s40 offen offset:1024 lds
    s_add_u32 m0, s44, 8192
    s_nop 0
    buffer_load_dwordx4 v9, s[36:39], s41 offen offset:0 lds
    buffer_load_dwordx4 v10, s[36:39], s41 offen offset:1024 lds
    s_add_u32 m0, s43, 0
    s_nop 0
    buffer_load_dwordx4 v4, s[32:35], s40 offen offset:2048 lds
    s_add_u32 m0, s44, 16384
    s_nop 0
    buffer_load_dwordx4 v11, s[36:39], s41 offen offset:0 lds
    buffer_load_dwordx4 v12, s[36:39], s41 offen offset:1024 lds
    s_add_u32 m0, s43, 0
    s_nop 0
    buffer_load_dwordx4 v5, s[32:35], s40 offen offset:3072 lds
    s_mov_b32 m0, 16384
    s_mov_b64 exec, s[46:47]
    buffer_load_dwordx4 v6, s[32:35], s40 offen lds
    s_mov_b64 exec, -1
    s_movk_i32 s40, 2048
    s_mov_b32 s41, 6291456
    s_mov_b32 s60, s8
    s_mov_b32 s61, s9
    s_mov_b32 s62, 0x400000
    s_mov_b32 s63, 0x20000
    s_movk_i32 s75, 8192
    buffer_load_dwordx4 v[208:211], v225, s[60:63], 0 offen offset:0 nt
    buffer_load_dwordx4 v[212:215], v225, s[60:63], 0 offen offset:2048 nt
    buffer_load_dwordx4 v[216:219], v225, s[60:63], s75 offen offset:0 nt
    buffer_load_dwordx4 v[220:223], v225, s[60:63], s75 offen offset:2048 nt
    s_cmp_lg_u32 s70, 0
    s_cbranch_scc1 L_pc_done_29
    s_waitcnt lgkmcnt(0)
    s_min_u32 s76, s76, s77
    s_min_u32 s78, s78, s79
    s_min_u32 s76, s76, s78
    s_cmp_ge_u32 s76, 64
    s_cbranch_scc1 L_pc_done_29
    s_mov_b32 s60, s28
    s_mov_b32 s61, s29
    s_mov_b32 s62, 0x100
    s_mov_b32 s63, 0x20000
    v_lshlrev_b32 v20, 6, v0
    s_mov_b32 s74, 131072
    s_mov_b64 exec, 0xf
L_pc_loop_30:
    buffer_load_dword v21, v20, s[60:63], 0 offen sc1
    s_waitcnt vmcnt(0)
    v_cmp_gt_u32 vcc, 64, v21
    s_cbranch_vccz L_pc_done_29
    s_sleep 4
    s_sub_u32 s74, s74, 1
    s_cbranch_scc0 L_pc_loop_30
L_pc_done_29:
    s_mov_b64 exec, -1
    s_waitcnt vmcnt(15)
    s_barrier
    s_waitcnt vmcnt(4)
    s_mov_b64 exec, 1
    ds_add_u32 v227, v244 offset:24
    s_mov_b64 exec, -1
    s_add_u32 s56, s30, s85
    s_addc_u32 s57, s31, 0
    s_movk_i32 s58, 4096
    s_mov_b32 s59, 0x20000
    s_add_u32 m0, s81, 0
    s_nop 0
    buffer_load_dwordx4 v224, s[56:59], 0 offen offset:0 sc1 lds
    buffer_load_dwordx4 v224, s[56:59], 0 offen offset:1024 sc1 lds
    buffer_load_dwordx4 v224, s[56:59], 0 offen offset:2048 sc1 lds
    buffer_load_dwordx4 v224, s[56:59], 0 offen offset:3072 sc1 lds
    s_add_u32 m0, s81, 4572
    s_nop 0
    buffer_load_dwordx4 v224, s[56:59], 0 offen offset:0 sc1 lds
    buffer_load_dwordx4 v224, s[56:59], 0 offen offset:1024 sc1 lds
    buffer_load_dwordx4 v224, s[56:59], 0 offen offset:2048 sc1 lds
    buffer_load_dwordx4 v224, s[56:59], 0 offen offset:3072 sc1 lds
    s_add_u32 s56, s16, s84
    s_addc_u32 s57, s17, 0
    s_movk_i32 s58, 4096
    s_mov_b32 s59, 0x20000
    s_add_u32 m0, s80, 64
    v_mov_b32 v132, 0
    v_mov_b32 v133, 0
    v_mov_b32 v134, 0
    v_mov_b32 v135, 0
    buffer_load_dwordx4 v224, s[56:59], 0 offen offset:0 lds
    buffer_load_dwordx4 v224, s[56:59], 0 offen offset:1024 lds
    buffer_load_dwordx4 v224, s[56:59], 0 offen offset:2048 lds
    buffer_load_dwordx4 v224, s[56:59], 0 offen offset:3072 lds
    s_add_u32 m0, s80, 4304
    s_mov_b64 exec, 0x100
    buffer_load_dwordx4 v[132:135], off, s[56:59], 0
    s_mov_b64 exec, -1
    buffer_load_dwordx4 v224, s[56:59], 14 offen offset:0 lds
    buffer_load_dwordx4 v224, s[56:59], 14 offen offset:1024 lds
    buffer_load_dwordx4 v224, s[56:59], 14 offen offset:2048 lds
    buffer_load_dwordx4 v224, s[56:59], 14 offen offset:3072 lds
    v_lshrrev_b32 v234, 5, v0
    v_mul_u32_u24 v234, 4064, v234
    v_add3_u32 v234, v234, v224, s81
    s_mov_b32 exec_lo, 0xfffffff
    s_mov_b32 exec_hi, 0xfffffff
    ds_write_b128 v234, v[228:231] offset:4096
    s_mov_b64 exec, 1
    ds_write_b32 v234, v228 offset:8668
    s_mov_b64 exec, -1
    s_setprio 3
    s_waitcnt vmcnt(9)
    s_mov_b32 s60, s24
    s_mov_b32 s61, s25
    s_mov_b32 s62, 0x200000
    s_mov_b32 s63, 0x20000
    s_lshr_b32 s74, s2, 3
    s_lshl2_add_u32 s74, s74, s70
    s_bfe_u32 s75, s2, 0x10002
    s_lshl4_add_u32 s74, s74, s75
    s_lshl_b32 s74, s74, 10
    v_lshrrev_b32 v234, 3, v0
    v_and_b32 v235, 7, v0
    v_lshlrev_b32 v235, 7, v235
    v_lshl_add_u32 v234, v234, 11, v235
    buffer_load_dword v250, v234, s[60:63], s74 offen
    s_waitcnt vmcnt(1)
    v_cmp_lt_u32 vcc, 3, v0
    v_mov_b32 v140, 4160
    v_lshlrev_b32 v136, 16, v132
    v_cndmask_b32 v140, 0, v140, vcc
    v_alignbit_b32 v137, v133, v132, 16
    v_alignbit_b32 v138, v134, v133, 16
    v_alignbit_b32 v139, v135, v134, 16
    v_add3_u32 v140, v140, v224, s80
    s_mov_b64 exec, 0x1ff
    ds_write_b128 v140, v[136:139]
    s_mov_b64 exec, -1
    ds_read_b128 v[112:115], v233 offset:3584
    ds_read_b64 v[48:49], v232 offset:0
    ds_read_b64 v[50:51], v232 offset:8
    ds_read_b128 v[116:119], v233 offset:3072
    ds_read_b64 v[52:53], v232 offset:512
    ds_read_b64 v[54:55], v232 offset:520
    ds_read_b128 v[120:123], v233 offset:2560
    ds_read_b64 v[56:57], v232 offset:1024
    ds_read_b64 v[58:59], v232 offset:1032
    ds_read_b128 v[124:127], v233 offset:2048
    ds_read_b64 v[60:61], v232 offset:1536
    ds_read_b64 v[62:63], v232 offset:1544
    ds_read_b128 v[128:131], v233 offset:1536
    ds_read_b64 v[64:65], v232 offset:2048
    ds_read_b64 v[66:67], v232 offset:2056
    ds_read_b128 v[132:135], v233 offset:1024
    ds_read_b64 v[68:69], v232 offset:2560
    ds_read_b64 v[70:71], v232 offset:2568
    ds_read_b128 v[136:139], v233 offset:512
    ds_read_b64 v[72:73], v232 offset:3072
    ds_read_b64 v[74:75], v232 offset:3080
    ds_read_b128 v[140:143], v233 offset:0
    ds_read_b64 v[76:77], v232 offset:3584
    ds_read_b64 v[78:79], v232 offset:3592
    s_setprio 1
    s_mov_b32 s74, 3
    s_waitcnt lgkmcnt(0)
    v_mfma_f32_16x16x32_bf16 v[16:19], v[240:243], v[112:115], 0
    v_mfma_f32_16x16x32_bf16 v[20:23], v[240:243], v[116:119], 0
    v_mfma_f32_16x16x32_bf16 v[24:27], v[240:243], v[120:123], 0
    v_mfma_f32_16x16x32_bf16 v[28:31], v[240:243], v[124:127], 0
    v_mfma_f32_16x16x32_bf16 v[32:35], v[240:243], v[128:131], 0
    v_mfma_f32_16x16x32_bf16 v[36:39], v[240:243], v[132:135], 0
    v_mfma_f32_16x16x32_bf16 v[40:43], v[240:243], v[136:139], 0
    v_mfma_f32_16x16x32_bf16 v[44:47], v[240:243], v[140:143], 0
L_conv:
    v_mfma_f32_16x16x32_bf16 v[16:19], v[48:51], v[112:115], v[16:19]
    ds_read_b128 v[144:147], v233 offset:3648
    v_mfma_f32_16x16x32_bf16 v[20:23], v[48:51], v[116:119], v[20:23]
    ds_read_b64 v[80:81], v232 offset:64
    v_mfma_f32_16x16x32_bf16 v[20:23], v[52:55], v[112:115], v[20:23]
    ds_read_b64 v[82:83], v232 offset:72
    v_mfma_f32_16x16x32_bf16 v[24:27], v[48:51], v[120:123], v[24:27]
    ds_read_b128 v[148:151], v233 offset:3136
    v_mfma_f32_16x16x32_bf16 v[24:27], v[52:55], v[116:119], v[24:27]
    ds_read_b64 v[84:85], v232 offset:576
    v_mfma_f32_16x16x32_bf16 v[24:27], v[56:59], v[112:115], v[24:27]
    ds_read_b64 v[86:87], v232 offset:584
    v_mfma_f32_16x16x32_bf16 v[28:31], v[48:51], v[124:127], v[28:31]
    ds_read_b128 v[152:155], v233 offset:2624
    v_mfma_f32_16x16x32_bf16 v[28:31], v[52:55], v[120:123], v[28:31]
    ds_read_b64 v[88:89], v232 offset:1088
    v_mfma_f32_16x16x32_bf16 v[28:31], v[56:59], v[116:119], v[28:31]
    ds_read_b64 v[90:91], v232 offset:1096
    v_mfma_f32_16x16x32_bf16 v[28:31], v[60:63], v[112:115], v[28:31]
    ds_read_b128 v[156:159], v233 offset:2112
    v_mfma_f32_16x16x32_bf16 v[32:35], v[48:51], v[128:131], v[32:35]
    ds_read_b64 v[92:93], v232 offset:1600
    v_mfma_f32_16x16x32_bf16 v[32:35], v[52:55], v[124:127], v[32:35]
    ds_read_b64 v[94:95], v232 offset:1608
    v_mfma_f32_16x16x32_bf16 v[32:35], v[56:59], v[120:123], v[32:35]
    ds_read_b128 v[160:163], v233 offset:1600
    v_mfma_f32_16x16x32_bf16 v[32:35], v[60:63], v[116:119], v[32:35]
    ds_read_b64 v[96:97], v232 offset:2112
    v_mfma_f32_16x16x32_bf16 v[32:35], v[64:67], v[112:115], v[32:35]
    ds_read_b64 v[98:99], v232 offset:2120
    v_mfma_f32_16x16x32_bf16 v[36:39], v[48:51], v[132:135], v[36:39]
    ds_read_b128 v[164:167], v233 offset:1088
    v_mfma_f32_16x16x32_bf16 v[36:39], v[52:55], v[128:131], v[36:39]
    ds_read_b64 v[100:101], v232 offset:2624
    v_mfma_f32_16x16x32_bf16 v[36:39], v[56:59], v[124:127], v[36:39]
    ds_read_b64 v[102:103], v232 offset:2632
    v_mfma_f32_16x16x32_bf16 v[36:39], v[60:63], v[120:123], v[36:39]
    ds_read_b128 v[168:171], v233 offset:576
    v_mfma_f32_16x16x32_bf16 v[36:39], v[64:67], v[116:119], v[36:39]
    ds_read_b64 v[104:105], v232 offset:3136
    v_mfma_f32_16x16x32_bf16 v[36:39], v[68:71], v[112:115], v[36:39]
    ds_read_b64 v[106:107], v232 offset:3144
    v_mfma_f32_16x16x32_bf16 v[40:43], v[48:51], v[136:139], v[40:43]
    ds_read_b128 v[172:175], v233 offset:64
    v_mfma_f32_16x16x32_bf16 v[40:43], v[52:55], v[132:135], v[40:43]
    ds_read_b64 v[108:109], v232 offset:3648
    v_mfma_f32_16x16x32_bf16 v[40:43], v[56:59], v[128:131], v[40:43]
    ds_read_b64 v[110:111], v232 offset:3656
    v_mfma_f32_16x16x32_bf16 v[40:43], v[60:63], v[124:127], v[40:43]
    v_mfma_f32_16x16x32_bf16 v[40:43], v[64:67], v[120:123], v[40:43]
    v_mfma_f32_16x16x32_bf16 v[40:43], v[68:71], v[116:119], v[40:43]
    v_mfma_f32_16x16x32_bf16 v[40:43], v[72:75], v[112:115], v[40:43]
    v_mfma_f32_16x16x32_bf16 v[44:47], v[48:51], v[140:143], v[44:47]
    v_mfma_f32_16x16x32_bf16 v[44:47], v[52:55], v[136:139], v[44:47]
    v_mfma_f32_16x16x32_bf16 v[44:47], v[56:59], v[132:135], v[44:47]
    v_mfma_f32_16x16x32_bf16 v[44:47], v[60:63], v[128:131], v[44:47]
    v_mfma_f32_16x16x32_bf16 v[44:47], v[64:67], v[124:127], v[44:47]
    v_mfma_f32_16x16x32_bf16 v[44:47], v[68:71], v[120:123], v[44:47]
    v_mfma_f32_16x16x32_bf16 v[44:47], v[72:75], v[116:119], v[44:47]
    v_mfma_f32_16x16x32_bf16 v[44:47], v[76:79], v[112:115], v[44:47]
    s_waitcnt lgkmcnt(0)
    v_mfma_f32_16x16x32_bf16 v[16:19], v[80:83], v[144:147], v[16:19]
    ds_read_b128 v[112:115], v233 offset:3712
    v_mfma_f32_16x16x32_bf16 v[20:23], v[80:83], v[148:151], v[20:23]
    ds_read_b64 v[48:49], v232 offset:128
    v_mfma_f32_16x16x32_bf16 v[20:23], v[84:87], v[144:147], v[20:23]
    ds_read_b64 v[50:51], v232 offset:136
    v_mfma_f32_16x16x32_bf16 v[24:27], v[80:83], v[152:155], v[24:27]
    ds_read_b128 v[116:119], v233 offset:3200
    v_mfma_f32_16x16x32_bf16 v[24:27], v[84:87], v[148:151], v[24:27]
    ds_read_b64 v[52:53], v232 offset:640
    v_mfma_f32_16x16x32_bf16 v[24:27], v[88:91], v[144:147], v[24:27]
    ds_read_b64 v[54:55], v232 offset:648
    v_mfma_f32_16x16x32_bf16 v[28:31], v[80:83], v[156:159], v[28:31]
    ds_read_b128 v[120:123], v233 offset:2688
    v_mfma_f32_16x16x32_bf16 v[28:31], v[84:87], v[152:155], v[28:31]
    ds_read_b64 v[56:57], v232 offset:1152
    v_mfma_f32_16x16x32_bf16 v[28:31], v[88:91], v[148:151], v[28:31]
    ds_read_b64 v[58:59], v232 offset:1160
    v_mfma_f32_16x16x32_bf16 v[28:31], v[92:95], v[144:147], v[28:31]
    ds_read_b128 v[124:127], v233 offset:2176
    v_mfma_f32_16x16x32_bf16 v[32:35], v[80:83], v[160:163], v[32:35]
    ds_read_b64 v[60:61], v232 offset:1664
    v_mfma_f32_16x16x32_bf16 v[32:35], v[84:87], v[156:159], v[32:35]
    ds_read_b64 v[62:63], v232 offset:1672
    v_mfma_f32_16x16x32_bf16 v[32:35], v[88:91], v[152:155], v[32:35]
    ds_read_b128 v[128:131], v233 offset:1664
    v_mfma_f32_16x16x32_bf16 v[32:35], v[92:95], v[148:151], v[32:35]
    ds_read_b64 v[64:65], v232 offset:2176
    v_mfma_f32_16x16x32_bf16 v[32:35], v[96:99], v[144:147], v[32:35]
    ds_read_b64 v[66:67], v232 offset:2184
    v_mfma_f32_16x16x32_bf16 v[36:39], v[80:83], v[164:167], v[36:39]
    ds_read_b128 v[132:135], v233 offset:1152
    v_mfma_f32_16x16x32_bf16 v[36:39], v[84:87], v[160:163], v[36:39]
    ds_read_b64 v[68:69], v232 offset:2688
    v_mfma_f32_16x16x32_bf16 v[36:39], v[88:91], v[156:159], v[36:39]
    ds_read_b64 v[70:71], v232 offset:2696
    v_mfma_f32_16x16x32_bf16 v[36:39], v[92:95], v[152:155], v[36:39]
    ds_read_b128 v[136:139], v233 offset:640
    v_mfma_f32_16x16x32_bf16 v[36:39], v[96:99], v[148:151], v[36:39]
    ds_read_b64 v[72:73], v232 offset:3200
    v_mfma_f32_16x16x32_bf16 v[36:39], v[100:103], v[144:147], v[36:39]
    ds_read_b64 v[74:75], v232 offset:3208
    v_mfma_f32_16x16x32_bf16 v[40:43], v[80:83], v[168:171], v[40:43]
    ds_read_b128 v[140:143], v233 offset:128
    v_mfma_f32_16x16x32_bf16 v[40:43], v[84:87], v[164:167], v[40:43]
    ds_read_b64 v[76:77], v232 offset:3712
    v_mfma_f32_16x16x32_bf16 v[40:43], v[88:91], v[160:163], v[40:43]
    ds_read_b64 v[78:79], v232 offset:3720
    v_mfma_f32_16x16x32_bf16 v[40:43], v[92:95], v[156:159], v[40:43]
    v_add_u32 v232, 128, v232
    v_mfma_f32_16x16x32_bf16 v[40:43], v[96:99], v[152:155], v[40:43]
    v_add_u32 v233, 128, v233
    v_mfma_f32_16x16x32_bf16 v[40:43], v[100:103], v[148:151], v[40:43]
    s_sub_u32 s74, s74, 1
    v_mfma_f32_16x16x32_bf16 v[40:43], v[104:107], v[144:147], v[40:43]
    s_cmp_lg_u32 s74, 0
    v_mfma_f32_16x16x32_bf16 v[44:47], v[80:83], v[172:175], v[44:47]
    v_mfma_f32_16x16x32_bf16 v[44:47], v[84:87], v[168:171], v[44:47]
    v_mfma_f32_16x16x32_bf16 v[44:47], v[88:91], v[164:167], v[44:47]
    v_mfma_f32_16x16x32_bf16 v[44:47], v[92:95], v[160:163], v[44:47]
    v_mfma_f32_16x16x32_bf16 v[44:47], v[96:99], v[156:159], v[44:47]
    v_mfma_f32_16x16x32_bf16 v[44:47], v[100:103], v[152:155], v[44:47]
    v_mfma_f32_16x16x32_bf16 v[44:47], v[104:107], v[148:151], v[44:47]
    v_mfma_f32_16x16x32_bf16 v[44:47], v[108:111], v[144:147], v[44:47]
    s_waitcnt lgkmcnt(0)
    s_cbranch_scc1 L_conv
    v_mfma_f32_16x16x32_bf16 v[16:19], v[48:51], v[112:115], v[16:19]
    ds_read_b128 v[144:147], v233 offset:3648
    v_mfma_f32_16x16x32_bf16 v[20:23], v[48:51], v[116:119], v[20:23]
    ds_read_b64 v[80:81], v232 offset:64
    v_mfma_f32_16x16x32_bf16 v[20:23], v[52:55], v[112:115], v[20:23]
    ds_read_b64 v[82:83], v232 offset:72
    v_mfma_f32_16x16x32_bf16 v[24:27], v[48:51], v[120:123], v[24:27]
    ds_read_b128 v[148:151], v233 offset:3136
    v_mfma_f32_16x16x32_bf16 v[24:27], v[52:55], v[116:119], v[24:27]
    ds_read_b64 v[84:85], v232 offset:576
    v_mfma_f32_16x16x32_bf16 v[24:27], v[56:59], v[112:115], v[24:27]
    ds_read_b64 v[86:87], v232 offset:584
    v_mfma_f32_16x16x32_bf16 v[28:31], v[48:51], v[124:127], v[28:31]
    ds_read_b128 v[152:155], v233 offset:2624
    v_mfma_f32_16x16x32_bf16 v[28:31], v[52:55], v[120:123], v[28:31]
    ds_read_b64 v[88:89], v232 offset:1088
    v_mfma_f32_16x16x32_bf16 v[28:31], v[56:59], v[116:119], v[28:31]
    ds_read_b64 v[90:91], v232 offset:1096
    v_mfma_f32_16x16x32_bf16 v[28:31], v[60:63], v[112:115], v[28:31]
    ds_read_b128 v[156:159], v233 offset:2112
    v_mfma_f32_16x16x32_bf16 v[32:35], v[48:51], v[128:131], v[32:35]
    ds_read_b64 v[92:93], v232 offset:1600
    v_mfma_f32_16x16x32_bf16 v[32:35], v[52:55], v[124:127], v[32:35]
    ds_read_b64 v[94:95], v232 offset:1608
    v_mfma_f32_16x16x32_bf16 v[32:35], v[56:59], v[120:123], v[32:35]
    ds_read_b128 v[160:163], v233 offset:1600
    v_mfma_f32_16x16x32_bf16 v[32:35], v[60:63], v[116:119], v[32:35]
    ds_read_b64 v[96:97], v232 offset:2112
    v_mfma_f32_16x16x32_bf16 v[32:35], v[64:67], v[112:115], v[32:35]
    ds_read_b64 v[98:99], v232 offset:2120
    v_mfma_f32_16x16x32_bf16 v[36:39], v[48:51], v[132:135], v[36:39]
    ds_read_b128 v[164:167], v233 offset:1088
    v_mfma_f32_16x16x32_bf16 v[36:39], v[52:55], v[128:131], v[36:39]
    ds_read_b64 v[100:101], v232 offset:2624
    v_mfma_f32_16x16x32_bf16 v[36:39], v[56:59], v[124:127], v[36:39]
    ds_read_b64 v[102:103], v232 offset:2632
    v_mfma_f32_16x16x32_bf16 v[36:39], v[60:63], v[120:123], v[36:39]
    ds_read_b128 v[168:171], v233 offset:576
    v_mfma_f32_16x16x32_bf16 v[36:39], v[64:67], v[116:119], v[36:39]
    ds_read_b64 v[104:105], v232 offset:3136
    v_mfma_f32_16x16x32_bf16 v[36:39], v[68:71], v[112:115], v[36:39]
    ds_read_b64 v[106:107], v232 offset:3144
    v_mfma_f32_16x16x32_bf16 v[40:43], v[48:51], v[136:139], v[40:43]
    ds_read_b128 v[172:175], v233 offset:64
    v_mfma_f32_16x16x32_bf16 v[40:43], v[52:55], v[132:135], v[40:43]
    ds_read_b64 v[108:109], v232 offset:3648
    v_mfma_f32_16x16x32_bf16 v[40:43], v[56:59], v[128:131], v[40:43]
    ds_read_b64 v[110:111], v232 offset:3656
    v_mfma_f32_16x16x32_bf16 v[40:43], v[60:63], v[124:127], v[40:43]
    s_mul_i32 s74, s68, 4224
    v_mfma_f32_16x16x32_bf16 v[40:43], v[64:67], v[120:123], v[40:43]
    s_and_b32 s75, s71, 63
    v_mfma_f32_16x16x32_bf16 v[40:43], v[68:71], v[116:119], v[40:43]
    s_add_u32 s74, s74, s75
    v_mfma_f32_16x16x32_bf16 v[40:43], v[72:75], v[112:115], v[40:43]
    s_lshl_b32 s74, s74, 6
    v_mfma_f32_16x16x32_bf16 v[44:47], v[48:51], v[140:143], v[44:47]
    v_and_b32 v234, 3, v0
    v_mfma_f32_16x16x32_bf16 v[44:47], v[52:55], v[136:139], v[44:47]
    v_lshl_add_u32 v234, v234, 4, s74
    v_mfma_f32_16x16x32_bf16 v[44:47], v[56:59], v[132:135], v[44:47]
    v_and_b32 v235, 12, v0
    v_mfma_f32_16x16x32_bf16 v[44:47], v[60:63], v[128:131], v[44:47]
    v_lshrrev_b32 v236, 4, v0
    v_mfma_f32_16x16x32_bf16 v[44:47], v[64:67], v[124:127], v[44:47]
    v_add_u32 v235, v235, v236
    v_mfma_f32_16x16x32_bf16 v[44:47], v[68:71], v[120:123], v[44:47]
    v_mul_u32_u24 v235, 4224, v235
    v_mfma_f32_16x16x32_bf16 v[44:47], v[72:75], v[116:119], v[44:47]
    v_add_u32 v234, v234, v235
    v_mfma_f32_16x16x32_bf16 v[44:47], v[76:79], v[112:115], v[44:47]
    s_waitcnt lgkmcnt(0)
    s_mov_b64 exec, 1
    ds_add_u32 v227, v244 offset:36
    s_mov_b64 exec, -1
    v_mfma_f32_16x16x32_bf16 v[16:19], v[80:83], v[144:147], v[16:19]
    s_bfe_u32 s86, s2, 0x10002
    s_lshr_b32 s74, s2, 5
    v_mfma_f32_16x16x32_bf16 v[20:23], v[80:83], v[148:151], v[20:23]
    s_lshl3_add_u32 s86, s86, s74
    v_lshrrev_b32 v236, 4, v0
    v_mfma_f32_16x16x32_bf16 v[20:23], v[84:87], v[144:147], v[20:23]
    v_lshlrev_b32 v236, 1, v236
    v_xor_b32 v236, v0, v236
    v_mfma_f32_16x16x32_bf16 v[24:27], v[80:83], v[152:155], v[24:27]
    v_and_b32 v236, 7, v236
    s_lshl_b32 s74, s86, 7
    v_cvt_pk_bf16_f32 v48, v16, v17
    v_cvt_pk_bf16_f32 v49, v18, v19
    v_mfma_f32_16x16x32_bf16 v[24:27], v[84:87], v[148:151], v[24:27]
    v_lshl_add_u32 v236, v236, 4, s74
    v_lshrrev_b32 v235, 3, v0
    v_cvt_pk_bf16_f32 v50, v20, v21
    v_cvt_pk_bf16_f32 v51, v22, v23
    v_mfma_f32_16x16x32_bf16 v[24:27], v[88:91], v[144:147], v[24:27]
    v_lshl_add_u32 v235, v235, 11, v236
    s_mov_b32 s56, s24
    s_mov_b32 s76, 0
    buffer_store_dwordx4 v[48:51], v234, s[64:67], s76 offen sc1
    v_mfma_f32_16x16x32_bf16 v[28:31], v[80:83], v[156:159], v[28:31]
    s_mov_b32 s57, s25
    s_mov_b32 s58, 0x200000
    v_mfma_f32_16x16x32_bf16 v[28:31], v[84:87], v[152:155], v[28:31]
    s_mov_b32 s59, 0x20000
    s_mul_i32 s74, s86, 4
    v_cvt_pk_bf16_f32 v52, v24, v25
    v_cvt_pk_bf16_f32 v53, v26, v27
    v_mfma_f32_16x16x32_bf16 v[28:31], v[88:91], v[148:151], v[28:31]
    s_and_b32 s74, s74, 7
    s_lshl1_add_u32 s82, s74, s70
    v_mfma_f32_16x16x32_bf16 v[28:31], v[92:95], v[144:147], v[28:31]
    s_lshl_b32 s82, s82, 17
    s_lshl4_add_u32 s73, s68, 256
    v_mfma_f32_16x16x32_bf16 v[32:35], v[80:83], v[160:163], v[32:35]
    s_add_u32 s45, s73, s69
    s_lshl_b32 s73, s73, 8
    v_mfma_f32_16x16x32_bf16 v[32:35], v[84:87], v[156:159], v[32:35]
    s_lshl_b32 s45, s45, 8
    v_mfma_f32_16x16x32_bf16 v[32:35], v[88:91], v[152:155], v[32:35]
    v_mfma_f32_16x16x32_bf16 v[32:35], v[92:95], v[148:151], v[32:35]
    v_mfma_f32_16x16x32_bf16 v[32:35], v[96:99], v[144:147], v[32:35]
    v_cvt_pk_bf16_f32 v54, v28, v29
    v_cvt_pk_bf16_f32 v55, v30, v31
    v_mfma_f32_16x16x32_bf16 v[36:39], v[80:83], v[164:167], v[36:39]
    s_mov_b32 s76, 67584
    buffer_store_dwordx4 v[52:55], v234, s[64:67], s76 offen sc1
    v_mfma_f32_16x16x32_bf16 v[36:39], v[84:87], v[160:163], v[36:39]
    v_mfma_f32_16x16x32_bf16 v[36:39], v[88:91], v[156:159], v[36:39]
    v_mfma_f32_16x16x32_bf16 v[36:39], v[92:95], v[152:155], v[36:39]
    v_cvt_pk_bf16_f32 v56, v32, v33
    v_cvt_pk_bf16_f32 v57, v34, v35
    v_mfma_f32_16x16x32_bf16 v[36:39], v[96:99], v[148:151], v[36:39]
    v_mfma_f32_16x16x32_bf16 v[36:39], v[100:103], v[144:147], v[36:39]
    v_mfma_f32_16x16x32_bf16 v[40:43], v[80:83], v[168:171], v[40:43]
    v_mfma_f32_16x16x32_bf16 v[40:43], v[84:87], v[164:167], v[40:43]
    v_mfma_f32_16x16x32_bf16 v[40:43], v[88:91], v[160:163], v[40:43]
    v_mfma_f32_16x16x32_bf16 v[40:43], v[92:95], v[156:159], v[40:43]
    v_mfma_f32_16x16x32_bf16 v[40:43], v[96:99], v[152:155], v[40:43]
    v_mfma_f32_16x16x32_bf16 v[40:43], v[100:103], v[148:151], v[40:43]
    v_mfma_f32_16x16x32_bf16 v[40:43], v[104:107], v[144:147], v[40:43]
    v_mfma_f32_16x16x32_bf16 v[44:47], v[80:83], v[172:175], v[44:47]
    v_cvt_pk_bf16_f32 v58, v36, v37
    v_cvt_pk_bf16_f32 v59, v38, v39
    v_mfma_f32_16x16x32_bf16 v[44:47], v[84:87], v[168:171], v[44:47]
    s_mov_b32 s76, 135168
    buffer_store_dwordx4 v[56:59], v234, s[64:67], s76 offen sc1
    v_mfma_f32_16x16x32_bf16 v[44:47], v[88:91], v[164:167], v[44:47]
    v_mfma_f32_16x16x32_bf16 v[44:47], v[92:95], v[160:163], v[44:47]
    v_cvt_pk_bf16_f32 v60, v40, v41
    v_cvt_pk_bf16_f32 v61, v42, v43
    v_mfma_f32_16x16x32_bf16 v[44:47], v[96:99], v[156:159], v[44:47]
    v_mfma_f32_16x16x32_bf16 v[44:47], v[100:103], v[152:155], v[44:47]
    v_mfma_f32_16x16x32_bf16 v[44:47], v[104:107], v[148:151], v[44:47]
    v_mfma_f32_16x16x32_bf16 v[44:47], v[108:111], v[144:147], v[44:47]
    s_nop 7
    v_cvt_pk_bf16_f32 v62, v44, v45
    v_cvt_pk_bf16_f32 v63, v46, v47
    s_mov_b32 s76, 202752
    buffer_store_dwordx4 v[60:63], v234, s[64:67], s76 offen sc1
    s_setprio 1
    s_waitcnt vmcnt(0)
    v_mov_b32 v238, 1
    s_mov_b64 exec, 1
    ds_add_rtn_u32 v237, v227, v238 offset:8
    s_waitcnt lgkmcnt(0)
    v_readfirstlane_b32 s76, v237
    s_nop 0
    s_cmp_eq_u32 s76, 3
    s_cbranch_scc0 L_jo_35a
    s_mov_b64 exec, 0xffff
    v_lshlrev_b32 v237, 8, v0
    buffer_atomic_add v238, v237, s[52:55], s73 offen sc1
L_jo_35a:
    s_mov_b64 exec, -1
    v_lshlrev_b32 v112, 16, v208
    v_and_b32 v113, 0xffff0000, v208
    v_lshlrev_b32 v114, 16, v209
    v_and_b32 v115, 0xffff0000, v209
    v_lshlrev_b32 v116, 16, v210
    v_and_b32 v117, 0xffff0000, v210
    v_lshlrev_b32 v118, 16, v211
    v_and_b32 v119, 0xffff0000, v211
    v_lshlrev_b32 v120, 16, v212
    v_and_b32 v121, 0xffff0000, v212
    v_lshlrev_b32 v122, 16, v213
    v_and_b32 v123, 0xffff0000, v213
    v_lshlrev_b32 v124, 16, v214
    v_and_b32 v125, 0xffff0000, v214
    v_lshlrev_b32 v126, 16, v215
    v_and_b32 v127, 0xffff0000, v215
    v_lshlrev_b32 v128, 16, v216
    v_and_b32 v129, 0xffff0000, v216
    v_lshlrev_b32 v130, 16, v217
    v_and_b32 v131, 0xffff0000, v217
    v_lshlrev_b32 v132, 16, v218
    v_and_b32 v133, 0xffff0000, v218
    v_lshlrev_b32 v134, 16, v219
    v_and_b32 v135, 0xffff0000, v219
    v_lshlrev_b32 v136, 16, v220
    v_and_b32 v137, 0xffff0000, v220
    v_lshlrev_b32 v138, 16, v221
    v_and_b32 v139, 0xffff0000, v221
    v_lshlrev_b32 v140, 16, v222
    v_and_b32 v141, 0xffff0000, v222
    v_lshlrev_b32 v142, 16, v223
    v_and_b32 v143, 0xffff0000, v223
    s_setprio 1
    s_setprio 1
    s_mul_i32 s77, s70, 4352
    s_add_u32 s77, s77, 60416
    v_lshrrev_b32 v234, 5, v0
    v_lshl_add_u32 v234, v234, 1, v0
    v_lshl_add_u32 v234, v234, 4, s77
    v_and_b32 v235, 7, v0
    v_mul_u32_u24 v235, 544, v235
    v_lshrrev_b32 v236, 3, v0
    v_lshl_add_u32 v235, v236, 3, v235
    v_add_u32 v235, s77, v235
    s_mul_i32 s77, s71, 4224
    s_mov_b32 s60, s26
    s_mov_b32 s61, s27
    s_mov_b32 s62, 0x800000
    s_mov_b32 s63, 0x20000
    s_cmp_eq_u32 s76, 3
    s_cbranch_scc0 L_jo_35
    s_mov_b32 s75, 131072
L_sg_loop_38:
    s_load_dword s74, s[52:53], s45 glc
L_sg_chk_39:
    s_waitcnt lgkmcnt(0)
    s_cmp_ge_u32 s74, 16
    s_cbranch_scc1 L_sg_done_37
    s_sub_u32 s75, s75, 1
    s_cbranch_scc0 L_sg_loop_38
L_sg_done_37:
    v_mov_b32 v237, 16
    s_mov_b64 exec, 1
    ds_add_u32 v227, v237 offset:16
    s_mov_b64 exec, -1
    s_branch L_jd_36
L_jo_35:
    s_mov_b32 s75, 1048576
L_sl_loop_41:
    ds_read_b32 v237, v227 offset:16
    s_waitcnt lgkmcnt(0)
    v_readfirstlane_b32 s74, v237
    s_nop 0
    s_cmp_ge_u32 s74, 16
    s_cbranch_scc1 L_sl_done_40
    s_sleep 1
    s_sub_u32 s75, s75, 1
    s_cbranch_scc0 L_sl_loop_41
L_sl_done_40:
L_jd_36:
    buffer_load_dwordx4 v[48:51], v224, s[64:67], s77 offen offset:0 sc1
    buffer_load_dwordx4 v[52:55], v224, s[64:67], s77 offen offset:1024 sc1
    buffer_load_dwordx4 v[56:59], v224, s[64:67], s77 offen offset:2048 sc1
    buffer_load_dwordx4 v[60:63], v224, s[64:67], s77 offen offset:3072 sc1
    s_waitcnt vmcnt(3)
    ds_write_b128 v234, v[48:51] offset:0
    s_waitcnt vmcnt(2)
    ds_write_b128 v234, v[52:55] offset:1088
    s_waitcnt vmcnt(1)
    ds_write_b128 v234, v[56:59] offset:2176
    s_waitcnt vmcnt(0)
    ds_write_b128 v234, v[60:63] offset:3264
    ds_read_b64 v[64:65], v235 offset:0
    ds_read_b64 v[66:67], v235 offset:64
    ds_read_b64 v[68:69], v235 offset:128
    ds_read_b64 v[70:71], v235 offset:192
    ds_read_b64 v[72:73], v235 offset:256
    ds_read_b64 v[74:75], v235 offset:320
    ds_read_b64 v[76:77], v235 offset:384
    ds_read_b64 v[78:79], v235 offset:448
    s_waitcnt lgkmcnt(7)
    v_lshlrev_b32 v16, 16, v64
    v_and_b32 v24, 0xffff0000, v64
    v_lshlrev_b32 v32, 16, v65
    v_and_b32 v40, 0xffff0000, v65
    s_waitcnt lgkmcnt(6)
    v_lshlrev_b32 v17, 16, v66
    v_and_b32 v25, 0xffff0000, v66
    v_lshlrev_b32 v33, 16, v67
    v_and_b32 v41, 0xffff0000, v67
    s_waitcnt lgkmcnt(5)
    v_lshlrev_b32 v18, 16, v68
    v_and_b32 v26, 0xffff0000, v68
    v_lshlrev_b32 v34, 16, v69
    v_and_b32 v42, 0xffff0000, v69
    s_waitcnt lgkmcnt(4)
    v_lshlrev_b32 v19, 16, v70
    v_and_b32 v27, 0xffff0000, v70
    v_lshlrev_b32 v35, 16, v71
    v_and_b32 v43, 0xffff0000, v71
    s_waitcnt lgkmcnt(3)
    v_lshlrev_b32 v20, 16, v72
    v_and_b32 v28, 0xffff0000, v72
    v_lshlrev_b32 v36, 16, v73
    v_and_b32 v44, 0xffff0000, v73
    s_waitcnt lgkmcnt(2)
    v_lshlrev_b32 v21, 16, v74
    v_and_b32 v29, 0xffff0000, v74
    v_lshlrev_b32 v37, 16, v75
    v_and_b32 v45, 0xffff0000, v75
    s_waitcnt lgkmcnt(1)
    v_lshlrev_b32 v22, 16, v76
    v_and_b32 v30, 0xffff0000, v76
    v_lshlrev_b32 v38, 16, v77
    v_and_b32 v46, 0xffff0000, v77
    s_waitcnt lgkmcnt(0)
    v_lshlrev_b32 v23, 16, v78
    v_and_b32 v31, 0xffff0000, v78
    v_lshlrev_b32 v39, 16, v79
    v_and_b32 v47, 0xffff0000, v79
    v_mul_f32 v16, v16, v112
    v_mul_f32 v17, v17, v113
    v_mul_f32 v18, v18, v114
    v_mul_f32 v19, v19, v115
    v_mul_f32 v20, v20, v116
    v_mul_f32 v21, v21, v117
    v_mul_f32 v22, v22, v118
    v_mul_f32 v23, v23, v119
    v_cvt_pk_bf16_f32 v48, v16, v17
    v_cvt_pk_bf16_f32 v49, v18, v19
    v_cvt_pk_bf16_f32 v50, v20, v21
    v_cvt_pk_bf16_f32 v51, v22, v23
    s_mov_b32 s74, 0
    buffer_store_dwordx4 v[48:51], v226, s[60:63], s74 offen nt
    v_mul_f32 v24, v24, v120
    v_mul_f32 v25, v25, v121
    v_mul_f32 v26, v26, v122
    v_mul_f32 v27, v27, v123
    v_mul_f32 v28, v28, v124
    v_mul_f32 v29, v29, v125
    v_mul_f32 v30, v30, v126
    v_mul_f32 v31, v31, v127
    v_cvt_pk_bf16_f32 v52, v24, v25
    v_cvt_pk_bf16_f32 v53, v26, v27
    v_cvt_pk_bf16_f32 v54, v28, v29
    v_cvt_pk_bf16_f32 v55, v30, v31
    s_mov_b32 s74, 4096
    buffer_store_dwordx4 v[52:55], v226, s[60:63], s74 offen nt
    v_mul_f32 v32, v32, v128
    v_mul_f32 v33, v33, v129
    v_mul_f32 v34, v34, v130
    v_mul_f32 v35, v35, v131
    v_mul_f32 v36, v36, v132
    v_mul_f32 v37, v37, v133
    v_mul_f32 v38, v38, v134
    v_mul_f32 v39, v39, v135
    v_cvt_pk_bf16_f32 v56, v32, v33
    v_cvt_pk_bf16_f32 v57, v34, v35
    v_cvt_pk_bf16_f32 v58, v36, v37
    v_cvt_pk_bf16_f32 v59, v38, v39
    s_mov_b32 s74, 16384
    buffer_store_dwordx4 v[56:59], v226, s[60:63], s74 offen nt
    v_mul_f32 v40, v40, v136
    v_mul_f32 v41, v41, v137
    v_mul_f32 v42, v42, v138
    v_mul_f32 v43, v43, v139
    v_mul_f32 v44, v44, v140
    v_mul_f32 v45, v45, v141
    v_mul_f32 v46, v46, v142
    v_mul_f32 v47, v47, v143
    v_cvt_pk_bf16_f32 v60, v40, v41
    v_cvt_pk_bf16_f32 v61, v42, v43
    v_cvt_pk_bf16_f32 v62, v44, v45
    v_cvt_pk_bf16_f32 v63, v46, v47
    s_mov_b32 s74, 20480
    buffer_store_dwordx4 v[60:63], v226, s[60:63], s74 offen nt
    s_endpgm
L_grole:
    s_setprio 2
    s_add_u32 s52, s30, 0xe00000
    s_addc_u32 s53, s31, 0
    s_mov_b32 s54, 0x20000
    s_mov_b32 s55, 0x20000
    s_lshr_b32 s32, s3, 1
    s_and_b32 s33, s3, 1
    v_and_b32 v1, 15, v0
    v_lshrrev_b32 v2, 4, v0
    v_lshrrev_b32 v3, 1, v1
    v_xor_b32 v3, v2, v3
    v_lshlrev_b32 v3, 4, v3
    v_lshl_add_u32 v3, v1, 7, v3
    s_lshl_b32 s37, s33, 13
    v_add_u32 v196, s37, v3
    v_xor_b32 v197, 64, v196
    v_and_b32 v3, 6, v1
    v_xor_b32 v3, v2, v3
    v_lshlrev_b32 v3, 4, v3
    v_and_b32 v198, 7, v1
    v_lshl_add_u32 v3, v198, 7, v3
    v_add_u32 v198, 16384, v3
    v_xor_b32 v199, 64, v198
    v_bfe_u32 v3, v0, 2, 2
    v_lshl_add_u32 v200, v2, 3, v3
    v_lshlrev_b32 v200, 7, v200
    v_bfe_u32 v3, v0, 3, 2
    v_xor_b32 v3, s3, v3
    v_lshl_add_u32 v200, v3, 5, v200
    v_and_b32 v3, 3, v0
    v_lshl_add_u32 v200, v3, 3, v200
    v_add_u32 v200, 17408, v200
    v_xor_b32 v201, 32, v200
    v_mov_b64 v[52:53], 0
    v_mov_b64 v[54:55], 0
    v_mov_b64 v[56:57], 0
    v_mov_b64 v[58:59], 0
    v_mov_b64 v[60:61], 0
    v_mov_b64 v[62:63], 0
    v_mov_b64 v[64:65], 0
    v_mov_b64 v[66:67], 0
    v_mov_b64 v[68:69], 0
    v_mov_b64 v[70:71], 0
    v_mov_b64 v[72:73], 0
    v_mov_b64 v[74:75], 0
    v_mov_b64 v[76:77], 0
    v_mov_b64 v[78:79], 0
    v_mov_b64 v[80:81], 0
    v_mov_b64 v[82:83], 0
    v_mov_b64 v[84:85], 0
    v_mov_b64 v[86:87], 0
    v_mov_b64 v[88:89], 0
    v_mov_b64 v[90:91], 0
    v_mov_b64 v[92:93], 0
    v_mov_b64 v[94:95], 0
    v_mov_b64 v[96:97], 0
    v_mov_b64 v[98:99], 0
    v_mov_b64 v[100:101], 0
    v_mov_b64 v[102:103], 0
    v_mov_b64 v[104:105], 0
    v_mov_b64 v[106:107], 0
    s_mov_b32 s34, 0
    v_mov_b32 v228, 134352
    v_and_b32 v1, 15, v0
    v_lshrrev_b32 v2, 4, v0
    v_lshlrev_b32 v2, 2, v2
    v_sub_u32 v1, v1, v2
    s_mov_b32 s37, 0xf149f2ca
    v_mov_b32 v3, s37
    s_or_b32 s38, s5, s33
    s_cmp_eq_u32 s38, 0
    s_cselect_b32 s38, s37, 0
    v_subrev_u32 v2, 0, v1
    v_cmp_gt_u32 vcc, 8, v2
    v_cmp_gt_i32 s[64:65], -8, v2
    v_ashrrev_i32 v2, 31, v2
    v_cndmask_b32 v204, v3, 0, vcc
    v_cndmask_b32 v208, v3, 0, s[64:65]
    v_mov_b32 v216, v2
    v_min_f32 v212, s38, v208
    v_subrev_u32 v2, 1, v1
    v_cmp_gt_u32 vcc, 8, v2
    v_cmp_gt_i32 s[64:65], -8, v2
    v_ashrrev_i32 v2, 31, v2
    v_cndmask_b32 v205, v3, 0, vcc
    v_cndmask_b32 v209, v3, 0, s[64:65]
    v_alignbit_b32 v216, v2, v216, 16
    v_min_f32 v213, s38, v209
    v_subrev_u32 v2, 2, v1
    v_cmp_gt_u32 vcc, 8, v2
    v_cmp_gt_i32 s[64:65], -8, v2
    v_ashrrev_i32 v2, 31, v2
    v_cndmask_b32 v206, v3, 0, vcc
    v_cndmask_b32 v210, v3, 0, s[64:65]
    v_mov_b32 v217, v2
    v_min_f32 v214, s38, v210
    v_subrev_u32 v2, 3, v1
    v_cmp_gt_u32 vcc, 8, v2
    v_cmp_gt_i32 s[64:65], -8, v2
    v_ashrrev_i32 v2, 31, v2
    v_cndmask_b32 v207, v3, 0, vcc
    v_cndmask_b32 v211, v3, 0, s[64:65]
    v_alignbit_b32 v217, v2, v217, 16
    v_min_f32 v215, s38, v211
    s_mul_i32 s37, s32, 80896
    s_add_u32 s37, s37, 78848
    v_lshl_add_u32 v220, v0, 3, s37
    s_lshl_b32 s38, s33, 9
    v_add_u32 v219, s38, v220
    s_mul_i32 s38, s33, 2560
    v_add_u32 v221, s38, v220
    v_xor_b32 v222, 512, v221
    s_lshl3_add_u32 s37, s4, s5
    s_lshl1_add_u32 s37, s37, s33
    s_lshl_b32 s37, s37, 7
    s_lshl1_add_u32 s38, s6, s32
    s_add_u32 s37, s37, s38
    s_lshl_b32 s37, s37, 10
    v_lshl_add_u32 v218, v0, 4, s37
    s_mov_b32 s40, s30
    s_mov_b32 s41, s31
    s_mov_b32 s42, 0x400000
    s_mov_b32 s43, 0x20000
    s_and_b32 s58, s2, 3
    s_bfe_u32 s37, s2, 0x20003
    s_lshl2_add_u32 s58, s58, s37
    s_bfe_u32 s59, s2, 0x10002
    s_lshr_b32 s37, s2, 5
    s_lshl3_add_u32 s59, s59, s37
    s_mov_b32 s44, s24
    s_mov_b32 s45, s25
    s_mov_b32 s46, 0x200000
    s_mov_b32 s47, 0x20000
    s_mov_b32 s48, s26
    s_mov_b32 s49, s27
    s_mov_b32 s50, 0x800000
    s_mov_b32 s51, 0x20000
    s_lshl3_add_u32 s56, s4, s5
    s_lshl4_add_u32 s56, s56, 0
    s_lshl_b32 s56, s56, 8
    s_lshl4_add_u32 s57, s58, 0
    s_add_u32 s57, s57, s59
    s_lshl_b32 s57, s57, 8
    s_lshl2_add_u32 s37, s58, s3
    s_lshl_b32 s38, s37, 16
    v_lshl_add_u32 v224, v0, 4, s38
    v_add_u32 v225, 0x8000, v224
    s_and_b32 s37, s37, 31
    s_lshl_b32 s37, s37, 6
    s_lshr_b32 s38, s58, 3
    s_add_u32 s37, s37, s38
    s_lshl_b32 s37, s37, 5
    s_add_u32 s37, s37, s59
    s_add_u32 s37, s37, 16
    s_lshl_b32 s37, s37, 7
    v_lshrrev_b32 v1, 3, v0
    v_lshl_add_u32 v1, v1, 13, s37
    v_and_b32 v2, 7, v0
    v_lshl_add_u32 v226, v2, 4, v1
    v_lshrrev_b32 v1, 4, v0
    v_lshlrev_b32 v1, 1, v1
    v_xor_b32 v1, v0, v1
    v_and_b32 v1, 7, v1
    s_lshl_b32 s37, s59, 7
    v_lshl_add_u32 v1, v1, 4, s37
    v_lshrrev_b32 v227, 3, v0
    v_lshl_add_u32 v227, v227, 11, v1
    v_add_u32 v223, 15360, v227
    s_lshl_b32 s60, s3, 11
    s_mul_i32 s61, s59, 4
    s_and_b32 s61, s61, 7
    s_lshl3_add_u32 s62, s61, s3
    s_lshl_b32 s62, s62, 15
    v_lshrrev_b32 v1, 2, v0
    v_lshlrev_b32 v1, 7, v1
    v_bfe_u32 v2, v0, 3, 2
    v_lshl_add_u32 v1, v2, 5, v1
    v_and_b32 v2, 3, v0
    v_lshl_add_u32 v229, v2, 3, v1
    v_and_b32 v231, 7, v0
    v_lshl_add_u32 v230, v231, 6, s86
    v_mul_u32_u24 v231, 528, v231
    v_lshrrev_b32 v232, 3, v0
    v_xor_b32 v232, 7, v232
    v_lshl_add_u32 v231, v232, 3, v231
    v_add_u32 v231, s86, v231
    v_lshrrev_b32 v232, 5, v0
    v_add_u32 v232, v0, v232
    v_lshl_add_u32 v232, v232, 4, s86
    s_mul_i32 s87, s84, 4224
    s_sub_u32 s87, s87, s85
    s_lshl_b32 s87, s87, 6
    s_add_u32 s87, s87, 4032
    v_and_b32 v233, 3, v0
    v_lshl_add_u32 v233, v233, 4, s87
    v_lshrrev_b32 v234, 2, v0
    v_mul_u32_u24 v234, 4224, v234
    v_add_u32 v233, v233, v234
    s_add_u32 s80, s30, 0x400000
    s_addc_u32 s81, s31, 0
    s_mov_b32 s82, 0x420000
    s_mov_b32 s83, 0x20000
    s_waitcnt vmcnt(13)
    ds_read_b128 v[36:39], v230 offset:4224
    ds_read_b128 v[40:43], v230 offset:4240
    ds_read_b128 v[44:47], v230 offset:4256
    ds_read_b128 v[48:51], v230 offset:4272
    s_waitcnt lgkmcnt(3)
    v_lshlrev_b32 v152, 16, v36
    v_and_b32 v154, 0xffff0000, v36
    v_lshlrev_b32 v156, 16, v37
    v_and_b32 v158, 0xffff0000, v37
    v_lshlrev_b32 v153, 16, v38
    v_and_b32 v155, 0xffff0000, v38
    v_lshlrev_b32 v157, 16, v39
    v_and_b32 v159, 0xffff0000, v39
    s_waitcnt lgkmcnt(2)
    v_lshlrev_b32 v160, 16, v40
    v_and_b32 v162, 0xffff0000, v40
    v_lshlrev_b32 v164, 16, v41
    v_and_b32 v166, 0xffff0000, v41
    v_lshlrev_b32 v161, 16, v42
    v_and_b32 v163, 0xffff0000, v42
    v_lshlrev_b32 v165, 16, v43
    v_and_b32 v167, 0xffff0000, v43
    s_waitcnt lgkmcnt(1)
    v_lshlrev_b32 v168, 16, v44
    v_and_b32 v170, 0xffff0000, v44
    v_lshlrev_b32 v172, 16, v45
    v_and_b32 v174, 0xffff0000, v45
    v_lshlrev_b32 v169, 16, v46
    v_and_b32 v171, 0xffff0000, v46
    v_lshlrev_b32 v173, 16, v47
    v_and_b32 v175, 0xffff0000, v47
    s_waitcnt lgkmcnt(0)
    v_lshlrev_b32 v176, 16, v48
    v_and_b32 v178, 0xffff0000, v48
    v_lshlrev_b32 v180, 16, v49
    v_and_b32 v182, 0xffff0000, v49
    v_lshlrev_b32 v177, 16, v50
    v_and_b32 v179, 0xffff0000, v50
    v_lshlrev_b32 v181, 16, v51
    v_and_b32 v183, 0xffff0000, v51
    v_mov_b64 v[36:37], 0
    v_mov_b64 v[38:39], 0
    v_mov_b64 v[40:41], 0
    v_mov_b64 v[42:43], 0
    v_mov_b64 v[44:45], 0
    v_mov_b64 v[46:47], 0
    v_mov_b64 v[48:49], 0
    v_mov_b64 v[50:51], 0
    s_waitcnt vmcnt(12)
    v_lshlrev_b32 v184, 16, v108
    v_and_b32 v185, 0xffff0000, v108
    v_lshlrev_b32 v186, 16, v109
    v_and_b32 v187, 0xffff0000, v109
    v_lshlrev_b32 v188, 16, v110
    v_and_b32 v189, 0xffff0000, v110
    v_lshlrev_b32 v190, 16, v111
    v_and_b32 v191, 0xffff0000, v111
    v_pk_mul_f32 v[4:5], v[184:185], v[158:159]
    v_pk_mul_f32 v[12:13], v[186:187], v[166:167]
    v_pk_mul_f32 v[20:21], v[188:189], v[174:175]
    v_pk_mul_f32 v[28:29], v[190:191], v[182:183]
    s_waitcnt vmcnt(11)
    v_lshlrev_b32 v184, 16, v112
    v_and_b32 v185, 0xffff0000, v112
    v_lshlrev_b32 v186, 16, v113
    v_and_b32 v187, 0xffff0000, v113
    v_lshlrev_b32 v188, 16, v114
    v_and_b32 v189, 0xffff0000, v114
    v_lshlrev_b32 v190, 16, v115
    v_and_b32 v191, 0xffff0000, v115
    v_pk_fma_f32 v[4:5], v[184:185], v[156:157], v[4:5]
    v_pk_fma_f32 v[12:13], v[186:187], v[164:165], v[12:13]
    v_pk_fma_f32 v[20:21], v[188:189], v[172:173], v[20:21]
    v_pk_fma_f32 v[28:29], v[190:191], v[180:181], v[28:29]
    v_pk_mul_f32 v[6:7], v[184:185], v[158:159]
    v_pk_mul_f32 v[14:15], v[186:187], v[166:167]
    v_pk_mul_f32 v[22:23], v[188:189], v[174:175]
    v_pk_mul_f32 v[30:31], v[190:191], v[182:183]
    s_waitcnt vmcnt(10)
    v_lshlrev_b32 v184, 16, v116
    v_and_b32 v185, 0xffff0000, v116
    v_lshlrev_b32 v186, 16, v117
    v_and_b32 v187, 0xffff0000, v117
    v_lshlrev_b32 v188, 16, v118
    v_and_b32 v189, 0xffff0000, v118
    v_lshlrev_b32 v190, 16, v119
    v_and_b32 v191, 0xffff0000, v119
    v_pk_fma_f32 v[4:5], v[184:185], v[154:155], v[4:5]
    v_pk_fma_f32 v[12:13], v[186:187], v[162:163], v[12:13]
    v_pk_fma_f32 v[20:21], v[188:189], v[170:171], v[20:21]
    v_pk_fma_f32 v[28:29], v[190:191], v[178:179], v[28:29]
    v_pk_fma_f32 v[6:7], v[184:185], v[156:157], v[6:7]
    v_pk_fma_f32 v[14:15], v[186:187], v[164:165], v[14:15]
    v_pk_fma_f32 v[22:23], v[188:189], v[172:173], v[22:23]
    v_pk_fma_f32 v[30:31], v[190:191], v[180:181], v[30:31]
    v_pk_mul_f32 v[8:9], v[184:185], v[158:159]
    v_pk_mul_f32 v[16:17], v[186:187], v[166:167]
    v_pk_mul_f32 v[24:25], v[188:189], v[174:175]
    v_pk_mul_f32 v[32:33], v[190:191], v[182:183]
    s_waitcnt vmcnt(9)
    v_lshlrev_b32 v184, 16, v120
    v_and_b32 v185, 0xffff0000, v120
    v_lshlrev_b32 v186, 16, v121
    v_and_b32 v187, 0xffff0000, v121
    v_lshlrev_b32 v188, 16, v122
    v_and_b32 v189, 0xffff0000, v122
    v_lshlrev_b32 v190, 16, v123
    v_and_b32 v191, 0xffff0000, v123
    v_pk_fma_f32 v[4:5], v[184:185], v[152:153], v[4:5]
    v_pk_fma_f32 v[12:13], v[186:187], v[160:161], v[12:13]
    v_pk_fma_f32 v[20:21], v[188:189], v[168:169], v[20:21]
    v_pk_fma_f32 v[28:29], v[190:191], v[176:177], v[28:29]
    v_pk_fma_f32 v[6:7], v[184:185], v[154:155], v[6:7]
    v_pk_fma_f32 v[14:15], v[186:187], v[162:163], v[14:15]
    v_pk_fma_f32 v[22:23], v[188:189], v[170:171], v[22:23]
    v_pk_fma_f32 v[30:31], v[190:191], v[178:179], v[30:31]
    v_pk_fma_f32 v[8:9], v[184:185], v[156:157], v[8:9]
    v_pk_fma_f32 v[16:17], v[186:187], v[164:165], v[16:17]
    v_pk_fma_f32 v[24:25], v[188:189], v[172:173], v[24:25]
    v_pk_fma_f32 v[32:33], v[190:191], v[180:181], v[32:33]
    v_pk_mul_f32 v[10:11], v[184:185], v[158:159]
    v_pk_mul_f32 v[18:19], v[186:187], v[166:167]
    v_pk_mul_f32 v[26:27], v[188:189], v[174:175]
    v_pk_mul_f32 v[34:35], v[190:191], v[182:183]
    s_waitcnt vmcnt(8)
    v_lshlrev_b32 v184, 16, v124
    v_and_b32 v185, 0xffff0000, v124
    v_lshlrev_b32 v186, 16, v125
    v_and_b32 v187, 0xffff0000, v125
    v_lshlrev_b32 v188, 16, v126
    v_and_b32 v189, 0xffff0000, v126
    v_lshlrev_b32 v190, 16, v127
    v_and_b32 v191, 0xffff0000, v127
    v_pk_fma_f32 v[6:7], v[184:185], v[152:153], v[6:7]
    v_pk_fma_f32 v[14:15], v[186:187], v[160:161], v[14:15]
    v_pk_fma_f32 v[22:23], v[188:189], v[168:169], v[22:23]
    v_pk_fma_f32 v[30:31], v[190:191], v[176:177], v[30:31]
    v_pk_fma_f32 v[8:9], v[184:185], v[154:155], v[8:9]
    v_pk_fma_f32 v[16:17], v[186:187], v[162:163], v[16:17]
    v_pk_fma_f32 v[24:25], v[188:189], v[170:171], v[24:25]
    v_pk_fma_f32 v[32:33], v[190:191], v[178:179], v[32:33]
    v_pk_fma_f32 v[10:11], v[184:185], v[156:157], v[10:11]
    v_pk_fma_f32 v[18:19], v[186:187], v[164:165], v[18:19]
    v_pk_fma_f32 v[26:27], v[188:189], v[172:173], v[26:27]
    v_pk_fma_f32 v[34:35], v[190:191], v[180:181], v[34:35]
    s_waitcnt vmcnt(7)
    v_lshlrev_b32 v184, 16, v128
    v_and_b32 v185, 0xffff0000, v128
    v_lshlrev_b32 v186, 16, v129
    v_and_b32 v187, 0xffff0000, v129
    v_lshlrev_b32 v188, 16, v130
    v_and_b32 v189, 0xffff0000, v130
    v_lshlrev_b32 v190, 16, v131
    v_and_b32 v191, 0xffff0000, v131
    v_pk_fma_f32 v[8:9], v[184:185], v[152:153], v[8:9]
    v_pk_fma_f32 v[16:17], v[186:187], v[160:161], v[16:17]
    v_pk_fma_f32 v[24:25], v[188:189], v[168:169], v[24:25]
    v_pk_fma_f32 v[32:33], v[190:191], v[176:177], v[32:33]
    v_pk_fma_f32 v[10:11], v[184:185], v[154:155], v[10:11]
    v_pk_fma_f32 v[18:19], v[186:187], v[162:163], v[18:19]
    v_pk_fma_f32 v[26:27], v[188:189], v[170:171], v[26:27]
    v_pk_fma_f32 v[34:35], v[190:191], v[178:179], v[34:35]
    s_waitcnt vmcnt(6)
    v_lshlrev_b32 v184, 16, v132
    v_and_b32 v185, 0xffff0000, v132
    v_lshlrev_b32 v186, 16, v133
    v_and_b32 v187, 0xffff0000, v133
    v_lshlrev_b32 v188, 16, v134
    v_and_b32 v189, 0xffff0000, v134
    v_lshlrev_b32 v190, 16, v135
    v_and_b32 v191, 0xffff0000, v135
    v_pk_fma_f32 v[10:11], v[184:185], v[152:153], v[10:11]
    v_pk_fma_f32 v[18:19], v[186:187], v[160:161], v[18:19]
    v_pk_fma_f32 v[26:27], v[188:189], v[168:169], v[26:27]
    v_pk_fma_f32 v[34:35], v[190:191], v[176:177], v[34:35]
    s_waitcnt vmcnt(5)
    v_lshlrev_b32 v184, 16, v136
    v_and_b32 v185, 0xffff0000, v136
    v_lshlrev_b32 v186, 16, v137
    v_and_b32 v187, 0xffff0000, v137
    v_lshlrev_b32 v188, 16, v138
    v_and_b32 v189, 0xffff0000, v138
    v_lshlrev_b32 v190, 16, v139
    v_and_b32 v191, 0xffff0000, v139
    v_pk_mul_f32 v[4:5], v[4:5], v[184:185]
    v_pk_mul_f32 v[12:13], v[12:13], v[186:187]
    v_pk_mul_f32 v[20:21], v[20:21], v[188:189]
    v_pk_mul_f32 v[28:29], v[28:29], v[190:191]
    s_waitcnt vmcnt(4)
    v_lshlrev_b32 v184, 16, v140
    v_and_b32 v185, 0xffff0000, v140
    v_lshlrev_b32 v186, 16, v141
    v_and_b32 v187, 0xffff0000, v141
    v_lshlrev_b32 v188, 16, v142
    v_and_b32 v189, 0xffff0000, v142
    v_lshlrev_b32 v190, 16, v143
    v_and_b32 v191, 0xffff0000, v143
    v_pk_mul_f32 v[6:7], v[6:7], v[184:185]
    v_pk_mul_f32 v[14:15], v[14:15], v[186:187]
    v_pk_mul_f32 v[22:23], v[22:23], v[188:189]
    v_pk_mul_f32 v[30:31], v[30:31], v[190:191]
    s_waitcnt vmcnt(3)
    v_lshlrev_b32 v184, 16, v144
    v_and_b32 v185, 0xffff0000, v144
    v_lshlrev_b32 v186, 16, v145
    v_and_b32 v187, 0xffff0000, v145
    v_lshlrev_b32 v188, 16, v146
    v_and_b32 v189, 0xffff0000, v146
    v_lshlrev_b32 v190, 16, v147
    v_and_b32 v191, 0xffff0000, v147
    v_pk_mul_f32 v[8:9], v[8:9], v[184:185]
    v_pk_mul_f32 v[16:17], v[16:17], v[186:187]
    v_pk_mul_f32 v[24:25], v[24:25], v[188:189]
    v_pk_mul_f32 v[32:33], v[32:33], v[190:191]
    s_waitcnt vmcnt(2)
    v_lshlrev_b32 v184, 16, v148
    v_and_b32 v185, 0xffff0000, v148
    v_lshlrev_b32 v186, 16, v149
    v_and_b32 v187, 0xffff0000, v149
    v_lshlrev_b32 v188, 16, v150
    v_and_b32 v189, 0xffff0000, v150
    v_lshlrev_b32 v190, 16, v151
    v_and_b32 v191, 0xffff0000, v151
    v_pk_mul_f32 v[10:11], v[10:11], v[184:185]
    v_pk_mul_f32 v[18:19], v[18:19], v[186:187]
    v_pk_mul_f32 v[26:27], v[26:27], v[188:189]
    v_pk_mul_f32 v[34:35], v[34:35], v[190:191]
    v_cvt_pk_bf16_f32 v108, v10, v8
    v_cvt_pk_bf16_f32 v109, v6, v4
    ds_write_b64 v231, v[108:109] offset:0
    v_cvt_pk_bf16_f32 v110, v11, v9
    v_cvt_pk_bf16_f32 v111, v7, v5
    ds_write_b64 v231, v[110:111] offset:64
    v_cvt_pk_bf16_f32 v112, v18, v16
    v_cvt_pk_bf16_f32 v113, v14, v12
    ds_write_b64 v231, v[112:113] offset:128
    v_cvt_pk_bf16_f32 v114, v19, v17
    v_cvt_pk_bf16_f32 v115, v15, v13
    ds_write_b64 v231, v[114:115] offset:192
    v_cvt_pk_bf16_f32 v116, v26, v24
    v_cvt_pk_bf16_f32 v117, v22, v20
    ds_write_b64 v231, v[116:117] offset:256
    v_cvt_pk_bf16_f32 v118, v27, v25
    v_cvt_pk_bf16_f32 v119, v23, v21
    ds_write_b64 v231, v[118:119] offset:320
    v_cvt_pk_bf16_f32 v120, v34, v32
    v_cvt_pk_bf16_f32 v121, v30, v28
    ds_write_b64 v231, v[120:121] offset:384
    v_cvt_pk_bf16_f32 v122, v35, v33
    v_cvt_pk_bf16_f32 v123, v31, v29
    ds_write_b64 v231, v[122:123] offset:448
    ds_read_b128 v[152:155], v232 offset:0
    ds_read_b128 v[156:159], v232 offset:1056
    ds_read_b128 v[160:163], v232 offset:2112
    ds_read_b128 v[164:167], v232 offset:3168
    v_mov_b64 v[4:5], 0
    v_mov_b64 v[6:7], 0
    v_mov_b64 v[8:9], 0
    v_mov_b64 v[10:11], 0
    v_mov_b64 v[12:13], 0
    v_mov_b64 v[14:15], 0
    v_mov_b64 v[16:17], 0
    v_mov_b64 v[18:19], 0
    v_mov_b64 v[20:21], 0
    v_mov_b64 v[22:23], 0
    v_mov_b64 v[24:25], 0
    v_mov_b64 v[26:27], 0
    v_mov_b64 v[28:29], 0
    v_mov_b64 v[30:31], 0
    v_mov_b64 v[32:33], 0
    v_mov_b64 v[34:35], 0
    s_waitcnt lgkmcnt(0)
    s_mov_b32 s87, 0
    buffer_store_dwordx4 v[152:155], v233, s[80:83], s87 offen sc1
    s_mov_b32 s87, 67584
    buffer_store_dwordx4 v[156:159], v233, s[80:83], s87 offen sc1
    s_mov_b32 s87, 135168
    buffer_store_dwordx4 v[160:163], v233, s[80:83], s87 offen sc1
    s_mov_b32 s87, 202752
    buffer_store_dwordx4 v[164:167], v233, s[80:83], s87 offen sc1
    s_and_b32 s37, s2, 7
    s_xor_b32 s37, s37, 2
    s_lshl_b32 s37, s37, 5
    s_lshr_b32 s38, s2, 3
    s_add_u32 s37, s37, s38
    s_add_u32 s37, s37, 256
    s_lshl_b32 s37, s37, 8
    s_cmp_eq_u32 s33, 0
    s_cselect_b32 s37, s37, s57
    s_cmp_eq_u32 s32, 0
    s_cbranch_scc0 L_noclear
    s_mov_b64 exec, 1
    buffer_store_dword v4, off, s[52:55], s37 sc1
    s_mov_b64 exec, -1
L_noclear:
    s_mov_b32 s37, 41984
    s_mov_b32 s36, 15
    s_barrier
    ds_read_b128 v[108:111], v196 offset:0
    ds_read_b64_tr_b16 v[128:129], v200 offset:0
    ds_read_b64_tr_b16 v[130:131], v200 offset:512
    ds_read_b128 v[112:115], v196 offset:2048
    ds_read_b64_tr_b16 v[132:133], v201 offset:0
    ds_read_b64_tr_b16 v[134:135], v201 offset:512
    ds_read_b128 v[116:119], v196 offset:4096
    ds_read_b64_tr_b16 v[136:137], v200 offset:8192
    ds_read_b64_tr_b16 v[138:139], v200 offset:8704
    ds_read_b128 v[120:123], v196 offset:6144
    ds_read_b64_tr_b16 v[140:141], v201 offset:8192
    ds_read_b64_tr_b16 v[142:143], v201 offset:8704
    ds_read_b128 v[124:127], v198
    ds_read_b64_tr_b16 v[144:145], v200 offset:16384
    ds_read_b64_tr_b16 v[146:147], v200 offset:16896
    ds_read_b64_tr_b16 v[148:149], v201 offset:16384
    ds_read_b64_tr_b16 v[150:151], v201 offset:16896
    s_waitcnt lgkmcnt(0)
L_g1_loop:
    v_mfma_f32_16x16x32_bf16 v[4:7], v[128:131], v[108:111], v[4:7]
    ds_read_b128 v[152:155], v197 offset:0
    v_mfma_f32_16x16x32_bf16 v[12:15], v[128:131], v[112:115], v[12:15]
    ds_read_b64_tr_b16 v[172:173], v200 offset:4096
    v_mfma_f32_16x16x32_bf16 v[20:23], v[128:131], v[116:119], v[20:23]
    ds_read_b64_tr_b16 v[174:175], v200 offset:4608
    v_mfma_f32_16x16x32_bf16 v[28:31], v[128:131], v[120:123], v[28:31]
    ds_read_b128 v[156:159], v197 offset:2048
    v_mfma_f32_16x16x32_bf16 v[32:35], v[132:135], v[120:123], v[32:35]
    ds_read_b64_tr_b16 v[176:177], v201 offset:4096
    v_mfma_f32_16x16x32_bf16 v[24:27], v[132:135], v[116:119], v[24:27]
    ds_read_b64_tr_b16 v[178:179], v201 offset:4608
    v_mfma_f32_16x16x32_bf16 v[16:19], v[132:135], v[112:115], v[16:19]
    ds_read_b128 v[160:163], v197 offset:4096
    v_mfma_f32_16x16x32_bf16 v[8:11], v[132:135], v[108:111], v[8:11]
    ds_read_b64_tr_b16 v[180:181], v200 offset:12288
    v_mfma_f32_16x16x32_bf16 v[40:43], v[140:143], v[108:111], v[40:43]
    ds_read_b64_tr_b16 v[182:183], v200 offset:12800
    v_mfma_f32_16x16x32_bf16 v[48:51], v[140:143], v[112:115], v[48:51]
    ds_read_b128 v[164:167], v197 offset:6144
    v_mfma_f32_16x16x32_bf16 v[56:59], v[140:143], v[116:119], v[56:59]
    ds_read_b64_tr_b16 v[184:185], v201 offset:12288
    v_mfma_f32_16x16x32_bf16 v[64:67], v[140:143], v[120:123], v[64:67]
    ds_read_b64_tr_b16 v[186:187], v201 offset:12800
    v_mfma_f32_16x16x32_bf16 v[60:63], v[136:139], v[120:123], v[60:63]
    ds_read_b128 v[168:171], v199
    v_mfma_f32_16x16x32_bf16 v[52:55], v[136:139], v[116:119], v[52:55]
    ds_read_b64_tr_b16 v[188:189], v200 offset:20480
    v_mfma_f32_16x16x32_bf16 v[44:47], v[136:139], v[112:115], v[44:47]
    ds_read_b64_tr_b16 v[190:191], v200 offset:20992
    v_mfma_f32_16x16x32_bf16 v[36:39], v[136:139], v[108:111], v[36:39]
    ds_read_b64_tr_b16 v[192:193], v201 offset:20480
    v_mfma_f32_16x16x32_bf16 v[100:103], v[136:139], v[124:127], v[100:103]
    ds_read_b64_tr_b16 v[194:195], v201 offset:20992
    v_mfma_f32_16x16x32_bf16 v[104:107], v[124:127], v[144:147], v[104:107]
    ds_read_b32 v1, v228 offset:24
    v_mfma_f32_16x16x32_bf16 v[68:71], v[108:111], v[144:147], v[68:71]
    s_add_u32 s34, s34, 41984
    s_cmp_eq_u32 s34, 125952
    v_mfma_f32_16x16x32_bf16 v[76:79], v[112:115], v[144:147], v[76:79]
    s_cselect_b32 s35, -83968, s37
    s_cselect_b32 s34, 0, s34
    v_mfma_f32_16x16x32_bf16 v[84:87], v[116:119], v[144:147], v[84:87]
    s_bitcmp1_b32 0x1002, s36
    v_add_u32 v196, s35, v196
    v_mfma_f32_16x16x32_bf16 v[92:95], v[120:123], v[144:147], v[92:95]
    v_add_u32 v197, s35, v197
    v_add_u32 v198, s35, v198
    v_mfma_f32_16x16x32_bf16 v[96:99], v[120:123], v[148:151], v[96:99]
    v_add_u32 v199, s35, v199
    v_add_u32 v200, s35, v200
    v_mfma_f32_16x16x32_bf16 v[88:91], v[116:119], v[148:151], v[88:91]
    v_add_u32 v201, s35, v201
    v_mfma_f32_16x16x32_bf16 v[80:83], v[112:115], v[148:151], v[80:83]
    s_waitcnt lgkmcnt(0)
    v_mfma_f32_16x16x32_bf16 v[72:75], v[108:111], v[148:151], v[72:75]
    s_cbranch_scc1 L_g1_rare
L_g1_bar:
    s_barrier
L_g1_nobar:
    v_mfma_f32_16x16x32_bf16 v[4:7], v[172:175], v[152:155], v[4:7]
    ds_read_b128 v[108:111], v196 offset:0
    v_mfma_f32_16x16x32_bf16 v[12:15], v[172:175], v[156:159], v[12:15]
    ds_read_b64_tr_b16 v[128:129], v200 offset:0
    v_mfma_f32_16x16x32_bf16 v[20:23], v[172:175], v[160:163], v[20:23]
    ds_read_b64_tr_b16 v[130:131], v200 offset:512
    v_mfma_f32_16x16x32_bf16 v[28:31], v[172:175], v[164:167], v[28:31]
    ds_read_b128 v[112:115], v196 offset:2048
    v_mfma_f32_16x16x32_bf16 v[32:35], v[176:179], v[164:167], v[32:35]
    ds_read_b64_tr_b16 v[132:133], v201 offset:0
    v_mfma_f32_16x16x32_bf16 v[24:27], v[176:179], v[160:163], v[24:27]
    ds_read_b64_tr_b16 v[134:135], v201 offset:512
    v_mfma_f32_16x16x32_bf16 v[16:19], v[176:179], v[156:159], v[16:19]
    ds_read_b128 v[116:119], v196 offset:4096
    v_mfma_f32_16x16x32_bf16 v[8:11], v[176:179], v[152:155], v[8:11]
    ds_read_b64_tr_b16 v[136:137], v200 offset:8192
    v_mfma_f32_16x16x32_bf16 v[40:43], v[184:187], v[152:155], v[40:43]
    ds_read_b64_tr_b16 v[138:139], v200 offset:8704
    v_mfma_f32_16x16x32_bf16 v[48:51], v[184:187], v[156:159], v[48:51]
    ds_read_b128 v[120:123], v196 offset:6144
    v_mfma_f32_16x16x32_bf16 v[56:59], v[184:187], v[160:163], v[56:59]
    ds_read_b64_tr_b16 v[140:141], v201 offset:8192
    v_mfma_f32_16x16x32_bf16 v[64:67], v[184:187], v[164:167], v[64:67]
    ds_read_b64_tr_b16 v[142:143], v201 offset:8704
    v_mfma_f32_16x16x32_bf16 v[60:63], v[180:183], v[164:167], v[60:63]
    ds_read_b128 v[124:127], v198
    v_mfma_f32_16x16x32_bf16 v[52:55], v[180:183], v[160:163], v[52:55]
    ds_read_b64_tr_b16 v[144:145], v200 offset:16384
    v_mfma_f32_16x16x32_bf16 v[44:47], v[180:183], v[156:159], v[44:47]
    ds_read_b64_tr_b16 v[146:147], v200 offset:16896
    v_mfma_f32_16x16x32_bf16 v[36:39], v[180:183], v[152:155], v[36:39]
    ds_read_b64_tr_b16 v[148:149], v201 offset:16384
    v_mfma_f32_16x16x32_bf16 v[100:103], v[180:183], v[168:171], v[100:103]
    ds_read_b64_tr_b16 v[150:151], v201 offset:16896
    v_mfma_f32_16x16x32_bf16 v[104:107], v[168:171], v[188:191], v[104:107]
    s_sub_u32 s36, s36, 1
    v_mfma_f32_16x16x32_bf16 v[68:71], v[152:155], v[188:191], v[68:71]
    s_cmp_lg_u32 s36, 0
    v_mfma_f32_16x16x32_bf16 v[76:79], v[156:159], v[188:191], v[76:79]
    v_mfma_f32_16x16x32_bf16 v[84:87], v[160:163], v[188:191], v[84:87]
    v_mfma_f32_16x16x32_bf16 v[92:95], v[164:167], v[188:191], v[92:95]
    v_mfma_f32_16x16x32_bf16 v[96:99], v[164:167], v[192:195], v[96:99]
    v_mfma_f32_16x16x32_bf16 v[88:91], v[160:163], v[192:195], v[88:91]
    v_mfma_f32_16x16x32_bf16 v[80:83], v[156:159], v[192:195], v[80:83]
    s_waitcnt lgkmcnt(0)
    v_mfma_f32_16x16x32_bf16 v[72:75], v[152:155], v[192:195], v[72:75]
    s_cbranch_scc1 L_g1_loop
    v_mfma_f32_16x16x32_bf16 v[4:7], v[128:131], v[108:111], v[4:7]
    ds_read_b128 v[152:155], v197 offset:0
    v_mfma_f32_16x16x32_bf16 v[12:15], v[128:131], v[112:115], v[12:15]
    ds_read_b64_tr_b16 v[172:173], v200 offset:4096
    v_mfma_f32_16x16x32_bf16 v[20:23], v[128:131], v[116:119], v[20:23]
    ds_read_b64_tr_b16 v[174:175], v200 offset:4608
    v_mfma_f32_16x16x32_bf16 v[28:31], v[128:131], v[120:123], v[28:31]
    ds_read_b128 v[156:159], v197 offset:2048
    v_mfma_f32_16x16x32_bf16 v[32:35], v[132:135], v[120:123], v[32:35]
    ds_read_b64_tr_b16 v[176:177], v201 offset:4096
    v_mfma_f32_16x16x32_bf16 v[24:27], v[132:135], v[116:119], v[24:27]
    ds_read_b64_tr_b16 v[178:179], v201 offset:4608
    v_mfma_f32_16x16x32_bf16 v[16:19], v[132:135], v[112:115], v[16:19]
    ds_read_b128 v[160:163], v197 offset:4096
    v_mfma_f32_16x16x32_bf16 v[8:11], v[132:135], v[108:111], v[8:11]
    ds_read_b64_tr_b16 v[180:181], v200 offset:12288
    v_mfma_f32_16x16x32_bf16 v[40:43], v[140:143], v[108:111], v[40:43]
    ds_read_b64_tr_b16 v[182:183], v200 offset:12800
    v_mfma_f32_16x16x32_bf16 v[48:51], v[140:143], v[112:115], v[48:51]
    ds_read_b128 v[164:167], v197 offset:6144
    v_mfma_f32_16x16x32_bf16 v[56:59], v[140:143], v[116:119], v[56:59]
    ds_read_b64_tr_b16 v[184:185], v201 offset:12288
    v_mfma_f32_16x16x32_bf16 v[64:67], v[140:143], v[120:123], v[64:67]
    ds_read_b64_tr_b16 v[186:187], v201 offset:12800
    v_mfma_f32_16x16x32_bf16 v[60:63], v[136:139], v[120:123], v[60:63]
    ds_read_b128 v[168:171], v199
    v_mfma_f32_16x16x32_bf16 v[52:55], v[136:139], v[116:119], v[52:55]
    ds_read_b64_tr_b16 v[188:189], v200 offset:20480
    v_mfma_f32_16x16x32_bf16 v[44:47], v[136:139], v[112:115], v[44:47]
    ds_read_b64_tr_b16 v[190:191], v200 offset:20992
    v_mfma_f32_16x16x32_bf16 v[36:39], v[136:139], v[108:111], v[36:39]
    ds_read_b64_tr_b16 v[192:193], v201 offset:20480
    v_mfma_f32_16x16x32_bf16 v[100:103], v[136:139], v[124:127], v[100:103]
    ds_read_b64_tr_b16 v[194:195], v201 offset:20992
    v_mfma_f32_16x16x32_bf16 v[104:107], v[124:127], v[144:147], v[104:107]
    v_mfma_f32_16x16x32_bf16 v[68:71], v[108:111], v[144:147], v[68:71]
    v_mfma_f32_16x16x32_bf16 v[76:79], v[112:115], v[144:147], v[76:79]
    v_mfma_f32_16x16x32_bf16 v[84:87], v[116:119], v[144:147], v[84:87]
    v_mfma_f32_16x16x32_bf16 v[92:95], v[120:123], v[144:147], v[92:95]
    v_mfma_f32_16x16x32_bf16 v[96:99], v[120:123], v[148:151], v[96:99]
    v_mfma_f32_16x16x32_bf16 v[88:91], v[116:119], v[148:151], v[88:91]
    v_mfma_f32_16x16x32_bf16 v[80:83], v[112:115], v[148:151], v[80:83]
    v_mfma_f32_16x16x32_bf16 v[72:75], v[108:111], v[148:151], v[72:75]
    s_waitcnt lgkmcnt(0)
    s_setprio 2
    v_mov_b32 v2, 1
    v_mfma_f32_16x16x32_bf16 v[100:103], v[180:183], v[168:171], v[100:103]
    v_mfma_f32_16x16x32_bf16 v[104:107], v[168:171], v[188:191], v[104:107]
    v_mfma_f32_16x16x32_bf16 v[60:63], v[180:183], v[164:167], v[60:63]
    v_mfma_f32_16x16x32_bf16 v[64:67], v[184:187], v[164:167], v[64:67]
    v_mfma_f32_16x16x32_bf16 v[92:95], v[164:167], v[188:191], v[92:95]
    v_mfma_f32_16x16x32_bf16 v[96:99], v[164:167], v[192:195], v[96:99]
    v_mfma_f32_16x16x32_bf16 v[28:31], v[172:175], v[164:167], v[28:31]
    v_mfma_f32_16x16x32_bf16 v[32:35], v[176:179], v[164:167], v[32:35]
    v_mfma_f32_16x16x32_bf16 v[52:55], v[180:183], v[160:163], v[52:55]
    v_cvt_pk_bf16_f32 v144, v100, v101
    v_cvt_pk_bf16_f32 v145, v102, v103
    v_mfma_f32_16x16x32_bf16 v[56:59], v[184:187], v[160:163], v[56:59]
    ds_write_b64 v219, v[144:145]
    v_cvt_pk_bf16_f32 v146, v104, v105
    v_mfma_f32_16x16x32_bf16 v[20:23], v[172:175], v[160:163], v[20:23]
    v_cvt_pk_bf16_f32 v147, v106, v107
    ds_write_b64 v219, v[146:147] offset:1024
    v_mfma_f32_16x16x32_bf16 v[24:27], v[176:179], v[160:163], v[24:27]
    v_cvt_pk_bf16_f32 v140, v60, v61
    v_cvt_pk_bf16_f32 v141, v62, v63
    v_mfma_f32_16x16x32_bf16 v[44:47], v[180:183], v[156:159], v[44:47]
    v_cvt_pk_bf16_f32 v142, v64, v65
    v_cvt_pk_bf16_f32 v143, v66, v67
    v_mfma_f32_16x16x32_bf16 v[48:51], v[184:187], v[156:159], v[48:51]
    v_cvt_pk_bf16_f32 v238, v92, v93
    v_cvt_pk_bf16_f32 v239, v94, v95
    v_mfma_f32_16x16x32_bf16 v[12:15], v[172:175], v[156:159], v[12:15]
    v_cvt_pk_bf16_f32 v248, v96, v97
    v_cvt_pk_bf16_f32 v249, v98, v99
    v_mfma_f32_16x16x32_bf16 v[16:19], v[176:179], v[156:159], v[16:19]
    s_cmp_eq_u32 s33, 0
    s_cbranch_scc0 L_at_nopub
    ds_write_b64 v220, v[140:141] offset:2048
    ds_write_b64 v220, v[238:239] offset:3072
    ds_write_b64 v220, v[142:143] offset:2560
    ds_write_b64 v220, v[248:249] offset:3584
L_at_nopub:
    s_mov_b64 exec, 1
    ds_add_u32 v228, v2 offset:20
    s_mov_b64 exec, -1
    v_cvt_pk_bf16_f32 v120, v28, v29
    v_mfma_f32_16x16x32_bf16 v[36:39], v[180:183], v[152:155], v[36:39]
    v_cvt_pk_bf16_f32 v121, v30, v31
    v_cvt_pk_bf16_f32 v122, v32, v33
    v_mfma_f32_16x16x32_bf16 v[40:43], v[184:187], v[152:155], v[40:43]
    v_cvt_pk_bf16_f32 v123, v34, v35
    v_cvt_pk_bf16_f32 v136, v52, v53
    v_mfma_f32_16x16x32_bf16 v[4:7], v[172:175], v[152:155], v[4:7]
    v_cvt_pk_bf16_f32 v137, v54, v55
    v_cvt_pk_bf16_f32 v138, v56, v57
    v_mfma_f32_16x16x32_bf16 v[8:11], v[176:179], v[152:155], v[8:11]
    v_cvt_pk_bf16_f32 v139, v58, v59
    v_cvt_pk_bf16_f32 v116, v20, v21
    v_mfma_f32_16x16x32_bf16 v[84:87], v[160:163], v[188:191], v[84:87]
    v_cvt_pk_bf16_f32 v117, v22, v23
    v_cvt_pk_bf16_f32 v118, v24, v25
    v_mfma_f32_16x16x32_bf16 v[88:91], v[160:163], v[192:195], v[88:91]
    v_cvt_pk_bf16_f32 v119, v26, v27
    v_cvt_pk_bf16_f32 v132, v44, v45
    v_mfma_f32_16x16x32_bf16 v[76:79], v[156:159], v[188:191], v[76:79]
    v_cvt_pk_bf16_f32 v133, v46, v47
    v_cvt_pk_bf16_f32 v134, v48, v49
    v_mfma_f32_16x16x32_bf16 v[80:83], v[156:159], v[192:195], v[80:83]
    v_cvt_pk_bf16_f32 v135, v50, v51
    v_cvt_pk_bf16_f32 v112, v12, v13
    v_mfma_f32_16x16x32_bf16 v[68:71], v[152:155], v[188:191], v[68:71]
    v_cvt_pk_bf16_f32 v113, v14, v15
    v_cvt_pk_bf16_f32 v114, v16, v17
    v_mfma_f32_16x16x32_bf16 v[72:75], v[152:155], v[192:195], v[72:75]
    v_cvt_pk_bf16_f32 v115, v18, v19
    v_cvt_pk_bf16_f32 v128, v36, v37
    v_mfma_f32_16x16x32_bf16 v[28:31], v[140:143], v[120:123], v[204:207]
    v_cvt_pk_bf16_f32 v129, v38, v39
    v_cvt_pk_bf16_f32 v130, v40, v41
    v_mfma_f32_16x16x32_bf16 v[32:35], v[136:139], v[120:123], v[208:211]
    v_cvt_pk_bf16_f32 v131, v42, v43
    v_cvt_pk_bf16_f32 v108, v4, v5
    v_mfma_f32_16x16x32_bf16 v[20:23], v[136:139], v[116:119], v[204:207]
    v_cvt_pk_bf16_f32 v109, v6, v7
    v_cvt_pk_bf16_f32 v110, v8, v9
    v_mfma_f32_16x16x32_bf16 v[24:27], v[132:135], v[116:119], v[208:211]
    v_cvt_pk_bf16_f32 v111, v10, v11
    v_cvt_pk_bf16_f32 v236, v84, v85
    v_mfma_f32_16x16x32_bf16 v[12:15], v[132:135], v[112:115], v[204:207]
    v_cvt_pk_bf16_f32 v237, v86, v87
    v_cvt_pk_bf16_f32 v246, v88, v89
    v_mfma_f32_16x16x32_bf16 v[16:19], v[128:131], v[112:115], v[208:211]
    v_cvt_pk_bf16_f32 v247, v90, v91
    v_cvt_pk_bf16_f32 v234, v76, v77
    v_mfma_f32_16x16x32_bf16 v[4:7], v[128:131], v[108:111], v[204:207]
    v_cvt_pk_bf16_f32 v235, v78, v79
    ds_read_b32 v1, v228 offset:20
    v_cvt_pk_bf16_f32 v244, v80, v81
    v_cvt_pk_bf16_f32 v245, v82, v83
    v_cvt_pk_bf16_f32 v232, v68, v69
    v_cvt_pk_bf16_f32 v233, v70, v71
    v_cvt_pk_bf16_f32 v242, v72, v73
    v_cvt_pk_bf16_f32 v243, v74, v75
    s_waitcnt lgkmcnt(0)
    v_readfirstlane_b32 s37, v1
    s_nop 0
    s_cmp_ge_u32 s37, 4
    s_cbranch_scc1 L_sl_done_42
    s_mov_b32 s38, 1048576
L_sl_loop_43:
    ds_read_b32 v1, v228 offset:20
    s_waitcnt lgkmcnt(0)
    v_readfirstlane_b32 s37, v1
    s_nop 0
    s_cmp_ge_u32 s37, 4
    s_cbranch_scc1 L_sl_done_42
    s_sleep 1
    s_sub_u32 s38, s38, 1
    s_cbranch_scc0 L_sl_loop_43
L_sl_done_42:
    ds_read_b64 v[124:125], v221
    ds_read_b64 v[126:127], v222
    ds_read_b64 v[230:231], v221 offset:1024
    ds_read_b64 v[240:241], v222 offset:1024
    v_max_f32 v28, v28, v32
    v_max_f32 v29, v29, v33
    v_max_f32 v30, v30, v34
    v_max_f32 v31, v31, v35
    v_max3_f32 v39, v28, v29, v30
    v_max_f32 v39, v39, v31
    v_max_f32 v20, v20, v24
    v_max_f32 v21, v21, v25
    v_max_f32 v22, v22, v26
    v_max_f32 v23, v23, v27
    v_max3_f32 v38, v20, v21, v22
    v_max_f32 v38, v38, v23
    s_waitcnt lgkmcnt(2)
    v_mfma_f32_16x16x32_bf16 v[8:11], v[124:127], v[108:111], v[212:215]
    s_setprio 2
    s_add_u32 m0, s60, 0
    s_mov_b32 s37, 0x3e8293ee
    v_max_f32 v12, v12, v16
    v_max_f32 v13, v13, v17
    s_xor_b32 s63, s62, 0
    v_max_f32 v14, v14, v18
    v_max_f32 v15, v15, v19
    v_max3_f32 v37, v12, v13, v14
    buffer_load_dwordx4 v227, s[44:47], s63 offen offset:0 lds
    v_max_f32 v37, v37, v15
    v_max_f32 v4, v4, v8
    v_max_f32 v5, v5, v9
    buffer_load_dwordx4 v223, s[44:47], s63 offen offset:1024 lds
    v_max_f32 v6, v6, v10
    v_max_f32 v7, v7, v11
    v_max3_f32 v36, v4, v5, v6
    s_add_u32 m0, s60, 8192
    v_max_f32 v36, v36, v7
    v_permlane32_swap_b32 v38, v39
    s_nop 0
    v_permlane32_swap_b32 v36, v37
    s_xor_b32 s63, s62, 131072
    v_max_f32 v38, v38, v39
    v_max_f32 v36, v36, v37
    s_nop 1
    v_permlane16_swap_b32 v36, v38
    buffer_load_dwordx4 v227, s[44:47], s63 offen offset:0 lds
    v_max_f32 v36, v36, v38
    v_mul_f32 v38, s37, v36
    v_mul_f32 v36, s37, v36
    buffer_load_dwordx4 v223, s[44:47], s63 offen offset:1024 lds
    s_nop 0
    v_permlane16_swap_b32 v36, v38
    v_mov_b32 v37, v36
    v_mov_b32 v39, v38
    s_add_u32 m0, s60, 16384
    v_permlane32_swap_b32 v36, v37
    v_permlane32_swap_b32 v38, v39
    v_fma_f32 v4, v4, s37, -v36
    s_xor_b32 s63, s62, 262144
    v_fma_f32 v5, v5, s37, -v36
    v_fma_f32 v6, v6, s37, -v36
    v_fma_f32 v7, v7, s37, -v36
    buffer_load_dwordx4 v227, s[44:47], s63 offen offset:0 lds
    v_fma_f32 v12, v12, s37, -v37
    v_fma_f32 v13, v13, s37, -v37
    v_fma_f32 v14, v14, s37, -v37
    buffer_load_dwordx4 v223, s[44:47], s63 offen offset:1024 lds
    v_fma_f32 v15, v15, s37, -v37
    v_fma_f32 v20, v20, s37, -v38
    v_fma_f32 v21, v21, s37, -v38
    s_add_u32 m0, s60, 24576
    v_fma_f32 v22, v22, s37, -v38
    v_fma_f32 v23, v23, s37, -v38
    v_fma_f32 v28, v28, s37, -v39
    s_xor_b32 s63, s62, 393216
    v_fma_f32 v29, v29, s37, -v39
    v_fma_f32 v30, v30, s37, -v39
    v_fma_f32 v31, v31, s37, -v39
    buffer_load_dwordx4 v227, s[44:47], s63 offen offset:0 lds
    v_exp_f32 v28, v28
    v_exp_f32 v29, v29
    v_exp_f32 v30, v30
    buffer_load_dwordx4 v223, s[44:47], s63 offen offset:1024 lds
    v_exp_f32 v31, v31
    v_exp_f32 v20, v20
    v_exp_f32 v21, v21
    s_add_u32 m0, s60, 32768
    v_exp_f32 v22, v22
    v_exp_f32 v23, v23
    v_exp_f32 v12, v12
    s_xor_b32 s63, s62, 524288
    v_exp_f32 v13, v13
    v_exp_f32 v14, v14
    v_exp_f32 v15, v15
    buffer_load_dwordx4 v227, s[44:47], s63 offen offset:0 lds
    v_exp_f32 v4, v4
    v_exp_f32 v5, v5
    v_exp_f32 v6, v6
    buffer_load_dwordx4 v223, s[44:47], s63 offen offset:1024 lds
    v_exp_f32 v7, v7
    v_add_f32 v39, v28, v29
    v_add_f32 v32, v30, v31
    s_add_u32 m0, s60, 83968
    v_add_f32 v39, v39, v32
    v_add_f32 v38, v20, v21
    v_add_f32 v24, v22, v23
    s_xor_b32 s63, s62, 655360
    v_add_f32 v38, v38, v24
    v_add_f32 v37, v12, v13
    v_add_f32 v16, v14, v15
    buffer_load_dwordx4 v227, s[44:47], s63 offen offset:0 lds
    v_add_f32 v37, v37, v16
    v_add_f32 v36, v4, v5
    v_add_f32 v8, v6, v7
    buffer_load_dwordx4 v223, s[44:47], s63 offen offset:1024 lds
    v_add_f32 v36, v36, v8
    v_permlane32_swap_b32 v38, v39
    s_nop 0
    v_permlane32_swap_b32 v36, v37
    s_add_u32 m0, s60, 92160
    v_add_f32 v38, v38, v39
    v_add_f32 v36, v36, v37
    s_nop 1
    v_permlane16_swap_b32 v36, v38
    s_xor_b32 s63, s62, 786432
    v_add_f32 v36, v36, v38
    v_rcp_f32 v38, v36
    v_rcp_f32 v36, v36
    buffer_load_dwordx4 v227, s[44:47], s63 offen offset:0 lds
    s_nop 0
    v_permlane16_swap_b32 v36, v38
    v_mov_b32 v37, v36
    v_mov_b32 v39, v38
    buffer_load_dwordx4 v223, s[44:47], s63 offen offset:1024 lds
    v_permlane32_swap_b32 v36, v37
    v_permlane32_swap_b32 v38, v39
    s_waitcnt lgkmcnt(0)
    s_cmp_eq_u32 s33, 0
    v_mul_f32 v4, v4, v36
    v_mul_f32 v5, v5, v36
    v_mul_f32 v6, v6, v36
    v_mul_f32 v7, v7, v36
    v_cvt_pk_bf16_f32 v10, v4, v5
    v_cvt_pk_bf16_f32 v11, v6, v7
    v_and_b32 v8, v216, v10
    v_and_b32 v9, v217, v11
    v_xor_b32 v10, v8, v10
    v_xor_b32 v11, v9, v11
    s_setprio 2
    s_nop 0
    v_mfma_f32_16x16x32_bf16 v[68:71], v[230:233], v[8:11], 0
    v_mfma_f32_16x16x32_bf16 v[72:75], v[240:243], v[8:11], 0
    s_setprio 2
    v_mul_f32 v12, v12, v37
    v_mul_f32 v13, v13, v37
    v_mul_f32 v14, v14, v37
    v_mul_f32 v15, v15, v37
    v_cvt_pk_bf16_f32 v18, v12, v13
    v_cvt_pk_bf16_f32 v19, v14, v15
    v_and_b32 v16, v216, v18
    v_and_b32 v17, v217, v19
    v_xor_b32 v18, v16, v18
    v_xor_b32 v19, v17, v19
    v_cvt_pk_bf16_f32 v108, v68, v69
    v_cvt_pk_bf16_f32 v109, v70, v71
    v_cvt_pk_bf16_f32 v110, v72, v73
    v_cvt_pk_bf16_f32 v111, v74, v75
    s_cbranch_scc1 L_at_noswap0
    v_swap_b32 v108, v110
    v_swap_b32 v109, v111
L_at_noswap0:
    s_mov_b32 s37, 0
    buffer_store_dwordx4 v[108:111], v218, s[40:43], s37 offen sc1
    s_setprio 2
    v_mfma_f32_16x16x32_bf16 v[76:79], v[232:235], v[16:19], 0
    v_mfma_f32_16x16x32_bf16 v[80:83], v[242:245], v[16:19], 0
    s_setprio 2
    v_mul_f32 v20, v20, v38
    v_mul_f32 v21, v21, v38
    v_mul_f32 v22, v22, v38
    v_mul_f32 v23, v23, v38
    v_cvt_pk_bf16_f32 v26, v20, v21
    v_cvt_pk_bf16_f32 v27, v22, v23
    v_and_b32 v24, v216, v26
    v_and_b32 v25, v217, v27
    v_xor_b32 v26, v24, v26
    v_xor_b32 v27, v25, v27
    v_cvt_pk_bf16_f32 v112, v76, v77
    v_cvt_pk_bf16_f32 v113, v78, v79
    v_cvt_pk_bf16_f32 v114, v80, v81
    v_cvt_pk_bf16_f32 v115, v82, v83
    s_cbranch_scc1 L_at_noswap1
    v_swap_b32 v112, v114
    v_swap_b32 v113, v115
L_at_noswap1:
    s_mov_b32 s37, 32768
    buffer_store_dwordx4 v[112:115], v218, s[40:43], s37 offen sc1
    s_setprio 2
    v_mfma_f32_16x16x32_bf16 v[84:87], v[234:237], v[24:27], 0
    v_mfma_f32_16x16x32_bf16 v[88:91], v[244:247], v[24:27], 0
    s_setprio 2
    v_mul_f32 v28, v28, v39
    v_mul_f32 v29, v29, v39
    v_mul_f32 v30, v30, v39
    v_mul_f32 v31, v31, v39
    v_cvt_pk_bf16_f32 v34, v28, v29
    v_cvt_pk_bf16_f32 v35, v30, v31
    v_and_b32 v32, v216, v34
    v_and_b32 v33, v217, v35
    v_xor_b32 v34, v32, v34
    v_xor_b32 v35, v33, v35
    v_cvt_pk_bf16_f32 v116, v84, v85
    v_cvt_pk_bf16_f32 v117, v86, v87
    v_cvt_pk_bf16_f32 v118, v88, v89
    v_cvt_pk_bf16_f32 v119, v90, v91
    s_cbranch_scc1 L_at_noswap2
    v_swap_b32 v116, v118
    v_swap_b32 v117, v119
L_at_noswap2:
    s_mov_b32 s37, 65536
    buffer_store_dwordx4 v[116:119], v218, s[40:43], s37 offen sc1
    s_setprio 2
    v_mfma_f32_16x16x32_bf16 v[92:95], v[236:239], v[32:35], 0
    v_mfma_f32_16x16x32_bf16 v[96:99], v[246:249], v[32:35], 0
    s_setprio 2
    s_nop 5
    v_cvt_pk_bf16_f32 v120, v92, v93
    v_cvt_pk_bf16_f32 v121, v94, v95
    v_cvt_pk_bf16_f32 v122, v96, v97
    v_cvt_pk_bf16_f32 v123, v98, v99
    s_cbranch_scc1 L_at_noswap3
    v_swap_b32 v120, v122
    v_swap_b32 v121, v123
L_at_noswap3:
    s_mov_b32 s37, 98304
    buffer_store_dwordx4 v[120:123], v218, s[40:43], s37 offen sc1
    s_setprio 0
    v_xor_b32 v84, 0, v229
    v_xor_b32 v85, 32, v229
    v_xor_b32 v86, 64, v229
    v_xor_b32 v87, 96, v229
    v_add_u32 v88, 83968, v84
    v_add_u32 v89, 83968, v85
    v_add_u32 v90, 83968, v86
    v_add_u32 v91, 83968, v87
    v_add_u32 v92, 125952, v84
    v_add_u32 v93, 125952, v85
    v_add_u32 v94, 125952, v86
    v_add_u32 v95, 125952, v87
    v_lshl_add_u32 v231, v0, 4, s60
    v_add_u32 v230, 125952, v231
    s_add_u32 s64, s61, 0
    s_and_b32 s64, s64, 7
    s_lshl_b32 s64, s64, 12
    s_add_u32 s65, s61, 1
    s_and_b32 s65, s65, 7
    s_lshl_b32 s65, s65, 12
    s_add_u32 s66, s61, 2
    s_and_b32 s66, s66, 7
    s_lshl_b32 s66, s66, 12
    s_add_u32 s67, s61, 3
    s_and_b32 s67, s67, 7
    s_lshl_b32 s67, s67, 12
    s_add_u32 s68, s61, 4
    s_and_b32 s68, s68, 7
    s_lshl_b32 s68, s68, 12
    s_add_u32 s69, s61, 5
    s_and_b32 s69, s69, 7
    s_lshl_b32 s69, s69, 12
    s_add_u32 s70, s61, 6
    s_and_b32 s70, s70, 7
    s_lshl_b32 s70, s70, 12
    s_add_u32 s71, s61, 7
    s_and_b32 s71, s71, 7
    s_lshl_b32 s71, s71, 12
    s_waitcnt vmcnt(0)
    s_setprio 2
    v_mov_b32 v2, 1
    s_mov_b64 exec, 1
    ds_add_rtn_u32 v1, v228, v2 offset:0
    s_waitcnt lgkmcnt(0)
    v_readfirstlane_b32 s39, v1
    s_nop 0
    s_cmp_eq_u32 s39, 3
    s_cbranch_scc0 L_jo_44a
    s_mov_b64 exec, 0xffff
    v_lshlrev_b32 v1, 8, v0
    buffer_atomic_add v2, v1, s[52:55], s56 offen sc1
L_jo_44a:
    s_mov_b64 exec, -1
    s_setprio 0
    s_add_u32 m0, s60, 100352
    s_xor_b32 s63, s62, 917504
    buffer_load_dwordx4 v227, s[44:47], s63 offen offset:0 lds
    buffer_load_dwordx4 v223, s[44:47], s63 offen offset:1024 lds
    s_add_u32 m0, s60, 108544
    s_xor_b32 s63, s62, 1048576
    buffer_load_dwordx4 v227, s[44:47], s63 offen offset:0 lds
    buffer_load_dwordx4 v223, s[44:47], s63 offen offset:1024 lds
    s_add_u32 m0, s60, 116736
    s_xor_b32 s63, s62, 1179648
    buffer_load_dwordx4 v227, s[44:47], s63 offen offset:0 lds
    buffer_load_dwordx4 v223, s[44:47], s63 offen offset:1024 lds
    s_xor_b32 s63, s62, 1310720
    buffer_load_dwordx4 v[172:175], v227, s[44:47], s63 offen offset:0
    buffer_load_dwordx4 v[176:179], v223, s[44:47], s63 offen offset:1024
    s_xor_b32 s63, s62, 1441792
    buffer_load_dwordx4 v[180:183], v227, s[44:47], s63 offen offset:0
    buffer_load_dwordx4 v[184:187], v223, s[44:47], s63 offen offset:1024
    s_cmp_eq_u32 s39, 3
    s_cbranch_scc0 L_ps_46
    s_load_dword s37, s[52:53], s57 glc
L_ps_46:
    s_xor_b32 s63, s62, 1572864
    buffer_load_dwordx4 v[188:191], v227, s[44:47], s63 offen offset:0
    buffer_load_dwordx4 v[192:195], v223, s[44:47], s63 offen offset:1024
    s_xor_b32 s63, s62, 1703936
    buffer_load_dwordx4 v[196:199], v227, s[44:47], s63 offen offset:0
    buffer_load_dwordx4 v[200:203], v223, s[44:47], s63 offen offset:1024
    s_xor_b32 s63, s62, 1835008
    buffer_load_dwordx4 v[204:207], v227, s[44:47], s63 offen offset:0
    buffer_load_dwordx4 v[208:211], v223, s[44:47], s63 offen offset:1024
    s_xor_b32 s63, s62, 1966080
    buffer_load_dwordx4 v[212:215], v227, s[44:47], s63 offen offset:0
    buffer_load_dwordx4 v[216:219], v223, s[44:47], s63 offen offset:1024
    s_setprio 0
    s_cmp_eq_u32 s39, 3
    s_cbranch_scc0 L_jo_44
    s_mov_b32 s38, 131072
    s_branch L_sg_chk_49
L_sg_loop_48:
    s_load_dword s37, s[52:53], s57 glc
L_sg_chk_49:
    s_waitcnt lgkmcnt(0)
    s_cmp_ge_u32 s37, 16
    s_cbranch_scc1 L_sg_done_47
    s_sub_u32 s38, s38, 1
    s_cbranch_scc0 L_sg_loop_48
L_sg_done_47:
    v_mov_b32 v1, 16
    s_mov_b64 exec, 1
    ds_add_u32 v228, v1 offset:4
    s_mov_b64 exec, -1
L_jo_44:
    s_waitcnt vmcnt(12)
    s_mov_b64 exec, 1
    ds_add_u32 v228, v2 offset:4
    s_mov_b64 exec, -1
    s_mov_b32 s38, 1048576
L_sl_loop_51:
    ds_read_b32 v1, v228 offset:4
    s_waitcnt lgkmcnt(0)
    v_readfirstlane_b32 s37, v1
    s_nop 0
    s_cmp_ge_u32 s37, 20
    s_cbranch_scc1 L_sl_done_50
    s_sleep 1
    s_sub_u32 s38, s38, 1
    s_cbranch_scc0 L_sl_loop_51
L_sl_done_50:
L_jd_45:
    buffer_load_dwordx4 v[96:99], v224, s[40:43], s64 offen offset:0 sc1
    buffer_load_dwordx4 v[100:103], v225, s[40:43], s64 offen offset:0 sc1
    ds_read_b64_tr_b16 v[36:37], v84 offset:0
    ds_read_b64_tr_b16 v[38:39], v84 offset:2048
    buffer_load_dwordx4 v[104:107], v224, s[40:43], s64 offen offset:1024 sc1
    buffer_load_dwordx4 v[108:111], v225, s[40:43], s64 offen offset:1024 sc1
    ds_read_b64_tr_b16 v[40:41], v85 offset:0
    ds_read_b64_tr_b16 v[42:43], v85 offset:2048
    buffer_load_dwordx4 v[112:115], v224, s[40:43], s64 offen offset:2048 sc1
    buffer_load_dwordx4 v[116:119], v225, s[40:43], s64 offen offset:2048 sc1
    ds_read_b64_tr_b16 v[44:45], v86 offset:0
    ds_read_b64_tr_b16 v[46:47], v86 offset:2048
    buffer_load_dwordx4 v[120:123], v224, s[40:43], s64 offen offset:3072 sc1
    buffer_load_dwordx4 v[124:127], v225, s[40:43], s64 offen offset:3072 sc1
    ds_read_b64_tr_b16 v[48:49], v87 offset:0
    ds_read_b64_tr_b16 v[50:51], v87 offset:2048
    buffer_load_dwordx4 v[128:131], v224, s[40:43], s65 offen offset:0 sc1
    buffer_load_dwordx4 v[132:135], v225, s[40:43], s65 offen offset:0 sc1
    ds_read_b64_tr_b16 v[52:53], v84 offset:4096
    ds_read_b64_tr_b16 v[54:55], v84 offset:6144
    buffer_load_dwordx4 v[136:139], v224, s[40:43], s65 offen offset:1024 sc1
    buffer_load_dwordx4 v[140:143], v225, s[40:43], s65 offen offset:1024 sc1
    ds_read_b64_tr_b16 v[56:57], v85 offset:4096
    ds_read_b64_tr_b16 v[58:59], v85 offset:6144
    ds_read_b64_tr_b16 v[60:61], v86 offset:4096
    ds_read_b64_tr_b16 v[62:63], v86 offset:6144
    s_waitcnt lgkmcnt(12)
    ds_read_b64_tr_b16 v[64:65], v87 offset:4096
    ds_read_b64_tr_b16 v[66:67], v87 offset:6144
    ds_read_b32 v1, v228 offset:36
    s_waitcnt vmcnt(10) lgkmcnt(9)
    v_mfma_f32_16x16x32_bf16 v[4:7], v[36:39], v[96:99], 0
    ds_read_b64_tr_b16 v[68:69], v84 offset:8192
    v_mfma_f32_16x16x32_bf16 v[20:23], v[36:39], v[100:103], 0
    ds_read_b64_tr_b16 v[70:71], v84 offset:10240
    v_mfma_f32_16x16x32_bf16 v[8:11], v[40:43], v[96:99], 0
    ds_read_b64_tr_b16 v[36:37], v85 offset:8192
    v_mfma_f32_16x16x32_bf16 v[24:27], v[40:43], v[100:103], 0
    ds_read_b64_tr_b16 v[38:39], v85 offset:10240
    buffer_load_dwordx4 v[144:147], v224, s[40:43], s65 offen offset:2048 sc1
    v_mfma_f32_16x16x32_bf16 v[12:15], v[44:47], v[96:99], 0
    ds_read_b64_tr_b16 v[40:41], v86 offset:8192
    v_mfma_f32_16x16x32_bf16 v[28:31], v[44:47], v[100:103], 0
    ds_read_b64_tr_b16 v[42:43], v86 offset:10240
    v_mfma_f32_16x16x32_bf16 v[16:19], v[48:51], v[96:99], 0
    ds_read_b64_tr_b16 v[44:45], v87 offset:8192
    v_mfma_f32_16x16x32_bf16 v[32:35], v[48:51], v[100:103], 0
    ds_read_b64_tr_b16 v[46:47], v87 offset:10240
    buffer_load_dwordx4 v[148:151], v225, s[40:43], s65 offen offset:2048 sc1
    s_waitcnt lgkmcnt(8)
    v_readfirstlane_b32 s37, v1
    s_nop 0
    s_cmp_ge_u32 s37, 4
    s_cbranch_scc1 L_sl_done_52
    s_mov_b32 s38, 1048576
L_sl_loop_53:
    ds_read_b32 v1, v228 offset:36
    s_waitcnt lgkmcnt(0)
    v_readfirstlane_b32 s37, v1
    s_nop 0
    s_cmp_ge_u32 s37, 4
    s_cbranch_scc1 L_sl_done_52
    s_sleep 1
    s_sub_u32 s38, s38, 1
    s_cbranch_scc0 L_sl_loop_53
L_sl_done_52:
    ds_write_b128 v230, v[172:175] offset:0
    s_waitcnt vmcnt(10)
    v_mfma_f32_16x16x32_bf16 v[4:7], v[52:55], v[104:107], v[4:7]
    ds_read_b64_tr_b16 v[48:49], v84 offset:12288
    v_mfma_f32_16x16x32_bf16 v[20:23], v[52:55], v[108:111], v[20:23]
    ds_read_b64_tr_b16 v[50:51], v84 offset:14336
    v_mfma_f32_16x16x32_bf16 v[8:11], v[56:59], v[104:107], v[8:11]
    ds_read_b64_tr_b16 v[52:53], v85 offset:12288
    v_mfma_f32_16x16x32_bf16 v[24:27], v[56:59], v[108:111], v[24:27]
    ds_read_b64_tr_b16 v[54:55], v85 offset:14336
    buffer_load_dwordx4 v[96:99], v224, s[40:43], s65 offen offset:3072 sc1
    ds_write_b128 v230, v[176:179] offset:1024
    v_mfma_f32_16x16x32_bf16 v[12:15], v[60:63], v[104:107], v[12:15]
    ds_read_b64_tr_b16 v[56:57], v86 offset:12288
    v_mfma_f32_16x16x32_bf16 v[28:31], v[60:63], v[108:111], v[28:31]
    ds_read_b64_tr_b16 v[58:59], v86 offset:14336
    v_mfma_f32_16x16x32_bf16 v[16:19], v[64:67], v[104:107], v[16:19]
    ds_read_b64_tr_b16 v[60:61], v87 offset:12288
    v_mfma_f32_16x16x32_bf16 v[32:35], v[64:67], v[108:111], v[32:35]
    ds_read_b64_tr_b16 v[62:63], v87 offset:14336
    buffer_load_dwordx4 v[100:103], v225, s[40:43], s65 offen offset:3072 sc1
    ds_write_b128 v230, v[180:183] offset:8448
    s_waitcnt vmcnt(10) lgkmcnt(11)
    v_mfma_f32_16x16x32_bf16 v[4:7], v[68:71], v[112:115], v[4:7]
    ds_read_b64_tr_b16 v[64:65], v84 offset:16384
    v_mfma_f32_16x16x32_bf16 v[20:23], v[68:71], v[116:119], v[20:23]
    ds_read_b64_tr_b16 v[66:67], v84 offset:18432
    v_mfma_f32_16x16x32_bf16 v[8:11], v[36:39], v[112:115], v[8:11]
    ds_read_b64_tr_b16 v[68:69], v85 offset:16384
    v_mfma_f32_16x16x32_bf16 v[24:27], v[36:39], v[116:119], v[24:27]
    ds_read_b64_tr_b16 v[70:71], v85 offset:18432
    buffer_load_dwordx4 v[104:107], v224, s[40:43], s66 offen offset:0 sc1
    ds_write_b128 v230, v[184:187] offset:9472
    v_mfma_f32_16x16x32_bf16 v[12:15], v[40:43], v[112:115], v[12:15]
    ds_read_b64_tr_b16 v[36:37], v86 offset:16384
    v_mfma_f32_16x16x32_bf16 v[28:31], v[40:43], v[116:119], v[28:31]
    ds_read_b64_tr_b16 v[38:39], v86 offset:18432
    v_mfma_f32_16x16x32_bf16 v[16:19], v[44:47], v[112:115], v[16:19]
    ds_read_b64_tr_b16 v[40:41], v87 offset:16384
    v_mfma_f32_16x16x32_bf16 v[32:35], v[44:47], v[116:119], v[32:35]
    ds_read_b64_tr_b16 v[42:43], v87 offset:18432
    buffer_load_dwordx4 v[108:111], v225, s[40:43], s66 offen offset:0 sc1
    ds_write_b128 v230, v[188:191] offset:16896
    s_waitcnt vmcnt(10) lgkmcnt(11)
    v_mfma_f32_16x16x32_bf16 v[4:7], v[48:51], v[120:123], v[4:7]
    ds_read_b64_tr_b16 v[44:45], v84 offset:20480
    v_mfma_f32_16x16x32_bf16 v[20:23], v[48:51], v[124:127], v[20:23]
    ds_read_b64_tr_b16 v[46:47], v84 offset:22528
    v_mfma_f32_16x16x32_bf16 v[8:11], v[52:55], v[120:123], v[8:11]
    ds_read_b64_tr_b16 v[48:49], v85 offset:20480
    v_mfma_f32_16x16x32_bf16 v[24:27], v[52:55], v[124:127], v[24:27]
    ds_read_b64_tr_b16 v[50:51], v85 offset:22528
    buffer_load_dwordx4 v[112:115], v224, s[40:43], s66 offen offset:1024 sc1
    ds_write_b128 v230, v[192:195] offset:17920
    v_mfma_f32_16x16x32_bf16 v[12:15], v[56:59], v[120:123], v[12:15]
    ds_read_b64_tr_b16 v[52:53], v86 offset:20480
    v_mfma_f32_16x16x32_bf16 v[28:31], v[56:59], v[124:127], v[28:31]
    ds_read_b64_tr_b16 v[54:55], v86 offset:22528
    v_mfma_f32_16x16x32_bf16 v[16:19], v[60:63], v[120:123], v[16:19]
    ds_read_b64_tr_b16 v[56:57], v87 offset:20480
    v_mfma_f32_16x16x32_bf16 v[32:35], v[60:63], v[124:127], v[32:35]
    ds_read_b64_tr_b16 v[58:59], v87 offset:22528
    buffer_load_dwordx4 v[116:119], v225, s[40:43], s66 offen offset:1024 sc1
    ds_write_b128 v230, v[196:199] offset:25344
    s_waitcnt vmcnt(10) lgkmcnt(11)
    v_mfma_f32_16x16x32_bf16 v[4:7], v[64:67], v[128:131], v[4:7]
    ds_read_b64_tr_b16 v[60:61], v84 offset:24576
    v_mfma_f32_16x16x32_bf16 v[20:23], v[64:67], v[132:135], v[20:23]
    ds_read_b64_tr_b16 v[62:63], v84 offset:26624
    v_mfma_f32_16x16x32_bf16 v[8:11], v[68:71], v[128:131], v[8:11]
    ds_read_b64_tr_b16 v[64:65], v85 offset:24576
    v_mfma_f32_16x16x32_bf16 v[24:27], v[68:71], v[132:135], v[24:27]
    ds_read_b64_tr_b16 v[66:67], v85 offset:26624
    buffer_load_dwordx4 v[120:123], v224, s[40:43], s66 offen offset:2048 sc1
    ds_write_b128 v230, v[200:203] offset:26368
    v_mfma_f32_16x16x32_bf16 v[12:15], v[36:39], v[128:131], v[12:15]
    ds_read_b64_tr_b16 v[68:69], v86 offset:24576
    v_mfma_f32_16x16x32_bf16 v[28:31], v[36:39], v[132:135], v[28:31]
    ds_read_b64_tr_b16 v[70:71], v86 offset:26624
    v_mfma_f32_16x16x32_bf16 v[16:19], v[40:43], v[128:131], v[16:19]
    ds_read_b64_tr_b16 v[36:37], v87 offset:24576
    v_mfma_f32_16x16x32_bf16 v[32:35], v[40:43], v[132:135], v[32:35]
    ds_read_b64_tr_b16 v[38:39], v87 offset:26624
    buffer_load_dwordx4 v[124:127], v225, s[40:43], s66 offen offset:2048 sc1
    ds_write_b128 v231, v[204:207] offset:41984
    s_waitcnt vmcnt(10) lgkmcnt(11)
    v_mfma_f32_16x16x32_bf16 v[4:7], v[44:47], v[136:139], v[4:7]
    ds_read_b64_tr_b16 v[40:41], v84 offset:28672
    v_mfma_f32_16x16x32_bf16 v[20:23], v[44:47], v[140:143], v[20:23]
    ds_read_b64_tr_b16 v[42:43], v84 offset:30720
    v_mfma_f32_16x16x32_bf16 v[8:11], v[48:51], v[136:139], v[8:11]
    ds_read_b64_tr_b16 v[44:45], v85 offset:28672
    v_mfma_f32_16x16x32_bf16 v[24:27], v[48:51], v[140:143], v[24:27]
    ds_read_b64_tr_b16 v[46:47], v85 offset:30720
    buffer_load_dwordx4 v[128:131], v224, s[40:43], s66 offen offset:3072 sc1
    ds_write_b128 v231, v[208:211] offset:43008
    v_mfma_f32_16x16x32_bf16 v[12:15], v[52:55], v[136:139], v[12:15]
    ds_read_b64_tr_b16 v[48:49], v86 offset:28672
    v_mfma_f32_16x16x32_bf16 v[28:31], v[52:55], v[140:143], v[28:31]
    ds_read_b64_tr_b16 v[50:51], v86 offset:30720
    v_mfma_f32_16x16x32_bf16 v[16:19], v[56:59], v[136:139], v[16:19]
    ds_read_b64_tr_b16 v[52:53], v87 offset:28672
    v_mfma_f32_16x16x32_bf16 v[32:35], v[56:59], v[140:143], v[32:35]
    ds_read_b64_tr_b16 v[54:55], v87 offset:30720
    buffer_load_dwordx4 v[132:135], v225, s[40:43], s66 offen offset:3072 sc1
    ds_write_b128 v231, v[212:215] offset:51200
    s_waitcnt vmcnt(10) lgkmcnt(11)
    v_mfma_f32_16x16x32_bf16 v[4:7], v[60:63], v[144:147], v[4:7]
    ds_read_b64_tr_b16 v[56:57], v84 offset:32768
    v_mfma_f32_16x16x32_bf16 v[20:23], v[60:63], v[148:151], v[20:23]
    ds_read_b64_tr_b16 v[58:59], v84 offset:34816
    v_mfma_f32_16x16x32_bf16 v[8:11], v[64:67], v[144:147], v[8:11]
    ds_read_b64_tr_b16 v[60:61], v85 offset:32768
    v_mfma_f32_16x16x32_bf16 v[24:27], v[64:67], v[148:151], v[24:27]
    ds_read_b64_tr_b16 v[62:63], v85 offset:34816
    buffer_load_dwordx4 v[136:139], v224, s[40:43], s67 offen offset:0 sc1
    ds_write_b128 v231, v[216:219] offset:52224
    s_mov_b64 exec, 1
    ds_add_u32 v228, v2 offset:12
    s_mov_b64 exec, -1
    v_mfma_f32_16x16x32_bf16 v[12:15], v[68:71], v[144:147], v[12:15]
    ds_read_b64_tr_b16 v[64:65], v86 offset:32768
    v_mfma_f32_16x16x32_bf16 v[28:31], v[68:71], v[148:151], v[28:31]
    ds_read_b64_tr_b16 v[66:67], v86 offset:34816
    v_mfma_f32_16x16x32_bf16 v[16:19], v[36:39], v[144:147], v[16:19]
    ds_read_b64_tr_b16 v[68:69], v87 offset:32768
    v_mfma_f32_16x16x32_bf16 v[32:35], v[36:39], v[148:151], v[32:35]
    ds_read_b64_tr_b16 v[70:71], v87 offset:34816
    buffer_load_dwordx4 v[140:143], v225, s[40:43], s67 offen offset:0 sc1
    s_waitcnt vmcnt(10) lgkmcnt(11)
    v_mfma_f32_16x16x32_bf16 v[4:7], v[40:43], v[96:99], v[4:7]
    ds_read_b64_tr_b16 v[36:37], v84 offset:36864
    v_mfma_f32_16x16x32_bf16 v[20:23], v[40:43], v[100:103], v[20:23]
    ds_read_b64_tr_b16 v[38:39], v84 offset:38912
    v_mfma_f32_16x16x32_bf16 v[8:11], v[44:47], v[96:99], v[8:11]
    ds_read_b64_tr_b16 v[40:41], v85 offset:36864
    v_mfma_f32_16x16x32_bf16 v[24:27], v[44:47], v[100:103], v[24:27]
    ds_read_b64_tr_b16 v[42:43], v85 offset:38912
    buffer_load_dwordx4 v[144:147], v224, s[40:43], s67 offen offset:1024 sc1
    v_mfma_f32_16x16x32_bf16 v[12:15], v[48:51], v[96:99], v[12:15]
    ds_read_b64_tr_b16 v[44:45], v86 offset:36864
    v_mfma_f32_16x16x32_bf16 v[28:31], v[48:51], v[100:103], v[28:31]
    ds_read_b64_tr_b16 v[46:47], v86 offset:38912
    v_mfma_f32_16x16x32_bf16 v[16:19], v[52:55], v[96:99], v[16:19]
    ds_read_b64_tr_b16 v[48:49], v87 offset:36864
    v_mfma_f32_16x16x32_bf16 v[32:35], v[52:55], v[100:103], v[32:35]
    ds_read_b64_tr_b16 v[50:51], v87 offset:38912
    buffer_load_dwordx4 v[148:151], v225, s[40:43], s67 offen offset:1024 sc1
    s_waitcnt vmcnt(10) lgkmcnt(8)
    v_mfma_f32_16x16x32_bf16 v[4:7], v[56:59], v[104:107], v[4:7]
    ds_read_b64_tr_b16 v[52:53], v88 offset:0
    v_mfma_f32_16x16x32_bf16 v[20:23], v[56:59], v[108:111], v[20:23]
    ds_read_b64_tr_b16 v[54:55], v88 offset:2048
    v_mfma_f32_16x16x32_bf16 v[8:11], v[60:63], v[104:107], v[8:11]
    ds_read_b64_tr_b16 v[56:57], v89 offset:0
    v_mfma_f32_16x16x32_bf16 v[24:27], v[60:63], v[108:111], v[24:27]
    ds_read_b64_tr_b16 v[58:59], v89 offset:2048
    buffer_load_dwordx4 v[96:99], v224, s[40:43], s67 offen offset:2048 sc1
    v_mfma_f32_16x16x32_bf16 v[12:15], v[64:67], v[104:107], v[12:15]
    ds_read_b64_tr_b16 v[60:61], v90 offset:0
    v_mfma_f32_16x16x32_bf16 v[28:31], v[64:67], v[108:111], v[28:31]
    ds_read_b64_tr_b16 v[62:63], v90 offset:2048
    v_mfma_f32_16x16x32_bf16 v[16:19], v[68:71], v[104:107], v[16:19]
    ds_read_b64_tr_b16 v[64:65], v91 offset:0
    v_mfma_f32_16x16x32_bf16 v[32:35], v[68:71], v[108:111], v[32:35]
    ds_read_b64_tr_b16 v[66:67], v91 offset:2048
    buffer_load_dwordx4 v[100:103], v225, s[40:43], s67 offen offset:2048 sc1
    s_waitcnt vmcnt(10) lgkmcnt(8)
    v_mfma_f32_16x16x32_bf16 v[4:7], v[36:39], v[112:115], v[4:7]
    ds_read_b64_tr_b16 v[68:69], v88 offset:4096
    v_mfma_f32_16x16x32_bf16 v[20:23], v[36:39], v[116:119], v[20:23]
    ds_read_b64_tr_b16 v[70:71], v88 offset:6144
    v_mfma_f32_16x16x32_bf16 v[8:11], v[40:43], v[112:115], v[8:11]
    ds_read_b64_tr_b16 v[36:37], v89 offset:4096
    v_mfma_f32_16x16x32_bf16 v[24:27], v[40:43], v[116:119], v[24:27]
    ds_read_b64_tr_b16 v[38:39], v89 offset:6144
    buffer_load_dwordx4 v[104:107], v224, s[40:43], s67 offen offset:3072 sc1
    v_mfma_f32_16x16x32_bf16 v[12:15], v[44:47], v[112:115], v[12:15]
    ds_read_b64_tr_b16 v[40:41], v90 offset:4096
    v_mfma_f32_16x16x32_bf16 v[28:31], v[44:47], v[116:119], v[28:31]
    ds_read_b64_tr_b16 v[42:43], v90 offset:6144
    v_mfma_f32_16x16x32_bf16 v[16:19], v[48:51], v[112:115], v[16:19]
    ds_read_b64_tr_b16 v[44:45], v91 offset:4096
    v_mfma_f32_16x16x32_bf16 v[32:35], v[48:51], v[116:119], v[32:35]
    ds_read_b64_tr_b16 v[46:47], v91 offset:6144
    buffer_load_dwordx4 v[108:111], v225, s[40:43], s67 offen offset:3072 sc1
    s_waitcnt vmcnt(10) lgkmcnt(8)
    v_mfma_f32_16x16x32_bf16 v[4:7], v[52:55], v[120:123], v[4:7]
    ds_read_b64_tr_b16 v[48:49], v88 offset:8192
    v_mfma_f32_16x16x32_bf16 v[20:23], v[52:55], v[124:127], v[20:23]
    ds_read_b64_tr_b16 v[50:51], v88 offset:10240
    v_mfma_f32_16x16x32_bf16 v[8:11], v[56:59], v[120:123], v[8:11]
    ds_read_b64_tr_b16 v[52:53], v89 offset:8192
    v_mfma_f32_16x16x32_bf16 v[24:27], v[56:59], v[124:127], v[24:27]
    ds_read_b64_tr_b16 v[54:55], v89 offset:10240
    buffer_load_dwordx4 v[112:115], v224, s[40:43], s68 offen offset:0 sc1
    v_mfma_f32_16x16x32_bf16 v[12:15], v[60:63], v[120:123], v[12:15]
    ds_read_b64_tr_b16 v[56:57], v90 offset:8192
    v_mfma_f32_16x16x32_bf16 v[28:31], v[60:63], v[124:127], v[28:31]
    ds_read_b64_tr_b16 v[58:59], v90 offset:10240
    v_mfma_f32_16x16x32_bf16 v[16:19], v[64:67], v[120:123], v[16:19]
    ds_read_b64_tr_b16 v[60:61], v91 offset:8192
    v_mfma_f32_16x16x32_bf16 v[32:35], v[64:67], v[124:127], v[32:35]
    ds_read_b64_tr_b16 v[62:63], v91 offset:10240
    buffer_load_dwordx4 v[116:119], v225, s[40:43], s68 offen offset:0 sc1
    s_waitcnt vmcnt(10) lgkmcnt(8)
    v_mfma_f32_16x16x32_bf16 v[4:7], v[68:71], v[128:131], v[4:7]
    ds_read_b64_tr_b16 v[64:65], v88 offset:12288
    v_mfma_f32_16x16x32_bf16 v[20:23], v[68:71], v[132:135], v[20:23]
    ds_read_b64_tr_b16 v[66:67], v88 offset:14336
    v_mfma_f32_16x16x32_bf16 v[8:11], v[36:39], v[128:131], v[8:11]
    ds_read_b64_tr_b16 v[68:69], v89 offset:12288
    v_mfma_f32_16x16x32_bf16 v[24:27], v[36:39], v[132:135], v[24:27]
    ds_read_b64_tr_b16 v[70:71], v89 offset:14336
    buffer_load_dwordx4 v[120:123], v224, s[40:43], s68 offen offset:1024 sc1
    v_mfma_f32_16x16x32_bf16 v[12:15], v[40:43], v[128:131], v[12:15]
    ds_read_b64_tr_b16 v[36:37], v90 offset:12288
    v_mfma_f32_16x16x32_bf16 v[28:31], v[40:43], v[132:135], v[28:31]
    ds_read_b64_tr_b16 v[38:39], v90 offset:14336
    v_mfma_f32_16x16x32_bf16 v[16:19], v[44:47], v[128:131], v[16:19]
    ds_read_b64_tr_b16 v[40:41], v91 offset:12288
    v_mfma_f32_16x16x32_bf16 v[32:35], v[44:47], v[132:135], v[32:35]
    ds_read_b64_tr_b16 v[42:43], v91 offset:14336
    buffer_load_dwordx4 v[124:127], v225, s[40:43], s68 offen offset:1024 sc1
    s_waitcnt vmcnt(10) lgkmcnt(8)
    v_mfma_f32_16x16x32_bf16 v[4:7], v[48:51], v[136:139], v[4:7]
    ds_read_b64_tr_b16 v[44:45], v88 offset:16384
    v_mfma_f32_16x16x32_bf16 v[20:23], v[48:51], v[140:143], v[20:23]
    ds_read_b64_tr_b16 v[46:47], v88 offset:18432
    v_mfma_f32_16x16x32_bf16 v[8:11], v[52:55], v[136:139], v[8:11]
    ds_read_b64_tr_b16 v[48:49], v89 offset:16384
    v_mfma_f32_16x16x32_bf16 v[24:27], v[52:55], v[140:143], v[24:27]
    ds_read_b64_tr_b16 v[50:51], v89 offset:18432
    buffer_load_dwordx4 v[128:131], v224, s[40:43], s68 offen offset:2048 sc1
    v_mfma_f32_16x16x32_bf16 v[12:15], v[56:59], v[136:139], v[12:15]
    ds_read_b64_tr_b16 v[52:53], v90 offset:16384
    v_mfma_f32_16x16x32_bf16 v[28:31], v[56:59], v[140:143], v[28:31]
    ds_read_b64_tr_b16 v[54:55], v90 offset:18432
    v_mfma_f32_16x16x32_bf16 v[16:19], v[60:63], v[136:139], v[16:19]
    ds_read_b64_tr_b16 v[56:57], v91 offset:16384
    v_mfma_f32_16x16x32_bf16 v[32:35], v[60:63], v[140:143], v[32:35]
    ds_read_b64_tr_b16 v[58:59], v91 offset:18432
    buffer_load_dwordx4 v[132:135], v225, s[40:43], s68 offen offset:2048 sc1
    s_waitcnt vmcnt(10) lgkmcnt(8)
    v_mfma_f32_16x16x32_bf16 v[4:7], v[64:67], v[144:147], v[4:7]
    ds_read_b64_tr_b16 v[60:61], v88 offset:20480
    v_mfma_f32_16x16x32_bf16 v[20:23], v[64:67], v[148:151], v[20:23]
    ds_read_b64_tr_b16 v[62:63], v88 offset:22528
    v_mfma_f32_16x16x32_bf16 v[8:11], v[68:71], v[144:147], v[8:11]
    ds_read_b64_tr_b16 v[64:65], v89 offset:20480
    v_mfma_f32_16x16x32_bf16 v[24:27], v[68:71], v[148:151], v[24:27]
    ds_read_b64_tr_b16 v[66:67], v89 offset:22528
    buffer_load_dwordx4 v[136:139], v224, s[40:43], s68 offen offset:3072 sc1
    v_mfma_f32_16x16x32_bf16 v[12:15], v[36:39], v[144:147], v[12:15]
    ds_read_b64_tr_b16 v[68:69], v90 offset:20480
    v_mfma_f32_16x16x32_bf16 v[28:31], v[36:39], v[148:151], v[28:31]
    ds_read_b64_tr_b16 v[70:71], v90 offset:22528
    v_mfma_f32_16x16x32_bf16 v[16:19], v[40:43], v[144:147], v[16:19]
    ds_read_b64_tr_b16 v[36:37], v91 offset:20480
    v_mfma_f32_16x16x32_bf16 v[32:35], v[40:43], v[148:151], v[32:35]
    ds_read_b64_tr_b16 v[38:39], v91 offset:22528
    buffer_load_dwordx4 v[140:143], v225, s[40:43], s68 offen offset:3072 sc1
    s_waitcnt vmcnt(10) lgkmcnt(8)
    v_mfma_f32_16x16x32_bf16 v[4:7], v[44:47], v[96:99], v[4:7]
    ds_read_b64_tr_b16 v[40:41], v88 offset:24576
    v_mfma_f32_16x16x32_bf16 v[20:23], v[44:47], v[100:103], v[20:23]
    ds_read_b64_tr_b16 v[42:43], v88 offset:26624
    v_mfma_f32_16x16x32_bf16 v[8:11], v[48:51], v[96:99], v[8:11]
    ds_read_b64_tr_b16 v[44:45], v89 offset:24576
    v_mfma_f32_16x16x32_bf16 v[24:27], v[48:51], v[100:103], v[24:27]
    ds_read_b64_tr_b16 v[46:47], v89 offset:26624
    buffer_load_dwordx4 v[144:147], v224, s[40:43], s69 offen offset:0 sc1
    v_mfma_f32_16x16x32_bf16 v[12:15], v[52:55], v[96:99], v[12:15]
    ds_read_b64_tr_b16 v[48:49], v90 offset:24576
    v_mfma_f32_16x16x32_bf16 v[28:31], v[52:55], v[100:103], v[28:31]
    ds_read_b64_tr_b16 v[50:51], v90 offset:26624
    v_mfma_f32_16x16x32_bf16 v[16:19], v[56:59], v[96:99], v[16:19]
    ds_read_b64_tr_b16 v[52:53], v91 offset:24576
    v_mfma_f32_16x16x32_bf16 v[32:35], v[56:59], v[100:103], v[32:35]
    ds_read_b64_tr_b16 v[54:55], v91 offset:26624
    buffer_load_dwordx4 v[148:151], v225, s[40:43], s69 offen offset:0 sc1
    s_waitcnt vmcnt(10) lgkmcnt(8)
    v_mfma_f32_16x16x32_bf16 v[4:7], v[60:63], v[104:107], v[4:7]
    ds_read_b64_tr_b16 v[56:57], v88 offset:28672
    v_mfma_f32_16x16x32_bf16 v[20:23], v[60:63], v[108:111], v[20:23]
    ds_read_b64_tr_b16 v[58:59], v88 offset:30720
    v_mfma_f32_16x16x32_bf16 v[8:11], v[64:67], v[104:107], v[8:11]
    ds_read_b64_tr_b16 v[60:61], v89 offset:28672
    v_mfma_f32_16x16x32_bf16 v[24:27], v[64:67], v[108:111], v[24:27]
    ds_read_b64_tr_b16 v[62:63], v89 offset:30720
    buffer_load_dwordx4 v[96:99], v224, s[40:43], s69 offen offset:1024 sc1
    v_mfma_f32_16x16x32_bf16 v[12:15], v[68:71], v[104:107], v[12:15]
    ds_read_b64_tr_b16 v[64:65], v90 offset:28672
    v_mfma_f32_16x16x32_bf16 v[28:31], v[68:71], v[108:111], v[28:31]
    ds_read_b64_tr_b16 v[66:67], v90 offset:30720
    v_mfma_f32_16x16x32_bf16 v[16:19], v[36:39], v[104:107], v[16:19]
    ds_read_b64_tr_b16 v[68:69], v91 offset:28672
    v_mfma_f32_16x16x32_bf16 v[32:35], v[36:39], v[108:111], v[32:35]
    ds_read_b64_tr_b16 v[70:71], v91 offset:30720
    buffer_load_dwordx4 v[100:103], v225, s[40:43], s69 offen offset:1024 sc1
    s_waitcnt vmcnt(10) lgkmcnt(8)
    v_mfma_f32_16x16x32_bf16 v[4:7], v[40:43], v[112:115], v[4:7]
    ds_read_b64_tr_b16 v[36:37], v88 offset:32768
    v_mfma_f32_16x16x32_bf16 v[20:23], v[40:43], v[116:119], v[20:23]
    ds_read_b64_tr_b16 v[38:39], v88 offset:34816
    v_mfma_f32_16x16x32_bf16 v[8:11], v[44:47], v[112:115], v[8:11]
    ds_read_b64_tr_b16 v[40:41], v89 offset:32768
    v_mfma_f32_16x16x32_bf16 v[24:27], v[44:47], v[116:119], v[24:27]
    ds_read_b64_tr_b16 v[42:43], v89 offset:34816
    buffer_load_dwordx4 v[104:107], v224, s[40:43], s69 offen offset:2048 sc1
    v_mfma_f32_16x16x32_bf16 v[12:15], v[48:51], v[112:115], v[12:15]
    ds_read_b64_tr_b16 v[44:45], v90 offset:32768
    v_mfma_f32_16x16x32_bf16 v[28:31], v[48:51], v[116:119], v[28:31]
    ds_read_b64_tr_b16 v[46:47], v90 offset:34816
    v_mfma_f32_16x16x32_bf16 v[16:19], v[52:55], v[112:115], v[16:19]
    ds_read_b64_tr_b16 v[48:49], v91 offset:32768
    v_mfma_f32_16x16x32_bf16 v[32:35], v[52:55], v[116:119], v[32:35]
    ds_read_b64_tr_b16 v[50:51], v91 offset:34816
    buffer_load_dwordx4 v[108:111], v225, s[40:43], s69 offen offset:2048 sc1
    ds_read_b32 v1, v228 offset:12
    s_waitcnt vmcnt(10) lgkmcnt(9)
    v_mfma_f32_16x16x32_bf16 v[4:7], v[56:59], v[120:123], v[4:7]
    ds_read_b64_tr_b16 v[52:53], v88 offset:36864
    v_mfma_f32_16x16x32_bf16 v[20:23], v[56:59], v[124:127], v[20:23]
    ds_read_b64_tr_b16 v[54:55], v88 offset:38912
    v_mfma_f32_16x16x32_bf16 v[8:11], v[60:63], v[120:123], v[8:11]
    ds_read_b64_tr_b16 v[56:57], v89 offset:36864
    v_mfma_f32_16x16x32_bf16 v[24:27], v[60:63], v[124:127], v[24:27]
    ds_read_b64_tr_b16 v[58:59], v89 offset:38912
    buffer_load_dwordx4 v[112:115], v224, s[40:43], s69 offen offset:3072 sc1
    v_mfma_f32_16x16x32_bf16 v[12:15], v[64:67], v[120:123], v[12:15]
    ds_read_b64_tr_b16 v[60:61], v90 offset:36864
    v_mfma_f32_16x16x32_bf16 v[28:31], v[64:67], v[124:127], v[28:31]
    ds_read_b64_tr_b16 v[62:63], v90 offset:38912
    v_mfma_f32_16x16x32_bf16 v[16:19], v[68:71], v[120:123], v[16:19]
    ds_read_b64_tr_b16 v[64:65], v91 offset:36864
    v_mfma_f32_16x16x32_bf16 v[32:35], v[68:71], v[124:127], v[32:35]
    ds_read_b64_tr_b16 v[66:67], v91 offset:38912
    buffer_load_dwordx4 v[116:119], v225, s[40:43], s69 offen offset:3072 sc1
    s_waitcnt lgkmcnt(8)
    v_readfirstlane_b32 s37, v1
    s_nop 0
    s_cmp_ge_u32 s37, 4
    s_cbranch_scc1 L_sl_done_54
    s_mov_b32 s38, 1048576
L_sl_loop_55:
    ds_read_b32 v1, v228 offset:12
    s_waitcnt lgkmcnt(0)
    v_readfirstlane_b32 s37, v1
    s_nop 0
    s_cmp_ge_u32 s37, 4
    s_cbranch_scc1 L_sl_done_54
    s_sleep 1
    s_sub_u32 s38, s38, 1
    s_cbranch_scc0 L_sl_loop_55
L_sl_done_54:
    s_waitcnt vmcnt(10)
    v_mfma_f32_16x16x32_bf16 v[4:7], v[36:39], v[128:131], v[4:7]
    ds_read_b64_tr_b16 v[68:69], v92 offset:0
    v_mfma_f32_16x16x32_bf16 v[20:23], v[36:39], v[132:135], v[20:23]
    ds_read_b64_tr_b16 v[70:71], v92 offset:2048
    v_mfma_f32_16x16x32_bf16 v[8:11], v[40:43], v[128:131], v[8:11]
    ds_read_b64_tr_b16 v[36:37], v93 offset:0
    v_mfma_f32_16x16x32_bf16 v[24:27], v[40:43], v[132:135], v[24:27]
    ds_read_b64_tr_b16 v[38:39], v93 offset:2048
    buffer_load_dwordx4 v[120:123], v224, s[40:43], s70 offen offset:0 sc1
    v_mfma_f32_16x16x32_bf16 v[12:15], v[44:47], v[128:131], v[12:15]
    ds_read_b64_tr_b16 v[40:41], v94 offset:0
    v_mfma_f32_16x16x32_bf16 v[28:31], v[44:47], v[132:135], v[28:31]
    ds_read_b64_tr_b16 v[42:43], v94 offset:2048
    v_mfma_f32_16x16x32_bf16 v[16:19], v[48:51], v[128:131], v[16:19]
    ds_read_b64_tr_b16 v[44:45], v95 offset:0
    v_mfma_f32_16x16x32_bf16 v[32:35], v[48:51], v[132:135], v[32:35]
    ds_read_b64_tr_b16 v[46:47], v95 offset:2048
    buffer_load_dwordx4 v[124:127], v225, s[40:43], s70 offen offset:0 sc1
    s_waitcnt vmcnt(10) lgkmcnt(8)
    v_mfma_f32_16x16x32_bf16 v[4:7], v[52:55], v[136:139], v[4:7]
    ds_read_b64_tr_b16 v[48:49], v92 offset:4096
    v_mfma_f32_16x16x32_bf16 v[20:23], v[52:55], v[140:143], v[20:23]
    ds_read_b64_tr_b16 v[50:51], v92 offset:6144
    v_mfma_f32_16x16x32_bf16 v[8:11], v[56:59], v[136:139], v[8:11]
    ds_read_b64_tr_b16 v[52:53], v93 offset:4096
    v_mfma_f32_16x16x32_bf16 v[24:27], v[56:59], v[140:143], v[24:27]
    ds_read_b64_tr_b16 v[54:55], v93 offset:6144
    buffer_load_dwordx4 v[128:131], v224, s[40:43], s70 offen offset:1024 sc1
    v_mfma_f32_16x16x32_bf16 v[12:15], v[60:63], v[136:139], v[12:15]
    ds_read_b64_tr_b16 v[56:57], v94 offset:4096
    v_mfma_f32_16x16x32_bf16 v[28:31], v[60:63], v[140:143], v[28:31]
    ds_read_b64_tr_b16 v[58:59], v94 offset:6144
    v_mfma_f32_16x16x32_bf16 v[16:19], v[64:67], v[136:139], v[16:19]
    ds_read_b64_tr_b16 v[60:61], v95 offset:4096
    v_mfma_f32_16x16x32_bf16 v[32:35], v[64:67], v[140:143], v[32:35]
    ds_read_b64_tr_b16 v[62:63], v95 offset:6144
    buffer_load_dwordx4 v[132:135], v225, s[40:43], s70 offen offset:1024 sc1
    s_waitcnt vmcnt(10) lgkmcnt(8)
    v_mfma_f32_16x16x32_bf16 v[4:7], v[68:71], v[144:147], v[4:7]
    ds_read_b64_tr_b16 v[64:65], v92 offset:8448
    v_mfma_f32_16x16x32_bf16 v[20:23], v[68:71], v[148:151], v[20:23]
    ds_read_b64_tr_b16 v[66:67], v92 offset:10496
    v_mfma_f32_16x16x32_bf16 v[8:11], v[36:39], v[144:147], v[8:11]
    ds_read_b64_tr_b16 v[68:69], v93 offset:8448
    v_mfma_f32_16x16x32_bf16 v[24:27], v[36:39], v[148:151], v[24:27]
    ds_read_b64_tr_b16 v[70:71], v93 offset:10496
    buffer_load_dwordx4 v[136:139], v224, s[40:43], s70 offen offset:2048 sc1
    v_mfma_f32_16x16x32_bf16 v[12:15], v[40:43], v[144:147], v[12:15]
    ds_read_b64_tr_b16 v[36:37], v94 offset:8448
    v_mfma_f32_16x16x32_bf16 v[28:31], v[40:43], v[148:151], v[28:31]
    ds_read_b64_tr_b16 v[38:39], v94 offset:10496
    v_mfma_f32_16x16x32_bf16 v[16:19], v[44:47], v[144:147], v[16:19]
    ds_read_b64_tr_b16 v[40:41], v95 offset:8448
    v_mfma_f32_16x16x32_bf16 v[32:35], v[44:47], v[148:151], v[32:35]
    ds_read_b64_tr_b16 v[42:43], v95 offset:10496
    buffer_load_dwordx4 v[140:143], v225, s[40:43], s70 offen offset:2048 sc1
    s_waitcnt vmcnt(10) lgkmcnt(8)
    v_mfma_f32_16x16x32_bf16 v[4:7], v[48:51], v[96:99], v[4:7]
    ds_read_b64_tr_b16 v[44:45], v92 offset:12544
    v_mfma_f32_16x16x32_bf16 v[20:23], v[48:51], v[100:103], v[20:23]
    ds_read_b64_tr_b16 v[46:47], v92 offset:14592
    v_mfma_f32_16x16x32_bf16 v[8:11], v[52:55], v[96:99], v[8:11]
    ds_read_b64_tr_b16 v[48:49], v93 offset:12544
    v_mfma_f32_16x16x32_bf16 v[24:27], v[52:55], v[100:103], v[24:27]
    ds_read_b64_tr_b16 v[50:51], v93 offset:14592
    buffer_load_dwordx4 v[144:147], v224, s[40:43], s70 offen offset:3072 sc1
    v_mfma_f32_16x16x32_bf16 v[12:15], v[56:59], v[96:99], v[12:15]
    ds_read_b64_tr_b16 v[52:53], v94 offset:12544
    v_mfma_f32_16x16x32_bf16 v[28:31], v[56:59], v[100:103], v[28:31]
    ds_read_b64_tr_b16 v[54:55], v94 offset:14592
    v_mfma_f32_16x16x32_bf16 v[16:19], v[60:63], v[96:99], v[16:19]
    ds_read_b64_tr_b16 v[56:57], v95 offset:12544
    v_mfma_f32_16x16x32_bf16 v[32:35], v[60:63], v[100:103], v[32:35]
    ds_read_b64_tr_b16 v[58:59], v95 offset:14592
    buffer_load_dwordx4 v[148:151], v225, s[40:43], s70 offen offset:3072 sc1
    s_waitcnt vmcnt(10) lgkmcnt(8)
    v_mfma_f32_16x16x32_bf16 v[4:7], v[64:67], v[104:107], v[4:7]
    ds_read_b64_tr_b16 v[60:61], v92 offset:16896
    v_mfma_f32_16x16x32_bf16 v[20:23], v[64:67], v[108:111], v[20:23]
    ds_read_b64_tr_b16 v[62:63], v92 offset:18944
    v_mfma_f32_16x16x32_bf16 v[8:11], v[68:71], v[104:107], v[8:11]
    ds_read_b64_tr_b16 v[64:65], v93 offset:16896
    v_mfma_f32_16x16x32_bf16 v[24:27], v[68:71], v[108:111], v[24:27]
    ds_read_b64_tr_b16 v[66:67], v93 offset:18944
    buffer_load_dwordx4 v[96:99], v224, s[40:43], s71 offen offset:0 sc1
    v_mfma_f32_16x16x32_bf16 v[12:15], v[36:39], v[104:107], v[12:15]
    ds_read_b64_tr_b16 v[68:69], v94 offset:16896
    v_mfma_f32_16x16x32_bf16 v[28:31], v[36:39], v[108:111], v[28:31]
    ds_read_b64_tr_b16 v[70:71], v94 offset:18944
    v_mfma_f32_16x16x32_bf16 v[16:19], v[40:43], v[104:107], v[16:19]
    ds_read_b64_tr_b16 v[36:37], v95 offset:16896
    v_mfma_f32_16x16x32_bf16 v[32:35], v[40:43], v[108:111], v[32:35]
    ds_read_b64_tr_b16 v[38:39], v95 offset:18944
    buffer_load_dwordx4 v[100:103], v225, s[40:43], s71 offen offset:0 sc1
    s_waitcnt vmcnt(10) lgkmcnt(8)
    v_mfma_f32_16x16x32_bf16 v[4:7], v[44:47], v[112:115], v[4:7]
    ds_read_b64_tr_b16 v[40:41], v92 offset:20992
    v_mfma_f32_16x16x32_bf16 v[20:23], v[44:47], v[116:119], v[20:23]
    ds_read_b64_tr_b16 v[42:43], v92 offset:23040
    v_mfma_f32_16x16x32_bf16 v[8:11], v[48:51], v[112:115], v[8:11]
    ds_read_b64_tr_b16 v[44:45], v93 offset:20992
    v_mfma_f32_16x16x32_bf16 v[24:27], v[48:51], v[116:119], v[24:27]
    ds_read_b64_tr_b16 v[46:47], v93 offset:23040
    buffer_load_dwordx4 v[104:107], v224, s[40:43], s71 offen offset:1024 sc1
    v_mfma_f32_16x16x32_bf16 v[12:15], v[52:55], v[112:115], v[12:15]
    ds_read_b64_tr_b16 v[48:49], v94 offset:20992
    v_mfma_f32_16x16x32_bf16 v[28:31], v[52:55], v[116:119], v[28:31]
    ds_read_b64_tr_b16 v[50:51], v94 offset:23040
    v_mfma_f32_16x16x32_bf16 v[16:19], v[56:59], v[112:115], v[16:19]
    ds_read_b64_tr_b16 v[52:53], v95 offset:20992
    v_mfma_f32_16x16x32_bf16 v[32:35], v[56:59], v[116:119], v[32:35]
    ds_read_b64_tr_b16 v[54:55], v95 offset:23040
    buffer_load_dwordx4 v[108:111], v225, s[40:43], s71 offen offset:1024 sc1
    s_waitcnt vmcnt(10) lgkmcnt(8)
    v_mfma_f32_16x16x32_bf16 v[4:7], v[60:63], v[120:123], v[4:7]
    ds_read_b64_tr_b16 v[56:57], v92 offset:25344
    v_mfma_f32_16x16x32_bf16 v[20:23], v[60:63], v[124:127], v[20:23]
    ds_read_b64_tr_b16 v[58:59], v92 offset:27392
    v_mfma_f32_16x16x32_bf16 v[8:11], v[64:67], v[120:123], v[8:11]
    ds_read_b64_tr_b16 v[60:61], v93 offset:25344
    v_mfma_f32_16x16x32_bf16 v[24:27], v[64:67], v[124:127], v[24:27]
    ds_read_b64_tr_b16 v[62:63], v93 offset:27392
    buffer_load_dwordx4 v[112:115], v224, s[40:43], s71 offen offset:2048 sc1
    v_mfma_f32_16x16x32_bf16 v[12:15], v[68:71], v[120:123], v[12:15]
    ds_read_b64_tr_b16 v[64:65], v94 offset:25344
    v_mfma_f32_16x16x32_bf16 v[28:31], v[68:71], v[124:127], v[28:31]
    ds_read_b64_tr_b16 v[66:67], v94 offset:27392
    v_mfma_f32_16x16x32_bf16 v[16:19], v[36:39], v[120:123], v[16:19]
    ds_read_b64_tr_b16 v[68:69], v95 offset:25344
    v_mfma_f32_16x16x32_bf16 v[32:35], v[36:39], v[124:127], v[32:35]
    ds_read_b64_tr_b16 v[70:71], v95 offset:27392
    buffer_load_dwordx4 v[116:119], v225, s[40:43], s71 offen offset:2048 sc1
    s_waitcnt vmcnt(10) lgkmcnt(8)
    v_mfma_f32_16x16x32_bf16 v[4:7], v[40:43], v[128:131], v[4:7]
    ds_read_b64_tr_b16 v[36:37], v92 offset:29440
    v_mfma_f32_16x16x32_bf16 v[20:23], v[40:43], v[132:135], v[20:23]
    ds_read_b64_tr_b16 v[38:39], v92 offset:31488
    v_mfma_f32_16x16x32_bf16 v[8:11], v[44:47], v[128:131], v[8:11]
    ds_read_b64_tr_b16 v[40:41], v93 offset:29440
    v_mfma_f32_16x16x32_bf16 v[24:27], v[44:47], v[132:135], v[24:27]
    ds_read_b64_tr_b16 v[42:43], v93 offset:31488
    buffer_load_dwordx4 v[120:123], v224, s[40:43], s71 offen offset:3072 sc1
    v_mfma_f32_16x16x32_bf16 v[12:15], v[48:51], v[128:131], v[12:15]
    ds_read_b64_tr_b16 v[44:45], v94 offset:29440
    v_mfma_f32_16x16x32_bf16 v[28:31], v[48:51], v[132:135], v[28:31]
    ds_read_b64_tr_b16 v[46:47], v94 offset:31488
    v_mfma_f32_16x16x32_bf16 v[16:19], v[52:55], v[128:131], v[16:19]
    ds_read_b64_tr_b16 v[48:49], v95 offset:29440
    v_mfma_f32_16x16x32_bf16 v[32:35], v[52:55], v[132:135], v[32:35]
    ds_read_b64_tr_b16 v[50:51], v95 offset:31488
    buffer_load_dwordx4 v[124:127], v225, s[40:43], s71 offen offset:3072 sc1
    s_waitcnt vmcnt(10) lgkmcnt(8)
    v_mfma_f32_16x16x32_bf16 v[4:7], v[56:59], v[136:139], v[4:7]
    ds_read_b64_tr_b16 v[52:53], v84 offset:41984
    v_mfma_f32_16x16x32_bf16 v[20:23], v[56:59], v[140:143], v[20:23]
    ds_read_b64_tr_b16 v[54:55], v84 offset:44032
    v_mfma_f32_16x16x32_bf16 v[8:11], v[60:63], v[136:139], v[8:11]
    ds_read_b64_tr_b16 v[56:57], v85 offset:41984
    v_mfma_f32_16x16x32_bf16 v[24:27], v[60:63], v[140:143], v[24:27]
    ds_read_b64_tr_b16 v[58:59], v85 offset:44032
    v_mfma_f32_16x16x32_bf16 v[12:15], v[64:67], v[136:139], v[12:15]
    ds_read_b64_tr_b16 v[60:61], v86 offset:41984
    v_mfma_f32_16x16x32_bf16 v[28:31], v[64:67], v[140:143], v[28:31]
    ds_read_b64_tr_b16 v[62:63], v86 offset:44032
    v_mfma_f32_16x16x32_bf16 v[16:19], v[68:71], v[136:139], v[16:19]
    ds_read_b64_tr_b16 v[64:65], v87 offset:41984
    v_mfma_f32_16x16x32_bf16 v[32:35], v[68:71], v[140:143], v[32:35]
    ds_read_b64_tr_b16 v[66:67], v87 offset:44032
    s_waitcnt vmcnt(8) lgkmcnt(8)
    v_mfma_f32_16x16x32_bf16 v[4:7], v[36:39], v[144:147], v[4:7]
    ds_read_b64_tr_b16 v[68:69], v84 offset:46080
    v_mfma_f32_16x16x32_bf16 v[20:23], v[36:39], v[148:151], v[20:23]
    ds_read_b64_tr_b16 v[70:71], v84 offset:48128
    v_mfma_f32_16x16x32_bf16 v[8:11], v[40:43], v[144:147], v[8:11]
    ds_read_b64_tr_b16 v[36:37], v85 offset:46080
    v_mfma_f32_16x16x32_bf16 v[24:27], v[40:43], v[148:151], v[24:27]
    ds_read_b64_tr_b16 v[38:39], v85 offset:48128
    v_mfma_f32_16x16x32_bf16 v[12:15], v[44:47], v[144:147], v[12:15]
    ds_read_b64_tr_b16 v[40:41], v86 offset:46080
    v_mfma_f32_16x16x32_bf16 v[28:31], v[44:47], v[148:151], v[28:31]
    ds_read_b64_tr_b16 v[42:43], v86 offset:48128
    v_mfma_f32_16x16x32_bf16 v[16:19], v[48:51], v[144:147], v[16:19]
    ds_read_b64_tr_b16 v[44:45], v87 offset:46080
    v_mfma_f32_16x16x32_bf16 v[32:35], v[48:51], v[148:151], v[32:35]
    ds_read_b64_tr_b16 v[46:47], v87 offset:48128
    s_waitcnt vmcnt(6) lgkmcnt(8)
    v_mfma_f32_16x16x32_bf16 v[4:7], v[52:55], v[96:99], v[4:7]
    ds_read_b64_tr_b16 v[48:49], v84 offset:51200
    v_mfma_f32_16x16x32_bf16 v[20:23], v[52:55], v[100:103], v[20:23]
    ds_read_b64_tr_b16 v[50:51], v84 offset:53248
    v_mfma_f32_16x16x32_bf16 v[8:11], v[56:59], v[96:99], v[8:11]
    ds_read_b64_tr_b16 v[52:53], v85 offset:51200
    v_mfma_f32_16x16x32_bf16 v[24:27], v[56:59], v[100:103], v[24:27]
    ds_read_b64_tr_b16 v[54:55], v85 offset:53248
    v_mfma_f32_16x16x32_bf16 v[12:15], v[60:63], v[96:99], v[12:15]
    ds_read_b64_tr_b16 v[56:57], v86 offset:51200
    v_mfma_f32_16x16x32_bf16 v[28:31], v[60:63], v[100:103], v[28:31]
    ds_read_b64_tr_b16 v[58:59], v86 offset:53248
    v_mfma_f32_16x16x32_bf16 v[16:19], v[64:67], v[96:99], v[16:19]
    ds_read_b64_tr_b16 v[60:61], v87 offset:51200
    v_mfma_f32_16x16x32_bf16 v[32:35], v[64:67], v[100:103], v[32:35]
    ds_read_b64_tr_b16 v[62:63], v87 offset:53248
    s_waitcnt vmcnt(4) lgkmcnt(8)
    v_mfma_f32_16x16x32_bf16 v[4:7], v[68:71], v[104:107], v[4:7]
    ds_read_b64_tr_b16 v[64:65], v84 offset:55296
    v_mfma_f32_16x16x32_bf16 v[20:23], v[68:71], v[108:111], v[20:23]
    ds_read_b64_tr_b16 v[66:67], v84 offset:57344
    v_mfma_f32_16x16x32_bf16 v[8:11], v[36:39], v[104:107], v[8:11]
    ds_read_b64_tr_b16 v[68:69], v85 offset:55296
    v_mfma_f32_16x16x32_bf16 v[24:27], v[36:39], v[108:111], v[24:27]
    ds_read_b64_tr_b16 v[70:71], v85 offset:57344
    v_mfma_f32_16x16x32_bf16 v[12:15], v[40:43], v[104:107], v[12:15]
    ds_read_b64_tr_b16 v[36:37], v86 offset:55296
    v_mfma_f32_16x16x32_bf16 v[28:31], v[40:43], v[108:111], v[28:31]
    ds_read_b64_tr_b16 v[38:39], v86 offset:57344
    v_mfma_f32_16x16x32_bf16 v[16:19], v[44:47], v[104:107], v[16:19]
    ds_read_b64_tr_b16 v[40:41], v87 offset:55296
    v_mfma_f32_16x16x32_bf16 v[32:35], v[44:47], v[108:111], v[32:35]
    ds_read_b64_tr_b16 v[42:43], v87 offset:57344
    s_waitcnt vmcnt(2) lgkmcnt(8)
    v_mfma_f32_16x16x32_bf16 v[4:7], v[48:51], v[112:115], v[4:7]
    s_mul_i32 s37, s32, 80896
    s_lshl_b32 s38, s33, 11
    v_mfma_f32_16x16x32_bf16 v[20:23], v[48:51], v[116:119], v[20:23]
    s_add_u32 s37, s37, s38
    s_add_u32 s37, s37, 78848
    v_mfma_f32_16x16x32_bf16 v[8:11], v[52:55], v[112:115], v[8:11]
    v_lshrrev_b32 v1, 5, v0
    v_xor_b32 v1, v1, v0
    v_mfma_f32_16x16x32_bf16 v[24:27], v[52:55], v[116:119], v[24:27]
    v_and_b32 v1, 7, v1
    v_lshl_add_u32 v1, v1, 4, s37
    v_mfma_f32_16x16x32_bf16 v[12:15], v[56:59], v[112:115], v[12:15]
    v_bfe_u32 v2, v0, 4, 1
    v_lshl_add_u32 v1, v2, 3, v1
    v_mfma_f32_16x16x32_bf16 v[28:31], v[56:59], v[116:119], v[28:31]
    v_and_b32 v2, 15, v0
    v_lshl_add_u32 v84, v2, 7, v1
    v_mfma_f32_16x16x32_bf16 v[16:19], v[60:63], v[112:115], v[16:19]
    v_xor_b32 v85, 32, v84
    v_xor_b32 v86, 64, v84
    v_mfma_f32_16x16x32_bf16 v[32:35], v[60:63], v[116:119], v[32:35]
    v_xor_b32 v87, 96, v84
    v_lshrrev_b32 v1, 3, v0
    s_waitcnt vmcnt(0) lgkmcnt(0)
    v_mfma_f32_16x16x32_bf16 v[4:7], v[64:67], v[120:123], v[4:7]
    v_xor_b32 v1, v1, v0
    v_and_b32 v1, 7, v1
    v_mfma_f32_16x16x32_bf16 v[20:23], v[64:67], v[124:127], v[20:23]
    v_and_b32 v2, 56, v0
    v_add_u32 v1, v1, v2
    v_mfma_f32_16x16x32_bf16 v[8:11], v[68:71], v[120:123], v[8:11]
    v_lshl_add_u32 v88, v1, 4, s37
    v_mfma_f32_16x16x32_bf16 v[24:27], v[68:71], v[124:127], v[24:27]
    v_mfma_f32_16x16x32_bf16 v[12:15], v[36:39], v[120:123], v[12:15]
    v_mfma_f32_16x16x32_bf16 v[28:31], v[36:39], v[124:127], v[28:31]
    v_mfma_f32_16x16x32_bf16 v[16:19], v[40:43], v[120:123], v[16:19]
    v_mfma_f32_16x16x32_bf16 v[32:35], v[40:43], v[124:127], v[32:35]
    v_cvt_pk_bf16_f32 v36, v4, v5
    v_cvt_pk_bf16_f32 v37, v6, v7
    ds_write_b64 v84, v[36:37]
    v_cvt_pk_bf16_f32 v38, v8, v9
    v_cvt_pk_bf16_f32 v39, v10, v11
    ds_write_b64 v85, v[38:39]
    v_cvt_pk_bf16_f32 v40, v12, v13
    v_cvt_pk_bf16_f32 v41, v14, v15
    ds_write_b64 v86, v[40:41]
    v_cvt_pk_bf16_f32 v42, v16, v17
    v_cvt_pk_bf16_f32 v43, v18, v19
    ds_write_b64 v87, v[42:43]
    ds_read_b128 v[52:55], v88 offset:0
    ds_read_b128 v[56:59], v88 offset:1024
    v_cvt_pk_bf16_f32 v44, v20, v21
    v_cvt_pk_bf16_f32 v45, v22, v23
    ds_write_b64 v84, v[44:45]
    v_cvt_pk_bf16_f32 v46, v24, v25
    v_cvt_pk_bf16_f32 v47, v26, v27
    ds_write_b64 v85, v[46:47]
    v_cvt_pk_bf16_f32 v48, v28, v29
    v_cvt_pk_bf16_f32 v49, v30, v31
    ds_write_b64 v86, v[48:49]
    v_cvt_pk_bf16_f32 v50, v32, v33
    v_cvt_pk_bf16_f32 v51, v34, v35
    ds_write_b64 v87, v[50:51]
    ds_read_b128 v[60:63], v88 offset:0
    ds_read_b128 v[64:67], v88 offset:1024
    s_mov_b32 s37, 0
    s_waitcnt lgkmcnt(7)
    buffer_store_dwordx4 v[52:55], v226, s[48:51], s37 offen nt
    s_mov_b32 s37, 65536
    s_waitcnt lgkmcnt(6)
    buffer_store_dwordx4 v[56:59], v226, s[48:51], s37 offen nt
    s_mov_b32 s37, 131072
    s_waitcnt lgkmcnt(1)
    buffer_store_dwordx4 v[60:63], v226, s[48:51], s37 offen nt
    s_mov_b32 s37, 196608
    s_waitcnt lgkmcnt(0)
    buffer_store_dwordx4 v[64:67], v226, s[48:51], s37 offen nt
    s_endpgm
L_g1_rare:
    s_waitcnt vmcnt(0)
    s_cmp_lg_u32 s36, 1
    s_cbranch_scc1 L_g1_bar
    v_readfirstlane_b32 s38, v1
    s_nop 0
    s_cmp_ge_u32 s38, 4
    s_cbranch_scc1 L_sl_done_56
    s_mov_b32 s39, 1048576
L_sl_loop_57:
    ds_read_b32 v1, v228 offset:24
    s_waitcnt lgkmcnt(0)
    v_readfirstlane_b32 s38, v1
    s_nop 0
    s_cmp_ge_u32 s38, 4
    s_cbranch_scc1 L_sl_done_56
    s_sleep 1
    s_sub_u32 s39, s39, 1
    s_cbranch_scc0 L_sl_loop_57
L_sl_done_56:
    s_branch L_g1_nobar
L_end:
    s_endpgm
.section .rodata,"a"
.p2align 6
.amdhsa_kernel concat_heads__ssm_conv_h3__sliding_local_dilated__prompt_kernel
  .amdhsa_next_free_vgpr 256
  .amdhsa_next_free_sgpr 102
  .amdhsa_accum_offset 256
  .amdhsa_group_segment_fixed_size 0
  .amdhsa_kernarg_size 96
  .amdhsa_user_sgpr_count 2
  .amdhsa_user_sgpr_kernarg_segment_ptr 1
  .amdhsa_system_sgpr_workgroup_id_x 1
  .amdhsa_float_denorm_mode_32 3
.end_amdhsa_kernel
```

```asm
; @launch grid=(256,1,1) block=(512,1,1) lds=163840
.amdgcn_target "amdgcn-amd-amdhsa--gfx950"
.text
.globl concat_heads__ssm_conv_h3__sliding_local_dilated__prompt_kernel
.p2align 8
.type concat_heads__ssm_conv_h3__sliding_local_dilated__prompt_kernel,@function
concat_heads__ssm_conv_h3__sliding_local_dilated__prompt_kernel:
L_entry:
    s_getpc_b64 s[32:33]
    s_cmp_ge_u32 s2, 256
    s_cbranch_scc1 L_end
    s_load_dwordx16 s[8:23], s[0:1], 0
    s_load_dwordx8 s[24:31], s[0:1], 64
    v_lshrrev_b32 v1, 6, v0
    s_and_b32 s4, s2, 1
    v_readfirstlane_b32 s3, v1
    v_and_b32 v0, 63, v0
    s_bfe_u32 s5, s2, 0x30003
    s_bfe_u32 s6, s2, 0x20001
    s_lshr_b32 s7, s2, 6
    s_lshl2_add_u32 s6, s6, s7
    s_cmp_ge_u32 s3, 4
    s_cbranch_scc1 L_crole
    s_bfe_u32 s34, s2, 0x20003
    s_lshl2_add_u32 s34, s34, s3
    s_lshl_b32 s34, s34, 7
    v_lshl_add_u32 v1, v0, 11, s34
    v_min_u32 v1, L_end-L_entry-8, v1
    s_mov_b64 exec, 0xffff
    global_load_dword v249, v1, s[32:33]
    s_mov_b64 exec, -1
    s_and_b32 s84, s2, 3
    s_lshl2_add_u32 s84, s84, s3
    s_lshr_b32 s85, s2, 2
    s_mul_i32 s86, s3, 8448
    s_add_u32 s86, s86, 125952
    s_lshl_b32 s87, s85, 9
    s_add_u32 s87, s87, s84
    s_lshl_b32 s87, s87, 7
    v_and_b32 v231, 7, v0
    v_lshl_add_u32 v231, v231, 4, s87
    v_lshrrev_b32 v230, 3, v0
    v_lshl_add_u32 v230, v230, 13, v231
    v_subrev_u32 v231, 6144, v230
    v_subrev_u32 v232, 4096, v230
    v_subrev_u32 v233, 2048, v230
    v_add_u32 v234, 4096, v230
    v_lshlrev_b32 v235, 4, v0
    s_lshl_b32 s87, s84, 9
    s_add_u32 m0, s86, 4224
    s_waitcnt lgkmcnt(0)
    s_mov_b32 s80, s14
    s_mov_b32 s81, s15
    s_mov_b32 s82, 0x2000
    s_mov_b32 s83, 0x20000
    s_mov_b32 s72, s10
    s_mov_b32 s73, s11
    s_mov_b32 s74, 0x400000
    s_mov_b32 s75, 0x20000
    s_mov_b32 exec_hi, 0
    buffer_load_dwordx4 v235, s[80:83], s87 offen lds
    s_mov_b64 exec, -1
    buffer_load_dwordx4 v[108:111], v231, s[72:75], 0 offen offset:0 nt
    buffer_load_dwordx4 v[112:115], v232, s[72:75], 0 offen offset:0 nt
    buffer_load_dwordx4 v[116:119], v233, s[72:75], 0 offen offset:0 nt
    buffer_load_dwordx4 v[120:123], v230, s[72:75], 0 offen offset:0 nt
    buffer_load_dwordx4 v[124:127], v230, s[72:75], 0 offen offset:2048 nt
    buffer_load_dwordx4 v[128:131], v234, s[72:75], 0 offen offset:0 nt
    buffer_load_dwordx4 v[132:135], v234, s[72:75], 0 offen offset:2048 nt
    s_mov_b32 s76, s12
    s_mov_b32 s77, s13
    s_mov_b32 s78, 0x400000
    s_mov_b32 s79, 0x20000
    buffer_load_dwordx4 v[136:139], v230, s[76:79], 0 offen offset:0 nt
    buffer_load_dwordx4 v[140:143], v230, s[76:79], 0 offen offset:2048 nt
    buffer_load_dwordx4 v[144:147], v234, s[76:79], 0 offen offset:0 nt
    buffer_load_dwordx4 v[148:151], v234, s[76:79], 0 offen offset:2048 nt
    s_branch L_grole
L_crole:
    s_sub_u32 s70, s3, 4
    s_lshl_b32 s43, s70, 12
    s_lshl_b32 s44, s70, 11
    s_add_u32 s44, s44, 17408
    s_lshl_b32 s49, s70, 4
    s_lshl_b64 s[46:47], 0xffff, s49
    v_lshrrev_b32 v13, 3, v0
    v_and_b32 v14, 7, v0
    v_lshrrev_b32 v15, 4, v0
    s_lshl2_add_u32 s50, s5, s70
    s_lshl_b32 s50, s50, 6
    s_add_u32 s50, s50, s4
    s_lshl_b32 s50, s50, 11
    v_lshl_add_u32 v16, v13, 12, s50
    v_xor_b32 v17, v14, v15
    v_lshl_add_u32 v2, v17, 4, v16
    v_xor_b32 v3, 64, v2
    v_add_u32 v3, 31744, v3
    v_add_u32 v4, 63488, v2
    v_add_u32 v5, 63488, v3
    s_lshl_b32 s49, s5, 7
    s_sub_u32 s49, s49, 8
    s_max_i32 s49, s49, 0
    s_lshl1_add_u32 s49, s49, s4
    s_lshl_b32 s49, s49, 11
    v_lshl_add_u32 v16, v13, 12, s49
    v_lshlrev_b32 v17, 1, v15
    v_xor_b32 v18, v14, v17
    v_lshl_add_u32 v6, v18, 4, v16
    s_mul_i32 s49, s70, 768
    s_add_u32 s49, s49, s6
    s_lshl_b32 s49, s49, 7
    v_mul_u32_u24 v16, 6144, v13
    v_and_b32 v17, 2, v17
    v_xor_b32 v17, v14, v17
    v_lshlrev_b32 v17, 4, v17
    v_add3_u32 v7, v17, v16, s49
    v_xor_b32 v8, 64, v7
    v_add_u32 v8, 48128, v8
    v_add_u32 v9, 2048, v7
    v_add_u32 v10, 2048, v8
    v_add_u32 v11, 4096, v7
    v_add_u32 v12, 4096, v8
    s_movk_i32 s40, 0
    s_mov_b32 s41, 0
    s_lshr_b32 s90, s2, 3
    s_and_b32 s91, s3, 3
    s_lshl2_add_u32 s90, s90, s91
    s_and_b32 s91, s2, 6
    s_lshl3_add_u32 s88, s90, s91
    s_lshl1_add_u32 s88, s88, s4
    s_lshl_b32 s88, s88, 11
    s_and_b32 s89, s2, 7
    s_and_b32 s91, s90, 1
    s_lshl1_add_u32 s89, s89, s91
    s_lshr_b32 s90, s90, 1
    s_mul_i32 s90, s90, 48
    s_add_u32 s89, s89, s90
    s_lshl_b32 s89, s89, 7
    v_and_b32 v251, 1, v0
    v_lshlrev_b32 v251, 12, v251
    v_lshrrev_b32 v252, 1, v0
    v_lshl_add_u32 v251, v252, 7, v251
    v_lshrrev_b32 v250, 2, v0
    v_mul_u32_u24 v250, 393216, v250
    v_and_b32 v252, 3, v0
    v_lshl_add_u32 v252, v252, 11, v250
    s_waitcnt lgkmcnt(0)
    s_mov_b32 s32, s20
    s_mov_b32 s33, s21
    s_mov_b32 s34, 0x400000
    s_mov_b32 s35, 0x20000
    s_mov_b32 s36, s22
    s_mov_b32 s37, s23
    s_mov_b32 s38, 0x600000
    s_mov_b32 s39, 0x20000
    s_setprio 0
    s_and_b32 s73, s2, 7
    s_xor_b32 s73, s73, 2
    s_lshr_b32 s74, s2, 7
    s_lshl1_add_u32 s68, s73, s74
    s_bfe_u32 s69, s2, 0x40003
    s_lshl4_add_u32 s71, s68, s69
    s_lshl2_add_u32 s71, s71, s70
    s_mul_i32 s80, s70, 8448
    s_add_u32 s80, s80, 125952
    s_mul_i32 s81, s70, 9216
    s_add_u32 s81, s81, 41984
    s_add_u32 s52, s30, 0xe00000
    s_addc_u32 s53, s31, 0
    s_mov_b32 s54, 0x20000
    s_mov_b32 s55, 0x20000
    s_add_u32 s64, s30, 0x900000
    s_addc_u32 s65, s31, 0
    s_mov_b32 s66, 0x420000
    s_mov_b32 s67, 0x20000
    s_lshl_b32 s84, s71, 12
    s_mul_i32 s85, s71, 4224
    s_add_u32 s85, s85, 4194304
    s_lshr_b32 s72, s71, 1
    s_lshl_b32 s72, s72, 2
    s_load_dword s72, s[18:19], s72
    v_lshlrev_b32 v224, 4, v0
    v_mov_b32 v228, 0
    v_mov_b32 v229, 0
    v_mov_b32 v230, 0
    v_mov_b32 v231, 0
    v_mov_b32 v227, 134352
    v_mov_b32 v244, 1
    s_bfe_u32 s87, s2, 0x10003
    s_mov_b64 exec, 1
    ds_write_b128 v227, v[228:231]
    ds_write_b128 v227, v[228:231] offset:16
    ds_write_b128 v227, v[228:231] offset:32
    s_mov_b64 exec, -1
    s_mov_b32 exec_lo, 0x7777
    s_mov_b32 exec_hi, 0x0
    s_bfe_u32 s7, s89, 0x30007
    s_cmp_lg_u32 s7, 1
    s_cbranch_scc1 L_wx3_1
    buffer_load_dword v250, v252, s[36:39], s89 offen offset:256
L_wx3_1:
    buffer_load_dword v250, v252, s[36:39], s89 offen
    s_mov_b32 exec_lo, 0xff
    s_mov_b32 exec_hi, 0
    buffer_load_dword v250, v251, s[32:35], s88 offen
    s_mov_b64 exec, -1
    s_add_u32 m0, s43, 0
    s_nop 0
    buffer_load_dwordx4 v2, s[32:35], s40 offen offset:0 lds
    s_add_u32 m0, s44, 0
    s_nop 0
    buffer_load_dwordx4 v7, s[36:39], s41 offen offset:0 lds
    buffer_load_dwordx4 v8, s[36:39], s41 offen offset:1024 lds
    s_add_u32 m0, s43, 0
    s_nop 0
    buffer_load_dwordx4 v3, s[32:35], s40 offen offset:1024 lds
    s_add_u32 m0, s44, 8192
    s_nop 0
    buffer_load_dwordx4 v9, s[36:39], s41 offen offset:0 lds
    buffer_load_dwordx4 v10, s[36:39], s41 offen offset:1024 lds
    s_add_u32 m0, s43, 0
    s_nop 0
    buffer_load_dwordx4 v4, s[32:35], s40 offen offset:2048 lds
    s_add_u32 m0, s44, 16384
    s_nop 0
    buffer_load_dwordx4 v11, s[36:39], s41 offen offset:0 lds
    buffer_load_dwordx4 v12, s[36:39], s41 offen offset:1024 lds
    s_add_u32 m0, s43, 0
    s_nop 0
    buffer_load_dwordx4 v5, s[32:35], s40 offen offset:3072 lds
    s_mov_b32 m0, 16384
    s_mov_b64 exec, s[46:47]
    buffer_load_dwordx4 v6, s[32:35], s40 offen lds
    s_mov_b64 exec, -1
    s_movk_i32 s40, 128
    s_mov_b32 s41, 393216
    s_add_u32 m0, s43, 41984
    s_nop 0
    buffer_load_dwordx4 v2, s[32:35], s40 offen offset:0 lds
    s_add_u32 m0, s44, 41984
    s_nop 0
    buffer_load_dwordx4 v7, s[36:39], s41 offen offset:0 lds
    buffer_load_dwordx4 v8, s[36:39], s41 offen offset:1024 lds
    s_add_u32 m0, s43, 41984
    s_nop 0
    buffer_load_dwordx4 v3, s[32:35], s40 offen offset:1024 lds
    s_add_u32 m0, s44, 50176
    s_nop 0
    buffer_load_dwordx4 v9, s[36:39], s41 offen offset:0 lds
    buffer_load_dwordx4 v10, s[36:39], s41 offen offset:1024 lds
    s_add_u32 m0, s43, 41984
    s_nop 0
    buffer_load_dwordx4 v4, s[32:35], s40 offen offset:2048 lds
    s_add_u32 m0, s44, 58368
    s_nop 0
    buffer_load_dwordx4 v11, s[36:39], s41 offen offset:0 lds
    buffer_load_dwordx4 v12, s[36:39], s41 offen offset:1024 lds
    s_add_u32 m0, s43, 41984
    s_nop 0
    buffer_load_dwordx4 v5, s[32:35], s40 offen offset:3072 lds
    s_mov_b32 m0, 58368
    s_mov_b64 exec, s[46:47]
    buffer_load_dwordx4 v6, s[32:35], s40 offen lds
    s_mov_b64 exec, -1
    s_movk_i32 s40, 256
    s_mov_b32 s41, 786432
    s_lshr_b32 s74, s69, 2
    s_and_b32 s75, s69, 3
    s_lshl3_add_u32 s74, s74, s75
    s_lshl3_add_u32 s74, s74, s70
    s_lshl_b32 s74, s74, 3
    v_bfe_u32 v234, v0, 3, 1
    v_lshl_add_u32 v225, v234, 8, s74
    v_bfe_u32 v234, v0, 4, 1
    v_lshl_add_u32 v225, v234, 1, v225
    v_lshrrev_b32 v234, 5, v0
    v_lshl_add_u32 v225, v234, 5, v225
    s_lshl_b32 s74, s68, 7
    v_and_b32 v234, 7, v0
    v_lshl_add_u32 v234, v234, 4, s74
    v_lshl_add_u32 v226, v225, 12, v234
    v_lshl_add_u32 v225, v225, 11, v234
    v_and_b32 v234, 1, v0
    v_xor_b32 v234, 1, v234
    v_mul_u32_u24 v232, 4224, v234
    v_mul_u32_u24 v233, 4576, v234
    v_bfe_u32 v234, v0, 1, 3
    v_lshl_add_u32 v232, v234, 3, v232
    v_xor_b32 v234, 7, v234
    v_lshl_add_u32 v233, v234, 6, v233
    v_lshrrev_b32 v234, 4, v0
    v_lshl_add_u32 v232, v234, 4, v232
    v_lshl_add_u32 v233, v234, 4, v233
    v_add3_u32 v232, v232, s80, 8
    v_add_u32 v233, s81, v233
    s_waitcnt lgkmcnt(0)
    s_bitcmp1_b32 s71, 0
    s_cselect_b32 s74, 0, 16
    s_lshl_b32 s72, s72, s74
    s_and_b32 s72, s72, 0xffff0000
    v_and_b32 v235, 1, v0
    v_lshlrev_b32 v235, 4, v235
    v_lshrrev_b32 v235, v235, s72
    v_bfe_u32 v236, v0, 1, 3
    v_lshl_add_u32 v236, v234, 1, v236
    v_cmp_eq_u32 vcc, 7, v236
    v_mov_b32 v241, 0
    v_mov_b32 v243, 0
    v_cndmask_b32 v240, 0, v235, vcc
    v_cmp_eq_u32 vcc, 6, v236
    s_nop 1
    v_cndmask_b32 v242, 0, v235, vcc
    s_waitcnt vmcnt(11)
    s_barrier
    s_add_u32 m0, s43, 83968
    s_nop 0
    buffer_load_dwordx4 v2, s[32:35], s40 offen offset:0 lds
    s_add_u32 m0, s44, 83968
    s_nop 0
    buffer_load_dwordx4 v7, s[36:39], s41 offen offset:0 lds
    buffer_load_dwordx4 v8, s[36:39], s41 offen offset:1024 lds
    s_add_u32 m0, s43, 83968
    s_nop 0
    buffer_load_dwordx4 v3, s[32:35], s40 offen offset:1024 lds
    s_add_u32 m0, s44, 92160
    s_nop 0
    buffer_load_dwordx4 v9, s[36:39], s41 offen offset:0 lds
    buffer_load_dwordx4 v10, s[36:39], s41 offen offset:1024 lds
    s_add_u32 m0, s43, 83968
    s_nop 0
    buffer_load_dwordx4 v4, s[32:35], s40 offen offset:2048 lds
    s_add_u32 m0, s44, 100352
    s_nop 0
    buffer_load_dwordx4 v11, s[36:39], s41 offen offset:0 lds
    buffer_load_dwordx4 v12, s[36:39], s41 offen offset:1024 lds
    s_add_u32 m0, s43, 83968
    s_nop 0
    buffer_load_dwordx4 v5, s[32:35], s40 offen offset:3072 lds
    s_mov_b32 m0, 100352
    s_mov_b64 exec, s[46:47]
    buffer_load_dwordx4 v6, s[32:35], s40 offen lds
    s_mov_b64 exec, -1
    s_movk_i32 s40, 384
    s_mov_b32 s41, 1179648
    s_waitcnt vmcnt(11)
    s_barrier
    s_add_u32 m0, s43, 0
    s_nop 0
    buffer_load_dwordx4 v2, s[32:35], s40 offen offset:0 lds
    s_add_u32 m0, s44, 0
    s_nop 0
    buffer_load_dwordx4 v7, s[36:39], s41 offen offset:0 lds
    buffer_load_dwordx4 v8, s[36:39], s41 offen offset:1024 lds
    s_add_u32 m0, s43, 0
    s_nop 0
    buffer_load_dwordx4 v3, s[32:35], s40 offen offset:1024 lds
    s_add_u32 m0, s44, 8192
    s_nop 0
    buffer_load_dwordx4 v9, s[36:39], s41 offen offset:0 lds
    buffer_load_dwordx4 v10, s[36:39], s41 offen offset:1024 lds
    s_add_u32 m0, s43, 0
    s_nop 0
    buffer_load_dwordx4 v4, s[32:35], s40 offen offset:2048 lds
    s_add_u32 m0, s44, 16384
    s_nop 0
    buffer_load_dwordx4 v11, s[36:39], s41 offen offset:0 lds
    buffer_load_dwordx4 v12, s[36:39], s41 offen offset:1024 lds
    s_add_u32 m0, s43, 0
    s_nop 0
    buffer_load_dwordx4 v5, s[32:35], s40 offen offset:3072 lds
    s_mov_b32 m0, 16384
    s_mov_b64 exec, s[46:47]
    buffer_load_dwordx4 v6, s[32:35], s40 offen lds
    s_mov_b64 exec, -1
    s_movk_i32 s40, 512
    s_mov_b32 s41, 1572864
    s_mov_b32 exec_lo, 0x77770000
    s_mov_b32 exec_hi, 0x0
    s_bfe_u32 s7, s89, 0x30007
    s_cmp_lg_u32 s7, 1
    s_cbranch_scc1 L_wx3_4
    buffer_load_dword v250, v252, s[36:39], s89 offen offset:256
L_wx3_4:
    buffer_load_dword v250, v252, s[36:39], s89 offen
    s_mov_b32 exec_lo, 0xff00
    s_mov_b32 exec_hi, 0
    buffer_load_dword v250, v251, s[32:35], s88 offen
    s_mov_b64 exec, -1
    s_waitcnt vmcnt(13)
    s_barrier
    s_add_u32 m0, s43, 41984
    s_nop 0
    buffer_load_dwordx4 v2, s[32:35], s40 offen offset:0 lds
    s_add_u32 m0, s44, 41984
    s_nop 0
    buffer_load_dwordx4 v7, s[36:39], s41 offen offset:0 lds
    buffer_load_dwordx4 v8, s[36:39], s41 offen offset:1024 lds
    s_add_u32 m0, s43, 41984
    s_nop 0
    buffer_load_dwordx4 v3, s[32:35], s40 offen offset:1024 lds
    s_add_u32 m0, s44, 50176
    s_nop 0
    buffer_load_dwordx4 v9, s[36:39], s41 offen offset:0 lds
    buffer_load_dwordx4 v10, s[36:39], s41 offen offset:1024 lds
    s_add_u32 m0, s43, 41984
    s_nop 0
    buffer_load_dwordx4 v4, s[32:35], s40 offen offset:2048 lds
    s_add_u32 m0, s44, 58368
    s_nop 0
    buffer_load_dwordx4 v11, s[36:39], s41 offen offset:0 lds
    buffer_load_dwordx4 v12, s[36:39], s41 offen offset:1024 lds
    s_add_u32 m0, s43, 41984
    s_nop 0
    buffer_load_dwordx4 v5, s[32:35], s40 offen offset:3072 lds
    s_mov_b32 m0, 58368
    s_mov_b64 exec, s[46:47]
    buffer_load_dwordx4 v6, s[32:35], s40 offen lds
    s_mov_b64 exec, -1
    s_movk_i32 s40, 640
    s_mov_b32 s41, 1966080
    s_waitcnt vmcnt(13)
    s_barrier
    s_add_u32 m0, s43, 83968
    s_nop 0
    buffer_load_dwordx4 v2, s[32:35], s40 offen offset:0 lds
    s_add_u32 m0, s44, 83968
    s_nop 0
    buffer_load_dwordx4 v7, s[36:39], s41 offen offset:0 lds
    buffer_load_dwordx4 v8, s[36:39], s41 offen offset:1024 lds
    s_add_u32 m0, s43, 83968
    s_nop 0
    buffer_load_dwordx4 v3, s[32:35], s40 offen offset:1024 lds
    s_add_u32 m0, s44, 92160
    s_nop 0
    buffer_load_dwordx4 v9, s[36:39], s41 offen offset:0 lds
    buffer_load_dwordx4 v10, s[36:39], s41 offen offset:1024 lds
    s_add_u32 m0, s43, 83968
    s_nop 0
    buffer_load_dwordx4 v4, s[32:35], s40 offen offset:2048 lds
    s_add_u32 m0, s44, 100352
    s_nop 0
    buffer_load_dwordx4 v11, s[36:39], s41 offen offset:0 lds
    buffer_load_dwordx4 v12, s[36:39], s41 offen offset:1024 lds
    s_add_u32 m0, s43, 83968
    s_nop 0
    buffer_load_dwordx4 v5, s[32:35], s40 offen offset:3072 lds
    s_mov_b32 m0, 100352
    s_mov_b64 exec, s[46:47]
    buffer_load_dwordx4 v6, s[32:35], s40 offen lds
    s_mov_b64 exec, -1
    s_movk_i32 s40, 768
    s_mov_b32 s41, 2359296
    s_cmp_lg_u32 s87, 0
    s_cbranch_scc1 L_stg_7
    s_mov_b32 exec_lo, 0x0
    s_mov_b32 exec_hi, 0x7777
    s_bfe_u32 s7, s89, 0x30007
    s_cmp_lg_u32 s7, 1
    s_cbranch_scc1 L_wx3_8
    buffer_load_dword v250, v252, s[36:39], s89 offen offset:256
L_wx3_8:
    buffer_load_dword v250, v252, s[36:39], s89 offen
    s_mov_b32 exec_lo, 0xff0000
    s_mov_b32 exec_hi, 0
    buffer_load_dword v250, v251, s[32:35], s88 offen
    s_mov_b64 exec, -1
L_stg_7:
    s_waitcnt vmcnt(13)
    s_bitcmp1_b32 1, s87
    s_cbranch_scc1 L_mw_9
    s_waitcnt vmcnt(11)
L_mw_9:
    s_barrier
    s_add_u32 m0, s43, 0
    s_nop 0
    buffer_load_dwordx4 v2, s[32:35], s40 offen offset:0 lds
    s_add_u32 m0, s44, 0
    s_nop 0
    buffer_load_dwordx4 v7, s[36:39], s41 offen offset:0 lds
    buffer_load_dwordx4 v8, s[36:39], s41 offen offset:1024 lds
    s_add_u32 m0, s43, 0
    s_nop 0
    buffer_load_dwordx4 v3, s[32:35], s40 offen offset:1024 lds
    s_add_u32 m0, s44, 8192
    s_nop 0
    buffer_load_dwordx4 v9, s[36:39], s41 offen offset:0 lds
    buffer_load_dwordx4 v10, s[36:39], s41 offen offset:1024 lds
    s_add_u32 m0, s43, 0
    s_nop 0
    buffer_load_dwordx4 v4, s[32:35], s40 offen offset:2048 lds
    s_add_u32 m0, s44, 16384
    s_nop 0
    buffer_load_dwordx4 v11, s[36:39], s41 offen offset:0 lds
    buffer_load_dwordx4 v12, s[36:39], s41 offen offset:1024 lds
    s_add_u32 m0, s43, 0
    s_nop 0
    buffer_load_dwordx4 v5, s[32:35], s40 offen offset:3072 lds
    s_mov_b32 m0, 16384
    s_mov_b64 exec, s[46:47]
    buffer_load_dwordx4 v6, s[32:35], s40 offen lds
    s_mov_b64 exec, -1
    s_movk_i32 s40, 896
    s_mov_b32 s41, 2752512
    s_cmp_lg_u32 s87, 1
    s_cbranch_scc1 L_stg_10
    s_mov_b32 exec_lo, 0x0
    s_mov_b32 exec_hi, 0x7777
    s_bfe_u32 s7, s89, 0x30007
    s_cmp_lg_u32 s7, 1
    s_cbranch_scc1 L_wx3_11
    buffer_load_dword v250, v252, s[36:39], s89 offen offset:256
L_wx3_11:
    buffer_load_dword v250, v252, s[36:39], s89 offen
    s_mov_b32 exec_lo, 0xff0000
    s_mov_b32 exec_hi, 0
    buffer_load_dword v250, v251, s[32:35], s88 offen
    s_mov_b64 exec, -1
L_stg_10:
    s_bfe_u32 s74, s2, 0x20003
    s_lshl2_add_u32 s74, s74, s70
    s_cmp_lg_u32 s74, 0
    s_cbranch_scc1 L_sig_12
    s_mov_b32 s60, s28
    s_mov_b32 s61, s29
    s_mov_b32 s62, 0x100
    s_mov_b32 s63, 0x20000
    s_and_b32 s74, s2, 3
    s_lshl_b32 s74, s74, 6
    s_mov_b64 exec, 1
    buffer_atomic_add v244, off, s[60:63], s74 sc1
    s_mov_b64 exec, -1
L_sig_12:
    s_load_dwordx2 s[90:91], s[16:17], s84 offset:60
    s_load_dwordx2 s[90:91], s[16:17], s84 offset:188
    s_load_dwordx2 s[90:91], s[16:17], s84 offset:316
    s_load_dwordx2 s[90:91], s[16:17], s84 offset:444
    s_waitcnt vmcnt(13)
    s_barrier
    s_add_u32 m0, s43, 41984
    s_nop 0
    buffer_load_dwordx4 v2, s[32:35], s40 offen offset:0 lds
    s_add_u32 m0, s44, 41984
    s_nop 0
    buffer_load_dwordx4 v7, s[36:39], s41 offen offset:0 lds
    buffer_load_dwordx4 v8, s[36:39], s41 offen offset:1024 lds
    s_add_u32 m0, s43, 41984
    s_nop 0
    buffer_load_dwordx4 v3, s[32:35], s40 offen offset:1024 lds
    s_add_u32 m0, s44, 50176
    s_nop 0
    buffer_load_dwordx4 v9, s[36:39], s41 offen offset:0 lds
    buffer_load_dwordx4 v10, s[36:39], s41 offen offset:1024 lds
    s_add_u32 m0, s43, 41984
    s_nop 0
    buffer_load_dwordx4 v4, s[32:35], s40 offen offset:2048 lds
    s_add_u32 m0, s44, 58368
    s_nop 0
    buffer_load_dwordx4 v11, s[36:39], s41 offen offset:0 lds
    buffer_load_dwordx4 v12, s[36:39], s41 offen offset:1024 lds
    s_add_u32 m0, s43, 41984
    s_nop 0
    buffer_load_dwordx4 v5, s[32:35], s40 offen offset:3072 lds
    s_mov_b32 m0, 58368
    s_mov_b64 exec, s[46:47]
    buffer_load_dwordx4 v6, s[32:35], s40 offen lds
    s_mov_b64 exec, -1
    s_movk_i32 s40, 1024
    s_mov_b32 s41, 3145728
    s_bfe_u32 s74, s2, 0x20003
    s_lshl2_add_u32 s74, s74, s70
    s_cmp_lg_u32 s74, 4
    s_cbranch_scc1 L_sig_14
    s_mov_b32 s60, s28
    s_mov_b32 s61, s29
    s_mov_b32 s62, 0x100
    s_mov_b32 s63, 0x20000
    s_and_b32 s74, s2, 3
    s_lshl_b32 s74, s74, 6
    s_mov_b64 exec, 1
    buffer_atomic_add v244, off, s[60:63], s74 sc1
    s_mov_b64 exec, -1
L_sig_14:
    s_load_dwordx2 s[90:91], s[16:17], s84 offset:572
    s_load_dwordx2 s[90:91], s[16:17], s84 offset:700
    s_load_dwordx2 s[90:91], s[16:17], s84 offset:828
    s_load_dwordx2 s[90:91], s[16:17], s84 offset:956
    s_waitcnt vmcnt(13)
    s_bitcmp1_b32 2, s87
    s_cbranch_scc1 L_mw_15
    s_waitcnt vmcnt(11)
L_mw_15:
    s_barrier
    s_add_u32 m0, s43, 83968
    s_nop 0
    buffer_load_dwordx4 v2, s[32:35], s40 offen offset:0 lds
    s_add_u32 m0, s44, 83968
    s_nop 0
    buffer_load_dwordx4 v7, s[36:39], s41 offen offset:0 lds
    buffer_load_dwordx4 v8, s[36:39], s41 offen offset:1024 lds
    s_add_u32 m0, s43, 83968
    s_nop 0
    buffer_load_dwordx4 v3, s[32:35], s40 offen offset:1024 lds
    s_add_u32 m0, s44, 92160
    s_nop 0
    buffer_load_dwordx4 v9, s[36:39], s41 offen offset:0 lds
    buffer_load_dwordx4 v10, s[36:39], s41 offen offset:1024 lds
    s_add_u32 m0, s43, 83968
    s_nop 0
    buffer_load_dwordx4 v4, s[32:35], s40 offen offset:2048 lds
    s_add_u32 m0, s44, 100352
    s_nop 0
    buffer_load_dwordx4 v11, s[36:39], s41 offen offset:0 lds
    buffer_load_dwordx4 v12, s[36:39], s41 offen offset:1024 lds
    s_add_u32 m0, s43, 83968
    s_nop 0
    buffer_load_dwordx4 v5, s[32:35], s40 offen offset:3072 lds
    s_mov_b32 m0, 100352
    s_mov_b64 exec, s[46:47]
    buffer_load_dwordx4 v6, s[32:35], s40 offen lds
    s_mov_b64 exec, -1
    s_movk_i32 s40, 1152
    s_mov_b32 s41, 3538944
    s_bfe_u32 s74, s2, 0x20003
    s_lshl2_add_u32 s74, s74, s70
    s_cmp_lg_u32 s74, 8
    s_cbranch_scc1 L_sig_16
    s_mov_b32 s60, s28
    s_mov_b32 s61, s29
    s_mov_b32 s62, 0x100
    s_mov_b32 s63, 0x20000
    s_and_b32 s74, s2, 3
    s_lshl_b32 s74, s74, 6
    s_mov_b64 exec, 1
    buffer_atomic_add v244, off, s[60:63], s74 sc1
    s_mov_b64 exec, -1
L_sig_16:
    s_load_dwordx2 s[90:91], s[16:17], s84 offset:1084
    s_load_dwordx2 s[90:91], s[16:17], s84 offset:1212
    s_load_dwordx2 s[90:91], s[16:17], s84 offset:1340
    s_load_dwordx2 s[90:91], s[16:17], s84 offset:1468
    s_waitcnt vmcnt(11)
    s_barrier
    s_add_u32 m0, s43, 0
    s_nop 0
    buffer_load_dwordx4 v2, s[32:35], s40 offen offset:0 lds
    s_add_u32 m0, s44, 0
    s_nop 0
    buffer_load_dwordx4 v7, s[36:39], s41 offen offset:0 lds
    buffer_load_dwordx4 v8, s[36:39], s41 offen offset:1024 lds
    s_add_u32 m0, s43, 0
    s_nop 0
    buffer_load_dwordx4 v3, s[32:35], s40 offen offset:1024 lds
    s_add_u32 m0, s44, 8192
    s_nop 0
    buffer_load_dwordx4 v9, s[36:39], s41 offen offset:0 lds
    buffer_load_dwordx4 v10, s[36:39], s41 offen offset:1024 lds
    s_add_u32 m0, s43, 0
    s_nop 0
    buffer_load_dwordx4 v4, s[32:35], s40 offen offset:2048 lds
    s_add_u32 m0, s44, 16384
    s_nop 0
    buffer_load_dwordx4 v11, s[36:39], s41 offen offset:0 lds
    buffer_load_dwordx4 v12, s[36:39], s41 offen offset:1024 lds
    s_add_u32 m0, s43, 0
    s_nop 0
    buffer_load_dwordx4 v5, s[32:35], s40 offen offset:3072 lds
    s_mov_b32 m0, 16384
    s_mov_b64 exec, s[46:47]
    buffer_load_dwordx4 v6, s[32:35], s40 offen lds
    s_mov_b64 exec, -1
    s_movk_i32 s40, 1280
    s_mov_b32 s41, 3932160
    s_cmp_lg_u32 s87, 0
    s_cbranch_scc1 L_stg_18
    s_mov_b32 exec_lo, 0x0
    s_mov_b32 exec_hi, 0x77770000
    s_bfe_u32 s7, s89, 0x30007
    s_cmp_lg_u32 s7, 1
    s_cbranch_scc1 L_wx3_19
    buffer_load_dword v250, v252, s[36:39], s89 offen offset:256
L_wx3_19:
    buffer_load_dword v250, v252, s[36:39], s89 offen
    s_mov_b32 exec_lo, 0xff000000
    s_mov_b32 exec_hi, 0
    buffer_load_dword v250, v251, s[32:35], s88 offen
    s_mov_b64 exec, -1
L_stg_18:
    s_bfe_u32 s74, s2, 0x20003
    s_lshl2_add_u32 s74, s74, s70
    s_cmp_lg_u32 s74, 12
    s_cbranch_scc1 L_sig_20
    s_mov_b32 s60, s28
    s_mov_b32 s61, s29
    s_mov_b32 s62, 0x100
    s_mov_b32 s63, 0x20000
    s_and_b32 s74, s2, 3
    s_lshl_b32 s74, s74, 6
    s_mov_b64 exec, 1
    buffer_atomic_add v244, off, s[60:63], s74 sc1
    s_mov_b64 exec, -1
L_sig_20:
    s_load_dwordx2 s[90:91], s[16:17], s84 offset:1596
    s_load_dwordx2 s[90:91], s[16:17], s84 offset:1724
    s_load_dwordx2 s[90:91], s[16:17], s84 offset:1852
    s_load_dwordx2 s[90:91], s[16:17], s84 offset:1980
    s_waitcnt vmcnt(13)
    s_bitcmp1_b32 1, s87
    s_cbranch_scc1 L_mw_21
    s_waitcnt vmcnt(11)
L_mw_21:
    s_barrier
    s_add_u32 m0, s43, 41984
    s_nop 0
    buffer_load_dwordx4 v2, s[32:35], s40 offen offset:0 lds
    s_add_u32 m0, s44, 41984
    s_nop 0
    buffer_load_dwordx4 v7, s[36:39], s41 offen offset:0 lds
    buffer_load_dwordx4 v8, s[36:39], s41 offen offset:1024 lds
    s_add_u32 m0, s43, 41984
    s_nop 0
    buffer_load_dwordx4 v3, s[32:35], s40 offen offset:1024 lds
    s_add_u32 m0, s44, 50176
    s_nop 0
    buffer_load_dwordx4 v9, s[36:39], s41 offen offset:0 lds
    buffer_load_dwordx4 v10, s[36:39], s41 offen offset:1024 lds
    s_add_u32 m0, s43, 41984
    s_nop 0
    buffer_load_dwordx4 v4, s[32:35], s40 offen offset:2048 lds
    s_add_u32 m0, s44, 58368
    s_nop 0
    buffer_load_dwordx4 v11, s[36:39], s41 offen offset:0 lds
    buffer_load_dwordx4 v12, s[36:39], s41 offen offset:1024 lds
    s_add_u32 m0, s43, 41984
    s_nop 0
    buffer_load_dwordx4 v5, s[32:35], s40 offen offset:3072 lds
    s_mov_b32 m0, 58368
    s_mov_b64 exec, s[46:47]
    buffer_load_dwordx4 v6, s[32:35], s40 offen lds
    s_mov_b64 exec, -1
    s_movk_i32 s40, 1408
    s_mov_b32 s41, 4325376
    s_cmp_lg_u32 s87, 1
    s_cbranch_scc1 L_stg_22
    s_mov_b32 exec_lo, 0x0
    s_mov_b32 exec_hi, 0x77770000
    s_bfe_u32 s7, s89, 0x30007
    s_cmp_lg_u32 s7, 1
    s_cbranch_scc1 L_wx3_23
    buffer_load_dword v250, v252, s[36:39], s89 offen offset:256
L_wx3_23:
    buffer_load_dword v250, v252, s[36:39], s89 offen
    s_mov_b32 exec_lo, 0xff000000
    s_mov_b32 exec_hi, 0
    buffer_load_dword v250, v251, s[32:35], s88 offen
    s_mov_b64 exec, -1
L_stg_22:
    s_load_dwordx2 s[90:91], s[16:17], s84 offset:2108
    s_load_dwordx2 s[90:91], s[16:17], s84 offset:2236
    s_load_dwordx2 s[90:91], s[16:17], s84 offset:2364
    s_load_dwordx2 s[90:91], s[16:17], s84 offset:2492
    s_waitcnt vmcnt(13)
    s_barrier
    s_add_u32 m0, s43, 83968
    s_nop 0
    buffer_load_dwordx4 v2, s[32:35], s40 offen offset:0 lds
    s_add_u32 m0, s44, 83968
    s_nop 0
    buffer_load_dwordx4 v7, s[36:39], s41 offen offset:0 lds
    buffer_load_dwordx4 v8, s[36:39], s41 offen offset:1024 lds
    s_add_u32 m0, s43, 83968
    s_nop 0
    buffer_load_dwordx4 v3, s[32:35], s40 offen offset:1024 lds
    s_add_u32 m0, s44, 92160
    s_nop 0
    buffer_load_dwordx4 v9, s[36:39], s41 offen offset:0 lds
    buffer_load_dwordx4 v10, s[36:39], s41 offen offset:1024 lds
    s_add_u32 m0, s43, 83968
    s_nop 0
    buffer_load_dwordx4 v4, s[32:35], s40 offen offset:2048 lds
    s_add_u32 m0, s44, 100352
    s_nop 0
    buffer_load_dwordx4 v11, s[36:39], s41 offen offset:0 lds
    buffer_load_dwordx4 v12, s[36:39], s41 offen offset:1024 lds
    s_add_u32 m0, s43, 83968
    s_nop 0
    buffer_load_dwordx4 v5, s[32:35], s40 offen offset:3072 lds
    s_mov_b32 m0, 100352
    s_mov_b64 exec, s[46:47]
    buffer_load_dwordx4 v6, s[32:35], s40 offen lds
    s_mov_b64 exec, -1
    s_movk_i32 s40, 1536
    s_mov_b32 s41, 4718592
    s_load_dwordx2 s[90:91], s[16:17], s84 offset:2620
    s_load_dwordx2 s[90:91], s[16:17], s84 offset:2748
    s_load_dwordx2 s[90:91], s[16:17], s84 offset:2876
    s_load_dwordx2 s[90:91], s[16:17], s84 offset:3004
    s_waitcnt vmcnt(13)
    s_bitcmp1_b32 2, s87
    s_cbranch_scc1 L_mw_25
    s_waitcnt vmcnt(11)
L_mw_25:
    s_barrier
    s_add_u32 m0, s43, 0
    s_nop 0
    buffer_load_dwordx4 v2, s[32:35], s40 offen offset:0 lds
    s_add_u32 m0, s44, 0
    s_nop 0
    buffer_load_dwordx4 v7, s[36:39], s41 offen offset:0 lds
    buffer_load_dwordx4 v8, s[36:39], s41 offen offset:1024 lds
    s_add_u32 m0, s43, 0
    s_nop 0
    buffer_load_dwordx4 v3, s[32:35], s40 offen offset:1024 lds
    s_add_u32 m0, s44, 8192
    s_nop 0
    buffer_load_dwordx4 v9, s[36:39], s41 offen offset:0 lds
    buffer_load_dwordx4 v10, s[36:39], s41 offen offset:1024 lds
    s_add_u32 m0, s43, 0
    s_nop 0
    buffer_load_dwordx4 v4, s[32:35], s40 offen offset:2048 lds
    s_add_u32 m0, s44, 16384
    s_nop 0
    buffer_load_dwordx4 v11, s[36:39], s41 offen offset:0 lds
    buffer_load_dwordx4 v12, s[36:39], s41 offen offset:1024 lds
    s_add_u32 m0, s43, 0
    s_nop 0
    buffer_load_dwordx4 v5, s[32:35], s40 offen offset:3072 lds
    s_mov_b32 m0, 16384
    s_mov_b64 exec, s[46:47]
    buffer_load_dwordx4 v6, s[32:35], s40 offen lds
    s_mov_b64 exec, -1
    s_movk_i32 s40, 1664
    s_mov_b32 s41, 5111808
    s_load_dwordx2 s[90:91], s[16:17], s84 offset:3132
    s_load_dwordx2 s[90:91], s[16:17], s84 offset:3260
    s_load_dwordx2 s[90:91], s[16:17], s84 offset:3388
    s_load_dwordx2 s[90:91], s[16:17], s84 offset:3516
    s_waitcnt vmcnt(11)
    s_barrier
    s_add_u32 m0, s43, 41984
    s_nop 0
    buffer_load_dwordx4 v2, s[32:35], s40 offen offset:0 lds
    s_add_u32 m0, s44, 41984
    s_nop 0
    buffer_load_dwordx4 v7, s[36:39], s41 offen offset:0 lds
    buffer_load_dwordx4 v8, s[36:39], s41 offen offset:1024 lds
    s_add_u32 m0, s43, 41984
    s_nop 0
    buffer_load_dwordx4 v3, s[32:35], s40 offen offset:1024 lds
    s_add_u32 m0, s44, 50176
    s_nop 0
    buffer_load_dwordx4 v9, s[36:39], s41 offen offset:0 lds
    buffer_load_dwordx4 v10, s[36:39], s41 offen offset:1024 lds
    s_add_u32 m0, s43, 41984
    s_nop 0
    buffer_load_dwordx4 v4, s[32:35], s40 offen offset:2048 lds
    s_add_u32 m0, s44, 58368
    s_nop 0
    buffer_load_dwordx4 v11, s[36:39], s41 offen offset:0 lds
    buffer_load_dwordx4 v12, s[36:39], s41 offen offset:1024 lds
    s_add_u32 m0, s43, 41984
    s_nop 0
    buffer_load_dwordx4 v5, s[32:35], s40 offen offset:3072 lds
    s_mov_b32 m0, 58368
    s_mov_b64 exec, s[46:47]
    buffer_load_dwordx4 v6, s[32:35], s40 offen lds
    s_mov_b64 exec, -1
    s_movk_i32 s40, 1792
    s_mov_b32 s41, 5505024
    s_load_dwordx2 s[90:91], s[16:17], s84 offset:3644
    s_load_dwordx2 s[90:91], s[16:17], s84 offset:3772
    s_load_dwordx2 s[90:91], s[16:17], s84 offset:3900
    s_load_dwordx2 s[90:91], s[16:17], s84 offset:4028
    s_waitcnt vmcnt(11)
    s_barrier
    s_add_u32 m0, s43, 83968
    s_nop 0
    buffer_load_dwordx4 v2, s[32:35], s40 offen offset:0 lds
    s_add_u32 m0, s44, 83968
    s_nop 0
    buffer_load_dwordx4 v7, s[36:39], s41 offen offset:0 lds
    buffer_load_dwordx4 v8, s[36:39], s41 offen offset:1024 lds
    s_add_u32 m0, s43, 83968
    s_nop 0
    buffer_load_dwordx4 v3, s[32:35], s40 offen offset:1024 lds
    s_add_u32 m0, s44, 92160
    s_nop 0
    buffer_load_dwordx4 v9, s[36:39], s41 offen offset:0 lds
    buffer_load_dwordx4 v10, s[36:39], s41 offen offset:1024 lds
    s_add_u32 m0, s43, 83968
    s_nop 0
    buffer_load_dwordx4 v4, s[32:35], s40 offen offset:2048 lds
    s_add_u32 m0, s44, 100352
    s_nop 0
    buffer_load_dwordx4 v11, s[36:39], s41 offen offset:0 lds
    buffer_load_dwordx4 v12, s[36:39], s41 offen offset:1024 lds
    s_add_u32 m0, s43, 83968
    s_nop 0
    buffer_load_dwordx4 v5, s[32:35], s40 offen offset:3072 lds
    s_mov_b32 m0, 100352
    s_mov_b64 exec, s[46:47]
    buffer_load_dwordx4 v6, s[32:35], s40 offen lds
    s_mov_b64 exec, -1
    s_movk_i32 s40, 1920
    s_mov_b32 s41, 5898240
    s_waitcnt vmcnt(11)
    s_barrier
    s_load_dword s4, s[28:29], 0
    s_load_dword s5, s[28:29], 64
    s_load_dword s6, s[28:29], 128
    s_load_dword s7, s[28:29], 192
    s_add_u32 m0, s43, 0
    s_nop 0
    buffer_load_dwordx4 v2, s[32:35], s40 offen offset:0 lds
    s_add_u32 m0, s44, 0
    s_nop 0
    buffer_load_dwordx4 v7, s[36:39], s41 offen offset:0 lds
    buffer_load_dwordx4 v8, s[36:39], s41 offen offset:1024 lds
    s_add_u32 m0, s43, 0
    s_nop 0
    buffer_load_dwordx4 v3, s[32:35], s40 offen offset:1024 lds
    s_add_u32 m0, s44, 8192
    s_nop 0
    buffer_load_dwordx4 v9, s[36:39], s41 offen offset:0 lds
    buffer_load_dwordx4 v10, s[36:39], s41 offen offset:1024 lds
    s_add_u32 m0, s43, 0
    s_nop 0
    buffer_load_dwordx4 v4, s[32:35], s40 offen offset:2048 lds
    s_add_u32 m0, s44, 16384
    s_nop 0
    buffer_load_dwordx4 v11, s[36:39], s41 offen offset:0 lds
    buffer_load_dwordx4 v12, s[36:39], s41 offen offset:1024 lds
    s_add_u32 m0, s43, 0
    s_nop 0
    buffer_load_dwordx4 v5, s[32:35], s40 offen offset:3072 lds
    s_mov_b32 m0, 16384
    s_mov_b64 exec, s[46:47]
    buffer_load_dwordx4 v6, s[32:35], s40 offen lds
    s_mov_b64 exec, -1
    s_movk_i32 s40, 2048
    s_mov_b32 s41, 6291456
    s_mov_b32 s60, s8
    s_mov_b32 s61, s9
    s_mov_b32 s62, 0x400000
    s_mov_b32 s63, 0x20000
    s_movk_i32 s75, 8192
    buffer_load_dwordx4 v[208:211], v225, s[60:63], 0 offen offset:0 nt
    buffer_load_dwordx4 v[212:215], v225, s[60:63], 0 offen offset:2048 nt
    buffer_load_dwordx4 v[216:219], v225, s[60:63], s75 offen offset:0 nt
    buffer_load_dwordx4 v[220:223], v225, s[60:63], s75 offen offset:2048 nt
    s_cmp_lg_u32 s70, 0
    s_cbranch_scc1 L_pc_done_29
    s_waitcnt lgkmcnt(0)
    s_min_u32 s4, s4, s5
    s_min_u32 s6, s6, s7
    s_min_u32 s4, s4, s6
    s_cmp_ge_u32 s4, 64
    s_cbranch_scc1 L_pc_done_29
    s_mov_b32 s60, s28
    s_mov_b32 s61, s29
    s_mov_b32 s62, 0x100
    s_mov_b32 s63, 0x20000
    v_lshlrev_b32 v20, 6, v0
    s_mov_b32 s74, 131072
    s_mov_b64 exec, 0xf
L_pc_loop_30:
    buffer_load_dword v21, v20, s[60:63], 0 offen sc1
    s_waitcnt vmcnt(0)
    v_cmp_gt_u32 vcc, 64, v21
    s_cbranch_vccz L_pc_done_29
    s_sleep 4
    s_sub_u32 s74, s74, 1
    s_cbranch_scc0 L_pc_loop_30
L_pc_done_29:
    s_mov_b64 exec, -1
    s_waitcnt vmcnt(15)
    s_barrier
    s_waitcnt vmcnt(4)
    s_mov_b64 exec, 1
    ds_add_u32 v227, v244 offset:24
    s_mov_b64 exec, -1
    s_add_u32 s56, s30, s85
    s_addc_u32 s57, s31, 0
    s_movk_i32 s58, 4096
    s_mov_b32 s59, 0x20000
    s_add_u32 m0, s81, 0
    s_nop 0
    buffer_load_dwordx4 v224, s[56:59], 0 offen offset:0 sc1 lds
    buffer_load_dwordx4 v224, s[56:59], 0 offen offset:1024 sc1 lds
    buffer_load_dwordx4 v224, s[56:59], 0 offen offset:2048 sc1 lds
    buffer_load_dwordx4 v224, s[56:59], 0 offen offset:3072 sc1 lds
    s_add_u32 m0, s81, 4572
    s_nop 0
    buffer_load_dwordx4 v224, s[56:59], 0 offen offset:0 sc1 lds
    buffer_load_dwordx4 v224, s[56:59], 0 offen offset:1024 sc1 lds
    buffer_load_dwordx4 v224, s[56:59], 0 offen offset:2048 sc1 lds
    buffer_load_dwordx4 v224, s[56:59], 0 offen offset:3072 sc1 lds
    s_add_u32 s56, s16, s84
    s_addc_u32 s57, s17, 0
    s_movk_i32 s58, 4096
    s_mov_b32 s59, 0x20000
    s_add_u32 m0, s80, 64
    v_mov_b32 v132, 0
    v_mov_b32 v133, 0
    v_mov_b32 v134, 0
    v_mov_b32 v135, 0
    buffer_load_dwordx4 v224, s[56:59], 0 offen offset:0 lds
    buffer_load_dwordx4 v224, s[56:59], 0 offen offset:1024 lds
    buffer_load_dwordx4 v224, s[56:59], 0 offen offset:2048 lds
    buffer_load_dwordx4 v224, s[56:59], 0 offen offset:3072 lds
    s_add_u32 m0, s80, 4304
    s_mov_b64 exec, 0x100
    buffer_load_dwordx4 v[132:135], off, s[56:59], 0
    s_mov_b64 exec, -1
    buffer_load_dwordx4 v224, s[56:59], 14 offen offset:0 lds
    buffer_load_dwordx4 v224, s[56:59], 14 offen offset:1024 lds
    buffer_load_dwordx4 v224, s[56:59], 14 offen offset:2048 lds
    buffer_load_dwordx4 v224, s[56:59], 14 offen offset:3072 lds
    v_lshrrev_b32 v234, 5, v0
    v_mul_u32_u24 v234, 4064, v234
    v_add3_u32 v234, v234, v224, s81
    s_mov_b32 exec_lo, 0xfffffff
    s_mov_b32 exec_hi, 0xfffffff
    ds_write_b128 v234, v[228:231] offset:4096
    s_mov_b64 exec, 1
    ds_write_b32 v234, v228 offset:8668
    s_mov_b64 exec, -1
    s_setprio 3
    s_waitcnt vmcnt(9)
    s_mov_b32 s60, s24
    s_mov_b32 s61, s25
    s_mov_b32 s62, 0x200000
    s_mov_b32 s63, 0x20000
    s_lshr_b32 s74, s2, 3
    s_lshl2_add_u32 s74, s74, s70
    s_bfe_u32 s75, s2, 0x10002
    s_lshl4_add_u32 s74, s74, s75
    s_lshl_b32 s74, s74, 10
    v_lshrrev_b32 v234, 3, v0
    v_and_b32 v235, 7, v0
    v_lshlrev_b32 v235, 7, v235
    v_lshl_add_u32 v234, v234, 11, v235
    buffer_load_dword v250, v234, s[60:63], s74 offen
    s_waitcnt vmcnt(1)
    v_cmp_lt_u32 vcc, 3, v0
    v_mov_b32 v140, 4160
    v_lshlrev_b32 v136, 16, v132
    v_cndmask_b32 v140, 0, v140, vcc
    v_alignbit_b32 v137, v133, v132, 16
    v_alignbit_b32 v138, v134, v133, 16
    v_alignbit_b32 v139, v135, v134, 16
    v_add3_u32 v140, v140, v224, s80
    s_mov_b64 exec, 0x1ff
    ds_write_b128 v140, v[136:139]
    s_mov_b64 exec, -1
    ds_read_b128 v[112:115], v233 offset:3584
    ds_read_b64 v[48:49], v232 offset:0
    ds_read_b64 v[50:51], v232 offset:8
    ds_read_b128 v[116:119], v233 offset:3072
    ds_read_b64 v[52:53], v232 offset:512
    ds_read_b64 v[54:55], v232 offset:520
    ds_read_b128 v[120:123], v233 offset:2560
    ds_read_b64 v[56:57], v232 offset:1024
    ds_read_b64 v[58:59], v232 offset:1032
    ds_read_b128 v[124:127], v233 offset:2048
    ds_read_b64 v[60:61], v232 offset:1536
    ds_read_b64 v[62:63], v232 offset:1544
    ds_read_b128 v[128:131], v233 offset:1536
    ds_read_b64 v[64:65], v232 offset:2048
    ds_read_b64 v[66:67], v232 offset:2056
    ds_read_b128 v[132:135], v233 offset:1024
    ds_read_b64 v[68:69], v232 offset:2560
    ds_read_b64 v[70:71], v232 offset:2568
    ds_read_b128 v[136:139], v233 offset:512
    ds_read_b64 v[72:73], v232 offset:3072
    ds_read_b64 v[74:75], v232 offset:3080
    ds_read_b128 v[140:143], v233 offset:0
    ds_read_b64 v[76:77], v232 offset:3584
    ds_read_b64 v[78:79], v232 offset:3592
    s_setprio 1
    s_mov_b32 s74, 3
    s_waitcnt lgkmcnt(0)
    v_mfma_f32_16x16x32_bf16 v[16:19], v[240:243], v[112:115], 0
    v_mfma_f32_16x16x32_bf16 v[20:23], v[240:243], v[116:119], 0
    v_mfma_f32_16x16x32_bf16 v[24:27], v[240:243], v[120:123], 0
    v_mfma_f32_16x16x32_bf16 v[28:31], v[240:243], v[124:127], 0
    v_mfma_f32_16x16x32_bf16 v[32:35], v[240:243], v[128:131], 0
    v_mfma_f32_16x16x32_bf16 v[36:39], v[240:243], v[132:135], 0
    v_mfma_f32_16x16x32_bf16 v[40:43], v[240:243], v[136:139], 0
    v_mfma_f32_16x16x32_bf16 v[44:47], v[240:243], v[140:143], 0
L_conv:
    v_mfma_f32_16x16x32_bf16 v[16:19], v[48:51], v[112:115], v[16:19]
    ds_read_b128 v[144:147], v233 offset:3648
    v_mfma_f32_16x16x32_bf16 v[20:23], v[48:51], v[116:119], v[20:23]
    ds_read_b64 v[80:81], v232 offset:64
    v_mfma_f32_16x16x32_bf16 v[20:23], v[52:55], v[112:115], v[20:23]
    ds_read_b64 v[82:83], v232 offset:72
    v_mfma_f32_16x16x32_bf16 v[24:27], v[48:51], v[120:123], v[24:27]
    ds_read_b128 v[148:151], v233 offset:3136
    v_mfma_f32_16x16x32_bf16 v[24:27], v[52:55], v[116:119], v[24:27]
    ds_read_b64 v[84:85], v232 offset:576
    v_mfma_f32_16x16x32_bf16 v[24:27], v[56:59], v[112:115], v[24:27]
    ds_read_b64 v[86:87], v232 offset:584
    v_mfma_f32_16x16x32_bf16 v[28:31], v[48:51], v[124:127], v[28:31]
    ds_read_b128 v[152:155], v233 offset:2624
    v_mfma_f32_16x16x32_bf16 v[28:31], v[52:55], v[120:123], v[28:31]
    ds_read_b64 v[88:89], v232 offset:1088
    v_mfma_f32_16x16x32_bf16 v[28:31], v[56:59], v[116:119], v[28:31]
    ds_read_b64 v[90:91], v232 offset:1096
    v_mfma_f32_16x16x32_bf16 v[28:31], v[60:63], v[112:115], v[28:31]
    ds_read_b128 v[156:159], v233 offset:2112
    v_mfma_f32_16x16x32_bf16 v[32:35], v[48:51], v[128:131], v[32:35]
    ds_read_b64 v[92:93], v232 offset:1600
    v_mfma_f32_16x16x32_bf16 v[32:35], v[52:55], v[124:127], v[32:35]
    ds_read_b64 v[94:95], v232 offset:1608
    v_mfma_f32_16x16x32_bf16 v[32:35], v[56:59], v[120:123], v[32:35]
    ds_read_b128 v[160:163], v233 offset:1600
    v_mfma_f32_16x16x32_bf16 v[32:35], v[60:63], v[116:119], v[32:35]
    ds_read_b64 v[96:97], v232 offset:2112
    v_mfma_f32_16x16x32_bf16 v[32:35], v[64:67], v[112:115], v[32:35]
    ds_read_b64 v[98:99], v232 offset:2120
    v_mfma_f32_16x16x32_bf16 v[36:39], v[48:51], v[132:135], v[36:39]
    ds_read_b128 v[164:167], v233 offset:1088
    v_mfma_f32_16x16x32_bf16 v[36:39], v[52:55], v[128:131], v[36:39]
    ds_read_b64 v[100:101], v232 offset:2624
    v_mfma_f32_16x16x32_bf16 v[36:39], v[56:59], v[124:127], v[36:39]
    ds_read_b64 v[102:103], v232 offset:2632
    v_mfma_f32_16x16x32_bf16 v[36:39], v[60:63], v[120:123], v[36:39]
    ds_read_b128 v[168:171], v233 offset:576
    v_mfma_f32_16x16x32_bf16 v[36:39], v[64:67], v[116:119], v[36:39]
    ds_read_b64 v[104:105], v232 offset:3136
    v_mfma_f32_16x16x32_bf16 v[36:39], v[68:71], v[112:115], v[36:39]
    ds_read_b64 v[106:107], v232 offset:3144
    v_mfma_f32_16x16x32_bf16 v[40:43], v[48:51], v[136:139], v[40:43]
    ds_read_b128 v[172:175], v233 offset:64
    v_mfma_f32_16x16x32_bf16 v[40:43], v[52:55], v[132:135], v[40:43]
    ds_read_b64 v[108:109], v232 offset:3648
    v_mfma_f32_16x16x32_bf16 v[40:43], v[56:59], v[128:131], v[40:43]
    ds_read_b64 v[110:111], v232 offset:3656
    v_mfma_f32_16x16x32_bf16 v[40:43], v[60:63], v[124:127], v[40:43]
    v_mfma_f32_16x16x32_bf16 v[40:43], v[64:67], v[120:123], v[40:43]
    v_mfma_f32_16x16x32_bf16 v[40:43], v[68:71], v[116:119], v[40:43]
    v_mfma_f32_16x16x32_bf16 v[40:43], v[72:75], v[112:115], v[40:43]
    v_mfma_f32_16x16x32_bf16 v[44:47], v[48:51], v[140:143], v[44:47]
    v_mfma_f32_16x16x32_bf16 v[44:47], v[52:55], v[136:139], v[44:47]
    v_mfma_f32_16x16x32_bf16 v[44:47], v[56:59], v[132:135], v[44:47]
    v_mfma_f32_16x16x32_bf16 v[44:47], v[60:63], v[128:131], v[44:47]
    v_mfma_f32_16x16x32_bf16 v[44:47], v[64:67], v[124:127], v[44:47]
    v_mfma_f32_16x16x32_bf16 v[44:47], v[68:71], v[120:123], v[44:47]
    v_mfma_f32_16x16x32_bf16 v[44:47], v[72:75], v[116:119], v[44:47]
    v_mfma_f32_16x16x32_bf16 v[44:47], v[76:79], v[112:115], v[44:47]
    s_waitcnt lgkmcnt(0)
    v_mfma_f32_16x16x32_bf16 v[16:19], v[80:83], v[144:147], v[16:19]
    ds_read_b128 v[112:115], v233 offset:3712
    v_mfma_f32_16x16x32_bf16 v[20:23], v[80:83], v[148:151], v[20:23]
    ds_read_b64 v[48:49], v232 offset:128
    v_mfma_f32_16x16x32_bf16 v[20:23], v[84:87], v[144:147], v[20:23]
    ds_read_b64 v[50:51], v232 offset:136
    v_mfma_f32_16x16x32_bf16 v[24:27], v[80:83], v[152:155], v[24:27]
    ds_read_b128 v[116:119], v233 offset:3200
    v_mfma_f32_16x16x32_bf16 v[24:27], v[84:87], v[148:151], v[24:27]
    ds_read_b64 v[52:53], v232 offset:640
    v_mfma_f32_16x16x32_bf16 v[24:27], v[88:91], v[144:147], v[24:27]
    ds_read_b64 v[54:55], v232 offset:648
    v_mfma_f32_16x16x32_bf16 v[28:31], v[80:83], v[156:159], v[28:31]
    ds_read_b128 v[120:123], v233 offset:2688
    v_mfma_f32_16x16x32_bf16 v[28:31], v[84:87], v[152:155], v[28:31]
    ds_read_b64 v[56:57], v232 offset:1152
    v_mfma_f32_16x16x32_bf16 v[28:31], v[88:91], v[148:151], v[28:31]
    ds_read_b64 v[58:59], v232 offset:1160
    v_mfma_f32_16x16x32_bf16 v[28:31], v[92:95], v[144:147], v[28:31]
    ds_read_b128 v[124:127], v233 offset:2176
    v_mfma_f32_16x16x32_bf16 v[32:35], v[80:83], v[160:163], v[32:35]
    ds_read_b64 v[60:61], v232 offset:1664
    v_mfma_f32_16x16x32_bf16 v[32:35], v[84:87], v[156:159], v[32:35]
    ds_read_b64 v[62:63], v232 offset:1672
    v_mfma_f32_16x16x32_bf16 v[32:35], v[88:91], v[152:155], v[32:35]
    ds_read_b128 v[128:131], v233 offset:1664
    v_mfma_f32_16x16x32_bf16 v[32:35], v[92:95], v[148:151], v[32:35]
    ds_read_b64 v[64:65], v232 offset:2176
    v_mfma_f32_16x16x32_bf16 v[32:35], v[96:99], v[144:147], v[32:35]
    ds_read_b64 v[66:67], v232 offset:2184
    v_mfma_f32_16x16x32_bf16 v[36:39], v[80:83], v[164:167], v[36:39]
    ds_read_b128 v[132:135], v233 offset:1152
    v_mfma_f32_16x16x32_bf16 v[36:39], v[84:87], v[160:163], v[36:39]
    ds_read_b64 v[68:69], v232 offset:2688
    v_mfma_f32_16x16x32_bf16 v[36:39], v[88:91], v[156:159], v[36:39]
    ds_read_b64 v[70:71], v232 offset:2696
    v_mfma_f32_16x16x32_bf16 v[36:39], v[92:95], v[152:155], v[36:39]
    ds_read_b128 v[136:139], v233 offset:640
    v_mfma_f32_16x16x32_bf16 v[36:39], v[96:99], v[148:151], v[36:39]
    ds_read_b64 v[72:73], v232 offset:3200
    v_mfma_f32_16x16x32_bf16 v[36:39], v[100:103], v[144:147], v[36:39]
    ds_read_b64 v[74:75], v232 offset:3208
    v_mfma_f32_16x16x32_bf16 v[40:43], v[80:83], v[168:171], v[40:43]
    ds_read_b128 v[140:143], v233 offset:128
    v_mfma_f32_16x16x32_bf16 v[40:43], v[84:87], v[164:167], v[40:43]
    ds_read_b64 v[76:77], v232 offset:3712
    v_mfma_f32_16x16x32_bf16 v[40:43], v[88:91], v[160:163], v[40:43]
    ds_read_b64 v[78:79], v232 offset:3720
    v_mfma_f32_16x16x32_bf16 v[40:43], v[92:95], v[156:159], v[40:43]
    v_add_u32 v232, 128, v232
    v_mfma_f32_16x16x32_bf16 v[40:43], v[96:99], v[152:155], v[40:43]
    v_add_u32 v233, 128, v233
    v_mfma_f32_16x16x32_bf16 v[40:43], v[100:103], v[148:151], v[40:43]
    s_sub_u32 s74, s74, 1
    v_mfma_f32_16x16x32_bf16 v[40:43], v[104:107], v[144:147], v[40:43]
    s_cmp_lg_u32 s74, 0
    v_mfma_f32_16x16x32_bf16 v[44:47], v[80:83], v[172:175], v[44:47]
    v_mfma_f32_16x16x32_bf16 v[44:47], v[84:87], v[168:171], v[44:47]
    v_mfma_f32_16x16x32_bf16 v[44:47], v[88:91], v[164:167], v[44:47]
    v_mfma_f32_16x16x32_bf16 v[44:47], v[92:95], v[160:163], v[44:47]
    v_mfma_f32_16x16x32_bf16 v[44:47], v[96:99], v[156:159], v[44:47]
    v_mfma_f32_16x16x32_bf16 v[44:47], v[100:103], v[152:155], v[44:47]
    v_mfma_f32_16x16x32_bf16 v[44:47], v[104:107], v[148:151], v[44:47]
    v_mfma_f32_16x16x32_bf16 v[44:47], v[108:111], v[144:147], v[44:47]
    s_waitcnt lgkmcnt(0)
    s_cbranch_scc1 L_conv
    v_mfma_f32_16x16x32_bf16 v[16:19], v[48:51], v[112:115], v[16:19]
    ds_read_b128 v[144:147], v233 offset:3648
    v_mfma_f32_16x16x32_bf16 v[20:23], v[48:51], v[116:119], v[20:23]
    ds_read_b64 v[80:81], v232 offset:64
    v_mfma_f32_16x16x32_bf16 v[20:23], v[52:55], v[112:115], v[20:23]
    ds_read_b64 v[82:83], v232 offset:72
    v_mfma_f32_16x16x32_bf16 v[24:27], v[48:51], v[120:123], v[24:27]
    ds_read_b128 v[148:151], v233 offset:3136
    v_mfma_f32_16x16x32_bf16 v[24:27], v[52:55], v[116:119], v[24:27]
    ds_read_b64 v[84:85], v232 offset:576
    v_mfma_f32_16x16x32_bf16 v[24:27], v[56:59], v[112:115], v[24:27]
    ds_read_b64 v[86:87], v232 offset:584
    v_mfma_f32_16x16x32_bf16 v[28:31], v[48:51], v[124:127], v[28:31]
    ds_read_b128 v[152:155], v233 offset:2624
    v_mfma_f32_16x16x32_bf16 v[28:31], v[52:55], v[120:123], v[28:31]
    ds_read_b64 v[88:89], v232 offset:1088
    v_mfma_f32_16x16x32_bf16 v[28:31], v[56:59], v[116:119], v[28:31]
    ds_read_b64 v[90:91], v232 offset:1096
    v_mfma_f32_16x16x32_bf16 v[28:31], v[60:63], v[112:115], v[28:31]
    ds_read_b128 v[156:159], v233 offset:2112
    v_mfma_f32_16x16x32_bf16 v[32:35], v[48:51], v[128:131], v[32:35]
    ds_read_b64 v[92:93], v232 offset:1600
    v_mfma_f32_16x16x32_bf16 v[32:35], v[52:55], v[124:127], v[32:35]
    ds_read_b64 v[94:95], v232 offset:1608
    v_mfma_f32_16x16x32_bf16 v[32:35], v[56:59], v[120:123], v[32:35]
    ds_read_b128 v[160:163], v233 offset:1600
    v_mfma_f32_16x16x32_bf16 v[32:35], v[60:63], v[116:119], v[32:35]
    ds_read_b64 v[96:97], v232 offset:2112
    v_mfma_f32_16x16x32_bf16 v[32:35], v[64:67], v[112:115], v[32:35]
    ds_read_b64 v[98:99], v232 offset:2120
    v_mfma_f32_16x16x32_bf16 v[36:39], v[48:51], v[132:135], v[36:39]
    ds_read_b128 v[164:167], v233 offset:1088
    v_mfma_f32_16x16x32_bf16 v[36:39], v[52:55], v[128:131], v[36:39]
    ds_read_b64 v[100:101], v232 offset:2624
    v_mfma_f32_16x16x32_bf16 v[36:39], v[56:59], v[124:127], v[36:39]
    ds_read_b64 v[102:103], v232 offset:2632
    v_mfma_f32_16x16x32_bf16 v[36:39], v[60:63], v[120:123], v[36:39]
    ds_read_b128 v[168:171], v233 offset:576
    v_mfma_f32_16x16x32_bf16 v[36:39], v[64:67], v[116:119], v[36:39]
    ds_read_b64 v[104:105], v232 offset:3136
    v_mfma_f32_16x16x32_bf16 v[36:39], v[68:71], v[112:115], v[36:39]
    ds_read_b64 v[106:107], v232 offset:3144
    v_mfma_f32_16x16x32_bf16 v[40:43], v[48:51], v[136:139], v[40:43]
    ds_read_b128 v[172:175], v233 offset:64
    v_mfma_f32_16x16x32_bf16 v[40:43], v[52:55], v[132:135], v[40:43]
    ds_read_b64 v[108:109], v232 offset:3648
    v_mfma_f32_16x16x32_bf16 v[40:43], v[56:59], v[128:131], v[40:43]
    ds_read_b64 v[110:111], v232 offset:3656
    v_mfma_f32_16x16x32_bf16 v[40:43], v[60:63], v[124:127], v[40:43]
    s_mul_i32 s74, s68, 4224
    v_mfma_f32_16x16x32_bf16 v[40:43], v[64:67], v[120:123], v[40:43]
    s_and_b32 s75, s71, 63
    v_mfma_f32_16x16x32_bf16 v[40:43], v[68:71], v[116:119], v[40:43]
    s_add_u32 s74, s74, s75
    v_mfma_f32_16x16x32_bf16 v[40:43], v[72:75], v[112:115], v[40:43]
    s_lshl_b32 s74, s74, 6
    v_mfma_f32_16x16x32_bf16 v[44:47], v[48:51], v[140:143], v[44:47]
    v_and_b32 v234, 3, v0
    v_mfma_f32_16x16x32_bf16 v[44:47], v[52:55], v[136:139], v[44:47]
    v_lshl_add_u32 v234, v234, 4, s74
    v_mfma_f32_16x16x32_bf16 v[44:47], v[56:59], v[132:135], v[44:47]
    v_and_b32 v235, 12, v0
    v_mfma_f32_16x16x32_bf16 v[44:47], v[60:63], v[128:131], v[44:47]
    v_lshrrev_b32 v236, 4, v0
    v_mfma_f32_16x16x32_bf16 v[44:47], v[64:67], v[124:127], v[44:47]
    v_add_u32 v235, v235, v236
    v_mfma_f32_16x16x32_bf16 v[44:47], v[68:71], v[120:123], v[44:47]
    v_mul_u32_u24 v235, 4224, v235
    v_mfma_f32_16x16x32_bf16 v[44:47], v[72:75], v[116:119], v[44:47]
    v_add_u32 v234, v234, v235
    v_mfma_f32_16x16x32_bf16 v[44:47], v[76:79], v[112:115], v[44:47]
    s_waitcnt lgkmcnt(0)
    s_mov_b64 exec, 1
    ds_add_u32 v227, v244 offset:36
    s_mov_b64 exec, -1
    v_mfma_f32_16x16x32_bf16 v[16:19], v[80:83], v[144:147], v[16:19]
    s_bfe_u32 s86, s2, 0x10002
    s_lshr_b32 s74, s2, 5
    v_mfma_f32_16x16x32_bf16 v[20:23], v[80:83], v[148:151], v[20:23]
    s_lshl3_add_u32 s86, s86, s74
    v_lshrrev_b32 v236, 4, v0
    v_mfma_f32_16x16x32_bf16 v[20:23], v[84:87], v[144:147], v[20:23]
    v_lshlrev_b32 v236, 1, v236
    v_xor_b32 v236, v0, v236
    v_mfma_f32_16x16x32_bf16 v[24:27], v[80:83], v[152:155], v[24:27]
    v_and_b32 v236, 7, v236
    s_lshl_b32 s74, s86, 7
    v_cvt_pk_bf16_f32 v48, v16, v17
    v_cvt_pk_bf16_f32 v49, v18, v19
    v_mfma_f32_16x16x32_bf16 v[24:27], v[84:87], v[148:151], v[24:27]
    v_lshl_add_u32 v236, v236, 4, s74
    v_lshrrev_b32 v235, 3, v0
    v_cvt_pk_bf16_f32 v50, v20, v21
    v_cvt_pk_bf16_f32 v51, v22, v23
    v_mfma_f32_16x16x32_bf16 v[24:27], v[88:91], v[144:147], v[24:27]
    v_lshl_add_u32 v235, v235, 11, v236
    s_mov_b32 s56, s24
    s_mov_b32 s76, 0
    buffer_store_dwordx4 v[48:51], v234, s[64:67], s76 offen sc1
    v_mfma_f32_16x16x32_bf16 v[28:31], v[80:83], v[156:159], v[28:31]
    s_mov_b32 s57, s25
    s_mov_b32 s58, 0x200000
    v_mfma_f32_16x16x32_bf16 v[28:31], v[84:87], v[152:155], v[28:31]
    s_mov_b32 s59, 0x20000
    s_mul_i32 s74, s86, 4
    v_cvt_pk_bf16_f32 v52, v24, v25
    v_cvt_pk_bf16_f32 v53, v26, v27
    v_mfma_f32_16x16x32_bf16 v[28:31], v[88:91], v[148:151], v[28:31]
    s_and_b32 s74, s74, 7
    s_lshl1_add_u32 s82, s74, s70
    v_mfma_f32_16x16x32_bf16 v[28:31], v[92:95], v[144:147], v[28:31]
    s_lshl_b32 s82, s82, 17
    s_lshl4_add_u32 s73, s68, 256
    v_mfma_f32_16x16x32_bf16 v[32:35], v[80:83], v[160:163], v[32:35]
    s_add_u32 s45, s73, s69
    s_lshl_b32 s73, s73, 8
    v_mfma_f32_16x16x32_bf16 v[32:35], v[84:87], v[156:159], v[32:35]
    s_lshl_b32 s45, s45, 8
    v_mfma_f32_16x16x32_bf16 v[32:35], v[88:91], v[152:155], v[32:35]
    v_mfma_f32_16x16x32_bf16 v[32:35], v[92:95], v[148:151], v[32:35]
    v_mfma_f32_16x16x32_bf16 v[32:35], v[96:99], v[144:147], v[32:35]
    v_cvt_pk_bf16_f32 v54, v28, v29
    v_cvt_pk_bf16_f32 v55, v30, v31
    v_mfma_f32_16x16x32_bf16 v[36:39], v[80:83], v[164:167], v[36:39]
    s_mov_b32 s76, 67584
    buffer_store_dwordx4 v[52:55], v234, s[64:67], s76 offen sc1
    v_mfma_f32_16x16x32_bf16 v[36:39], v[84:87], v[160:163], v[36:39]
    v_mfma_f32_16x16x32_bf16 v[36:39], v[88:91], v[156:159], v[36:39]
    v_mfma_f32_16x16x32_bf16 v[36:39], v[92:95], v[152:155], v[36:39]
    v_cvt_pk_bf16_f32 v56, v32, v33
    v_cvt_pk_bf16_f32 v57, v34, v35
    v_mfma_f32_16x16x32_bf16 v[36:39], v[96:99], v[148:151], v[36:39]
    v_mfma_f32_16x16x32_bf16 v[36:39], v[100:103], v[144:147], v[36:39]
    v_mfma_f32_16x16x32_bf16 v[40:43], v[80:83], v[168:171], v[40:43]
    v_mfma_f32_16x16x32_bf16 v[40:43], v[84:87], v[164:167], v[40:43]
    v_mfma_f32_16x16x32_bf16 v[40:43], v[88:91], v[160:163], v[40:43]
    v_mfma_f32_16x16x32_bf16 v[40:43], v[92:95], v[156:159], v[40:43]
    v_mfma_f32_16x16x32_bf16 v[40:43], v[96:99], v[152:155], v[40:43]
    v_mfma_f32_16x16x32_bf16 v[40:43], v[100:103], v[148:151], v[40:43]
    v_mfma_f32_16x16x32_bf16 v[40:43], v[104:107], v[144:147], v[40:43]
    v_mfma_f32_16x16x32_bf16 v[44:47], v[80:83], v[172:175], v[44:47]
    v_cvt_pk_bf16_f32 v58, v36, v37
    v_cvt_pk_bf16_f32 v59, v38, v39
    v_mfma_f32_16x16x32_bf16 v[44:47], v[84:87], v[168:171], v[44:47]
    s_mov_b32 s76, 135168
    buffer_store_dwordx4 v[56:59], v234, s[64:67], s76 offen sc1
    v_mfma_f32_16x16x32_bf16 v[44:47], v[88:91], v[164:167], v[44:47]
    v_mfma_f32_16x16x32_bf16 v[44:47], v[92:95], v[160:163], v[44:47]
    v_cvt_pk_bf16_f32 v60, v40, v41
    v_cvt_pk_bf16_f32 v61, v42, v43
    v_mfma_f32_16x16x32_bf16 v[44:47], v[96:99], v[156:159], v[44:47]
    v_mfma_f32_16x16x32_bf16 v[44:47], v[100:103], v[152:155], v[44:47]
    v_mfma_f32_16x16x32_bf16 v[44:47], v[104:107], v[148:151], v[44:47]
    v_mfma_f32_16x16x32_bf16 v[44:47], v[108:111], v[144:147], v[44:47]
    s_nop 7
    v_cvt_pk_bf16_f32 v62, v44, v45
    v_cvt_pk_bf16_f32 v63, v46, v47
    s_mov_b32 s76, 202752
    buffer_store_dwordx4 v[60:63], v234, s[64:67], s76 offen sc1
    s_setprio 1
    s_waitcnt vmcnt(0)
    v_mov_b32 v238, 1
    s_mov_b64 exec, 1
    ds_add_rtn_u32 v237, v227, v238 offset:8
    s_waitcnt lgkmcnt(0)
    v_readfirstlane_b32 s76, v237
    s_nop 0
    s_cmp_eq_u32 s76, 3
    s_cbranch_scc0 L_jo_35a
    s_mov_b64 exec, 0xffff
    v_lshlrev_b32 v237, 8, v0
    buffer_atomic_add v238, v237, s[52:55], s73 offen sc1
L_jo_35a:
    s_mov_b64 exec, -1
    v_lshlrev_b32 v112, 16, v208
    v_and_b32 v113, 0xffff0000, v208
    v_lshlrev_b32 v114, 16, v209
    v_and_b32 v115, 0xffff0000, v209
    v_lshlrev_b32 v116, 16, v210
    v_and_b32 v117, 0xffff0000, v210
    v_lshlrev_b32 v118, 16, v211
    v_and_b32 v119, 0xffff0000, v211
    v_lshlrev_b32 v120, 16, v212
    v_and_b32 v121, 0xffff0000, v212
    v_lshlrev_b32 v122, 16, v213
    v_and_b32 v123, 0xffff0000, v213
    v_lshlrev_b32 v124, 16, v214
    v_and_b32 v125, 0xffff0000, v214
    v_lshlrev_b32 v126, 16, v215
    v_and_b32 v127, 0xffff0000, v215
    v_lshlrev_b32 v128, 16, v216
    v_and_b32 v129, 0xffff0000, v216
    v_lshlrev_b32 v130, 16, v217
    v_and_b32 v131, 0xffff0000, v217
    v_lshlrev_b32 v132, 16, v218
    v_and_b32 v133, 0xffff0000, v218
    v_lshlrev_b32 v134, 16, v219
    v_and_b32 v135, 0xffff0000, v219
    v_lshlrev_b32 v136, 16, v220
    v_and_b32 v137, 0xffff0000, v220
    v_lshlrev_b32 v138, 16, v221
    v_and_b32 v139, 0xffff0000, v221
    v_lshlrev_b32 v140, 16, v222
    v_and_b32 v141, 0xffff0000, v222
    v_lshlrev_b32 v142, 16, v223
    v_and_b32 v143, 0xffff0000, v223
    s_setprio 1
    s_setprio 1
    s_mul_i32 s77, s70, 4352
    s_add_u32 s77, s77, 60416
    v_lshrrev_b32 v234, 5, v0
    v_lshl_add_u32 v234, v234, 1, v0
    v_lshl_add_u32 v234, v234, 4, s77
    v_and_b32 v235, 7, v0
    v_mul_u32_u24 v235, 544, v235
    v_lshrrev_b32 v236, 3, v0
    v_lshl_add_u32 v235, v236, 3, v235
    v_add_u32 v235, s77, v235
    s_mul_i32 s77, s71, 4224
    s_mov_b32 s60, s26
    s_mov_b32 s61, s27
    s_mov_b32 s62, 0x800000
    s_mov_b32 s63, 0x20000
    s_cmp_eq_u32 s76, 3
    s_cbranch_scc0 L_jo_35
    s_mov_b32 s75, 131072
L_sg_loop_38:
    s_load_dword s74, s[52:53], s45 glc
L_sg_chk_39:
    s_waitcnt lgkmcnt(0)
    s_cmp_ge_u32 s74, 16
    s_cbranch_scc1 L_sg_done_37
    s_sub_u32 s75, s75, 1
    s_cbranch_scc0 L_sg_loop_38
L_sg_done_37:
    v_mov_b32 v237, 16
    s_mov_b64 exec, 1
    ds_add_u32 v227, v237 offset:16
    s_mov_b64 exec, -1
    s_branch L_jd_36
L_jo_35:
    s_mov_b32 s75, 1048576
L_sl_loop_41:
    ds_read_b32 v237, v227 offset:16
    s_waitcnt lgkmcnt(0)
    v_readfirstlane_b32 s74, v237
    s_nop 0
    s_cmp_ge_u32 s74, 16
    s_cbranch_scc1 L_sl_done_40
    s_sleep 1
    s_sub_u32 s75, s75, 1
    s_cbranch_scc0 L_sl_loop_41
L_sl_done_40:
L_jd_36:
    buffer_load_dwordx4 v[48:51], v224, s[64:67], s77 offen offset:0 sc1
    buffer_load_dwordx4 v[52:55], v224, s[64:67], s77 offen offset:1024 sc1
    buffer_load_dwordx4 v[56:59], v224, s[64:67], s77 offen offset:2048 sc1
    buffer_load_dwordx4 v[60:63], v224, s[64:67], s77 offen offset:3072 sc1
    s_waitcnt vmcnt(3)
    ds_write_b128 v234, v[48:51] offset:0
    s_waitcnt vmcnt(2)
    ds_write_b128 v234, v[52:55] offset:1088
    s_waitcnt vmcnt(1)
    ds_write_b128 v234, v[56:59] offset:2176
    s_waitcnt vmcnt(0)
    ds_write_b128 v234, v[60:63] offset:3264
    ds_read_b64 v[64:65], v235 offset:0
    ds_read_b64 v[66:67], v235 offset:64
    ds_read_b64 v[68:69], v235 offset:128
    ds_read_b64 v[70:71], v235 offset:192
    ds_read_b64 v[72:73], v235 offset:256
    ds_read_b64 v[74:75], v235 offset:320
    ds_read_b64 v[76:77], v235 offset:384
    ds_read_b64 v[78:79], v235 offset:448
    s_waitcnt lgkmcnt(7)
    v_lshlrev_b32 v16, 16, v64
    v_and_b32 v24, 0xffff0000, v64
    v_lshlrev_b32 v32, 16, v65
    v_and_b32 v40, 0xffff0000, v65
    s_waitcnt lgkmcnt(6)
    v_lshlrev_b32 v17, 16, v66
    v_and_b32 v25, 0xffff0000, v66
    v_lshlrev_b32 v33, 16, v67
    v_and_b32 v41, 0xffff0000, v67
    s_waitcnt lgkmcnt(5)
    v_lshlrev_b32 v18, 16, v68
    v_and_b32 v26, 0xffff0000, v68
    v_lshlrev_b32 v34, 16, v69
    v_and_b32 v42, 0xffff0000, v69
    s_waitcnt lgkmcnt(4)
    v_lshlrev_b32 v19, 16, v70
    v_and_b32 v27, 0xffff0000, v70
    v_lshlrev_b32 v35, 16, v71
    v_and_b32 v43, 0xffff0000, v71
    s_waitcnt lgkmcnt(3)
    v_lshlrev_b32 v20, 16, v72
    v_and_b32 v28, 0xffff0000, v72
    v_lshlrev_b32 v36, 16, v73
    v_and_b32 v44, 0xffff0000, v73
    s_waitcnt lgkmcnt(2)
    v_lshlrev_b32 v21, 16, v74
    v_and_b32 v29, 0xffff0000, v74
    v_lshlrev_b32 v37, 16, v75
    v_and_b32 v45, 0xffff0000, v75
    s_waitcnt lgkmcnt(1)
    v_lshlrev_b32 v22, 16, v76
    v_and_b32 v30, 0xffff0000, v76
    v_lshlrev_b32 v38, 16, v77
    v_and_b32 v46, 0xffff0000, v77
    s_waitcnt lgkmcnt(0)
    v_lshlrev_b32 v23, 16, v78
    v_and_b32 v31, 0xffff0000, v78
    v_lshlrev_b32 v39, 16, v79
    v_and_b32 v47, 0xffff0000, v79
    v_mul_f32 v16, v16, v112
    v_mul_f32 v17, v17, v113
    v_mul_f32 v18, v18, v114
    v_mul_f32 v19, v19, v115
    v_mul_f32 v20, v20, v116
    v_mul_f32 v21, v21, v117
    v_mul_f32 v22, v22, v118
    v_mul_f32 v23, v23, v119
    v_cvt_pk_bf16_f32 v48, v16, v17
    v_cvt_pk_bf16_f32 v49, v18, v19
    v_cvt_pk_bf16_f32 v50, v20, v21
    v_cvt_pk_bf16_f32 v51, v22, v23
    s_mov_b32 s74, 0
    buffer_store_dwordx4 v[48:51], v226, s[60:63], s74 offen nt
    v_mul_f32 v24, v24, v120
    v_mul_f32 v25, v25, v121
    v_mul_f32 v26, v26, v122
    v_mul_f32 v27, v27, v123
    v_mul_f32 v28, v28, v124
    v_mul_f32 v29, v29, v125
    v_mul_f32 v30, v30, v126
    v_mul_f32 v31, v31, v127
    v_cvt_pk_bf16_f32 v52, v24, v25
    v_cvt_pk_bf16_f32 v53, v26, v27
    v_cvt_pk_bf16_f32 v54, v28, v29
    v_cvt_pk_bf16_f32 v55, v30, v31
    s_mov_b32 s74, 4096
    buffer_store_dwordx4 v[52:55], v226, s[60:63], s74 offen nt
    v_mul_f32 v32, v32, v128
    v_mul_f32 v33, v33, v129
    v_mul_f32 v34, v34, v130
    v_mul_f32 v35, v35, v131
    v_mul_f32 v36, v36, v132
    v_mul_f32 v37, v37, v133
    v_mul_f32 v38, v38, v134
    v_mul_f32 v39, v39, v135
    v_cvt_pk_bf16_f32 v56, v32, v33
    v_cvt_pk_bf16_f32 v57, v34, v35
    v_cvt_pk_bf16_f32 v58, v36, v37
    v_cvt_pk_bf16_f32 v59, v38, v39
    s_mov_b32 s74, 16384
    buffer_store_dwordx4 v[56:59], v226, s[60:63], s74 offen nt
    v_mul_f32 v40, v40, v136
    v_mul_f32 v41, v41, v137
    v_mul_f32 v42, v42, v138
    v_mul_f32 v43, v43, v139
    v_mul_f32 v44, v44, v140
    v_mul_f32 v45, v45, v141
    v_mul_f32 v46, v46, v142
    v_mul_f32 v47, v47, v143
    v_cvt_pk_bf16_f32 v60, v40, v41
    v_cvt_pk_bf16_f32 v61, v42, v43
    v_cvt_pk_bf16_f32 v62, v44, v45
    v_cvt_pk_bf16_f32 v63, v46, v47
    s_mov_b32 s74, 20480
    buffer_store_dwordx4 v[60:63], v226, s[60:63], s74 offen nt
    s_endpgm
L_grole:
    s_setprio 2
    s_add_u32 s52, s30, 0xe00000
    s_addc_u32 s53, s31, 0
    s_mov_b32 s54, 0x20000
    s_mov_b32 s55, 0x20000
    s_lshr_b32 s32, s3, 1
    s_and_b32 s33, s3, 1
    v_and_b32 v1, 15, v0
    v_lshrrev_b32 v2, 4, v0
    v_lshrrev_b32 v3, 1, v1
    v_xor_b32 v3, v2, v3
    v_lshlrev_b32 v3, 4, v3
    v_lshl_add_u32 v3, v1, 7, v3
    s_lshl_b32 s37, s33, 13
    v_add_u32 v196, s37, v3
    v_xor_b32 v197, 64, v196
    v_and_b32 v3, 6, v1
    v_xor_b32 v3, v2, v3
    v_lshlrev_b32 v3, 4, v3
    v_and_b32 v198, 7, v1
    v_lshl_add_u32 v3, v198, 7, v3
    v_add_u32 v198, 16384, v3
    v_xor_b32 v199, 64, v198
    v_bfe_u32 v3, v0, 2, 2
    v_lshl_add_u32 v200, v2, 3, v3
    v_lshlrev_b32 v200, 7, v200
    v_bfe_u32 v3, v0, 3, 2
    v_xor_b32 v3, s3, v3
    v_lshl_add_u32 v200, v3, 5, v200
    v_and_b32 v3, 3, v0
    v_lshl_add_u32 v200, v3, 3, v200
    v_add_u32 v200, 17408, v200
    v_xor_b32 v201, 32, v200
    v_mov_b64 v[52:53], 0
    v_mov_b64 v[54:55], 0
    v_mov_b64 v[56:57], 0
    v_mov_b64 v[58:59], 0
    v_mov_b64 v[60:61], 0
    v_mov_b64 v[62:63], 0
    v_mov_b64 v[64:65], 0
    v_mov_b64 v[66:67], 0
    v_mov_b64 v[68:69], 0
    v_mov_b64 v[70:71], 0
    v_mov_b64 v[72:73], 0
    v_mov_b64 v[74:75], 0
    v_mov_b64 v[76:77], 0
    v_mov_b64 v[78:79], 0
    v_mov_b64 v[80:81], 0
    v_mov_b64 v[82:83], 0
    v_mov_b64 v[84:85], 0
    v_mov_b64 v[86:87], 0
    v_mov_b64 v[88:89], 0
    v_mov_b64 v[90:91], 0
    v_mov_b64 v[92:93], 0
    v_mov_b64 v[94:95], 0
    v_mov_b64 v[96:97], 0
    v_mov_b64 v[98:99], 0
    v_mov_b64 v[100:101], 0
    v_mov_b64 v[102:103], 0
    v_mov_b64 v[104:105], 0
    v_mov_b64 v[106:107], 0
    s_mov_b32 s34, 0
    v_mov_b32 v228, 134352
    v_and_b32 v1, 15, v0
    v_lshrrev_b32 v2, 4, v0
    v_lshlrev_b32 v2, 2, v2
    v_sub_u32 v1, v1, v2
    s_mov_b32 s37, 0xf149f2ca
    v_mov_b32 v3, s37
    s_or_b32 s38, s5, s33
    s_cmp_eq_u32 s38, 0
    s_cselect_b32 s38, s37, 0
    v_subrev_u32 v2, 0, v1
    v_cmp_gt_u32 vcc, 8, v2
    v_cmp_gt_i32 s[64:65], -8, v2
    v_ashrrev_i32 v2, 31, v2
    v_cndmask_b32 v204, v3, 0, vcc
    v_cndmask_b32 v208, v3, 0, s[64:65]
    v_mov_b32 v216, v2
    v_min_f32 v212, s38, v208
    v_subrev_u32 v2, 1, v1
    v_cmp_gt_u32 vcc, 8, v2
    v_cmp_gt_i32 s[64:65], -8, v2
    v_ashrrev_i32 v2, 31, v2
    v_cndmask_b32 v205, v3, 0, vcc
    v_cndmask_b32 v209, v3, 0, s[64:65]
    v_alignbit_b32 v216, v2, v216, 16
    v_min_f32 v213, s38, v209
    v_subrev_u32 v2, 2, v1
    v_cmp_gt_u32 vcc, 8, v2
    v_cmp_gt_i32 s[64:65], -8, v2
    v_ashrrev_i32 v2, 31, v2
    v_cndmask_b32 v206, v3, 0, vcc
    v_cndmask_b32 v210, v3, 0, s[64:65]
    v_mov_b32 v217, v2
    v_min_f32 v214, s38, v210
    v_subrev_u32 v2, 3, v1
    v_cmp_gt_u32 vcc, 8, v2
    v_cmp_gt_i32 s[64:65], -8, v2
    v_ashrrev_i32 v2, 31, v2
    v_cndmask_b32 v207, v3, 0, vcc
    v_cndmask_b32 v211, v3, 0, s[64:65]
    v_alignbit_b32 v217, v2, v217, 16
    v_min_f32 v215, s38, v211
    s_mul_i32 s37, s32, 80896
    s_add_u32 s37, s37, 78848
    v_lshl_add_u32 v220, v0, 3, s37
    s_lshl_b32 s38, s33, 9
    v_add_u32 v219, s38, v220
    s_mul_i32 s38, s33, 2560
    v_add_u32 v221, s38, v220
    v_xor_b32 v222, 512, v221
    s_lshl3_add_u32 s37, s4, s5
    s_lshl1_add_u32 s37, s37, s33
    s_lshl_b32 s37, s37, 7
    s_lshl1_add_u32 s38, s6, s32
    s_add_u32 s37, s37, s38
    s_lshl_b32 s37, s37, 10
    v_lshl_add_u32 v218, v0, 4, s37
    s_mov_b32 s40, s30
    s_mov_b32 s41, s31
    s_mov_b32 s42, 0x400000
    s_mov_b32 s43, 0x20000
    s_and_b32 s58, s2, 3
    s_bfe_u32 s37, s2, 0x20003
    s_lshl2_add_u32 s58, s58, s37
    s_bfe_u32 s59, s2, 0x10002
    s_lshr_b32 s37, s2, 5
    s_lshl3_add_u32 s59, s59, s37
    s_mov_b32 s44, s24
    s_mov_b32 s45, s25
    s_mov_b32 s46, 0x200000
    s_mov_b32 s47, 0x20000
    s_mov_b32 s48, s26
    s_mov_b32 s49, s27
    s_mov_b32 s50, 0x800000
    s_mov_b32 s51, 0x20000
    s_lshl3_add_u32 s56, s4, s5
    s_lshl4_add_u32 s56, s56, 0
    s_lshl_b32 s56, s56, 8
    s_lshl4_add_u32 s57, s58, 0
    s_add_u32 s57, s57, s59
    s_lshl_b32 s57, s57, 8
    s_lshl2_add_u32 s37, s58, s3
    s_lshl_b32 s38, s37, 16
    v_lshl_add_u32 v224, v0, 4, s38
    v_add_u32 v225, 0x8000, v224
    s_and_b32 s37, s37, 31
    s_lshl_b32 s37, s37, 6
    s_lshr_b32 s38, s58, 3
    s_add_u32 s37, s37, s38
    s_lshl_b32 s37, s37, 5
    s_add_u32 s37, s37, s59
    s_add_u32 s37, s37, 16
    s_lshl_b32 s37, s37, 7
    v_lshrrev_b32 v1, 3, v0
    v_lshl_add_u32 v1, v1, 13, s37
    v_and_b32 v2, 7, v0
    v_lshl_add_u32 v226, v2, 4, v1
    v_lshrrev_b32 v1, 4, v0
    v_lshlrev_b32 v1, 1, v1
    v_xor_b32 v1, v0, v1
    v_and_b32 v1, 7, v1
    s_lshl_b32 s37, s59, 7
    v_lshl_add_u32 v1, v1, 4, s37
    v_lshrrev_b32 v227, 3, v0
    v_lshl_add_u32 v227, v227, 11, v1
    v_add_u32 v223, 15360, v227
    s_lshl_b32 s60, s3, 11
    s_mul_i32 s61, s59, 4
    s_and_b32 s61, s61, 7
    s_lshl3_add_u32 s62, s61, s3
    s_lshl_b32 s62, s62, 15
    v_lshrrev_b32 v1, 2, v0
    v_lshlrev_b32 v1, 7, v1
    v_bfe_u32 v2, v0, 3, 2
    v_lshl_add_u32 v1, v2, 5, v1
    v_and_b32 v2, 3, v0
    v_lshl_add_u32 v229, v2, 3, v1
    v_and_b32 v231, 7, v0
    v_lshl_add_u32 v230, v231, 6, s86
    v_mul_u32_u24 v231, 528, v231
    v_lshrrev_b32 v232, 3, v0
    v_xor_b32 v232, 7, v232
    v_lshl_add_u32 v231, v232, 3, v231
    v_add_u32 v231, s86, v231
    v_lshrrev_b32 v232, 5, v0
    v_add_u32 v232, v0, v232
    v_lshl_add_u32 v232, v232, 4, s86
    s_mul_i32 s87, s84, 4224
    s_sub_u32 s87, s87, s85
    s_lshl_b32 s87, s87, 6
    s_add_u32 s87, s87, 4032
    v_and_b32 v233, 3, v0
    v_lshl_add_u32 v233, v233, 4, s87
    v_lshrrev_b32 v234, 2, v0
    v_mul_u32_u24 v234, 4224, v234
    v_add_u32 v233, v233, v234
    s_add_u32 s80, s30, 0x400000
    s_addc_u32 s81, s31, 0
    s_mov_b32 s82, 0x420000
    s_mov_b32 s83, 0x20000
    s_waitcnt vmcnt(11)
    ds_read_b128 v[36:39], v230 offset:4224
    ds_read_b128 v[40:43], v230 offset:4240
    ds_read_b128 v[44:47], v230 offset:4256
    ds_read_b128 v[48:51], v230 offset:4272
    s_waitcnt lgkmcnt(3)
    v_lshlrev_b32 v152, 16, v36
    v_and_b32 v154, 0xffff0000, v36
    v_lshlrev_b32 v156, 16, v37
    v_and_b32 v158, 0xffff0000, v37
    v_lshlrev_b32 v153, 16, v38
    v_and_b32 v155, 0xffff0000, v38
    v_lshlrev_b32 v157, 16, v39
    v_and_b32 v159, 0xffff0000, v39
    s_waitcnt lgkmcnt(2)
    v_lshlrev_b32 v160, 16, v40
    v_and_b32 v162, 0xffff0000, v40
    v_lshlrev_b32 v164, 16, v41
    v_and_b32 v166, 0xffff0000, v41
    v_lshlrev_b32 v161, 16, v42
    v_and_b32 v163, 0xffff0000, v42
    v_lshlrev_b32 v165, 16, v43
    v_and_b32 v167, 0xffff0000, v43
    s_waitcnt lgkmcnt(1)
    v_lshlrev_b32 v168, 16, v44
    v_and_b32 v170, 0xffff0000, v44
    v_lshlrev_b32 v172, 16, v45
    v_and_b32 v174, 0xffff0000, v45
    v_lshlrev_b32 v169, 16, v46
    v_and_b32 v171, 0xffff0000, v46
    v_lshlrev_b32 v173, 16, v47
    v_and_b32 v175, 0xffff0000, v47
    s_waitcnt lgkmcnt(0)
    v_lshlrev_b32 v176, 16, v48
    v_and_b32 v178, 0xffff0000, v48
    v_lshlrev_b32 v180, 16, v49
    v_and_b32 v182, 0xffff0000, v49
    v_lshlrev_b32 v177, 16, v50
    v_and_b32 v179, 0xffff0000, v50
    v_lshlrev_b32 v181, 16, v51
    v_and_b32 v183, 0xffff0000, v51
    v_mov_b64 v[36:37], 0
    v_mov_b64 v[38:39], 0
    v_mov_b64 v[40:41], 0
    v_mov_b64 v[42:43], 0
    v_mov_b64 v[44:45], 0
    v_mov_b64 v[46:47], 0
    v_mov_b64 v[48:49], 0
    v_mov_b64 v[50:51], 0
    s_waitcnt vmcnt(10)
    v_lshlrev_b32 v184, 16, v108
    v_and_b32 v185, 0xffff0000, v108
    v_lshlrev_b32 v186, 16, v109
    v_and_b32 v187, 0xffff0000, v109
    v_lshlrev_b32 v188, 16, v110
    v_and_b32 v189, 0xffff0000, v110
    v_lshlrev_b32 v190, 16, v111
    v_and_b32 v191, 0xffff0000, v111
    v_pk_mul_f32 v[4:5], v[184:185], v[158:159]
    v_pk_mul_f32 v[12:13], v[186:187], v[166:167]
    v_pk_mul_f32 v[20:21], v[188:189], v[174:175]
    v_pk_mul_f32 v[28:29], v[190:191], v[182:183]
    s_waitcnt vmcnt(9)
    v_lshlrev_b32 v184, 16, v112
    v_and_b32 v185, 0xffff0000, v112
    v_lshlrev_b32 v186, 16, v113
    v_and_b32 v187, 0xffff0000, v113
    v_lshlrev_b32 v188, 16, v114
    v_and_b32 v189, 0xffff0000, v114
    v_lshlrev_b32 v190, 16, v115
    v_and_b32 v191, 0xffff0000, v115
    v_pk_fma_f32 v[4:5], v[184:185], v[156:157], v[4:5]
    v_pk_fma_f32 v[12:13], v[186:187], v[164:165], v[12:13]
    v_pk_fma_f32 v[20:21], v[188:189], v[172:173], v[20:21]
    v_pk_fma_f32 v[28:29], v[190:191], v[180:181], v[28:29]
    v_pk_mul_f32 v[6:7], v[184:185], v[158:159]
    v_pk_mul_f32 v[14:15], v[186:187], v[166:167]
    v_pk_mul_f32 v[22:23], v[188:189], v[174:175]
    v_pk_mul_f32 v[30:31], v[190:191], v[182:183]
    s_waitcnt vmcnt(8)
    v_lshlrev_b32 v184, 16, v116
    v_and_b32 v185, 0xffff0000, v116
    v_lshlrev_b32 v186, 16, v117
    v_and_b32 v187, 0xffff0000, v117
    v_lshlrev_b32 v188, 16, v118
    v_and_b32 v189, 0xffff0000, v118
    v_lshlrev_b32 v190, 16, v119
    v_and_b32 v191, 0xffff0000, v119
    v_pk_fma_f32 v[4:5], v[184:185], v[154:155], v[4:5]
    v_pk_fma_f32 v[12:13], v[186:187], v[162:163], v[12:13]
    v_pk_fma_f32 v[20:21], v[188:189], v[170:171], v[20:21]
    v_pk_fma_f32 v[28:29], v[190:191], v[178:179], v[28:29]
    v_pk_fma_f32 v[6:7], v[184:185], v[156:157], v[6:7]
    v_pk_fma_f32 v[14:15], v[186:187], v[164:165], v[14:15]
    v_pk_fma_f32 v[22:23], v[188:189], v[172:173], v[22:23]
    v_pk_fma_f32 v[30:31], v[190:191], v[180:181], v[30:31]
    v_pk_mul_f32 v[8:9], v[184:185], v[158:159]
    v_pk_mul_f32 v[16:17], v[186:187], v[166:167]
    v_pk_mul_f32 v[24:25], v[188:189], v[174:175]
    v_pk_mul_f32 v[32:33], v[190:191], v[182:183]
    s_waitcnt vmcnt(7)
    v_lshlrev_b32 v184, 16, v120
    v_and_b32 v185, 0xffff0000, v120
    v_lshlrev_b32 v186, 16, v121
    v_and_b32 v187, 0xffff0000, v121
    v_lshlrev_b32 v188, 16, v122
    v_and_b32 v189, 0xffff0000, v122
    v_lshlrev_b32 v190, 16, v123
    v_and_b32 v191, 0xffff0000, v123
    v_pk_fma_f32 v[4:5], v[184:185], v[152:153], v[4:5]
    v_pk_fma_f32 v[12:13], v[186:187], v[160:161], v[12:13]
    v_pk_fma_f32 v[20:21], v[188:189], v[168:169], v[20:21]
    v_pk_fma_f32 v[28:29], v[190:191], v[176:177], v[28:29]
    v_pk_fma_f32 v[6:7], v[184:185], v[154:155], v[6:7]
    v_pk_fma_f32 v[14:15], v[186:187], v[162:163], v[14:15]
    v_pk_fma_f32 v[22:23], v[188:189], v[170:171], v[22:23]
    v_pk_fma_f32 v[30:31], v[190:191], v[178:179], v[30:31]
    v_pk_fma_f32 v[8:9], v[184:185], v[156:157], v[8:9]
    v_pk_fma_f32 v[16:17], v[186:187], v[164:165], v[16:17]
    v_pk_fma_f32 v[24:25], v[188:189], v[172:173], v[24:25]
    v_pk_fma_f32 v[32:33], v[190:191], v[180:181], v[32:33]
    v_pk_mul_f32 v[10:11], v[184:185], v[158:159]
    v_pk_mul_f32 v[18:19], v[186:187], v[166:167]
    v_pk_mul_f32 v[26:27], v[188:189], v[174:175]
    v_pk_mul_f32 v[34:35], v[190:191], v[182:183]
    s_waitcnt vmcnt(6)
    v_lshlrev_b32 v184, 16, v124
    v_and_b32 v185, 0xffff0000, v124
    v_lshlrev_b32 v186, 16, v125
    v_and_b32 v187, 0xffff0000, v125
    v_lshlrev_b32 v188, 16, v126
    v_and_b32 v189, 0xffff0000, v126
    v_lshlrev_b32 v190, 16, v127
    v_and_b32 v191, 0xffff0000, v127
    v_pk_fma_f32 v[6:7], v[184:185], v[152:153], v[6:7]
    v_pk_fma_f32 v[14:15], v[186:187], v[160:161], v[14:15]
    v_pk_fma_f32 v[22:23], v[188:189], v[168:169], v[22:23]
    v_pk_fma_f32 v[30:31], v[190:191], v[176:177], v[30:31]
    v_pk_fma_f32 v[8:9], v[184:185], v[154:155], v[8:9]
    v_pk_fma_f32 v[16:17], v[186:187], v[162:163], v[16:17]
    v_pk_fma_f32 v[24:25], v[188:189], v[170:171], v[24:25]
    v_pk_fma_f32 v[32:33], v[190:191], v[178:179], v[32:33]
    v_pk_fma_f32 v[10:11], v[184:185], v[156:157], v[10:11]
    v_pk_fma_f32 v[18:19], v[186:187], v[164:165], v[18:19]
    v_pk_fma_f32 v[26:27], v[188:189], v[172:173], v[26:27]
    v_pk_fma_f32 v[34:35], v[190:191], v[180:181], v[34:35]
    s_waitcnt vmcnt(5)
    v_lshlrev_b32 v184, 16, v128
    v_and_b32 v185, 0xffff0000, v128
    v_lshlrev_b32 v186, 16, v129
    v_and_b32 v187, 0xffff0000, v129
    v_lshlrev_b32 v188, 16, v130
    v_and_b32 v189, 0xffff0000, v130
    v_lshlrev_b32 v190, 16, v131
    v_and_b32 v191, 0xffff0000, v131
    v_pk_fma_f32 v[8:9], v[184:185], v[152:153], v[8:9]
    v_pk_fma_f32 v[16:17], v[186:187], v[160:161], v[16:17]
    v_pk_fma_f32 v[24:25], v[188:189], v[168:169], v[24:25]
    v_pk_fma_f32 v[32:33], v[190:191], v[176:177], v[32:33]
    v_pk_fma_f32 v[10:11], v[184:185], v[154:155], v[10:11]
    v_pk_fma_f32 v[18:19], v[186:187], v[162:163], v[18:19]
    v_pk_fma_f32 v[26:27], v[188:189], v[170:171], v[26:27]
    v_pk_fma_f32 v[34:35], v[190:191], v[178:179], v[34:35]
    s_waitcnt vmcnt(4)
    v_lshlrev_b32 v184, 16, v132
    v_and_b32 v185, 0xffff0000, v132
    v_lshlrev_b32 v186, 16, v133
    v_and_b32 v187, 0xffff0000, v133
    v_lshlrev_b32 v188, 16, v134
    v_and_b32 v189, 0xffff0000, v134
    v_lshlrev_b32 v190, 16, v135
    v_and_b32 v191, 0xffff0000, v135
    v_pk_fma_f32 v[10:11], v[184:185], v[152:153], v[10:11]
    v_pk_fma_f32 v[18:19], v[186:187], v[160:161], v[18:19]
    v_pk_fma_f32 v[26:27], v[188:189], v[168:169], v[26:27]
    v_pk_fma_f32 v[34:35], v[190:191], v[176:177], v[34:35]
    s_waitcnt vmcnt(3)
    v_lshlrev_b32 v184, 16, v136
    v_and_b32 v185, 0xffff0000, v136
    v_lshlrev_b32 v186, 16, v137
    v_and_b32 v187, 0xffff0000, v137
    v_lshlrev_b32 v188, 16, v138
    v_and_b32 v189, 0xffff0000, v138
    v_lshlrev_b32 v190, 16, v139
    v_and_b32 v191, 0xffff0000, v139
    v_pk_mul_f32 v[4:5], v[4:5], v[184:185]
    v_pk_mul_f32 v[12:13], v[12:13], v[186:187]
    v_pk_mul_f32 v[20:21], v[20:21], v[188:189]
    v_pk_mul_f32 v[28:29], v[28:29], v[190:191]
    s_waitcnt vmcnt(2)
    v_lshlrev_b32 v184, 16, v140
    v_and_b32 v185, 0xffff0000, v140
    v_lshlrev_b32 v186, 16, v141
    v_and_b32 v187, 0xffff0000, v141
    v_lshlrev_b32 v188, 16, v142
    v_and_b32 v189, 0xffff0000, v142
    v_lshlrev_b32 v190, 16, v143
    v_and_b32 v191, 0xffff0000, v143
    v_pk_mul_f32 v[6:7], v[6:7], v[184:185]
    v_pk_mul_f32 v[14:15], v[14:15], v[186:187]
    v_pk_mul_f32 v[22:23], v[22:23], v[188:189]
    v_pk_mul_f32 v[30:31], v[30:31], v[190:191]
    s_waitcnt vmcnt(1)
    v_lshlrev_b32 v184, 16, v144
    v_and_b32 v185, 0xffff0000, v144
    v_lshlrev_b32 v186, 16, v145
    v_and_b32 v187, 0xffff0000, v145
    v_lshlrev_b32 v188, 16, v146
    v_and_b32 v189, 0xffff0000, v146
    v_lshlrev_b32 v190, 16, v147
    v_and_b32 v191, 0xffff0000, v147
    v_pk_mul_f32 v[8:9], v[8:9], v[184:185]
    v_pk_mul_f32 v[16:17], v[16:17], v[186:187]
    v_pk_mul_f32 v[24:25], v[24:25], v[188:189]
    v_pk_mul_f32 v[32:33], v[32:33], v[190:191]
    s_waitcnt vmcnt(0)
    v_lshlrev_b32 v184, 16, v148
    v_and_b32 v185, 0xffff0000, v148
    v_lshlrev_b32 v186, 16, v149
    v_and_b32 v187, 0xffff0000, v149
    v_lshlrev_b32 v188, 16, v150
    v_and_b32 v189, 0xffff0000, v150
    v_lshlrev_b32 v190, 16, v151
    v_and_b32 v191, 0xffff0000, v151
    v_pk_mul_f32 v[10:11], v[10:11], v[184:185]
    v_pk_mul_f32 v[18:19], v[18:19], v[186:187]
    v_pk_mul_f32 v[26:27], v[26:27], v[188:189]
    v_pk_mul_f32 v[34:35], v[34:35], v[190:191]
    v_cvt_pk_bf16_f32 v108, v10, v8
    v_cvt_pk_bf16_f32 v109, v6, v4
    ds_write_b64 v231, v[108:109] offset:0
    v_cvt_pk_bf16_f32 v110, v11, v9
    v_cvt_pk_bf16_f32 v111, v7, v5
    ds_write_b64 v231, v[110:111] offset:64
    v_cvt_pk_bf16_f32 v112, v18, v16
    v_cvt_pk_bf16_f32 v113, v14, v12
    ds_write_b64 v231, v[112:113] offset:128
    v_cvt_pk_bf16_f32 v114, v19, v17
    v_cvt_pk_bf16_f32 v115, v15, v13
    ds_write_b64 v231, v[114:115] offset:192
    v_cvt_pk_bf16_f32 v116, v26, v24
    v_cvt_pk_bf16_f32 v117, v22, v20
    ds_write_b64 v231, v[116:117] offset:256
    v_cvt_pk_bf16_f32 v118, v27, v25
    v_cvt_pk_bf16_f32 v119, v23, v21
    ds_write_b64 v231, v[118:119] offset:320
    v_cvt_pk_bf16_f32 v120, v34, v32
    v_cvt_pk_bf16_f32 v121, v30, v28
    ds_write_b64 v231, v[120:121] offset:384
    v_cvt_pk_bf16_f32 v122, v35, v33
    v_cvt_pk_bf16_f32 v123, v31, v29
    ds_write_b64 v231, v[122:123] offset:448
    ds_read_b128 v[234:237], v232 offset:0
    ds_read_b128 v[238:241], v232 offset:1056
    ds_read_b128 v[242:245], v232 offset:2112
    ds_read_b128 v[246:249], v232 offset:3168
    v_mov_b64 v[4:5], 0
    v_mov_b64 v[6:7], 0
    v_mov_b64 v[8:9], 0
    v_mov_b64 v[10:11], 0
    v_mov_b64 v[12:13], 0
    v_mov_b64 v[14:15], 0
    v_mov_b64 v[16:17], 0
    v_mov_b64 v[18:19], 0
    v_mov_b64 v[20:21], 0
    v_mov_b64 v[22:23], 0
    v_mov_b64 v[24:25], 0
    v_mov_b64 v[26:27], 0
    v_mov_b64 v[28:29], 0
    v_mov_b64 v[30:31], 0
    v_mov_b64 v[32:33], 0
    v_mov_b64 v[34:35], 0
    s_waitcnt lgkmcnt(0)
    s_and_b32 s37, s2, 7
    s_xor_b32 s37, s37, 2
    s_lshl_b32 s37, s37, 5
    s_lshr_b32 s38, s2, 3
    s_add_u32 s37, s37, s38
    s_add_u32 s37, s37, 256
    s_lshl_b32 s37, s37, 8
    s_cmp_eq_u32 s33, 0
    s_cselect_b32 s37, s37, s57
    s_cmp_eq_u32 s32, 0
    s_cbranch_scc0 L_noclear
    s_mov_b64 exec, 1
    buffer_store_dword v4, off, s[52:55], s37 sc1
    s_mov_b64 exec, -1
L_noclear:
    s_mov_b32 s37, 41984
    s_mov_b32 s36, 15
    s_barrier
    ds_read_b128 v[108:111], v196 offset:0
    ds_read_b64_tr_b16 v[128:129], v200 offset:0
    ds_read_b64_tr_b16 v[130:131], v200 offset:512
    ds_read_b128 v[112:115], v196 offset:2048
    ds_read_b64_tr_b16 v[132:133], v201 offset:0
    ds_read_b64_tr_b16 v[134:135], v201 offset:512
    ds_read_b128 v[116:119], v196 offset:4096
    ds_read_b64_tr_b16 v[136:137], v200 offset:8192
    ds_read_b64_tr_b16 v[138:139], v200 offset:8704
    ds_read_b128 v[120:123], v196 offset:6144
    ds_read_b64_tr_b16 v[140:141], v201 offset:8192
    ds_read_b64_tr_b16 v[142:143], v201 offset:8704
    ds_read_b128 v[124:127], v198
    ds_read_b64_tr_b16 v[144:145], v200 offset:16384
    ds_read_b64_tr_b16 v[146:147], v200 offset:16896
    ds_read_b64_tr_b16 v[148:149], v201 offset:16384
    ds_read_b64_tr_b16 v[150:151], v201 offset:16896
    s_mov_b32 s87, 0
    buffer_store_dwordx4 v[234:237], v233, s[80:83], s87 offen sc1
    s_mov_b32 s87, 67584
    buffer_store_dwordx4 v[238:241], v233, s[80:83], s87 offen sc1
    s_mov_b32 s87, 135168
    buffer_store_dwordx4 v[242:245], v233, s[80:83], s87 offen sc1
    s_mov_b32 s87, 202752
    buffer_store_dwordx4 v[246:249], v233, s[80:83], s87 offen sc1
    s_waitcnt lgkmcnt(0)
L_g1_loop:
    v_mfma_f32_16x16x32_bf16 v[4:7], v[128:131], v[108:111], v[4:7]
    ds_read_b128 v[152:155], v197 offset:0
    v_mfma_f32_16x16x32_bf16 v[12:15], v[128:131], v[112:115], v[12:15]
    ds_read_b64_tr_b16 v[172:173], v200 offset:4096
    v_mfma_f32_16x16x32_bf16 v[20:23], v[128:131], v[116:119], v[20:23]
    ds_read_b64_tr_b16 v[174:175], v200 offset:4608
    v_mfma_f32_16x16x32_bf16 v[28:31], v[128:131], v[120:123], v[28:31]
    ds_read_b128 v[156:159], v197 offset:2048
    v_mfma_f32_16x16x32_bf16 v[32:35], v[132:135], v[120:123], v[32:35]
    ds_read_b64_tr_b16 v[176:177], v201 offset:4096
    v_mfma_f32_16x16x32_bf16 v[24:27], v[132:135], v[116:119], v[24:27]
    ds_read_b64_tr_b16 v[178:179], v201 offset:4608
    v_mfma_f32_16x16x32_bf16 v[16:19], v[132:135], v[112:115], v[16:19]
    ds_read_b128 v[160:163], v197 offset:4096
    v_mfma_f32_16x16x32_bf16 v[8:11], v[132:135], v[108:111], v[8:11]
    ds_read_b64_tr_b16 v[180:181], v200 offset:12288
    v_mfma_f32_16x16x32_bf16 v[40:43], v[140:143], v[108:111], v[40:43]
    ds_read_b64_tr_b16 v[182:183], v200 offset:12800
    v_mfma_f32_16x16x32_bf16 v[48:51], v[140:143], v[112:115], v[48:51]
    ds_read_b128 v[164:167], v197 offset:6144
    v_mfma_f32_16x16x32_bf16 v[56:59], v[140:143], v[116:119], v[56:59]
    ds_read_b64_tr_b16 v[184:185], v201 offset:12288
    v_mfma_f32_16x16x32_bf16 v[64:67], v[140:143], v[120:123], v[64:67]
    ds_read_b64_tr_b16 v[186:187], v201 offset:12800
    v_mfma_f32_16x16x32_bf16 v[60:63], v[136:139], v[120:123], v[60:63]
    ds_read_b128 v[168:171], v199
    v_mfma_f32_16x16x32_bf16 v[52:55], v[136:139], v[116:119], v[52:55]
    ds_read_b64_tr_b16 v[188:189], v200 offset:20480
    v_mfma_f32_16x16x32_bf16 v[44:47], v[136:139], v[112:115], v[44:47]
    ds_read_b64_tr_b16 v[190:191], v200 offset:20992
    v_mfma_f32_16x16x32_bf16 v[36:39], v[136:139], v[108:111], v[36:39]
    ds_read_b64_tr_b16 v[192:193], v201 offset:20480
    v_mfma_f32_16x16x32_bf16 v[100:103], v[136:139], v[124:127], v[100:103]
    ds_read_b64_tr_b16 v[194:195], v201 offset:20992
    v_mfma_f32_16x16x32_bf16 v[104:107], v[124:127], v[144:147], v[104:107]
    ds_read_b32 v1, v228 offset:24
    v_mfma_f32_16x16x32_bf16 v[68:71], v[108:111], v[144:147], v[68:71]
    s_add_u32 s34, s34, 41984
    s_cmp_eq_u32 s34, 125952
    v_mfma_f32_16x16x32_bf16 v[76:79], v[112:115], v[144:147], v[76:79]
    s_cselect_b32 s35, -83968, s37
    s_cselect_b32 s34, 0, s34
    v_mfma_f32_16x16x32_bf16 v[84:87], v[116:119], v[144:147], v[84:87]
    s_bitcmp1_b32 0x1002, s36
    v_add_u32 v196, s35, v196
    v_mfma_f32_16x16x32_bf16 v[92:95], v[120:123], v[144:147], v[92:95]
    v_add_u32 v197, s35, v197
    v_add_u32 v198, s35, v198
    v_mfma_f32_16x16x32_bf16 v[96:99], v[120:123], v[148:151], v[96:99]
    v_add_u32 v199, s35, v199
    v_add_u32 v200, s35, v200
    v_mfma_f32_16x16x32_bf16 v[88:91], v[116:119], v[148:151], v[88:91]
    v_add_u32 v201, s35, v201
    v_mfma_f32_16x16x32_bf16 v[80:83], v[112:115], v[148:151], v[80:83]
    s_waitcnt lgkmcnt(0)
    v_mfma_f32_16x16x32_bf16 v[72:75], v[108:111], v[148:151], v[72:75]
    s_cbranch_scc1 L_g1_rare
L_g1_bar:
    s_barrier
L_g1_nobar:
    v_mfma_f32_16x16x32_bf16 v[4:7], v[172:175], v[152:155], v[4:7]
    ds_read_b128 v[108:111], v196 offset:0
    v_mfma_f32_16x16x32_bf16 v[12:15], v[172:175], v[156:159], v[12:15]
    ds_read_b64_tr_b16 v[128:129], v200 offset:0
    v_mfma_f32_16x16x32_bf16 v[20:23], v[172:175], v[160:163], v[20:23]
    ds_read_b64_tr_b16 v[130:131], v200 offset:512
    v_mfma_f32_16x16x32_bf16 v[28:31], v[172:175], v[164:167], v[28:31]
    ds_read_b128 v[112:115], v196 offset:2048
    v_mfma_f32_16x16x32_bf16 v[32:35], v[176:179], v[164:167], v[32:35]
    ds_read_b64_tr_b16 v[132:133], v201 offset:0
    v_mfma_f32_16x16x32_bf16 v[24:27], v[176:179], v[160:163], v[24:27]
    ds_read_b64_tr_b16 v[134:135], v201 offset:512
    v_mfma_f32_16x16x32_bf16 v[16:19], v[176:179], v[156:159], v[16:19]
    ds_read_b128 v[116:119], v196 offset:4096
    v_mfma_f32_16x16x32_bf16 v[8:11], v[176:179], v[152:155], v[8:11]
    ds_read_b64_tr_b16 v[136:137], v200 offset:8192
    v_mfma_f32_16x16x32_bf16 v[40:43], v[184:187], v[152:155], v[40:43]
    ds_read_b64_tr_b16 v[138:139], v200 offset:8704
    v_mfma_f32_16x16x32_bf16 v[48:51], v[184:187], v[156:159], v[48:51]
    ds_read_b128 v[120:123], v196 offset:6144
    v_mfma_f32_16x16x32_bf16 v[56:59], v[184:187], v[160:163], v[56:59]
    ds_read_b64_tr_b16 v[140:141], v201 offset:8192
    v_mfma_f32_16x16x32_bf16 v[64:67], v[184:187], v[164:167], v[64:67]
    ds_read_b64_tr_b16 v[142:143], v201 offset:8704
    v_mfma_f32_16x16x32_bf16 v[60:63], v[180:183], v[164:167], v[60:63]
    ds_read_b128 v[124:127], v198
    v_mfma_f32_16x16x32_bf16 v[52:55], v[180:183], v[160:163], v[52:55]
    ds_read_b64_tr_b16 v[144:145], v200 offset:16384
    v_mfma_f32_16x16x32_bf16 v[44:47], v[180:183], v[156:159], v[44:47]
    ds_read_b64_tr_b16 v[146:147], v200 offset:16896
    v_mfma_f32_16x16x32_bf16 v[36:39], v[180:183], v[152:155], v[36:39]
    ds_read_b64_tr_b16 v[148:149], v201 offset:16384
    v_mfma_f32_16x16x32_bf16 v[100:103], v[180:183], v[168:171], v[100:103]
    ds_read_b64_tr_b16 v[150:151], v201 offset:16896
    v_mfma_f32_16x16x32_bf16 v[104:107], v[168:171], v[188:191], v[104:107]
    s_sub_u32 s36, s36, 1
    v_mfma_f32_16x16x32_bf16 v[68:71], v[152:155], v[188:191], v[68:71]
    s_cmp_lg_u32 s36, 0
    v_mfma_f32_16x16x32_bf16 v[76:79], v[156:159], v[188:191], v[76:79]
    v_mfma_f32_16x16x32_bf16 v[84:87], v[160:163], v[188:191], v[84:87]
    v_mfma_f32_16x16x32_bf16 v[92:95], v[164:167], v[188:191], v[92:95]
    v_mfma_f32_16x16x32_bf16 v[96:99], v[164:167], v[192:195], v[96:99]
    v_mfma_f32_16x16x32_bf16 v[88:91], v[160:163], v[192:195], v[88:91]
    v_mfma_f32_16x16x32_bf16 v[80:83], v[156:159], v[192:195], v[80:83]
    s_waitcnt lgkmcnt(0)
    v_mfma_f32_16x16x32_bf16 v[72:75], v[152:155], v[192:195], v[72:75]
    s_cbranch_scc1 L_g1_loop
    v_mfma_f32_16x16x32_bf16 v[4:7], v[128:131], v[108:111], v[4:7]
    ds_read_b128 v[152:155], v197 offset:0
    v_mfma_f32_16x16x32_bf16 v[12:15], v[128:131], v[112:115], v[12:15]
    ds_read_b64_tr_b16 v[172:173], v200 offset:4096
    v_mfma_f32_16x16x32_bf16 v[20:23], v[128:131], v[116:119], v[20:23]
    ds_read_b64_tr_b16 v[174:175], v200 offset:4608
    v_mfma_f32_16x16x32_bf16 v[28:31], v[128:131], v[120:123], v[28:31]
    ds_read_b128 v[156:159], v197 offset:2048
    v_mfma_f32_16x16x32_bf16 v[32:35], v[132:135], v[120:123], v[32:35]
    ds_read_b64_tr_b16 v[176:177], v201 offset:4096
    v_mfma_f32_16x16x32_bf16 v[24:27], v[132:135], v[116:119], v[24:27]
    ds_read_b64_tr_b16 v[178:179], v201 offset:4608
    v_mfma_f32_16x16x32_bf16 v[16:19], v[132:135], v[112:115], v[16:19]
    ds_read_b128 v[160:163], v197 offset:4096
    v_mfma_f32_16x16x32_bf16 v[8:11], v[132:135], v[108:111], v[8:11]
    ds_read_b64_tr_b16 v[180:181], v200 offset:12288
    v_mfma_f32_16x16x32_bf16 v[40:43], v[140:143], v[108:111], v[40:43]
    ds_read_b64_tr_b16 v[182:183], v200 offset:12800
    v_mfma_f32_16x16x32_bf16 v[48:51], v[140:143], v[112:115], v[48:51]
    ds_read_b128 v[164:167], v197 offset:6144
    v_mfma_f32_16x16x32_bf16 v[56:59], v[140:143], v[116:119], v[56:59]
    ds_read_b64_tr_b16 v[184:185], v201 offset:12288
    v_mfma_f32_16x16x32_bf16 v[64:67], v[140:143], v[120:123], v[64:67]
    ds_read_b64_tr_b16 v[186:187], v201 offset:12800
    v_mfma_f32_16x16x32_bf16 v[60:63], v[136:139], v[120:123], v[60:63]
    ds_read_b128 v[168:171], v199
    v_mfma_f32_16x16x32_bf16 v[52:55], v[136:139], v[116:119], v[52:55]
    ds_read_b64_tr_b16 v[188:189], v200 offset:20480
    v_mfma_f32_16x16x32_bf16 v[44:47], v[136:139], v[112:115], v[44:47]
    ds_read_b64_tr_b16 v[190:191], v200 offset:20992
    v_mfma_f32_16x16x32_bf16 v[36:39], v[136:139], v[108:111], v[36:39]
    ds_read_b64_tr_b16 v[192:193], v201 offset:20480
    v_mfma_f32_16x16x32_bf16 v[100:103], v[136:139], v[124:127], v[100:103]
    ds_read_b64_tr_b16 v[194:195], v201 offset:20992
    v_mfma_f32_16x16x32_bf16 v[104:107], v[124:127], v[144:147], v[104:107]
    v_mfma_f32_16x16x32_bf16 v[68:71], v[108:111], v[144:147], v[68:71]
    v_mfma_f32_16x16x32_bf16 v[76:79], v[112:115], v[144:147], v[76:79]
    v_mfma_f32_16x16x32_bf16 v[84:87], v[116:119], v[144:147], v[84:87]
    v_mfma_f32_16x16x32_bf16 v[92:95], v[120:123], v[144:147], v[92:95]
    v_mfma_f32_16x16x32_bf16 v[96:99], v[120:123], v[148:151], v[96:99]
    v_mfma_f32_16x16x32_bf16 v[88:91], v[116:119], v[148:151], v[88:91]
    v_mfma_f32_16x16x32_bf16 v[80:83], v[112:115], v[148:151], v[80:83]
    v_mfma_f32_16x16x32_bf16 v[72:75], v[108:111], v[148:151], v[72:75]
    s_waitcnt lgkmcnt(0)
    s_setprio 2
    v_mov_b32 v2, 1
    v_mfma_f32_16x16x32_bf16 v[100:103], v[180:183], v[168:171], v[100:103]
    v_mfma_f32_16x16x32_bf16 v[104:107], v[168:171], v[188:191], v[104:107]
    v_mfma_f32_16x16x32_bf16 v[60:63], v[180:183], v[164:167], v[60:63]
    v_mfma_f32_16x16x32_bf16 v[64:67], v[184:187], v[164:167], v[64:67]
    v_mfma_f32_16x16x32_bf16 v[92:95], v[164:167], v[188:191], v[92:95]
    v_mfma_f32_16x16x32_bf16 v[96:99], v[164:167], v[192:195], v[96:99]
    v_mfma_f32_16x16x32_bf16 v[28:31], v[172:175], v[164:167], v[28:31]
    v_mfma_f32_16x16x32_bf16 v[32:35], v[176:179], v[164:167], v[32:35]
    v_mfma_f32_16x16x32_bf16 v[52:55], v[180:183], v[160:163], v[52:55]
    v_cvt_pk_bf16_f32 v144, v100, v101
    v_cvt_pk_bf16_f32 v145, v102, v103
    v_mfma_f32_16x16x32_bf16 v[56:59], v[184:187], v[160:163], v[56:59]
    ds_write_b64 v219, v[144:145]
    v_cvt_pk_bf16_f32 v146, v104, v105
    v_mfma_f32_16x16x32_bf16 v[20:23], v[172:175], v[160:163], v[20:23]
    v_cvt_pk_bf16_f32 v147, v106, v107
    ds_write_b64 v219, v[146:147] offset:1024
    v_mfma_f32_16x16x32_bf16 v[24:27], v[176:179], v[160:163], v[24:27]
    v_cvt_pk_bf16_f32 v140, v60, v61
    v_cvt_pk_bf16_f32 v141, v62, v63
    v_mfma_f32_16x16x32_bf16 v[44:47], v[180:183], v[156:159], v[44:47]
    v_cvt_pk_bf16_f32 v142, v64, v65
    v_cvt_pk_bf16_f32 v143, v66, v67
    v_mfma_f32_16x16x32_bf16 v[48:51], v[184:187], v[156:159], v[48:51]
    v_cvt_pk_bf16_f32 v238, v92, v93
    v_cvt_pk_bf16_f32 v239, v94, v95
    v_mfma_f32_16x16x32_bf16 v[12:15], v[172:175], v[156:159], v[12:15]
    v_cvt_pk_bf16_f32 v248, v96, v97
    v_cvt_pk_bf16_f32 v249, v98, v99
    v_mfma_f32_16x16x32_bf16 v[16:19], v[176:179], v[156:159], v[16:19]
    s_cmp_eq_u32 s33, 0
    s_cbranch_scc0 L_at_nopub
    ds_write_b64 v220, v[140:141] offset:2048
    ds_write_b64 v220, v[238:239] offset:3072
    ds_write_b64 v220, v[142:143] offset:2560
    ds_write_b64 v220, v[248:249] offset:3584
L_at_nopub:
    s_mov_b64 exec, 1
    ds_add_u32 v228, v2 offset:20
    s_mov_b64 exec, -1
    v_cvt_pk_bf16_f32 v120, v28, v29
    v_mfma_f32_16x16x32_bf16 v[36:39], v[180:183], v[152:155], v[36:39]
    v_cvt_pk_bf16_f32 v121, v30, v31
    v_cvt_pk_bf16_f32 v122, v32, v33
    v_mfma_f32_16x16x32_bf16 v[40:43], v[184:187], v[152:155], v[40:43]
    v_cvt_pk_bf16_f32 v123, v34, v35
    v_cvt_pk_bf16_f32 v136, v52, v53
    v_mfma_f32_16x16x32_bf16 v[4:7], v[172:175], v[152:155], v[4:7]
    v_cvt_pk_bf16_f32 v137, v54, v55
    v_cvt_pk_bf16_f32 v138, v56, v57
    v_mfma_f32_16x16x32_bf16 v[8:11], v[176:179], v[152:155], v[8:11]
    v_cvt_pk_bf16_f32 v139, v58, v59
    v_cvt_pk_bf16_f32 v116, v20, v21
    v_mfma_f32_16x16x32_bf16 v[84:87], v[160:163], v[188:191], v[84:87]
    v_cvt_pk_bf16_f32 v117, v22, v23
    v_cvt_pk_bf16_f32 v118, v24, v25
    v_mfma_f32_16x16x32_bf16 v[88:91], v[160:163], v[192:195], v[88:91]
    v_cvt_pk_bf16_f32 v119, v26, v27
    v_cvt_pk_bf16_f32 v132, v44, v45
    v_mfma_f32_16x16x32_bf16 v[76:79], v[156:159], v[188:191], v[76:79]
    v_cvt_pk_bf16_f32 v133, v46, v47
    v_cvt_pk_bf16_f32 v134, v48, v49
    v_mfma_f32_16x16x32_bf16 v[80:83], v[156:159], v[192:195], v[80:83]
    v_cvt_pk_bf16_f32 v135, v50, v51
    v_cvt_pk_bf16_f32 v112, v12, v13
    v_mfma_f32_16x16x32_bf16 v[68:71], v[152:155], v[188:191], v[68:71]
    v_cvt_pk_bf16_f32 v113, v14, v15
    v_cvt_pk_bf16_f32 v114, v16, v17
    v_mfma_f32_16x16x32_bf16 v[72:75], v[152:155], v[192:195], v[72:75]
    v_cvt_pk_bf16_f32 v115, v18, v19
    v_cvt_pk_bf16_f32 v128, v36, v37
    v_mfma_f32_16x16x32_bf16 v[28:31], v[140:143], v[120:123], v[204:207]
    v_cvt_pk_bf16_f32 v129, v38, v39
    v_cvt_pk_bf16_f32 v130, v40, v41
    v_mfma_f32_16x16x32_bf16 v[32:35], v[136:139], v[120:123], v[208:211]
    v_cvt_pk_bf16_f32 v131, v42, v43
    v_cvt_pk_bf16_f32 v108, v4, v5
    v_mfma_f32_16x16x32_bf16 v[20:23], v[136:139], v[116:119], v[204:207]
    v_cvt_pk_bf16_f32 v109, v6, v7
    v_cvt_pk_bf16_f32 v110, v8, v9
    v_mfma_f32_16x16x32_bf16 v[24:27], v[132:135], v[116:119], v[208:211]
    v_cvt_pk_bf16_f32 v111, v10, v11
    v_cvt_pk_bf16_f32 v236, v84, v85
    v_mfma_f32_16x16x32_bf16 v[12:15], v[132:135], v[112:115], v[204:207]
    v_cvt_pk_bf16_f32 v237, v86, v87
    v_cvt_pk_bf16_f32 v246, v88, v89
    v_mfma_f32_16x16x32_bf16 v[16:19], v[128:131], v[112:115], v[208:211]
    v_cvt_pk_bf16_f32 v247, v90, v91
    v_cvt_pk_bf16_f32 v234, v76, v77
    v_mfma_f32_16x16x32_bf16 v[4:7], v[128:131], v[108:111], v[204:207]
    v_cvt_pk_bf16_f32 v235, v78, v79
    ds_read_b32 v1, v228 offset:20
    v_cvt_pk_bf16_f32 v244, v80, v81
    v_cvt_pk_bf16_f32 v245, v82, v83
    v_cvt_pk_bf16_f32 v232, v68, v69
    v_cvt_pk_bf16_f32 v233, v70, v71
    v_cvt_pk_bf16_f32 v242, v72, v73
    v_cvt_pk_bf16_f32 v243, v74, v75
    s_waitcnt lgkmcnt(0)
    v_readfirstlane_b32 s37, v1
    s_nop 0
    s_cmp_ge_u32 s37, 4
    s_cbranch_scc1 L_sl_done_42
    s_mov_b32 s38, 1048576
L_sl_loop_43:
    ds_read_b32 v1, v228 offset:20
    s_waitcnt lgkmcnt(0)
    v_readfirstlane_b32 s37, v1
    s_nop 0
    s_cmp_ge_u32 s37, 4
    s_cbranch_scc1 L_sl_done_42
    s_sleep 1
    s_sub_u32 s38, s38, 1
    s_cbranch_scc0 L_sl_loop_43
L_sl_done_42:
    ds_read_b64 v[124:125], v221
    ds_read_b64 v[126:127], v222
    ds_read_b64 v[230:231], v221 offset:1024
    ds_read_b64 v[240:241], v222 offset:1024
    v_max_f32 v28, v28, v32
    v_max_f32 v29, v29, v33
    v_max_f32 v30, v30, v34
    v_max_f32 v31, v31, v35
    v_max3_f32 v39, v28, v29, v30
    v_max_f32 v39, v39, v31
    v_max_f32 v20, v20, v24
    v_max_f32 v21, v21, v25
    v_max_f32 v22, v22, v26
    v_max_f32 v23, v23, v27
    v_max3_f32 v38, v20, v21, v22
    v_max_f32 v38, v38, v23
    s_waitcnt lgkmcnt(2)
    v_mfma_f32_16x16x32_bf16 v[8:11], v[124:127], v[108:111], v[212:215]
    s_setprio 2
    s_add_u32 m0, s60, 0
    s_mov_b32 s37, 0x3e8293ee
    v_max_f32 v12, v12, v16
    v_max_f32 v13, v13, v17
    s_xor_b32 s63, s62, 0
    v_max_f32 v14, v14, v18
    v_max_f32 v15, v15, v19
    v_max3_f32 v37, v12, v13, v14
    buffer_load_dwordx4 v227, s[44:47], s63 offen offset:0 lds
    v_max_f32 v37, v37, v15
    v_max_f32 v4, v4, v8
    v_max_f32 v5, v5, v9
    buffer_load_dwordx4 v223, s[44:47], s63 offen offset:1024 lds
    v_max_f32 v6, v6, v10
    v_max_f32 v7, v7, v11
    v_max3_f32 v36, v4, v5, v6
    s_add_u32 m0, s60, 8192
    v_max_f32 v36, v36, v7
    v_permlane32_swap_b32 v38, v39
    s_nop 0
    v_permlane32_swap_b32 v36, v37
    s_xor_b32 s63, s62, 131072
    v_max_f32 v38, v38, v39
    v_max_f32 v36, v36, v37
    s_nop 1
    v_permlane16_swap_b32 v36, v38
    buffer_load_dwordx4 v227, s[44:47], s63 offen offset:0 lds
    v_max_f32 v36, v36, v38
    v_mul_f32 v38, s37, v36
    v_mul_f32 v36, s37, v36
    buffer_load_dwordx4 v223, s[44:47], s63 offen offset:1024 lds
    s_nop 0
    v_permlane16_swap_b32 v36, v38
    v_mov_b32 v37, v36
    v_mov_b32 v39, v38
    s_add_u32 m0, s60, 16384
    v_permlane32_swap_b32 v36, v37
    v_permlane32_swap_b32 v38, v39
    v_fma_f32 v4, v4, s37, -v36
    s_xor_b32 s63, s62, 262144
    v_fma_f32 v5, v5, s37, -v36
    v_fma_f32 v6, v6, s37, -v36
    v_fma_f32 v7, v7, s37, -v36
    buffer_load_dwordx4 v227, s[44:47], s63 offen offset:0 lds
    v_fma_f32 v12, v12, s37, -v37
    v_fma_f32 v13, v13, s37, -v37
    v_fma_f32 v14, v14, s37, -v37
    buffer_load_dwordx4 v223, s[44:47], s63 offen offset:1024 lds
    v_fma_f32 v15, v15, s37, -v37
    v_fma_f32 v20, v20, s37, -v38
    v_fma_f32 v21, v21, s37, -v38
    s_add_u32 m0, s60, 24576
    v_fma_f32 v22, v22, s37, -v38
    v_fma_f32 v23, v23, s37, -v38
    v_fma_f32 v28, v28, s37, -v39
    s_xor_b32 s63, s62, 393216
    v_fma_f32 v29, v29, s37, -v39
    v_fma_f32 v30, v30, s37, -v39
    v_fma_f32 v31, v31, s37, -v39
    buffer_load_dwordx4 v227, s[44:47], s63 offen offset:0 lds
    v_exp_f32 v28, v28
    v_exp_f32 v29, v29
    v_exp_f32 v30, v30
    buffer_load_dwordx4 v223, s[44:47], s63 offen offset:1024 lds
    v_exp_f32 v31, v31
    v_exp_f32 v20, v20
    v_exp_f32 v21, v21
    s_add_u32 m0, s60, 32768
    v_exp_f32 v22, v22
    v_exp_f32 v23, v23
    v_exp_f32 v12, v12
    s_xor_b32 s63, s62, 524288
    v_exp_f32 v13, v13
    v_exp_f32 v14, v14
    v_exp_f32 v15, v15
    buffer_load_dwordx4 v227, s[44:47], s63 offen offset:0 lds
    v_exp_f32 v4, v4
    v_exp_f32 v5, v5
    v_exp_f32 v6, v6
    buffer_load_dwordx4 v223, s[44:47], s63 offen offset:1024 lds
    v_exp_f32 v7, v7
    v_add_f32 v39, v28, v29
    v_add_f32 v32, v30, v31
    s_add_u32 m0, s60, 83968
    v_add_f32 v39, v39, v32
    v_add_f32 v38, v20, v21
    v_add_f32 v24, v22, v23
    s_xor_b32 s63, s62, 655360
    v_add_f32 v38, v38, v24
    v_add_f32 v37, v12, v13
    v_add_f32 v16, v14, v15
    buffer_load_dwordx4 v227, s[44:47], s63 offen offset:0 lds
    v_add_f32 v37, v37, v16
    v_add_f32 v36, v4, v5
    v_add_f32 v8, v6, v7
    buffer_load_dwordx4 v223, s[44:47], s63 offen offset:1024 lds
    v_add_f32 v36, v36, v8
    v_permlane32_swap_b32 v38, v39
    s_nop 0
    v_permlane32_swap_b32 v36, v37
    s_add_u32 m0, s60, 92160
    v_add_f32 v38, v38, v39
    v_add_f32 v36, v36, v37
    s_nop 1
    v_permlane16_swap_b32 v36, v38
    s_xor_b32 s63, s62, 786432
    v_add_f32 v36, v36, v38
    v_rcp_f32 v38, v36
    v_rcp_f32 v36, v36
    buffer_load_dwordx4 v227, s[44:47], s63 offen offset:0 lds
    s_nop 0
    v_permlane16_swap_b32 v36, v38
    v_mov_b32 v37, v36
    v_mov_b32 v39, v38
    buffer_load_dwordx4 v223, s[44:47], s63 offen offset:1024 lds
    v_permlane32_swap_b32 v36, v37
    v_permlane32_swap_b32 v38, v39
    s_waitcnt lgkmcnt(0)
    s_cmp_eq_u32 s33, 0
    v_mul_f32 v4, v4, v36
    v_mul_f32 v5, v5, v36
    v_mul_f32 v6, v6, v36
    v_mul_f32 v7, v7, v36
    v_cvt_pk_bf16_f32 v10, v4, v5
    v_cvt_pk_bf16_f32 v11, v6, v7
    v_and_b32 v8, v216, v10
    v_and_b32 v9, v217, v11
    v_xor_b32 v10, v8, v10
    v_xor_b32 v11, v9, v11
    s_setprio 2
    s_nop 0
    v_mfma_f32_16x16x32_bf16 v[68:71], v[230:233], v[8:11], 0
    v_mfma_f32_16x16x32_bf16 v[72:75], v[240:243], v[8:11], 0
    s_setprio 2
    v_mul_f32 v12, v12, v37
    v_mul_f32 v13, v13, v37
    v_mul_f32 v14, v14, v37
    v_mul_f32 v15, v15, v37
    v_cvt_pk_bf16_f32 v18, v12, v13
    v_cvt_pk_bf16_f32 v19, v14, v15
    v_and_b32 v16, v216, v18
    v_and_b32 v17, v217, v19
    v_xor_b32 v18, v16, v18
    v_xor_b32 v19, v17, v19
    v_cvt_pk_bf16_f32 v108, v68, v69
    v_cvt_pk_bf16_f32 v109, v70, v71
    v_cvt_pk_bf16_f32 v110, v72, v73
    v_cvt_pk_bf16_f32 v111, v74, v75
    s_cbranch_scc1 L_at_noswap0
    v_swap_b32 v108, v110
    v_swap_b32 v109, v111
L_at_noswap0:
    s_mov_b32 s37, 0
    buffer_store_dwordx4 v[108:111], v218, s[40:43], s37 offen sc1
    s_setprio 2
    v_mfma_f32_16x16x32_bf16 v[76:79], v[232:235], v[16:19], 0
    v_mfma_f32_16x16x32_bf16 v[80:83], v[242:245], v[16:19], 0
    s_setprio 2
    v_mul_f32 v20, v20, v38
    v_mul_f32 v21, v21, v38
    v_mul_f32 v22, v22, v38
    v_mul_f32 v23, v23, v38
    v_cvt_pk_bf16_f32 v26, v20, v21
    v_cvt_pk_bf16_f32 v27, v22, v23
    v_and_b32 v24, v216, v26
    v_and_b32 v25, v217, v27
    v_xor_b32 v26, v24, v26
    v_xor_b32 v27, v25, v27
    v_cvt_pk_bf16_f32 v112, v76, v77
    v_cvt_pk_bf16_f32 v113, v78, v79
    v_cvt_pk_bf16_f32 v114, v80, v81
    v_cvt_pk_bf16_f32 v115, v82, v83
    s_cbranch_scc1 L_at_noswap1
    v_swap_b32 v112, v114
    v_swap_b32 v113, v115
L_at_noswap1:
    s_mov_b32 s37, 32768
    buffer_store_dwordx4 v[112:115], v218, s[40:43], s37 offen sc1
    s_setprio 2
    v_mfma_f32_16x16x32_bf16 v[84:87], v[234:237], v[24:27], 0
    v_mfma_f32_16x16x32_bf16 v[88:91], v[244:247], v[24:27], 0
    s_setprio 2
    v_mul_f32 v28, v28, v39
    v_mul_f32 v29, v29, v39
    v_mul_f32 v30, v30, v39
    v_mul_f32 v31, v31, v39
    v_cvt_pk_bf16_f32 v34, v28, v29
    v_cvt_pk_bf16_f32 v35, v30, v31
    v_and_b32 v32, v216, v34
    v_and_b32 v33, v217, v35
    v_xor_b32 v34, v32, v34
    v_xor_b32 v35, v33, v35
    v_cvt_pk_bf16_f32 v116, v84, v85
    v_cvt_pk_bf16_f32 v117, v86, v87
    v_cvt_pk_bf16_f32 v118, v88, v89
    v_cvt_pk_bf16_f32 v119, v90, v91
    s_cbranch_scc1 L_at_noswap2
    v_swap_b32 v116, v118
    v_swap_b32 v117, v119
L_at_noswap2:
    s_mov_b32 s37, 65536
    buffer_store_dwordx4 v[116:119], v218, s[40:43], s37 offen sc1
    s_setprio 2
    v_mfma_f32_16x16x32_bf16 v[92:95], v[236:239], v[32:35], 0
    v_mfma_f32_16x16x32_bf16 v[96:99], v[246:249], v[32:35], 0
    s_setprio 2
    s_nop 5
    v_cvt_pk_bf16_f32 v120, v92, v93
    v_cvt_pk_bf16_f32 v121, v94, v95
    v_cvt_pk_bf16_f32 v122, v96, v97
    v_cvt_pk_bf16_f32 v123, v98, v99
    s_cbranch_scc1 L_at_noswap3
    v_swap_b32 v120, v122
    v_swap_b32 v121, v123
L_at_noswap3:
    s_mov_b32 s37, 98304
    buffer_store_dwordx4 v[120:123], v218, s[40:43], s37 offen sc1
    s_setprio 0
    v_xor_b32 v84, 0, v229
    v_xor_b32 v85, 32, v229
    v_xor_b32 v86, 64, v229
    v_xor_b32 v87, 96, v229
    v_add_u32 v88, 83968, v84
    v_add_u32 v89, 83968, v85
    v_add_u32 v90, 83968, v86
    v_add_u32 v91, 83968, v87
    v_add_u32 v92, 125952, v84
    v_add_u32 v93, 125952, v85
    v_add_u32 v94, 125952, v86
    v_add_u32 v95, 125952, v87
    v_lshl_add_u32 v231, v0, 4, s60
    v_add_u32 v230, 125952, v231
    s_add_u32 s64, s61, 0
    s_and_b32 s64, s64, 7
    s_lshl_b32 s64, s64, 12
    s_add_u32 s65, s61, 1
    s_and_b32 s65, s65, 7
    s_lshl_b32 s65, s65, 12
    s_add_u32 s66, s61, 2
    s_and_b32 s66, s66, 7
    s_lshl_b32 s66, s66, 12
    s_add_u32 s67, s61, 3
    s_and_b32 s67, s67, 7
    s_lshl_b32 s67, s67, 12
    s_add_u32 s68, s61, 4
    s_and_b32 s68, s68, 7
    s_lshl_b32 s68, s68, 12
    s_add_u32 s69, s61, 5
    s_and_b32 s69, s69, 7
    s_lshl_b32 s69, s69, 12
    s_add_u32 s70, s61, 6
    s_and_b32 s70, s70, 7
    s_lshl_b32 s70, s70, 12
    s_add_u32 s71, s61, 7
    s_and_b32 s71, s71, 7
    s_lshl_b32 s71, s71, 12
    s_waitcnt vmcnt(0)
    s_setprio 2
    v_mov_b32 v2, 1
    s_mov_b64 exec, 1
    ds_add_rtn_u32 v1, v228, v2 offset:0
    s_waitcnt lgkmcnt(0)
    v_readfirstlane_b32 s39, v1
    s_nop 0
    s_cmp_eq_u32 s39, 3
    s_cbranch_scc0 L_jo_44a
    s_mov_b64 exec, 0xffff
    v_lshlrev_b32 v1, 8, v0
    buffer_atomic_add v2, v1, s[52:55], s56 offen sc1
L_jo_44a:
    s_mov_b64 exec, -1
    s_setprio 0
    s_add_u32 m0, s60, 100352
    s_xor_b32 s63, s62, 917504
    buffer_load_dwordx4 v227, s[44:47], s63 offen offset:0 lds
    buffer_load_dwordx4 v223, s[44:47], s63 offen offset:1024 lds
    s_add_u32 m0, s60, 108544
    s_xor_b32 s63, s62, 1048576
    buffer_load_dwordx4 v227, s[44:47], s63 offen offset:0 lds
    buffer_load_dwordx4 v223, s[44:47], s63 offen offset:1024 lds
    s_add_u32 m0, s60, 116736
    s_xor_b32 s63, s62, 1179648
    buffer_load_dwordx4 v227, s[44:47], s63 offen offset:0 lds
    buffer_load_dwordx4 v223, s[44:47], s63 offen offset:1024 lds
    s_xor_b32 s63, s62, 1310720
    buffer_load_dwordx4 v[172:175], v227, s[44:47], s63 offen offset:0
    buffer_load_dwordx4 v[176:179], v223, s[44:47], s63 offen offset:1024
    s_xor_b32 s63, s62, 1441792
    buffer_load_dwordx4 v[180:183], v227, s[44:47], s63 offen offset:0
    buffer_load_dwordx4 v[184:187], v223, s[44:47], s63 offen offset:1024
    s_cmp_eq_u32 s39, 3
    s_cbranch_scc0 L_ps_46
    s_load_dword s37, s[52:53], s57 glc
L_ps_46:
    s_xor_b32 s63, s62, 1572864
    buffer_load_dwordx4 v[188:191], v227, s[44:47], s63 offen offset:0
    buffer_load_dwordx4 v[192:195], v223, s[44:47], s63 offen offset:1024
    s_xor_b32 s63, s62, 1703936
    buffer_load_dwordx4 v[196:199], v227, s[44:47], s63 offen offset:0
    buffer_load_dwordx4 v[200:203], v223, s[44:47], s63 offen offset:1024
    s_xor_b32 s63, s62, 1835008
    buffer_load_dwordx4 v[204:207], v227, s[44:47], s63 offen offset:0
    buffer_load_dwordx4 v[208:211], v223, s[44:47], s63 offen offset:1024
    s_xor_b32 s63, s62, 1966080
    buffer_load_dwordx4 v[212:215], v227, s[44:47], s63 offen offset:0
    buffer_load_dwordx4 v[216:219], v223, s[44:47], s63 offen offset:1024
    s_setprio 0
    s_cmp_eq_u32 s39, 3
    s_cbranch_scc0 L_jo_44
    s_mov_b32 s38, 131072
    s_branch L_sg_chk_49
L_sg_loop_48:
    s_load_dword s37, s[52:53], s57 glc
L_sg_chk_49:
    s_waitcnt lgkmcnt(0)
    s_cmp_ge_u32 s37, 16
    s_cbranch_scc1 L_sg_done_47
    s_sub_u32 s38, s38, 1
    s_cbranch_scc0 L_sg_loop_48
L_sg_done_47:
    v_mov_b32 v1, 16
    s_mov_b64 exec, 1
    ds_add_u32 v228, v1 offset:4
    s_mov_b64 exec, -1
L_jo_44:
    s_waitcnt vmcnt(12)
    s_mov_b64 exec, 1
    ds_add_u32 v228, v2 offset:4
    s_mov_b64 exec, -1
    s_mov_b32 s38, 1048576
L_sl_loop_51:
    ds_read_b32 v1, v228 offset:4
    s_waitcnt lgkmcnt(0)
    v_readfirstlane_b32 s37, v1
    s_nop 0
    s_cmp_ge_u32 s37, 20
    s_cbranch_scc1 L_sl_done_50
    s_sleep 1
    s_sub_u32 s38, s38, 1
    s_cbranch_scc0 L_sl_loop_51
L_sl_done_50:
L_jd_45:
    buffer_load_dwordx4 v[96:99], v224, s[40:43], s64 offen offset:0 sc1
    buffer_load_dwordx4 v[100:103], v225, s[40:43], s64 offen offset:0 sc1
    ds_read_b64_tr_b16 v[36:37], v84 offset:0
    ds_read_b64_tr_b16 v[38:39], v84 offset:2048
    buffer_load_dwordx4 v[104:107], v224, s[40:43], s64 offen offset:1024 sc1
    buffer_load_dwordx4 v[108:111], v225, s[40:43], s64 offen offset:1024 sc1
    ds_read_b64_tr_b16 v[40:41], v85 offset:0
    ds_read_b64_tr_b16 v[42:43], v85 offset:2048
    buffer_load_dwordx4 v[112:115], v224, s[40:43], s64 offen offset:2048 sc1
    buffer_load_dwordx4 v[116:119], v225, s[40:43], s64 offen offset:2048 sc1
    ds_read_b64_tr_b16 v[44:45], v86 offset:0
    ds_read_b64_tr_b16 v[46:47], v86 offset:2048
    buffer_load_dwordx4 v[120:123], v224, s[40:43], s64 offen offset:3072 sc1
    buffer_load_dwordx4 v[124:127], v225, s[40:43], s64 offen offset:3072 sc1
    ds_read_b64_tr_b16 v[48:49], v87 offset:0
    ds_read_b64_tr_b16 v[50:51], v87 offset:2048
    buffer_load_dwordx4 v[128:131], v224, s[40:43], s65 offen offset:0 sc1
    buffer_load_dwordx4 v[132:135], v225, s[40:43], s65 offen offset:0 sc1
    ds_read_b64_tr_b16 v[52:53], v84 offset:4096
    ds_read_b64_tr_b16 v[54:55], v84 offset:6144
    buffer_load_dwordx4 v[136:139], v224, s[40:43], s65 offen offset:1024 sc1
    buffer_load_dwordx4 v[140:143], v225, s[40:43], s65 offen offset:1024 sc1
    ds_read_b64_tr_b16 v[56:57], v85 offset:4096
    ds_read_b64_tr_b16 v[58:59], v85 offset:6144
    ds_read_b64_tr_b16 v[60:61], v86 offset:4096
    ds_read_b64_tr_b16 v[62:63], v86 offset:6144
    s_waitcnt lgkmcnt(12)
    ds_read_b64_tr_b16 v[64:65], v87 offset:4096
    ds_read_b64_tr_b16 v[66:67], v87 offset:6144
    ds_read_b32 v1, v228 offset:36
    s_waitcnt vmcnt(10) lgkmcnt(9)
    v_mfma_f32_16x16x32_bf16 v[4:7], v[36:39], v[96:99], 0
    ds_read_b64_tr_b16 v[68:69], v84 offset:8192
    v_mfma_f32_16x16x32_bf16 v[20:23], v[36:39], v[100:103], 0
    ds_read_b64_tr_b16 v[70:71], v84 offset:10240
    v_mfma_f32_16x16x32_bf16 v[8:11], v[40:43], v[96:99], 0
    ds_read_b64_tr_b16 v[36:37], v85 offset:8192
    v_mfma_f32_16x16x32_bf16 v[24:27], v[40:43], v[100:103], 0
    ds_read_b64_tr_b16 v[38:39], v85 offset:10240
    buffer_load_dwordx4 v[144:147], v224, s[40:43], s65 offen offset:2048 sc1
    v_mfma_f32_16x16x32_bf16 v[12:15], v[44:47], v[96:99], 0
    ds_read_b64_tr_b16 v[40:41], v86 offset:8192
    v_mfma_f32_16x16x32_bf16 v[28:31], v[44:47], v[100:103], 0
    ds_read_b64_tr_b16 v[42:43], v86 offset:10240
    v_mfma_f32_16x16x32_bf16 v[16:19], v[48:51], v[96:99], 0
    ds_read_b64_tr_b16 v[44:45], v87 offset:8192
    v_mfma_f32_16x16x32_bf16 v[32:35], v[48:51], v[100:103], 0
    ds_read_b64_tr_b16 v[46:47], v87 offset:10240
    buffer_load_dwordx4 v[148:151], v225, s[40:43], s65 offen offset:2048 sc1
    s_waitcnt lgkmcnt(8)
    v_readfirstlane_b32 s37, v1
    s_nop 0
    s_cmp_ge_u32 s37, 4
    s_cbranch_scc1 L_sl_done_52
    s_mov_b32 s38, 1048576
L_sl_loop_53:
    ds_read_b32 v1, v228 offset:36
    s_waitcnt lgkmcnt(0)
    v_readfirstlane_b32 s37, v1
    s_nop 0
    s_cmp_ge_u32 s37, 4
    s_cbranch_scc1 L_sl_done_52
    s_sleep 1
    s_sub_u32 s38, s38, 1
    s_cbranch_scc0 L_sl_loop_53
L_sl_done_52:
    ds_write_b128 v230, v[172:175] offset:0
    s_waitcnt vmcnt(10)
    v_mfma_f32_16x16x32_bf16 v[4:7], v[52:55], v[104:107], v[4:7]
    ds_read_b64_tr_b16 v[48:49], v84 offset:12288
    v_mfma_f32_16x16x32_bf16 v[20:23], v[52:55], v[108:111], v[20:23]
    ds_read_b64_tr_b16 v[50:51], v84 offset:14336
    v_mfma_f32_16x16x32_bf16 v[8:11], v[56:59], v[104:107], v[8:11]
    ds_read_b64_tr_b16 v[52:53], v85 offset:12288
    v_mfma_f32_16x16x32_bf16 v[24:27], v[56:59], v[108:111], v[24:27]
    ds_read_b64_tr_b16 v[54:55], v85 offset:14336
    buffer_load_dwordx4 v[96:99], v224, s[40:43], s65 offen offset:3072 sc1
    ds_write_b128 v230, v[176:179] offset:1024
    v_mfma_f32_16x16x32_bf16 v[12:15], v[60:63], v[104:107], v[12:15]
    ds_read_b64_tr_b16 v[56:57], v86 offset:12288
    v_mfma_f32_16x16x32_bf16 v[28:31], v[60:63], v[108:111], v[28:31]
    ds_read_b64_tr_b16 v[58:59], v86 offset:14336
    v_mfma_f32_16x16x32_bf16 v[16:19], v[64:67], v[104:107], v[16:19]
    ds_read_b64_tr_b16 v[60:61], v87 offset:12288
    v_mfma_f32_16x16x32_bf16 v[32:35], v[64:67], v[108:111], v[32:35]
    ds_read_b64_tr_b16 v[62:63], v87 offset:14336
    buffer_load_dwordx4 v[100:103], v225, s[40:43], s65 offen offset:3072 sc1
    ds_write_b128 v230, v[180:183] offset:8448
    s_waitcnt vmcnt(10) lgkmcnt(11)
    v_mfma_f32_16x16x32_bf16 v[4:7], v[68:71], v[112:115], v[4:7]
    ds_read_b64_tr_b16 v[64:65], v84 offset:16384
    v_mfma_f32_16x16x32_bf16 v[20:23], v[68:71], v[116:119], v[20:23]
    ds_read_b64_tr_b16 v[66:67], v84 offset:18432
    v_mfma_f32_16x16x32_bf16 v[8:11], v[36:39], v[112:115], v[8:11]
    ds_read_b64_tr_b16 v[68:69], v85 offset:16384
    v_mfma_f32_16x16x32_bf16 v[24:27], v[36:39], v[116:119], v[24:27]
    ds_read_b64_tr_b16 v[70:71], v85 offset:18432
    buffer_load_dwordx4 v[104:107], v224, s[40:43], s66 offen offset:0 sc1
    ds_write_b128 v230, v[184:187] offset:9472
    v_mfma_f32_16x16x32_bf16 v[12:15], v[40:43], v[112:115], v[12:15]
    ds_read_b64_tr_b16 v[36:37], v86 offset:16384
    v_mfma_f32_16x16x32_bf16 v[28:31], v[40:43], v[116:119], v[28:31]
    ds_read_b64_tr_b16 v[38:39], v86 offset:18432
    v_mfma_f32_16x16x32_bf16 v[16:19], v[44:47], v[112:115], v[16:19]
    ds_read_b64_tr_b16 v[40:41], v87 offset:16384
    v_mfma_f32_16x16x32_bf16 v[32:35], v[44:47], v[116:119], v[32:35]
    ds_read_b64_tr_b16 v[42:43], v87 offset:18432
    buffer_load_dwordx4 v[108:111], v225, s[40:43], s66 offen offset:0 sc1
    ds_write_b128 v230, v[188:191] offset:16896
    s_waitcnt vmcnt(10) lgkmcnt(11)
    v_mfma_f32_16x16x32_bf16 v[4:7], v[48:51], v[120:123], v[4:7]
    ds_read_b64_tr_b16 v[44:45], v84 offset:20480
    v_mfma_f32_16x16x32_bf16 v[20:23], v[48:51], v[124:127], v[20:23]
    ds_read_b64_tr_b16 v[46:47], v84 offset:22528
    v_mfma_f32_16x16x32_bf16 v[8:11], v[52:55], v[120:123], v[8:11]
    ds_read_b64_tr_b16 v[48:49], v85 offset:20480
    v_mfma_f32_16x16x32_bf16 v[24:27], v[52:55], v[124:127], v[24:27]
    ds_read_b64_tr_b16 v[50:51], v85 offset:22528
    buffer_load_dwordx4 v[112:115], v224, s[40:43], s66 offen offset:1024 sc1
    ds_write_b128 v230, v[192:195] offset:17920
    v_mfma_f32_16x16x32_bf16 v[12:15], v[56:59], v[120:123], v[12:15]
    ds_read_b64_tr_b16 v[52:53], v86 offset:20480
    v_mfma_f32_16x16x32_bf16 v[28:31], v[56:59], v[124:127], v[28:31]
    ds_read_b64_tr_b16 v[54:55], v86 offset:22528
    v_mfma_f32_16x16x32_bf16 v[16:19], v[60:63], v[120:123], v[16:19]
    ds_read_b64_tr_b16 v[56:57], v87 offset:20480
    v_mfma_f32_16x16x32_bf16 v[32:35], v[60:63], v[124:127], v[32:35]
    ds_read_b64_tr_b16 v[58:59], v87 offset:22528
    buffer_load_dwordx4 v[116:119], v225, s[40:43], s66 offen offset:1024 sc1
    ds_write_b128 v230, v[196:199] offset:25344
    s_waitcnt vmcnt(10) lgkmcnt(11)
    v_mfma_f32_16x16x32_bf16 v[4:7], v[64:67], v[128:131], v[4:7]
    ds_read_b64_tr_b16 v[60:61], v84 offset:24576
    v_mfma_f32_16x16x32_bf16 v[20:23], v[64:67], v[132:135], v[20:23]
    ds_read_b64_tr_b16 v[62:63], v84 offset:26624
    v_mfma_f32_16x16x32_bf16 v[8:11], v[68:71], v[128:131], v[8:11]
    ds_read_b64_tr_b16 v[64:65], v85 offset:24576
    v_mfma_f32_16x16x32_bf16 v[24:27], v[68:71], v[132:135], v[24:27]
    ds_read_b64_tr_b16 v[66:67], v85 offset:26624
    buffer_load_dwordx4 v[120:123], v224, s[40:43], s66 offen offset:2048 sc1
    ds_write_b128 v230, v[200:203] offset:26368
    v_mfma_f32_16x16x32_bf16 v[12:15], v[36:39], v[128:131], v[12:15]
    ds_read_b64_tr_b16 v[68:69], v86 offset:24576
    v_mfma_f32_16x16x32_bf16 v[28:31], v[36:39], v[132:135], v[28:31]
    ds_read_b64_tr_b16 v[70:71], v86 offset:26624
    v_mfma_f32_16x16x32_bf16 v[16:19], v[40:43], v[128:131], v[16:19]
    ds_read_b64_tr_b16 v[36:37], v87 offset:24576
    v_mfma_f32_16x16x32_bf16 v[32:35], v[40:43], v[132:135], v[32:35]
    ds_read_b64_tr_b16 v[38:39], v87 offset:26624
    buffer_load_dwordx4 v[124:127], v225, s[40:43], s66 offen offset:2048 sc1
    ds_write_b128 v231, v[204:207] offset:41984
    s_waitcnt vmcnt(10) lgkmcnt(11)
    v_mfma_f32_16x16x32_bf16 v[4:7], v[44:47], v[136:139], v[4:7]
    ds_read_b64_tr_b16 v[40:41], v84 offset:28672
    v_mfma_f32_16x16x32_bf16 v[20:23], v[44:47], v[140:143], v[20:23]
    ds_read_b64_tr_b16 v[42:43], v84 offset:30720
    v_mfma_f32_16x16x32_bf16 v[8:11], v[48:51], v[136:139], v[8:11]
    ds_read_b64_tr_b16 v[44:45], v85 offset:28672
    v_mfma_f32_16x16x32_bf16 v[24:27], v[48:51], v[140:143], v[24:27]
    ds_read_b64_tr_b16 v[46:47], v85 offset:30720
    buffer_load_dwordx4 v[128:131], v224, s[40:43], s66 offen offset:3072 sc1
    ds_write_b128 v231, v[208:211] offset:43008
    v_mfma_f32_16x16x32_bf16 v[12:15], v[52:55], v[136:139], v[12:15]
    ds_read_b64_tr_b16 v[48:49], v86 offset:28672
    v_mfma_f32_16x16x32_bf16 v[28:31], v[52:55], v[140:143], v[28:31]
    ds_read_b64_tr_b16 v[50:51], v86 offset:30720
    v_mfma_f32_16x16x32_bf16 v[16:19], v[56:59], v[136:139], v[16:19]
    ds_read_b64_tr_b16 v[52:53], v87 offset:28672
    v_mfma_f32_16x16x32_bf16 v[32:35], v[56:59], v[140:143], v[32:35]
    ds_read_b64_tr_b16 v[54:55], v87 offset:30720
    buffer_load_dwordx4 v[132:135], v225, s[40:43], s66 offen offset:3072 sc1
    ds_write_b128 v231, v[212:215] offset:51200
    s_waitcnt vmcnt(10) lgkmcnt(11)
    v_mfma_f32_16x16x32_bf16 v[4:7], v[60:63], v[144:147], v[4:7]
    ds_read_b64_tr_b16 v[56:57], v84 offset:32768
    v_mfma_f32_16x16x32_bf16 v[20:23], v[60:63], v[148:151], v[20:23]
    ds_read_b64_tr_b16 v[58:59], v84 offset:34816
    v_mfma_f32_16x16x32_bf16 v[8:11], v[64:67], v[144:147], v[8:11]
    ds_read_b64_tr_b16 v[60:61], v85 offset:32768
    v_mfma_f32_16x16x32_bf16 v[24:27], v[64:67], v[148:151], v[24:27]
    ds_read_b64_tr_b16 v[62:63], v85 offset:34816
    buffer_load_dwordx4 v[136:139], v224, s[40:43], s67 offen offset:0 sc1
    ds_write_b128 v231, v[216:219] offset:52224
    s_mov_b64 exec, 1
    ds_add_u32 v228, v2 offset:12
    s_mov_b64 exec, -1
    v_mfma_f32_16x16x32_bf16 v[12:15], v[68:71], v[144:147], v[12:15]
    ds_read_b64_tr_b16 v[64:65], v86 offset:32768
    v_mfma_f32_16x16x32_bf16 v[28:31], v[68:71], v[148:151], v[28:31]
    ds_read_b64_tr_b16 v[66:67], v86 offset:34816
    v_mfma_f32_16x16x32_bf16 v[16:19], v[36:39], v[144:147], v[16:19]
    ds_read_b64_tr_b16 v[68:69], v87 offset:32768
    v_mfma_f32_16x16x32_bf16 v[32:35], v[36:39], v[148:151], v[32:35]
    ds_read_b64_tr_b16 v[70:71], v87 offset:34816
    buffer_load_dwordx4 v[140:143], v225, s[40:43], s67 offen offset:0 sc1
    s_waitcnt vmcnt(10) lgkmcnt(11)
    v_mfma_f32_16x16x32_bf16 v[4:7], v[40:43], v[96:99], v[4:7]
    ds_read_b64_tr_b16 v[36:37], v84 offset:36864
    v_mfma_f32_16x16x32_bf16 v[20:23], v[40:43], v[100:103], v[20:23]
    ds_read_b64_tr_b16 v[38:39], v84 offset:38912
    v_mfma_f32_16x16x32_bf16 v[8:11], v[44:47], v[96:99], v[8:11]
    ds_read_b64_tr_b16 v[40:41], v85 offset:36864
    v_mfma_f32_16x16x32_bf16 v[24:27], v[44:47], v[100:103], v[24:27]
    ds_read_b64_tr_b16 v[42:43], v85 offset:38912
    buffer_load_dwordx4 v[144:147], v224, s[40:43], s67 offen offset:1024 sc1
    v_mfma_f32_16x16x32_bf16 v[12:15], v[48:51], v[96:99], v[12:15]
    ds_read_b64_tr_b16 v[44:45], v86 offset:36864
    v_mfma_f32_16x16x32_bf16 v[28:31], v[48:51], v[100:103], v[28:31]
    ds_read_b64_tr_b16 v[46:47], v86 offset:38912
    v_mfma_f32_16x16x32_bf16 v[16:19], v[52:55], v[96:99], v[16:19]
    ds_read_b64_tr_b16 v[48:49], v87 offset:36864
    v_mfma_f32_16x16x32_bf16 v[32:35], v[52:55], v[100:103], v[32:35]
    ds_read_b64_tr_b16 v[50:51], v87 offset:38912
    buffer_load_dwordx4 v[148:151], v225, s[40:43], s67 offen offset:1024 sc1
    s_waitcnt vmcnt(10) lgkmcnt(8)
    v_mfma_f32_16x16x32_bf16 v[4:7], v[56:59], v[104:107], v[4:7]
    ds_read_b64_tr_b16 v[52:53], v88 offset:0
    v_mfma_f32_16x16x32_bf16 v[20:23], v[56:59], v[108:111], v[20:23]
    ds_read_b64_tr_b16 v[54:55], v88 offset:2048
    v_mfma_f32_16x16x32_bf16 v[8:11], v[60:63], v[104:107], v[8:11]
    ds_read_b64_tr_b16 v[56:57], v89 offset:0
    v_mfma_f32_16x16x32_bf16 v[24:27], v[60:63], v[108:111], v[24:27]
    ds_read_b64_tr_b16 v[58:59], v89 offset:2048
    buffer_load_dwordx4 v[96:99], v224, s[40:43], s67 offen offset:2048 sc1
    v_mfma_f32_16x16x32_bf16 v[12:15], v[64:67], v[104:107], v[12:15]
    ds_read_b64_tr_b16 v[60:61], v90 offset:0
    v_mfma_f32_16x16x32_bf16 v[28:31], v[64:67], v[108:111], v[28:31]
    ds_read_b64_tr_b16 v[62:63], v90 offset:2048
    v_mfma_f32_16x16x32_bf16 v[16:19], v[68:71], v[104:107], v[16:19]
    ds_read_b64_tr_b16 v[64:65], v91 offset:0
    v_mfma_f32_16x16x32_bf16 v[32:35], v[68:71], v[108:111], v[32:35]
    ds_read_b64_tr_b16 v[66:67], v91 offset:2048
    buffer_load_dwordx4 v[100:103], v225, s[40:43], s67 offen offset:2048 sc1
    s_waitcnt vmcnt(10) lgkmcnt(8)
    v_mfma_f32_16x16x32_bf16 v[4:7], v[36:39], v[112:115], v[4:7]
    ds_read_b64_tr_b16 v[68:69], v88 offset:4096
    v_mfma_f32_16x16x32_bf16 v[20:23], v[36:39], v[116:119], v[20:23]
    ds_read_b64_tr_b16 v[70:71], v88 offset:6144
    v_mfma_f32_16x16x32_bf16 v[8:11], v[40:43], v[112:115], v[8:11]
    ds_read_b64_tr_b16 v[36:37], v89 offset:4096
    v_mfma_f32_16x16x32_bf16 v[24:27], v[40:43], v[116:119], v[24:27]
    ds_read_b64_tr_b16 v[38:39], v89 offset:6144
    buffer_load_dwordx4 v[104:107], v224, s[40:43], s67 offen offset:3072 sc1
    v_mfma_f32_16x16x32_bf16 v[12:15], v[44:47], v[112:115], v[12:15]
    ds_read_b64_tr_b16 v[40:41], v90 offset:4096
    v_mfma_f32_16x16x32_bf16 v[28:31], v[44:47], v[116:119], v[28:31]
    ds_read_b64_tr_b16 v[42:43], v90 offset:6144
    v_mfma_f32_16x16x32_bf16 v[16:19], v[48:51], v[112:115], v[16:19]
    ds_read_b64_tr_b16 v[44:45], v91 offset:4096
    v_mfma_f32_16x16x32_bf16 v[32:35], v[48:51], v[116:119], v[32:35]
    ds_read_b64_tr_b16 v[46:47], v91 offset:6144
    buffer_load_dwordx4 v[108:111], v225, s[40:43], s67 offen offset:3072 sc1
    s_waitcnt vmcnt(10) lgkmcnt(8)
    v_mfma_f32_16x16x32_bf16 v[4:7], v[52:55], v[120:123], v[4:7]
    ds_read_b64_tr_b16 v[48:49], v88 offset:8192
    v_mfma_f32_16x16x32_bf16 v[20:23], v[52:55], v[124:127], v[20:23]
    ds_read_b64_tr_b16 v[50:51], v88 offset:10240
    v_mfma_f32_16x16x32_bf16 v[8:11], v[56:59], v[120:123], v[8:11]
    ds_read_b64_tr_b16 v[52:53], v89 offset:8192
    v_mfma_f32_16x16x32_bf16 v[24:27], v[56:59], v[124:127], v[24:27]
    ds_read_b64_tr_b16 v[54:55], v89 offset:10240
    buffer_load_dwordx4 v[112:115], v224, s[40:43], s68 offen offset:0 sc1
    v_mfma_f32_16x16x32_bf16 v[12:15], v[60:63], v[120:123], v[12:15]
    ds_read_b64_tr_b16 v[56:57], v90 offset:8192
    v_mfma_f32_16x16x32_bf16 v[28:31], v[60:63], v[124:127], v[28:31]
    ds_read_b64_tr_b16 v[58:59], v90 offset:10240
    v_mfma_f32_16x16x32_bf16 v[16:19], v[64:67], v[120:123], v[16:19]
    ds_read_b64_tr_b16 v[60:61], v91 offset:8192
    v_mfma_f32_16x16x32_bf16 v[32:35], v[64:67], v[124:127], v[32:35]
    ds_read_b64_tr_b16 v[62:63], v91 offset:10240
    buffer_load_dwordx4 v[116:119], v225, s[40:43], s68 offen offset:0 sc1
    s_waitcnt vmcnt(10) lgkmcnt(8)
    v_mfma_f32_16x16x32_bf16 v[4:7], v[68:71], v[128:131], v[4:7]
    ds_read_b64_tr_b16 v[64:65], v88 offset:12288
    v_mfma_f32_16x16x32_bf16 v[20:23], v[68:71], v[132:135], v[20:23]
    ds_read_b64_tr_b16 v[66:67], v88 offset:14336
    v_mfma_f32_16x16x32_bf16 v[8:11], v[36:39], v[128:131], v[8:11]
    ds_read_b64_tr_b16 v[68:69], v89 offset:12288
    v_mfma_f32_16x16x32_bf16 v[24:27], v[36:39], v[132:135], v[24:27]
    ds_read_b64_tr_b16 v[70:71], v89 offset:14336
    buffer_load_dwordx4 v[120:123], v224, s[40:43], s68 offen offset:1024 sc1
    v_mfma_f32_16x16x32_bf16 v[12:15], v[40:43], v[128:131], v[12:15]
    ds_read_b64_tr_b16 v[36:37], v90 offset:12288
    v_mfma_f32_16x16x32_bf16 v[28:31], v[40:43], v[132:135], v[28:31]
    ds_read_b64_tr_b16 v[38:39], v90 offset:14336
    v_mfma_f32_16x16x32_bf16 v[16:19], v[44:47], v[128:131], v[16:19]
    ds_read_b64_tr_b16 v[40:41], v91 offset:12288
    v_mfma_f32_16x16x32_bf16 v[32:35], v[44:47], v[132:135], v[32:35]
    ds_read_b64_tr_b16 v[42:43], v91 offset:14336
    buffer_load_dwordx4 v[124:127], v225, s[40:43], s68 offen offset:1024 sc1
    s_waitcnt vmcnt(10) lgkmcnt(8)
    v_mfma_f32_16x16x32_bf16 v[4:7], v[48:51], v[136:139], v[4:7]
    ds_read_b64_tr_b16 v[44:45], v88 offset:16384
    v_mfma_f32_16x16x32_bf16 v[20:23], v[48:51], v[140:143], v[20:23]
    ds_read_b64_tr_b16 v[46:47], v88 offset:18432
    v_mfma_f32_16x16x32_bf16 v[8:11], v[52:55], v[136:139], v[8:11]
    ds_read_b64_tr_b16 v[48:49], v89 offset:16384
    v_mfma_f32_16x16x32_bf16 v[24:27], v[52:55], v[140:143], v[24:27]
    ds_read_b64_tr_b16 v[50:51], v89 offset:18432
    buffer_load_dwordx4 v[128:131], v224, s[40:43], s68 offen offset:2048 sc1
    v_mfma_f32_16x16x32_bf16 v[12:15], v[56:59], v[136:139], v[12:15]
    ds_read_b64_tr_b16 v[52:53], v90 offset:16384
    v_mfma_f32_16x16x32_bf16 v[28:31], v[56:59], v[140:143], v[28:31]
    ds_read_b64_tr_b16 v[54:55], v90 offset:18432
    v_mfma_f32_16x16x32_bf16 v[16:19], v[60:63], v[136:139], v[16:19]
    ds_read_b64_tr_b16 v[56:57], v91 offset:16384
    v_mfma_f32_16x16x32_bf16 v[32:35], v[60:63], v[140:143], v[32:35]
    ds_read_b64_tr_b16 v[58:59], v91 offset:18432
    buffer_load_dwordx4 v[132:135], v225, s[40:43], s68 offen offset:2048 sc1
    s_waitcnt vmcnt(10) lgkmcnt(8)
    v_mfma_f32_16x16x32_bf16 v[4:7], v[64:67], v[144:147], v[4:7]
    ds_read_b64_tr_b16 v[60:61], v88 offset:20480
    v_mfma_f32_16x16x32_bf16 v[20:23], v[64:67], v[148:151], v[20:23]
    ds_read_b64_tr_b16 v[62:63], v88 offset:22528
    v_mfma_f32_16x16x32_bf16 v[8:11], v[68:71], v[144:147], v[8:11]
    ds_read_b64_tr_b16 v[64:65], v89 offset:20480
    v_mfma_f32_16x16x32_bf16 v[24:27], v[68:71], v[148:151], v[24:27]
    ds_read_b64_tr_b16 v[66:67], v89 offset:22528
    buffer_load_dwordx4 v[136:139], v224, s[40:43], s68 offen offset:3072 sc1
    v_mfma_f32_16x16x32_bf16 v[12:15], v[36:39], v[144:147], v[12:15]
    ds_read_b64_tr_b16 v[68:69], v90 offset:20480
    v_mfma_f32_16x16x32_bf16 v[28:31], v[36:39], v[148:151], v[28:31]
    ds_read_b64_tr_b16 v[70:71], v90 offset:22528
    v_mfma_f32_16x16x32_bf16 v[16:19], v[40:43], v[144:147], v[16:19]
    ds_read_b64_tr_b16 v[36:37], v91 offset:20480
    v_mfma_f32_16x16x32_bf16 v[32:35], v[40:43], v[148:151], v[32:35]
    ds_read_b64_tr_b16 v[38:39], v91 offset:22528
    buffer_load_dwordx4 v[140:143], v225, s[40:43], s68 offen offset:3072 sc1
    s_waitcnt vmcnt(10) lgkmcnt(8)
    v_mfma_f32_16x16x32_bf16 v[4:7], v[44:47], v[96:99], v[4:7]
    ds_read_b64_tr_b16 v[40:41], v88 offset:24576
    v_mfma_f32_16x16x32_bf16 v[20:23], v[44:47], v[100:103], v[20:23]
    ds_read_b64_tr_b16 v[42:43], v88 offset:26624
    v_mfma_f32_16x16x32_bf16 v[8:11], v[48:51], v[96:99], v[8:11]
    ds_read_b64_tr_b16 v[44:45], v89 offset:24576
    v_mfma_f32_16x16x32_bf16 v[24:27], v[48:51], v[100:103], v[24:27]
    ds_read_b64_tr_b16 v[46:47], v89 offset:26624
    buffer_load_dwordx4 v[144:147], v224, s[40:43], s69 offen offset:0 sc1
    v_mfma_f32_16x16x32_bf16 v[12:15], v[52:55], v[96:99], v[12:15]
    ds_read_b64_tr_b16 v[48:49], v90 offset:24576
    v_mfma_f32_16x16x32_bf16 v[28:31], v[52:55], v[100:103], v[28:31]
    ds_read_b64_tr_b16 v[50:51], v90 offset:26624
    v_mfma_f32_16x16x32_bf16 v[16:19], v[56:59], v[96:99], v[16:19]
    ds_read_b64_tr_b16 v[52:53], v91 offset:24576
    v_mfma_f32_16x16x32_bf16 v[32:35], v[56:59], v[100:103], v[32:35]
    ds_read_b64_tr_b16 v[54:55], v91 offset:26624
    buffer_load_dwordx4 v[148:151], v225, s[40:43], s69 offen offset:0 sc1
    s_waitcnt vmcnt(10) lgkmcnt(8)
    v_mfma_f32_16x16x32_bf16 v[4:7], v[60:63], v[104:107], v[4:7]
    ds_read_b64_tr_b16 v[56:57], v88 offset:28672
    v_mfma_f32_16x16x32_bf16 v[20:23], v[60:63], v[108:111], v[20:23]
    ds_read_b64_tr_b16 v[58:59], v88 offset:30720
    v_mfma_f32_16x16x32_bf16 v[8:11], v[64:67], v[104:107], v[8:11]
    ds_read_b64_tr_b16 v[60:61], v89 offset:28672
    v_mfma_f32_16x16x32_bf16 v[24:27], v[64:67], v[108:111], v[24:27]
    ds_read_b64_tr_b16 v[62:63], v89 offset:30720
    buffer_load_dwordx4 v[96:99], v224, s[40:43], s69 offen offset:1024 sc1
    v_mfma_f32_16x16x32_bf16 v[12:15], v[68:71], v[104:107], v[12:15]
    ds_read_b64_tr_b16 v[64:65], v90 offset:28672
    v_mfma_f32_16x16x32_bf16 v[28:31], v[68:71], v[108:111], v[28:31]
    ds_read_b64_tr_b16 v[66:67], v90 offset:30720
    v_mfma_f32_16x16x32_bf16 v[16:19], v[36:39], v[104:107], v[16:19]
    ds_read_b64_tr_b16 v[68:69], v91 offset:28672
    v_mfma_f32_16x16x32_bf16 v[32:35], v[36:39], v[108:111], v[32:35]
    ds_read_b64_tr_b16 v[70:71], v91 offset:30720
    buffer_load_dwordx4 v[100:103], v225, s[40:43], s69 offen offset:1024 sc1
    s_waitcnt vmcnt(10) lgkmcnt(8)
    v_mfma_f32_16x16x32_bf16 v[4:7], v[40:43], v[112:115], v[4:7]
    ds_read_b64_tr_b16 v[36:37], v88 offset:32768
    v_mfma_f32_16x16x32_bf16 v[20:23], v[40:43], v[116:119], v[20:23]
    ds_read_b64_tr_b16 v[38:39], v88 offset:34816
    v_mfma_f32_16x16x32_bf16 v[8:11], v[44:47], v[112:115], v[8:11]
    ds_read_b64_tr_b16 v[40:41], v89 offset:32768
    v_mfma_f32_16x16x32_bf16 v[24:27], v[44:47], v[116:119], v[24:27]
    ds_read_b64_tr_b16 v[42:43], v89 offset:34816
    buffer_load_dwordx4 v[104:107], v224, s[40:43], s69 offen offset:2048 sc1
    v_mfma_f32_16x16x32_bf16 v[12:15], v[48:51], v[112:115], v[12:15]
    ds_read_b64_tr_b16 v[44:45], v90 offset:32768
    v_mfma_f32_16x16x32_bf16 v[28:31], v[48:51], v[116:119], v[28:31]
    ds_read_b64_tr_b16 v[46:47], v90 offset:34816
    v_mfma_f32_16x16x32_bf16 v[16:19], v[52:55], v[112:115], v[16:19]
    ds_read_b64_tr_b16 v[48:49], v91 offset:32768
    v_mfma_f32_16x16x32_bf16 v[32:35], v[52:55], v[116:119], v[32:35]
    ds_read_b64_tr_b16 v[50:51], v91 offset:34816
    buffer_load_dwordx4 v[108:111], v225, s[40:43], s69 offen offset:2048 sc1
    ds_read_b32 v1, v228 offset:12
    s_waitcnt vmcnt(10) lgkmcnt(9)
    v_mfma_f32_16x16x32_bf16 v[4:7], v[56:59], v[120:123], v[4:7]
    ds_read_b64_tr_b16 v[52:53], v88 offset:36864
    v_mfma_f32_16x16x32_bf16 v[20:23], v[56:59], v[124:127], v[20:23]
    ds_read_b64_tr_b16 v[54:55], v88 offset:38912
    v_mfma_f32_16x16x32_bf16 v[8:11], v[60:63], v[120:123], v[8:11]
    ds_read_b64_tr_b16 v[56:57], v89 offset:36864
    v_mfma_f32_16x16x32_bf16 v[24:27], v[60:63], v[124:127], v[24:27]
    ds_read_b64_tr_b16 v[58:59], v89 offset:38912
    buffer_load_dwordx4 v[112:115], v224, s[40:43], s69 offen offset:3072 sc1
    v_mfma_f32_16x16x32_bf16 v[12:15], v[64:67], v[120:123], v[12:15]
    ds_read_b64_tr_b16 v[60:61], v90 offset:36864
    v_mfma_f32_16x16x32_bf16 v[28:31], v[64:67], v[124:127], v[28:31]
    ds_read_b64_tr_b16 v[62:63], v90 offset:38912
    v_mfma_f32_16x16x32_bf16 v[16:19], v[68:71], v[120:123], v[16:19]
    ds_read_b64_tr_b16 v[64:65], v91 offset:36864
    v_mfma_f32_16x16x32_bf16 v[32:35], v[68:71], v[124:127], v[32:35]
    ds_read_b64_tr_b16 v[66:67], v91 offset:38912
    buffer_load_dwordx4 v[116:119], v225, s[40:43], s69 offen offset:3072 sc1
    s_waitcnt lgkmcnt(8)
    v_readfirstlane_b32 s37, v1
    s_nop 0
    s_cmp_ge_u32 s37, 4
    s_cbranch_scc1 L_sl_done_54
    s_mov_b32 s38, 1048576
L_sl_loop_55:
    ds_read_b32 v1, v228 offset:12
    s_waitcnt lgkmcnt(0)
    v_readfirstlane_b32 s37, v1
    s_nop 0
    s_cmp_ge_u32 s37, 4
    s_cbranch_scc1 L_sl_done_54
    s_sleep 1
    s_sub_u32 s38, s38, 1
    s_cbranch_scc0 L_sl_loop_55
L_sl_done_54:
    s_waitcnt vmcnt(10)
    v_mfma_f32_16x16x32_bf16 v[4:7], v[36:39], v[128:131], v[4:7]
    ds_read_b64_tr_b16 v[68:69], v92 offset:0
    v_mfma_f32_16x16x32_bf16 v[20:23], v[36:39], v[132:135], v[20:23]
    ds_read_b64_tr_b16 v[70:71], v92 offset:2048
    v_mfma_f32_16x16x32_bf16 v[8:11], v[40:43], v[128:131], v[8:11]
    ds_read_b64_tr_b16 v[36:37], v93 offset:0
    v_mfma_f32_16x16x32_bf16 v[24:27], v[40:43], v[132:135], v[24:27]
    ds_read_b64_tr_b16 v[38:39], v93 offset:2048
    buffer_load_dwordx4 v[120:123], v224, s[40:43], s70 offen offset:0 sc1
    v_mfma_f32_16x16x32_bf16 v[12:15], v[44:47], v[128:131], v[12:15]
    ds_read_b64_tr_b16 v[40:41], v94 offset:0
    v_mfma_f32_16x16x32_bf16 v[28:31], v[44:47], v[132:135], v[28:31]
    ds_read_b64_tr_b16 v[42:43], v94 offset:2048
    v_mfma_f32_16x16x32_bf16 v[16:19], v[48:51], v[128:131], v[16:19]
    ds_read_b64_tr_b16 v[44:45], v95 offset:0
    v_mfma_f32_16x16x32_bf16 v[32:35], v[48:51], v[132:135], v[32:35]
    ds_read_b64_tr_b16 v[46:47], v95 offset:2048
    buffer_load_dwordx4 v[124:127], v225, s[40:43], s70 offen offset:0 sc1
    s_waitcnt vmcnt(10) lgkmcnt(8)
    v_mfma_f32_16x16x32_bf16 v[4:7], v[52:55], v[136:139], v[4:7]
    ds_read_b64_tr_b16 v[48:49], v92 offset:4096
    v_mfma_f32_16x16x32_bf16 v[20:23], v[52:55], v[140:143], v[20:23]
    ds_read_b64_tr_b16 v[50:51], v92 offset:6144
    v_mfma_f32_16x16x32_bf16 v[8:11], v[56:59], v[136:139], v[8:11]
    ds_read_b64_tr_b16 v[52:53], v93 offset:4096
    v_mfma_f32_16x16x32_bf16 v[24:27], v[56:59], v[140:143], v[24:27]
    ds_read_b64_tr_b16 v[54:55], v93 offset:6144
    buffer_load_dwordx4 v[128:131], v224, s[40:43], s70 offen offset:1024 sc1
    v_mfma_f32_16x16x32_bf16 v[12:15], v[60:63], v[136:139], v[12:15]
    ds_read_b64_tr_b16 v[56:57], v94 offset:4096
    v_mfma_f32_16x16x32_bf16 v[28:31], v[60:63], v[140:143], v[28:31]
    ds_read_b64_tr_b16 v[58:59], v94 offset:6144
    v_mfma_f32_16x16x32_bf16 v[16:19], v[64:67], v[136:139], v[16:19]
    ds_read_b64_tr_b16 v[60:61], v95 offset:4096
    v_mfma_f32_16x16x32_bf16 v[32:35], v[64:67], v[140:143], v[32:35]
    ds_read_b64_tr_b16 v[62:63], v95 offset:6144
    buffer_load_dwordx4 v[132:135], v225, s[40:43], s70 offen offset:1024 sc1
    s_waitcnt vmcnt(10) lgkmcnt(8)
    v_mfma_f32_16x16x32_bf16 v[4:7], v[68:71], v[144:147], v[4:7]
    ds_read_b64_tr_b16 v[64:65], v92 offset:8448
    v_mfma_f32_16x16x32_bf16 v[20:23], v[68:71], v[148:151], v[20:23]
    ds_read_b64_tr_b16 v[66:67], v92 offset:10496
    v_mfma_f32_16x16x32_bf16 v[8:11], v[36:39], v[144:147], v[8:11]
    ds_read_b64_tr_b16 v[68:69], v93 offset:8448
    v_mfma_f32_16x16x32_bf16 v[24:27], v[36:39], v[148:151], v[24:27]
    ds_read_b64_tr_b16 v[70:71], v93 offset:10496
    buffer_load_dwordx4 v[136:139], v224, s[40:43], s70 offen offset:2048 sc1
    v_mfma_f32_16x16x32_bf16 v[12:15], v[40:43], v[144:147], v[12:15]
    ds_read_b64_tr_b16 v[36:37], v94 offset:8448
    v_mfma_f32_16x16x32_bf16 v[28:31], v[40:43], v[148:151], v[28:31]
    ds_read_b64_tr_b16 v[38:39], v94 offset:10496
    v_mfma_f32_16x16x32_bf16 v[16:19], v[44:47], v[144:147], v[16:19]
    ds_read_b64_tr_b16 v[40:41], v95 offset:8448
    v_mfma_f32_16x16x32_bf16 v[32:35], v[44:47], v[148:151], v[32:35]
    ds_read_b64_tr_b16 v[42:43], v95 offset:10496
    buffer_load_dwordx4 v[140:143], v225, s[40:43], s70 offen offset:2048 sc1
    s_waitcnt vmcnt(10) lgkmcnt(8)
    v_mfma_f32_16x16x32_bf16 v[4:7], v[48:51], v[96:99], v[4:7]
    ds_read_b64_tr_b16 v[44:45], v92 offset:12544
    v_mfma_f32_16x16x32_bf16 v[20:23], v[48:51], v[100:103], v[20:23]
    ds_read_b64_tr_b16 v[46:47], v92 offset:14592
    v_mfma_f32_16x16x32_bf16 v[8:11], v[52:55], v[96:99], v[8:11]
    ds_read_b64_tr_b16 v[48:49], v93 offset:12544
    v_mfma_f32_16x16x32_bf16 v[24:27], v[52:55], v[100:103], v[24:27]
    ds_read_b64_tr_b16 v[50:51], v93 offset:14592
    buffer_load_dwordx4 v[144:147], v224, s[40:43], s70 offen offset:3072 sc1
    v_mfma_f32_16x16x32_bf16 v[12:15], v[56:59], v[96:99], v[12:15]
    ds_read_b64_tr_b16 v[52:53], v94 offset:12544
    v_mfma_f32_16x16x32_bf16 v[28:31], v[56:59], v[100:103], v[28:31]
    ds_read_b64_tr_b16 v[54:55], v94 offset:14592
    v_mfma_f32_16x16x32_bf16 v[16:19], v[60:63], v[96:99], v[16:19]
    ds_read_b64_tr_b16 v[56:57], v95 offset:12544
    v_mfma_f32_16x16x32_bf16 v[32:35], v[60:63], v[100:103], v[32:35]
    ds_read_b64_tr_b16 v[58:59], v95 offset:14592
    buffer_load_dwordx4 v[148:151], v225, s[40:43], s70 offen offset:3072 sc1
    s_waitcnt vmcnt(10) lgkmcnt(8)
    v_mfma_f32_16x16x32_bf16 v[4:7], v[64:67], v[104:107], v[4:7]
    ds_read_b64_tr_b16 v[60:61], v92 offset:16896
    v_mfma_f32_16x16x32_bf16 v[20:23], v[64:67], v[108:111], v[20:23]
    ds_read_b64_tr_b16 v[62:63], v92 offset:18944
    v_mfma_f32_16x16x32_bf16 v[8:11], v[68:71], v[104:107], v[8:11]
    ds_read_b64_tr_b16 v[64:65], v93 offset:16896
    v_mfma_f32_16x16x32_bf16 v[24:27], v[68:71], v[108:111], v[24:27]
    ds_read_b64_tr_b16 v[66:67], v93 offset:18944
    buffer_load_dwordx4 v[96:99], v224, s[40:43], s71 offen offset:0 sc1
    v_mfma_f32_16x16x32_bf16 v[12:15], v[36:39], v[104:107], v[12:15]
    ds_read_b64_tr_b16 v[68:69], v94 offset:16896
    v_mfma_f32_16x16x32_bf16 v[28:31], v[36:39], v[108:111], v[28:31]
    ds_read_b64_tr_b16 v[70:71], v94 offset:18944
    v_mfma_f32_16x16x32_bf16 v[16:19], v[40:43], v[104:107], v[16:19]
    ds_read_b64_tr_b16 v[36:37], v95 offset:16896
    v_mfma_f32_16x16x32_bf16 v[32:35], v[40:43], v[108:111], v[32:35]
    ds_read_b64_tr_b16 v[38:39], v95 offset:18944
    buffer_load_dwordx4 v[100:103], v225, s[40:43], s71 offen offset:0 sc1
    s_waitcnt vmcnt(10) lgkmcnt(8)
    v_mfma_f32_16x16x32_bf16 v[4:7], v[44:47], v[112:115], v[4:7]
    ds_read_b64_tr_b16 v[40:41], v92 offset:20992
    v_mfma_f32_16x16x32_bf16 v[20:23], v[44:47], v[116:119], v[20:23]
    ds_read_b64_tr_b16 v[42:43], v92 offset:23040
    v_mfma_f32_16x16x32_bf16 v[8:11], v[48:51], v[112:115], v[8:11]
    ds_read_b64_tr_b16 v[44:45], v93 offset:20992
    v_mfma_f32_16x16x32_bf16 v[24:27], v[48:51], v[116:119], v[24:27]
    ds_read_b64_tr_b16 v[46:47], v93 offset:23040
    buffer_load_dwordx4 v[104:107], v224, s[40:43], s71 offen offset:1024 sc1
    v_mfma_f32_16x16x32_bf16 v[12:15], v[52:55], v[112:115], v[12:15]
    ds_read_b64_tr_b16 v[48:49], v94 offset:20992
    v_mfma_f32_16x16x32_bf16 v[28:31], v[52:55], v[116:119], v[28:31]
    ds_read_b64_tr_b16 v[50:51], v94 offset:23040
    v_mfma_f32_16x16x32_bf16 v[16:19], v[56:59], v[112:115], v[16:19]
    ds_read_b64_tr_b16 v[52:53], v95 offset:20992
    v_mfma_f32_16x16x32_bf16 v[32:35], v[56:59], v[116:119], v[32:35]
    ds_read_b64_tr_b16 v[54:55], v95 offset:23040
    buffer_load_dwordx4 v[108:111], v225, s[40:43], s71 offen offset:1024 sc1
    s_waitcnt vmcnt(10) lgkmcnt(8)
    v_mfma_f32_16x16x32_bf16 v[4:7], v[60:63], v[120:123], v[4:7]
    ds_read_b64_tr_b16 v[56:57], v92 offset:25344
    v_mfma_f32_16x16x32_bf16 v[20:23], v[60:63], v[124:127], v[20:23]
    ds_read_b64_tr_b16 v[58:59], v92 offset:27392
    v_mfma_f32_16x16x32_bf16 v[8:11], v[64:67], v[120:123], v[8:11]
    ds_read_b64_tr_b16 v[60:61], v93 offset:25344
    v_mfma_f32_16x16x32_bf16 v[24:27], v[64:67], v[124:127], v[24:27]
    ds_read_b64_tr_b16 v[62:63], v93 offset:27392
    buffer_load_dwordx4 v[112:115], v224, s[40:43], s71 offen offset:2048 sc1
    v_mfma_f32_16x16x32_bf16 v[12:15], v[68:71], v[120:123], v[12:15]
    ds_read_b64_tr_b16 v[64:65], v94 offset:25344
    v_mfma_f32_16x16x32_bf16 v[28:31], v[68:71], v[124:127], v[28:31]
    ds_read_b64_tr_b16 v[66:67], v94 offset:27392
    v_mfma_f32_16x16x32_bf16 v[16:19], v[36:39], v[120:123], v[16:19]
    ds_read_b64_tr_b16 v[68:69], v95 offset:25344
    v_mfma_f32_16x16x32_bf16 v[32:35], v[36:39], v[124:127], v[32:35]
    ds_read_b64_tr_b16 v[70:71], v95 offset:27392
    buffer_load_dwordx4 v[116:119], v225, s[40:43], s71 offen offset:2048 sc1
    s_waitcnt vmcnt(10) lgkmcnt(8)
    v_mfma_f32_16x16x32_bf16 v[4:7], v[40:43], v[128:131], v[4:7]
    ds_read_b64_tr_b16 v[36:37], v92 offset:29440
    v_mfma_f32_16x16x32_bf16 v[20:23], v[40:43], v[132:135], v[20:23]
    ds_read_b64_tr_b16 v[38:39], v92 offset:31488
    v_mfma_f32_16x16x32_bf16 v[8:11], v[44:47], v[128:131], v[8:11]
    ds_read_b64_tr_b16 v[40:41], v93 offset:29440
    v_mfma_f32_16x16x32_bf16 v[24:27], v[44:47], v[132:135], v[24:27]
    ds_read_b64_tr_b16 v[42:43], v93 offset:31488
    buffer_load_dwordx4 v[120:123], v224, s[40:43], s71 offen offset:3072 sc1
    v_mfma_f32_16x16x32_bf16 v[12:15], v[48:51], v[128:131], v[12:15]
    ds_read_b64_tr_b16 v[44:45], v94 offset:29440
    v_mfma_f32_16x16x32_bf16 v[28:31], v[48:51], v[132:135], v[28:31]
    ds_read_b64_tr_b16 v[46:47], v94 offset:31488
    v_mfma_f32_16x16x32_bf16 v[16:19], v[52:55], v[128:131], v[16:19]
    ds_read_b64_tr_b16 v[48:49], v95 offset:29440
    v_mfma_f32_16x16x32_bf16 v[32:35], v[52:55], v[132:135], v[32:35]
    ds_read_b64_tr_b16 v[50:51], v95 offset:31488
    buffer_load_dwordx4 v[124:127], v225, s[40:43], s71 offen offset:3072 sc1
    s_waitcnt vmcnt(10) lgkmcnt(8)
    v_mfma_f32_16x16x32_bf16 v[4:7], v[56:59], v[136:139], v[4:7]
    ds_read_b64_tr_b16 v[52:53], v84 offset:41984
    v_mfma_f32_16x16x32_bf16 v[20:23], v[56:59], v[140:143], v[20:23]
    ds_read_b64_tr_b16 v[54:55], v84 offset:44032
    v_mfma_f32_16x16x32_bf16 v[8:11], v[60:63], v[136:139], v[8:11]
    ds_read_b64_tr_b16 v[56:57], v85 offset:41984
    v_mfma_f32_16x16x32_bf16 v[24:27], v[60:63], v[140:143], v[24:27]
    ds_read_b64_tr_b16 v[58:59], v85 offset:44032
    v_mfma_f32_16x16x32_bf16 v[12:15], v[64:67], v[136:139], v[12:15]
    ds_read_b64_tr_b16 v[60:61], v86 offset:41984
    v_mfma_f32_16x16x32_bf16 v[28:31], v[64:67], v[140:143], v[28:31]
    ds_read_b64_tr_b16 v[62:63], v86 offset:44032
    v_mfma_f32_16x16x32_bf16 v[16:19], v[68:71], v[136:139], v[16:19]
    ds_read_b64_tr_b16 v[64:65], v87 offset:41984
    v_mfma_f32_16x16x32_bf16 v[32:35], v[68:71], v[140:143], v[32:35]
    ds_read_b64_tr_b16 v[66:67], v87 offset:44032
    s_waitcnt vmcnt(8) lgkmcnt(8)
    v_mfma_f32_16x16x32_bf16 v[4:7], v[36:39], v[144:147], v[4:7]
    ds_read_b64_tr_b16 v[68:69], v84 offset:46080
    v_mfma_f32_16x16x32_bf16 v[20:23], v[36:39], v[148:151], v[20:23]
    ds_read_b64_tr_b16 v[70:71], v84 offset:48128
    v_mfma_f32_16x16x32_bf16 v[8:11], v[40:43], v[144:147], v[8:11]
    ds_read_b64_tr_b16 v[36:37], v85 offset:46080
    v_mfma_f32_16x16x32_bf16 v[24:27], v[40:43], v[148:151], v[24:27]
    ds_read_b64_tr_b16 v[38:39], v85 offset:48128
    v_mfma_f32_16x16x32_bf16 v[12:15], v[44:47], v[144:147], v[12:15]
    ds_read_b64_tr_b16 v[40:41], v86 offset:46080
    v_mfma_f32_16x16x32_bf16 v[28:31], v[44:47], v[148:151], v[28:31]
    ds_read_b64_tr_b16 v[42:43], v86 offset:48128
    v_mfma_f32_16x16x32_bf16 v[16:19], v[48:51], v[144:147], v[16:19]
    ds_read_b64_tr_b16 v[44:45], v87 offset:46080
    v_mfma_f32_16x16x32_bf16 v[32:35], v[48:51], v[148:151], v[32:35]
    ds_read_b64_tr_b16 v[46:47], v87 offset:48128
    s_waitcnt vmcnt(6) lgkmcnt(8)
    v_mfma_f32_16x16x32_bf16 v[4:7], v[52:55], v[96:99], v[4:7]
    ds_read_b64_tr_b16 v[48:49], v84 offset:51200
    v_mfma_f32_16x16x32_bf16 v[20:23], v[52:55], v[100:103], v[20:23]
    ds_read_b64_tr_b16 v[50:51], v84 offset:53248
    v_mfma_f32_16x16x32_bf16 v[8:11], v[56:59], v[96:99], v[8:11]
    ds_read_b64_tr_b16 v[52:53], v85 offset:51200
    v_mfma_f32_16x16x32_bf16 v[24:27], v[56:59], v[100:103], v[24:27]
    ds_read_b64_tr_b16 v[54:55], v85 offset:53248
    v_mfma_f32_16x16x32_bf16 v[12:15], v[60:63], v[96:99], v[12:15]
    ds_read_b64_tr_b16 v[56:57], v86 offset:51200
    v_mfma_f32_16x16x32_bf16 v[28:31], v[60:63], v[100:103], v[28:31]
    ds_read_b64_tr_b16 v[58:59], v86 offset:53248
    v_mfma_f32_16x16x32_bf16 v[16:19], v[64:67], v[96:99], v[16:19]
    ds_read_b64_tr_b16 v[60:61], v87 offset:51200
    v_mfma_f32_16x16x32_bf16 v[32:35], v[64:67], v[100:103], v[32:35]
    ds_read_b64_tr_b16 v[62:63], v87 offset:53248
    s_waitcnt vmcnt(4) lgkmcnt(8)
    v_mfma_f32_16x16x32_bf16 v[4:7], v[68:71], v[104:107], v[4:7]
    ds_read_b64_tr_b16 v[64:65], v84 offset:55296
    v_mfma_f32_16x16x32_bf16 v[20:23], v[68:71], v[108:111], v[20:23]
    ds_read_b64_tr_b16 v[66:67], v84 offset:57344
    v_mfma_f32_16x16x32_bf16 v[8:11], v[36:39], v[104:107], v[8:11]
    ds_read_b64_tr_b16 v[68:69], v85 offset:55296
    v_mfma_f32_16x16x32_bf16 v[24:27], v[36:39], v[108:111], v[24:27]
    ds_read_b64_tr_b16 v[70:71], v85 offset:57344
    v_mfma_f32_16x16x32_bf16 v[12:15], v[40:43], v[104:107], v[12:15]
    ds_read_b64_tr_b16 v[36:37], v86 offset:55296
    v_mfma_f32_16x16x32_bf16 v[28:31], v[40:43], v[108:111], v[28:31]
    ds_read_b64_tr_b16 v[38:39], v86 offset:57344
    v_mfma_f32_16x16x32_bf16 v[16:19], v[44:47], v[104:107], v[16:19]
    ds_read_b64_tr_b16 v[40:41], v87 offset:55296
    v_mfma_f32_16x16x32_bf16 v[32:35], v[44:47], v[108:111], v[32:35]
    ds_read_b64_tr_b16 v[42:43], v87 offset:57344
    s_waitcnt vmcnt(2) lgkmcnt(8)
    v_mfma_f32_16x16x32_bf16 v[4:7], v[48:51], v[112:115], v[4:7]
    s_mul_i32 s37, s32, 80896
    s_lshl_b32 s38, s33, 11
    v_mfma_f32_16x16x32_bf16 v[20:23], v[48:51], v[116:119], v[20:23]
    s_add_u32 s37, s37, s38
    s_add_u32 s37, s37, 78848
    v_mfma_f32_16x16x32_bf16 v[8:11], v[52:55], v[112:115], v[8:11]
    v_lshrrev_b32 v1, 5, v0
    v_xor_b32 v1, v1, v0
    v_mfma_f32_16x16x32_bf16 v[24:27], v[52:55], v[116:119], v[24:27]
    v_and_b32 v1, 7, v1
    v_lshl_add_u32 v1, v1, 4, s37
    v_mfma_f32_16x16x32_bf16 v[12:15], v[56:59], v[112:115], v[12:15]
    v_bfe_u32 v2, v0, 4, 1
    v_lshl_add_u32 v1, v2, 3, v1
    v_mfma_f32_16x16x32_bf16 v[28:31], v[56:59], v[116:119], v[28:31]
    v_and_b32 v2, 15, v0
    v_lshl_add_u32 v84, v2, 7, v1
    v_mfma_f32_16x16x32_bf16 v[16:19], v[60:63], v[112:115], v[16:19]
    v_xor_b32 v85, 32, v84
    v_xor_b32 v86, 64, v84
    v_mfma_f32_16x16x32_bf16 v[32:35], v[60:63], v[116:119], v[32:35]
    v_xor_b32 v87, 96, v84
    v_lshrrev_b32 v1, 3, v0
    s_waitcnt vmcnt(0) lgkmcnt(0)
    v_mfma_f32_16x16x32_bf16 v[4:7], v[64:67], v[120:123], v[4:7]
    v_xor_b32 v1, v1, v0
    v_and_b32 v1, 7, v1
    v_mfma_f32_16x16x32_bf16 v[20:23], v[64:67], v[124:127], v[20:23]
    v_and_b32 v2, 56, v0
    v_add_u32 v1, v1, v2
    v_mfma_f32_16x16x32_bf16 v[8:11], v[68:71], v[120:123], v[8:11]
    v_lshl_add_u32 v88, v1, 4, s37
    v_mfma_f32_16x16x32_bf16 v[24:27], v[68:71], v[124:127], v[24:27]
    v_mfma_f32_16x16x32_bf16 v[12:15], v[36:39], v[120:123], v[12:15]
    v_mfma_f32_16x16x32_bf16 v[28:31], v[36:39], v[124:127], v[28:31]
    v_mfma_f32_16x16x32_bf16 v[16:19], v[40:43], v[120:123], v[16:19]
    v_mfma_f32_16x16x32_bf16 v[32:35], v[40:43], v[124:127], v[32:35]
    v_cvt_pk_bf16_f32 v36, v4, v5
    v_cvt_pk_bf16_f32 v37, v6, v7
    ds_write_b64 v84, v[36:37]
    v_cvt_pk_bf16_f32 v38, v8, v9
    v_cvt_pk_bf16_f32 v39, v10, v11
    ds_write_b64 v85, v[38:39]
    v_cvt_pk_bf16_f32 v40, v12, v13
    v_cvt_pk_bf16_f32 v41, v14, v15
    ds_write_b64 v86, v[40:41]
    v_cvt_pk_bf16_f32 v42, v16, v17
    v_cvt_pk_bf16_f32 v43, v18, v19
    ds_write_b64 v87, v[42:43]
    ds_read_b128 v[52:55], v88 offset:0
    ds_read_b128 v[56:59], v88 offset:1024
    v_cvt_pk_bf16_f32 v44, v20, v21
    v_cvt_pk_bf16_f32 v45, v22, v23
    ds_write_b64 v84, v[44:45]
    v_cvt_pk_bf16_f32 v46, v24, v25
    v_cvt_pk_bf16_f32 v47, v26, v27
    ds_write_b64 v85, v[46:47]
    v_cvt_pk_bf16_f32 v48, v28, v29
    v_cvt_pk_bf16_f32 v49, v30, v31
    ds_write_b64 v86, v[48:49]
    v_cvt_pk_bf16_f32 v50, v32, v33
    v_cvt_pk_bf16_f32 v51, v34, v35
    ds_write_b64 v87, v[50:51]
    ds_read_b128 v[60:63], v88 offset:0
    ds_read_b128 v[64:67], v88 offset:1024
    s_mov_b32 s37, 0
    s_waitcnt lgkmcnt(7)
    buffer_store_dwordx4 v[52:55], v226, s[48:51], s37 offen nt
    s_mov_b32 s37, 65536
    s_waitcnt lgkmcnt(6)
    buffer_store_dwordx4 v[56:59], v226, s[48:51], s37 offen nt
    s_mov_b32 s37, 131072
    s_waitcnt lgkmcnt(1)
    buffer_store_dwordx4 v[60:63], v226, s[48:51], s37 offen nt
    s_mov_b32 s37, 196608
    s_waitcnt lgkmcnt(0)
    buffer_store_dwordx4 v[64:67], v226, s[48:51], s37 offen nt
    s_endpgm
L_g1_rare:
    s_waitcnt vmcnt(0)
    s_cmp_lg_u32 s36, 1
    s_cbranch_scc1 L_g1_bar
    v_readfirstlane_b32 s38, v1
    s_nop 0
    s_cmp_ge_u32 s38, 4
    s_cbranch_scc1 L_sl_done_56
    s_mov_b32 s39, 1048576
L_sl_loop_57:
    ds_read_b32 v1, v228 offset:24
    s_waitcnt lgkmcnt(0)
    v_readfirstlane_b32 s38, v1
    s_nop 0
    s_cmp_ge_u32 s38, 4
    s_cbranch_scc1 L_sl_done_56
    s_sleep 1
    s_sub_u32 s39, s39, 1
    s_cbranch_scc0 L_sl_loop_57
L_sl_done_56:
    s_branch L_g1_nobar
L_end:
    s_endpgm
.section .rodata,"a"
.p2align 6
.amdhsa_kernel concat_heads__ssm_conv_h3__sliding_local_dilated__prompt_kernel
  .amdhsa_next_free_vgpr 256
  .amdhsa_next_free_sgpr 102
  .amdhsa_accum_offset 256
  .amdhsa_group_segment_fixed_size 0
  .amdhsa_kernarg_size 96
  .amdhsa_user_sgpr_count 2
  .amdhsa_user_sgpr_kernarg_segment_ptr 1
  .amdhsa_system_sgpr_workgroup_id_x 1
  .amdhsa_float_denorm_mode_32 3
.end_amdhsa_kernel
```

```asm
; @launch grid=(256,1,1) block=(512,1,1) lds=163840
.amdgcn_target "amdgcn-amd-amdhsa--gfx950"
.text
.globl concat_heads__ssm_conv_h3__sliding_local_dilated__prompt_kernel
.p2align 8
.type concat_heads__ssm_conv_h3__sliding_local_dilated__prompt_kernel,@function
concat_heads__ssm_conv_h3__sliding_local_dilated__prompt_kernel:
L_entry:
    s_getpc_b64 s[32:33]
    s_cmp_ge_u32 s2, 256
    s_cbranch_scc1 L_end
    s_load_dwordx16 s[8:23], s[0:1], 0
    s_load_dwordx8 s[24:31], s[0:1], 64
    v_lshrrev_b32 v1, 6, v0
    s_and_b32 s4, s2, 1
    v_readfirstlane_b32 s3, v1
    v_and_b32 v0, 63, v0
    s_bfe_u32 s5, s2, 0x30003
    s_bfe_u32 s6, s2, 0x20001
    s_lshr_b32 s7, s2, 6
    s_lshl2_add_u32 s6, s6, s7
    s_cmp_ge_u32 s3, 4
    s_cbranch_scc1 L_crole
    s_bfe_u32 s34, s2, 0x20003
    s_lshl2_add_u32 s34, s34, s3
    s_lshl_b32 s34, s34, 7
    v_lshl_add_u32 v1, v0, 11, s34
    v_min_u32 v1, L_end-L_entry-8, v1
    s_mov_b64 exec, 0xffff
    global_load_dword v249, v1, s[32:33]
    s_mov_b64 exec, -1
    s_and_b32 s84, s2, 3
    s_lshl2_add_u32 s84, s84, s3
    s_lshr_b32 s85, s2, 2
    s_mul_i32 s86, s3, 8448
    s_add_u32 s86, s86, 125952
    s_lshl_b32 s87, s85, 9
    s_add_u32 s87, s87, s84
    s_lshl_b32 s87, s87, 7
    v_and_b32 v231, 7, v0
    v_lshl_add_u32 v231, v231, 4, s87
    v_lshrrev_b32 v230, 3, v0
    v_lshl_add_u32 v230, v230, 13, v231
    v_subrev_u32 v231, 6144, v230
    v_subrev_u32 v232, 4096, v230
    v_subrev_u32 v233, 2048, v230
    v_add_u32 v234, 4096, v230
    v_lshlrev_b32 v235, 4, v0
    s_lshl_b32 s87, s84, 9
    s_add_u32 m0, s86, 4224
    s_waitcnt lgkmcnt(0)
    s_mov_b32 s80, s14
    s_mov_b32 s81, s15
    s_mov_b32 s82, 0x2000
    s_mov_b32 s83, 0x20000
    s_mov_b32 s72, s10
    s_mov_b32 s73, s11
    s_mov_b32 s74, 0x400000
    s_mov_b32 s75, 0x20000
    s_mov_b32 exec_hi, 0
    buffer_load_dwordx4 v235, s[80:83], s87 offen lds
    s_mov_b64 exec, -1
    buffer_load_dwordx4 v[108:111], v231, s[72:75], 0 offen offset:0 nt
    buffer_load_dwordx4 v[112:115], v232, s[72:75], 0 offen offset:0 nt
    buffer_load_dwordx4 v[116:119], v233, s[72:75], 0 offen offset:0 nt
    buffer_load_dwordx4 v[120:123], v230, s[72:75], 0 offen offset:0 nt
    buffer_load_dwordx4 v[124:127], v230, s[72:75], 0 offen offset:2048 nt
    buffer_load_dwordx4 v[128:131], v234, s[72:75], 0 offen offset:0 nt
    buffer_load_dwordx4 v[132:135], v234, s[72:75], 0 offen offset:2048 nt
    s_mov_b32 s76, s12
    s_mov_b32 s77, s13
    s_mov_b32 s78, 0x400000
    s_mov_b32 s79, 0x20000
    buffer_load_dwordx4 v[136:139], v230, s[76:79], 0 offen offset:0 nt
    buffer_load_dwordx4 v[140:143], v230, s[76:79], 0 offen offset:2048 nt
    buffer_load_dwordx4 v[144:147], v234, s[76:79], 0 offen offset:0 nt
    buffer_load_dwordx4 v[148:151], v234, s[76:79], 0 offen offset:2048 nt
    s_branch L_grole
L_crole:
    s_sub_u32 s70, s3, 4
    s_lshl_b32 s43, s70, 12
    s_lshl_b32 s44, s70, 11
    s_add_u32 s44, s44, 17408
    s_lshl_b32 s49, s70, 4
    s_lshl_b64 s[46:47], 0xffff, s49
    v_lshrrev_b32 v13, 3, v0
    v_and_b32 v14, 7, v0
    v_lshrrev_b32 v15, 4, v0
    s_lshl2_add_u32 s50, s5, s70
    s_lshl_b32 s50, s50, 6
    s_add_u32 s50, s50, s4
    s_lshl_b32 s50, s50, 11
    v_lshl_add_u32 v16, v13, 12, s50
    v_xor_b32 v17, v14, v15
    v_lshl_add_u32 v2, v17, 4, v16
    v_xor_b32 v3, 64, v2
    v_add_u32 v3, 31744, v3
    v_add_u32 v4, 63488, v2
    v_add_u32 v5, 63488, v3
    s_lshl_b32 s49, s5, 7
    s_sub_u32 s49, s49, 8
    s_max_i32 s49, s49, 0
    s_lshl1_add_u32 s49, s49, s4
    s_lshl_b32 s49, s49, 11
    v_lshl_add_u32 v16, v13, 12, s49
    v_lshlrev_b32 v17, 1, v15
    v_xor_b32 v18, v14, v13
    v_lshl_add_u32 v6, v18, 4, v16
    s_mul_i32 s49, s70, 768
    s_add_u32 s49, s49, s6
    s_lshl_b32 s49, s49, 7
    v_mul_u32_u24 v16, 6144, v13
    v_and_b32 v17, 2, v17
    v_xor_b32 v17, v14, v17
    v_lshlrev_b32 v17, 4, v17
    v_add3_u32 v7, v17, v16, s49
    v_xor_b32 v8, 64, v7
    v_add_u32 v8, 48128, v8
    v_add_u32 v9, 2048, v7
    v_add_u32 v10, 2048, v8
    v_add_u32 v11, 4096, v7
    v_add_u32 v12, 4096, v8
    s_movk_i32 s40, 0
    s_mov_b32 s41, 0
    s_lshr_b32 s90, s2, 3
    s_and_b32 s91, s3, 3
    s_lshl2_add_u32 s90, s90, s91
    s_and_b32 s91, s2, 6
    s_lshl3_add_u32 s88, s90, s91
    s_lshl1_add_u32 s88, s88, s4
    s_lshl_b32 s88, s88, 11
    s_and_b32 s89, s2, 7
    s_and_b32 s91, s90, 1
    s_lshl1_add_u32 s89, s89, s91
    s_lshr_b32 s90, s90, 1
    s_mul_i32 s90, s90, 48
    s_add_u32 s89, s89, s90
    s_lshl_b32 s89, s89, 7
    v_and_b32 v251, 1, v0
    v_lshlrev_b32 v251, 12, v251
    v_lshrrev_b32 v252, 1, v0
    v_lshl_add_u32 v251, v252, 7, v251
    v_lshrrev_b32 v250, 2, v0
    v_mul_u32_u24 v250, 393216, v250
    v_and_b32 v252, 3, v0
    v_lshl_add_u32 v252, v252, 11, v250
    s_waitcnt lgkmcnt(0)
    s_mov_b32 s32, s20
    s_mov_b32 s33, s21
    s_mov_b32 s34, 0x400000
    s_mov_b32 s35, 0x20000
    s_mov_b32 s36, s22
    s_mov_b32 s37, s23
    s_mov_b32 s38, 0x600000
    s_mov_b32 s39, 0x20000
    s_setprio 0
    s_and_b32 s73, s2, 7
    s_xor_b32 s73, s73, 2
    s_lshr_b32 s74, s2, 7
    s_lshl1_add_u32 s68, s73, s74
    s_bfe_u32 s69, s2, 0x40003
    s_lshl4_add_u32 s71, s68, s69
    s_lshl2_add_u32 s71, s71, s70
    s_mul_i32 s80, s70, 8448
    s_add_u32 s80, s80, 125952
    s_mul_i32 s81, s70, 9216
    s_add_u32 s81, s81, 41984
    s_add_u32 s52, s30, 0xe00000
    s_addc_u32 s53, s31, 0
    s_mov_b32 s54, 0x20000
    s_mov_b32 s55, 0x20000
    s_add_u32 s64, s30, 0x900000
    s_addc_u32 s65, s31, 0
    s_mov_b32 s66, 0x420000
    s_mov_b32 s67, 0x20000
    s_lshl_b32 s84, s71, 12
    s_mul_i32 s85, s71, 4224
    s_add_u32 s85, s85, 4194304
    s_lshr_b32 s72, s71, 1
    s_lshl_b32 s72, s72, 2
    s_load_dword s72, s[18:19], s72
    v_lshlrev_b32 v224, 4, v0
    v_mov_b32 v228, 0
    v_mov_b32 v229, 0
    v_mov_b32 v230, 0
    v_mov_b32 v231, 0
    v_mov_b32 v227, 134352
    v_mov_b32 v244, 1
    s_bfe_u32 s87, s2, 0x10003
    s_mov_b64 exec, 1
    ds_write_b128 v227, v[228:231]
    ds_write_b128 v227, v[228:231] offset:16
    ds_write_b128 v227, v[228:231] offset:32
    s_mov_b64 exec, -1
    s_mov_b32 exec_lo, 0x7777
    s_mov_b32 exec_hi, 0x0
    s_bfe_u32 s7, s89, 0x30007
    s_cmp_lg_u32 s7, 1
    s_cbranch_scc1 L_wx3_1
    buffer_load_dword v250, v252, s[36:39], s89 offen offset:256
L_wx3_1:
    buffer_load_dword v250, v252, s[36:39], s89 offen
    s_mov_b32 exec_lo, 0xff
    s_mov_b32 exec_hi, 0
    buffer_load_dword v250, v251, s[32:35], s88 offen
    s_mov_b64 exec, -1
    s_add_u32 m0, s43, 0
    s_nop 0
    buffer_load_dwordx4 v2, s[32:35], s40 offen offset:0 lds
    s_add_u32 m0, s44, 0
    s_nop 0
    buffer_load_dwordx4 v7, s[36:39], s41 offen offset:0 lds
    buffer_load_dwordx4 v8, s[36:39], s41 offen offset:1024 lds
    s_add_u32 m0, s43, 0
    s_nop 0
    buffer_load_dwordx4 v3, s[32:35], s40 offen offset:1024 lds
    s_add_u32 m0, s44, 8192
    s_nop 0
    buffer_load_dwordx4 v9, s[36:39], s41 offen offset:0 lds
    buffer_load_dwordx4 v10, s[36:39], s41 offen offset:1024 lds
    s_add_u32 m0, s43, 0
    s_nop 0
    buffer_load_dwordx4 v4, s[32:35], s40 offen offset:2048 lds
    s_add_u32 m0, s44, 16384
    s_nop 0
    buffer_load_dwordx4 v11, s[36:39], s41 offen offset:0 lds
    buffer_load_dwordx4 v12, s[36:39], s41 offen offset:1024 lds
    s_add_u32 m0, s43, 0
    s_nop 0
    buffer_load_dwordx4 v5, s[32:35], s40 offen offset:3072 lds
    s_mov_b32 m0, 16384
    s_mov_b64 exec, s[46:47]
    buffer_load_dwordx4 v6, s[32:35], s40 offen lds
    s_mov_b64 exec, -1
    s_movk_i32 s40, 128
    s_mov_b32 s41, 393216
    s_add_u32 m0, s43, 41984
    s_nop 0
    buffer_load_dwordx4 v2, s[32:35], s40 offen offset:0 lds
    s_add_u32 m0, s44, 41984
    s_nop 0
    buffer_load_dwordx4 v7, s[36:39], s41 offen offset:0 lds
    buffer_load_dwordx4 v8, s[36:39], s41 offen offset:1024 lds
    s_add_u32 m0, s43, 41984
    s_nop 0
    buffer_load_dwordx4 v3, s[32:35], s40 offen offset:1024 lds
    s_add_u32 m0, s44, 50176
    s_nop 0
    buffer_load_dwordx4 v9, s[36:39], s41 offen offset:0 lds
    buffer_load_dwordx4 v10, s[36:39], s41 offen offset:1024 lds
    s_add_u32 m0, s43, 41984
    s_nop 0
    buffer_load_dwordx4 v4, s[32:35], s40 offen offset:2048 lds
    s_add_u32 m0, s44, 58368
    s_nop 0
    buffer_load_dwordx4 v11, s[36:39], s41 offen offset:0 lds
    buffer_load_dwordx4 v12, s[36:39], s41 offen offset:1024 lds
    s_add_u32 m0, s43, 41984
    s_nop 0
    buffer_load_dwordx4 v5, s[32:35], s40 offen offset:3072 lds
    s_mov_b32 m0, 58368
    s_mov_b64 exec, s[46:47]
    buffer_load_dwordx4 v6, s[32:35], s40 offen lds
    s_mov_b64 exec, -1
    s_movk_i32 s40, 256
    s_mov_b32 s41, 786432
    s_lshr_b32 s74, s69, 2
    s_and_b32 s75, s69, 3
    s_lshl3_add_u32 s74, s74, s75
    s_lshl3_add_u32 s74, s74, s70
    s_lshl_b32 s74, s74, 3
    v_bfe_u32 v234, v0, 3, 1
    v_lshl_add_u32 v225, v234, 8, s74
    v_bfe_u32 v234, v0, 4, 1
    v_lshl_add_u32 v225, v234, 1, v225
    v_lshrrev_b32 v234, 5, v0
    v_lshl_add_u32 v225, v234, 5, v225
    s_lshl_b32 s74, s68, 7
    v_and_b32 v234, 7, v0
    v_lshl_add_u32 v234, v234, 4, s74
    v_lshl_add_u32 v226, v225, 12, v234
    v_lshl_add_u32 v225, v225, 11, v234
    v_and_b32 v234, 1, v0
    v_xor_b32 v234, 1, v234
    v_mul_u32_u24 v232, 4224, v234
    v_mul_u32_u24 v233, 4576, v234
    v_bfe_u32 v234, v0, 1, 3
    v_lshl_add_u32 v232, v234, 3, v232
    v_xor_b32 v234, 7, v234
    v_lshl_add_u32 v233, v234, 6, v233
    v_lshrrev_b32 v234, 4, v0
    v_lshl_add_u32 v232, v234, 4, v232
    v_lshl_add_u32 v233, v234, 4, v233
    v_add3_u32 v232, v232, s80, 8
    v_add_u32 v233, s81, v233
    s_waitcnt lgkmcnt(0)
    s_bitcmp1_b32 s71, 0
    s_cselect_b32 s74, 0, 16
    s_lshl_b32 s72, s72, s74
    s_and_b32 s72, s72, 0xffff0000
    v_and_b32 v235, 1, v0
    v_lshlrev_b32 v235, 4, v235
    v_lshrrev_b32 v235, v235, s72
    v_bfe_u32 v236, v0, 1, 3
    v_lshl_add_u32 v236, v234, 1, v236
    v_cmp_eq_u32 vcc, 7, v236
    v_mov_b32 v241, 0
    v_mov_b32 v243, 0
    v_cndmask_b32 v240, 0, v235, vcc
    v_cmp_eq_u32 vcc, 6, v236
    s_nop 1
    v_cndmask_b32 v242, 0, v235, vcc
    s_waitcnt vmcnt(11)
    s_barrier
    s_add_u32 m0, s43, 83968
    s_nop 0
    buffer_load_dwordx4 v2, s[32:35], s40 offen offset:0 lds
    s_add_u32 m0, s44, 83968
    s_nop 0
    buffer_load_dwordx4 v7, s[36:39], s41 offen offset:0 lds
    buffer_load_dwordx4 v8, s[36:39], s41 offen offset:1024 lds
    s_add_u32 m0, s43, 83968
    s_nop 0
    buffer_load_dwordx4 v3, s[32:35], s40 offen offset:1024 lds
    s_add_u32 m0, s44, 92160
    s_nop 0
    buffer_load_dwordx4 v9, s[36:39], s41 offen offset:0 lds
    buffer_load_dwordx4 v10, s[36:39], s41 offen offset:1024 lds
    s_add_u32 m0, s43, 83968
    s_nop 0
    buffer_load_dwordx4 v4, s[32:35], s40 offen offset:2048 lds
    s_add_u32 m0, s44, 100352
    s_nop 0
    buffer_load_dwordx4 v11, s[36:39], s41 offen offset:0 lds
    buffer_load_dwordx4 v12, s[36:39], s41 offen offset:1024 lds
    s_add_u32 m0, s43, 83968
    s_nop 0
    buffer_load_dwordx4 v5, s[32:35], s40 offen offset:3072 lds
    s_mov_b32 m0, 100352
    s_mov_b64 exec, s[46:47]
    buffer_load_dwordx4 v6, s[32:35], s40 offen lds
    s_mov_b64 exec, -1
    s_movk_i32 s40, 384
    s_mov_b32 s41, 1179648
    s_waitcnt vmcnt(11)
    s_barrier
    s_add_u32 m0, s43, 0
    s_nop 0
    buffer_load_dwordx4 v2, s[32:35], s40 offen offset:0 lds
    s_add_u32 m0, s44, 0
    s_nop 0
    buffer_load_dwordx4 v7, s[36:39], s41 offen offset:0 lds
    buffer_load_dwordx4 v8, s[36:39], s41 offen offset:1024 lds
    s_add_u32 m0, s43, 0
    s_nop 0
    buffer_load_dwordx4 v3, s[32:35], s40 offen offset:1024 lds
    s_add_u32 m0, s44, 8192
    s_nop 0
    buffer_load_dwordx4 v9, s[36:39], s41 offen offset:0 lds
    buffer_load_dwordx4 v10, s[36:39], s41 offen offset:1024 lds
    s_add_u32 m0, s43, 0
    s_nop 0
    buffer_load_dwordx4 v4, s[32:35], s40 offen offset:2048 lds
    s_add_u32 m0, s44, 16384
    s_nop 0
    buffer_load_dwordx4 v11, s[36:39], s41 offen offset:0 lds
    buffer_load_dwordx4 v12, s[36:39], s41 offen offset:1024 lds
    s_add_u32 m0, s43, 0
    s_nop 0
    buffer_load_dwordx4 v5, s[32:35], s40 offen offset:3072 lds
    s_mov_b32 m0, 16384
    s_mov_b64 exec, s[46:47]
    buffer_load_dwordx4 v6, s[32:35], s40 offen lds
    s_mov_b64 exec, -1
    s_movk_i32 s40, 512
    s_mov_b32 s41, 1572864
    s_mov_b32 exec_lo, 0x77770000
    s_mov_b32 exec_hi, 0x0
    s_bfe_u32 s7, s89, 0x30007
    s_cmp_lg_u32 s7, 1
    s_cbranch_scc1 L_wx3_4
    buffer_load_dword v250, v252, s[36:39], s89 offen offset:256
L_wx3_4:
    buffer_load_dword v250, v252, s[36:39], s89 offen
    s_mov_b32 exec_lo, 0xff00
    s_mov_b32 exec_hi, 0
    buffer_load_dword v250, v251, s[32:35], s88 offen
    s_mov_b64 exec, -1
    s_waitcnt vmcnt(13)
    s_barrier
    s_add_u32 m0, s43, 41984
    s_nop 0
    buffer_load_dwordx4 v2, s[32:35], s40 offen offset:0 lds
    s_add_u32 m0, s44, 41984
    s_nop 0
    buffer_load_dwordx4 v7, s[36:39], s41 offen offset:0 lds
    buffer_load_dwordx4 v8, s[36:39], s41 offen offset:1024 lds
    s_add_u32 m0, s43, 41984
    s_nop 0
    buffer_load_dwordx4 v3, s[32:35], s40 offen offset:1024 lds
    s_add_u32 m0, s44, 50176
    s_nop 0
    buffer_load_dwordx4 v9, s[36:39], s41 offen offset:0 lds
    buffer_load_dwordx4 v10, s[36:39], s41 offen offset:1024 lds
    s_add_u32 m0, s43, 41984
    s_nop 0
    buffer_load_dwordx4 v4, s[32:35], s40 offen offset:2048 lds
    s_add_u32 m0, s44, 58368
    s_nop 0
    buffer_load_dwordx4 v11, s[36:39], s41 offen offset:0 lds
    buffer_load_dwordx4 v12, s[36:39], s41 offen offset:1024 lds
    s_add_u32 m0, s43, 41984
    s_nop 0
    buffer_load_dwordx4 v5, s[32:35], s40 offen offset:3072 lds
    s_mov_b32 m0, 58368
    s_mov_b64 exec, s[46:47]
    buffer_load_dwordx4 v6, s[32:35], s40 offen lds
    s_mov_b64 exec, -1
    s_movk_i32 s40, 640
    s_mov_b32 s41, 1966080
    s_waitcnt vmcnt(13)
    s_barrier
    s_add_u32 m0, s43, 83968
    s_nop 0
    buffer_load_dwordx4 v2, s[32:35], s40 offen offset:0 lds
    s_add_u32 m0, s44, 83968
    s_nop 0
    buffer_load_dwordx4 v7, s[36:39], s41 offen offset:0 lds
    buffer_load_dwordx4 v8, s[36:39], s41 offen offset:1024 lds
    s_add_u32 m0, s43, 83968
    s_nop 0
    buffer_load_dwordx4 v3, s[32:35], s40 offen offset:1024 lds
    s_add_u32 m0, s44, 92160
    s_nop 0
    buffer_load_dwordx4 v9, s[36:39], s41 offen offset:0 lds
    buffer_load_dwordx4 v10, s[36:39], s41 offen offset:1024 lds
    s_add_u32 m0, s43, 83968
    s_nop 0
    buffer_load_dwordx4 v4, s[32:35], s40 offen offset:2048 lds
    s_add_u32 m0, s44, 100352
    s_nop 0
    buffer_load_dwordx4 v11, s[36:39], s41 offen offset:0 lds
    buffer_load_dwordx4 v12, s[36:39], s41 offen offset:1024 lds
    s_add_u32 m0, s43, 83968
    s_nop 0
    buffer_load_dwordx4 v5, s[32:35], s40 offen offset:3072 lds
    s_mov_b32 m0, 100352
    s_mov_b64 exec, s[46:47]
    buffer_load_dwordx4 v6, s[32:35], s40 offen lds
    s_mov_b64 exec, -1
    s_movk_i32 s40, 768
    s_mov_b32 s41, 2359296
    s_cmp_lg_u32 s87, 0
    s_cbranch_scc1 L_stg_7
    s_mov_b32 exec_lo, 0x0
    s_mov_b32 exec_hi, 0x7777
    s_bfe_u32 s7, s89, 0x30007
    s_cmp_lg_u32 s7, 1
    s_cbranch_scc1 L_wx3_8
    buffer_load_dword v250, v252, s[36:39], s89 offen offset:256
L_wx3_8:
    buffer_load_dword v250, v252, s[36:39], s89 offen
    s_mov_b32 exec_lo, 0xff0000
    s_mov_b32 exec_hi, 0
    buffer_load_dword v250, v251, s[32:35], s88 offen
    s_mov_b64 exec, -1
L_stg_7:
    s_waitcnt vmcnt(13)
    s_bitcmp1_b32 1, s87
    s_cbranch_scc1 L_mw_9
    s_waitcnt vmcnt(11)
L_mw_9:
    s_barrier
    s_add_u32 m0, s43, 0
    s_nop 0
    buffer_load_dwordx4 v2, s[32:35], s40 offen offset:0 lds
    s_add_u32 m0, s44, 0
    s_nop 0
    buffer_load_dwordx4 v7, s[36:39], s41 offen offset:0 lds
    buffer_load_dwordx4 v8, s[36:39], s41 offen offset:1024 lds
    s_add_u32 m0, s43, 0
    s_nop 0
    buffer_load_dwordx4 v3, s[32:35], s40 offen offset:1024 lds
    s_add_u32 m0, s44, 8192
    s_nop 0
    buffer_load_dwordx4 v9, s[36:39], s41 offen offset:0 lds
    buffer_load_dwordx4 v10, s[36:39], s41 offen offset:1024 lds
    s_add_u32 m0, s43, 0
    s_nop 0
    buffer_load_dwordx4 v4, s[32:35], s40 offen offset:2048 lds
    s_add_u32 m0, s44, 16384
    s_nop 0
    buffer_load_dwordx4 v11, s[36:39], s41 offen offset:0 lds
    buffer_load_dwordx4 v12, s[36:39], s41 offen offset:1024 lds
    s_add_u32 m0, s43, 0
    s_nop 0
    buffer_load_dwordx4 v5, s[32:35], s40 offen offset:3072 lds
    s_mov_b32 m0, 16384
    s_mov_b64 exec, s[46:47]
    buffer_load_dwordx4 v6, s[32:35], s40 offen lds
    s_mov_b64 exec, -1
    s_movk_i32 s40, 896
    s_mov_b32 s41, 2752512
    s_cmp_lg_u32 s87, 1
    s_cbranch_scc1 L_stg_10
    s_mov_b32 exec_lo, 0x0
    s_mov_b32 exec_hi, 0x7777
    s_bfe_u32 s7, s89, 0x30007
    s_cmp_lg_u32 s7, 1
    s_cbranch_scc1 L_wx3_11
    buffer_load_dword v250, v252, s[36:39], s89 offen offset:256
L_wx3_11:
    buffer_load_dword v250, v252, s[36:39], s89 offen
    s_mov_b32 exec_lo, 0xff0000
    s_mov_b32 exec_hi, 0
    buffer_load_dword v250, v251, s[32:35], s88 offen
    s_mov_b64 exec, -1
L_stg_10:
    s_bfe_u32 s74, s2, 0x20003
    s_lshl2_add_u32 s74, s74, s70
    s_cmp_lg_u32 s74, 0
    s_cbranch_scc1 L_sig_12
    s_mov_b32 s60, s28
    s_mov_b32 s61, s29
    s_mov_b32 s62, 0x100
    s_mov_b32 s63, 0x20000
    s_and_b32 s74, s2, 3
    s_lshl_b32 s74, s74, 6
    s_mov_b64 exec, 1
    buffer_atomic_add v244, off, s[60:63], s74 sc1
    s_mov_b64 exec, -1
L_sig_12:
    s_load_dwordx2 s[90:91], s[16:17], s84 offset:60
    s_load_dwordx2 s[90:91], s[16:17], s84 offset:188
    s_load_dwordx2 s[90:91], s[16:17], s84 offset:316
    s_load_dwordx2 s[90:91], s[16:17], s84 offset:444
    s_waitcnt vmcnt(13)
    s_barrier
    s_add_u32 m0, s43, 41984
    s_nop 0
    buffer_load_dwordx4 v2, s[32:35], s40 offen offset:0 lds
    s_add_u32 m0, s44, 41984
    s_nop 0
    buffer_load_dwordx4 v7, s[36:39], s41 offen offset:0 lds
    buffer_load_dwordx4 v8, s[36:39], s41 offen offset:1024 lds
    s_add_u32 m0, s43, 41984
    s_nop 0
    buffer_load_dwordx4 v3, s[32:35], s40 offen offset:1024 lds
    s_add_u32 m0, s44, 50176
    s_nop 0
    buffer_load_dwordx4 v9, s[36:39], s41 offen offset:0 lds
    buffer_load_dwordx4 v10, s[36:39], s41 offen offset:1024 lds
    s_add_u32 m0, s43, 41984
    s_nop 0
    buffer_load_dwordx4 v4, s[32:35], s40 offen offset:2048 lds
    s_add_u32 m0, s44, 58368
    s_nop 0
    buffer_load_dwordx4 v11, s[36:39], s41 offen offset:0 lds
    buffer_load_dwordx4 v12, s[36:39], s41 offen offset:1024 lds
    s_add_u32 m0, s43, 41984
    s_nop 0
    buffer_load_dwordx4 v5, s[32:35], s40 offen offset:3072 lds
    s_mov_b32 m0, 58368
    s_mov_b64 exec, s[46:47]
    buffer_load_dwordx4 v6, s[32:35], s40 offen lds
    s_mov_b64 exec, -1
    s_movk_i32 s40, 1024
    s_mov_b32 s41, 3145728
    s_bfe_u32 s74, s2, 0x20003
    s_lshl2_add_u32 s74, s74, s70
    s_cmp_lg_u32 s74, 4
    s_cbranch_scc1 L_sig_14
    s_mov_b32 s60, s28
    s_mov_b32 s61, s29
    s_mov_b32 s62, 0x100
    s_mov_b32 s63, 0x20000
    s_and_b32 s74, s2, 3
    s_lshl_b32 s74, s74, 6
    s_mov_b64 exec, 1
    buffer_atomic_add v244, off, s[60:63], s74 sc1
    s_mov_b64 exec, -1
L_sig_14:
    s_load_dwordx2 s[90:91], s[16:17], s84 offset:572
    s_load_dwordx2 s[90:91], s[16:17], s84 offset:700
    s_load_dwordx2 s[90:91], s[16:17], s84 offset:828
    s_load_dwordx2 s[90:91], s[16:17], s84 offset:956
    s_waitcnt vmcnt(13)
    s_bitcmp1_b32 2, s87
    s_cbranch_scc1 L_mw_15
    s_waitcnt vmcnt(11)
L_mw_15:
    s_barrier
    s_add_u32 m0, s43, 83968
    s_nop 0
    buffer_load_dwordx4 v2, s[32:35], s40 offen offset:0 lds
    s_add_u32 m0, s44, 83968
    s_nop 0
    buffer_load_dwordx4 v7, s[36:39], s41 offen offset:0 lds
    buffer_load_dwordx4 v8, s[36:39], s41 offen offset:1024 lds
    s_add_u32 m0, s43, 83968
    s_nop 0
    buffer_load_dwordx4 v3, s[32:35], s40 offen offset:1024 lds
    s_add_u32 m0, s44, 92160
    s_nop 0
    buffer_load_dwordx4 v9, s[36:39], s41 offen offset:0 lds
    buffer_load_dwordx4 v10, s[36:39], s41 offen offset:1024 lds
    s_add_u32 m0, s43, 83968
    s_nop 0
    buffer_load_dwordx4 v4, s[32:35], s40 offen offset:2048 lds
    s_add_u32 m0, s44, 100352
    s_nop 0
    buffer_load_dwordx4 v11, s[36:39], s41 offen offset:0 lds
    buffer_load_dwordx4 v12, s[36:39], s41 offen offset:1024 lds
    s_add_u32 m0, s43, 83968
    s_nop 0
    buffer_load_dwordx4 v5, s[32:35], s40 offen offset:3072 lds
    s_mov_b32 m0, 100352
    s_mov_b64 exec, s[46:47]
    buffer_load_dwordx4 v6, s[32:35], s40 offen lds
    s_mov_b64 exec, -1
    s_movk_i32 s40, 1152
    s_mov_b32 s41, 3538944
    s_bfe_u32 s74, s2, 0x20003
    s_lshl2_add_u32 s74, s74, s70
    s_cmp_lg_u32 s74, 8
    s_cbranch_scc1 L_sig_16
    s_mov_b32 s60, s28
    s_mov_b32 s61, s29
    s_mov_b32 s62, 0x100
    s_mov_b32 s63, 0x20000
    s_and_b32 s74, s2, 3
    s_lshl_b32 s74, s74, 6
    s_mov_b64 exec, 1
    buffer_atomic_add v244, off, s[60:63], s74 sc1
    s_mov_b64 exec, -1
L_sig_16:
    s_load_dwordx2 s[90:91], s[16:17], s84 offset:1084
    s_load_dwordx2 s[90:91], s[16:17], s84 offset:1212
    s_load_dwordx2 s[90:91], s[16:17], s84 offset:1340
    s_load_dwordx2 s[90:91], s[16:17], s84 offset:1468
    s_waitcnt vmcnt(11)
    s_barrier
    s_add_u32 m0, s43, 0
    s_nop 0
    buffer_load_dwordx4 v2, s[32:35], s40 offen offset:0 lds
    s_add_u32 m0, s44, 0
    s_nop 0
    buffer_load_dwordx4 v7, s[36:39], s41 offen offset:0 lds
    buffer_load_dwordx4 v8, s[36:39], s41 offen offset:1024 lds
    s_add_u32 m0, s43, 0
    s_nop 0
    buffer_load_dwordx4 v3, s[32:35], s40 offen offset:1024 lds
    s_add_u32 m0, s44, 8192
    s_nop 0
    buffer_load_dwordx4 v9, s[36:39], s41 offen offset:0 lds
    buffer_load_dwordx4 v10, s[36:39], s41 offen offset:1024 lds
    s_add_u32 m0, s43, 0
    s_nop 0
    buffer_load_dwordx4 v4, s[32:35], s40 offen offset:2048 lds
    s_add_u32 m0, s44, 16384
    s_nop 0
    buffer_load_dwordx4 v11, s[36:39], s41 offen offset:0 lds
    buffer_load_dwordx4 v12, s[36:39], s41 offen offset:1024 lds
    s_add_u32 m0, s43, 0
    s_nop 0
    buffer_load_dwordx4 v5, s[32:35], s40 offen offset:3072 lds
    s_mov_b32 m0, 16384
    s_mov_b64 exec, s[46:47]
    buffer_load_dwordx4 v6, s[32:35], s40 offen lds
    s_mov_b64 exec, -1
    s_movk_i32 s40, 1280
    s_mov_b32 s41, 3932160
    s_cmp_lg_u32 s87, 0
    s_cbranch_scc1 L_stg_18
    s_mov_b32 exec_lo, 0x0
    s_mov_b32 exec_hi, 0x77770000
    s_bfe_u32 s7, s89, 0x30007
    s_cmp_lg_u32 s7, 1
    s_cbranch_scc1 L_wx3_19
    buffer_load_dword v250, v252, s[36:39], s89 offen offset:256
L_wx3_19:
    buffer_load_dword v250, v252, s[36:39], s89 offen
    s_mov_b32 exec_lo, 0xff000000
    s_mov_b32 exec_hi, 0
    buffer_load_dword v250, v251, s[32:35], s88 offen
    s_mov_b64 exec, -1
L_stg_18:
    s_bfe_u32 s74, s2, 0x20003
    s_lshl2_add_u32 s74, s74, s70
    s_cmp_lg_u32 s74, 12
    s_cbranch_scc1 L_sig_20
    s_mov_b32 s60, s28
    s_mov_b32 s61, s29
    s_mov_b32 s62, 0x100
    s_mov_b32 s63, 0x20000
    s_and_b32 s74, s2, 3
    s_lshl_b32 s74, s74, 6
    s_mov_b64 exec, 1
    buffer_atomic_add v244, off, s[60:63], s74 sc1
    s_mov_b64 exec, -1
L_sig_20:
    s_load_dwordx2 s[90:91], s[16:17], s84 offset:1596
    s_load_dwordx2 s[90:91], s[16:17], s84 offset:1724
    s_load_dwordx2 s[90:91], s[16:17], s84 offset:1852
    s_load_dwordx2 s[90:91], s[16:17], s84 offset:1980
    s_waitcnt vmcnt(13)
    s_bitcmp1_b32 1, s87
    s_cbranch_scc1 L_mw_21
    s_waitcnt vmcnt(11)
L_mw_21:
    s_barrier
    s_add_u32 m0, s43, 41984
    s_nop 0
    buffer_load_dwordx4 v2, s[32:35], s40 offen offset:0 lds
    s_add_u32 m0, s44, 41984
    s_nop 0
    buffer_load_dwordx4 v7, s[36:39], s41 offen offset:0 lds
    buffer_load_dwordx4 v8, s[36:39], s41 offen offset:1024 lds
    s_add_u32 m0, s43, 41984
    s_nop 0
    buffer_load_dwordx4 v3, s[32:35], s40 offen offset:1024 lds
    s_add_u32 m0, s44, 50176
    s_nop 0
    buffer_load_dwordx4 v9, s[36:39], s41 offen offset:0 lds
    buffer_load_dwordx4 v10, s[36:39], s41 offen offset:1024 lds
    s_add_u32 m0, s43, 41984
    s_nop 0
    buffer_load_dwordx4 v4, s[32:35], s40 offen offset:2048 lds
    s_add_u32 m0, s44, 58368
    s_nop 0
    buffer_load_dwordx4 v11, s[36:39], s41 offen offset:0 lds
    buffer_load_dwordx4 v12, s[36:39], s41 offen offset:1024 lds
    s_add_u32 m0, s43, 41984
    s_nop 0
    buffer_load_dwordx4 v5, s[32:35], s40 offen offset:3072 lds
    s_mov_b32 m0, 58368
    s_mov_b64 exec, s[46:47]
    buffer_load_dwordx4 v6, s[32:35], s40 offen lds
    s_mov_b64 exec, -1
    s_movk_i32 s40, 1408
    s_mov_b32 s41, 4325376
    s_cmp_lg_u32 s87, 1
    s_cbranch_scc1 L_stg_22
    s_mov_b32 exec_lo, 0x0
    s_mov_b32 exec_hi, 0x77770000
    s_bfe_u32 s7, s89, 0x30007
    s_cmp_lg_u32 s7, 1
    s_cbranch_scc1 L_wx3_23
    buffer_load_dword v250, v252, s[36:39], s89 offen offset:256
L_wx3_23:
    buffer_load_dword v250, v252, s[36:39], s89 offen
    s_mov_b32 exec_lo, 0xff000000
    s_mov_b32 exec_hi, 0
    buffer_load_dword v250, v251, s[32:35], s88 offen
    s_mov_b64 exec, -1
L_stg_22:
    s_load_dwordx2 s[90:91], s[16:17], s84 offset:2108
    s_load_dwordx2 s[90:91], s[16:17], s84 offset:2236
    s_load_dwordx2 s[90:91], s[16:17], s84 offset:2364
    s_load_dwordx2 s[90:91], s[16:17], s84 offset:2492
    s_waitcnt vmcnt(13)
    s_barrier
    s_add_u32 m0, s43, 83968
    s_nop 0
    buffer_load_dwordx4 v2, s[32:35], s40 offen offset:0 lds
    s_add_u32 m0, s44, 83968
    s_nop 0
    buffer_load_dwordx4 v7, s[36:39], s41 offen offset:0 lds
    buffer_load_dwordx4 v8, s[36:39], s41 offen offset:1024 lds
    s_add_u32 m0, s43, 83968
    s_nop 0
    buffer_load_dwordx4 v3, s[32:35], s40 offen offset:1024 lds
    s_add_u32 m0, s44, 92160
    s_nop 0
    buffer_load_dwordx4 v9, s[36:39], s41 offen offset:0 lds
    buffer_load_dwordx4 v10, s[36:39], s41 offen offset:1024 lds
    s_add_u32 m0, s43, 83968
    s_nop 0
    buffer_load_dwordx4 v4, s[32:35], s40 offen offset:2048 lds
    s_add_u32 m0, s44, 100352
    s_nop 0
    buffer_load_dwordx4 v11, s[36:39], s41 offen offset:0 lds
    buffer_load_dwordx4 v12, s[36:39], s41 offen offset:1024 lds
    s_add_u32 m0, s43, 83968
    s_nop 0
    buffer_load_dwordx4 v5, s[32:35], s40 offen offset:3072 lds
    s_mov_b32 m0, 100352
    s_mov_b64 exec, s[46:47]
    buffer_load_dwordx4 v6, s[32:35], s40 offen lds
    s_mov_b64 exec, -1
    s_movk_i32 s40, 1536
    s_mov_b32 s41, 4718592
    s_load_dwordx2 s[90:91], s[16:17], s84 offset:2620
    s_load_dwordx2 s[90:91], s[16:17], s84 offset:2748
    s_load_dwordx2 s[90:91], s[16:17], s84 offset:2876
    s_load_dwordx2 s[90:91], s[16:17], s84 offset:3004
    s_waitcnt vmcnt(13)
    s_bitcmp1_b32 2, s87
    s_cbranch_scc1 L_mw_25
    s_waitcnt vmcnt(11)
L_mw_25:
    s_barrier
    s_add_u32 m0, s43, 0
    s_nop 0
    buffer_load_dwordx4 v2, s[32:35], s40 offen offset:0 lds
    s_add_u32 m0, s44, 0
    s_nop 0
    buffer_load_dwordx4 v7, s[36:39], s41 offen offset:0 lds
    buffer_load_dwordx4 v8, s[36:39], s41 offen offset:1024 lds
    s_add_u32 m0, s43, 0
    s_nop 0
    buffer_load_dwordx4 v3, s[32:35], s40 offen offset:1024 lds
    s_add_u32 m0, s44, 8192
    s_nop 0
    buffer_load_dwordx4 v9, s[36:39], s41 offen offset:0 lds
    buffer_load_dwordx4 v10, s[36:39], s41 offen offset:1024 lds
    s_add_u32 m0, s43, 0
    s_nop 0
    buffer_load_dwordx4 v4, s[32:35], s40 offen offset:2048 lds
    s_add_u32 m0, s44, 16384
    s_nop 0
    buffer_load_dwordx4 v11, s[36:39], s41 offen offset:0 lds
    buffer_load_dwordx4 v12, s[36:39], s41 offen offset:1024 lds
    s_add_u32 m0, s43, 0
    s_nop 0
    buffer_load_dwordx4 v5, s[32:35], s40 offen offset:3072 lds
    s_mov_b32 m0, 16384
    s_mov_b64 exec, s[46:47]
    buffer_load_dwordx4 v6, s[32:35], s40 offen lds
    s_mov_b64 exec, -1
    s_movk_i32 s40, 1664
    s_mov_b32 s41, 5111808
    s_load_dwordx2 s[90:91], s[16:17], s84 offset:3132
    s_load_dwordx2 s[90:91], s[16:17], s84 offset:3260
    s_load_dwordx2 s[90:91], s[16:17], s84 offset:3388
    s_load_dwordx2 s[90:91], s[16:17], s84 offset:3516
    s_waitcnt vmcnt(11)
    s_barrier
    s_add_u32 m0, s43, 41984
    s_nop 0
    buffer_load_dwordx4 v2, s[32:35], s40 offen offset:0 lds
    s_add_u32 m0, s44, 41984
    s_nop 0
    buffer_load_dwordx4 v7, s[36:39], s41 offen offset:0 lds
    buffer_load_dwordx4 v8, s[36:39], s41 offen offset:1024 lds
    s_add_u32 m0, s43, 41984
    s_nop 0
    buffer_load_dwordx4 v3, s[32:35], s40 offen offset:1024 lds
    s_add_u32 m0, s44, 50176
    s_nop 0
    buffer_load_dwordx4 v9, s[36:39], s41 offen offset:0 lds
    buffer_load_dwordx4 v10, s[36:39], s41 offen offset:1024 lds
    s_add_u32 m0, s43, 41984
    s_nop 0
    buffer_load_dwordx4 v4, s[32:35], s40 offen offset:2048 lds
    s_add_u32 m0, s44, 58368
    s_nop 0
    buffer_load_dwordx4 v11, s[36:39], s41 offen offset:0 lds
    buffer_load_dwordx4 v12, s[36:39], s41 offen offset:1024 lds
    s_add_u32 m0, s43, 41984
    s_nop 0
    buffer_load_dwordx4 v5, s[32:35], s40 offen offset:3072 lds
    s_mov_b32 m0, 58368
    s_mov_b64 exec, s[46:47]
    buffer_load_dwordx4 v6, s[32:35], s40 offen lds
    s_mov_b64 exec, -1
    s_movk_i32 s40, 1792
    s_mov_b32 s41, 5505024
    s_load_dwordx2 s[90:91], s[16:17], s84 offset:3644
    s_load_dwordx2 s[90:91], s[16:17], s84 offset:3772
    s_load_dwordx2 s[90:91], s[16:17], s84 offset:3900
    s_load_dwordx2 s[90:91], s[16:17], s84 offset:4028
    s_waitcnt vmcnt(11)
    s_barrier
    s_add_u32 m0, s43, 83968
    s_nop 0
    buffer_load_dwordx4 v2, s[32:35], s40 offen offset:0 lds
    s_add_u32 m0, s44, 83968
    s_nop 0
    buffer_load_dwordx4 v7, s[36:39], s41 offen offset:0 lds
    buffer_load_dwordx4 v8, s[36:39], s41 offen offset:1024 lds
    s_add_u32 m0, s43, 83968
    s_nop 0
    buffer_load_dwordx4 v3, s[32:35], s40 offen offset:1024 lds
    s_add_u32 m0, s44, 92160
    s_nop 0
    buffer_load_dwordx4 v9, s[36:39], s41 offen offset:0 lds
    buffer_load_dwordx4 v10, s[36:39], s41 offen offset:1024 lds
    s_add_u32 m0, s43, 83968
    s_nop 0
    buffer_load_dwordx4 v4, s[32:35], s40 offen offset:2048 lds
    s_add_u32 m0, s44, 100352
    s_nop 0
    buffer_load_dwordx4 v11, s[36:39], s41 offen offset:0 lds
    buffer_load_dwordx4 v12, s[36:39], s41 offen offset:1024 lds
    s_add_u32 m0, s43, 83968
    s_nop 0
    buffer_load_dwordx4 v5, s[32:35], s40 offen offset:3072 lds
    s_mov_b32 m0, 100352
    s_mov_b64 exec, s[46:47]
    buffer_load_dwordx4 v6, s[32:35], s40 offen lds
    s_mov_b64 exec, -1
    s_movk_i32 s40, 1920
    s_mov_b32 s41, 5898240
    s_waitcnt vmcnt(11)
    s_barrier
    s_load_dword s4, s[28:29], 0
    s_load_dword s5, s[28:29], 64
    s_load_dword s6, s[28:29], 128
    s_load_dword s7, s[28:29], 192
    s_add_u32 m0, s43, 0
    s_nop 0
    buffer_load_dwordx4 v2, s[32:35], s40 offen offset:0 lds
    s_add_u32 m0, s44, 0
    s_nop 0
    buffer_load_dwordx4 v7, s[36:39], s41 offen offset:0 lds
    buffer_load_dwordx4 v8, s[36:39], s41 offen offset:1024 lds
    s_add_u32 m0, s43, 0
    s_nop 0
    buffer_load_dwordx4 v3, s[32:35], s40 offen offset:1024 lds
    s_add_u32 m0, s44, 8192
    s_nop 0
    buffer_load_dwordx4 v9, s[36:39], s41 offen offset:0 lds
    buffer_load_dwordx4 v10, s[36:39], s41 offen offset:1024 lds
    s_add_u32 m0, s43, 0
    s_nop 0
    buffer_load_dwordx4 v4, s[32:35], s40 offen offset:2048 lds
    s_add_u32 m0, s44, 16384
    s_nop 0
    buffer_load_dwordx4 v11, s[36:39], s41 offen offset:0 lds
    buffer_load_dwordx4 v12, s[36:39], s41 offen offset:1024 lds
    s_add_u32 m0, s43, 0
    s_nop 0
    buffer_load_dwordx4 v5, s[32:35], s40 offen offset:3072 lds
    s_mov_b32 m0, 16384
    s_mov_b64 exec, s[46:47]
    buffer_load_dwordx4 v6, s[32:35], s40 offen lds
    s_mov_b64 exec, -1
    s_movk_i32 s40, 2048
    s_mov_b32 s41, 6291456
    s_mov_b32 s60, s8
    s_mov_b32 s61, s9
    s_mov_b32 s62, 0x400000
    s_mov_b32 s63, 0x20000
    s_movk_i32 s75, 8192
    buffer_load_dwordx4 v[208:211], v225, s[60:63], 0 offen offset:0 nt
    buffer_load_dwordx4 v[212:215], v225, s[60:63], 0 offen offset:2048 nt
    buffer_load_dwordx4 v[216:219], v225, s[60:63], s75 offen offset:0 nt
    buffer_load_dwordx4 v[220:223], v225, s[60:63], s75 offen offset:2048 nt
    s_cmp_lg_u32 s70, 0
    s_cbranch_scc1 L_pc_done_29
    s_waitcnt lgkmcnt(0)
    s_min_u32 s4, s4, s5
    s_min_u32 s6, s6, s7
    s_min_u32 s4, s4, s6
    s_cmp_ge_u32 s4, 64
    s_cbranch_scc1 L_pc_done_29
    s_mov_b32 s60, s28
    s_mov_b32 s61, s29
    s_mov_b32 s62, 0x100
    s_mov_b32 s63, 0x20000
    v_lshlrev_b32 v20, 6, v0
    s_mov_b32 s74, 131072
    s_mov_b64 exec, 0xf
L_pc_loop_30:
    buffer_load_dword v21, v20, s[60:63], 0 offen sc1
    s_waitcnt vmcnt(0)
    v_cmp_gt_u32 vcc, 64, v21
    s_cbranch_vccz L_pc_done_29
    s_sleep 4
    s_sub_u32 s74, s74, 1
    s_cbranch_scc0 L_pc_loop_30
L_pc_done_29:
    s_mov_b64 exec, -1
    s_waitcnt vmcnt(15)
    s_barrier
    s_waitcnt vmcnt(4)
    s_mov_b64 exec, 1
    ds_add_u32 v227, v244 offset:24
    s_mov_b64 exec, -1
    s_add_u32 s56, s30, s85
    s_addc_u32 s57, s31, 0
    s_movk_i32 s58, 4096
    s_mov_b32 s59, 0x20000
    s_add_u32 m0, s81, 0
    s_nop 0
    buffer_load_dwordx4 v224, s[56:59], 0 offen offset:0 sc1 lds
    buffer_load_dwordx4 v224, s[56:59], 0 offen offset:1024 sc1 lds
    buffer_load_dwordx4 v224, s[56:59], 0 offen offset:2048 sc1 lds
    buffer_load_dwordx4 v224, s[56:59], 0 offen offset:3072 sc1 lds
    s_add_u32 m0, s81, 4572
    s_nop 0
    buffer_load_dwordx4 v224, s[56:59], 0 offen offset:0 sc1 lds
    buffer_load_dwordx4 v224, s[56:59], 0 offen offset:1024 sc1 lds
    buffer_load_dwordx4 v224, s[56:59], 0 offen offset:2048 sc1 lds
    buffer_load_dwordx4 v224, s[56:59], 0 offen offset:3072 sc1 lds
    s_add_u32 s56, s16, s84
    s_addc_u32 s57, s17, 0
    s_movk_i32 s58, 4096
    s_mov_b32 s59, 0x20000
    s_add_u32 m0, s80, 64
    v_mov_b32 v132, 0
    v_mov_b32 v133, 0
    v_mov_b32 v134, 0
    v_mov_b32 v135, 0
    buffer_load_dwordx4 v224, s[56:59], 0 offen offset:0 lds
    buffer_load_dwordx4 v224, s[56:59], 0 offen offset:1024 lds
    buffer_load_dwordx4 v224, s[56:59], 0 offen offset:2048 lds
    buffer_load_dwordx4 v224, s[56:59], 0 offen offset:3072 lds
    s_add_u32 m0, s80, 4304
    s_mov_b64 exec, 0x100
    buffer_load_dwordx4 v[132:135], off, s[56:59], 0
    s_mov_b64 exec, -1
    buffer_load_dwordx4 v224, s[56:59], 14 offen offset:0 lds
    buffer_load_dwordx4 v224, s[56:59], 14 offen offset:1024 lds
    buffer_load_dwordx4 v224, s[56:59], 14 offen offset:2048 lds
    buffer_load_dwordx4 v224, s[56:59], 14 offen offset:3072 lds
    v_lshrrev_b32 v234, 5, v0
    v_mul_u32_u24 v234, 4064, v234
    v_add3_u32 v234, v234, v224, s81
    s_mov_b32 exec_lo, 0xfffffff
    s_mov_b32 exec_hi, 0xfffffff
    ds_write_b128 v234, v[228:231] offset:4096
    s_mov_b64 exec, 1
    ds_write_b32 v234, v228 offset:8668
    s_mov_b64 exec, -1
    s_setprio 3
    s_waitcnt vmcnt(9)
    s_mov_b32 s60, s24
    s_mov_b32 s61, s25
    s_mov_b32 s62, 0x200000
    s_mov_b32 s63, 0x20000
    s_lshr_b32 s74, s2, 3
    s_lshl2_add_u32 s74, s74, s70
    s_bfe_u32 s75, s2, 0x10002
    s_lshl4_add_u32 s74, s74, s75
    s_lshl_b32 s74, s74, 10
    v_lshrrev_b32 v234, 3, v0
    v_and_b32 v235, 7, v0
    v_lshlrev_b32 v235, 7, v235
    v_lshl_add_u32 v234, v234, 11, v235
    buffer_load_dword v250, v234, s[60:63], s74 offen
    s_waitcnt vmcnt(1)
    v_cmp_lt_u32 vcc, 3, v0
    v_mov_b32 v140, 4160
    v_lshlrev_b32 v136, 16, v132
    v_cndmask_b32 v140, 0, v140, vcc
    v_alignbit_b32 v137, v133, v132, 16
    v_alignbit_b32 v138, v134, v133, 16
    v_alignbit_b32 v139, v135, v134, 16
    v_add3_u32 v140, v140, v224, s80
    s_mov_b64 exec, 0x1ff
    ds_write_b128 v140, v[136:139]
    s_mov_b64 exec, -1
    ds_read_b128 v[112:115], v233 offset:3584
    ds_read_b64 v[48:49], v232 offset:0
    ds_read_b64 v[50:51], v232 offset:8
    ds_read_b128 v[116:119], v233 offset:3072
    ds_read_b64 v[52:53], v232 offset:512
    ds_read_b64 v[54:55], v232 offset:520
    ds_read_b128 v[120:123], v233 offset:2560
    ds_read_b64 v[56:57], v232 offset:1024
    ds_read_b64 v[58:59], v232 offset:1032
    ds_read_b128 v[124:127], v233 offset:2048
    ds_read_b64 v[60:61], v232 offset:1536
    ds_read_b64 v[62:63], v232 offset:1544
    ds_read_b128 v[128:131], v233 offset:1536
    ds_read_b64 v[64:65], v232 offset:2048
    ds_read_b64 v[66:67], v232 offset:2056
    ds_read_b128 v[132:135], v233 offset:1024
    ds_read_b64 v[68:69], v232 offset:2560
    ds_read_b64 v[70:71], v232 offset:2568
    ds_read_b128 v[136:139], v233 offset:512
    ds_read_b64 v[72:73], v232 offset:3072
    ds_read_b64 v[74:75], v232 offset:3080
    ds_read_b128 v[140:143], v233 offset:0
    ds_read_b64 v[76:77], v232 offset:3584
    ds_read_b64 v[78:79], v232 offset:3592
    s_setprio 1
    s_mov_b32 s74, 3
    s_waitcnt lgkmcnt(0)
.p2align 6
    v_mfma_f32_16x16x32_bf16 v[16:19], v[240:243], v[112:115], 0
    v_mfma_f32_16x16x32_bf16 v[20:23], v[240:243], v[116:119], 0
    v_mfma_f32_16x16x32_bf16 v[24:27], v[240:243], v[120:123], 0
    v_mfma_f32_16x16x32_bf16 v[28:31], v[240:243], v[124:127], 0
    v_mfma_f32_16x16x32_bf16 v[32:35], v[240:243], v[128:131], 0
    v_mfma_f32_16x16x32_bf16 v[36:39], v[240:243], v[132:135], 0
    v_mfma_f32_16x16x32_bf16 v[40:43], v[240:243], v[136:139], 0
    v_mfma_f32_16x16x32_bf16 v[44:47], v[240:243], v[140:143], 0
L_conv:
    v_mfma_f32_16x16x32_bf16 v[16:19], v[48:51], v[112:115], v[16:19]
    ds_read_b128 v[144:147], v233 offset:3648
    v_mfma_f32_16x16x32_bf16 v[20:23], v[48:51], v[116:119], v[20:23]
    ds_read_b64 v[80:81], v232 offset:64
    v_mfma_f32_16x16x32_bf16 v[20:23], v[52:55], v[112:115], v[20:23]
    ds_read_b64 v[82:83], v232 offset:72
    v_mfma_f32_16x16x32_bf16 v[24:27], v[48:51], v[120:123], v[24:27]
    ds_read_b128 v[148:151], v233 offset:3136
    v_mfma_f32_16x16x32_bf16 v[24:27], v[52:55], v[116:119], v[24:27]
    ds_read_b64 v[84:85], v232 offset:576
    v_mfma_f32_16x16x32_bf16 v[24:27], v[56:59], v[112:115], v[24:27]
    ds_read_b64 v[86:87], v232 offset:584
    v_mfma_f32_16x16x32_bf16 v[28:31], v[48:51], v[124:127], v[28:31]
    ds_read_b128 v[152:155], v233 offset:2624
    v_mfma_f32_16x16x32_bf16 v[28:31], v[52:55], v[120:123], v[28:31]
    ds_read_b64 v[88:89], v232 offset:1088
    v_mfma_f32_16x16x32_bf16 v[28:31], v[56:59], v[116:119], v[28:31]
    ds_read_b64 v[90:91], v232 offset:1096
    v_mfma_f32_16x16x32_bf16 v[28:31], v[60:63], v[112:115], v[28:31]
    ds_read_b128 v[156:159], v233 offset:2112
    v_mfma_f32_16x16x32_bf16 v[32:35], v[48:51], v[128:131], v[32:35]
    ds_read_b64 v[92:93], v232 offset:1600
    v_mfma_f32_16x16x32_bf16 v[32:35], v[52:55], v[124:127], v[32:35]
    ds_read_b64 v[94:95], v232 offset:1608
    v_mfma_f32_16x16x32_bf16 v[32:35], v[56:59], v[120:123], v[32:35]
    ds_read_b128 v[160:163], v233 offset:1600
    v_mfma_f32_16x16x32_bf16 v[32:35], v[60:63], v[116:119], v[32:35]
    ds_read_b64 v[96:97], v232 offset:2112
    v_mfma_f32_16x16x32_bf16 v[32:35], v[64:67], v[112:115], v[32:35]
    ds_read_b64 v[98:99], v232 offset:2120
    v_mfma_f32_16x16x32_bf16 v[36:39], v[48:51], v[132:135], v[36:39]
    ds_read_b128 v[164:167], v233 offset:1088
    v_mfma_f32_16x16x32_bf16 v[36:39], v[52:55], v[128:131], v[36:39]
    ds_read_b64 v[100:101], v232 offset:2624
    v_mfma_f32_16x16x32_bf16 v[36:39], v[56:59], v[124:127], v[36:39]
    ds_read_b64 v[102:103], v232 offset:2632
    v_mfma_f32_16x16x32_bf16 v[36:39], v[60:63], v[120:123], v[36:39]
    ds_read_b128 v[168:171], v233 offset:576
    v_mfma_f32_16x16x32_bf16 v[36:39], v[64:67], v[116:119], v[36:39]
    ds_read_b64 v[104:105], v232 offset:3136
    v_mfma_f32_16x16x32_bf16 v[36:39], v[68:71], v[112:115], v[36:39]
    ds_read_b64 v[106:107], v232 offset:3144
    v_mfma_f32_16x16x32_bf16 v[40:43], v[48:51], v[136:139], v[40:43]
    ds_read_b128 v[172:175], v233 offset:64
    v_mfma_f32_16x16x32_bf16 v[40:43], v[52:55], v[132:135], v[40:43]
    ds_read_b64 v[108:109], v232 offset:3648
    v_mfma_f32_16x16x32_bf16 v[40:43], v[56:59], v[128:131], v[40:43]
    ds_read_b64 v[110:111], v232 offset:3656
    v_mfma_f32_16x16x32_bf16 v[40:43], v[60:63], v[124:127], v[40:43]
    v_mfma_f32_16x16x32_bf16 v[40:43], v[64:67], v[120:123], v[40:43]
    v_mfma_f32_16x16x32_bf16 v[40:43], v[68:71], v[116:119], v[40:43]
    v_mfma_f32_16x16x32_bf16 v[40:43], v[72:75], v[112:115], v[40:43]
    v_mfma_f32_16x16x32_bf16 v[44:47], v[48:51], v[140:143], v[44:47]
    v_mfma_f32_16x16x32_bf16 v[44:47], v[52:55], v[136:139], v[44:47]
    v_mfma_f32_16x16x32_bf16 v[44:47], v[56:59], v[132:135], v[44:47]
    v_mfma_f32_16x16x32_bf16 v[44:47], v[60:63], v[128:131], v[44:47]
    v_mfma_f32_16x16x32_bf16 v[44:47], v[64:67], v[124:127], v[44:47]
    v_mfma_f32_16x16x32_bf16 v[44:47], v[68:71], v[120:123], v[44:47]
    v_mfma_f32_16x16x32_bf16 v[44:47], v[72:75], v[116:119], v[44:47]
    v_mfma_f32_16x16x32_bf16 v[44:47], v[76:79], v[112:115], v[44:47]
    s_waitcnt lgkmcnt(0)
    v_mfma_f32_16x16x32_bf16 v[16:19], v[80:83], v[144:147], v[16:19]
    ds_read_b128 v[112:115], v233 offset:3712
    v_mfma_f32_16x16x32_bf16 v[20:23], v[80:83], v[148:151], v[20:23]
    ds_read_b64 v[48:49], v232 offset:128
    v_mfma_f32_16x16x32_bf16 v[20:23], v[84:87], v[144:147], v[20:23]
    ds_read_b64 v[50:51], v232 offset:136
    v_mfma_f32_16x16x32_bf16 v[24:27], v[80:83], v[152:155], v[24:27]
    ds_read_b128 v[116:119], v233 offset:3200
    v_mfma_f32_16x16x32_bf16 v[24:27], v[84:87], v[148:151], v[24:27]
    ds_read_b64 v[52:53], v232 offset:640
    v_mfma_f32_16x16x32_bf16 v[24:27], v[88:91], v[144:147], v[24:27]
    ds_read_b64 v[54:55], v232 offset:648
    v_mfma_f32_16x16x32_bf16 v[28:31], v[80:83], v[156:159], v[28:31]
    ds_read_b128 v[120:123], v233 offset:2688
    v_mfma_f32_16x16x32_bf16 v[28:31], v[84:87], v[152:155], v[28:31]
    ds_read_b64 v[56:57], v232 offset:1152
    v_mfma_f32_16x16x32_bf16 v[28:31], v[88:91], v[148:151], v[28:31]
    ds_read_b64 v[58:59], v232 offset:1160
    v_mfma_f32_16x16x32_bf16 v[28:31], v[92:95], v[144:147], v[28:31]
    ds_read_b128 v[124:127], v233 offset:2176
    v_mfma_f32_16x16x32_bf16 v[32:35], v[80:83], v[160:163], v[32:35]
    ds_read_b64 v[60:61], v232 offset:1664
    v_mfma_f32_16x16x32_bf16 v[32:35], v[84:87], v[156:159], v[32:35]
    ds_read_b64 v[62:63], v232 offset:1672
    v_mfma_f32_16x16x32_bf16 v[32:35], v[88:91], v[152:155], v[32:35]
    ds_read_b128 v[128:131], v233 offset:1664
    v_mfma_f32_16x16x32_bf16 v[32:35], v[92:95], v[148:151], v[32:35]
    ds_read_b64 v[64:65], v232 offset:2176
    v_mfma_f32_16x16x32_bf16 v[32:35], v[96:99], v[144:147], v[32:35]
    ds_read_b64 v[66:67], v232 offset:2184
    v_mfma_f32_16x16x32_bf16 v[36:39], v[80:83], v[164:167], v[36:39]
    ds_read_b128 v[132:135], v233 offset:1152
    v_mfma_f32_16x16x32_bf16 v[36:39], v[84:87], v[160:163], v[36:39]
    ds_read_b64 v[68:69], v232 offset:2688
    v_mfma_f32_16x16x32_bf16 v[36:39], v[88:91], v[156:159], v[36:39]
    ds_read_b64 v[70:71], v232 offset:2696
    v_mfma_f32_16x16x32_bf16 v[36:39], v[92:95], v[152:155], v[36:39]
    ds_read_b128 v[136:139], v233 offset:640
    v_mfma_f32_16x16x32_bf16 v[36:39], v[96:99], v[148:151], v[36:39]
    ds_read_b64 v[72:73], v232 offset:3200
    v_mfma_f32_16x16x32_bf16 v[36:39], v[100:103], v[144:147], v[36:39]
    ds_read_b64 v[74:75], v232 offset:3208
    v_mfma_f32_16x16x32_bf16 v[40:43], v[80:83], v[168:171], v[40:43]
    ds_read_b128 v[140:143], v233 offset:128
    v_mfma_f32_16x16x32_bf16 v[40:43], v[84:87], v[164:167], v[40:43]
    ds_read_b64 v[76:77], v232 offset:3712
    v_mfma_f32_16x16x32_bf16 v[40:43], v[88:91], v[160:163], v[40:43]
    ds_read_b64 v[78:79], v232 offset:3720
    v_mfma_f32_16x16x32_bf16 v[40:43], v[92:95], v[156:159], v[40:43]
    v_add_u32 v232, 128, v232
    v_mfma_f32_16x16x32_bf16 v[40:43], v[96:99], v[152:155], v[40:43]
    v_add_u32 v233, 128, v233
    v_mfma_f32_16x16x32_bf16 v[40:43], v[100:103], v[148:151], v[40:43]
    s_sub_u32 s74, s74, 1
    v_mfma_f32_16x16x32_bf16 v[40:43], v[104:107], v[144:147], v[40:43]
    s_cmp_lg_u32 s74, 0
    v_mfma_f32_16x16x32_bf16 v[44:47], v[80:83], v[172:175], v[44:47]
    v_mfma_f32_16x16x32_bf16 v[44:47], v[84:87], v[168:171], v[44:47]
    v_mfma_f32_16x16x32_bf16 v[44:47], v[88:91], v[164:167], v[44:47]
    v_mfma_f32_16x16x32_bf16 v[44:47], v[92:95], v[160:163], v[44:47]
    v_mfma_f32_16x16x32_bf16 v[44:47], v[96:99], v[156:159], v[44:47]
    v_mfma_f32_16x16x32_bf16 v[44:47], v[100:103], v[152:155], v[44:47]
    v_mfma_f32_16x16x32_bf16 v[44:47], v[104:107], v[148:151], v[44:47]
    v_mfma_f32_16x16x32_bf16 v[44:47], v[108:111], v[144:147], v[44:47]
    s_waitcnt lgkmcnt(0)
    s_cbranch_scc1 L_conv
    v_mfma_f32_16x16x32_bf16 v[16:19], v[48:51], v[112:115], v[16:19]
    ds_read_b128 v[144:147], v233 offset:3648
    v_mfma_f32_16x16x32_bf16 v[20:23], v[48:51], v[116:119], v[20:23]
    ds_read_b64 v[80:81], v232 offset:64
    v_mfma_f32_16x16x32_bf16 v[20:23], v[52:55], v[112:115], v[20:23]
    ds_read_b64 v[82:83], v232 offset:72
    v_mfma_f32_16x16x32_bf16 v[24:27], v[48:51], v[120:123], v[24:27]
    ds_read_b128 v[148:151], v233 offset:3136
    v_mfma_f32_16x16x32_bf16 v[24:27], v[52:55], v[116:119], v[24:27]
    ds_read_b64 v[84:85], v232 offset:576
    v_mfma_f32_16x16x32_bf16 v[24:27], v[56:59], v[112:115], v[24:27]
    ds_read_b64 v[86:87], v232 offset:584
    v_mfma_f32_16x16x32_bf16 v[28:31], v[48:51], v[124:127], v[28:31]
    ds_read_b128 v[152:155], v233 offset:2624
    v_mfma_f32_16x16x32_bf16 v[28:31], v[52:55], v[120:123], v[28:31]
    ds_read_b64 v[88:89], v232 offset:1088
    v_mfma_f32_16x16x32_bf16 v[28:31], v[56:59], v[116:119], v[28:31]
    ds_read_b64 v[90:91], v232 offset:1096
    v_mfma_f32_16x16x32_bf16 v[28:31], v[60:63], v[112:115], v[28:31]
    ds_read_b128 v[156:159], v233 offset:2112
    v_mfma_f32_16x16x32_bf16 v[32:35], v[48:51], v[128:131], v[32:35]
    ds_read_b64 v[92:93], v232 offset:1600
    v_mfma_f32_16x16x32_bf16 v[32:35], v[52:55], v[124:127], v[32:35]
    ds_read_b64 v[94:95], v232 offset:1608
    v_mfma_f32_16x16x32_bf16 v[32:35], v[56:59], v[120:123], v[32:35]
    ds_read_b128 v[160:163], v233 offset:1600
    v_mfma_f32_16x16x32_bf16 v[32:35], v[60:63], v[116:119], v[32:35]
    ds_read_b64 v[96:97], v232 offset:2112
    v_mfma_f32_16x16x32_bf16 v[32:35], v[64:67], v[112:115], v[32:35]
    ds_read_b64 v[98:99], v232 offset:2120
    v_mfma_f32_16x16x32_bf16 v[36:39], v[48:51], v[132:135], v[36:39]
    ds_read_b128 v[164:167], v233 offset:1088
    v_mfma_f32_16x16x32_bf16 v[36:39], v[52:55], v[128:131], v[36:39]
    ds_read_b64 v[100:101], v232 offset:2624
    v_mfma_f32_16x16x32_bf16 v[36:39], v[56:59], v[124:127], v[36:39]
    ds_read_b64 v[102:103], v232 offset:2632
    v_mfma_f32_16x16x32_bf16 v[36:39], v[60:63], v[120:123], v[36:39]
    ds_read_b128 v[168:171], v233 offset:576
    v_mfma_f32_16x16x32_bf16 v[36:39], v[64:67], v[116:119], v[36:39]
    ds_read_b64 v[104:105], v232 offset:3136
    v_mfma_f32_16x16x32_bf16 v[36:39], v[68:71], v[112:115], v[36:39]
    ds_read_b64 v[106:107], v232 offset:3144
    v_mfma_f32_16x16x32_bf16 v[40:43], v[48:51], v[136:139], v[40:43]
    ds_read_b128 v[172:175], v233 offset:64
    v_mfma_f32_16x16x32_bf16 v[40:43], v[52:55], v[132:135], v[40:43]
    ds_read_b64 v[108:109], v232 offset:3648
    v_mfma_f32_16x16x32_bf16 v[40:43], v[56:59], v[128:131], v[40:43]
    ds_read_b64 v[110:111], v232 offset:3656
    v_mfma_f32_16x16x32_bf16 v[40:43], v[60:63], v[124:127], v[40:43]
    s_mul_i32 s74, s68, 4224
    v_mfma_f32_16x16x32_bf16 v[40:43], v[64:67], v[120:123], v[40:43]
    s_and_b32 s75, s71, 63
    v_mfma_f32_16x16x32_bf16 v[40:43], v[68:71], v[116:119], v[40:43]
    s_add_u32 s74, s74, s75
    v_mfma_f32_16x16x32_bf16 v[40:43], v[72:75], v[112:115], v[40:43]
    s_lshl_b32 s74, s74, 6
    v_mfma_f32_16x16x32_bf16 v[44:47], v[48:51], v[140:143], v[44:47]
    v_and_b32 v234, 3, v0
    v_mfma_f32_16x16x32_bf16 v[44:47], v[52:55], v[136:139], v[44:47]
    v_lshl_add_u32 v234, v234, 4, s74
    v_mfma_f32_16x16x32_bf16 v[44:47], v[56:59], v[132:135], v[44:47]
    v_and_b32 v235, 12, v0
    v_mfma_f32_16x16x32_bf16 v[44:47], v[60:63], v[128:131], v[44:47]
    v_lshrrev_b32 v236, 4, v0
    v_mfma_f32_16x16x32_bf16 v[44:47], v[64:67], v[124:127], v[44:47]
    v_add_u32 v235, v235, v236
    v_mfma_f32_16x16x32_bf16 v[44:47], v[68:71], v[120:123], v[44:47]
    v_mul_u32_u24 v235, 4224, v235
    v_mfma_f32_16x16x32_bf16 v[44:47], v[72:75], v[116:119], v[44:47]
    v_add_u32 v234, v234, v235
    v_mfma_f32_16x16x32_bf16 v[44:47], v[76:79], v[112:115], v[44:47]
    s_waitcnt lgkmcnt(0)
    s_mov_b64 exec, 1
    ds_add_u32 v227, v244 offset:36
    s_mov_b64 exec, -1
    v_mfma_f32_16x16x32_bf16 v[16:19], v[80:83], v[144:147], v[16:19]
    s_bfe_u32 s86, s2, 0x10002
    s_lshr_b32 s74, s2, 5
    v_mfma_f32_16x16x32_bf16 v[20:23], v[80:83], v[148:151], v[20:23]
    s_lshl3_add_u32 s86, s86, s74
    v_lshrrev_b32 v236, 4, v0
    v_mfma_f32_16x16x32_bf16 v[20:23], v[84:87], v[144:147], v[20:23]
    v_lshlrev_b32 v236, 1, v236
    v_xor_b32 v236, v0, v236
    v_mfma_f32_16x16x32_bf16 v[24:27], v[80:83], v[152:155], v[24:27]
    v_and_b32 v236, 7, v236
    s_lshl_b32 s74, s86, 7
    v_cvt_pk_bf16_f32 v48, v16, v17
    v_cvt_pk_bf16_f32 v49, v18, v19
    v_mfma_f32_16x16x32_bf16 v[24:27], v[84:87], v[148:151], v[24:27]
    v_lshl_add_u32 v236, v236, 4, s74
    v_lshrrev_b32 v235, 3, v0
    v_cvt_pk_bf16_f32 v50, v20, v21
    v_cvt_pk_bf16_f32 v51, v22, v23
    v_mfma_f32_16x16x32_bf16 v[24:27], v[88:91], v[144:147], v[24:27]
    v_lshl_add_u32 v235, v235, 11, v236
    s_mov_b32 s56, s24
    s_mov_b32 s76, 0
    buffer_store_dwordx4 v[48:51], v234, s[64:67], s76 offen sc1
    v_mfma_f32_16x16x32_bf16 v[28:31], v[80:83], v[156:159], v[28:31]
    s_mov_b32 s57, s25
    s_mov_b32 s58, 0x200000
    v_mfma_f32_16x16x32_bf16 v[28:31], v[84:87], v[152:155], v[28:31]
    s_mov_b32 s59, 0x20000
    s_mul_i32 s74, s86, 4
    v_cvt_pk_bf16_f32 v52, v24, v25
    v_cvt_pk_bf16_f32 v53, v26, v27
    v_mfma_f32_16x16x32_bf16 v[28:31], v[88:91], v[148:151], v[28:31]
    s_and_b32 s74, s74, 7
    s_lshl1_add_u32 s82, s74, s70
    v_mfma_f32_16x16x32_bf16 v[28:31], v[92:95], v[144:147], v[28:31]
    s_lshl_b32 s82, s82, 17
    s_lshl4_add_u32 s73, s68, 256
    v_mfma_f32_16x16x32_bf16 v[32:35], v[80:83], v[160:163], v[32:35]
    s_add_u32 s45, s73, s69
    s_lshl_b32 s73, s73, 8
    v_mfma_f32_16x16x32_bf16 v[32:35], v[84:87], v[156:159], v[32:35]
    s_lshl_b32 s45, s45, 8
    v_mfma_f32_16x16x32_bf16 v[32:35], v[88:91], v[152:155], v[32:35]
    v_mfma_f32_16x16x32_bf16 v[32:35], v[92:95], v[148:151], v[32:35]
    v_mfma_f32_16x16x32_bf16 v[32:35], v[96:99], v[144:147], v[32:35]
    v_cvt_pk_bf16_f32 v54, v28, v29
    v_cvt_pk_bf16_f32 v55, v30, v31
    v_mfma_f32_16x16x32_bf16 v[36:39], v[80:83], v[164:167], v[36:39]
    s_mov_b32 s76, 67584
    buffer_store_dwordx4 v[52:55], v234, s[64:67], s76 offen sc1
    v_mfma_f32_16x16x32_bf16 v[36:39], v[84:87], v[160:163], v[36:39]
    v_mfma_f32_16x16x32_bf16 v[36:39], v[88:91], v[156:159], v[36:39]
    v_mfma_f32_16x16x32_bf16 v[36:39], v[92:95], v[152:155], v[36:39]
    v_cvt_pk_bf16_f32 v56, v32, v33
    v_cvt_pk_bf16_f32 v57, v34, v35
    v_mfma_f32_16x16x32_bf16 v[36:39], v[96:99], v[148:151], v[36:39]
    v_mfma_f32_16x16x32_bf16 v[36:39], v[100:103], v[144:147], v[36:39]
    v_mfma_f32_16x16x32_bf16 v[40:43], v[80:83], v[168:171], v[40:43]
    v_mfma_f32_16x16x32_bf16 v[40:43], v[84:87], v[164:167], v[40:43]
    v_mfma_f32_16x16x32_bf16 v[40:43], v[88:91], v[160:163], v[40:43]
    v_mfma_f32_16x16x32_bf16 v[40:43], v[92:95], v[156:159], v[40:43]
    v_mfma_f32_16x16x32_bf16 v[40:43], v[96:99], v[152:155], v[40:43]
    v_mfma_f32_16x16x32_bf16 v[40:43], v[100:103], v[148:151], v[40:43]
    v_mfma_f32_16x16x32_bf16 v[40:43], v[104:107], v[144:147], v[40:43]
    v_mfma_f32_16x16x32_bf16 v[44:47], v[80:83], v[172:175], v[44:47]
    v_cvt_pk_bf16_f32 v58, v36, v37
    v_cvt_pk_bf16_f32 v59, v38, v39
    v_mfma_f32_16x16x32_bf16 v[44:47], v[84:87], v[168:171], v[44:47]
    s_mov_b32 s76, 135168
    buffer_store_dwordx4 v[56:59], v234, s[64:67], s76 offen sc1
    v_mfma_f32_16x16x32_bf16 v[44:47], v[88:91], v[164:167], v[44:47]
    v_mfma_f32_16x16x32_bf16 v[44:47], v[92:95], v[160:163], v[44:47]
    v_cvt_pk_bf16_f32 v60, v40, v41
    v_cvt_pk_bf16_f32 v61, v42, v43
    v_mfma_f32_16x16x32_bf16 v[44:47], v[96:99], v[156:159], v[44:47]
    v_mfma_f32_16x16x32_bf16 v[44:47], v[100:103], v[152:155], v[44:47]
    v_mfma_f32_16x16x32_bf16 v[44:47], v[104:107], v[148:151], v[44:47]
    v_mfma_f32_16x16x32_bf16 v[44:47], v[108:111], v[144:147], v[44:47]
    s_nop 7
    v_cvt_pk_bf16_f32 v62, v44, v45
    v_cvt_pk_bf16_f32 v63, v46, v47
    s_mov_b32 s76, 202752
    buffer_store_dwordx4 v[60:63], v234, s[64:67], s76 offen sc1
    s_setprio 1
    s_waitcnt vmcnt(0)
    v_mov_b32 v238, 1
    s_mov_b64 exec, 1
    ds_add_rtn_u32 v237, v227, v238 offset:8
    s_waitcnt lgkmcnt(0)
    v_readfirstlane_b32 s76, v237
    s_nop 0
    s_cmp_eq_u32 s76, 3
    s_cbranch_scc0 L_jo_35a
    s_mov_b64 exec, 0xffff
    v_lshlrev_b32 v237, 8, v0
    buffer_atomic_add v238, v237, s[52:55], s73 offen sc1
L_jo_35a:
    s_mov_b64 exec, -1
    v_lshlrev_b32 v112, 16, v208
    v_and_b32 v113, 0xffff0000, v208
    v_lshlrev_b32 v114, 16, v209
    v_and_b32 v115, 0xffff0000, v209
    v_lshlrev_b32 v116, 16, v210
    v_and_b32 v117, 0xffff0000, v210
    v_lshlrev_b32 v118, 16, v211
    v_and_b32 v119, 0xffff0000, v211
    v_lshlrev_b32 v120, 16, v212
    v_and_b32 v121, 0xffff0000, v212
    v_lshlrev_b32 v122, 16, v213
    v_and_b32 v123, 0xffff0000, v213
    v_lshlrev_b32 v124, 16, v214
    v_and_b32 v125, 0xffff0000, v214
    v_lshlrev_b32 v126, 16, v215
    v_and_b32 v127, 0xffff0000, v215
    v_lshlrev_b32 v128, 16, v216
    v_and_b32 v129, 0xffff0000, v216
    v_lshlrev_b32 v130, 16, v217
    v_and_b32 v131, 0xffff0000, v217
    v_lshlrev_b32 v132, 16, v218
    v_and_b32 v133, 0xffff0000, v218
    v_lshlrev_b32 v134, 16, v219
    v_and_b32 v135, 0xffff0000, v219
    v_lshlrev_b32 v136, 16, v220
    v_and_b32 v137, 0xffff0000, v220
    v_lshlrev_b32 v138, 16, v221
    v_and_b32 v139, 0xffff0000, v221
    v_lshlrev_b32 v140, 16, v222
    v_and_b32 v141, 0xffff0000, v222
    v_lshlrev_b32 v142, 16, v223
    v_and_b32 v143, 0xffff0000, v223
    s_setprio 1
    s_setprio 1
    s_mul_i32 s77, s70, 4352
    s_add_u32 s77, s77, 60416
    v_lshrrev_b32 v234, 5, v0
    v_lshl_add_u32 v234, v234, 1, v0
    v_lshl_add_u32 v234, v234, 4, s77
    v_and_b32 v235, 7, v0
    v_mul_u32_u24 v235, 544, v235
    v_lshrrev_b32 v236, 3, v0
    v_lshl_add_u32 v235, v236, 3, v235
    v_add_u32 v235, s77, v235
    s_mul_i32 s77, s71, 4224
    s_mov_b32 s60, s26
    s_mov_b32 s61, s27
    s_mov_b32 s62, 0x800000
    s_mov_b32 s63, 0x20000
    s_cmp_eq_u32 s76, 3
    s_cbranch_scc0 L_jo_35
    s_mov_b32 s75, 131072
L_sg_loop_38:
    s_load_dword s74, s[52:53], s45 glc
L_sg_chk_39:
    s_waitcnt lgkmcnt(0)
    s_cmp_ge_u32 s74, 16
    s_cbranch_scc1 L_sg_done_37
    s_sub_u32 s75, s75, 1
    s_cbranch_scc0 L_sg_loop_38
L_sg_done_37:
    v_mov_b32 v237, 16
    s_mov_b64 exec, 1
    ds_add_u32 v227, v237 offset:16
    s_mov_b64 exec, -1
    s_branch L_jd_36
L_jo_35:
    s_mov_b32 s75, 1048576
L_sl_loop_41:
    ds_read_b32 v237, v227 offset:16
    s_waitcnt lgkmcnt(0)
    v_readfirstlane_b32 s74, v237
    s_nop 0
    s_cmp_ge_u32 s74, 16
    s_cbranch_scc1 L_sl_done_40
    s_sleep 1
    s_sub_u32 s75, s75, 1
    s_cbranch_scc0 L_sl_loop_41
L_sl_done_40:
L_jd_36:
    buffer_load_dwordx4 v[48:51], v224, s[64:67], s77 offen offset:0 sc1
    buffer_load_dwordx4 v[52:55], v224, s[64:67], s77 offen offset:1024 sc1
    buffer_load_dwordx4 v[56:59], v224, s[64:67], s77 offen offset:2048 sc1
    buffer_load_dwordx4 v[60:63], v224, s[64:67], s77 offen offset:3072 sc1
    s_waitcnt vmcnt(3)
    ds_write_b128 v234, v[48:51] offset:0
    s_waitcnt vmcnt(2)
    ds_write_b128 v234, v[52:55] offset:1088
    s_waitcnt vmcnt(1)
    ds_write_b128 v234, v[56:59] offset:2176
    s_waitcnt vmcnt(0)
    ds_write_b128 v234, v[60:63] offset:3264
    ds_read_b64 v[64:65], v235 offset:0
    ds_read_b64 v[66:67], v235 offset:64
    ds_read_b64 v[68:69], v235 offset:128
    ds_read_b64 v[70:71], v235 offset:192
    ds_read_b64 v[72:73], v235 offset:256
    ds_read_b64 v[74:75], v235 offset:320
    ds_read_b64 v[76:77], v235 offset:384
    ds_read_b64 v[78:79], v235 offset:448
    s_waitcnt lgkmcnt(7)
    v_lshlrev_b32 v16, 16, v64
    v_and_b32 v24, 0xffff0000, v64
    v_lshlrev_b32 v32, 16, v65
    v_and_b32 v40, 0xffff0000, v65
    s_waitcnt lgkmcnt(6)
    v_lshlrev_b32 v17, 16, v66
    v_and_b32 v25, 0xffff0000, v66
    v_lshlrev_b32 v33, 16, v67
    v_and_b32 v41, 0xffff0000, v67
    s_waitcnt lgkmcnt(5)
    v_lshlrev_b32 v18, 16, v68
    v_and_b32 v26, 0xffff0000, v68
    v_lshlrev_b32 v34, 16, v69
    v_and_b32 v42, 0xffff0000, v69
    s_waitcnt lgkmcnt(4)
    v_lshlrev_b32 v19, 16, v70
    v_and_b32 v27, 0xffff0000, v70
    v_lshlrev_b32 v35, 16, v71
    v_and_b32 v43, 0xffff0000, v71
    s_waitcnt lgkmcnt(3)
    v_lshlrev_b32 v20, 16, v72
    v_and_b32 v28, 0xffff0000, v72
    v_lshlrev_b32 v36, 16, v73
    v_and_b32 v44, 0xffff0000, v73
    s_waitcnt lgkmcnt(2)
    v_lshlrev_b32 v21, 16, v74
    v_and_b32 v29, 0xffff0000, v74
    v_lshlrev_b32 v37, 16, v75
    v_and_b32 v45, 0xffff0000, v75
    s_waitcnt lgkmcnt(1)
    v_lshlrev_b32 v22, 16, v76
    v_and_b32 v30, 0xffff0000, v76
    v_lshlrev_b32 v38, 16, v77
    v_and_b32 v46, 0xffff0000, v77
    s_waitcnt lgkmcnt(0)
    v_lshlrev_b32 v23, 16, v78
    v_and_b32 v31, 0xffff0000, v78
    v_lshlrev_b32 v39, 16, v79
    v_and_b32 v47, 0xffff0000, v79
    v_mul_f32 v16, v16, v112
    v_mul_f32 v17, v17, v113
    v_mul_f32 v18, v18, v114
    v_mul_f32 v19, v19, v115
    v_mul_f32 v20, v20, v116
    v_mul_f32 v21, v21, v117
    v_mul_f32 v22, v22, v118
    v_mul_f32 v23, v23, v119
    v_cvt_pk_bf16_f32 v48, v16, v17
    v_cvt_pk_bf16_f32 v49, v18, v19
    v_cvt_pk_bf16_f32 v50, v20, v21
    v_cvt_pk_bf16_f32 v51, v22, v23
    s_mov_b32 s74, 0
    buffer_store_dwordx4 v[48:51], v226, s[60:63], s74 offen nt
    v_mul_f32 v24, v24, v120
    v_mul_f32 v25, v25, v121
    v_mul_f32 v26, v26, v122
    v_mul_f32 v27, v27, v123
    v_mul_f32 v28, v28, v124
    v_mul_f32 v29, v29, v125
    v_mul_f32 v30, v30, v126
    v_mul_f32 v31, v31, v127
    v_cvt_pk_bf16_f32 v52, v24, v25
    v_cvt_pk_bf16_f32 v53, v26, v27
    v_cvt_pk_bf16_f32 v54, v28, v29
    v_cvt_pk_bf16_f32 v55, v30, v31
    s_mov_b32 s74, 4096
    buffer_store_dwordx4 v[52:55], v226, s[60:63], s74 offen nt
    v_mul_f32 v32, v32, v128
    v_mul_f32 v33, v33, v129
    v_mul_f32 v34, v34, v130
    v_mul_f32 v35, v35, v131
    v_mul_f32 v36, v36, v132
    v_mul_f32 v37, v37, v133
    v_mul_f32 v38, v38, v134
    v_mul_f32 v39, v39, v135
    v_cvt_pk_bf16_f32 v56, v32, v33
    v_cvt_pk_bf16_f32 v57, v34, v35
    v_cvt_pk_bf16_f32 v58, v36, v37
    v_cvt_pk_bf16_f32 v59, v38, v39
    s_mov_b32 s74, 16384
    buffer_store_dwordx4 v[56:59], v226, s[60:63], s74 offen nt
    v_mul_f32 v40, v40, v136
    v_mul_f32 v41, v41, v137
    v_mul_f32 v42, v42, v138
    v_mul_f32 v43, v43, v139
    v_mul_f32 v44, v44, v140
    v_mul_f32 v45, v45, v141
    v_mul_f32 v46, v46, v142
    v_mul_f32 v47, v47, v143
    v_cvt_pk_bf16_f32 v60, v40, v41
    v_cvt_pk_bf16_f32 v61, v42, v43
    v_cvt_pk_bf16_f32 v62, v44, v45
    v_cvt_pk_bf16_f32 v63, v46, v47
    s_mov_b32 s74, 20480
    buffer_store_dwordx4 v[60:63], v226, s[60:63], s74 offen nt
    s_endpgm
L_grole:
    s_setprio 2
    s_add_u32 s52, s30, 0xe00000
    s_addc_u32 s53, s31, 0
    s_mov_b32 s54, 0x20000
    s_mov_b32 s55, 0x20000
    s_lshr_b32 s32, s3, 1
    s_and_b32 s33, s3, 1
    v_and_b32 v1, 15, v0
    v_lshrrev_b32 v2, 4, v0
    v_lshrrev_b32 v3, 1, v1
    v_xor_b32 v3, v2, v3
    v_lshlrev_b32 v3, 4, v3
    v_lshl_add_u32 v3, v1, 7, v3
    s_lshl_b32 s37, s33, 13
    v_add_u32 v196, s37, v3
    v_xor_b32 v197, 64, v196
    v_and_b32 v198, 7, v1
    v_lshlrev_b32 v3, 1, v2
    v_xor_b32 v3, v3, v198
    v_lshlrev_b32 v3, 4, v3
    v_lshl_add_u32 v3, v198, 7, v3
    v_lshrrev_b32 v202, 3, v1
    v_lshl_add_u32 v3, v202, 2, v3
    v_add_u32 v198, 16384, v3
    v_xor_b32 v199, 16, v198
    v_mul_u32_u24 v202, 0xaaaa, v202
    v_add_u32 v202, 0x4444, v202
    v_bfe_u32 v3, v0, 2, 2
    v_lshl_add_u32 v200, v2, 3, v3
    v_lshlrev_b32 v200, 7, v200
    v_bfe_u32 v3, v0, 3, 2
    v_xor_b32 v3, s3, v3
    v_lshl_add_u32 v200, v3, 5, v200
    v_and_b32 v3, 3, v0
    v_lshl_add_u32 v200, v3, 3, v200
    v_add_u32 v200, 17408, v200
    v_xor_b32 v201, 32, v200
    v_mov_b64 v[52:53], 0
    v_mov_b64 v[54:55], 0
    v_mov_b64 v[56:57], 0
    v_mov_b64 v[58:59], 0
    v_mov_b64 v[60:61], 0
    v_mov_b64 v[62:63], 0
    v_mov_b64 v[64:65], 0
    v_mov_b64 v[66:67], 0
    v_mov_b64 v[68:69], 0
    v_mov_b64 v[70:71], 0
    v_mov_b64 v[72:73], 0
    v_mov_b64 v[74:75], 0
    v_mov_b64 v[76:77], 0
    v_mov_b64 v[78:79], 0
    v_mov_b64 v[80:81], 0
    v_mov_b64 v[82:83], 0
    v_mov_b64 v[84:85], 0
    v_mov_b64 v[86:87], 0
    v_mov_b64 v[88:89], 0
    v_mov_b64 v[90:91], 0
    v_mov_b64 v[92:93], 0
    v_mov_b64 v[94:95], 0
    v_mov_b64 v[96:97], 0
    v_mov_b64 v[98:99], 0
    v_mov_b64 v[100:101], 0
    v_mov_b64 v[102:103], 0
    v_mov_b64 v[104:105], 0
    v_mov_b64 v[106:107], 0
    s_mov_b32 s34, 0
    v_mov_b32 v228, 134352
    v_and_b32 v1, 15, v0
    v_lshrrev_b32 v2, 4, v0
    v_lshlrev_b32 v2, 2, v2
    v_sub_u32 v1, v1, v2
    s_mov_b32 s37, 0xf149f2ca
    v_mov_b32 v3, s37
    s_or_b32 s38, s5, s33
    s_cmp_eq_u32 s38, 0
    s_cselect_b32 s38, s37, 0
    v_subrev_u32 v2, 0, v1
    v_cmp_gt_u32 vcc, 8, v2
    v_cmp_gt_i32 s[64:65], -8, v2
    v_ashrrev_i32 v2, 31, v2
    v_cndmask_b32 v204, v3, 0, vcc
    v_cndmask_b32 v208, v3, 0, s[64:65]
    v_mov_b32 v216, v2
    v_min_f32 v212, s38, v208
    v_subrev_u32 v2, 1, v1
    v_cmp_gt_u32 vcc, 8, v2
    v_cmp_gt_i32 s[64:65], -8, v2
    v_ashrrev_i32 v2, 31, v2
    v_cndmask_b32 v205, v3, 0, vcc
    v_cndmask_b32 v209, v3, 0, s[64:65]
    v_alignbit_b32 v216, v2, v216, 16
    v_min_f32 v213, s38, v209
    v_subrev_u32 v2, 2, v1
    v_cmp_gt_u32 vcc, 8, v2
    v_cmp_gt_i32 s[64:65], -8, v2
    v_ashrrev_i32 v2, 31, v2
    v_cndmask_b32 v206, v3, 0, vcc
    v_cndmask_b32 v210, v3, 0, s[64:65]
    v_mov_b32 v217, v2
    v_min_f32 v214, s38, v210
    v_subrev_u32 v2, 3, v1
    v_cmp_gt_u32 vcc, 8, v2
    v_cmp_gt_i32 s[64:65], -8, v2
    v_ashrrev_i32 v2, 31, v2
    v_cndmask_b32 v207, v3, 0, vcc
    v_cndmask_b32 v211, v3, 0, s[64:65]
    v_alignbit_b32 v217, v2, v217, 16
    v_min_f32 v215, s38, v211
    s_mul_i32 s37, s32, 80896
    s_add_u32 s37, s37, 78848
    v_lshl_add_u32 v220, v0, 3, s37
    s_lshl_b32 s38, s33, 9
    v_add_u32 v219, s38, v220
    s_add_u32 s38, s38, s37
    v_and_b32 v1, 3, v0
    v_lshl_add_u32 v1, v1, 1, s38
    v_bfe_u32 v2, v0, 2, 2
    v_lshl_add_u32 v1, v2, 7, v1
    v_lshrrev_b32 v2, 4, v0
    v_xor_b32 v2, 2, v2
    v_lshl_add_u32 v203, v2, 5, v1
    s_mul_i32 s38, s33, 2560
    v_add_u32 v221, s38, v220
    v_xor_b32 v222, 512, v221
    s_lshl3_add_u32 s37, s4, s5
    s_lshl1_add_u32 s37, s37, s33
    s_lshl_b32 s37, s37, 7
    s_lshl1_add_u32 s38, s6, s32
    s_add_u32 s37, s37, s38
    s_lshl_b32 s37, s37, 10
    v_lshl_add_u32 v218, v0, 4, s37
    s_mov_b32 s40, s30
    s_mov_b32 s41, s31
    s_mov_b32 s42, 0x400000
    s_mov_b32 s43, 0x20000
    s_and_b32 s58, s2, 3
    s_bfe_u32 s37, s2, 0x20003
    s_lshl2_add_u32 s58, s58, s37
    s_bfe_u32 s59, s2, 0x10002
    s_lshr_b32 s37, s2, 5
    s_lshl3_add_u32 s59, s59, s37
    s_mov_b32 s44, s24
    s_mov_b32 s45, s25
    s_mov_b32 s46, 0x200000
    s_mov_b32 s47, 0x20000
    s_mov_b32 s48, s26
    s_mov_b32 s49, s27
    s_mov_b32 s50, 0x800000
    s_mov_b32 s51, 0x20000
    s_lshl3_add_u32 s56, s4, s5
    s_lshl4_add_u32 s56, s56, 0
    s_lshl_b32 s56, s56, 8
    s_lshl4_add_u32 s57, s58, 0
    s_add_u32 s57, s57, s59
    s_lshl_b32 s57, s57, 8
    s_lshl2_add_u32 s37, s58, s3
    s_lshl_b32 s38, s37, 16
    v_lshl_add_u32 v224, v0, 4, s38
    v_add_u32 v225, 0x8000, v224
    s_and_b32 s37, s37, 31
    s_lshl_b32 s37, s37, 6
    s_lshr_b32 s38, s58, 3
    s_add_u32 s37, s37, s38
    s_lshl_b32 s37, s37, 5
    s_add_u32 s37, s37, s59
    s_add_u32 s37, s37, 16
    s_lshl_b32 s37, s37, 7
    v_lshrrev_b32 v1, 3, v0
    v_lshl_add_u32 v1, v1, 13, s37
    v_and_b32 v2, 7, v0
    v_lshl_add_u32 v226, v2, 4, v1
    v_lshrrev_b32 v1, 4, v0
    v_lshlrev_b32 v1, 1, v1
    v_xor_b32 v1, v0, v1
    v_and_b32 v1, 7, v1
    s_lshl_b32 s37, s59, 7
    v_lshl_add_u32 v1, v1, 4, s37
    v_lshrrev_b32 v227, 3, v0
    v_lshl_add_u32 v227, v227, 11, v1
    v_add_u32 v223, 15360, v227
    s_lshl_b32 s60, s3, 11
    s_mul_i32 s61, s59, 4
    s_and_b32 s61, s61, 7
    s_lshl3_add_u32 s62, s61, s3
    s_lshl_b32 s62, s62, 15
    v_lshrrev_b32 v1, 2, v0
    v_lshlrev_b32 v1, 7, v1
    v_bfe_u32 v2, v0, 3, 2
    v_lshl_add_u32 v1, v2, 5, v1
    v_and_b32 v2, 3, v0
    v_lshl_add_u32 v229, v2, 3, v1
    v_and_b32 v231, 7, v0
    v_lshl_add_u32 v230, v231, 6, s86
    v_mul_u32_u24 v231, 528, v231
    v_lshrrev_b32 v232, 3, v0
    v_xor_b32 v232, 7, v232
    v_lshl_add_u32 v231, v232, 3, v231
    v_add_u32 v231, s86, v231
    v_lshrrev_b32 v232, 5, v0
    v_add_u32 v232, v0, v232
    v_lshl_add_u32 v232, v232, 4, s86
    s_mul_i32 s87, s84, 4224
    s_sub_u32 s87, s87, s85
    s_lshl_b32 s87, s87, 6
    s_add_u32 s87, s87, 4032
    v_and_b32 v233, 3, v0
    v_lshl_add_u32 v233, v233, 4, s87
    v_lshrrev_b32 v234, 2, v0
    v_mul_u32_u24 v234, 4224, v234
    v_add_u32 v233, v233, v234
    s_add_u32 s80, s30, 0x400000
    s_addc_u32 s81, s31, 0
    s_mov_b32 s82, 0x420000
    s_mov_b32 s83, 0x20000
    s_waitcnt vmcnt(11)
    ds_read_b128 v[36:39], v230 offset:4224
    ds_read_b128 v[40:43], v230 offset:4240
    ds_read_b128 v[44:47], v230 offset:4256
    ds_read_b128 v[48:51], v230 offset:4272
    s_waitcnt lgkmcnt(3)
    v_lshlrev_b32 v152, 16, v36
    v_and_b32 v154, 0xffff0000, v36
    v_lshlrev_b32 v156, 16, v37
    v_and_b32 v158, 0xffff0000, v37
    v_lshlrev_b32 v153, 16, v38
    v_and_b32 v155, 0xffff0000, v38
    v_lshlrev_b32 v157, 16, v39
    v_and_b32 v159, 0xffff0000, v39
    s_waitcnt lgkmcnt(2)
    v_lshlrev_b32 v160, 16, v40
    v_and_b32 v162, 0xffff0000, v40
    v_lshlrev_b32 v164, 16, v41
    v_and_b32 v166, 0xffff0000, v41
    v_lshlrev_b32 v161, 16, v42
    v_and_b32 v163, 0xffff0000, v42
    v_lshlrev_b32 v165, 16, v43
    v_and_b32 v167, 0xffff0000, v43
    s_waitcnt lgkmcnt(1)
    v_lshlrev_b32 v168, 16, v44
    v_and_b32 v170, 0xffff0000, v44
    v_lshlrev_b32 v172, 16, v45
    v_and_b32 v174, 0xffff0000, v45
    v_lshlrev_b32 v169, 16, v46
    v_and_b32 v171, 0xffff0000, v46
    v_lshlrev_b32 v173, 16, v47
    v_and_b32 v175, 0xffff0000, v47
    s_waitcnt lgkmcnt(0)
    v_lshlrev_b32 v176, 16, v48
    v_and_b32 v178, 0xffff0000, v48
    v_lshlrev_b32 v180, 16, v49
    v_and_b32 v182, 0xffff0000, v49
    v_lshlrev_b32 v177, 16, v50
    v_and_b32 v179, 0xffff0000, v50
    v_lshlrev_b32 v181, 16, v51
    v_and_b32 v183, 0xffff0000, v51
    v_mov_b64 v[36:37], 0
    v_mov_b64 v[38:39], 0
    v_mov_b64 v[40:41], 0
    v_mov_b64 v[42:43], 0
    v_mov_b64 v[44:45], 0
    v_mov_b64 v[46:47], 0
    v_mov_b64 v[48:49], 0
    v_mov_b64 v[50:51], 0
    s_waitcnt vmcnt(10)
    v_lshlrev_b32 v184, 16, v108
    v_and_b32 v185, 0xffff0000, v108
    v_lshlrev_b32 v186, 16, v109
    v_and_b32 v187, 0xffff0000, v109
    v_lshlrev_b32 v188, 16, v110
    v_and_b32 v189, 0xffff0000, v110
    v_lshlrev_b32 v190, 16, v111
    v_and_b32 v191, 0xffff0000, v111
    v_pk_mul_f32 v[4:5], v[184:185], v[158:159]
    v_pk_mul_f32 v[12:13], v[186:187], v[166:167]
    v_pk_mul_f32 v[20:21], v[188:189], v[174:175]
    v_pk_mul_f32 v[28:29], v[190:191], v[182:183]
    s_waitcnt vmcnt(9)
    v_lshlrev_b32 v184, 16, v112
    v_and_b32 v185, 0xffff0000, v112
    v_lshlrev_b32 v186, 16, v113
    v_and_b32 v187, 0xffff0000, v113
    v_lshlrev_b32 v188, 16, v114
    v_and_b32 v189, 0xffff0000, v114
    v_lshlrev_b32 v190, 16, v115
    v_and_b32 v191, 0xffff0000, v115
    v_pk_fma_f32 v[4:5], v[184:185], v[156:157], v[4:5]
    v_pk_fma_f32 v[12:13], v[186:187], v[164:165], v[12:13]
    v_pk_fma_f32 v[20:21], v[188:189], v[172:173], v[20:21]
    v_pk_fma_f32 v[28:29], v[190:191], v[180:181], v[28:29]
    v_pk_mul_f32 v[6:7], v[184:185], v[158:159]
    v_pk_mul_f32 v[14:15], v[186:187], v[166:167]
    v_pk_mul_f32 v[22:23], v[188:189], v[174:175]
    v_pk_mul_f32 v[30:31], v[190:191], v[182:183]
    s_waitcnt vmcnt(8)
    v_lshlrev_b32 v184, 16, v116
    v_and_b32 v185, 0xffff0000, v116
    v_lshlrev_b32 v186, 16, v117
    v_and_b32 v187, 0xffff0000, v117
    v_lshlrev_b32 v188, 16, v118
    v_and_b32 v189, 0xffff0000, v118
    v_lshlrev_b32 v190, 16, v119
    v_and_b32 v191, 0xffff0000, v119
    v_pk_fma_f32 v[4:5], v[184:185], v[154:155], v[4:5]
    v_pk_fma_f32 v[12:13], v[186:187], v[162:163], v[12:13]
    v_pk_fma_f32 v[20:21], v[188:189], v[170:171], v[20:21]
    v_pk_fma_f32 v[28:29], v[190:191], v[178:179], v[28:29]
    v_pk_fma_f32 v[6:7], v[184:185], v[156:157], v[6:7]
    v_pk_fma_f32 v[14:15], v[186:187], v[164:165], v[14:15]
    v_pk_fma_f32 v[22:23], v[188:189], v[172:173], v[22:23]
    v_pk_fma_f32 v[30:31], v[190:191], v[180:181], v[30:31]
    v_pk_mul_f32 v[8:9], v[184:185], v[158:159]
    v_pk_mul_f32 v[16:17], v[186:187], v[166:167]
    v_pk_mul_f32 v[24:25], v[188:189], v[174:175]
    v_pk_mul_f32 v[32:33], v[190:191], v[182:183]
    s_waitcnt vmcnt(7)
    v_lshlrev_b32 v184, 16, v120
    v_and_b32 v185, 0xffff0000, v120
    v_lshlrev_b32 v186, 16, v121
    v_and_b32 v187, 0xffff0000, v121
    v_lshlrev_b32 v188, 16, v122
    v_and_b32 v189, 0xffff0000, v122
    v_lshlrev_b32 v190, 16, v123
    v_and_b32 v191, 0xffff0000, v123
    v_pk_fma_f32 v[4:5], v[184:185], v[152:153], v[4:5]
    v_pk_fma_f32 v[12:13], v[186:187], v[160:161], v[12:13]
    v_pk_fma_f32 v[20:21], v[188:189], v[168:169], v[20:21]
    v_pk_fma_f32 v[28:29], v[190:191], v[176:177], v[28:29]
    v_pk_fma_f32 v[6:7], v[184:185], v[154:155], v[6:7]
    v_pk_fma_f32 v[14:15], v[186:187], v[162:163], v[14:15]
    v_pk_fma_f32 v[22:23], v[188:189], v[170:171], v[22:23]
    v_pk_fma_f32 v[30:31], v[190:191], v[178:179], v[30:31]
    v_pk_fma_f32 v[8:9], v[184:185], v[156:157], v[8:9]
    v_pk_fma_f32 v[16:17], v[186:187], v[164:165], v[16:17]
    v_pk_fma_f32 v[24:25], v[188:189], v[172:173], v[24:25]
    v_pk_fma_f32 v[32:33], v[190:191], v[180:181], v[32:33]
    v_pk_mul_f32 v[10:11], v[184:185], v[158:159]
    v_pk_mul_f32 v[18:19], v[186:187], v[166:167]
    v_pk_mul_f32 v[26:27], v[188:189], v[174:175]
    v_pk_mul_f32 v[34:35], v[190:191], v[182:183]
    s_waitcnt vmcnt(6)
    v_lshlrev_b32 v184, 16, v124
    v_and_b32 v185, 0xffff0000, v124
    v_lshlrev_b32 v186, 16, v125
    v_and_b32 v187, 0xffff0000, v125
    v_lshlrev_b32 v188, 16, v126
    v_and_b32 v189, 0xffff0000, v126
    v_lshlrev_b32 v190, 16, v127
    v_and_b32 v191, 0xffff0000, v127
    v_pk_fma_f32 v[6:7], v[184:185], v[152:153], v[6:7]
    v_pk_fma_f32 v[14:15], v[186:187], v[160:161], v[14:15]
    v_pk_fma_f32 v[22:23], v[188:189], v[168:169], v[22:23]
    v_pk_fma_f32 v[30:31], v[190:191], v[176:177], v[30:31]
    v_pk_fma_f32 v[8:9], v[184:185], v[154:155], v[8:9]
    v_pk_fma_f32 v[16:17], v[186:187], v[162:163], v[16:17]
    v_pk_fma_f32 v[24:25], v[188:189], v[170:171], v[24:25]
    v_pk_fma_f32 v[32:33], v[190:191], v[178:179], v[32:33]
    v_pk_fma_f32 v[10:11], v[184:185], v[156:157], v[10:11]
    v_pk_fma_f32 v[18:19], v[186:187], v[164:165], v[18:19]
    v_pk_fma_f32 v[26:27], v[188:189], v[172:173], v[26:27]
    v_pk_fma_f32 v[34:35], v[190:191], v[180:181], v[34:35]
    s_waitcnt vmcnt(5)
    v_lshlrev_b32 v184, 16, v128
    v_and_b32 v185, 0xffff0000, v128
    v_lshlrev_b32 v186, 16, v129
    v_and_b32 v187, 0xffff0000, v129
    v_lshlrev_b32 v188, 16, v130
    v_and_b32 v189, 0xffff0000, v130
    v_lshlrev_b32 v190, 16, v131
    v_and_b32 v191, 0xffff0000, v131
    v_pk_fma_f32 v[8:9], v[184:185], v[152:153], v[8:9]
    v_pk_fma_f32 v[16:17], v[186:187], v[160:161], v[16:17]
    v_pk_fma_f32 v[24:25], v[188:189], v[168:169], v[24:25]
    v_pk_fma_f32 v[32:33], v[190:191], v[176:177], v[32:33]
    v_pk_fma_f32 v[10:11], v[184:185], v[154:155], v[10:11]
    v_pk_fma_f32 v[18:19], v[186:187], v[162:163], v[18:19]
    v_pk_fma_f32 v[26:27], v[188:189], v[170:171], v[26:27]
    v_pk_fma_f32 v[34:35], v[190:191], v[178:179], v[34:35]
    s_waitcnt vmcnt(4)
    v_lshlrev_b32 v184, 16, v132
    v_and_b32 v185, 0xffff0000, v132
    v_lshlrev_b32 v186, 16, v133
    v_and_b32 v187, 0xffff0000, v133
    v_lshlrev_b32 v188, 16, v134
    v_and_b32 v189, 0xffff0000, v134
    v_lshlrev_b32 v190, 16, v135
    v_and_b32 v191, 0xffff0000, v135
    v_pk_fma_f32 v[10:11], v[184:185], v[152:153], v[10:11]
    v_pk_fma_f32 v[18:19], v[186:187], v[160:161], v[18:19]
    v_pk_fma_f32 v[26:27], v[188:189], v[168:169], v[26:27]
    v_pk_fma_f32 v[34:35], v[190:191], v[176:177], v[34:35]
    s_waitcnt vmcnt(3)
    v_lshlrev_b32 v184, 16, v136
    v_and_b32 v185, 0xffff0000, v136
    v_lshlrev_b32 v186, 16, v137
    v_and_b32 v187, 0xffff0000, v137
    v_lshlrev_b32 v188, 16, v138
    v_and_b32 v189, 0xffff0000, v138
    v_lshlrev_b32 v190, 16, v139
    v_and_b32 v191, 0xffff0000, v139
    v_pk_mul_f32 v[4:5], v[4:5], v[184:185]
    v_pk_mul_f32 v[12:13], v[12:13], v[186:187]
    v_pk_mul_f32 v[20:21], v[20:21], v[188:189]
    v_pk_mul_f32 v[28:29], v[28:29], v[190:191]
    s_waitcnt vmcnt(2)
    v_lshlrev_b32 v184, 16, v140
    v_and_b32 v185, 0xffff0000, v140
    v_lshlrev_b32 v186, 16, v141
    v_and_b32 v187, 0xffff0000, v141
    v_lshlrev_b32 v188, 16, v142
    v_and_b32 v189, 0xffff0000, v142
    v_lshlrev_b32 v190, 16, v143
    v_and_b32 v191, 0xffff0000, v143
    v_pk_mul_f32 v[6:7], v[6:7], v[184:185]
    v_pk_mul_f32 v[14:15], v[14:15], v[186:187]
    v_pk_mul_f32 v[22:23], v[22:23], v[188:189]
    v_pk_mul_f32 v[30:31], v[30:31], v[190:191]
    s_waitcnt vmcnt(1)
    v_lshlrev_b32 v184, 16, v144
    v_and_b32 v185, 0xffff0000, v144
    v_lshlrev_b32 v186, 16, v145
    v_and_b32 v187, 0xffff0000, v145
    v_lshlrev_b32 v188, 16, v146
    v_and_b32 v189, 0xffff0000, v146
    v_lshlrev_b32 v190, 16, v147
    v_and_b32 v191, 0xffff0000, v147
    v_pk_mul_f32 v[8:9], v[8:9], v[184:185]
    v_pk_mul_f32 v[16:17], v[16:17], v[186:187]
    v_pk_mul_f32 v[24:25], v[24:25], v[188:189]
    v_pk_mul_f32 v[32:33], v[32:33], v[190:191]
    s_waitcnt vmcnt(0)
    v_lshlrev_b32 v184, 16, v148
    v_and_b32 v185, 0xffff0000, v148
    v_lshlrev_b32 v186, 16, v149
    v_and_b32 v187, 0xffff0000, v149
    v_lshlrev_b32 v188, 16, v150
    v_and_b32 v189, 0xffff0000, v150
    v_lshlrev_b32 v190, 16, v151
    v_and_b32 v191, 0xffff0000, v151
    v_pk_mul_f32 v[10:11], v[10:11], v[184:185]
    v_pk_mul_f32 v[18:19], v[18:19], v[186:187]
    v_pk_mul_f32 v[26:27], v[26:27], v[188:189]
    v_pk_mul_f32 v[34:35], v[34:35], v[190:191]
    v_cvt_pk_bf16_f32 v108, v10, v8
    v_cvt_pk_bf16_f32 v109, v6, v4
    ds_write_b64 v231, v[108:109] offset:0
    v_cvt_pk_bf16_f32 v110, v11, v9
    v_cvt_pk_bf16_f32 v111, v7, v5
    ds_write_b64 v231, v[110:111] offset:64
    v_cvt_pk_bf16_f32 v112, v18, v16
    v_cvt_pk_bf16_f32 v113, v14, v12
    ds_write_b64 v231, v[112:113] offset:128
    v_cvt_pk_bf16_f32 v114, v19, v17
    v_cvt_pk_bf16_f32 v115, v15, v13
    ds_write_b64 v231, v[114:115] offset:192
    v_cvt_pk_bf16_f32 v116, v26, v24
    v_cvt_pk_bf16_f32 v117, v22, v20
    ds_write_b64 v231, v[116:117] offset:256
    v_cvt_pk_bf16_f32 v118, v27, v25
    v_cvt_pk_bf16_f32 v119, v23, v21
    ds_write_b64 v231, v[118:119] offset:320
    v_cvt_pk_bf16_f32 v120, v34, v32
    v_cvt_pk_bf16_f32 v121, v30, v28
    ds_write_b64 v231, v[120:121] offset:384
    v_cvt_pk_bf16_f32 v122, v35, v33
    v_cvt_pk_bf16_f32 v123, v31, v29
    ds_write_b64 v231, v[122:123] offset:448
    ds_read_b128 v[234:237], v232 offset:0
    ds_read_b128 v[238:241], v232 offset:1056
    ds_read_b128 v[242:245], v232 offset:2112
    ds_read_b128 v[246:249], v232 offset:3168
    v_mov_b64 v[4:5], 0
    v_mov_b64 v[6:7], 0
    v_mov_b64 v[8:9], 0
    v_mov_b64 v[10:11], 0
    v_mov_b64 v[12:13], 0
    v_mov_b64 v[14:15], 0
    v_mov_b64 v[16:17], 0
    v_mov_b64 v[18:19], 0
    v_mov_b64 v[20:21], 0
    v_mov_b64 v[22:23], 0
    v_mov_b64 v[24:25], 0
    v_mov_b64 v[26:27], 0
    v_mov_b64 v[28:29], 0
    v_mov_b64 v[30:31], 0
    v_mov_b64 v[32:33], 0
    v_mov_b64 v[34:35], 0
    s_waitcnt lgkmcnt(0)
    s_and_b32 s37, s2, 7
    s_xor_b32 s37, s37, 2
    s_lshl_b32 s37, s37, 5
    s_lshr_b32 s38, s2, 3
    s_add_u32 s37, s37, s38
    s_add_u32 s37, s37, 256
    s_lshl_b32 s37, s37, 8
    s_cmp_eq_u32 s33, 0
    s_cselect_b32 s37, s37, s57
    s_cmp_eq_u32 s32, 0
    s_cbranch_scc0 L_noclear
    s_mov_b64 exec, 1
    buffer_store_dword v4, off, s[52:55], s37 sc1
    s_mov_b64 exec, -1
L_noclear:
    s_mov_b32 s37, 41984
    s_mov_b32 s36, 15
    s_barrier
    ds_read_b128 v[108:111], v196 offset:0
    ds_read_b64_tr_b16 v[124:125], v200 offset:0
    ds_read_b64_tr_b16 v[126:127], v200 offset:512
    ds_read_b128 v[112:115], v196 offset:2048
    ds_read_b64_tr_b16 v[128:129], v201 offset:0
    ds_read_b64_tr_b16 v[130:131], v201 offset:512
    ds_read_b128 v[116:119], v196 offset:4096
    ds_read_b64_tr_b16 v[148:149], v200 offset:8192
    ds_read_b64_tr_b16 v[150:151], v200 offset:8704
    ds_read_b128 v[120:123], v196 offset:6144
    ds_read_b64_tr_b16 v[132:133], v201 offset:8192
    ds_read_b64_tr_b16 v[134:135], v201 offset:8704
    ds_read_b64_tr_b16 v[156:157], v200 offset:16384
    ds_read_b64_tr_b16 v[158:159], v200 offset:16896
    ds_read_b64_tr_b16 v[136:137], v201 offset:16384
    ds_read_b64_tr_b16 v[138:139], v201 offset:16896
    s_mov_b32 s87, 0
    buffer_store_dwordx4 v[234:237], v233, s[80:83], s87 offen sc1
    s_mov_b32 s87, 67584
    buffer_store_dwordx4 v[238:241], v233, s[80:83], s87 offen sc1
    s_mov_b32 s87, 135168
    buffer_store_dwordx4 v[242:245], v233, s[80:83], s87 offen sc1
    s_mov_b32 s87, 202752
    buffer_store_dwordx4 v[246:249], v233, s[80:83], s87 offen sc1
.p2align 6
    s_nop 0
    s_nop 0
    s_nop 0
    s_nop 0
    s_nop 0
    s_nop 0
    s_nop 0
    s_nop 0
    s_nop 0
    s_nop 0
    s_nop 0
    s_nop 0
    s_nop 0
    s_nop 0
    s_nop 0
    s_waitcnt lgkmcnt(0)
L_g1_loop:
    v_mfma_f32_16x16x32_bf16 v[4:7], v[124:127], v[108:111], v[4:7]
    ds_read_b128 v[164:167], v197 offset:0
    v_mfma_f32_16x16x32_bf16 v[12:15], v[124:127], v[112:115], v[12:15]
    ds_read_b64_tr_b16 v[180:181], v200 offset:4096
    v_mfma_f32_16x16x32_bf16 v[20:23], v[124:127], v[116:119], v[20:23]
    ds_read_b64_tr_b16 v[182:183], v200 offset:4608
    v_mfma_f32_16x16x32_bf16 v[28:31], v[124:127], v[120:123], v[28:31]
    ds_read_b128 v[168:171], v197 offset:2048
    v_mfma_f32_16x16x32_bf16 v[32:35], v[128:131], v[120:123], v[32:35]
    ds_read_b64_tr_b16 v[184:185], v201 offset:4096
    v_mfma_f32_16x16x32_bf16 v[24:27], v[128:131], v[116:119], v[24:27]
    ds_read_b64_tr_b16 v[186:187], v201 offset:4608
    v_mfma_f32_16x16x32_bf16 v[16:19], v[128:131], v[112:115], v[16:19]
    ds_read_b128 v[172:175], v197 offset:4096
    v_mfma_f32_16x16x32_bf16 v[8:11], v[128:131], v[108:111], v[8:11]
    ds_read_b64_tr_b16 v[152:153], v200 offset:12288
    v_mfma_f32_16x16x32_bf16 v[40:43], v[132:135], v[108:111], v[40:43]
    ds_read_b64_tr_b16 v[154:155], v200 offset:12800
    v_mfma_f32_16x16x32_bf16 v[48:51], v[132:135], v[112:115], v[48:51]
    ds_read_b128 v[176:179], v197 offset:6144
    v_mfma_f32_16x16x32_bf16 v[56:59], v[132:135], v[116:119], v[56:59]
    ds_read_b64_tr_b16 v[188:189], v201 offset:12288
    v_mfma_f32_16x16x32_bf16 v[64:67], v[132:135], v[120:123], v[64:67]
    ds_read_b64_tr_b16 v[190:191], v201 offset:12800
    v_mfma_f32_16x16x32_bf16 v[60:63], v[148:151], v[120:123], v[60:63]
    ds_read2_b32 v[140:141], v198 offset1:2
    v_mfma_f32_16x16x32_bf16 v[52:55], v[148:151], v[116:119], v[52:55]
    ds_read2_b32 v[142:143], v199 offset1:2
    v_mfma_f32_16x16x32_bf16 v[44:47], v[148:151], v[112:115], v[44:47]
    ds_read_b64_tr_b16 v[160:161], v200 offset:20480
    v_mfma_f32_16x16x32_bf16 v[36:39], v[148:151], v[108:111], v[36:39]
    ds_read_b64_tr_b16 v[162:163], v200 offset:20992
    v_mfma_f32_16x16x32_bf16 v[68:71], v[108:111], v[156:159], v[68:71]
    ds_read_b64_tr_b16 v[192:193], v201 offset:20480
    ds_read_b64_tr_b16 v[194:195], v201 offset:20992
    v_mfma_f32_16x16x32_bf16 v[76:79], v[112:115], v[156:159], v[76:79]
    ds_read_b32 v1, v228 offset:24
    s_add_u32 s34, s34, 41984
    v_mfma_f32_16x16x32_bf16 v[84:87], v[116:119], v[156:159], v[84:87]
    s_cmp_eq_u32 s34, 125952
    s_cselect_b32 s35, -83968, s37
    v_mfma_f32_16x16x32_bf16 v[92:95], v[120:123], v[156:159], v[92:95]
    s_cselect_b32 s34, 0, s34
    s_bitcmp1_b32 0x1002, s36
    v_mfma_f32_16x16x32_bf16 v[96:99], v[120:123], v[136:139], v[96:99]
    v_add_u32 v196, s35, v196
    v_add_u32 v197, s35, v197
    v_mfma_f32_16x16x32_bf16 v[88:91], v[116:119], v[136:139], v[88:91]
    v_add_u32 v198, s35, v198
    v_add_u32 v199, s35, v199
    v_mfma_f32_16x16x32_bf16 v[80:83], v[112:115], v[136:139], v[80:83]
    v_add_u32 v200, s35, v200
    v_add_u32 v201, s35, v201
    v_mfma_f32_16x16x32_bf16 v[72:75], v[108:111], v[136:139], v[72:75]
    s_waitcnt lgkmcnt(0)
    v_smfmac_f32_16x16x64_bf16 v[100:103], v[140:143], v[148:155], v202
    v_smfmac_f32_16x16x64_bf16 v[104:107], v[140:143], v[156:163], v202
    s_cbranch_scc1 L_g1_rare
L_g1_bar:
    s_barrier
L_g1_nobar:
    v_mfma_f32_16x16x32_bf16 v[4:7], v[180:183], v[164:167], v[4:7]
    ds_read_b128 v[108:111], v196 offset:0
    v_mfma_f32_16x16x32_bf16 v[12:15], v[180:183], v[168:171], v[12:15]
    ds_read_b64_tr_b16 v[124:125], v200 offset:0
    v_mfma_f32_16x16x32_bf16 v[20:23], v[180:183], v[172:175], v[20:23]
    ds_read_b64_tr_b16 v[126:127], v200 offset:512
    v_mfma_f32_16x16x32_bf16 v[28:31], v[180:183], v[176:179], v[28:31]
    ds_read_b128 v[112:115], v196 offset:2048
    v_mfma_f32_16x16x32_bf16 v[32:35], v[184:187], v[176:179], v[32:35]
    ds_read_b64_tr_b16 v[128:129], v201 offset:0
    v_mfma_f32_16x16x32_bf16 v[24:27], v[184:187], v[172:175], v[24:27]
    ds_read_b64_tr_b16 v[130:131], v201 offset:512
    v_mfma_f32_16x16x32_bf16 v[16:19], v[184:187], v[168:171], v[16:19]
    ds_read_b128 v[116:119], v196 offset:4096
    v_mfma_f32_16x16x32_bf16 v[8:11], v[184:187], v[164:167], v[8:11]
    ds_read_b64_tr_b16 v[148:149], v200 offset:8192
    v_mfma_f32_16x16x32_bf16 v[40:43], v[188:191], v[164:167], v[40:43]
    ds_read_b64_tr_b16 v[150:151], v200 offset:8704
    v_mfma_f32_16x16x32_bf16 v[48:51], v[188:191], v[168:171], v[48:51]
    ds_read_b128 v[120:123], v196 offset:6144
    v_mfma_f32_16x16x32_bf16 v[56:59], v[188:191], v[172:175], v[56:59]
    ds_read_b64_tr_b16 v[132:133], v201 offset:8192
    v_mfma_f32_16x16x32_bf16 v[64:67], v[188:191], v[176:179], v[64:67]
    ds_read_b64_tr_b16 v[134:135], v201 offset:8704
    v_mfma_f32_16x16x32_bf16 v[60:63], v[152:155], v[176:179], v[60:63]
    ds_read_b64_tr_b16 v[156:157], v200 offset:16384
    v_mfma_f32_16x16x32_bf16 v[52:55], v[152:155], v[172:175], v[52:55]
    ds_read_b64_tr_b16 v[158:159], v200 offset:16896
    v_mfma_f32_16x16x32_bf16 v[44:47], v[152:155], v[168:171], v[44:47]
    ds_read_b64_tr_b16 v[136:137], v201 offset:16384
    v_mfma_f32_16x16x32_bf16 v[36:39], v[152:155], v[164:167], v[36:39]
    ds_read_b64_tr_b16 v[138:139], v201 offset:16896
    v_mfma_f32_16x16x32_bf16 v[68:71], v[164:167], v[160:163], v[68:71]
    s_sub_u32 s36, s36, 1
    v_mfma_f32_16x16x32_bf16 v[76:79], v[168:171], v[160:163], v[76:79]
    s_cmp_lg_u32 s36, 0
    v_mfma_f32_16x16x32_bf16 v[84:87], v[172:175], v[160:163], v[84:87]
    v_mfma_f32_16x16x32_bf16 v[92:95], v[176:179], v[160:163], v[92:95]
    v_mfma_f32_16x16x32_bf16 v[96:99], v[176:179], v[192:195], v[96:99]
    v_mfma_f32_16x16x32_bf16 v[88:91], v[172:175], v[192:195], v[88:91]
    v_mfma_f32_16x16x32_bf16 v[80:83], v[168:171], v[192:195], v[80:83]
    s_waitcnt lgkmcnt(0)
    v_mfma_f32_16x16x32_bf16 v[72:75], v[164:167], v[192:195], v[72:75]
    s_cbranch_scc1 L_g1_loop
    v_mfma_f32_16x16x32_bf16 v[4:7], v[124:127], v[108:111], v[4:7]
    ds_read_b128 v[164:167], v197 offset:0
    v_mfma_f32_16x16x32_bf16 v[12:15], v[124:127], v[112:115], v[12:15]
    ds_read_b64_tr_b16 v[180:181], v200 offset:4096
    v_mfma_f32_16x16x32_bf16 v[20:23], v[124:127], v[116:119], v[20:23]
    ds_read_b64_tr_b16 v[182:183], v200 offset:4608
    v_mfma_f32_16x16x32_bf16 v[28:31], v[124:127], v[120:123], v[28:31]
    ds_read_b128 v[168:171], v197 offset:2048
    v_mfma_f32_16x16x32_bf16 v[32:35], v[128:131], v[120:123], v[32:35]
    ds_read_b64_tr_b16 v[184:185], v201 offset:4096
    v_mfma_f32_16x16x32_bf16 v[24:27], v[128:131], v[116:119], v[24:27]
    ds_read_b64_tr_b16 v[186:187], v201 offset:4608
    v_mfma_f32_16x16x32_bf16 v[16:19], v[128:131], v[112:115], v[16:19]
    ds_read_b128 v[172:175], v197 offset:4096
    v_mfma_f32_16x16x32_bf16 v[8:11], v[128:131], v[108:111], v[8:11]
    ds_read_b64_tr_b16 v[152:153], v200 offset:12288
    v_mfma_f32_16x16x32_bf16 v[40:43], v[132:135], v[108:111], v[40:43]
    ds_read_b64_tr_b16 v[154:155], v200 offset:12800
    v_mfma_f32_16x16x32_bf16 v[48:51], v[132:135], v[112:115], v[48:51]
    ds_read_b128 v[176:179], v197 offset:6144
    v_mfma_f32_16x16x32_bf16 v[56:59], v[132:135], v[116:119], v[56:59]
    ds_read_b64_tr_b16 v[188:189], v201 offset:12288
    v_mfma_f32_16x16x32_bf16 v[64:67], v[132:135], v[120:123], v[64:67]
    ds_read_b64_tr_b16 v[190:191], v201 offset:12800
    v_mfma_f32_16x16x32_bf16 v[60:63], v[148:151], v[120:123], v[60:63]
    ds_read2_b32 v[140:141], v198 offset1:2
    v_mfma_f32_16x16x32_bf16 v[52:55], v[148:151], v[116:119], v[52:55]
    ds_read2_b32 v[142:143], v199 offset1:2
    v_mfma_f32_16x16x32_bf16 v[44:47], v[148:151], v[112:115], v[44:47]
    ds_read_b64_tr_b16 v[160:161], v200 offset:20480
    v_mfma_f32_16x16x32_bf16 v[36:39], v[148:151], v[108:111], v[36:39]
    ds_read_b64_tr_b16 v[162:163], v200 offset:20992
    v_mfma_f32_16x16x32_bf16 v[68:71], v[108:111], v[156:159], v[68:71]
    ds_read_b64_tr_b16 v[192:193], v201 offset:20480
    v_mfma_f32_16x16x32_bf16 v[76:79], v[112:115], v[156:159], v[76:79]
    ds_read_b64_tr_b16 v[194:195], v201 offset:20992
    v_mfma_f32_16x16x32_bf16 v[84:87], v[116:119], v[156:159], v[84:87]
    v_mfma_f32_16x16x32_bf16 v[92:95], v[120:123], v[156:159], v[92:95]
    v_mfma_f32_16x16x32_bf16 v[96:99], v[120:123], v[136:139], v[96:99]
    v_mfma_f32_16x16x32_bf16 v[88:91], v[116:119], v[136:139], v[88:91]
    v_mfma_f32_16x16x32_bf16 v[80:83], v[112:115], v[136:139], v[80:83]
    v_mfma_f32_16x16x32_bf16 v[72:75], v[108:111], v[136:139], v[72:75]
    s_waitcnt lgkmcnt(0)
    s_setprio 2
    v_mov_b32 v2, 1
    v_smfmac_f32_16x16x64_bf16 v[100:103], v[140:143], v[148:155], v202
    v_smfmac_f32_16x16x64_bf16 v[104:107], v[140:143], v[156:163], v202
    v_mfma_f32_16x16x32_bf16 v[60:63], v[152:155], v[176:179], v[60:63]
    v_mfma_f32_16x16x32_bf16 v[64:67], v[188:191], v[176:179], v[64:67]
    v_mfma_f32_16x16x32_bf16 v[92:95], v[176:179], v[160:163], v[92:95]
    v_mfma_f32_16x16x32_bf16 v[96:99], v[176:179], v[192:195], v[96:99]
    v_mfma_f32_16x16x32_bf16 v[28:31], v[180:183], v[176:179], v[28:31]
    v_mfma_f32_16x16x32_bf16 v[32:35], v[184:187], v[176:179], v[32:35]
    v_mfma_f32_16x16x32_bf16 v[52:55], v[152:155], v[172:175], v[52:55]
    v_mfma_f32_16x16x32_bf16 v[56:59], v[188:191], v[172:175], v[56:59]
    s_nop 3
    v_permlane32_swap_b32 v100, v104
    v_permlane32_swap_b32 v101, v105
    v_mfma_f32_16x16x32_bf16 v[20:23], v[180:183], v[172:175], v[20:23]
    v_permlane32_swap_b32 v102, v106
    v_permlane32_swap_b32 v103, v107
    v_mfma_f32_16x16x32_bf16 v[24:27], v[184:187], v[172:175], v[24:27]
    v_add_f32 v100, v100, v104
    v_add_f32 v101, v101, v105
    v_mfma_f32_16x16x32_bf16 v[44:47], v[152:155], v[168:171], v[44:47]
    v_add_f32 v102, v102, v106
    v_add_f32 v103, v103, v107
    v_mfma_f32_16x16x32_bf16 v[48:51], v[188:191], v[168:171], v[48:51]
    v_cvt_pk_bf16_f32 v144, v100, v101
    v_cvt_pk_bf16_f32 v145, v102, v103
    v_mfma_f32_16x16x32_bf16 v[12:15], v[180:183], v[168:171], v[12:15]
    ds_write_b64 v219, v[144:145] offset:1024
    ds_write_b16 v203, v144 offset:0
    v_mfma_f32_16x16x32_bf16 v[16:19], v[184:187], v[168:171], v[16:19]
    ds_write_b16_d16_hi v203, v144 offset:8
    ds_write_b16 v203, v145 offset:16
    v_mfma_f32_16x16x32_bf16 v[36:39], v[152:155], v[164:167], v[36:39]
    ds_write_b16_d16_hi v203, v145 offset:24
    v_cvt_pk_bf16_f32 v140, v60, v61
    v_mfma_f32_16x16x32_bf16 v[40:43], v[188:191], v[164:167], v[40:43]
    v_cvt_pk_bf16_f32 v141, v62, v63
    v_cvt_pk_bf16_f32 v142, v64, v65
    v_mfma_f32_16x16x32_bf16 v[4:7], v[180:183], v[164:167], v[4:7]
    v_cvt_pk_bf16_f32 v143, v66, v67
    v_cvt_pk_bf16_f32 v238, v92, v93
    v_mfma_f32_16x16x32_bf16 v[8:11], v[184:187], v[164:167], v[8:11]
    v_cvt_pk_bf16_f32 v239, v94, v95
    v_cvt_pk_bf16_f32 v248, v96, v97
    v_mfma_f32_16x16x32_bf16 v[84:87], v[172:175], v[160:163], v[84:87]
    v_cvt_pk_bf16_f32 v249, v98, v99
    s_cmp_eq_u32 s33, 0
    s_cbranch_scc0 L_at_nopub
    ds_write_b64 v220, v[140:141] offset:2048
    ds_write_b64 v220, v[238:239] offset:3072
    ds_write_b64 v220, v[142:143] offset:2560
    ds_write_b64 v220, v[248:249] offset:3584
L_at_nopub:
    s_mov_b64 exec, 1
    ds_add_u32 v228, v2 offset:20
    s_mov_b64 exec, -1
    v_mfma_f32_16x16x32_bf16 v[88:91], v[172:175], v[192:195], v[88:91]
    v_cvt_pk_bf16_f32 v120, v28, v29
    v_cvt_pk_bf16_f32 v121, v30, v31
    v_mfma_f32_16x16x32_bf16 v[76:79], v[168:171], v[160:163], v[76:79]
    v_cvt_pk_bf16_f32 v122, v32, v33
    v_cvt_pk_bf16_f32 v123, v34, v35
    v_mfma_f32_16x16x32_bf16 v[80:83], v[168:171], v[192:195], v[80:83]
    v_cvt_pk_bf16_f32 v136, v52, v53
    v_cvt_pk_bf16_f32 v137, v54, v55
    v_mfma_f32_16x16x32_bf16 v[68:71], v[164:167], v[160:163], v[68:71]
    v_cvt_pk_bf16_f32 v138, v56, v57
    v_cvt_pk_bf16_f32 v139, v58, v59
    v_mfma_f32_16x16x32_bf16 v[72:75], v[164:167], v[192:195], v[72:75]
    v_cvt_pk_bf16_f32 v116, v20, v21
    v_cvt_pk_bf16_f32 v117, v22, v23
    v_mfma_f32_16x16x32_bf16 v[28:31], v[140:143], v[120:123], v[204:207]
    v_cvt_pk_bf16_f32 v118, v24, v25
    v_cvt_pk_bf16_f32 v119, v26, v27
    v_mfma_f32_16x16x32_bf16 v[32:35], v[136:139], v[120:123], v[208:211]
    v_cvt_pk_bf16_f32 v132, v44, v45
    v_cvt_pk_bf16_f32 v133, v46, v47
    v_mfma_f32_16x16x32_bf16 v[20:23], v[136:139], v[116:119], v[204:207]
    v_cvt_pk_bf16_f32 v134, v48, v49
    v_cvt_pk_bf16_f32 v135, v50, v51
    s_nop 1
    v_mfma_f32_16x16x32_bf16 v[24:27], v[132:135], v[116:119], v[208:211]
    v_cvt_pk_bf16_f32 v112, v12, v13
    v_cvt_pk_bf16_f32 v113, v14, v15
    v_cvt_pk_bf16_f32 v114, v16, v17
    v_cvt_pk_bf16_f32 v115, v18, v19
    s_nop 1
    v_mfma_f32_16x16x32_bf16 v[12:15], v[132:135], v[112:115], v[204:207]
    v_cvt_pk_bf16_f32 v128, v36, v37
    v_cvt_pk_bf16_f32 v129, v38, v39
    v_cvt_pk_bf16_f32 v130, v40, v41
    v_cvt_pk_bf16_f32 v131, v42, v43
    s_nop 1
    v_mfma_f32_16x16x32_bf16 v[16:19], v[128:131], v[112:115], v[208:211]
    v_cvt_pk_bf16_f32 v108, v4, v5
    v_cvt_pk_bf16_f32 v109, v6, v7
    v_cvt_pk_bf16_f32 v110, v8, v9
    v_cvt_pk_bf16_f32 v111, v10, v11
    s_nop 1
    v_mfma_f32_16x16x32_bf16 v[4:7], v[128:131], v[108:111], v[204:207]
    v_cvt_pk_bf16_f32 v236, v84, v85
    v_cvt_pk_bf16_f32 v237, v86, v87
    v_cvt_pk_bf16_f32 v246, v88, v89
    v_cvt_pk_bf16_f32 v247, v90, v91
    v_cvt_pk_bf16_f32 v234, v76, v77
    v_cvt_pk_bf16_f32 v235, v78, v79
    ds_read_b32 v1, v228 offset:20
    v_cvt_pk_bf16_f32 v244, v80, v81
    v_cvt_pk_bf16_f32 v245, v82, v83
    v_cvt_pk_bf16_f32 v232, v68, v69
    v_cvt_pk_bf16_f32 v233, v70, v71
    v_cvt_pk_bf16_f32 v242, v72, v73
    v_cvt_pk_bf16_f32 v243, v74, v75
    s_waitcnt lgkmcnt(0)
    v_readfirstlane_b32 s37, v1
    s_nop 0
    s_cmp_ge_u32 s37, 4
    s_cbranch_scc1 L_sl_done_42
    s_mov_b32 s38, 1048576
L_sl_loop_43:
    ds_read_b32 v1, v228 offset:20
    s_waitcnt lgkmcnt(0)
    v_readfirstlane_b32 s37, v1
    s_nop 0
    s_cmp_ge_u32 s37, 4
    s_cbranch_scc1 L_sl_done_42
    s_sleep 1
    s_sub_u32 s38, s38, 1
    s_cbranch_scc0 L_sl_loop_43
L_sl_done_42:
    ds_read_b64 v[124:125], v221
    ds_read_b64 v[126:127], v222
    ds_read_b64 v[230:231], v221 offset:1024
    ds_read_b64 v[240:241], v222 offset:1024
    v_max_f32 v28, v28, v32
    v_max_f32 v29, v29, v33
    v_max_f32 v30, v30, v34
    v_max_f32 v31, v31, v35
    v_max3_f32 v39, v28, v29, v30
    v_max_f32 v39, v39, v31
    v_max_f32 v20, v20, v24
    v_max_f32 v21, v21, v25
    v_max_f32 v22, v22, v26
    v_max_f32 v23, v23, v27
    v_max3_f32 v38, v20, v21, v22
    v_max_f32 v38, v38, v23
    s_waitcnt lgkmcnt(2)
    v_mfma_f32_16x16x32_bf16 v[8:11], v[124:127], v[108:111], v[212:215]
    s_setprio 2
    s_mov_b32 s37, 0x3e8293ee
    v_max_f32 v12, v12, v16
    v_max_f32 v13, v13, v17
    v_max_f32 v14, v14, v18
    v_max_f32 v15, v15, v19
    v_max3_f32 v37, v12, v13, v14
    v_max_f32 v37, v37, v15
    v_max_f32 v4, v4, v8
    v_max_f32 v5, v5, v9
    v_max_f32 v6, v6, v10
    v_max_f32 v7, v7, v11
    v_max3_f32 v36, v4, v5, v6
    v_max_f32 v36, v36, v7
    v_permlane32_swap_b32 v38, v39
    s_nop 0
    v_permlane32_swap_b32 v36, v37
    v_max_f32 v38, v38, v39
    v_max_f32 v36, v36, v37
    s_nop 1
    v_permlane16_swap_b32 v36, v38
    v_max_f32 v36, v36, v38
    v_mul_f32 v38, s37, v36
    v_mul_f32 v36, s37, v36
    s_nop 1
    v_permlane16_swap_b32 v36, v38
    v_mov_b32 v37, v36
    s_add_u32 m0, s60, 0
    v_mov_b32 v39, v38
    v_permlane32_swap_b32 v36, v37
    s_xor_b32 s63, s62, 0
    v_permlane32_swap_b32 v38, v39
    v_fma_f32 v4, v4, s37, -v36
    buffer_load_dwordx4 v227, s[44:47], s63 offen offset:0 lds
    v_fma_f32 v5, v5, s37, -v36
    v_fma_f32 v6, v6, s37, -v36
    buffer_load_dwordx4 v223, s[44:47], s63 offen offset:1024 lds
    v_fma_f32 v7, v7, s37, -v36
    v_fma_f32 v12, v12, s37, -v37
    s_add_u32 m0, s60, 8192
    v_fma_f32 v13, v13, s37, -v37
    v_fma_f32 v14, v14, s37, -v37
    s_xor_b32 s63, s62, 131072
    v_fma_f32 v15, v15, s37, -v37
    v_fma_f32 v20, v20, s37, -v38
    buffer_load_dwordx4 v227, s[44:47], s63 offen offset:0 lds
    v_fma_f32 v21, v21, s37, -v38
    v_fma_f32 v22, v22, s37, -v38
    buffer_load_dwordx4 v223, s[44:47], s63 offen offset:1024 lds
    v_fma_f32 v23, v23, s37, -v38
    v_fma_f32 v28, v28, s37, -v39
    s_add_u32 m0, s60, 16384
    v_fma_f32 v29, v29, s37, -v39
    v_fma_f32 v30, v30, s37, -v39
    s_xor_b32 s63, s62, 262144
    v_fma_f32 v31, v31, s37, -v39
    v_exp_f32 v28, v28
    buffer_load_dwordx4 v227, s[44:47], s63 offen offset:0 lds
    v_exp_f32 v29, v29
    v_exp_f32 v30, v30
    buffer_load_dwordx4 v223, s[44:47], s63 offen offset:1024 lds
    v_exp_f32 v31, v31
    v_exp_f32 v20, v20
    s_add_u32 m0, s60, 24576
    v_exp_f32 v21, v21
    v_exp_f32 v22, v22
    s_xor_b32 s63, s62, 393216
    v_exp_f32 v23, v23
    v_exp_f32 v12, v12
    buffer_load_dwordx4 v227, s[44:47], s63 offen offset:0 lds
    v_exp_f32 v13, v13
    v_exp_f32 v14, v14
    buffer_load_dwordx4 v223, s[44:47], s63 offen offset:1024 lds
    v_exp_f32 v15, v15
    v_exp_f32 v4, v4
    s_add_u32 m0, s60, 32768
    v_exp_f32 v5, v5
    v_exp_f32 v6, v6
    s_xor_b32 s63, s62, 524288
    v_exp_f32 v7, v7
    v_add_f32 v39, v28, v29
    buffer_load_dwordx4 v227, s[44:47], s63 offen offset:0 lds
    v_add_f32 v32, v30, v31
    v_add_f32 v39, v39, v32
    buffer_load_dwordx4 v223, s[44:47], s63 offen offset:1024 lds
    v_add_f32 v38, v20, v21
    v_add_f32 v24, v22, v23
    s_add_u32 m0, s60, 83968
    v_add_f32 v38, v38, v24
    v_add_f32 v37, v12, v13
    s_xor_b32 s63, s62, 655360
    v_add_f32 v16, v14, v15
    v_add_f32 v37, v37, v16
    buffer_load_dwordx4 v227, s[44:47], s63 offen offset:0 lds
    v_add_f32 v36, v4, v5
    v_add_f32 v8, v6, v7
    buffer_load_dwordx4 v223, s[44:47], s63 offen offset:1024 lds
    v_add_f32 v36, v36, v8
    v_permlane32_swap_b32 v38, v39
    s_add_u32 m0, s60, 92160
    v_permlane32_swap_b32 v36, v37
    v_add_f32 v38, v38, v39
    s_xor_b32 s63, s62, 786432
    v_add_f32 v36, v36, v37
    s_nop 1
    v_permlane16_swap_b32 v36, v38
    buffer_load_dwordx4 v227, s[44:47], s63 offen offset:0 lds
    v_add_f32 v36, v36, v38
    v_rcp_f32 v38, v36
    buffer_load_dwordx4 v223, s[44:47], s63 offen offset:1024 lds
    v_rcp_f32 v36, v36
    s_nop 1
    v_permlane16_swap_b32 v36, v38
    s_add_u32 m0, s60, 100352
    v_mov_b32 v37, v36
    v_mov_b32 v39, v38
    s_xor_b32 s63, s62, 917504
    v_permlane32_swap_b32 v36, v37
    v_permlane32_swap_b32 v38, v39
    buffer_load_dwordx4 v227, s[44:47], s63 offen offset:0 lds
    s_waitcnt lgkmcnt(0)
    buffer_load_dwordx4 v223, s[44:47], s63 offen offset:1024 lds
    s_add_u32 m0, s60, 108544
    s_xor_b32 s63, s62, 1048576
    buffer_load_dwordx4 v227, s[44:47], s63 offen offset:0 lds
    buffer_load_dwordx4 v223, s[44:47], s63 offen offset:1024 lds
    s_add_u32 m0, s60, 116736
    s_xor_b32 s63, s62, 1179648
    buffer_load_dwordx4 v227, s[44:47], s63 offen offset:0 lds
    buffer_load_dwordx4 v223, s[44:47], s63 offen offset:1024 lds
    s_cmp_eq_u32 s33, 0
    v_mul_f32 v4, v4, v36
    v_mul_f32 v5, v5, v36
    v_mul_f32 v6, v6, v36
    v_mul_f32 v7, v7, v36
    v_cvt_pk_bf16_f32 v10, v4, v5
    v_cvt_pk_bf16_f32 v11, v6, v7
    v_and_b32 v8, v216, v10
    v_and_b32 v9, v217, v11
    v_xor_b32 v10, v8, v10
    v_xor_b32 v11, v9, v11
    s_setprio 2
    s_nop 0
    v_mfma_f32_16x16x32_bf16 v[68:71], v[230:233], v[8:11], 0
    v_mfma_f32_16x16x32_bf16 v[72:75], v[240:243], v[8:11], 0
    s_setprio 2
    v_mul_f32 v12, v12, v37
    v_mul_f32 v13, v13, v37
    v_mul_f32 v14, v14, v37
    v_mul_f32 v15, v15, v37
    v_cvt_pk_bf16_f32 v18, v12, v13
    v_cvt_pk_bf16_f32 v19, v14, v15
    v_and_b32 v16, v216, v18
    v_and_b32 v17, v217, v19
    v_xor_b32 v18, v16, v18
    v_xor_b32 v19, v17, v19
    v_cvt_pk_bf16_f32 v108, v68, v69
    v_cvt_pk_bf16_f32 v109, v70, v71
    v_cvt_pk_bf16_f32 v110, v72, v73
    v_cvt_pk_bf16_f32 v111, v74, v75
    s_cbranch_scc1 L_at_noswap0
    v_swap_b32 v108, v110
    v_swap_b32 v109, v111
L_at_noswap0:
    s_mov_b32 s37, 0
    buffer_store_dwordx4 v[108:111], v218, s[40:43], s37 offen sc1
    s_setprio 2
    v_mfma_f32_16x16x32_bf16 v[76:79], v[232:235], v[16:19], 0
    v_mfma_f32_16x16x32_bf16 v[80:83], v[242:245], v[16:19], 0
    s_setprio 2
    v_mul_f32 v20, v20, v38
    v_mul_f32 v21, v21, v38
    v_mul_f32 v22, v22, v38
    v_mul_f32 v23, v23, v38
    v_cvt_pk_bf16_f32 v26, v20, v21
    v_cvt_pk_bf16_f32 v27, v22, v23
    v_and_b32 v24, v216, v26
    v_and_b32 v25, v217, v27
    v_xor_b32 v26, v24, v26
    v_xor_b32 v27, v25, v27
    v_cvt_pk_bf16_f32 v112, v76, v77
    v_cvt_pk_bf16_f32 v113, v78, v79
    v_cvt_pk_bf16_f32 v114, v80, v81
    v_cvt_pk_bf16_f32 v115, v82, v83
    s_cbranch_scc1 L_at_noswap1
    v_swap_b32 v112, v114
    v_swap_b32 v113, v115
L_at_noswap1:
    s_mov_b32 s37, 32768
    buffer_store_dwordx4 v[112:115], v218, s[40:43], s37 offen sc1
    s_setprio 2
    v_mfma_f32_16x16x32_bf16 v[84:87], v[234:237], v[24:27], 0
    v_mfma_f32_16x16x32_bf16 v[88:91], v[244:247], v[24:27], 0
    s_setprio 2
    v_mul_f32 v28, v28, v39
    v_mul_f32 v29, v29, v39
    v_mul_f32 v30, v30, v39
    v_mul_f32 v31, v31, v39
    v_cvt_pk_bf16_f32 v34, v28, v29
    v_cvt_pk_bf16_f32 v35, v30, v31
    v_and_b32 v32, v216, v34
    v_and_b32 v33, v217, v35
    v_xor_b32 v34, v32, v34
    v_xor_b32 v35, v33, v35
    v_cvt_pk_bf16_f32 v116, v84, v85
    v_cvt_pk_bf16_f32 v117, v86, v87
    v_cvt_pk_bf16_f32 v118, v88, v89
    v_cvt_pk_bf16_f32 v119, v90, v91
    s_cbranch_scc1 L_at_noswap2
    v_swap_b32 v116, v118
    v_swap_b32 v117, v119
L_at_noswap2:
    s_mov_b32 s37, 65536
    buffer_store_dwordx4 v[116:119], v218, s[40:43], s37 offen sc1
    s_setprio 2
    v_mfma_f32_16x16x32_bf16 v[92:95], v[236:239], v[32:35], 0
    v_mfma_f32_16x16x32_bf16 v[96:99], v[246:249], v[32:35], 0
    s_setprio 2
    s_nop 5
    v_cvt_pk_bf16_f32 v120, v92, v93
    v_cvt_pk_bf16_f32 v121, v94, v95
    v_cvt_pk_bf16_f32 v122, v96, v97
    v_cvt_pk_bf16_f32 v123, v98, v99
    s_cbranch_scc1 L_at_noswap3
    v_swap_b32 v120, v122
    v_swap_b32 v121, v123
L_at_noswap3:
    s_mov_b32 s37, 98304
    buffer_store_dwordx4 v[120:123], v218, s[40:43], s37 offen sc1
    s_setprio 0
    v_xor_b32 v84, 0, v229
    v_xor_b32 v85, 32, v229
    v_xor_b32 v86, 64, v229
    v_xor_b32 v87, 96, v229
    v_add_u32 v88, 83968, v84
    v_add_u32 v89, 83968, v85
    v_add_u32 v90, 83968, v86
    v_add_u32 v91, 83968, v87
    v_add_u32 v92, 125952, v84
    v_add_u32 v93, 125952, v85
    v_add_u32 v94, 125952, v86
    v_add_u32 v95, 125952, v87
    v_lshl_add_u32 v231, v0, 4, s60
    v_add_u32 v230, 125952, v231
    s_add_u32 s64, s61, 0
    s_and_b32 s64, s64, 7
    s_lshl_b32 s64, s64, 12
    s_add_u32 s65, s61, 1
    s_and_b32 s65, s65, 7
    s_lshl_b32 s65, s65, 12
    s_add_u32 s66, s61, 2
    s_and_b32 s66, s66, 7
    s_lshl_b32 s66, s66, 12
    s_add_u32 s67, s61, 3
    s_and_b32 s67, s67, 7
    s_lshl_b32 s67, s67, 12
    s_add_u32 s68, s61, 4
    s_and_b32 s68, s68, 7
    s_lshl_b32 s68, s68, 12
    s_add_u32 s69, s61, 5
    s_and_b32 s69, s69, 7
    s_lshl_b32 s69, s69, 12
    s_add_u32 s70, s61, 6
    s_and_b32 s70, s70, 7
    s_lshl_b32 s70, s70, 12
    s_add_u32 s71, s61, 7
    s_and_b32 s71, s71, 7
    s_lshl_b32 s71, s71, 12
    s_waitcnt vmcnt(0)
    s_setprio 2
    v_mov_b32 v2, 1
    s_mov_b64 exec, 1
    ds_add_rtn_u32 v1, v228, v2 offset:0
    s_waitcnt lgkmcnt(0)
    v_readfirstlane_b32 s39, v1
    s_nop 0
    s_cmp_eq_u32 s39, 3
    s_cbranch_scc0 L_jo_44a
    s_mov_b64 exec, 0xffff
    v_lshlrev_b32 v1, 8, v0
    buffer_atomic_add v2, v1, s[52:55], s56 offen sc1
L_jo_44a:
    s_mov_b64 exec, -1
    s_setprio 0
    s_xor_b32 s63, s62, 1310720
    buffer_load_dwordx4 v[172:175], v227, s[44:47], s63 offen offset:0
    buffer_load_dwordx4 v[176:179], v223, s[44:47], s63 offen offset:1024
    s_xor_b32 s63, s62, 1441792
    buffer_load_dwordx4 v[180:183], v227, s[44:47], s63 offen offset:0
    buffer_load_dwordx4 v[184:187], v223, s[44:47], s63 offen offset:1024
    s_cmp_eq_u32 s39, 3
    s_cbranch_scc0 L_ps_46
    s_load_dword s37, s[52:53], s57 glc
L_ps_46:
    s_xor_b32 s63, s62, 1572864
    buffer_load_dwordx4 v[188:191], v227, s[44:47], s63 offen offset:0
    buffer_load_dwordx4 v[192:195], v223, s[44:47], s63 offen offset:1024
    s_xor_b32 s63, s62, 1703936
    buffer_load_dwordx4 v[196:199], v227, s[44:47], s63 offen offset:0
    buffer_load_dwordx4 v[200:203], v223, s[44:47], s63 offen offset:1024
    s_xor_b32 s63, s62, 1835008
    buffer_load_dwordx4 v[204:207], v227, s[44:47], s63 offen offset:0
    buffer_load_dwordx4 v[208:211], v223, s[44:47], s63 offen offset:1024
    s_xor_b32 s63, s62, 1966080
    buffer_load_dwordx4 v[212:215], v227, s[44:47], s63 offen offset:0
    buffer_load_dwordx4 v[216:219], v223, s[44:47], s63 offen offset:1024
    s_setprio 0
    s_cmp_eq_u32 s39, 3
    s_cbranch_scc0 L_jo_44
    s_mov_b32 s38, 131072
    s_branch L_sg_chk_49
L_sg_loop_48:
    s_load_dword s37, s[52:53], s57 glc
L_sg_chk_49:
    s_waitcnt lgkmcnt(0)
    s_cmp_ge_u32 s37, 16
    s_cbranch_scc1 L_sg_done_47
    s_sub_u32 s38, s38, 1
    s_cbranch_scc0 L_sg_loop_48
L_sg_done_47:
    v_mov_b32 v1, 16
    s_mov_b64 exec, 1
    ds_add_u32 v228, v1 offset:4
    s_mov_b64 exec, -1
L_jo_44:
    s_waitcnt vmcnt(12)
    s_mov_b64 exec, 1
    ds_add_u32 v228, v2 offset:4
    s_mov_b64 exec, -1
    s_mov_b32 s38, 1048576
L_sl_loop_51:
    ds_read_b32 v1, v228 offset:4
    s_waitcnt lgkmcnt(0)
    v_readfirstlane_b32 s37, v1
    s_nop 0
    s_cmp_ge_u32 s37, 20
    s_cbranch_scc1 L_sl_done_50
    s_sleep 1
    s_sub_u32 s38, s38, 1
    s_cbranch_scc0 L_sl_loop_51
L_sl_done_50:
L_jd_45:
    buffer_load_dwordx4 v[96:99], v224, s[40:43], s64 offen offset:0 sc1
    buffer_load_dwordx4 v[100:103], v225, s[40:43], s64 offen offset:0 sc1
    ds_read_b64_tr_b16 v[36:37], v84 offset:0
    ds_read_b64_tr_b16 v[38:39], v84 offset:2048
    buffer_load_dwordx4 v[104:107], v224, s[40:43], s64 offen offset:1024 sc1
    buffer_load_dwordx4 v[108:111], v225, s[40:43], s64 offen offset:1024 sc1
    ds_read_b64_tr_b16 v[40:41], v85 offset:0
    ds_read_b64_tr_b16 v[42:43], v85 offset:2048
    buffer_load_dwordx4 v[112:115], v224, s[40:43], s64 offen offset:2048 sc1
    buffer_load_dwordx4 v[116:119], v225, s[40:43], s64 offen offset:2048 sc1
    ds_read_b64_tr_b16 v[44:45], v86 offset:0
    ds_read_b64_tr_b16 v[46:47], v86 offset:2048
    buffer_load_dwordx4 v[120:123], v224, s[40:43], s64 offen offset:3072 sc1
    buffer_load_dwordx4 v[124:127], v225, s[40:43], s64 offen offset:3072 sc1
    ds_read_b64_tr_b16 v[48:49], v87 offset:0
    ds_read_b64_tr_b16 v[50:51], v87 offset:2048
    buffer_load_dwordx4 v[128:131], v224, s[40:43], s65 offen offset:0 sc1
    buffer_load_dwordx4 v[132:135], v225, s[40:43], s65 offen offset:0 sc1
    ds_read_b64_tr_b16 v[52:53], v84 offset:4096
    ds_read_b64_tr_b16 v[54:55], v84 offset:6144
    buffer_load_dwordx4 v[136:139], v224, s[40:43], s65 offen offset:1024 sc1
    buffer_load_dwordx4 v[140:143], v225, s[40:43], s65 offen offset:1024 sc1
    ds_read_b64_tr_b16 v[56:57], v85 offset:4096
    ds_read_b64_tr_b16 v[58:59], v85 offset:6144
    ds_read_b64_tr_b16 v[60:61], v86 offset:4096
    ds_read_b64_tr_b16 v[62:63], v86 offset:6144
    s_waitcnt lgkmcnt(12)
    ds_read_b64_tr_b16 v[64:65], v87 offset:4096
    ds_read_b64_tr_b16 v[66:67], v87 offset:6144
    ds_read_b32 v1, v228 offset:36
    s_waitcnt vmcnt(10) lgkmcnt(9)
    v_mfma_f32_16x16x32_bf16 v[4:7], v[36:39], v[96:99], 0
    ds_read_b64_tr_b16 v[68:69], v84 offset:8192
    v_mfma_f32_16x16x32_bf16 v[20:23], v[36:39], v[100:103], 0
    ds_read_b64_tr_b16 v[70:71], v84 offset:10240
    v_mfma_f32_16x16x32_bf16 v[8:11], v[40:43], v[96:99], 0
    ds_read_b64_tr_b16 v[36:37], v85 offset:8192
    v_mfma_f32_16x16x32_bf16 v[24:27], v[40:43], v[100:103], 0
    ds_read_b64_tr_b16 v[38:39], v85 offset:10240
    buffer_load_dwordx4 v[144:147], v224, s[40:43], s65 offen offset:2048 sc1
    v_mfma_f32_16x16x32_bf16 v[12:15], v[44:47], v[96:99], 0
    ds_read_b64_tr_b16 v[40:41], v86 offset:8192
    v_mfma_f32_16x16x32_bf16 v[28:31], v[44:47], v[100:103], 0
    ds_read_b64_tr_b16 v[42:43], v86 offset:10240
    v_mfma_f32_16x16x32_bf16 v[16:19], v[48:51], v[96:99], 0
    ds_read_b64_tr_b16 v[44:45], v87 offset:8192
    v_mfma_f32_16x16x32_bf16 v[32:35], v[48:51], v[100:103], 0
    ds_read_b64_tr_b16 v[46:47], v87 offset:10240
    buffer_load_dwordx4 v[148:151], v225, s[40:43], s65 offen offset:2048 sc1
    s_waitcnt lgkmcnt(8)
    v_readfirstlane_b32 s37, v1
    s_nop 0
    s_cmp_ge_u32 s37, 4
    s_cbranch_scc1 L_sl_done_52
    s_mov_b32 s38, 1048576
L_sl_loop_53:
    ds_read_b32 v1, v228 offset:36
    s_waitcnt lgkmcnt(0)
    v_readfirstlane_b32 s37, v1
    s_nop 0
    s_cmp_ge_u32 s37, 4
    s_cbranch_scc1 L_sl_done_52
    s_sleep 1
    s_sub_u32 s38, s38, 1
    s_cbranch_scc0 L_sl_loop_53
L_sl_done_52:
    ds_write_b128 v230, v[172:175] offset:0
    s_waitcnt vmcnt(10)
    v_mfma_f32_16x16x32_bf16 v[4:7], v[52:55], v[104:107], v[4:7]
    ds_read_b64_tr_b16 v[48:49], v84 offset:12288
    v_mfma_f32_16x16x32_bf16 v[20:23], v[52:55], v[108:111], v[20:23]
    ds_read_b64_tr_b16 v[50:51], v84 offset:14336
    v_mfma_f32_16x16x32_bf16 v[8:11], v[56:59], v[104:107], v[8:11]
    ds_read_b64_tr_b16 v[52:53], v85 offset:12288
    v_mfma_f32_16x16x32_bf16 v[24:27], v[56:59], v[108:111], v[24:27]
    ds_read_b64_tr_b16 v[54:55], v85 offset:14336
    buffer_load_dwordx4 v[96:99], v224, s[40:43], s65 offen offset:3072 sc1
    ds_write_b128 v230, v[176:179] offset:1024
    v_mfma_f32_16x16x32_bf16 v[12:15], v[60:63], v[104:107], v[12:15]
    ds_read_b64_tr_b16 v[56:57], v86 offset:12288
    v_mfma_f32_16x16x32_bf16 v[28:31], v[60:63], v[108:111], v[28:31]
    ds_read_b64_tr_b16 v[58:59], v86 offset:14336
    v_mfma_f32_16x16x32_bf16 v[16:19], v[64:67], v[104:107], v[16:19]
    ds_read_b64_tr_b16 v[60:61], v87 offset:12288
    v_mfma_f32_16x16x32_bf16 v[32:35], v[64:67], v[108:111], v[32:35]
    ds_read_b64_tr_b16 v[62:63], v87 offset:14336
    buffer_load_dwordx4 v[100:103], v225, s[40:43], s65 offen offset:3072 sc1
    ds_write_b128 v230, v[180:183] offset:8448
    s_waitcnt vmcnt(10) lgkmcnt(11)
    v_mfma_f32_16x16x32_bf16 v[4:7], v[68:71], v[112:115], v[4:7]
    ds_read_b64_tr_b16 v[64:65], v84 offset:16384
    v_mfma_f32_16x16x32_bf16 v[20:23], v[68:71], v[116:119], v[20:23]
    ds_read_b64_tr_b16 v[66:67], v84 offset:18432
    v_mfma_f32_16x16x32_bf16 v[8:11], v[36:39], v[112:115], v[8:11]
    ds_read_b64_tr_b16 v[68:69], v85 offset:16384
    v_mfma_f32_16x16x32_bf16 v[24:27], v[36:39], v[116:119], v[24:27]
    ds_read_b64_tr_b16 v[70:71], v85 offset:18432
    buffer_load_dwordx4 v[104:107], v224, s[40:43], s66 offen offset:0 sc1
    ds_write_b128 v230, v[184:187] offset:9472
    v_mfma_f32_16x16x32_bf16 v[12:15], v[40:43], v[112:115], v[12:15]
    ds_read_b64_tr_b16 v[36:37], v86 offset:16384
    v_mfma_f32_16x16x32_bf16 v[28:31], v[40:43], v[116:119], v[28:31]
    ds_read_b64_tr_b16 v[38:39], v86 offset:18432
    v_mfma_f32_16x16x32_bf16 v[16:19], v[44:47], v[112:115], v[16:19]
    ds_read_b64_tr_b16 v[40:41], v87 offset:16384
    v_mfma_f32_16x16x32_bf16 v[32:35], v[44:47], v[116:119], v[32:35]
    ds_read_b64_tr_b16 v[42:43], v87 offset:18432
    buffer_load_dwordx4 v[108:111], v225, s[40:43], s66 offen offset:0 sc1
    ds_write_b128 v230, v[188:191] offset:16896
    s_waitcnt vmcnt(10) lgkmcnt(11)
    v_mfma_f32_16x16x32_bf16 v[4:7], v[48:51], v[120:123], v[4:7]
    ds_read_b64_tr_b16 v[44:45], v84 offset:20480
    v_mfma_f32_16x16x32_bf16 v[20:23], v[48:51], v[124:127], v[20:23]
    ds_read_b64_tr_b16 v[46:47], v84 offset:22528
    v_mfma_f32_16x16x32_bf16 v[8:11], v[52:55], v[120:123], v[8:11]
    ds_read_b64_tr_b16 v[48:49], v85 offset:20480
    v_mfma_f32_16x16x32_bf16 v[24:27], v[52:55], v[124:127], v[24:27]
    ds_read_b64_tr_b16 v[50:51], v85 offset:22528
    buffer_load_dwordx4 v[112:115], v224, s[40:43], s66 offen offset:1024 sc1
    ds_write_b128 v230, v[192:195] offset:17920
    v_mfma_f32_16x16x32_bf16 v[12:15], v[56:59], v[120:123], v[12:15]
    ds_read_b64_tr_b16 v[52:53], v86 offset:20480
    v_mfma_f32_16x16x32_bf16 v[28:31], v[56:59], v[124:127], v[28:31]
    ds_read_b64_tr_b16 v[54:55], v86 offset:22528
    v_mfma_f32_16x16x32_bf16 v[16:19], v[60:63], v[120:123], v[16:19]
    ds_read_b64_tr_b16 v[56:57], v87 offset:20480
    v_mfma_f32_16x16x32_bf16 v[32:35], v[60:63], v[124:127], v[32:35]
    ds_read_b64_tr_b16 v[58:59], v87 offset:22528
    buffer_load_dwordx4 v[116:119], v225, s[40:43], s66 offen offset:1024 sc1
    ds_write_b128 v230, v[196:199] offset:25344
    s_waitcnt vmcnt(10) lgkmcnt(11)
    v_mfma_f32_16x16x32_bf16 v[4:7], v[64:67], v[128:131], v[4:7]
    ds_read_b64_tr_b16 v[60:61], v84 offset:24576
    v_mfma_f32_16x16x32_bf16 v[20:23], v[64:67], v[132:135], v[20:23]
    ds_read_b64_tr_b16 v[62:63], v84 offset:26624
    v_mfma_f32_16x16x32_bf16 v[8:11], v[68:71], v[128:131], v[8:11]
    ds_read_b64_tr_b16 v[64:65], v85 offset:24576
    v_mfma_f32_16x16x32_bf16 v[24:27], v[68:71], v[132:135], v[24:27]
    ds_read_b64_tr_b16 v[66:67], v85 offset:26624
    buffer_load_dwordx4 v[120:123], v224, s[40:43], s66 offen offset:2048 sc1
    ds_write_b128 v230, v[200:203] offset:26368
    v_mfma_f32_16x16x32_bf16 v[12:15], v[36:39], v[128:131], v[12:15]
    ds_read_b64_tr_b16 v[68:69], v86 offset:24576
    v_mfma_f32_16x16x32_bf16 v[28:31], v[36:39], v[132:135], v[28:31]
    ds_read_b64_tr_b16 v[70:71], v86 offset:26624
    v_mfma_f32_16x16x32_bf16 v[16:19], v[40:43], v[128:131], v[16:19]
    ds_read_b64_tr_b16 v[36:37], v87 offset:24576
    v_mfma_f32_16x16x32_bf16 v[32:35], v[40:43], v[132:135], v[32:35]
    ds_read_b64_tr_b16 v[38:39], v87 offset:26624
    buffer_load_dwordx4 v[124:127], v225, s[40:43], s66 offen offset:2048 sc1
    ds_write_b128 v231, v[204:207] offset:41984
    s_waitcnt vmcnt(10) lgkmcnt(11)
    v_mfma_f32_16x16x32_bf16 v[4:7], v[44:47], v[136:139], v[4:7]
    ds_read_b64_tr_b16 v[40:41], v84 offset:28672
    v_mfma_f32_16x16x32_bf16 v[20:23], v[44:47], v[140:143], v[20:23]
    ds_read_b64_tr_b16 v[42:43], v84 offset:30720
    v_mfma_f32_16x16x32_bf16 v[8:11], v[48:51], v[136:139], v[8:11]
    ds_read_b64_tr_b16 v[44:45], v85 offset:28672
    v_mfma_f32_16x16x32_bf16 v[24:27], v[48:51], v[140:143], v[24:27]
    ds_read_b64_tr_b16 v[46:47], v85 offset:30720
    buffer_load_dwordx4 v[128:131], v224, s[40:43], s66 offen offset:3072 sc1
    ds_write_b128 v231, v[208:211] offset:43008
    v_mfma_f32_16x16x32_bf16 v[12:15], v[52:55], v[136:139], v[12:15]
    ds_read_b64_tr_b16 v[48:49], v86 offset:28672
    v_mfma_f32_16x16x32_bf16 v[28:31], v[52:55], v[140:143], v[28:31]
    ds_read_b64_tr_b16 v[50:51], v86 offset:30720
    v_mfma_f32_16x16x32_bf16 v[16:19], v[56:59], v[136:139], v[16:19]
    ds_read_b64_tr_b16 v[52:53], v87 offset:28672
    v_mfma_f32_16x16x32_bf16 v[32:35], v[56:59], v[140:143], v[32:35]
    ds_read_b64_tr_b16 v[54:55], v87 offset:30720
    buffer_load_dwordx4 v[132:135], v225, s[40:43], s66 offen offset:3072 sc1
    ds_write_b128 v231, v[212:215] offset:51200
    s_waitcnt vmcnt(10) lgkmcnt(11)
    v_mfma_f32_16x16x32_bf16 v[4:7], v[60:63], v[144:147], v[4:7]
    ds_read_b64_tr_b16 v[56:57], v84 offset:32768
    v_mfma_f32_16x16x32_bf16 v[20:23], v[60:63], v[148:151], v[20:23]
    ds_read_b64_tr_b16 v[58:59], v84 offset:34816
    v_mfma_f32_16x16x32_bf16 v[8:11], v[64:67], v[144:147], v[8:11]
    ds_read_b64_tr_b16 v[60:61], v85 offset:32768
    v_mfma_f32_16x16x32_bf16 v[24:27], v[64:67], v[148:151], v[24:27]
    ds_read_b64_tr_b16 v[62:63], v85 offset:34816
    buffer_load_dwordx4 v[136:139], v224, s[40:43], s67 offen offset:0 sc1
    ds_write_b128 v231, v[216:219] offset:52224
    s_mov_b64 exec, 1
    ds_add_u32 v228, v2 offset:12
    s_mov_b64 exec, -1
    v_mfma_f32_16x16x32_bf16 v[12:15], v[68:71], v[144:147], v[12:15]
    ds_read_b64_tr_b16 v[64:65], v86 offset:32768
    v_mfma_f32_16x16x32_bf16 v[28:31], v[68:71], v[148:151], v[28:31]
    ds_read_b64_tr_b16 v[66:67], v86 offset:34816
    v_mfma_f32_16x16x32_bf16 v[16:19], v[36:39], v[144:147], v[16:19]
    ds_read_b64_tr_b16 v[68:69], v87 offset:32768
    v_mfma_f32_16x16x32_bf16 v[32:35], v[36:39], v[148:151], v[32:35]
    ds_read_b64_tr_b16 v[70:71], v87 offset:34816
    buffer_load_dwordx4 v[140:143], v225, s[40:43], s67 offen offset:0 sc1
    s_waitcnt vmcnt(10) lgkmcnt(11)
    v_mfma_f32_16x16x32_bf16 v[4:7], v[40:43], v[96:99], v[4:7]
    ds_read_b64_tr_b16 v[36:37], v84 offset:36864
    v_mfma_f32_16x16x32_bf16 v[20:23], v[40:43], v[100:103], v[20:23]
    ds_read_b64_tr_b16 v[38:39], v84 offset:38912
    v_mfma_f32_16x16x32_bf16 v[8:11], v[44:47], v[96:99], v[8:11]
    ds_read_b64_tr_b16 v[40:41], v85 offset:36864
    v_mfma_f32_16x16x32_bf16 v[24:27], v[44:47], v[100:103], v[24:27]
    ds_read_b64_tr_b16 v[42:43], v85 offset:38912
    buffer_load_dwordx4 v[144:147], v224, s[40:43], s67 offen offset:1024 sc1
    v_mfma_f32_16x16x32_bf16 v[12:15], v[48:51], v[96:99], v[12:15]
    ds_read_b64_tr_b16 v[44:45], v86 offset:36864
    v_mfma_f32_16x16x32_bf16 v[28:31], v[48:51], v[100:103], v[28:31]
    ds_read_b64_tr_b16 v[46:47], v86 offset:38912
    v_mfma_f32_16x16x32_bf16 v[16:19], v[52:55], v[96:99], v[16:19]
    ds_read_b64_tr_b16 v[48:49], v87 offset:36864
    v_mfma_f32_16x16x32_bf16 v[32:35], v[52:55], v[100:103], v[32:35]
    ds_read_b64_tr_b16 v[50:51], v87 offset:38912
    buffer_load_dwordx4 v[148:151], v225, s[40:43], s67 offen offset:1024 sc1
    s_waitcnt vmcnt(10) lgkmcnt(8)
    v_mfma_f32_16x16x32_bf16 v[4:7], v[56:59], v[104:107], v[4:7]
    ds_read_b64_tr_b16 v[52:53], v88 offset:0
    v_mfma_f32_16x16x32_bf16 v[20:23], v[56:59], v[108:111], v[20:23]
    ds_read_b64_tr_b16 v[54:55], v88 offset:2048
    v_mfma_f32_16x16x32_bf16 v[8:11], v[60:63], v[104:107], v[8:11]
    ds_read_b64_tr_b16 v[56:57], v89 offset:0
    v_mfma_f32_16x16x32_bf16 v[24:27], v[60:63], v[108:111], v[24:27]
    ds_read_b64_tr_b16 v[58:59], v89 offset:2048
    buffer_load_dwordx4 v[96:99], v224, s[40:43], s67 offen offset:2048 sc1
    v_mfma_f32_16x16x32_bf16 v[12:15], v[64:67], v[104:107], v[12:15]
    ds_read_b64_tr_b16 v[60:61], v90 offset:0
    v_mfma_f32_16x16x32_bf16 v[28:31], v[64:67], v[108:111], v[28:31]
    ds_read_b64_tr_b16 v[62:63], v90 offset:2048
    v_mfma_f32_16x16x32_bf16 v[16:19], v[68:71], v[104:107], v[16:19]
    ds_read_b64_tr_b16 v[64:65], v91 offset:0
    v_mfma_f32_16x16x32_bf16 v[32:35], v[68:71], v[108:111], v[32:35]
    ds_read_b64_tr_b16 v[66:67], v91 offset:2048
    buffer_load_dwordx4 v[100:103], v225, s[40:43], s67 offen offset:2048 sc1
    s_waitcnt vmcnt(10) lgkmcnt(8)
    v_mfma_f32_16x16x32_bf16 v[4:7], v[36:39], v[112:115], v[4:7]
    ds_read_b64_tr_b16 v[68:69], v88 offset:4096
    v_mfma_f32_16x16x32_bf16 v[20:23], v[36:39], v[116:119], v[20:23]
    ds_read_b64_tr_b16 v[70:71], v88 offset:6144
    v_mfma_f32_16x16x32_bf16 v[8:11], v[40:43], v[112:115], v[8:11]
    ds_read_b64_tr_b16 v[36:37], v89 offset:4096
    v_mfma_f32_16x16x32_bf16 v[24:27], v[40:43], v[116:119], v[24:27]
    ds_read_b64_tr_b16 v[38:39], v89 offset:6144
    buffer_load_dwordx4 v[104:107], v224, s[40:43], s67 offen offset:3072 sc1
    v_mfma_f32_16x16x32_bf16 v[12:15], v[44:47], v[112:115], v[12:15]
    ds_read_b64_tr_b16 v[40:41], v90 offset:4096
    v_mfma_f32_16x16x32_bf16 v[28:31], v[44:47], v[116:119], v[28:31]
    ds_read_b64_tr_b16 v[42:43], v90 offset:6144
    v_mfma_f32_16x16x32_bf16 v[16:19], v[48:51], v[112:115], v[16:19]
    ds_read_b64_tr_b16 v[44:45], v91 offset:4096
    v_mfma_f32_16x16x32_bf16 v[32:35], v[48:51], v[116:119], v[32:35]
    ds_read_b64_tr_b16 v[46:47], v91 offset:6144
    buffer_load_dwordx4 v[108:111], v225, s[40:43], s67 offen offset:3072 sc1
    s_waitcnt vmcnt(10) lgkmcnt(8)
    v_mfma_f32_16x16x32_bf16 v[4:7], v[52:55], v[120:123], v[4:7]
    ds_read_b64_tr_b16 v[48:49], v88 offset:8192
    v_mfma_f32_16x16x32_bf16 v[20:23], v[52:55], v[124:127], v[20:23]
    ds_read_b64_tr_b16 v[50:51], v88 offset:10240
    v_mfma_f32_16x16x32_bf16 v[8:11], v[56:59], v[120:123], v[8:11]
    ds_read_b64_tr_b16 v[52:53], v89 offset:8192
    v_mfma_f32_16x16x32_bf16 v[24:27], v[56:59], v[124:127], v[24:27]
    ds_read_b64_tr_b16 v[54:55], v89 offset:10240
    buffer_load_dwordx4 v[112:115], v224, s[40:43], s68 offen offset:0 sc1
    v_mfma_f32_16x16x32_bf16 v[12:15], v[60:63], v[120:123], v[12:15]
    ds_read_b64_tr_b16 v[56:57], v90 offset:8192
    v_mfma_f32_16x16x32_bf16 v[28:31], v[60:63], v[124:127], v[28:31]
    ds_read_b64_tr_b16 v[58:59], v90 offset:10240
    v_mfma_f32_16x16x32_bf16 v[16:19], v[64:67], v[120:123], v[16:19]
    ds_read_b64_tr_b16 v[60:61], v91 offset:8192
    v_mfma_f32_16x16x32_bf16 v[32:35], v[64:67], v[124:127], v[32:35]
    ds_read_b64_tr_b16 v[62:63], v91 offset:10240
    buffer_load_dwordx4 v[116:119], v225, s[40:43], s68 offen offset:0 sc1
    s_waitcnt vmcnt(10) lgkmcnt(8)
    v_mfma_f32_16x16x32_bf16 v[4:7], v[68:71], v[128:131], v[4:7]
    ds_read_b64_tr_b16 v[64:65], v88 offset:12288
    v_mfma_f32_16x16x32_bf16 v[20:23], v[68:71], v[132:135], v[20:23]
    ds_read_b64_tr_b16 v[66:67], v88 offset:14336
    v_mfma_f32_16x16x32_bf16 v[8:11], v[36:39], v[128:131], v[8:11]
    ds_read_b64_tr_b16 v[68:69], v89 offset:12288
    v_mfma_f32_16x16x32_bf16 v[24:27], v[36:39], v[132:135], v[24:27]
    ds_read_b64_tr_b16 v[70:71], v89 offset:14336
    buffer_load_dwordx4 v[120:123], v224, s[40:43], s68 offen offset:1024 sc1
    v_mfma_f32_16x16x32_bf16 v[12:15], v[40:43], v[128:131], v[12:15]
    ds_read_b64_tr_b16 v[36:37], v90 offset:12288
    v_mfma_f32_16x16x32_bf16 v[28:31], v[40:43], v[132:135], v[28:31]
    ds_read_b64_tr_b16 v[38:39], v90 offset:14336
    v_mfma_f32_16x16x32_bf16 v[16:19], v[44:47], v[128:131], v[16:19]
    ds_read_b64_tr_b16 v[40:41], v91 offset:12288
    v_mfma_f32_16x16x32_bf16 v[32:35], v[44:47], v[132:135], v[32:35]
    ds_read_b64_tr_b16 v[42:43], v91 offset:14336
    buffer_load_dwordx4 v[124:127], v225, s[40:43], s68 offen offset:1024 sc1
    s_waitcnt vmcnt(10) lgkmcnt(8)
    v_mfma_f32_16x16x32_bf16 v[4:7], v[48:51], v[136:139], v[4:7]
    ds_read_b64_tr_b16 v[44:45], v88 offset:16384
    v_mfma_f32_16x16x32_bf16 v[20:23], v[48:51], v[140:143], v[20:23]
    ds_read_b64_tr_b16 v[46:47], v88 offset:18432
    v_mfma_f32_16x16x32_bf16 v[8:11], v[52:55], v[136:139], v[8:11]
    ds_read_b64_tr_b16 v[48:49], v89 offset:16384
    v_mfma_f32_16x16x32_bf16 v[24:27], v[52:55], v[140:143], v[24:27]
    ds_read_b64_tr_b16 v[50:51], v89 offset:18432
    buffer_load_dwordx4 v[128:131], v224, s[40:43], s68 offen offset:2048 sc1
    v_mfma_f32_16x16x32_bf16 v[12:15], v[56:59], v[136:139], v[12:15]
    ds_read_b64_tr_b16 v[52:53], v90 offset:16384
    v_mfma_f32_16x16x32_bf16 v[28:31], v[56:59], v[140:143], v[28:31]
    ds_read_b64_tr_b16 v[54:55], v90 offset:18432
    v_mfma_f32_16x16x32_bf16 v[16:19], v[60:63], v[136:139], v[16:19]
    ds_read_b64_tr_b16 v[56:57], v91 offset:16384
    v_mfma_f32_16x16x32_bf16 v[32:35], v[60:63], v[140:143], v[32:35]
    ds_read_b64_tr_b16 v[58:59], v91 offset:18432
    buffer_load_dwordx4 v[132:135], v225, s[40:43], s68 offen offset:2048 sc1
    s_waitcnt vmcnt(10) lgkmcnt(8)
    v_mfma_f32_16x16x32_bf16 v[4:7], v[64:67], v[144:147], v[4:7]
    ds_read_b64_tr_b16 v[60:61], v88 offset:20480
    v_mfma_f32_16x16x32_bf16 v[20:23], v[64:67], v[148:151], v[20:23]
    ds_read_b64_tr_b16 v[62:63], v88 offset:22528
    v_mfma_f32_16x16x32_bf16 v[8:11], v[68:71], v[144:147], v[8:11]
    ds_read_b64_tr_b16 v[64:65], v89 offset:20480
    v_mfma_f32_16x16x32_bf16 v[24:27], v[68:71], v[148:151], v[24:27]
    ds_read_b64_tr_b16 v[66:67], v89 offset:22528
    buffer_load_dwordx4 v[136:139], v224, s[40:43], s68 offen offset:3072 sc1
    v_mfma_f32_16x16x32_bf16 v[12:15], v[36:39], v[144:147], v[12:15]
    ds_read_b64_tr_b16 v[68:69], v90 offset:20480
    v_mfma_f32_16x16x32_bf16 v[28:31], v[36:39], v[148:151], v[28:31]
    ds_read_b64_tr_b16 v[70:71], v90 offset:22528
    v_mfma_f32_16x16x32_bf16 v[16:19], v[40:43], v[144:147], v[16:19]
    ds_read_b64_tr_b16 v[36:37], v91 offset:20480
    v_mfma_f32_16x16x32_bf16 v[32:35], v[40:43], v[148:151], v[32:35]
    ds_read_b64_tr_b16 v[38:39], v91 offset:22528
    buffer_load_dwordx4 v[140:143], v225, s[40:43], s68 offen offset:3072 sc1
    s_waitcnt vmcnt(10) lgkmcnt(8)
    v_mfma_f32_16x16x32_bf16 v[4:7], v[44:47], v[96:99], v[4:7]
    ds_read_b64_tr_b16 v[40:41], v88 offset:24576
    v_mfma_f32_16x16x32_bf16 v[20:23], v[44:47], v[100:103], v[20:23]
    ds_read_b64_tr_b16 v[42:43], v88 offset:26624
    v_mfma_f32_16x16x32_bf16 v[8:11], v[48:51], v[96:99], v[8:11]
    ds_read_b64_tr_b16 v[44:45], v89 offset:24576
    v_mfma_f32_16x16x32_bf16 v[24:27], v[48:51], v[100:103], v[24:27]
    ds_read_b64_tr_b16 v[46:47], v89 offset:26624
    buffer_load_dwordx4 v[144:147], v224, s[40:43], s69 offen offset:0 sc1
    v_mfma_f32_16x16x32_bf16 v[12:15], v[52:55], v[96:99], v[12:15]
    ds_read_b64_tr_b16 v[48:49], v90 offset:24576
    v_mfma_f32_16x16x32_bf16 v[28:31], v[52:55], v[100:103], v[28:31]
    ds_read_b64_tr_b16 v[50:51], v90 offset:26624
    v_mfma_f32_16x16x32_bf16 v[16:19], v[56:59], v[96:99], v[16:19]
    ds_read_b64_tr_b16 v[52:53], v91 offset:24576
    v_mfma_f32_16x16x32_bf16 v[32:35], v[56:59], v[100:103], v[32:35]
    ds_read_b64_tr_b16 v[54:55], v91 offset:26624
    buffer_load_dwordx4 v[148:151], v225, s[40:43], s69 offen offset:0 sc1
    s_waitcnt vmcnt(10) lgkmcnt(8)
    v_mfma_f32_16x16x32_bf16 v[4:7], v[60:63], v[104:107], v[4:7]
    ds_read_b64_tr_b16 v[56:57], v88 offset:28672
    v_mfma_f32_16x16x32_bf16 v[20:23], v[60:63], v[108:111], v[20:23]
    ds_read_b64_tr_b16 v[58:59], v88 offset:30720
    v_mfma_f32_16x16x32_bf16 v[8:11], v[64:67], v[104:107], v[8:11]
    ds_read_b64_tr_b16 v[60:61], v89 offset:28672
    v_mfma_f32_16x16x32_bf16 v[24:27], v[64:67], v[108:111], v[24:27]
    ds_read_b64_tr_b16 v[62:63], v89 offset:30720
    buffer_load_dwordx4 v[96:99], v224, s[40:43], s69 offen offset:1024 sc1
    v_mfma_f32_16x16x32_bf16 v[12:15], v[68:71], v[104:107], v[12:15]
    ds_read_b64_tr_b16 v[64:65], v90 offset:28672
    v_mfma_f32_16x16x32_bf16 v[28:31], v[68:71], v[108:111], v[28:31]
    ds_read_b64_tr_b16 v[66:67], v90 offset:30720
    v_mfma_f32_16x16x32_bf16 v[16:19], v[36:39], v[104:107], v[16:19]
    ds_read_b64_tr_b16 v[68:69], v91 offset:28672
    v_mfma_f32_16x16x32_bf16 v[32:35], v[36:39], v[108:111], v[32:35]
    ds_read_b64_tr_b16 v[70:71], v91 offset:30720
    buffer_load_dwordx4 v[100:103], v225, s[40:43], s69 offen offset:1024 sc1
    s_waitcnt vmcnt(10) lgkmcnt(8)
    v_mfma_f32_16x16x32_bf16 v[4:7], v[40:43], v[112:115], v[4:7]
    ds_read_b64_tr_b16 v[36:37], v88 offset:32768
    v_mfma_f32_16x16x32_bf16 v[20:23], v[40:43], v[116:119], v[20:23]
    ds_read_b64_tr_b16 v[38:39], v88 offset:34816
    v_mfma_f32_16x16x32_bf16 v[8:11], v[44:47], v[112:115], v[8:11]
    ds_read_b64_tr_b16 v[40:41], v89 offset:32768
    v_mfma_f32_16x16x32_bf16 v[24:27], v[44:47], v[116:119], v[24:27]
    ds_read_b64_tr_b16 v[42:43], v89 offset:34816
    buffer_load_dwordx4 v[104:107], v224, s[40:43], s69 offen offset:2048 sc1
    v_mfma_f32_16x16x32_bf16 v[12:15], v[48:51], v[112:115], v[12:15]
    ds_read_b64_tr_b16 v[44:45], v90 offset:32768
    v_mfma_f32_16x16x32_bf16 v[28:31], v[48:51], v[116:119], v[28:31]
    ds_read_b64_tr_b16 v[46:47], v90 offset:34816
    v_mfma_f32_16x16x32_bf16 v[16:19], v[52:55], v[112:115], v[16:19]
    ds_read_b64_tr_b16 v[48:49], v91 offset:32768
    v_mfma_f32_16x16x32_bf16 v[32:35], v[52:55], v[116:119], v[32:35]
    ds_read_b64_tr_b16 v[50:51], v91 offset:34816
    buffer_load_dwordx4 v[108:111], v225, s[40:43], s69 offen offset:2048 sc1
    ds_read_b32 v1, v228 offset:12
    s_waitcnt vmcnt(10) lgkmcnt(9)
    v_mfma_f32_16x16x32_bf16 v[4:7], v[56:59], v[120:123], v[4:7]
    ds_read_b64_tr_b16 v[52:53], v88 offset:36864
    v_mfma_f32_16x16x32_bf16 v[20:23], v[56:59], v[124:127], v[20:23]
    ds_read_b64_tr_b16 v[54:55], v88 offset:38912
    v_mfma_f32_16x16x32_bf16 v[8:11], v[60:63], v[120:123], v[8:11]
    ds_read_b64_tr_b16 v[56:57], v89 offset:36864
    v_mfma_f32_16x16x32_bf16 v[24:27], v[60:63], v[124:127], v[24:27]
    ds_read_b64_tr_b16 v[58:59], v89 offset:38912
    buffer_load_dwordx4 v[112:115], v224, s[40:43], s69 offen offset:3072 sc1
    v_mfma_f32_16x16x32_bf16 v[12:15], v[64:67], v[120:123], v[12:15]
    ds_read_b64_tr_b16 v[60:61], v90 offset:36864
    v_mfma_f32_16x16x32_bf16 v[28:31], v[64:67], v[124:127], v[28:31]
    ds_read_b64_tr_b16 v[62:63], v90 offset:38912
    v_mfma_f32_16x16x32_bf16 v[16:19], v[68:71], v[120:123], v[16:19]
    ds_read_b64_tr_b16 v[64:65], v91 offset:36864
    v_mfma_f32_16x16x32_bf16 v[32:35], v[68:71], v[124:127], v[32:35]
    ds_read_b64_tr_b16 v[66:67], v91 offset:38912
    buffer_load_dwordx4 v[116:119], v225, s[40:43], s69 offen offset:3072 sc1
    s_waitcnt lgkmcnt(8)
    v_readfirstlane_b32 s37, v1
    s_nop 0
    s_cmp_ge_u32 s37, 4
    s_cbranch_scc1 L_sl_done_54
    s_mov_b32 s38, 1048576
L_sl_loop_55:
    ds_read_b32 v1, v228 offset:12
    s_waitcnt lgkmcnt(0)
    v_readfirstlane_b32 s37, v1
    s_nop 0
    s_cmp_ge_u32 s37, 4
    s_cbranch_scc1 L_sl_done_54
    s_sleep 1
    s_sub_u32 s38, s38, 1
    s_cbranch_scc0 L_sl_loop_55
L_sl_done_54:
    s_waitcnt vmcnt(10)
    v_mfma_f32_16x16x32_bf16 v[4:7], v[36:39], v[128:131], v[4:7]
    ds_read_b64_tr_b16 v[68:69], v92 offset:0
    v_mfma_f32_16x16x32_bf16 v[20:23], v[36:39], v[132:135], v[20:23]
    ds_read_b64_tr_b16 v[70:71], v92 offset:2048
    v_mfma_f32_16x16x32_bf16 v[8:11], v[40:43], v[128:131], v[8:11]
    ds_read_b64_tr_b16 v[36:37], v93 offset:0
    v_mfma_f32_16x16x32_bf16 v[24:27], v[40:43], v[132:135], v[24:27]
    ds_read_b64_tr_b16 v[38:39], v93 offset:2048
    buffer_load_dwordx4 v[120:123], v224, s[40:43], s70 offen offset:0 sc1
    v_mfma_f32_16x16x32_bf16 v[12:15], v[44:47], v[128:131], v[12:15]
    ds_read_b64_tr_b16 v[40:41], v94 offset:0
    v_mfma_f32_16x16x32_bf16 v[28:31], v[44:47], v[132:135], v[28:31]
    ds_read_b64_tr_b16 v[42:43], v94 offset:2048
    v_mfma_f32_16x16x32_bf16 v[16:19], v[48:51], v[128:131], v[16:19]
    ds_read_b64_tr_b16 v[44:45], v95 offset:0
    v_mfma_f32_16x16x32_bf16 v[32:35], v[48:51], v[132:135], v[32:35]
    ds_read_b64_tr_b16 v[46:47], v95 offset:2048
    buffer_load_dwordx4 v[124:127], v225, s[40:43], s70 offen offset:0 sc1
    s_waitcnt vmcnt(10) lgkmcnt(8)
    v_mfma_f32_16x16x32_bf16 v[4:7], v[52:55], v[136:139], v[4:7]
    ds_read_b64_tr_b16 v[48:49], v92 offset:4096
    v_mfma_f32_16x16x32_bf16 v[20:23], v[52:55], v[140:143], v[20:23]
    ds_read_b64_tr_b16 v[50:51], v92 offset:6144
    v_mfma_f32_16x16x32_bf16 v[8:11], v[56:59], v[136:139], v[8:11]
    ds_read_b64_tr_b16 v[52:53], v93 offset:4096
    v_mfma_f32_16x16x32_bf16 v[24:27], v[56:59], v[140:143], v[24:27]
    ds_read_b64_tr_b16 v[54:55], v93 offset:6144
    buffer_load_dwordx4 v[128:131], v224, s[40:43], s70 offen offset:1024 sc1
    v_mfma_f32_16x16x32_bf16 v[12:15], v[60:63], v[136:139], v[12:15]
    ds_read_b64_tr_b16 v[56:57], v94 offset:4096
    v_mfma_f32_16x16x32_bf16 v[28:31], v[60:63], v[140:143], v[28:31]
    ds_read_b64_tr_b16 v[58:59], v94 offset:6144
    v_mfma_f32_16x16x32_bf16 v[16:19], v[64:67], v[136:139], v[16:19]
    ds_read_b64_tr_b16 v[60:61], v95 offset:4096
    v_mfma_f32_16x16x32_bf16 v[32:35], v[64:67], v[140:143], v[32:35]
    ds_read_b64_tr_b16 v[62:63], v95 offset:6144
    buffer_load_dwordx4 v[132:135], v225, s[40:43], s70 offen offset:1024 sc1
    s_waitcnt vmcnt(10) lgkmcnt(8)
    v_mfma_f32_16x16x32_bf16 v[4:7], v[68:71], v[144:147], v[4:7]
    ds_read_b64_tr_b16 v[64:65], v92 offset:8448
    v_mfma_f32_16x16x32_bf16 v[20:23], v[68:71], v[148:151], v[20:23]
    ds_read_b64_tr_b16 v[66:67], v92 offset:10496
    v_mfma_f32_16x16x32_bf16 v[8:11], v[36:39], v[144:147], v[8:11]
    ds_read_b64_tr_b16 v[68:69], v93 offset:8448
    v_mfma_f32_16x16x32_bf16 v[24:27], v[36:39], v[148:151], v[24:27]
    ds_read_b64_tr_b16 v[70:71], v93 offset:10496
    buffer_load_dwordx4 v[136:139], v224, s[40:43], s70 offen offset:2048 sc1
    v_mfma_f32_16x16x32_bf16 v[12:15], v[40:43], v[144:147], v[12:15]
    ds_read_b64_tr_b16 v[36:37], v94 offset:8448
    v_mfma_f32_16x16x32_bf16 v[28:31], v[40:43], v[148:151], v[28:31]
    ds_read_b64_tr_b16 v[38:39], v94 offset:10496
    v_mfma_f32_16x16x32_bf16 v[16:19], v[44:47], v[144:147], v[16:19]
    ds_read_b64_tr_b16 v[40:41], v95 offset:8448
    v_mfma_f32_16x16x32_bf16 v[32:35], v[44:47], v[148:151], v[32:35]
    ds_read_b64_tr_b16 v[42:43], v95 offset:10496
    buffer_load_dwordx4 v[140:143], v225, s[40:43], s70 offen offset:2048 sc1
    s_waitcnt vmcnt(10) lgkmcnt(8)
    v_mfma_f32_16x16x32_bf16 v[4:7], v[48:51], v[96:99], v[4:7]
    ds_read_b64_tr_b16 v[44:45], v92 offset:12544
    v_mfma_f32_16x16x32_bf16 v[20:23], v[48:51], v[100:103], v[20:23]
    ds_read_b64_tr_b16 v[46:47], v92 offset:14592
    v_mfma_f32_16x16x32_bf16 v[8:11], v[52:55], v[96:99], v[8:11]
    ds_read_b64_tr_b16 v[48:49], v93 offset:12544
    v_mfma_f32_16x16x32_bf16 v[24:27], v[52:55], v[100:103], v[24:27]
    ds_read_b64_tr_b16 v[50:51], v93 offset:14592
    buffer_load_dwordx4 v[144:147], v224, s[40:43], s70 offen offset:3072 sc1
    v_mfma_f32_16x16x32_bf16 v[12:15], v[56:59], v[96:99], v[12:15]
    ds_read_b64_tr_b16 v[52:53], v94 offset:12544
    v_mfma_f32_16x16x32_bf16 v[28:31], v[56:59], v[100:103], v[28:31]
    ds_read_b64_tr_b16 v[54:55], v94 offset:14592
    v_mfma_f32_16x16x32_bf16 v[16:19], v[60:63], v[96:99], v[16:19]
    ds_read_b64_tr_b16 v[56:57], v95 offset:12544
    v_mfma_f32_16x16x32_bf16 v[32:35], v[60:63], v[100:103], v[32:35]
    ds_read_b64_tr_b16 v[58:59], v95 offset:14592
    buffer_load_dwordx4 v[148:151], v225, s[40:43], s70 offen offset:3072 sc1
    s_waitcnt vmcnt(10) lgkmcnt(8)
    v_mfma_f32_16x16x32_bf16 v[4:7], v[64:67], v[104:107], v[4:7]
    ds_read_b64_tr_b16 v[60:61], v92 offset:16896
    v_mfma_f32_16x16x32_bf16 v[20:23], v[64:67], v[108:111], v[20:23]
    ds_read_b64_tr_b16 v[62:63], v92 offset:18944
    v_mfma_f32_16x16x32_bf16 v[8:11], v[68:71], v[104:107], v[8:11]
    ds_read_b64_tr_b16 v[64:65], v93 offset:16896
    v_mfma_f32_16x16x32_bf16 v[24:27], v[68:71], v[108:111], v[24:27]
    ds_read_b64_tr_b16 v[66:67], v93 offset:18944
    buffer_load_dwordx4 v[96:99], v224, s[40:43], s71 offen offset:0 sc1
    v_mfma_f32_16x16x32_bf16 v[12:15], v[36:39], v[104:107], v[12:15]
    ds_read_b64_tr_b16 v[68:69], v94 offset:16896
    v_mfma_f32_16x16x32_bf16 v[28:31], v[36:39], v[108:111], v[28:31]
    ds_read_b64_tr_b16 v[70:71], v94 offset:18944
    v_mfma_f32_16x16x32_bf16 v[16:19], v[40:43], v[104:107], v[16:19]
    ds_read_b64_tr_b16 v[36:37], v95 offset:16896
    v_mfma_f32_16x16x32_bf16 v[32:35], v[40:43], v[108:111], v[32:35]
    ds_read_b64_tr_b16 v[38:39], v95 offset:18944
    buffer_load_dwordx4 v[100:103], v225, s[40:43], s71 offen offset:0 sc1
    s_waitcnt vmcnt(10) lgkmcnt(8)
    v_mfma_f32_16x16x32_bf16 v[4:7], v[44:47], v[112:115], v[4:7]
    ds_read_b64_tr_b16 v[40:41], v92 offset:20992
    v_mfma_f32_16x16x32_bf16 v[20:23], v[44:47], v[116:119], v[20:23]
    ds_read_b64_tr_b16 v[42:43], v92 offset:23040
    v_mfma_f32_16x16x32_bf16 v[8:11], v[48:51], v[112:115], v[8:11]
    ds_read_b64_tr_b16 v[44:45], v93 offset:20992
    v_mfma_f32_16x16x32_bf16 v[24:27], v[48:51], v[116:119], v[24:27]
    ds_read_b64_tr_b16 v[46:47], v93 offset:23040
    buffer_load_dwordx4 v[104:107], v224, s[40:43], s71 offen offset:1024 sc1
    v_mfma_f32_16x16x32_bf16 v[12:15], v[52:55], v[112:115], v[12:15]
    ds_read_b64_tr_b16 v[48:49], v94 offset:20992
    v_mfma_f32_16x16x32_bf16 v[28:31], v[52:55], v[116:119], v[28:31]
    ds_read_b64_tr_b16 v[50:51], v94 offset:23040
    v_mfma_f32_16x16x32_bf16 v[16:19], v[56:59], v[112:115], v[16:19]
    ds_read_b64_tr_b16 v[52:53], v95 offset:20992
    v_mfma_f32_16x16x32_bf16 v[32:35], v[56:59], v[116:119], v[32:35]
    ds_read_b64_tr_b16 v[54:55], v95 offset:23040
    buffer_load_dwordx4 v[108:111], v225, s[40:43], s71 offen offset:1024 sc1
    s_waitcnt vmcnt(10) lgkmcnt(8)
    v_mfma_f32_16x16x32_bf16 v[4:7], v[60:63], v[120:123], v[4:7]
    ds_read_b64_tr_b16 v[56:57], v92 offset:25344
    v_mfma_f32_16x16x32_bf16 v[20:23], v[60:63], v[124:127], v[20:23]
    ds_read_b64_tr_b16 v[58:59], v92 offset:27392
    v_mfma_f32_16x16x32_bf16 v[8:11], v[64:67], v[120:123], v[8:11]
    ds_read_b64_tr_b16 v[60:61], v93 offset:25344
    v_mfma_f32_16x16x32_bf16 v[24:27], v[64:67], v[124:127], v[24:27]
    ds_read_b64_tr_b16 v[62:63], v93 offset:27392
    buffer_load_dwordx4 v[112:115], v224, s[40:43], s71 offen offset:2048 sc1
    v_mfma_f32_16x16x32_bf16 v[12:15], v[68:71], v[120:123], v[12:15]
    ds_read_b64_tr_b16 v[64:65], v94 offset:25344
    v_mfma_f32_16x16x32_bf16 v[28:31], v[68:71], v[124:127], v[28:31]
    ds_read_b64_tr_b16 v[66:67], v94 offset:27392
    v_mfma_f32_16x16x32_bf16 v[16:19], v[36:39], v[120:123], v[16:19]
    ds_read_b64_tr_b16 v[68:69], v95 offset:25344
    v_mfma_f32_16x16x32_bf16 v[32:35], v[36:39], v[124:127], v[32:35]
    ds_read_b64_tr_b16 v[70:71], v95 offset:27392
    buffer_load_dwordx4 v[116:119], v225, s[40:43], s71 offen offset:2048 sc1
    s_waitcnt vmcnt(10) lgkmcnt(8)
    v_mfma_f32_16x16x32_bf16 v[4:7], v[40:43], v[128:131], v[4:7]
    ds_read_b64_tr_b16 v[36:37], v92 offset:29440
    v_mfma_f32_16x16x32_bf16 v[20:23], v[40:43], v[132:135], v[20:23]
    ds_read_b64_tr_b16 v[38:39], v92 offset:31488
    v_mfma_f32_16x16x32_bf16 v[8:11], v[44:47], v[128:131], v[8:11]
    ds_read_b64_tr_b16 v[40:41], v93 offset:29440
    v_mfma_f32_16x16x32_bf16 v[24:27], v[44:47], v[132:135], v[24:27]
    ds_read_b64_tr_b16 v[42:43], v93 offset:31488
    buffer_load_dwordx4 v[120:123], v224, s[40:43], s71 offen offset:3072 sc1
    v_mfma_f32_16x16x32_bf16 v[12:15], v[48:51], v[128:131], v[12:15]
    ds_read_b64_tr_b16 v[44:45], v94 offset:29440
    v_mfma_f32_16x16x32_bf16 v[28:31], v[48:51], v[132:135], v[28:31]
    ds_read_b64_tr_b16 v[46:47], v94 offset:31488
    v_mfma_f32_16x16x32_bf16 v[16:19], v[52:55], v[128:131], v[16:19]
    ds_read_b64_tr_b16 v[48:49], v95 offset:29440
    v_mfma_f32_16x16x32_bf16 v[32:35], v[52:55], v[132:135], v[32:35]
    ds_read_b64_tr_b16 v[50:51], v95 offset:31488
    buffer_load_dwordx4 v[124:127], v225, s[40:43], s71 offen offset:3072 sc1
    s_waitcnt vmcnt(10) lgkmcnt(8)
    v_mfma_f32_16x16x32_bf16 v[4:7], v[56:59], v[136:139], v[4:7]
    ds_read_b64_tr_b16 v[52:53], v84 offset:41984
    v_mfma_f32_16x16x32_bf16 v[20:23], v[56:59], v[140:143], v[20:23]
    ds_read_b64_tr_b16 v[54:55], v84 offset:44032
    v_mfma_f32_16x16x32_bf16 v[8:11], v[60:63], v[136:139], v[8:11]
    ds_read_b64_tr_b16 v[56:57], v85 offset:41984
    v_mfma_f32_16x16x32_bf16 v[24:27], v[60:63], v[140:143], v[24:27]
    ds_read_b64_tr_b16 v[58:59], v85 offset:44032
    v_mfma_f32_16x16x32_bf16 v[12:15], v[64:67], v[136:139], v[12:15]
    ds_read_b64_tr_b16 v[60:61], v86 offset:41984
    v_mfma_f32_16x16x32_bf16 v[28:31], v[64:67], v[140:143], v[28:31]
    ds_read_b64_tr_b16 v[62:63], v86 offset:44032
    v_mfma_f32_16x16x32_bf16 v[16:19], v[68:71], v[136:139], v[16:19]
    ds_read_b64_tr_b16 v[64:65], v87 offset:41984
    v_mfma_f32_16x16x32_bf16 v[32:35], v[68:71], v[140:143], v[32:35]
    ds_read_b64_tr_b16 v[66:67], v87 offset:44032
    s_waitcnt vmcnt(8) lgkmcnt(8)
    v_mfma_f32_16x16x32_bf16 v[4:7], v[36:39], v[144:147], v[4:7]
    ds_read_b64_tr_b16 v[68:69], v84 offset:46080
    v_mfma_f32_16x16x32_bf16 v[20:23], v[36:39], v[148:151], v[20:23]
    ds_read_b64_tr_b16 v[70:71], v84 offset:48128
    v_mfma_f32_16x16x32_bf16 v[8:11], v[40:43], v[144:147], v[8:11]
    ds_read_b64_tr_b16 v[36:37], v85 offset:46080
    v_mfma_f32_16x16x32_bf16 v[24:27], v[40:43], v[148:151], v[24:27]
    ds_read_b64_tr_b16 v[38:39], v85 offset:48128
    v_mfma_f32_16x16x32_bf16 v[12:15], v[44:47], v[144:147], v[12:15]
    ds_read_b64_tr_b16 v[40:41], v86 offset:46080
    v_mfma_f32_16x16x32_bf16 v[28:31], v[44:47], v[148:151], v[28:31]
    ds_read_b64_tr_b16 v[42:43], v86 offset:48128
    v_mfma_f32_16x16x32_bf16 v[16:19], v[48:51], v[144:147], v[16:19]
    ds_read_b64_tr_b16 v[44:45], v87 offset:46080
    v_mfma_f32_16x16x32_bf16 v[32:35], v[48:51], v[148:151], v[32:35]
    ds_read_b64_tr_b16 v[46:47], v87 offset:48128
    s_waitcnt vmcnt(6) lgkmcnt(8)
    v_mfma_f32_16x16x32_bf16 v[4:7], v[52:55], v[96:99], v[4:7]
    ds_read_b64_tr_b16 v[48:49], v84 offset:51200
    v_mfma_f32_16x16x32_bf16 v[20:23], v[52:55], v[100:103], v[20:23]
    ds_read_b64_tr_b16 v[50:51], v84 offset:53248
    v_mfma_f32_16x16x32_bf16 v[8:11], v[56:59], v[96:99], v[8:11]
    ds_read_b64_tr_b16 v[52:53], v85 offset:51200
    v_mfma_f32_16x16x32_bf16 v[24:27], v[56:59], v[100:103], v[24:27]
    ds_read_b64_tr_b16 v[54:55], v85 offset:53248
    v_mfma_f32_16x16x32_bf16 v[12:15], v[60:63], v[96:99], v[12:15]
    ds_read_b64_tr_b16 v[56:57], v86 offset:51200
    v_mfma_f32_16x16x32_bf16 v[28:31], v[60:63], v[100:103], v[28:31]
    ds_read_b64_tr_b16 v[58:59], v86 offset:53248
    v_mfma_f32_16x16x32_bf16 v[16:19], v[64:67], v[96:99], v[16:19]
    ds_read_b64_tr_b16 v[60:61], v87 offset:51200
    v_mfma_f32_16x16x32_bf16 v[32:35], v[64:67], v[100:103], v[32:35]
    ds_read_b64_tr_b16 v[62:63], v87 offset:53248
    s_waitcnt vmcnt(4) lgkmcnt(8)
    v_mfma_f32_16x16x32_bf16 v[4:7], v[68:71], v[104:107], v[4:7]
    ds_read_b64_tr_b16 v[64:65], v84 offset:55296
    v_mfma_f32_16x16x32_bf16 v[20:23], v[68:71], v[108:111], v[20:23]
    ds_read_b64_tr_b16 v[66:67], v84 offset:57344
    v_mfma_f32_16x16x32_bf16 v[8:11], v[36:39], v[104:107], v[8:11]
    ds_read_b64_tr_b16 v[68:69], v85 offset:55296
    v_mfma_f32_16x16x32_bf16 v[24:27], v[36:39], v[108:111], v[24:27]
    ds_read_b64_tr_b16 v[70:71], v85 offset:57344
    v_mfma_f32_16x16x32_bf16 v[12:15], v[40:43], v[104:107], v[12:15]
    ds_read_b64_tr_b16 v[36:37], v86 offset:55296
    v_mfma_f32_16x16x32_bf16 v[28:31], v[40:43], v[108:111], v[28:31]
    ds_read_b64_tr_b16 v[38:39], v86 offset:57344
    v_mfma_f32_16x16x32_bf16 v[16:19], v[44:47], v[104:107], v[16:19]
    ds_read_b64_tr_b16 v[40:41], v87 offset:55296
    v_mfma_f32_16x16x32_bf16 v[32:35], v[44:47], v[108:111], v[32:35]
    ds_read_b64_tr_b16 v[42:43], v87 offset:57344
    s_waitcnt vmcnt(2) lgkmcnt(8)
    v_mfma_f32_16x16x32_bf16 v[4:7], v[48:51], v[112:115], v[4:7]
    s_mul_i32 s37, s32, 80896
    s_lshl_b32 s38, s33, 11
    v_mfma_f32_16x16x32_bf16 v[20:23], v[48:51], v[116:119], v[20:23]
    s_add_u32 s37, s37, s38
    s_add_u32 s37, s37, 78848
    v_mfma_f32_16x16x32_bf16 v[8:11], v[52:55], v[112:115], v[8:11]
    v_lshrrev_b32 v1, 5, v0
    v_xor_b32 v1, v1, v0
    v_mfma_f32_16x16x32_bf16 v[24:27], v[52:55], v[116:119], v[24:27]
    v_and_b32 v1, 7, v1
    v_lshl_add_u32 v1, v1, 4, s37
    v_mfma_f32_16x16x32_bf16 v[12:15], v[56:59], v[112:115], v[12:15]
    v_bfe_u32 v2, v0, 4, 1
    v_lshl_add_u32 v1, v2, 3, v1
    v_mfma_f32_16x16x32_bf16 v[28:31], v[56:59], v[116:119], v[28:31]
    v_and_b32 v2, 15, v0
    v_lshl_add_u32 v84, v2, 7, v1
    v_mfma_f32_16x16x32_bf16 v[16:19], v[60:63], v[112:115], v[16:19]
    v_xor_b32 v85, 32, v84
    v_xor_b32 v86, 64, v84
    v_mfma_f32_16x16x32_bf16 v[32:35], v[60:63], v[116:119], v[32:35]
    v_xor_b32 v87, 96, v84
    v_lshrrev_b32 v1, 3, v0
    s_waitcnt vmcnt(0) lgkmcnt(0)
    v_mfma_f32_16x16x32_bf16 v[4:7], v[64:67], v[120:123], v[4:7]
    v_xor_b32 v1, v1, v0
    v_and_b32 v1, 7, v1
    v_mfma_f32_16x16x32_bf16 v[20:23], v[64:67], v[124:127], v[20:23]
    v_and_b32 v2, 56, v0
    v_add_u32 v1, v1, v2
    v_mfma_f32_16x16x32_bf16 v[8:11], v[68:71], v[120:123], v[8:11]
    v_lshl_add_u32 v88, v1, 4, s37
    v_mfma_f32_16x16x32_bf16 v[24:27], v[68:71], v[124:127], v[24:27]
    v_mfma_f32_16x16x32_bf16 v[12:15], v[36:39], v[120:123], v[12:15]
    v_mfma_f32_16x16x32_bf16 v[28:31], v[36:39], v[124:127], v[28:31]
    v_mfma_f32_16x16x32_bf16 v[16:19], v[40:43], v[120:123], v[16:19]
    v_mfma_f32_16x16x32_bf16 v[32:35], v[40:43], v[124:127], v[32:35]
    v_cvt_pk_bf16_f32 v36, v4, v5
    v_cvt_pk_bf16_f32 v37, v6, v7
    ds_write_b64 v84, v[36:37]
    v_cvt_pk_bf16_f32 v38, v8, v9
    v_cvt_pk_bf16_f32 v39, v10, v11
    ds_write_b64 v85, v[38:39]
    v_cvt_pk_bf16_f32 v40, v12, v13
    v_cvt_pk_bf16_f32 v41, v14, v15
    ds_write_b64 v86, v[40:41]
    v_cvt_pk_bf16_f32 v42, v16, v17
    v_cvt_pk_bf16_f32 v43, v18, v19
    ds_write_b64 v87, v[42:43]
    ds_read_b128 v[52:55], v88 offset:0
    ds_read_b128 v[56:59], v88 offset:1024
    v_cvt_pk_bf16_f32 v44, v20, v21
    v_cvt_pk_bf16_f32 v45, v22, v23
    ds_write_b64 v84, v[44:45]
    v_cvt_pk_bf16_f32 v46, v24, v25
    v_cvt_pk_bf16_f32 v47, v26, v27
    ds_write_b64 v85, v[46:47]
    v_cvt_pk_bf16_f32 v48, v28, v29
    v_cvt_pk_bf16_f32 v49, v30, v31
    ds_write_b64 v86, v[48:49]
    v_cvt_pk_bf16_f32 v50, v32, v33
    v_cvt_pk_bf16_f32 v51, v34, v35
    ds_write_b64 v87, v[50:51]
    ds_read_b128 v[60:63], v88 offset:0
    ds_read_b128 v[64:67], v88 offset:1024
    s_mov_b32 s37, 0
    s_waitcnt lgkmcnt(7)
    buffer_store_dwordx4 v[52:55], v226, s[48:51], s37 offen nt
    s_mov_b32 s37, 65536
    s_waitcnt lgkmcnt(6)
    buffer_store_dwordx4 v[56:59], v226, s[48:51], s37 offen nt
    s_mov_b32 s37, 131072
    s_waitcnt lgkmcnt(1)
    buffer_store_dwordx4 v[60:63], v226, s[48:51], s37 offen nt
    s_mov_b32 s37, 196608
    s_waitcnt lgkmcnt(0)
    buffer_store_dwordx4 v[64:67], v226, s[48:51], s37 offen nt
    s_endpgm
L_g1_rare:
    s_waitcnt vmcnt(0)
    s_cmp_lg_u32 s36, 1
    s_cbranch_scc1 L_g1_bar
    v_readfirstlane_b32 s38, v1
    s_nop 0
    s_cmp_ge_u32 s38, 4
    s_cbranch_scc1 L_sl_done_56
    s_mov_b32 s39, 1048576
L_sl_loop_57:
    ds_read_b32 v1, v228 offset:24
    s_waitcnt lgkmcnt(0)
    v_readfirstlane_b32 s38, v1
    s_nop 0
    s_cmp_ge_u32 s38, 4
    s_cbranch_scc1 L_sl_done_56
    s_sleep 1
    s_sub_u32 s39, s39, 1
    s_cbranch_scc0 L_sl_loop_57
L_sl_done_56:
    s_branch L_g1_nobar
L_end:
    s_endpgm
.section .rodata,"a"
.p2align 6
.amdhsa_kernel concat_heads__ssm_conv_h3__sliding_local_dilated__prompt_kernel
  .amdhsa_next_free_vgpr 256
  .amdhsa_next_free_sgpr 102
  .amdhsa_accum_offset 256
  .amdhsa_group_segment_fixed_size 0
  .amdhsa_kernarg_size 96
  .amdhsa_user_sgpr_count 2
  .amdhsa_user_sgpr_kernarg_segment_ptr 1
  .amdhsa_system_sgpr_workgroup_id_x 1
  .amdhsa_float_denorm_mode_32 3
.end_amdhsa_kernel
```

```asm
; @launch grid=(256,1,1) block=(512,1,1) lds=163840
.amdgcn_target "amdgcn-amd-amdhsa--gfx950"
.text
.globl concat_heads__ssm_conv_h3__sliding_local_dilated__prompt_kernel
.p2align 8
.type concat_heads__ssm_conv_h3__sliding_local_dilated__prompt_kernel,@function
concat_heads__ssm_conv_h3__sliding_local_dilated__prompt_kernel:
L_entry:
    s_getpc_b64 s[32:33]
    s_cmp_ge_u32 s2, 256
    s_cbranch_scc1 L_end
    s_load_dwordx16 s[8:23], s[0:1], 0
    s_load_dwordx8 s[24:31], s[0:1], 64
    v_lshrrev_b32 v1, 6, v0
    s_and_b32 s4, s2, 1
    v_readfirstlane_b32 s3, v1
    v_and_b32 v0, 63, v0
    s_bfe_u32 s5, s2, 0x30003
    s_bfe_u32 s6, s2, 0x20001
    s_lshr_b32 s7, s2, 6
    s_lshl2_add_u32 s6, s6, s7
    s_cmp_ge_u32 s3, 4
    s_cbranch_scc1 L_crole
    s_bfe_u32 s34, s2, 0x20003
    s_lshl2_add_u32 s34, s34, s3
    s_lshl_b32 s34, s34, 7
    v_lshl_add_u32 v1, v0, 11, s34
    v_min_u32 v1, L_end-L_entry-8, v1
    s_mov_b64 exec, 0xffff
    global_load_dword v249, v1, s[32:33]
    s_mov_b64 exec, -1
    s_and_b32 s84, s2, 3
    s_lshl2_add_u32 s84, s84, s3
    s_lshr_b32 s85, s2, 2
    s_mul_i32 s86, s3, 8448
    s_add_u32 s86, s86, 125952
    s_lshl_b32 s87, s85, 9
    s_add_u32 s87, s87, s84
    s_lshl_b32 s87, s87, 7
    v_and_b32 v231, 7, v0
    v_lshl_add_u32 v231, v231, 4, s87
    v_lshrrev_b32 v230, 3, v0
    v_lshl_add_u32 v230, v230, 13, v231
    v_subrev_u32 v231, 6144, v230
    v_subrev_u32 v232, 4096, v230
    v_subrev_u32 v233, 2048, v230
    v_add_u32 v234, 4096, v230
    v_lshlrev_b32 v235, 4, v0
    s_lshl_b32 s87, s84, 9
    s_add_u32 m0, s86, 4224
    s_waitcnt lgkmcnt(0)
    s_mov_b32 s80, s14
    s_mov_b32 s81, s15
    s_mov_b32 s82, 0x2000
    s_mov_b32 s83, 0x20000
    s_mov_b32 s72, s10
    s_mov_b32 s73, s11
    s_mov_b32 s74, 0x400000
    s_mov_b32 s75, 0x20000
    s_mov_b32 exec_hi, 0
    buffer_load_dwordx4 v235, s[80:83], s87 offen lds
    s_mov_b64 exec, -1
    buffer_load_dwordx4 v[108:111], v231, s[72:75], 0 offen offset:0 nt
    buffer_load_dwordx4 v[112:115], v232, s[72:75], 0 offen offset:0 nt
    buffer_load_dwordx4 v[116:119], v233, s[72:75], 0 offen offset:0 nt
    buffer_load_dwordx4 v[120:123], v230, s[72:75], 0 offen offset:0 nt
    buffer_load_dwordx4 v[124:127], v230, s[72:75], 0 offen offset:2048 nt
    buffer_load_dwordx4 v[128:131], v234, s[72:75], 0 offen offset:0 nt
    buffer_load_dwordx4 v[132:135], v234, s[72:75], 0 offen offset:2048 nt
    s_mov_b32 s76, s12
    s_mov_b32 s77, s13
    s_mov_b32 s78, 0x400000
    s_mov_b32 s79, 0x20000
    buffer_load_dwordx4 v[136:139], v230, s[76:79], 0 offen offset:0 nt
    buffer_load_dwordx4 v[140:143], v230, s[76:79], 0 offen offset:2048 nt
    buffer_load_dwordx4 v[144:147], v234, s[76:79], 0 offen offset:0 nt
    buffer_load_dwordx4 v[148:151], v234, s[76:79], 0 offen offset:2048 nt
    s_branch L_grole
L_crole:
    s_sub_u32 s70, s3, 4
    s_lshl_b32 s43, s70, 12
    s_lshl_b32 s44, s70, 11
    s_add_u32 s44, s44, 17408
    s_lshl_b32 s49, s70, 4
    s_lshl_b64 s[46:47], 0xffff, s49
    v_lshrrev_b32 v13, 3, v0
    v_and_b32 v14, 7, v0
    v_lshrrev_b32 v15, 4, v0
    s_lshl2_add_u32 s50, s5, s70
    s_lshl_b32 s50, s50, 6
    s_add_u32 s50, s50, s4
    s_lshl_b32 s50, s50, 11
    v_lshl_add_u32 v16, v13, 12, s50
    v_xor_b32 v17, v14, v15
    v_lshl_add_u32 v2, v17, 4, v16
    v_xor_b32 v3, 64, v2
    v_add_u32 v3, 31744, v3
    v_add_u32 v4, 63488, v2
    v_add_u32 v5, 63488, v3
    s_lshl_b32 s49, s5, 7
    s_sub_u32 s49, s49, 8
    s_max_i32 s49, s49, 0
    s_lshl1_add_u32 s49, s49, s4
    s_lshl_b32 s49, s49, 11
    v_lshl_add_u32 v16, v13, 12, s49
    v_lshlrev_b32 v17, 1, v15
    v_xor_b32 v18, v14, v13
    v_lshl_add_u32 v6, v18, 4, v16
    s_mul_i32 s49, s70, 768
    s_add_u32 s49, s49, s6
    s_lshl_b32 s49, s49, 7
    v_mul_u32_u24 v16, 6144, v13
    v_and_b32 v17, 2, v17
    v_xor_b32 v17, v14, v17
    v_lshlrev_b32 v17, 4, v17
    v_add3_u32 v7, v17, v16, s49
    v_xor_b32 v8, 64, v7
    v_add_u32 v8, 48128, v8
    v_add_u32 v9, 2048, v7
    v_add_u32 v10, 2048, v8
    v_add_u32 v11, 4096, v7
    v_add_u32 v12, 4096, v8
    s_movk_i32 s40, 0
    s_mov_b32 s41, 0
    s_lshr_b32 s90, s2, 3
    s_and_b32 s91, s3, 3
    s_lshl2_add_u32 s90, s90, s91
    s_and_b32 s91, s2, 6
    s_lshl3_add_u32 s88, s90, s91
    s_lshl1_add_u32 s88, s88, s4
    s_lshl_b32 s88, s88, 11
    s_and_b32 s89, s2, 7
    s_and_b32 s91, s90, 1
    s_lshl1_add_u32 s89, s89, s91
    s_lshr_b32 s90, s90, 1
    s_mul_i32 s90, s90, 48
    s_add_u32 s89, s89, s90
    s_lshl_b32 s89, s89, 7
    v_and_b32 v251, 1, v0
    v_lshlrev_b32 v251, 12, v251
    v_lshrrev_b32 v252, 1, v0
    v_lshl_add_u32 v251, v252, 7, v251
    v_lshrrev_b32 v250, 2, v0
    v_mul_u32_u24 v250, 393216, v250
    v_and_b32 v252, 3, v0
    v_lshl_add_u32 v252, v252, 11, v250
    s_waitcnt lgkmcnt(0)
    s_mov_b32 s32, s20
    s_mov_b32 s33, s21
    s_mov_b32 s34, 0x400000
    s_mov_b32 s35, 0x20000
    s_mov_b32 s36, s22
    s_mov_b32 s37, s23
    s_mov_b32 s38, 0x600000
    s_mov_b32 s39, 0x20000
    s_setprio 0
    s_and_b32 s73, s2, 7
    s_xor_b32 s73, s73, 2
    s_lshr_b32 s74, s2, 7
    s_lshl1_add_u32 s68, s73, s74
    s_bfe_u32 s69, s2, 0x40003
    s_lshl4_add_u32 s71, s68, s69
    s_lshl2_add_u32 s71, s71, s70
    s_mul_i32 s80, s70, 8448
    s_add_u32 s80, s80, 125952
    s_mul_i32 s81, s70, 9216
    s_add_u32 s81, s81, 41984
    s_add_u32 s52, s30, 0xe00000
    s_addc_u32 s53, s31, 0
    s_mov_b32 s54, 0x20000
    s_mov_b32 s55, 0x20000
    s_add_u32 s64, s30, 0x900000
    s_addc_u32 s65, s31, 0
    s_mov_b32 s66, 0x420000
    s_mov_b32 s67, 0x20000
    s_lshl_b32 s84, s71, 12
    s_mul_i32 s85, s71, 4224
    s_add_u32 s85, s85, 4194304
    s_lshr_b32 s72, s71, 1
    s_lshl_b32 s72, s72, 2
    s_load_dword s72, s[18:19], s72
    v_lshlrev_b32 v224, 4, v0
    v_mov_b32 v228, 0
    v_mov_b32 v229, 0
    v_mov_b32 v230, 0
    v_mov_b32 v231, 0
    v_mov_b32 v227, 134352
    v_mov_b32 v244, 1
    s_bfe_u32 s87, s2, 0x10003
    s_mov_b64 exec, 1
    ds_write_b128 v227, v[228:231]
    ds_write_b128 v227, v[228:231] offset:16
    ds_write_b128 v227, v[228:231] offset:32
    s_mov_b64 exec, -1
    s_mov_b32 exec_lo, 0x7777
    s_mov_b32 exec_hi, 0x0
    s_bfe_u32 s7, s89, 0x30007
    s_cmp_lg_u32 s7, 1
    s_cbranch_scc1 L_wx3_1
    buffer_load_dword v250, v252, s[36:39], s89 offen offset:256
L_wx3_1:
    buffer_load_dword v250, v252, s[36:39], s89 offen
    s_mov_b32 exec_lo, 0xff
    s_mov_b32 exec_hi, 0
    buffer_load_dword v250, v251, s[32:35], s88 offen
    s_mov_b64 exec, -1
    s_add_u32 m0, s43, 0
    s_nop 0
    buffer_load_dwordx4 v2, s[32:35], s40 offen offset:0 lds
    s_add_u32 m0, s44, 0
    s_nop 0
    buffer_load_dwordx4 v7, s[36:39], s41 offen offset:0 lds
    buffer_load_dwordx4 v8, s[36:39], s41 offen offset:1024 lds
    s_add_u32 m0, s43, 0
    s_nop 0
    buffer_load_dwordx4 v3, s[32:35], s40 offen offset:1024 lds
    s_add_u32 m0, s44, 8192
    s_nop 0
    buffer_load_dwordx4 v9, s[36:39], s41 offen offset:0 lds
    buffer_load_dwordx4 v10, s[36:39], s41 offen offset:1024 lds
    s_add_u32 m0, s43, 0
    s_nop 0
    buffer_load_dwordx4 v4, s[32:35], s40 offen offset:2048 lds
    s_add_u32 m0, s44, 16384
    s_nop 0
    buffer_load_dwordx4 v11, s[36:39], s41 offen offset:0 lds
    buffer_load_dwordx4 v12, s[36:39], s41 offen offset:1024 lds
    s_add_u32 m0, s43, 0
    s_nop 0
    buffer_load_dwordx4 v5, s[32:35], s40 offen offset:3072 lds
    s_mov_b32 m0, 16384
    s_mov_b64 exec, s[46:47]
    buffer_load_dwordx4 v6, s[32:35], s40 offen lds
    s_mov_b64 exec, -1
    s_movk_i32 s40, 128
    s_mov_b32 s41, 393216
    s_add_u32 m0, s43, 41984
    s_nop 0
    buffer_load_dwordx4 v2, s[32:35], s40 offen offset:0 lds
    s_add_u32 m0, s44, 41984
    s_nop 0
    buffer_load_dwordx4 v7, s[36:39], s41 offen offset:0 lds
    buffer_load_dwordx4 v8, s[36:39], s41 offen offset:1024 lds
    s_add_u32 m0, s43, 41984
    s_nop 0
    buffer_load_dwordx4 v3, s[32:35], s40 offen offset:1024 lds
    s_add_u32 m0, s44, 50176
    s_nop 0
    buffer_load_dwordx4 v9, s[36:39], s41 offen offset:0 lds
    buffer_load_dwordx4 v10, s[36:39], s41 offen offset:1024 lds
    s_add_u32 m0, s43, 41984
    s_nop 0
    buffer_load_dwordx4 v4, s[32:35], s40 offen offset:2048 lds
    s_add_u32 m0, s44, 58368
    s_nop 0
    buffer_load_dwordx4 v11, s[36:39], s41 offen offset:0 lds
    buffer_load_dwordx4 v12, s[36:39], s41 offen offset:1024 lds
    s_add_u32 m0, s43, 41984
    s_nop 0
    buffer_load_dwordx4 v5, s[32:35], s40 offen offset:3072 lds
    s_mov_b32 m0, 58368
    s_mov_b64 exec, s[46:47]
    buffer_load_dwordx4 v6, s[32:35], s40 offen lds
    s_mov_b64 exec, -1
    s_movk_i32 s40, 256
    s_mov_b32 s41, 786432
    s_lshr_b32 s74, s69, 2
    s_and_b32 s75, s69, 3
    s_lshl3_add_u32 s74, s74, s75
    s_lshl3_add_u32 s74, s74, s70
    s_lshl_b32 s74, s74, 3
    v_bfe_u32 v234, v0, 3, 1
    v_lshl_add_u32 v225, v234, 8, s74
    v_bfe_u32 v234, v0, 4, 1
    v_lshl_add_u32 v225, v234, 1, v225
    v_lshrrev_b32 v234, 5, v0
    v_lshl_add_u32 v225, v234, 5, v225
    s_lshl_b32 s74, s68, 7
    v_and_b32 v234, 7, v0
    v_lshl_add_u32 v234, v234, 4, s74
    v_lshl_add_u32 v226, v225, 12, v234
    v_lshl_add_u32 v225, v225, 11, v234
    v_and_b32 v234, 1, v0
    v_xor_b32 v234, 1, v234
    v_mul_u32_u24 v232, 4224, v234
    v_mul_u32_u24 v233, 4576, v234
    v_bfe_u32 v234, v0, 1, 3
    v_lshl_add_u32 v232, v234, 3, v232
    v_xor_b32 v234, 7, v234
    v_lshl_add_u32 v233, v234, 6, v233
    v_lshrrev_b32 v234, 4, v0
    v_lshl_add_u32 v232, v234, 4, v232
    v_lshl_add_u32 v233, v234, 4, v233
    v_add3_u32 v232, v232, s80, 8
    v_add_u32 v233, s81, v233
    s_waitcnt lgkmcnt(0)
    s_bitcmp1_b32 s71, 0
    s_cselect_b32 s74, 0, 16
    s_lshl_b32 s72, s72, s74
    s_and_b32 s72, s72, 0xffff0000
    v_and_b32 v235, 1, v0
    v_lshlrev_b32 v235, 4, v235
    v_lshrrev_b32 v235, v235, s72
    v_bfe_u32 v236, v0, 1, 3
    v_lshl_add_u32 v236, v234, 1, v236
    v_cmp_eq_u32 vcc, 7, v236
    v_mov_b32 v241, 0
    v_mov_b32 v243, 0
    v_cndmask_b32 v240, 0, v235, vcc
    v_cmp_eq_u32 vcc, 6, v236
    s_nop 1
    v_cndmask_b32 v242, 0, v235, vcc
    s_waitcnt vmcnt(11)
    s_barrier
    s_add_u32 m0, s43, 83968
    s_nop 0
    buffer_load_dwordx4 v2, s[32:35], s40 offen offset:0 lds
    s_add_u32 m0, s44, 83968
    s_nop 0
    buffer_load_dwordx4 v7, s[36:39], s41 offen offset:0 lds
    buffer_load_dwordx4 v8, s[36:39], s41 offen offset:1024 lds
    s_add_u32 m0, s43, 83968
    s_nop 0
    buffer_load_dwordx4 v3, s[32:35], s40 offen offset:1024 lds
    s_add_u32 m0, s44, 92160
    s_nop 0
    buffer_load_dwordx4 v9, s[36:39], s41 offen offset:0 lds
    buffer_load_dwordx4 v10, s[36:39], s41 offen offset:1024 lds
    s_add_u32 m0, s43, 83968
    s_nop 0
    buffer_load_dwordx4 v4, s[32:35], s40 offen offset:2048 lds
    s_add_u32 m0, s44, 100352
    s_nop 0
    buffer_load_dwordx4 v11, s[36:39], s41 offen offset:0 lds
    buffer_load_dwordx4 v12, s[36:39], s41 offen offset:1024 lds
    s_add_u32 m0, s43, 83968
    s_nop 0
    buffer_load_dwordx4 v5, s[32:35], s40 offen offset:3072 lds
    s_mov_b32 m0, 100352
    s_mov_b64 exec, s[46:47]
    buffer_load_dwordx4 v6, s[32:35], s40 offen lds
    s_mov_b64 exec, -1
    s_movk_i32 s40, 384
    s_mov_b32 s41, 1179648
    s_waitcnt vmcnt(11)
    s_barrier
    s_add_u32 m0, s43, 0
    s_nop 0
    buffer_load_dwordx4 v2, s[32:35], s40 offen offset:0 lds
    s_add_u32 m0, s44, 0
    s_nop 0
    buffer_load_dwordx4 v7, s[36:39], s41 offen offset:0 lds
    buffer_load_dwordx4 v8, s[36:39], s41 offen offset:1024 lds
    s_add_u32 m0, s43, 0
    s_nop 0
    buffer_load_dwordx4 v3, s[32:35], s40 offen offset:1024 lds
    s_add_u32 m0, s44, 8192
    s_nop 0
    buffer_load_dwordx4 v9, s[36:39], s41 offen offset:0 lds
    buffer_load_dwordx4 v10, s[36:39], s41 offen offset:1024 lds
    s_add_u32 m0, s43, 0
    s_nop 0
    buffer_load_dwordx4 v4, s[32:35], s40 offen offset:2048 lds
    s_add_u32 m0, s44, 16384
    s_nop 0
    buffer_load_dwordx4 v11, s[36:39], s41 offen offset:0 lds
    buffer_load_dwordx4 v12, s[36:39], s41 offen offset:1024 lds
    s_add_u32 m0, s43, 0
    s_nop 0
    buffer_load_dwordx4 v5, s[32:35], s40 offen offset:3072 lds
    s_mov_b32 m0, 16384
    s_mov_b64 exec, s[46:47]
    buffer_load_dwordx4 v6, s[32:35], s40 offen lds
    s_mov_b64 exec, -1
    s_movk_i32 s40, 512
    s_mov_b32 s41, 1572864
    s_mov_b32 exec_lo, 0x77770000
    s_mov_b32 exec_hi, 0x0
    s_bfe_u32 s7, s89, 0x30007
    s_cmp_lg_u32 s7, 1
    s_cbranch_scc1 L_wx3_4
    buffer_load_dword v250, v252, s[36:39], s89 offen offset:256
L_wx3_4:
    buffer_load_dword v250, v252, s[36:39], s89 offen
    s_mov_b32 exec_lo, 0xff00
    s_mov_b32 exec_hi, 0
    buffer_load_dword v250, v251, s[32:35], s88 offen
    s_mov_b64 exec, -1
    s_waitcnt vmcnt(13)
    s_barrier
    s_add_u32 m0, s43, 41984
    s_nop 0
    buffer_load_dwordx4 v2, s[32:35], s40 offen offset:0 lds
    s_add_u32 m0, s44, 41984
    s_nop 0
    buffer_load_dwordx4 v7, s[36:39], s41 offen offset:0 lds
    buffer_load_dwordx4 v8, s[36:39], s41 offen offset:1024 lds
    s_add_u32 m0, s43, 41984
    s_nop 0
    buffer_load_dwordx4 v3, s[32:35], s40 offen offset:1024 lds
    s_add_u32 m0, s44, 50176
    s_nop 0
    buffer_load_dwordx4 v9, s[36:39], s41 offen offset:0 lds
    buffer_load_dwordx4 v10, s[36:39], s41 offen offset:1024 lds
    s_add_u32 m0, s43, 41984
    s_nop 0
    buffer_load_dwordx4 v4, s[32:35], s40 offen offset:2048 lds
    s_add_u32 m0, s44, 58368
    s_nop 0
    buffer_load_dwordx4 v11, s[36:39], s41 offen offset:0 lds
    buffer_load_dwordx4 v12, s[36:39], s41 offen offset:1024 lds
    s_add_u32 m0, s43, 41984
    s_nop 0
    buffer_load_dwordx4 v5, s[32:35], s40 offen offset:3072 lds
    s_mov_b32 m0, 58368
    s_mov_b64 exec, s[46:47]
    buffer_load_dwordx4 v6, s[32:35], s40 offen lds
    s_mov_b64 exec, -1
    s_movk_i32 s40, 640
    s_mov_b32 s41, 1966080
    s_waitcnt vmcnt(13)
    s_barrier
    s_add_u32 m0, s43, 83968
    s_nop 0
    buffer_load_dwordx4 v2, s[32:35], s40 offen offset:0 lds
    s_add_u32 m0, s44, 83968
    s_nop 0
    buffer_load_dwordx4 v7, s[36:39], s41 offen offset:0 lds
    buffer_load_dwordx4 v8, s[36:39], s41 offen offset:1024 lds
    s_add_u32 m0, s43, 83968
    s_nop 0
    buffer_load_dwordx4 v3, s[32:35], s40 offen offset:1024 lds
    s_add_u32 m0, s44, 92160
    s_nop 0
    buffer_load_dwordx4 v9, s[36:39], s41 offen offset:0 lds
    buffer_load_dwordx4 v10, s[36:39], s41 offen offset:1024 lds
    s_add_u32 m0, s43, 83968
    s_nop 0
    buffer_load_dwordx4 v4, s[32:35], s40 offen offset:2048 lds
    s_add_u32 m0, s44, 100352
    s_nop 0
    buffer_load_dwordx4 v11, s[36:39], s41 offen offset:0 lds
    buffer_load_dwordx4 v12, s[36:39], s41 offen offset:1024 lds
    s_add_u32 m0, s43, 83968
    s_nop 0
    buffer_load_dwordx4 v5, s[32:35], s40 offen offset:3072 lds
    s_mov_b32 m0, 100352
    s_mov_b64 exec, s[46:47]
    buffer_load_dwordx4 v6, s[32:35], s40 offen lds
    s_mov_b64 exec, -1
    s_movk_i32 s40, 768
    s_mov_b32 s41, 2359296
    s_cmp_lg_u32 s87, 0
    s_cbranch_scc1 L_stg_7
    s_mov_b32 exec_lo, 0x0
    s_mov_b32 exec_hi, 0x7777
    s_bfe_u32 s7, s89, 0x30007
    s_cmp_lg_u32 s7, 1
    s_cbranch_scc1 L_wx3_8
    buffer_load_dword v250, v252, s[36:39], s89 offen offset:256
L_wx3_8:
    buffer_load_dword v250, v252, s[36:39], s89 offen
    s_mov_b32 exec_lo, 0xff0000
    s_mov_b32 exec_hi, 0
    buffer_load_dword v250, v251, s[32:35], s88 offen
    s_mov_b64 exec, -1
L_stg_7:
    s_waitcnt vmcnt(13)
    s_bitcmp1_b32 1, s87
    s_cbranch_scc1 L_mw_9
    s_waitcnt vmcnt(11)
L_mw_9:
    s_barrier
    s_add_u32 m0, s43, 0
    s_nop 0
    buffer_load_dwordx4 v2, s[32:35], s40 offen offset:0 lds
    s_add_u32 m0, s44, 0
    s_nop 0
    buffer_load_dwordx4 v7, s[36:39], s41 offen offset:0 lds
    buffer_load_dwordx4 v8, s[36:39], s41 offen offset:1024 lds
    s_add_u32 m0, s43, 0
    s_nop 0
    buffer_load_dwordx4 v3, s[32:35], s40 offen offset:1024 lds
    s_add_u32 m0, s44, 8192
    s_nop 0
    buffer_load_dwordx4 v9, s[36:39], s41 offen offset:0 lds
    buffer_load_dwordx4 v10, s[36:39], s41 offen offset:1024 lds
    s_add_u32 m0, s43, 0
    s_nop 0
    buffer_load_dwordx4 v4, s[32:35], s40 offen offset:2048 lds
    s_add_u32 m0, s44, 16384
    s_nop 0
    buffer_load_dwordx4 v11, s[36:39], s41 offen offset:0 lds
    buffer_load_dwordx4 v12, s[36:39], s41 offen offset:1024 lds
    s_add_u32 m0, s43, 0
    s_nop 0
    buffer_load_dwordx4 v5, s[32:35], s40 offen offset:3072 lds
    s_mov_b32 m0, 16384
    s_mov_b64 exec, s[46:47]
    buffer_load_dwordx4 v6, s[32:35], s40 offen lds
    s_mov_b64 exec, -1
    s_movk_i32 s40, 896
    s_mov_b32 s41, 2752512
    s_cmp_lg_u32 s87, 1
    s_cbranch_scc1 L_stg_10
    s_mov_b32 exec_lo, 0x0
    s_mov_b32 exec_hi, 0x7777
    s_bfe_u32 s7, s89, 0x30007
    s_cmp_lg_u32 s7, 1
    s_cbranch_scc1 L_wx3_11
    buffer_load_dword v250, v252, s[36:39], s89 offen offset:256
L_wx3_11:
    buffer_load_dword v250, v252, s[36:39], s89 offen
    s_mov_b32 exec_lo, 0xff0000
    s_mov_b32 exec_hi, 0
    buffer_load_dword v250, v251, s[32:35], s88 offen
    s_mov_b64 exec, -1
L_stg_10:
    s_bfe_u32 s74, s2, 0x20003
    s_lshl2_add_u32 s74, s74, s70
    s_cmp_lg_u32 s74, 0
    s_cbranch_scc1 L_sig_12
    s_mov_b32 s60, s28
    s_mov_b32 s61, s29
    s_mov_b32 s62, 0x100
    s_mov_b32 s63, 0x20000
    s_and_b32 s74, s2, 3
    s_lshl_b32 s74, s74, 6
    s_mov_b64 exec, 1
    buffer_atomic_add v244, off, s[60:63], s74 sc1
    s_mov_b64 exec, -1
L_sig_12:
    s_load_dwordx2 s[90:91], s[16:17], s84 offset:60
    s_load_dwordx2 s[90:91], s[16:17], s84 offset:188
    s_load_dwordx2 s[90:91], s[16:17], s84 offset:316
    s_load_dwordx2 s[90:91], s[16:17], s84 offset:444
    s_waitcnt vmcnt(13)
    s_barrier
    s_add_u32 m0, s43, 41984
    s_nop 0
    buffer_load_dwordx4 v2, s[32:35], s40 offen offset:0 lds
    s_add_u32 m0, s44, 41984
    s_nop 0
    buffer_load_dwordx4 v7, s[36:39], s41 offen offset:0 lds
    buffer_load_dwordx4 v8, s[36:39], s41 offen offset:1024 lds
    s_add_u32 m0, s43, 41984
    s_nop 0
    buffer_load_dwordx4 v3, s[32:35], s40 offen offset:1024 lds
    s_add_u32 m0, s44, 50176
    s_nop 0
    buffer_load_dwordx4 v9, s[36:39], s41 offen offset:0 lds
    buffer_load_dwordx4 v10, s[36:39], s41 offen offset:1024 lds
    s_add_u32 m0, s43, 41984
    s_nop 0
    buffer_load_dwordx4 v4, s[32:35], s40 offen offset:2048 lds
    s_add_u32 m0, s44, 58368
    s_nop 0
    buffer_load_dwordx4 v11, s[36:39], s41 offen offset:0 lds
    buffer_load_dwordx4 v12, s[36:39], s41 offen offset:1024 lds
    s_add_u32 m0, s43, 41984
    s_nop 0
    buffer_load_dwordx4 v5, s[32:35], s40 offen offset:3072 lds
    s_mov_b32 m0, 58368
    s_mov_b64 exec, s[46:47]
    buffer_load_dwordx4 v6, s[32:35], s40 offen lds
    s_mov_b64 exec, -1
    s_movk_i32 s40, 1024
    s_mov_b32 s41, 3145728
    s_bfe_u32 s74, s2, 0x20003
    s_lshl2_add_u32 s74, s74, s70
    s_cmp_lg_u32 s74, 4
    s_cbranch_scc1 L_sig_14
    s_mov_b32 s60, s28
    s_mov_b32 s61, s29
    s_mov_b32 s62, 0x100
    s_mov_b32 s63, 0x20000
    s_and_b32 s74, s2, 3
    s_lshl_b32 s74, s74, 6
    s_mov_b64 exec, 1
    buffer_atomic_add v244, off, s[60:63], s74 sc1
    s_mov_b64 exec, -1
L_sig_14:
    s_load_dwordx2 s[90:91], s[16:17], s84 offset:572
    s_load_dwordx2 s[90:91], s[16:17], s84 offset:700
    s_load_dwordx2 s[90:91], s[16:17], s84 offset:828
    s_load_dwordx2 s[90:91], s[16:17], s84 offset:956
    s_waitcnt vmcnt(13)
    s_bitcmp1_b32 2, s87
    s_cbranch_scc1 L_mw_15
    s_waitcnt vmcnt(11)
L_mw_15:
    s_barrier
    s_add_u32 m0, s43, 83968
    s_nop 0
    buffer_load_dwordx4 v2, s[32:35], s40 offen offset:0 lds
    s_add_u32 m0, s44, 83968
    s_nop 0
    buffer_load_dwordx4 v7, s[36:39], s41 offen offset:0 lds
    buffer_load_dwordx4 v8, s[36:39], s41 offen offset:1024 lds
    s_add_u32 m0, s43, 83968
    s_nop 0
    buffer_load_dwordx4 v3, s[32:35], s40 offen offset:1024 lds
    s_add_u32 m0, s44, 92160
    s_nop 0
    buffer_load_dwordx4 v9, s[36:39], s41 offen offset:0 lds
    buffer_load_dwordx4 v10, s[36:39], s41 offen offset:1024 lds
    s_add_u32 m0, s43, 83968
    s_nop 0
    buffer_load_dwordx4 v4, s[32:35], s40 offen offset:2048 lds
    s_add_u32 m0, s44, 100352
    s_nop 0
    buffer_load_dwordx4 v11, s[36:39], s41 offen offset:0 lds
    buffer_load_dwordx4 v12, s[36:39], s41 offen offset:1024 lds
    s_add_u32 m0, s43, 83968
    s_nop 0
    buffer_load_dwordx4 v5, s[32:35], s40 offen offset:3072 lds
    s_mov_b32 m0, 100352
    s_mov_b64 exec, s[46:47]
    buffer_load_dwordx4 v6, s[32:35], s40 offen lds
    s_mov_b64 exec, -1
    s_movk_i32 s40, 1152
    s_mov_b32 s41, 3538944
    s_bfe_u32 s74, s2, 0x20003
    s_lshl2_add_u32 s74, s74, s70
    s_cmp_lg_u32 s74, 8
    s_cbranch_scc1 L_sig_16
    s_mov_b32 s60, s28
    s_mov_b32 s61, s29
    s_mov_b32 s62, 0x100
    s_mov_b32 s63, 0x20000
    s_and_b32 s74, s2, 3
    s_lshl_b32 s74, s74, 6
    s_mov_b64 exec, 1
    buffer_atomic_add v244, off, s[60:63], s74 sc1
    s_mov_b64 exec, -1
L_sig_16:
    s_load_dwordx2 s[90:91], s[16:17], s84 offset:1084
    s_load_dwordx2 s[90:91], s[16:17], s84 offset:1212
    s_load_dwordx2 s[90:91], s[16:17], s84 offset:1340
    s_load_dwordx2 s[90:91], s[16:17], s84 offset:1468
    s_waitcnt vmcnt(11)
    s_barrier
    s_add_u32 m0, s43, 0
    s_nop 0
    buffer_load_dwordx4 v2, s[32:35], s40 offen offset:0 lds
    s_add_u32 m0, s44, 0
    s_nop 0
    buffer_load_dwordx4 v7, s[36:39], s41 offen offset:0 lds
    buffer_load_dwordx4 v8, s[36:39], s41 offen offset:1024 lds
    s_add_u32 m0, s43, 0
    s_nop 0
    buffer_load_dwordx4 v3, s[32:35], s40 offen offset:1024 lds
    s_add_u32 m0, s44, 8192
    s_nop 0
    buffer_load_dwordx4 v9, s[36:39], s41 offen offset:0 lds
    buffer_load_dwordx4 v10, s[36:39], s41 offen offset:1024 lds
    s_add_u32 m0, s43, 0
    s_nop 0
    buffer_load_dwordx4 v4, s[32:35], s40 offen offset:2048 lds
    s_add_u32 m0, s44, 16384
    s_nop 0
    buffer_load_dwordx4 v11, s[36:39], s41 offen offset:0 lds
    buffer_load_dwordx4 v12, s[36:39], s41 offen offset:1024 lds
    s_add_u32 m0, s43, 0
    s_nop 0
    buffer_load_dwordx4 v5, s[32:35], s40 offen offset:3072 lds
    s_mov_b32 m0, 16384
    s_mov_b64 exec, s[46:47]
    buffer_load_dwordx4 v6, s[32:35], s40 offen lds
    s_mov_b64 exec, -1
    s_movk_i32 s40, 1280
    s_mov_b32 s41, 3932160
    s_cmp_lg_u32 s87, 0
    s_cbranch_scc1 L_stg_18
    s_mov_b32 exec_lo, 0x0
    s_mov_b32 exec_hi, 0x77770000
    s_bfe_u32 s7, s89, 0x30007
    s_cmp_lg_u32 s7, 1
    s_cbranch_scc1 L_wx3_19
    buffer_load_dword v250, v252, s[36:39], s89 offen offset:256
L_wx3_19:
    buffer_load_dword v250, v252, s[36:39], s89 offen
    s_mov_b32 exec_lo, 0xff000000
    s_mov_b32 exec_hi, 0
    buffer_load_dword v250, v251, s[32:35], s88 offen
    s_mov_b64 exec, -1
L_stg_18:
    s_bfe_u32 s74, s2, 0x20003
    s_lshl2_add_u32 s74, s74, s70
    s_cmp_lg_u32 s74, 12
    s_cbranch_scc1 L_sig_20
    s_mov_b32 s60, s28
    s_mov_b32 s61, s29
    s_mov_b32 s62, 0x100
    s_mov_b32 s63, 0x20000
    s_and_b32 s74, s2, 3
    s_lshl_b32 s74, s74, 6
    s_mov_b64 exec, 1
    buffer_atomic_add v244, off, s[60:63], s74 sc1
    s_mov_b64 exec, -1
L_sig_20:
    s_load_dwordx2 s[90:91], s[16:17], s84 offset:1596
    s_load_dwordx2 s[90:91], s[16:17], s84 offset:1724
    s_load_dwordx2 s[90:91], s[16:17], s84 offset:1852
    s_load_dwordx2 s[90:91], s[16:17], s84 offset:1980
    s_waitcnt vmcnt(13)
    s_bitcmp1_b32 1, s87
    s_cbranch_scc1 L_mw_21
    s_waitcnt vmcnt(11)
L_mw_21:
    s_barrier
    s_add_u32 m0, s43, 41984
    s_nop 0
    buffer_load_dwordx4 v2, s[32:35], s40 offen offset:0 lds
    s_add_u32 m0, s44, 41984
    s_nop 0
    buffer_load_dwordx4 v7, s[36:39], s41 offen offset:0 lds
    buffer_load_dwordx4 v8, s[36:39], s41 offen offset:1024 lds
    s_add_u32 m0, s43, 41984
    s_nop 0
    buffer_load_dwordx4 v3, s[32:35], s40 offen offset:1024 lds
    s_add_u32 m0, s44, 50176
    s_nop 0
    buffer_load_dwordx4 v9, s[36:39], s41 offen offset:0 lds
    buffer_load_dwordx4 v10, s[36:39], s41 offen offset:1024 lds
    s_add_u32 m0, s43, 41984
    s_nop 0
    buffer_load_dwordx4 v4, s[32:35], s40 offen offset:2048 lds
    s_add_u32 m0, s44, 58368
    s_nop 0
    buffer_load_dwordx4 v11, s[36:39], s41 offen offset:0 lds
    buffer_load_dwordx4 v12, s[36:39], s41 offen offset:1024 lds
    s_add_u32 m0, s43, 41984
    s_nop 0
    buffer_load_dwordx4 v5, s[32:35], s40 offen offset:3072 lds
    s_mov_b32 m0, 58368
    s_mov_b64 exec, s[46:47]
    buffer_load_dwordx4 v6, s[32:35], s40 offen lds
    s_mov_b64 exec, -1
    s_movk_i32 s40, 1408
    s_mov_b32 s41, 4325376
    s_cmp_lg_u32 s87, 1
    s_cbranch_scc1 L_stg_22
    s_mov_b32 exec_lo, 0x0
    s_mov_b32 exec_hi, 0x77770000
    s_bfe_u32 s7, s89, 0x30007
    s_cmp_lg_u32 s7, 1
    s_cbranch_scc1 L_wx3_23
    buffer_load_dword v250, v252, s[36:39], s89 offen offset:256
L_wx3_23:
    buffer_load_dword v250, v252, s[36:39], s89 offen
    s_mov_b32 exec_lo, 0xff000000
    s_mov_b32 exec_hi, 0
    buffer_load_dword v250, v251, s[32:35], s88 offen
    s_mov_b64 exec, -1
L_stg_22:
    s_load_dwordx2 s[90:91], s[16:17], s84 offset:2108
    s_load_dwordx2 s[90:91], s[16:17], s84 offset:2236
    s_load_dwordx2 s[90:91], s[16:17], s84 offset:2364
    s_load_dwordx2 s[90:91], s[16:17], s84 offset:2492
    s_waitcnt vmcnt(13)
    s_barrier
    s_add_u32 m0, s43, 83968
    s_nop 0
    buffer_load_dwordx4 v2, s[32:35], s40 offen offset:0 lds
    s_add_u32 m0, s44, 83968
    s_nop 0
    buffer_load_dwordx4 v7, s[36:39], s41 offen offset:0 lds
    buffer_load_dwordx4 v8, s[36:39], s41 offen offset:1024 lds
    s_add_u32 m0, s43, 83968
    s_nop 0
    buffer_load_dwordx4 v3, s[32:35], s40 offen offset:1024 lds
    s_add_u32 m0, s44, 92160
    s_nop 0
    buffer_load_dwordx4 v9, s[36:39], s41 offen offset:0 lds
    buffer_load_dwordx4 v10, s[36:39], s41 offen offset:1024 lds
    s_add_u32 m0, s43, 83968
    s_nop 0
    buffer_load_dwordx4 v4, s[32:35], s40 offen offset:2048 lds
    s_add_u32 m0, s44, 100352
    s_nop 0
    buffer_load_dwordx4 v11, s[36:39], s41 offen offset:0 lds
    buffer_load_dwordx4 v12, s[36:39], s41 offen offset:1024 lds
    s_add_u32 m0, s43, 83968
    s_nop 0
    buffer_load_dwordx4 v5, s[32:35], s40 offen offset:3072 lds
    s_mov_b32 m0, 100352
    s_mov_b64 exec, s[46:47]
    buffer_load_dwordx4 v6, s[32:35], s40 offen lds
    s_mov_b64 exec, -1
    s_movk_i32 s40, 1536
    s_mov_b32 s41, 4718592
    s_load_dwordx2 s[90:91], s[16:17], s84 offset:2620
    s_load_dwordx2 s[90:91], s[16:17], s84 offset:2748
    s_load_dwordx2 s[90:91], s[16:17], s84 offset:2876
    s_load_dwordx2 s[90:91], s[16:17], s84 offset:3004
    s_waitcnt vmcnt(13)
    s_bitcmp1_b32 2, s87
    s_cbranch_scc1 L_mw_25
    s_waitcnt vmcnt(11)
L_mw_25:
    s_barrier
    s_add_u32 m0, s43, 0
    s_nop 0
    buffer_load_dwordx4 v2, s[32:35], s40 offen offset:0 lds
    s_add_u32 m0, s44, 0
    s_nop 0
    buffer_load_dwordx4 v7, s[36:39], s41 offen offset:0 lds
    buffer_load_dwordx4 v8, s[36:39], s41 offen offset:1024 lds
    s_add_u32 m0, s43, 0
    s_nop 0
    buffer_load_dwordx4 v3, s[32:35], s40 offen offset:1024 lds
    s_add_u32 m0, s44, 8192
    s_nop 0
    buffer_load_dwordx4 v9, s[36:39], s41 offen offset:0 lds
    buffer_load_dwordx4 v10, s[36:39], s41 offen offset:1024 lds
    s_add_u32 m0, s43, 0
    s_nop 0
    buffer_load_dwordx4 v4, s[32:35], s40 offen offset:2048 lds
    s_add_u32 m0, s44, 16384
    s_nop 0
    buffer_load_dwordx4 v11, s[36:39], s41 offen offset:0 lds
    buffer_load_dwordx4 v12, s[36:39], s41 offen offset:1024 lds
    s_add_u32 m0, s43, 0
    s_nop 0
    buffer_load_dwordx4 v5, s[32:35], s40 offen offset:3072 lds
    s_mov_b32 m0, 16384
    s_mov_b64 exec, s[46:47]
    buffer_load_dwordx4 v6, s[32:35], s40 offen lds
    s_mov_b64 exec, -1
    s_movk_i32 s40, 1664
    s_mov_b32 s41, 5111808
    s_load_dwordx2 s[90:91], s[16:17], s84 offset:3132
    s_load_dwordx2 s[90:91], s[16:17], s84 offset:3260
    s_load_dwordx2 s[90:91], s[16:17], s84 offset:3388
    s_load_dwordx2 s[90:91], s[16:17], s84 offset:3516
    s_waitcnt vmcnt(11)
    s_barrier
    s_add_u32 m0, s43, 41984
    s_nop 0
    buffer_load_dwordx4 v2, s[32:35], s40 offen offset:0 lds
    s_add_u32 m0, s44, 41984
    s_nop 0
    buffer_load_dwordx4 v7, s[36:39], s41 offen offset:0 lds
    buffer_load_dwordx4 v8, s[36:39], s41 offen offset:1024 lds
    s_add_u32 m0, s43, 41984
    s_nop 0
    buffer_load_dwordx4 v3, s[32:35], s40 offen offset:1024 lds
    s_add_u32 m0, s44, 50176
    s_nop 0
    buffer_load_dwordx4 v9, s[36:39], s41 offen offset:0 lds
    buffer_load_dwordx4 v10, s[36:39], s41 offen offset:1024 lds
    s_add_u32 m0, s43, 41984
    s_nop 0
    buffer_load_dwordx4 v4, s[32:35], s40 offen offset:2048 lds
    s_add_u32 m0, s44, 58368
    s_nop 0
    buffer_load_dwordx4 v11, s[36:39], s41 offen offset:0 lds
    buffer_load_dwordx4 v12, s[36:39], s41 offen offset:1024 lds
    s_add_u32 m0, s43, 41984
    s_nop 0
    buffer_load_dwordx4 v5, s[32:35], s40 offen offset:3072 lds
    s_mov_b32 m0, 58368
    s_mov_b64 exec, s[46:47]
    buffer_load_dwordx4 v6, s[32:35], s40 offen lds
    s_mov_b64 exec, -1
    s_movk_i32 s40, 1792
    s_mov_b32 s41, 5505024
    s_load_dwordx2 s[90:91], s[16:17], s84 offset:3644
    s_load_dwordx2 s[90:91], s[16:17], s84 offset:3772
    s_load_dwordx2 s[90:91], s[16:17], s84 offset:3900
    s_load_dwordx2 s[90:91], s[16:17], s84 offset:4028
    s_waitcnt vmcnt(11)
    s_barrier
    s_add_u32 m0, s43, 83968
    s_nop 0
    buffer_load_dwordx4 v2, s[32:35], s40 offen offset:0 lds
    s_add_u32 m0, s44, 83968
    s_nop 0
    buffer_load_dwordx4 v7, s[36:39], s41 offen offset:0 lds
    buffer_load_dwordx4 v8, s[36:39], s41 offen offset:1024 lds
    s_add_u32 m0, s43, 83968
    s_nop 0
    buffer_load_dwordx4 v3, s[32:35], s40 offen offset:1024 lds
    s_add_u32 m0, s44, 92160
    s_nop 0
    buffer_load_dwordx4 v9, s[36:39], s41 offen offset:0 lds
    buffer_load_dwordx4 v10, s[36:39], s41 offen offset:1024 lds
    s_add_u32 m0, s43, 83968
    s_nop 0
    buffer_load_dwordx4 v4, s[32:35], s40 offen offset:2048 lds
    s_add_u32 m0, s44, 100352
    s_nop 0
    buffer_load_dwordx4 v11, s[36:39], s41 offen offset:0 lds
    buffer_load_dwordx4 v12, s[36:39], s41 offen offset:1024 lds
    s_add_u32 m0, s43, 83968
    s_nop 0
    buffer_load_dwordx4 v5, s[32:35], s40 offen offset:3072 lds
    s_mov_b32 m0, 100352
    s_mov_b64 exec, s[46:47]
    buffer_load_dwordx4 v6, s[32:35], s40 offen lds
    s_mov_b64 exec, -1
    s_movk_i32 s40, 1920
    s_mov_b32 s41, 5898240
    s_waitcnt vmcnt(11)
    s_barrier
    s_load_dword s4, s[28:29], 0
    s_load_dword s5, s[28:29], 64
    s_load_dword s6, s[28:29], 128
    s_load_dword s7, s[28:29], 192
    s_add_u32 m0, s43, 0
    s_nop 0
    buffer_load_dwordx4 v2, s[32:35], s40 offen offset:0 lds
    s_add_u32 m0, s44, 0
    s_nop 0
    buffer_load_dwordx4 v7, s[36:39], s41 offen offset:0 lds
    buffer_load_dwordx4 v8, s[36:39], s41 offen offset:1024 lds
    s_add_u32 m0, s43, 0
    s_nop 0
    buffer_load_dwordx4 v3, s[32:35], s40 offen offset:1024 lds
    s_add_u32 m0, s44, 8192
    s_nop 0
    buffer_load_dwordx4 v9, s[36:39], s41 offen offset:0 lds
    buffer_load_dwordx4 v10, s[36:39], s41 offen offset:1024 lds
    s_add_u32 m0, s43, 0
    s_nop 0
    buffer_load_dwordx4 v4, s[32:35], s40 offen offset:2048 lds
    s_add_u32 m0, s44, 16384
    s_nop 0
    buffer_load_dwordx4 v11, s[36:39], s41 offen offset:0 lds
    buffer_load_dwordx4 v12, s[36:39], s41 offen offset:1024 lds
    s_add_u32 m0, s43, 0
    s_nop 0
    buffer_load_dwordx4 v5, s[32:35], s40 offen offset:3072 lds
    s_mov_b32 m0, 16384
    s_mov_b64 exec, s[46:47]
    buffer_load_dwordx4 v6, s[32:35], s40 offen lds
    s_mov_b64 exec, -1
    s_movk_i32 s40, 2048
    s_mov_b32 s41, 6291456
    s_mov_b32 s60, s8
    s_mov_b32 s61, s9
    s_mov_b32 s62, 0x400000
    s_mov_b32 s63, 0x20000
    s_movk_i32 s75, 8192
    buffer_load_dwordx4 v[208:211], v225, s[60:63], 0 offen offset:0 nt
    buffer_load_dwordx4 v[212:215], v225, s[60:63], 0 offen offset:2048 nt
    buffer_load_dwordx4 v[216:219], v225, s[60:63], s75 offen offset:0 nt
    buffer_load_dwordx4 v[220:223], v225, s[60:63], s75 offen offset:2048 nt
    s_cmp_lg_u32 s70, 0
    s_cbranch_scc1 L_pc_done_29
    s_waitcnt lgkmcnt(0)
    s_min_u32 s4, s4, s5
    s_min_u32 s6, s6, s7
    s_min_u32 s4, s4, s6
    s_cmp_ge_u32 s4, 64
    s_cbranch_scc1 L_pc_done_29
    s_mov_b32 s60, s28
    s_mov_b32 s61, s29
    s_mov_b32 s62, 0x100
    s_mov_b32 s63, 0x20000
    v_lshlrev_b32 v20, 6, v0
    s_mov_b32 s74, 131072
    s_mov_b64 exec, 0xf
L_pc_loop_30:
    buffer_load_dword v21, v20, s[60:63], 0 offen sc1
    s_waitcnt vmcnt(0)
    v_cmp_gt_u32 vcc, 64, v21
    s_cbranch_vccz L_pc_done_29
    s_sleep 4
    s_sub_u32 s74, s74, 1
    s_cbranch_scc0 L_pc_loop_30
L_pc_done_29:
    s_mov_b64 exec, -1
    s_waitcnt vmcnt(15)
    s_barrier
    s_waitcnt vmcnt(4)
    s_mov_b64 exec, 1
    ds_add_u32 v227, v244 offset:24
    s_mov_b64 exec, -1
    s_add_u32 s56, s30, s85
    s_addc_u32 s57, s31, 0
    s_movk_i32 s58, 4096
    s_mov_b32 s59, 0x20000
    s_add_u32 m0, s81, 0
    s_nop 0
    buffer_load_dwordx4 v224, s[56:59], 0 offen offset:0 sc1 lds
    buffer_load_dwordx4 v224, s[56:59], 0 offen offset:1024 sc1 lds
    buffer_load_dwordx4 v224, s[56:59], 0 offen offset:2048 sc1 lds
    buffer_load_dwordx4 v224, s[56:59], 0 offen offset:3072 sc1 lds
    s_add_u32 m0, s81, 4572
    s_nop 0
    buffer_load_dwordx4 v224, s[56:59], 0 offen offset:0 sc1 lds
    buffer_load_dwordx4 v224, s[56:59], 0 offen offset:1024 sc1 lds
    buffer_load_dwordx4 v224, s[56:59], 0 offen offset:2048 sc1 lds
    buffer_load_dwordx4 v224, s[56:59], 0 offen offset:3072 sc1 lds
    s_add_u32 s56, s16, s84
    s_addc_u32 s57, s17, 0
    s_movk_i32 s58, 4096
    s_mov_b32 s59, 0x20000
    s_add_u32 m0, s80, 64
    v_mov_b32 v132, 0
    v_mov_b32 v133, 0
    v_mov_b32 v134, 0
    v_mov_b32 v135, 0
    buffer_load_dwordx4 v224, s[56:59], 0 offen offset:0 lds
    buffer_load_dwordx4 v224, s[56:59], 0 offen offset:1024 lds
    buffer_load_dwordx4 v224, s[56:59], 0 offen offset:2048 lds
    buffer_load_dwordx4 v224, s[56:59], 0 offen offset:3072 lds
    s_add_u32 m0, s80, 4304
    s_mov_b64 exec, 0x100
    buffer_load_dwordx4 v[132:135], off, s[56:59], 0
    s_mov_b64 exec, -1
    buffer_load_dwordx4 v224, s[56:59], 14 offen offset:0 lds
    buffer_load_dwordx4 v224, s[56:59], 14 offen offset:1024 lds
    buffer_load_dwordx4 v224, s[56:59], 14 offen offset:2048 lds
    buffer_load_dwordx4 v224, s[56:59], 14 offen offset:3072 lds
    v_lshrrev_b32 v234, 5, v0
    v_mul_u32_u24 v234, 4064, v234
    v_add3_u32 v234, v234, v224, s81
    s_mov_b32 exec_lo, 0xfffffff
    s_mov_b32 exec_hi, 0xfffffff
    ds_write_b128 v234, v[228:231] offset:4096
    s_mov_b64 exec, 1
    ds_write_b32 v234, v228 offset:8668
    s_mov_b64 exec, -1
    s_setprio 3
    s_waitcnt vmcnt(9)
    s_mov_b32 s60, s24
    s_mov_b32 s61, s25
    s_mov_b32 s62, 0x200000
    s_mov_b32 s63, 0x20000
    s_lshr_b32 s74, s2, 3
    s_lshl2_add_u32 s74, s74, s70
    s_bfe_u32 s75, s2, 0x10002
    s_lshl4_add_u32 s74, s74, s75
    s_lshl_b32 s74, s74, 10
    v_lshrrev_b32 v234, 3, v0
    v_and_b32 v235, 7, v0
    v_lshlrev_b32 v235, 7, v235
    v_lshl_add_u32 v234, v234, 11, v235
    buffer_load_dword v250, v234, s[60:63], s74 offen
    s_waitcnt vmcnt(1)
    v_cmp_lt_u32 vcc, 3, v0
    v_mov_b32 v140, 4160
    v_lshlrev_b32 v136, 16, v132
    v_cndmask_b32 v140, 0, v140, vcc
    v_alignbit_b32 v137, v133, v132, 16
    v_alignbit_b32 v138, v134, v133, 16
    v_alignbit_b32 v139, v135, v134, 16
    v_add3_u32 v140, v140, v224, s80
    s_mov_b64 exec, 0x1ff
    ds_write_b128 v140, v[136:139]
    s_mov_b64 exec, -1
    ds_read_b128 v[112:115], v233 offset:3584
    ds_read_b64 v[48:49], v232 offset:0
    ds_read_b64 v[50:51], v232 offset:8
    ds_read_b128 v[116:119], v233 offset:3072
    ds_read_b64 v[52:53], v232 offset:512
    ds_read_b64 v[54:55], v232 offset:520
    ds_read_b128 v[120:123], v233 offset:2560
    ds_read_b64 v[56:57], v232 offset:1024
    ds_read_b64 v[58:59], v232 offset:1032
    ds_read_b128 v[124:127], v233 offset:2048
    ds_read_b64 v[60:61], v232 offset:1536
    ds_read_b64 v[62:63], v232 offset:1544
    ds_read_b128 v[128:131], v233 offset:1536
    ds_read_b64 v[64:65], v232 offset:2048
    ds_read_b64 v[66:67], v232 offset:2056
    ds_read_b128 v[132:135], v233 offset:1024
    ds_read_b64 v[68:69], v232 offset:2560
    ds_read_b64 v[70:71], v232 offset:2568
    ds_read_b128 v[136:139], v233 offset:512
    ds_read_b64 v[72:73], v232 offset:3072
    ds_read_b64 v[74:75], v232 offset:3080
    ds_read_b128 v[140:143], v233 offset:0
    ds_read_b64 v[76:77], v232 offset:3584
    ds_read_b64 v[78:79], v232 offset:3592
    s_setprio 1
    s_mov_b32 s74, 3
    s_waitcnt lgkmcnt(0)
    v_mfma_f32_16x16x32_bf16 v[16:19], v[240:243], v[112:115], 0
    v_mfma_f32_16x16x32_bf16 v[20:23], v[240:243], v[116:119], 0
    v_mfma_f32_16x16x32_bf16 v[24:27], v[240:243], v[120:123], 0
    v_mfma_f32_16x16x32_bf16 v[28:31], v[240:243], v[124:127], 0
    v_mfma_f32_16x16x32_bf16 v[32:35], v[240:243], v[128:131], 0
    v_mfma_f32_16x16x32_bf16 v[36:39], v[240:243], v[132:135], 0
    v_mfma_f32_16x16x32_bf16 v[40:43], v[240:243], v[136:139], 0
    v_mfma_f32_16x16x32_bf16 v[44:47], v[240:243], v[140:143], 0
L_conv:
    v_mfma_f32_16x16x32_bf16 v[16:19], v[48:51], v[112:115], v[16:19]
    ds_read_b128 v[144:147], v233 offset:3648
    v_mfma_f32_16x16x32_bf16 v[20:23], v[48:51], v[116:119], v[20:23]
    ds_read_b64 v[80:81], v232 offset:64
    v_mfma_f32_16x16x32_bf16 v[20:23], v[52:55], v[112:115], v[20:23]
    ds_read_b64 v[82:83], v232 offset:72
    v_mfma_f32_16x16x32_bf16 v[24:27], v[48:51], v[120:123], v[24:27]
    ds_read_b128 v[148:151], v233 offset:3136
    v_mfma_f32_16x16x32_bf16 v[24:27], v[52:55], v[116:119], v[24:27]
    ds_read_b64 v[84:85], v232 offset:576
    v_mfma_f32_16x16x32_bf16 v[24:27], v[56:59], v[112:115], v[24:27]
    ds_read_b64 v[86:87], v232 offset:584
    v_mfma_f32_16x16x32_bf16 v[28:31], v[48:51], v[124:127], v[28:31]
    ds_read_b128 v[152:155], v233 offset:2624
    v_mfma_f32_16x16x32_bf16 v[28:31], v[52:55], v[120:123], v[28:31]
    ds_read_b64 v[88:89], v232 offset:1088
    v_mfma_f32_16x16x32_bf16 v[28:31], v[56:59], v[116:119], v[28:31]
    ds_read_b64 v[90:91], v232 offset:1096
    v_mfma_f32_16x16x32_bf16 v[28:31], v[60:63], v[112:115], v[28:31]
    ds_read_b128 v[156:159], v233 offset:2112
    v_mfma_f32_16x16x32_bf16 v[32:35], v[48:51], v[128:131], v[32:35]
    ds_read_b64 v[92:93], v232 offset:1600
    v_mfma_f32_16x16x32_bf16 v[32:35], v[52:55], v[124:127], v[32:35]
    ds_read_b64 v[94:95], v232 offset:1608
    v_mfma_f32_16x16x32_bf16 v[32:35], v[56:59], v[120:123], v[32:35]
    ds_read_b128 v[160:163], v233 offset:1600
    v_mfma_f32_16x16x32_bf16 v[32:35], v[60:63], v[116:119], v[32:35]
    ds_read_b64 v[96:97], v232 offset:2112
    v_mfma_f32_16x16x32_bf16 v[32:35], v[64:67], v[112:115], v[32:35]
    ds_read_b64 v[98:99], v232 offset:2120
    v_mfma_f32_16x16x32_bf16 v[36:39], v[48:51], v[132:135], v[36:39]
    ds_read_b128 v[164:167], v233 offset:1088
    v_mfma_f32_16x16x32_bf16 v[36:39], v[52:55], v[128:131], v[36:39]
    ds_read_b64 v[100:101], v232 offset:2624
    v_mfma_f32_16x16x32_bf16 v[36:39], v[56:59], v[124:127], v[36:39]
    ds_read_b64 v[102:103], v232 offset:2632
    v_mfma_f32_16x16x32_bf16 v[36:39], v[60:63], v[120:123], v[36:39]
    ds_read_b128 v[168:171], v233 offset:576
    v_mfma_f32_16x16x32_bf16 v[36:39], v[64:67], v[116:119], v[36:39]
    ds_read_b64 v[104:105], v232 offset:3136
    v_mfma_f32_16x16x32_bf16 v[36:39], v[68:71], v[112:115], v[36:39]
    ds_read_b64 v[106:107], v232 offset:3144
    v_mfma_f32_16x16x32_bf16 v[40:43], v[48:51], v[136:139], v[40:43]
    ds_read_b128 v[172:175], v233 offset:64
    v_mfma_f32_16x16x32_bf16 v[40:43], v[52:55], v[132:135], v[40:43]
    ds_read_b64 v[108:109], v232 offset:3648
    v_mfma_f32_16x16x32_bf16 v[40:43], v[56:59], v[128:131], v[40:43]
    ds_read_b64 v[110:111], v232 offset:3656
    v_mfma_f32_16x16x32_bf16 v[40:43], v[60:63], v[124:127], v[40:43]
    v_mfma_f32_16x16x32_bf16 v[40:43], v[64:67], v[120:123], v[40:43]
    v_mfma_f32_16x16x32_bf16 v[40:43], v[68:71], v[116:119], v[40:43]
    v_mfma_f32_16x16x32_bf16 v[40:43], v[72:75], v[112:115], v[40:43]
    v_mfma_f32_16x16x32_bf16 v[44:47], v[48:51], v[140:143], v[44:47]
    v_mfma_f32_16x16x32_bf16 v[44:47], v[52:55], v[136:139], v[44:47]
    v_mfma_f32_16x16x32_bf16 v[44:47], v[56:59], v[132:135], v[44:47]
    v_mfma_f32_16x16x32_bf16 v[44:47], v[60:63], v[128:131], v[44:47]
    v_mfma_f32_16x16x32_bf16 v[44:47], v[64:67], v[124:127], v[44:47]
    v_mfma_f32_16x16x32_bf16 v[44:47], v[68:71], v[120:123], v[44:47]
    v_mfma_f32_16x16x32_bf16 v[44:47], v[72:75], v[116:119], v[44:47]
    v_mfma_f32_16x16x32_bf16 v[44:47], v[76:79], v[112:115], v[44:47]
    s_waitcnt lgkmcnt(0)
    v_mfma_f32_16x16x32_bf16 v[16:19], v[80:83], v[144:147], v[16:19]
    ds_read_b128 v[112:115], v233 offset:3712
    v_mfma_f32_16x16x32_bf16 v[20:23], v[80:83], v[148:151], v[20:23]
    ds_read_b64 v[48:49], v232 offset:128
    v_mfma_f32_16x16x32_bf16 v[20:23], v[84:87], v[144:147], v[20:23]
    ds_read_b64 v[50:51], v232 offset:136
    v_mfma_f32_16x16x32_bf16 v[24:27], v[80:83], v[152:155], v[24:27]
    ds_read_b128 v[116:119], v233 offset:3200
    v_mfma_f32_16x16x32_bf16 v[24:27], v[84:87], v[148:151], v[24:27]
    ds_read_b64 v[52:53], v232 offset:640
    v_mfma_f32_16x16x32_bf16 v[24:27], v[88:91], v[144:147], v[24:27]
    ds_read_b64 v[54:55], v232 offset:648
    v_mfma_f32_16x16x32_bf16 v[28:31], v[80:83], v[156:159], v[28:31]
    ds_read_b128 v[120:123], v233 offset:2688
    v_mfma_f32_16x16x32_bf16 v[28:31], v[84:87], v[152:155], v[28:31]
    ds_read_b64 v[56:57], v232 offset:1152
    v_mfma_f32_16x16x32_bf16 v[28:31], v[88:91], v[148:151], v[28:31]
    ds_read_b64 v[58:59], v232 offset:1160
    v_mfma_f32_16x16x32_bf16 v[28:31], v[92:95], v[144:147], v[28:31]
    ds_read_b128 v[124:127], v233 offset:2176
    v_mfma_f32_16x16x32_bf16 v[32:35], v[80:83], v[160:163], v[32:35]
    ds_read_b64 v[60:61], v232 offset:1664
    v_mfma_f32_16x16x32_bf16 v[32:35], v[84:87], v[156:159], v[32:35]
    ds_read_b64 v[62:63], v232 offset:1672
    v_mfma_f32_16x16x32_bf16 v[32:35], v[88:91], v[152:155], v[32:35]
    ds_read_b128 v[128:131], v233 offset:1664
    v_mfma_f32_16x16x32_bf16 v[32:35], v[92:95], v[148:151], v[32:35]
    ds_read_b64 v[64:65], v232 offset:2176
    v_mfma_f32_16x16x32_bf16 v[32:35], v[96:99], v[144:147], v[32:35]
    ds_read_b64 v[66:67], v232 offset:2184
    v_mfma_f32_16x16x32_bf16 v[36:39], v[80:83], v[164:167], v[36:39]
    ds_read_b128 v[132:135], v233 offset:1152
    v_mfma_f32_16x16x32_bf16 v[36:39], v[84:87], v[160:163], v[36:39]
    ds_read_b64 v[68:69], v232 offset:2688
    v_mfma_f32_16x16x32_bf16 v[36:39], v[88:91], v[156:159], v[36:39]
    ds_read_b64 v[70:71], v232 offset:2696
    v_mfma_f32_16x16x32_bf16 v[36:39], v[92:95], v[152:155], v[36:39]
    ds_read_b128 v[136:139], v233 offset:640
    v_mfma_f32_16x16x32_bf16 v[36:39], v[96:99], v[148:151], v[36:39]
    ds_read_b64 v[72:73], v232 offset:3200
    v_mfma_f32_16x16x32_bf16 v[36:39], v[100:103], v[144:147], v[36:39]
    ds_read_b64 v[74:75], v232 offset:3208
    v_mfma_f32_16x16x32_bf16 v[40:43], v[80:83], v[168:171], v[40:43]
    ds_read_b128 v[140:143], v233 offset:128
    v_mfma_f32_16x16x32_bf16 v[40:43], v[84:87], v[164:167], v[40:43]
    ds_read_b64 v[76:77], v232 offset:3712
    v_mfma_f32_16x16x32_bf16 v[40:43], v[88:91], v[160:163], v[40:43]
    ds_read_b64 v[78:79], v232 offset:3720
    v_mfma_f32_16x16x32_bf16 v[40:43], v[92:95], v[156:159], v[40:43]
    v_add_u32 v232, 128, v232
    v_mfma_f32_16x16x32_bf16 v[40:43], v[96:99], v[152:155], v[40:43]
    v_add_u32 v233, 128, v233
    v_mfma_f32_16x16x32_bf16 v[40:43], v[100:103], v[148:151], v[40:43]
    s_sub_u32 s74, s74, 1
    v_mfma_f32_16x16x32_bf16 v[40:43], v[104:107], v[144:147], v[40:43]
    s_cmp_lg_u32 s74, 0
    v_mfma_f32_16x16x32_bf16 v[44:47], v[80:83], v[172:175], v[44:47]
    v_mfma_f32_16x16x32_bf16 v[44:47], v[84:87], v[168:171], v[44:47]
    v_mfma_f32_16x16x32_bf16 v[44:47], v[88:91], v[164:167], v[44:47]
    v_mfma_f32_16x16x32_bf16 v[44:47], v[92:95], v[160:163], v[44:47]
    v_mfma_f32_16x16x32_bf16 v[44:47], v[96:99], v[156:159], v[44:47]
    v_mfma_f32_16x16x32_bf16 v[44:47], v[100:103], v[152:155], v[44:47]
    v_mfma_f32_16x16x32_bf16 v[44:47], v[104:107], v[148:151], v[44:47]
    v_mfma_f32_16x16x32_bf16 v[44:47], v[108:111], v[144:147], v[44:47]
    s_waitcnt lgkmcnt(0)
    s_cbranch_scc1 L_conv
    v_mfma_f32_16x16x32_bf16 v[16:19], v[48:51], v[112:115], v[16:19]
    ds_read_b128 v[144:147], v233 offset:3648
    v_mfma_f32_16x16x32_bf16 v[20:23], v[48:51], v[116:119], v[20:23]
    ds_read_b64 v[80:81], v232 offset:64
    v_mfma_f32_16x16x32_bf16 v[20:23], v[52:55], v[112:115], v[20:23]
    ds_read_b64 v[82:83], v232 offset:72
    v_mfma_f32_16x16x32_bf16 v[24:27], v[48:51], v[120:123], v[24:27]
    ds_read_b128 v[148:151], v233 offset:3136
    v_mfma_f32_16x16x32_bf16 v[24:27], v[52:55], v[116:119], v[24:27]
    ds_read_b64 v[84:85], v232 offset:576
    v_mfma_f32_16x16x32_bf16 v[24:27], v[56:59], v[112:115], v[24:27]
    ds_read_b64 v[86:87], v232 offset:584
    v_mfma_f32_16x16x32_bf16 v[28:31], v[48:51], v[124:127], v[28:31]
    ds_read_b128 v[152:155], v233 offset:2624
    v_mfma_f32_16x16x32_bf16 v[28:31], v[52:55], v[120:123], v[28:31]
    ds_read_b64 v[88:89], v232 offset:1088
    v_mfma_f32_16x16x32_bf16 v[28:31], v[56:59], v[116:119], v[28:31]
    ds_read_b64 v[90:91], v232 offset:1096
    v_mfma_f32_16x16x32_bf16 v[28:31], v[60:63], v[112:115], v[28:31]
    ds_read_b128 v[156:159], v233 offset:2112
    v_mfma_f32_16x16x32_bf16 v[32:35], v[48:51], v[128:131], v[32:35]
    ds_read_b64 v[92:93], v232 offset:1600
    v_mfma_f32_16x16x32_bf16 v[32:35], v[52:55], v[124:127], v[32:35]
    ds_read_b64 v[94:95], v232 offset:1608
    v_mfma_f32_16x16x32_bf16 v[32:35], v[56:59], v[120:123], v[32:35]
    ds_read_b128 v[160:163], v233 offset:1600
    v_mfma_f32_16x16x32_bf16 v[32:35], v[60:63], v[116:119], v[32:35]
    ds_read_b64 v[96:97], v232 offset:2112
    v_mfma_f32_16x16x32_bf16 v[32:35], v[64:67], v[112:115], v[32:35]
    ds_read_b64 v[98:99], v232 offset:2120
    v_mfma_f32_16x16x32_bf16 v[36:39], v[48:51], v[132:135], v[36:39]
    ds_read_b128 v[164:167], v233 offset:1088
    v_mfma_f32_16x16x32_bf16 v[36:39], v[52:55], v[128:131], v[36:39]
    ds_read_b64 v[100:101], v232 offset:2624
    v_mfma_f32_16x16x32_bf16 v[36:39], v[56:59], v[124:127], v[36:39]
    ds_read_b64 v[102:103], v232 offset:2632
    v_mfma_f32_16x16x32_bf16 v[36:39], v[60:63], v[120:123], v[36:39]
    ds_read_b128 v[168:171], v233 offset:576
    v_mfma_f32_16x16x32_bf16 v[36:39], v[64:67], v[116:119], v[36:39]
    ds_read_b64 v[104:105], v232 offset:3136
    v_mfma_f32_16x16x32_bf16 v[36:39], v[68:71], v[112:115], v[36:39]
    ds_read_b64 v[106:107], v232 offset:3144
    v_mfma_f32_16x16x32_bf16 v[40:43], v[48:51], v[136:139], v[40:43]
    ds_read_b128 v[172:175], v233 offset:64
    v_mfma_f32_16x16x32_bf16 v[40:43], v[52:55], v[132:135], v[40:43]
    ds_read_b64 v[108:109], v232 offset:3648
    v_mfma_f32_16x16x32_bf16 v[40:43], v[56:59], v[128:131], v[40:43]
    ds_read_b64 v[110:111], v232 offset:3656
    v_mfma_f32_16x16x32_bf16 v[40:43], v[60:63], v[124:127], v[40:43]
    s_mul_i32 s74, s68, 4224
    v_mfma_f32_16x16x32_bf16 v[40:43], v[64:67], v[120:123], v[40:43]
    s_and_b32 s75, s71, 63
    v_mfma_f32_16x16x32_bf16 v[40:43], v[68:71], v[116:119], v[40:43]
    s_add_u32 s74, s74, s75
    v_mfma_f32_16x16x32_bf16 v[40:43], v[72:75], v[112:115], v[40:43]
    s_lshl_b32 s74, s74, 6
    v_mfma_f32_16x16x32_bf16 v[44:47], v[48:51], v[140:143], v[44:47]
    v_and_b32 v234, 3, v0
    v_mfma_f32_16x16x32_bf16 v[44:47], v[52:55], v[136:139], v[44:47]
    v_lshl_add_u32 v234, v234, 4, s74
    v_mfma_f32_16x16x32_bf16 v[44:47], v[56:59], v[132:135], v[44:47]
    v_and_b32 v235, 12, v0
    v_mfma_f32_16x16x32_bf16 v[44:47], v[60:63], v[128:131], v[44:47]
    v_lshrrev_b32 v236, 4, v0
    v_mfma_f32_16x16x32_bf16 v[44:47], v[64:67], v[124:127], v[44:47]
    v_add_u32 v235, v235, v236
    v_mfma_f32_16x16x32_bf16 v[44:47], v[68:71], v[120:123], v[44:47]
    v_mul_u32_u24 v235, 4224, v235
    v_mfma_f32_16x16x32_bf16 v[44:47], v[72:75], v[116:119], v[44:47]
    v_add_u32 v234, v234, v235
    v_mfma_f32_16x16x32_bf16 v[44:47], v[76:79], v[112:115], v[44:47]
    s_waitcnt lgkmcnt(0)
    s_mov_b64 exec, 1
    ds_add_u32 v227, v244 offset:36
    s_mov_b64 exec, -1
    v_mfma_f32_16x16x32_bf16 v[16:19], v[80:83], v[144:147], v[16:19]
    s_bfe_u32 s86, s2, 0x10002
    s_lshr_b32 s74, s2, 5
    v_mfma_f32_16x16x32_bf16 v[20:23], v[80:83], v[148:151], v[20:23]
    s_lshl3_add_u32 s86, s86, s74
    v_lshrrev_b32 v236, 4, v0
    v_mfma_f32_16x16x32_bf16 v[20:23], v[84:87], v[144:147], v[20:23]
    v_lshlrev_b32 v236, 1, v236
    v_xor_b32 v236, v0, v236
    v_mfma_f32_16x16x32_bf16 v[24:27], v[80:83], v[152:155], v[24:27]
    v_and_b32 v236, 7, v236
    s_lshl_b32 s74, s86, 7
    v_cvt_pk_bf16_f32 v48, v16, v17
    v_cvt_pk_bf16_f32 v49, v18, v19
    v_mfma_f32_16x16x32_bf16 v[24:27], v[84:87], v[148:151], v[24:27]
    v_lshl_add_u32 v236, v236, 4, s74
    v_lshrrev_b32 v235, 3, v0
    v_cvt_pk_bf16_f32 v50, v20, v21
    v_cvt_pk_bf16_f32 v51, v22, v23
    v_mfma_f32_16x16x32_bf16 v[24:27], v[88:91], v[144:147], v[24:27]
    v_lshl_add_u32 v235, v235, 11, v236
    s_mov_b32 s56, s24
    s_mov_b32 s76, 0
    buffer_store_dwordx4 v[48:51], v234, s[64:67], s76 offen sc1
    v_mfma_f32_16x16x32_bf16 v[28:31], v[80:83], v[156:159], v[28:31]
    s_mov_b32 s57, s25
    s_mov_b32 s58, 0x200000
    v_mfma_f32_16x16x32_bf16 v[28:31], v[84:87], v[152:155], v[28:31]
    s_mov_b32 s59, 0x20000
    s_mul_i32 s74, s86, 4
    v_cvt_pk_bf16_f32 v52, v24, v25
    v_cvt_pk_bf16_f32 v53, v26, v27
    v_mfma_f32_16x16x32_bf16 v[28:31], v[88:91], v[148:151], v[28:31]
    s_and_b32 s74, s74, 7
    s_lshl1_add_u32 s82, s74, s70
    v_mfma_f32_16x16x32_bf16 v[28:31], v[92:95], v[144:147], v[28:31]
    s_lshl_b32 s82, s82, 17
    s_lshl4_add_u32 s73, s68, 256
    v_mfma_f32_16x16x32_bf16 v[32:35], v[80:83], v[160:163], v[32:35]
    s_add_u32 s45, s73, s69
    s_lshl_b32 s73, s73, 8
    v_mfma_f32_16x16x32_bf16 v[32:35], v[84:87], v[156:159], v[32:35]
    s_lshl_b32 s45, s45, 8
    v_mfma_f32_16x16x32_bf16 v[32:35], v[88:91], v[152:155], v[32:35]
    v_mfma_f32_16x16x32_bf16 v[32:35], v[92:95], v[148:151], v[32:35]
    v_mfma_f32_16x16x32_bf16 v[32:35], v[96:99], v[144:147], v[32:35]
    v_cvt_pk_bf16_f32 v54, v28, v29
    v_cvt_pk_bf16_f32 v55, v30, v31
    v_mfma_f32_16x16x32_bf16 v[36:39], v[80:83], v[164:167], v[36:39]
    s_mov_b32 s76, 67584
    buffer_store_dwordx4 v[52:55], v234, s[64:67], s76 offen sc1
    v_mfma_f32_16x16x32_bf16 v[36:39], v[84:87], v[160:163], v[36:39]
    v_mfma_f32_16x16x32_bf16 v[36:39], v[88:91], v[156:159], v[36:39]
    v_mfma_f32_16x16x32_bf16 v[36:39], v[92:95], v[152:155], v[36:39]
    v_cvt_pk_bf16_f32 v56, v32, v33
    v_cvt_pk_bf16_f32 v57, v34, v35
    v_mfma_f32_16x16x32_bf16 v[36:39], v[96:99], v[148:151], v[36:39]
    v_mfma_f32_16x16x32_bf16 v[36:39], v[100:103], v[144:147], v[36:39]
    v_mfma_f32_16x16x32_bf16 v[40:43], v[80:83], v[168:171], v[40:43]
    v_mfma_f32_16x16x32_bf16 v[40:43], v[84:87], v[164:167], v[40:43]
    v_mfma_f32_16x16x32_bf16 v[40:43], v[88:91], v[160:163], v[40:43]
    v_mfma_f32_16x16x32_bf16 v[40:43], v[92:95], v[156:159], v[40:43]
    v_mfma_f32_16x16x32_bf16 v[40:43], v[96:99], v[152:155], v[40:43]
    v_mfma_f32_16x16x32_bf16 v[40:43], v[100:103], v[148:151], v[40:43]
    v_mfma_f32_16x16x32_bf16 v[40:43], v[104:107], v[144:147], v[40:43]
    v_mfma_f32_16x16x32_bf16 v[44:47], v[80:83], v[172:175], v[44:47]
    v_cvt_pk_bf16_f32 v58, v36, v37
    v_cvt_pk_bf16_f32 v59, v38, v39
    v_mfma_f32_16x16x32_bf16 v[44:47], v[84:87], v[168:171], v[44:47]
    s_mov_b32 s76, 135168
    buffer_store_dwordx4 v[56:59], v234, s[64:67], s76 offen sc1
    v_mfma_f32_16x16x32_bf16 v[44:47], v[88:91], v[164:167], v[44:47]
    v_mfma_f32_16x16x32_bf16 v[44:47], v[92:95], v[160:163], v[44:47]
    v_cvt_pk_bf16_f32 v60, v40, v41
    v_cvt_pk_bf16_f32 v61, v42, v43
    v_mfma_f32_16x16x32_bf16 v[44:47], v[96:99], v[156:159], v[44:47]
    v_mfma_f32_16x16x32_bf16 v[44:47], v[100:103], v[152:155], v[44:47]
    v_mfma_f32_16x16x32_bf16 v[44:47], v[104:107], v[148:151], v[44:47]
    v_mfma_f32_16x16x32_bf16 v[44:47], v[108:111], v[144:147], v[44:47]
    s_nop 7
    v_cvt_pk_bf16_f32 v62, v44, v45
    v_cvt_pk_bf16_f32 v63, v46, v47
    s_mov_b32 s76, 202752
    buffer_store_dwordx4 v[60:63], v234, s[64:67], s76 offen sc1
    s_setprio 1
    s_waitcnt vmcnt(0)
    v_mov_b32 v238, 1
    s_mov_b64 exec, 1
    ds_add_rtn_u32 v237, v227, v238 offset:8
    s_waitcnt lgkmcnt(0)
    v_readfirstlane_b32 s76, v237
    s_nop 0
    s_cmp_eq_u32 s76, 3
    s_cbranch_scc0 L_jo_35a
    s_mov_b64 exec, 0xffff
    v_lshlrev_b32 v237, 8, v0
    buffer_atomic_add v238, v237, s[52:55], s73 offen sc1
L_jo_35a:
    s_mov_b64 exec, -1
    v_lshlrev_b32 v112, 16, v208
    v_and_b32 v113, 0xffff0000, v208
    v_lshlrev_b32 v114, 16, v209
    v_and_b32 v115, 0xffff0000, v209
    v_lshlrev_b32 v116, 16, v210
    v_and_b32 v117, 0xffff0000, v210
    v_lshlrev_b32 v118, 16, v211
    v_and_b32 v119, 0xffff0000, v211
    v_lshlrev_b32 v120, 16, v212
    v_and_b32 v121, 0xffff0000, v212
    v_lshlrev_b32 v122, 16, v213
    v_and_b32 v123, 0xffff0000, v213
    v_lshlrev_b32 v124, 16, v214
    v_and_b32 v125, 0xffff0000, v214
    v_lshlrev_b32 v126, 16, v215
    v_and_b32 v127, 0xffff0000, v215
    v_lshlrev_b32 v128, 16, v216
    v_and_b32 v129, 0xffff0000, v216
    v_lshlrev_b32 v130, 16, v217
    v_and_b32 v131, 0xffff0000, v217
    v_lshlrev_b32 v132, 16, v218
    v_and_b32 v133, 0xffff0000, v218
    v_lshlrev_b32 v134, 16, v219
    v_and_b32 v135, 0xffff0000, v219
    v_lshlrev_b32 v136, 16, v220
    v_and_b32 v137, 0xffff0000, v220
    v_lshlrev_b32 v138, 16, v221
    v_and_b32 v139, 0xffff0000, v221
    v_lshlrev_b32 v140, 16, v222
    v_and_b32 v141, 0xffff0000, v222
    v_lshlrev_b32 v142, 16, v223
    v_and_b32 v143, 0xffff0000, v223
    s_setprio 1
    s_setprio 1
    s_mul_i32 s77, s70, 4352
    s_add_u32 s77, s77, 60416
    v_lshrrev_b32 v234, 5, v0
    v_lshl_add_u32 v234, v234, 1, v0
    v_lshl_add_u32 v234, v234, 4, s77
    v_and_b32 v235, 7, v0
    v_mul_u32_u24 v235, 544, v235
    v_lshrrev_b32 v236, 3, v0
    v_lshl_add_u32 v235, v236, 3, v235
    v_add_u32 v235, s77, v235
    s_mul_i32 s77, s71, 4224
    s_mov_b32 s60, s26
    s_mov_b32 s61, s27
    s_mov_b32 s62, 0x800000
    s_mov_b32 s63, 0x20000
    s_cmp_eq_u32 s76, 3
    s_cbranch_scc0 L_jo_35
    s_mov_b32 s75, 131072
L_sg_loop_38:
    s_load_dword s74, s[52:53], s45 glc
L_sg_chk_39:
    s_waitcnt lgkmcnt(0)
    s_cmp_ge_u32 s74, 16
    s_cbranch_scc1 L_sg_done_37
    s_sub_u32 s75, s75, 1
    s_cbranch_scc0 L_sg_loop_38
L_sg_done_37:
    v_mov_b32 v237, 16
    s_mov_b64 exec, 1
    ds_add_u32 v227, v237 offset:16
    s_mov_b64 exec, -1
    s_branch L_jd_36
L_jo_35:
    s_mov_b32 s75, 1048576
L_sl_loop_41:
    ds_read_b32 v237, v227 offset:16
    s_waitcnt lgkmcnt(0)
    v_readfirstlane_b32 s74, v237
    s_nop 0
    s_cmp_ge_u32 s74, 16
    s_cbranch_scc1 L_sl_done_40
    s_sleep 1
    s_sub_u32 s75, s75, 1
    s_cbranch_scc0 L_sl_loop_41
L_sl_done_40:
L_jd_36:
    buffer_load_dwordx4 v[48:51], v224, s[64:67], s77 offen offset:0 sc1
    buffer_load_dwordx4 v[52:55], v224, s[64:67], s77 offen offset:1024 sc1
    buffer_load_dwordx4 v[56:59], v224, s[64:67], s77 offen offset:2048 sc1
    buffer_load_dwordx4 v[60:63], v224, s[64:67], s77 offen offset:3072 sc1
    s_waitcnt vmcnt(3)
    ds_write_b128 v234, v[48:51] offset:0
    s_waitcnt vmcnt(2)
    ds_write_b128 v234, v[52:55] offset:1088
    s_waitcnt vmcnt(1)
    ds_write_b128 v234, v[56:59] offset:2176
    s_waitcnt vmcnt(0)
    ds_write_b128 v234, v[60:63] offset:3264
    ds_read_b64 v[64:65], v235 offset:0
    ds_read_b64 v[66:67], v235 offset:64
    ds_read_b64 v[68:69], v235 offset:128
    ds_read_b64 v[70:71], v235 offset:192
    ds_read_b64 v[72:73], v235 offset:256
    ds_read_b64 v[74:75], v235 offset:320
    ds_read_b64 v[76:77], v235 offset:384
    ds_read_b64 v[78:79], v235 offset:448
    s_waitcnt lgkmcnt(7)
    v_lshlrev_b32 v16, 16, v64
    v_and_b32 v24, 0xffff0000, v64
    v_lshlrev_b32 v32, 16, v65
    v_and_b32 v40, 0xffff0000, v65
    s_waitcnt lgkmcnt(6)
    v_lshlrev_b32 v17, 16, v66
    v_and_b32 v25, 0xffff0000, v66
    v_lshlrev_b32 v33, 16, v67
    v_and_b32 v41, 0xffff0000, v67
    s_waitcnt lgkmcnt(5)
    v_lshlrev_b32 v18, 16, v68
    v_and_b32 v26, 0xffff0000, v68
    v_lshlrev_b32 v34, 16, v69
    v_and_b32 v42, 0xffff0000, v69
    s_waitcnt lgkmcnt(4)
    v_lshlrev_b32 v19, 16, v70
    v_and_b32 v27, 0xffff0000, v70
    v_lshlrev_b32 v35, 16, v71
    v_and_b32 v43, 0xffff0000, v71
    s_waitcnt lgkmcnt(3)
    v_lshlrev_b32 v20, 16, v72
    v_and_b32 v28, 0xffff0000, v72
    v_lshlrev_b32 v36, 16, v73
    v_and_b32 v44, 0xffff0000, v73
    s_waitcnt lgkmcnt(2)
    v_lshlrev_b32 v21, 16, v74
    v_and_b32 v29, 0xffff0000, v74
    v_lshlrev_b32 v37, 16, v75
    v_and_b32 v45, 0xffff0000, v75
    s_waitcnt lgkmcnt(1)
    v_lshlrev_b32 v22, 16, v76
    v_and_b32 v30, 0xffff0000, v76
    v_lshlrev_b32 v38, 16, v77
    v_and_b32 v46, 0xffff0000, v77
    s_waitcnt lgkmcnt(0)
    v_lshlrev_b32 v23, 16, v78
    v_and_b32 v31, 0xffff0000, v78
    v_lshlrev_b32 v39, 16, v79
    v_and_b32 v47, 0xffff0000, v79
    v_mul_f32 v16, v16, v112
    v_mul_f32 v17, v17, v113
    v_mul_f32 v18, v18, v114
    v_mul_f32 v19, v19, v115
    v_mul_f32 v20, v20, v116
    v_mul_f32 v21, v21, v117
    v_mul_f32 v22, v22, v118
    v_mul_f32 v23, v23, v119
    v_cvt_pk_bf16_f32 v48, v16, v17
    v_cvt_pk_bf16_f32 v49, v18, v19
    v_cvt_pk_bf16_f32 v50, v20, v21
    v_cvt_pk_bf16_f32 v51, v22, v23
    s_mov_b32 s74, 0
    buffer_store_dwordx4 v[48:51], v226, s[60:63], s74 offen nt
    v_mul_f32 v24, v24, v120
    v_mul_f32 v25, v25, v121
    v_mul_f32 v26, v26, v122
    v_mul_f32 v27, v27, v123
    v_mul_f32 v28, v28, v124
    v_mul_f32 v29, v29, v125
    v_mul_f32 v30, v30, v126
    v_mul_f32 v31, v31, v127
    v_cvt_pk_bf16_f32 v52, v24, v25
    v_cvt_pk_bf16_f32 v53, v26, v27
    v_cvt_pk_bf16_f32 v54, v28, v29
    v_cvt_pk_bf16_f32 v55, v30, v31
    s_mov_b32 s74, 4096
    buffer_store_dwordx4 v[52:55], v226, s[60:63], s74 offen nt
    v_mul_f32 v32, v32, v128
    v_mul_f32 v33, v33, v129
    v_mul_f32 v34, v34, v130
    v_mul_f32 v35, v35, v131
    v_mul_f32 v36, v36, v132
    v_mul_f32 v37, v37, v133
    v_mul_f32 v38, v38, v134
    v_mul_f32 v39, v39, v135
    v_cvt_pk_bf16_f32 v56, v32, v33
    v_cvt_pk_bf16_f32 v57, v34, v35
    v_cvt_pk_bf16_f32 v58, v36, v37
    v_cvt_pk_bf16_f32 v59, v38, v39
    s_mov_b32 s74, 16384
    buffer_store_dwordx4 v[56:59], v226, s[60:63], s74 offen nt
    v_mul_f32 v40, v40, v136
    v_mul_f32 v41, v41, v137
    v_mul_f32 v42, v42, v138
    v_mul_f32 v43, v43, v139
    v_mul_f32 v44, v44, v140
    v_mul_f32 v45, v45, v141
    v_mul_f32 v46, v46, v142
    v_mul_f32 v47, v47, v143
    v_cvt_pk_bf16_f32 v60, v40, v41
    v_cvt_pk_bf16_f32 v61, v42, v43
    v_cvt_pk_bf16_f32 v62, v44, v45
    v_cvt_pk_bf16_f32 v63, v46, v47
    s_mov_b32 s74, 20480
    buffer_store_dwordx4 v[60:63], v226, s[60:63], s74 offen nt
    s_endpgm
L_grole:
    s_setprio 2
    s_add_u32 s52, s30, 0xe00000
    s_addc_u32 s53, s31, 0
    s_mov_b32 s54, 0x20000
    s_mov_b32 s55, 0x20000
    s_lshr_b32 s32, s3, 1
    s_and_b32 s33, s3, 1
    v_and_b32 v1, 15, v0
    v_lshrrev_b32 v2, 4, v0
    v_lshrrev_b32 v3, 1, v1
    v_xor_b32 v3, v2, v3
    v_lshlrev_b32 v3, 4, v3
    v_lshl_add_u32 v3, v1, 7, v3
    s_lshl_b32 s37, s33, 13
    v_add_u32 v196, s37, v3
    v_xor_b32 v197, 64, v196
    v_and_b32 v198, 7, v1
    v_lshlrev_b32 v3, 1, v2
    v_xor_b32 v3, v3, v198
    v_lshlrev_b32 v3, 4, v3
    v_lshl_add_u32 v3, v198, 7, v3
    v_lshrrev_b32 v202, 3, v1
    v_lshl_add_u32 v3, v202, 2, v3
    v_add_u32 v198, 16384, v3
    v_xor_b32 v199, 16, v198
    v_mul_u32_u24 v202, 0xaaaa, v202
    v_add_u32 v202, 0x4444, v202
    v_bfe_u32 v3, v0, 2, 2
    v_lshl_add_u32 v200, v2, 3, v3
    v_lshlrev_b32 v200, 7, v200
    v_bfe_u32 v3, v0, 3, 2
    v_xor_b32 v3, s3, v3
    v_lshl_add_u32 v200, v3, 5, v200
    v_and_b32 v3, 3, v0
    v_lshl_add_u32 v200, v3, 3, v200
    v_add_u32 v200, 17408, v200
    v_xor_b32 v201, 32, v200
    v_mov_b64 v[52:53], 0
    v_mov_b64 v[54:55], 0
    v_mov_b64 v[56:57], 0
    v_mov_b64 v[58:59], 0
    v_mov_b64 v[60:61], 0
    v_mov_b64 v[62:63], 0
    v_mov_b64 v[64:65], 0
    v_mov_b64 v[66:67], 0
    v_mov_b64 v[68:69], 0
    v_mov_b64 v[70:71], 0
    v_mov_b64 v[72:73], 0
    v_mov_b64 v[74:75], 0
    v_mov_b64 v[76:77], 0
    v_mov_b64 v[78:79], 0
    v_mov_b64 v[80:81], 0
    v_mov_b64 v[82:83], 0
    v_mov_b64 v[84:85], 0
    v_mov_b64 v[86:87], 0
    v_mov_b64 v[88:89], 0
    v_mov_b64 v[90:91], 0
    v_mov_b64 v[92:93], 0
    v_mov_b64 v[94:95], 0
    v_mov_b64 v[96:97], 0
    v_mov_b64 v[98:99], 0
    v_mov_b64 v[100:101], 0
    v_mov_b64 v[102:103], 0
    v_mov_b64 v[104:105], 0
    v_mov_b64 v[106:107], 0
    s_mov_b32 s34, 0
    v_mov_b32 v228, 134352
    v_and_b32 v1, 15, v0
    v_lshrrev_b32 v2, 4, v0
    v_lshlrev_b32 v2, 2, v2
    v_sub_u32 v1, v1, v2
    s_mov_b32 s37, 0xf149f2ca
    v_mov_b32 v3, s37
    s_or_b32 s38, s5, s33
    s_cmp_eq_u32 s38, 0
    s_cselect_b32 s38, s37, 0
    v_subrev_u32 v2, 0, v1
    v_cmp_gt_u32 vcc, 8, v2
    v_cmp_gt_i32 s[64:65], -8, v2
    v_ashrrev_i32 v2, 31, v2
    v_cndmask_b32 v204, v3, 0, vcc
    v_cndmask_b32 v208, v3, 0, s[64:65]
    v_mov_b32 v216, v2
    v_min_f32 v212, s38, v208
    v_subrev_u32 v2, 1, v1
    v_cmp_gt_u32 vcc, 8, v2
    v_cmp_gt_i32 s[64:65], -8, v2
    v_ashrrev_i32 v2, 31, v2
    v_cndmask_b32 v205, v3, 0, vcc
    v_cndmask_b32 v209, v3, 0, s[64:65]
    v_alignbit_b32 v216, v2, v216, 16
    v_min_f32 v213, s38, v209
    v_subrev_u32 v2, 2, v1
    v_cmp_gt_u32 vcc, 8, v2
    v_cmp_gt_i32 s[64:65], -8, v2
    v_ashrrev_i32 v2, 31, v2
    v_cndmask_b32 v206, v3, 0, vcc
    v_cndmask_b32 v210, v3, 0, s[64:65]
    v_mov_b32 v217, v2
    v_min_f32 v214, s38, v210
    v_subrev_u32 v2, 3, v1
    v_cmp_gt_u32 vcc, 8, v2
    v_cmp_gt_i32 s[64:65], -8, v2
    v_ashrrev_i32 v2, 31, v2
    v_cndmask_b32 v207, v3, 0, vcc
    v_cndmask_b32 v211, v3, 0, s[64:65]
    v_alignbit_b32 v217, v2, v217, 16
    v_min_f32 v215, s38, v211
    s_mul_i32 s37, s32, 80896
    s_add_u32 s37, s37, 78848
    v_lshl_add_u32 v220, v0, 3, s37
    s_lshl_b32 s38, s33, 9
    v_add_u32 v219, s38, v220
    s_add_u32 s38, s38, s37
    v_and_b32 v1, 3, v0
    v_lshl_add_u32 v1, v1, 1, s38
    v_bfe_u32 v2, v0, 2, 2
    v_lshl_add_u32 v1, v2, 7, v1
    v_lshrrev_b32 v2, 4, v0
    v_xor_b32 v2, 2, v2
    v_lshl_add_u32 v203, v2, 5, v1
    s_mul_i32 s38, s33, 2560
    v_add_u32 v221, s38, v220
    v_xor_b32 v222, 512, v221
    s_lshl3_add_u32 s37, s4, s5
    s_lshl1_add_u32 s37, s37, s33
    s_lshl_b32 s37, s37, 7
    s_lshl1_add_u32 s38, s6, s32
    s_add_u32 s37, s37, s38
    s_lshl_b32 s37, s37, 10
    v_lshl_add_u32 v218, v0, 4, s37
    s_mov_b32 s40, s30
    s_mov_b32 s41, s31
    s_mov_b32 s42, 0x400000
    s_mov_b32 s43, 0x20000
    s_and_b32 s58, s2, 3
    s_bfe_u32 s37, s2, 0x20003
    s_lshl2_add_u32 s58, s58, s37
    s_bfe_u32 s59, s2, 0x10002
    s_lshr_b32 s37, s2, 5
    s_lshl3_add_u32 s59, s59, s37
    s_mov_b32 s44, s24
    s_mov_b32 s45, s25
    s_mov_b32 s46, 0x200000
    s_mov_b32 s47, 0x20000
    s_mov_b32 s48, s26
    s_mov_b32 s49, s27
    s_mov_b32 s50, 0x800000
    s_mov_b32 s51, 0x20000
    s_lshl3_add_u32 s56, s4, s5
    s_lshl4_add_u32 s56, s56, 0
    s_lshl_b32 s56, s56, 8
    s_lshl4_add_u32 s57, s58, 0
    s_add_u32 s57, s57, s59
    s_lshl_b32 s57, s57, 8
    s_lshl2_add_u32 s37, s58, s3
    s_lshl_b32 s38, s37, 16
    v_lshl_add_u32 v224, v0, 4, s38
    v_add_u32 v225, 0x8000, v224
    s_and_b32 s37, s37, 31
    s_lshl_b32 s37, s37, 6
    s_lshr_b32 s38, s58, 3
    s_add_u32 s37, s37, s38
    s_lshl_b32 s37, s37, 5
    s_add_u32 s37, s37, s59
    s_add_u32 s37, s37, 16
    s_lshl_b32 s37, s37, 7
    v_lshrrev_b32 v1, 3, v0
    v_lshl_add_u32 v1, v1, 13, s37
    v_and_b32 v2, 7, v0
    v_lshl_add_u32 v226, v2, 4, v1
    v_lshrrev_b32 v1, 4, v0
    v_lshlrev_b32 v1, 1, v1
    v_xor_b32 v1, v0, v1
    v_and_b32 v1, 7, v1
    s_lshl_b32 s37, s59, 7
    v_lshl_add_u32 v1, v1, 4, s37
    v_lshrrev_b32 v227, 3, v0
    v_lshl_add_u32 v227, v227, 11, v1
    v_add_u32 v223, 15360, v227
    s_lshl_b32 s60, s3, 11
    s_mul_i32 s61, s59, 4
    s_and_b32 s61, s61, 7
    s_lshl3_add_u32 s62, s61, s3
    s_lshl_b32 s62, s62, 15
    v_lshrrev_b32 v1, 2, v0
    v_lshlrev_b32 v1, 7, v1
    v_bfe_u32 v2, v0, 3, 2
    v_lshl_add_u32 v1, v2, 5, v1
    v_and_b32 v2, 3, v0
    v_lshl_add_u32 v229, v2, 3, v1
    v_and_b32 v231, 7, v0
    v_lshl_add_u32 v230, v231, 6, s86
    v_mul_u32_u24 v231, 528, v231
    v_lshrrev_b32 v232, 3, v0
    v_xor_b32 v232, 7, v232
    v_lshl_add_u32 v231, v232, 3, v231
    v_add_u32 v231, s86, v231
    v_lshrrev_b32 v232, 5, v0
    v_add_u32 v232, v0, v232
    v_lshl_add_u32 v232, v232, 4, s86
    s_mul_i32 s87, s84, 4224
    s_sub_u32 s87, s87, s85
    s_lshl_b32 s87, s87, 6
    s_add_u32 s87, s87, 4032
    v_and_b32 v233, 3, v0
    v_lshl_add_u32 v233, v233, 4, s87
    v_lshrrev_b32 v234, 2, v0
    v_mul_u32_u24 v234, 4224, v234
    v_add_u32 v233, v233, v234
    s_add_u32 s80, s30, 0x400000
    s_addc_u32 s81, s31, 0
    s_mov_b32 s82, 0x420000
    s_mov_b32 s83, 0x20000
    s_waitcnt vmcnt(11)
    ds_read_b128 v[36:39], v230 offset:4224
    ds_read_b128 v[40:43], v230 offset:4240
    ds_read_b128 v[44:47], v230 offset:4256
    ds_read_b128 v[48:51], v230 offset:4272
    s_waitcnt lgkmcnt(3)
    v_lshlrev_b32 v152, 16, v36
    v_and_b32 v154, 0xffff0000, v36
    v_lshlrev_b32 v156, 16, v37
    v_and_b32 v158, 0xffff0000, v37
    v_lshlrev_b32 v153, 16, v38
    v_and_b32 v155, 0xffff0000, v38
    v_lshlrev_b32 v157, 16, v39
    v_and_b32 v159, 0xffff0000, v39
    s_waitcnt lgkmcnt(2)
    v_lshlrev_b32 v160, 16, v40
    v_and_b32 v162, 0xffff0000, v40
    v_lshlrev_b32 v164, 16, v41
    v_and_b32 v166, 0xffff0000, v41
    v_lshlrev_b32 v161, 16, v42
    v_and_b32 v163, 0xffff0000, v42
    v_lshlrev_b32 v165, 16, v43
    v_and_b32 v167, 0xffff0000, v43
    s_waitcnt lgkmcnt(1)
    v_lshlrev_b32 v168, 16, v44
    v_and_b32 v170, 0xffff0000, v44
    v_lshlrev_b32 v172, 16, v45
    v_and_b32 v174, 0xffff0000, v45
    v_lshlrev_b32 v169, 16, v46
    v_and_b32 v171, 0xffff0000, v46
    v_lshlrev_b32 v173, 16, v47
    v_and_b32 v175, 0xffff0000, v47
    s_waitcnt lgkmcnt(0)
    v_lshlrev_b32 v176, 16, v48
    v_and_b32 v178, 0xffff0000, v48
    v_lshlrev_b32 v180, 16, v49
    v_and_b32 v182, 0xffff0000, v49
    v_lshlrev_b32 v177, 16, v50
    v_and_b32 v179, 0xffff0000, v50
    v_lshlrev_b32 v181, 16, v51
    v_and_b32 v183, 0xffff0000, v51
    v_mov_b64 v[36:37], 0
    v_mov_b64 v[38:39], 0
    v_mov_b64 v[40:41], 0
    v_mov_b64 v[42:43], 0
    v_mov_b64 v[44:45], 0
    v_mov_b64 v[46:47], 0
    v_mov_b64 v[48:49], 0
    v_mov_b64 v[50:51], 0
    s_waitcnt vmcnt(10)
    v_lshlrev_b32 v184, 16, v108
    v_and_b32 v185, 0xffff0000, v108
    v_lshlrev_b32 v186, 16, v109
    v_and_b32 v187, 0xffff0000, v109
    v_lshlrev_b32 v188, 16, v110
    v_and_b32 v189, 0xffff0000, v110
    v_lshlrev_b32 v190, 16, v111
    v_and_b32 v191, 0xffff0000, v111
    v_pk_mul_f32 v[4:5], v[184:185], v[158:159]
    v_pk_mul_f32 v[12:13], v[186:187], v[166:167]
    v_pk_mul_f32 v[20:21], v[188:189], v[174:175]
    v_pk_mul_f32 v[28:29], v[190:191], v[182:183]
    s_waitcnt vmcnt(9)
    v_lshlrev_b32 v184, 16, v112
    v_and_b32 v185, 0xffff0000, v112
    v_lshlrev_b32 v186, 16, v113
    v_and_b32 v187, 0xffff0000, v113
    v_lshlrev_b32 v188, 16, v114
    v_and_b32 v189, 0xffff0000, v114
    v_lshlrev_b32 v190, 16, v115
    v_and_b32 v191, 0xffff0000, v115
    v_pk_fma_f32 v[4:5], v[184:185], v[156:157], v[4:5]
    v_pk_fma_f32 v[12:13], v[186:187], v[164:165], v[12:13]
    v_pk_fma_f32 v[20:21], v[188:189], v[172:173], v[20:21]
    v_pk_fma_f32 v[28:29], v[190:191], v[180:181], v[28:29]
    v_pk_mul_f32 v[6:7], v[184:185], v[158:159]
    v_pk_mul_f32 v[14:15], v[186:187], v[166:167]
    v_pk_mul_f32 v[22:23], v[188:189], v[174:175]
    v_pk_mul_f32 v[30:31], v[190:191], v[182:183]
    s_waitcnt vmcnt(8)
    v_lshlrev_b32 v184, 16, v116
    v_and_b32 v185, 0xffff0000, v116
    v_lshlrev_b32 v186, 16, v117
    v_and_b32 v187, 0xffff0000, v117
    v_lshlrev_b32 v188, 16, v118
    v_and_b32 v189, 0xffff0000, v118
    v_lshlrev_b32 v190, 16, v119
    v_and_b32 v191, 0xffff0000, v119
    v_pk_fma_f32 v[4:5], v[184:185], v[154:155], v[4:5]
    v_pk_fma_f32 v[12:13], v[186:187], v[162:163], v[12:13]
    v_pk_fma_f32 v[20:21], v[188:189], v[170:171], v[20:21]
    v_pk_fma_f32 v[28:29], v[190:191], v[178:179], v[28:29]
    v_pk_fma_f32 v[6:7], v[184:185], v[156:157], v[6:7]
    v_pk_fma_f32 v[14:15], v[186:187], v[164:165], v[14:15]
    v_pk_fma_f32 v[22:23], v[188:189], v[172:173], v[22:23]
    v_pk_fma_f32 v[30:31], v[190:191], v[180:181], v[30:31]
    v_pk_mul_f32 v[8:9], v[184:185], v[158:159]
    v_pk_mul_f32 v[16:17], v[186:187], v[166:167]
    v_pk_mul_f32 v[24:25], v[188:189], v[174:175]
    v_pk_mul_f32 v[32:33], v[190:191], v[182:183]
    s_waitcnt vmcnt(7)
    v_lshlrev_b32 v184, 16, v120
    v_and_b32 v185, 0xffff0000, v120
    v_lshlrev_b32 v186, 16, v121
    v_and_b32 v187, 0xffff0000, v121
    v_lshlrev_b32 v188, 16, v122
    v_and_b32 v189, 0xffff0000, v122
    v_lshlrev_b32 v190, 16, v123
    v_and_b32 v191, 0xffff0000, v123
    v_pk_fma_f32 v[4:5], v[184:185], v[152:153], v[4:5]
    v_pk_fma_f32 v[12:13], v[186:187], v[160:161], v[12:13]
    v_pk_fma_f32 v[20:21], v[188:189], v[168:169], v[20:21]
    v_pk_fma_f32 v[28:29], v[190:191], v[176:177], v[28:29]
    v_pk_fma_f32 v[6:7], v[184:185], v[154:155], v[6:7]
    v_pk_fma_f32 v[14:15], v[186:187], v[162:163], v[14:15]
    v_pk_fma_f32 v[22:23], v[188:189], v[170:171], v[22:23]
    v_pk_fma_f32 v[30:31], v[190:191], v[178:179], v[30:31]
    v_pk_fma_f32 v[8:9], v[184:185], v[156:157], v[8:9]
    v_pk_fma_f32 v[16:17], v[186:187], v[164:165], v[16:17]
    v_pk_fma_f32 v[24:25], v[188:189], v[172:173], v[24:25]
    v_pk_fma_f32 v[32:33], v[190:191], v[180:181], v[32:33]
    v_pk_mul_f32 v[10:11], v[184:185], v[158:159]
    v_pk_mul_f32 v[18:19], v[186:187], v[166:167]
    v_pk_mul_f32 v[26:27], v[188:189], v[174:175]
    v_pk_mul_f32 v[34:35], v[190:191], v[182:183]
    s_waitcnt vmcnt(6)
    v_lshlrev_b32 v184, 16, v124
    v_and_b32 v185, 0xffff0000, v124
    v_lshlrev_b32 v186, 16, v125
    v_and_b32 v187, 0xffff0000, v125
    v_lshlrev_b32 v188, 16, v126
    v_and_b32 v189, 0xffff0000, v126
    v_lshlrev_b32 v190, 16, v127
    v_and_b32 v191, 0xffff0000, v127
    v_pk_fma_f32 v[6:7], v[184:185], v[152:153], v[6:7]
    v_pk_fma_f32 v[14:15], v[186:187], v[160:161], v[14:15]
    v_pk_fma_f32 v[22:23], v[188:189], v[168:169], v[22:23]
    v_pk_fma_f32 v[30:31], v[190:191], v[176:177], v[30:31]
    v_pk_fma_f32 v[8:9], v[184:185], v[154:155], v[8:9]
    v_pk_fma_f32 v[16:17], v[186:187], v[162:163], v[16:17]
    v_pk_fma_f32 v[24:25], v[188:189], v[170:171], v[24:25]
    v_pk_fma_f32 v[32:33], v[190:191], v[178:179], v[32:33]
    v_pk_fma_f32 v[10:11], v[184:185], v[156:157], v[10:11]
    v_pk_fma_f32 v[18:19], v[186:187], v[164:165], v[18:19]
    v_pk_fma_f32 v[26:27], v[188:189], v[172:173], v[26:27]
    v_pk_fma_f32 v[34:35], v[190:191], v[180:181], v[34:35]
    s_waitcnt vmcnt(5)
    v_lshlrev_b32 v184, 16, v128
    v_and_b32 v185, 0xffff0000, v128
    v_lshlrev_b32 v186, 16, v129
    v_and_b32 v187, 0xffff0000, v129
    v_lshlrev_b32 v188, 16, v130
    v_and_b32 v189, 0xffff0000, v130
    v_lshlrev_b32 v190, 16, v131
    v_and_b32 v191, 0xffff0000, v131
    v_pk_fma_f32 v[8:9], v[184:185], v[152:153], v[8:9]
    v_pk_fma_f32 v[16:17], v[186:187], v[160:161], v[16:17]
    v_pk_fma_f32 v[24:25], v[188:189], v[168:169], v[24:25]
    v_pk_fma_f32 v[32:33], v[190:191], v[176:177], v[32:33]
    v_pk_fma_f32 v[10:11], v[184:185], v[154:155], v[10:11]
    v_pk_fma_f32 v[18:19], v[186:187], v[162:163], v[18:19]
    v_pk_fma_f32 v[26:27], v[188:189], v[170:171], v[26:27]
    v_pk_fma_f32 v[34:35], v[190:191], v[178:179], v[34:35]
    s_waitcnt vmcnt(4)
    v_lshlrev_b32 v184, 16, v132
    v_and_b32 v185, 0xffff0000, v132
    v_lshlrev_b32 v186, 16, v133
    v_and_b32 v187, 0xffff0000, v133
    v_lshlrev_b32 v188, 16, v134
    v_and_b32 v189, 0xffff0000, v134
    v_lshlrev_b32 v190, 16, v135
    v_and_b32 v191, 0xffff0000, v135
    v_pk_fma_f32 v[10:11], v[184:185], v[152:153], v[10:11]
    v_pk_fma_f32 v[18:19], v[186:187], v[160:161], v[18:19]
    v_pk_fma_f32 v[26:27], v[188:189], v[168:169], v[26:27]
    v_pk_fma_f32 v[34:35], v[190:191], v[176:177], v[34:35]
    s_waitcnt vmcnt(3)
    v_lshlrev_b32 v184, 16, v136
    v_and_b32 v185, 0xffff0000, v136
    v_lshlrev_b32 v186, 16, v137
    v_and_b32 v187, 0xffff0000, v137
    v_lshlrev_b32 v188, 16, v138
    v_and_b32 v189, 0xffff0000, v138
    v_lshlrev_b32 v190, 16, v139
    v_and_b32 v191, 0xffff0000, v139
    v_pk_mul_f32 v[4:5], v[4:5], v[184:185]
    v_pk_mul_f32 v[12:13], v[12:13], v[186:187]
    v_pk_mul_f32 v[20:21], v[20:21], v[188:189]
    v_pk_mul_f32 v[28:29], v[28:29], v[190:191]
    s_waitcnt vmcnt(2)
    v_lshlrev_b32 v184, 16, v140
    v_and_b32 v185, 0xffff0000, v140
    v_lshlrev_b32 v186, 16, v141
    v_and_b32 v187, 0xffff0000, v141
    v_lshlrev_b32 v188, 16, v142
    v_and_b32 v189, 0xffff0000, v142
    v_lshlrev_b32 v190, 16, v143
    v_and_b32 v191, 0xffff0000, v143
    v_pk_mul_f32 v[6:7], v[6:7], v[184:185]
    v_pk_mul_f32 v[14:15], v[14:15], v[186:187]
    v_pk_mul_f32 v[22:23], v[22:23], v[188:189]
    v_pk_mul_f32 v[30:31], v[30:31], v[190:191]
    s_waitcnt vmcnt(1)
    v_lshlrev_b32 v184, 16, v144
    v_and_b32 v185, 0xffff0000, v144
    v_lshlrev_b32 v186, 16, v145
    v_and_b32 v187, 0xffff0000, v145
    v_lshlrev_b32 v188, 16, v146
    v_and_b32 v189, 0xffff0000, v146
    v_lshlrev_b32 v190, 16, v147
    v_and_b32 v191, 0xffff0000, v147
    v_pk_mul_f32 v[8:9], v[8:9], v[184:185]
    v_pk_mul_f32 v[16:17], v[16:17], v[186:187]
    v_pk_mul_f32 v[24:25], v[24:25], v[188:189]
    v_pk_mul_f32 v[32:33], v[32:33], v[190:191]
    s_waitcnt vmcnt(0)
    v_lshlrev_b32 v184, 16, v148
    v_and_b32 v185, 0xffff0000, v148
    v_lshlrev_b32 v186, 16, v149
    v_and_b32 v187, 0xffff0000, v149
    v_lshlrev_b32 v188, 16, v150
    v_and_b32 v189, 0xffff0000, v150
    v_lshlrev_b32 v190, 16, v151
    v_and_b32 v191, 0xffff0000, v151
    v_pk_mul_f32 v[10:11], v[10:11], v[184:185]
    v_pk_mul_f32 v[18:19], v[18:19], v[186:187]
    v_pk_mul_f32 v[26:27], v[26:27], v[188:189]
    v_pk_mul_f32 v[34:35], v[34:35], v[190:191]
    v_cvt_pk_bf16_f32 v108, v10, v8
    v_cvt_pk_bf16_f32 v109, v6, v4
    ds_write_b64 v231, v[108:109] offset:0
    v_cvt_pk_bf16_f32 v110, v11, v9
    v_cvt_pk_bf16_f32 v111, v7, v5
    ds_write_b64 v231, v[110:111] offset:64
    v_cvt_pk_bf16_f32 v112, v18, v16
    v_cvt_pk_bf16_f32 v113, v14, v12
    ds_write_b64 v231, v[112:113] offset:128
    v_cvt_pk_bf16_f32 v114, v19, v17
    v_cvt_pk_bf16_f32 v115, v15, v13
    ds_write_b64 v231, v[114:115] offset:192
    v_cvt_pk_bf16_f32 v116, v26, v24
    v_cvt_pk_bf16_f32 v117, v22, v20
    ds_write_b64 v231, v[116:117] offset:256
    v_cvt_pk_bf16_f32 v118, v27, v25
    v_cvt_pk_bf16_f32 v119, v23, v21
    ds_write_b64 v231, v[118:119] offset:320
    v_cvt_pk_bf16_f32 v120, v34, v32
    v_cvt_pk_bf16_f32 v121, v30, v28
    ds_write_b64 v231, v[120:121] offset:384
    v_cvt_pk_bf16_f32 v122, v35, v33
    v_cvt_pk_bf16_f32 v123, v31, v29
    ds_write_b64 v231, v[122:123] offset:448
    ds_read_b128 v[234:237], v232 offset:0
    ds_read_b128 v[238:241], v232 offset:1056
    ds_read_b128 v[242:245], v232 offset:2112
    ds_read_b128 v[246:249], v232 offset:3168
    v_mov_b64 v[4:5], 0
    v_mov_b64 v[6:7], 0
    v_mov_b64 v[8:9], 0
    v_mov_b64 v[10:11], 0
    v_mov_b64 v[12:13], 0
    v_mov_b64 v[14:15], 0
    v_mov_b64 v[16:17], 0
    v_mov_b64 v[18:19], 0
    v_mov_b64 v[20:21], 0
    v_mov_b64 v[22:23], 0
    v_mov_b64 v[24:25], 0
    v_mov_b64 v[26:27], 0
    v_mov_b64 v[28:29], 0
    v_mov_b64 v[30:31], 0
    v_mov_b64 v[32:33], 0
    v_mov_b64 v[34:35], 0
    s_waitcnt lgkmcnt(0)
    s_and_b32 s37, s2, 7
    s_xor_b32 s37, s37, 2
    s_lshl_b32 s37, s37, 5
    s_lshr_b32 s38, s2, 3
    s_add_u32 s37, s37, s38
    s_add_u32 s37, s37, 256
    s_lshl_b32 s37, s37, 8
    s_cmp_eq_u32 s33, 0
    s_cselect_b32 s37, s37, s57
    s_cmp_eq_u32 s32, 0
    s_cbranch_scc0 L_noclear
    s_mov_b64 exec, 1
    buffer_store_dword v4, off, s[52:55], s37 sc1
    s_mov_b64 exec, -1
L_noclear:
    s_mov_b32 s37, 41984
    s_mov_b32 s36, 15
    s_barrier
    ds_read_b128 v[108:111], v196 offset:0
    ds_read_b64_tr_b16 v[124:125], v200 offset:0
    ds_read_b64_tr_b16 v[126:127], v200 offset:512
    ds_read_b128 v[112:115], v196 offset:2048
    ds_read_b64_tr_b16 v[128:129], v201 offset:0
    ds_read_b64_tr_b16 v[130:131], v201 offset:512
    ds_read_b128 v[116:119], v196 offset:4096
    ds_read_b64_tr_b16 v[148:149], v200 offset:8192
    ds_read_b64_tr_b16 v[150:151], v200 offset:8704
    ds_read_b128 v[120:123], v196 offset:6144
    ds_read_b64_tr_b16 v[132:133], v201 offset:8192
    ds_read_b64_tr_b16 v[134:135], v201 offset:8704
    ds_read_b64_tr_b16 v[156:157], v200 offset:16384
    ds_read_b64_tr_b16 v[158:159], v200 offset:16896
    ds_read_b64_tr_b16 v[136:137], v201 offset:16384
    ds_read_b64_tr_b16 v[138:139], v201 offset:16896
    s_mov_b32 s87, 0
    buffer_store_dwordx4 v[234:237], v233, s[80:83], s87 offen sc1
    s_mov_b32 s87, 67584
    buffer_store_dwordx4 v[238:241], v233, s[80:83], s87 offen sc1
    s_mov_b32 s87, 135168
    buffer_store_dwordx4 v[242:245], v233, s[80:83], s87 offen sc1
    s_mov_b32 s87, 202752
    buffer_store_dwordx4 v[246:249], v233, s[80:83], s87 offen sc1
    s_branch L_g1_head
.p2align 6
L_g1_head:
    s_waitcnt lgkmcnt(0)
L_g1_loop:
    v_mfma_f32_16x16x32_bf16 v[4:7], v[124:127], v[108:111], v[4:7]
    ds_read_b128 v[164:167], v197 offset:0
    v_mfma_f32_16x16x32_bf16 v[12:15], v[124:127], v[112:115], v[12:15]
    ds_read_b64_tr_b16 v[180:181], v200 offset:4096
    v_mfma_f32_16x16x32_bf16 v[20:23], v[124:127], v[116:119], v[20:23]
    ds_read_b64_tr_b16 v[182:183], v200 offset:4608
    v_mfma_f32_16x16x32_bf16 v[28:31], v[124:127], v[120:123], v[28:31]
    ds_read_b128 v[168:171], v197 offset:2048
    v_mfma_f32_16x16x32_bf16 v[32:35], v[128:131], v[120:123], v[32:35]
    ds_read_b64_tr_b16 v[184:185], v201 offset:4096
    v_mfma_f32_16x16x32_bf16 v[24:27], v[128:131], v[116:119], v[24:27]
    ds_read_b64_tr_b16 v[186:187], v201 offset:4608
    v_mfma_f32_16x16x32_bf16 v[16:19], v[128:131], v[112:115], v[16:19]
    ds_read_b128 v[172:175], v197 offset:4096
    v_mfma_f32_16x16x32_bf16 v[8:11], v[128:131], v[108:111], v[8:11]
    ds_read_b64_tr_b16 v[152:153], v200 offset:12288
    v_mfma_f32_16x16x32_bf16 v[40:43], v[132:135], v[108:111], v[40:43]
    ds_read_b64_tr_b16 v[154:155], v200 offset:12800
    v_mfma_f32_16x16x32_bf16 v[48:51], v[132:135], v[112:115], v[48:51]
    ds_read_b128 v[176:179], v197 offset:6144
    v_mfma_f32_16x16x32_bf16 v[56:59], v[132:135], v[116:119], v[56:59]
    ds_read_b64_tr_b16 v[188:189], v201 offset:12288
    v_mfma_f32_16x16x32_bf16 v[64:67], v[132:135], v[120:123], v[64:67]
    ds_read_b64_tr_b16 v[190:191], v201 offset:12800
    v_mfma_f32_16x16x32_bf16 v[60:63], v[148:151], v[120:123], v[60:63]
    ds_read2_b32 v[140:141], v198 offset1:2
    v_mfma_f32_16x16x32_bf16 v[52:55], v[148:151], v[116:119], v[52:55]
    ds_read2_b32 v[142:143], v199 offset1:2
    v_mfma_f32_16x16x32_bf16 v[44:47], v[148:151], v[112:115], v[44:47]
    ds_read_b64_tr_b16 v[160:161], v200 offset:20480
    v_mfma_f32_16x16x32_bf16 v[36:39], v[148:151], v[108:111], v[36:39]
    ds_read_b64_tr_b16 v[162:163], v200 offset:20992
    v_mfma_f32_16x16x32_bf16 v[68:71], v[108:111], v[156:159], v[68:71]
    ds_read_b64_tr_b16 v[192:193], v201 offset:20480
    ds_read_b64_tr_b16 v[194:195], v201 offset:20992
    v_mfma_f32_16x16x32_bf16 v[76:79], v[112:115], v[156:159], v[76:79]
    ds_read_b32 v1, v228 offset:24
    s_add_u32 s34, s34, 41984
    v_mfma_f32_16x16x32_bf16 v[84:87], v[116:119], v[156:159], v[84:87]
    s_cmp_eq_u32 s34, 125952
    s_cselect_b32 s35, -83968, s37
    v_mfma_f32_16x16x32_bf16 v[92:95], v[120:123], v[156:159], v[92:95]
    s_cselect_b32 s34, 0, s34
    s_bitcmp1_b32 0x1002, s36
    v_mfma_f32_16x16x32_bf16 v[96:99], v[120:123], v[136:139], v[96:99]
    v_add_u32 v196, s35, v196
    v_add_u32 v197, s35, v197
    v_mfma_f32_16x16x32_bf16 v[88:91], v[116:119], v[136:139], v[88:91]
    v_add_u32 v198, s35, v198
    v_add_u32 v199, s35, v199
    v_mfma_f32_16x16x32_bf16 v[80:83], v[112:115], v[136:139], v[80:83]
    v_add_u32 v200, s35, v200
    v_add_u32 v201, s35, v201
    v_mfma_f32_16x16x32_bf16 v[72:75], v[108:111], v[136:139], v[72:75]
    s_waitcnt lgkmcnt(0)
    v_smfmac_f32_16x16x64_bf16 v[100:103], v[140:143], v[148:155], v202
    v_smfmac_f32_16x16x64_bf16 v[104:107], v[140:143], v[156:163], v202
    s_cbranch_scc1 L_g1_rare
L_g1_bar:
    s_barrier
L_g1_nobar:
    v_mfma_f32_16x16x32_bf16 v[4:7], v[180:183], v[164:167], v[4:7]
    ds_read_b128 v[108:111], v196 offset:0
    v_mfma_f32_16x16x32_bf16 v[12:15], v[180:183], v[168:171], v[12:15]
    ds_read_b64_tr_b16 v[124:125], v200 offset:0
    v_mfma_f32_16x16x32_bf16 v[20:23], v[180:183], v[172:175], v[20:23]
    ds_read_b64_tr_b16 v[126:127], v200 offset:512
    v_mfma_f32_16x16x32_bf16 v[28:31], v[180:183], v[176:179], v[28:31]
    ds_read_b128 v[112:115], v196 offset:2048
    v_mfma_f32_16x16x32_bf16 v[32:35], v[184:187], v[176:179], v[32:35]
    ds_read_b64_tr_b16 v[128:129], v201 offset:0
    v_mfma_f32_16x16x32_bf16 v[24:27], v[184:187], v[172:175], v[24:27]
    ds_read_b64_tr_b16 v[130:131], v201 offset:512
    v_mfma_f32_16x16x32_bf16 v[16:19], v[184:187], v[168:171], v[16:19]
    ds_read_b128 v[116:119], v196 offset:4096
    v_mfma_f32_16x16x32_bf16 v[8:11], v[184:187], v[164:167], v[8:11]
    ds_read_b64_tr_b16 v[148:149], v200 offset:8192
    v_mfma_f32_16x16x32_bf16 v[40:43], v[188:191], v[164:167], v[40:43]
    ds_read_b64_tr_b16 v[150:151], v200 offset:8704
    v_mfma_f32_16x16x32_bf16 v[48:51], v[188:191], v[168:171], v[48:51]
    ds_read_b128 v[120:123], v196 offset:6144
    v_mfma_f32_16x16x32_bf16 v[56:59], v[188:191], v[172:175], v[56:59]
    ds_read_b64_tr_b16 v[132:133], v201 offset:8192
    v_mfma_f32_16x16x32_bf16 v[64:67], v[188:191], v[176:179], v[64:67]
    ds_read_b64_tr_b16 v[134:135], v201 offset:8704
    v_mfma_f32_16x16x32_bf16 v[60:63], v[152:155], v[176:179], v[60:63]
    ds_read_b64_tr_b16 v[156:157], v200 offset:16384
    v_mfma_f32_16x16x32_bf16 v[52:55], v[152:155], v[172:175], v[52:55]
    ds_read_b64_tr_b16 v[158:159], v200 offset:16896
    v_mfma_f32_16x16x32_bf16 v[44:47], v[152:155], v[168:171], v[44:47]
    ds_read_b64_tr_b16 v[136:137], v201 offset:16384
    v_mfma_f32_16x16x32_bf16 v[36:39], v[152:155], v[164:167], v[36:39]
    ds_read_b64_tr_b16 v[138:139], v201 offset:16896
    v_mfma_f32_16x16x32_bf16 v[68:71], v[164:167], v[160:163], v[68:71]
    s_sub_u32 s36, s36, 1
    v_mfma_f32_16x16x32_bf16 v[76:79], v[168:171], v[160:163], v[76:79]
    s_cmp_lg_u32 s36, 0
    v_mfma_f32_16x16x32_bf16 v[84:87], v[172:175], v[160:163], v[84:87]
    v_mfma_f32_16x16x32_bf16 v[92:95], v[176:179], v[160:163], v[92:95]
    v_mfma_f32_16x16x32_bf16 v[96:99], v[176:179], v[192:195], v[96:99]
    v_mfma_f32_16x16x32_bf16 v[88:91], v[172:175], v[192:195], v[88:91]
    v_mfma_f32_16x16x32_bf16 v[80:83], v[168:171], v[192:195], v[80:83]
    s_waitcnt lgkmcnt(0)
    v_mfma_f32_16x16x32_bf16 v[72:75], v[164:167], v[192:195], v[72:75]
    s_cbranch_scc1 L_g1_loop
    v_mfma_f32_16x16x32_bf16 v[4:7], v[124:127], v[108:111], v[4:7]
    ds_read_b128 v[164:167], v197 offset:0
    v_mfma_f32_16x16x32_bf16 v[12:15], v[124:127], v[112:115], v[12:15]
    ds_read_b64_tr_b16 v[180:181], v200 offset:4096
    v_mfma_f32_16x16x32_bf16 v[20:23], v[124:127], v[116:119], v[20:23]
    ds_read_b64_tr_b16 v[182:183], v200 offset:4608
    v_mfma_f32_16x16x32_bf16 v[28:31], v[124:127], v[120:123], v[28:31]
    ds_read_b128 v[168:171], v197 offset:2048
    v_mfma_f32_16x16x32_bf16 v[32:35], v[128:131], v[120:123], v[32:35]
    ds_read_b64_tr_b16 v[184:185], v201 offset:4096
    v_mfma_f32_16x16x32_bf16 v[24:27], v[128:131], v[116:119], v[24:27]
    ds_read_b64_tr_b16 v[186:187], v201 offset:4608
    v_mfma_f32_16x16x32_bf16 v[16:19], v[128:131], v[112:115], v[16:19]
    ds_read_b128 v[172:175], v197 offset:4096
    v_mfma_f32_16x16x32_bf16 v[8:11], v[128:131], v[108:111], v[8:11]
    ds_read_b64_tr_b16 v[152:153], v200 offset:12288
    v_mfma_f32_16x16x32_bf16 v[40:43], v[132:135], v[108:111], v[40:43]
    ds_read_b64_tr_b16 v[154:155], v200 offset:12800
    v_mfma_f32_16x16x32_bf16 v[48:51], v[132:135], v[112:115], v[48:51]
    ds_read_b128 v[176:179], v197 offset:6144
    v_mfma_f32_16x16x32_bf16 v[56:59], v[132:135], v[116:119], v[56:59]
    ds_read_b64_tr_b16 v[188:189], v201 offset:12288
    v_mfma_f32_16x16x32_bf16 v[64:67], v[132:135], v[120:123], v[64:67]
    ds_read_b64_tr_b16 v[190:191], v201 offset:12800
    v_mfma_f32_16x16x32_bf16 v[60:63], v[148:151], v[120:123], v[60:63]
    ds_read2_b32 v[140:141], v198 offset1:2
    v_mfma_f32_16x16x32_bf16 v[52:55], v[148:151], v[116:119], v[52:55]
    ds_read2_b32 v[142:143], v199 offset1:2
    v_mfma_f32_16x16x32_bf16 v[44:47], v[148:151], v[112:115], v[44:47]
    ds_read_b64_tr_b16 v[160:161], v200 offset:20480
    v_mfma_f32_16x16x32_bf16 v[36:39], v[148:151], v[108:111], v[36:39]
    ds_read_b64_tr_b16 v[162:163], v200 offset:20992
    v_mfma_f32_16x16x32_bf16 v[68:71], v[108:111], v[156:159], v[68:71]
    ds_read_b64_tr_b16 v[192:193], v201 offset:20480
    v_mfma_f32_16x16x32_bf16 v[76:79], v[112:115], v[156:159], v[76:79]
    ds_read_b64_tr_b16 v[194:195], v201 offset:20992
    v_mfma_f32_16x16x32_bf16 v[84:87], v[116:119], v[156:159], v[84:87]
    v_mfma_f32_16x16x32_bf16 v[92:95], v[120:123], v[156:159], v[92:95]
    v_mfma_f32_16x16x32_bf16 v[96:99], v[120:123], v[136:139], v[96:99]
    v_mfma_f32_16x16x32_bf16 v[88:91], v[116:119], v[136:139], v[88:91]
    v_mfma_f32_16x16x32_bf16 v[80:83], v[112:115], v[136:139], v[80:83]
    v_mfma_f32_16x16x32_bf16 v[72:75], v[108:111], v[136:139], v[72:75]
    s_waitcnt lgkmcnt(0)
    s_setprio 2
    v_mov_b32 v2, 1
    v_smfmac_f32_16x16x64_bf16 v[100:103], v[140:143], v[148:155], v202
    v_smfmac_f32_16x16x64_bf16 v[104:107], v[140:143], v[156:163], v202
    v_mfma_f32_16x16x32_bf16 v[60:63], v[152:155], v[176:179], v[60:63]
    v_mfma_f32_16x16x32_bf16 v[64:67], v[188:191], v[176:179], v[64:67]
    v_mfma_f32_16x16x32_bf16 v[92:95], v[176:179], v[160:163], v[92:95]
    v_mfma_f32_16x16x32_bf16 v[96:99], v[176:179], v[192:195], v[96:99]
    v_mfma_f32_16x16x32_bf16 v[28:31], v[180:183], v[176:179], v[28:31]
    v_mfma_f32_16x16x32_bf16 v[32:35], v[184:187], v[176:179], v[32:35]
    v_mfma_f32_16x16x32_bf16 v[52:55], v[152:155], v[172:175], v[52:55]
    v_mfma_f32_16x16x32_bf16 v[56:59], v[188:191], v[172:175], v[56:59]
    s_nop 3
    v_permlane32_swap_b32 v100, v104
    v_permlane32_swap_b32 v101, v105
    v_mfma_f32_16x16x32_bf16 v[20:23], v[180:183], v[172:175], v[20:23]
    v_permlane32_swap_b32 v102, v106
    v_permlane32_swap_b32 v103, v107
    v_mfma_f32_16x16x32_bf16 v[24:27], v[184:187], v[172:175], v[24:27]
    v_add_f32 v100, v100, v104
    v_add_f32 v101, v101, v105
    v_mfma_f32_16x16x32_bf16 v[44:47], v[152:155], v[168:171], v[44:47]
    v_add_f32 v102, v102, v106
    v_add_f32 v103, v103, v107
    v_mfma_f32_16x16x32_bf16 v[48:51], v[188:191], v[168:171], v[48:51]
    v_cvt_pk_bf16_f32 v144, v100, v101
    v_cvt_pk_bf16_f32 v145, v102, v103
    v_mfma_f32_16x16x32_bf16 v[12:15], v[180:183], v[168:171], v[12:15]
    ds_write_b64 v219, v[144:145] offset:1024
    ds_write_b16 v203, v144 offset:0
    v_mfma_f32_16x16x32_bf16 v[16:19], v[184:187], v[168:171], v[16:19]
    ds_write_b16_d16_hi v203, v144 offset:8
    ds_write_b16 v203, v145 offset:16
    v_mfma_f32_16x16x32_bf16 v[36:39], v[152:155], v[164:167], v[36:39]
    ds_write_b16_d16_hi v203, v145 offset:24
    v_cvt_pk_bf16_f32 v140, v60, v61
    v_mfma_f32_16x16x32_bf16 v[40:43], v[188:191], v[164:167], v[40:43]
    v_cvt_pk_bf16_f32 v141, v62, v63
    v_cvt_pk_bf16_f32 v142, v64, v65
    v_mfma_f32_16x16x32_bf16 v[4:7], v[180:183], v[164:167], v[4:7]
    v_cvt_pk_bf16_f32 v143, v66, v67
    v_cvt_pk_bf16_f32 v238, v92, v93
    v_mfma_f32_16x16x32_bf16 v[8:11], v[184:187], v[164:167], v[8:11]
    v_cvt_pk_bf16_f32 v239, v94, v95
    v_cvt_pk_bf16_f32 v248, v96, v97
    v_mfma_f32_16x16x32_bf16 v[84:87], v[172:175], v[160:163], v[84:87]
    v_cvt_pk_bf16_f32 v249, v98, v99
    s_cmp_eq_u32 s33, 0
    s_cbranch_scc0 L_at_nopub
    ds_write_b64 v220, v[140:141] offset:2048
    ds_write_b64 v220, v[238:239] offset:3072
    ds_write_b64 v220, v[142:143] offset:2560
    ds_write_b64 v220, v[248:249] offset:3584
L_at_nopub:
    s_mov_b64 exec, 1
    ds_add_u32 v228, v2 offset:20
    s_mov_b64 exec, -1
    v_mfma_f32_16x16x32_bf16 v[88:91], v[172:175], v[192:195], v[88:91]
    v_cvt_pk_bf16_f32 v120, v28, v29
    v_cvt_pk_bf16_f32 v121, v30, v31
    v_mfma_f32_16x16x32_bf16 v[76:79], v[168:171], v[160:163], v[76:79]
    v_cvt_pk_bf16_f32 v122, v32, v33
    v_cvt_pk_bf16_f32 v123, v34, v35
    v_mfma_f32_16x16x32_bf16 v[80:83], v[168:171], v[192:195], v[80:83]
    v_cvt_pk_bf16_f32 v136, v52, v53
    v_cvt_pk_bf16_f32 v137, v54, v55
    v_mfma_f32_16x16x32_bf16 v[68:71], v[164:167], v[160:163], v[68:71]
    v_cvt_pk_bf16_f32 v138, v56, v57
    v_cvt_pk_bf16_f32 v139, v58, v59
    v_mfma_f32_16x16x32_bf16 v[72:75], v[164:167], v[192:195], v[72:75]
    v_cvt_pk_bf16_f32 v116, v20, v21
    v_cvt_pk_bf16_f32 v117, v22, v23
    v_mfma_f32_16x16x32_bf16 v[28:31], v[140:143], v[120:123], v[204:207]
    v_cvt_pk_bf16_f32 v118, v24, v25
    v_cvt_pk_bf16_f32 v119, v26, v27
    v_mfma_f32_16x16x32_bf16 v[32:35], v[136:139], v[120:123], v[208:211]
    v_cvt_pk_bf16_f32 v132, v44, v45
    v_cvt_pk_bf16_f32 v133, v46, v47
    v_mfma_f32_16x16x32_bf16 v[20:23], v[136:139], v[116:119], v[204:207]
    v_cvt_pk_bf16_f32 v134, v48, v49
    v_cvt_pk_bf16_f32 v135, v50, v51
    s_nop 1
    v_mfma_f32_16x16x32_bf16 v[24:27], v[132:135], v[116:119], v[208:211]
    v_cvt_pk_bf16_f32 v112, v12, v13
    v_cvt_pk_bf16_f32 v113, v14, v15
    v_cvt_pk_bf16_f32 v114, v16, v17
    v_cvt_pk_bf16_f32 v115, v18, v19
    s_nop 1
    v_mfma_f32_16x16x32_bf16 v[12:15], v[132:135], v[112:115], v[204:207]
    v_cvt_pk_bf16_f32 v128, v36, v37
    v_cvt_pk_bf16_f32 v129, v38, v39
    v_cvt_pk_bf16_f32 v130, v40, v41
    v_cvt_pk_bf16_f32 v131, v42, v43
    s_nop 1
    v_mfma_f32_16x16x32_bf16 v[16:19], v[128:131], v[112:115], v[208:211]
    v_cvt_pk_bf16_f32 v108, v4, v5
    v_cvt_pk_bf16_f32 v109, v6, v7
    v_cvt_pk_bf16_f32 v110, v8, v9
    v_cvt_pk_bf16_f32 v111, v10, v11
    s_nop 1
    v_mfma_f32_16x16x32_bf16 v[4:7], v[128:131], v[108:111], v[204:207]
    v_cvt_pk_bf16_f32 v236, v84, v85
    v_cvt_pk_bf16_f32 v237, v86, v87
    v_cvt_pk_bf16_f32 v246, v88, v89
    v_cvt_pk_bf16_f32 v247, v90, v91
    v_cvt_pk_bf16_f32 v234, v76, v77
    v_cvt_pk_bf16_f32 v235, v78, v79
    ds_read_b32 v1, v228 offset:20
    v_cvt_pk_bf16_f32 v244, v80, v81
    v_cvt_pk_bf16_f32 v245, v82, v83
    v_cvt_pk_bf16_f32 v232, v68, v69
    v_cvt_pk_bf16_f32 v233, v70, v71
    v_cvt_pk_bf16_f32 v242, v72, v73
    v_cvt_pk_bf16_f32 v243, v74, v75
    s_waitcnt lgkmcnt(0)
    v_readfirstlane_b32 s37, v1
    s_nop 0
    s_cmp_ge_u32 s37, 4
    s_cbranch_scc1 L_sl_done_42
    s_mov_b32 s38, 1048576
L_sl_loop_43:
    ds_read_b32 v1, v228 offset:20
    s_waitcnt lgkmcnt(0)
    v_readfirstlane_b32 s37, v1
    s_nop 0
    s_cmp_ge_u32 s37, 4
    s_cbranch_scc1 L_sl_done_42
    s_sleep 1
    s_sub_u32 s38, s38, 1
    s_cbranch_scc0 L_sl_loop_43
L_sl_done_42:
    ds_read_b64 v[124:125], v221
    ds_read_b64 v[126:127], v222
    ds_read_b64 v[230:231], v221 offset:1024
    ds_read_b64 v[240:241], v222 offset:1024
    v_max_f32 v28, v28, v32
    v_max_f32 v29, v29, v33
    v_max_f32 v30, v30, v34
    v_max_f32 v31, v31, v35
    v_max3_f32 v39, v28, v29, v30
    v_max_f32 v39, v39, v31
    v_max_f32 v20, v20, v24
    v_max_f32 v21, v21, v25
    v_max_f32 v22, v22, v26
    v_max_f32 v23, v23, v27
    v_max3_f32 v38, v20, v21, v22
    v_max_f32 v38, v38, v23
    s_waitcnt lgkmcnt(2)
    v_mfma_f32_16x16x32_bf16 v[8:11], v[124:127], v[108:111], v[212:215]
    s_setprio 2
    s_mov_b32 s37, 0x3e8293ee
    v_max_f32 v12, v12, v16
    v_max_f32 v13, v13, v17
    v_max_f32 v14, v14, v18
    v_max_f32 v15, v15, v19
    v_max3_f32 v37, v12, v13, v14
    v_max_f32 v37, v37, v15
    v_max_f32 v4, v4, v8
    v_max_f32 v5, v5, v9
    v_max_f32 v6, v6, v10
    v_max_f32 v7, v7, v11
    v_max3_f32 v36, v4, v5, v6
    v_max_f32 v36, v36, v7
    v_permlane32_swap_b32 v38, v39
    s_nop 0
    v_permlane32_swap_b32 v36, v37
    v_max_f32 v38, v38, v39
    v_max_f32 v36, v36, v37
    s_nop 1
    v_permlane16_swap_b32 v36, v38
    v_max_f32 v36, v36, v38
    v_mul_f32 v38, s37, v36
    v_mul_f32 v36, s37, v36
    s_nop 1
    v_permlane16_swap_b32 v36, v38
    v_mov_b32 v37, v36
    s_add_u32 m0, s60, 0
    v_mov_b32 v39, v38
    v_permlane32_swap_b32 v36, v37
    s_xor_b32 s63, s62, 0
    v_permlane32_swap_b32 v38, v39
    v_fma_f32 v4, v4, s37, -v36
    buffer_load_dwordx4 v227, s[44:47], s63 offen offset:0 lds
    v_fma_f32 v5, v5, s37, -v36
    v_fma_f32 v6, v6, s37, -v36
    buffer_load_dwordx4 v223, s[44:47], s63 offen offset:1024 lds
    v_fma_f32 v7, v7, s37, -v36
    v_fma_f32 v12, v12, s37, -v37
    s_add_u32 m0, s60, 8192
    v_fma_f32 v13, v13, s37, -v37
    v_fma_f32 v14, v14, s37, -v37
    s_xor_b32 s63, s62, 131072
    v_fma_f32 v15, v15, s37, -v37
    v_fma_f32 v20, v20, s37, -v38
    buffer_load_dwordx4 v227, s[44:47], s63 offen offset:0 lds
    v_fma_f32 v21, v21, s37, -v38
    v_fma_f32 v22, v22, s37, -v38
    buffer_load_dwordx4 v223, s[44:47], s63 offen offset:1024 lds
    v_fma_f32 v23, v23, s37, -v38
    v_fma_f32 v28, v28, s37, -v39
    s_add_u32 m0, s60, 16384
    v_fma_f32 v29, v29, s37, -v39
    v_fma_f32 v30, v30, s37, -v39
    s_xor_b32 s63, s62, 262144
    v_fma_f32 v31, v31, s37, -v39
    v_exp_f32 v28, v28
    buffer_load_dwordx4 v227, s[44:47], s63 offen offset:0 lds
    v_exp_f32 v29, v29
    v_exp_f32 v30, v30
    buffer_load_dwordx4 v223, s[44:47], s63 offen offset:1024 lds
    v_exp_f32 v31, v31
    v_exp_f32 v20, v20
    s_add_u32 m0, s60, 24576
    v_exp_f32 v21, v21
    v_exp_f32 v22, v22
    s_xor_b32 s63, s62, 393216
    v_exp_f32 v23, v23
    v_exp_f32 v12, v12
    buffer_load_dwordx4 v227, s[44:47], s63 offen offset:0 lds
    v_exp_f32 v13, v13
    v_exp_f32 v14, v14
    buffer_load_dwordx4 v223, s[44:47], s63 offen offset:1024 lds
    v_exp_f32 v15, v15
    v_exp_f32 v4, v4
    s_add_u32 m0, s60, 32768
    v_exp_f32 v5, v5
    v_exp_f32 v6, v6
    s_xor_b32 s63, s62, 524288
    v_exp_f32 v7, v7
    v_add_f32 v39, v28, v29
    buffer_load_dwordx4 v227, s[44:47], s63 offen offset:0 lds
    v_add_f32 v32, v30, v31
    v_add_f32 v39, v39, v32
    buffer_load_dwordx4 v223, s[44:47], s63 offen offset:1024 lds
    v_add_f32 v38, v20, v21
    v_add_f32 v24, v22, v23
    s_add_u32 m0, s60, 83968
    v_add_f32 v38, v38, v24
    v_add_f32 v37, v12, v13
    s_xor_b32 s63, s62, 655360
    v_add_f32 v16, v14, v15
    v_add_f32 v37, v37, v16
    buffer_load_dwordx4 v227, s[44:47], s63 offen offset:0 lds
    v_add_f32 v36, v4, v5
    v_add_f32 v8, v6, v7
    buffer_load_dwordx4 v223, s[44:47], s63 offen offset:1024 lds
    v_add_f32 v36, v36, v8
    v_permlane32_swap_b32 v38, v39
    s_add_u32 m0, s60, 92160
    v_permlane32_swap_b32 v36, v37
    v_add_f32 v38, v38, v39
    s_xor_b32 s63, s62, 786432
    v_add_f32 v36, v36, v37
    s_nop 1
    v_permlane16_swap_b32 v36, v38
    buffer_load_dwordx4 v227, s[44:47], s63 offen offset:0 lds
    v_add_f32 v36, v36, v38
    v_rcp_f32 v38, v36
    buffer_load_dwordx4 v223, s[44:47], s63 offen offset:1024 lds
    v_rcp_f32 v36, v36
    s_nop 1
    v_permlane16_swap_b32 v36, v38
    s_add_u32 m0, s60, 100352
    v_mov_b32 v37, v36
    v_mov_b32 v39, v38
    s_xor_b32 s63, s62, 917504
    v_permlane32_swap_b32 v36, v37
    v_permlane32_swap_b32 v38, v39
    buffer_load_dwordx4 v227, s[44:47], s63 offen offset:0 lds
    s_waitcnt lgkmcnt(0)
    buffer_load_dwordx4 v223, s[44:47], s63 offen offset:1024 lds
    s_add_u32 m0, s60, 108544
    s_xor_b32 s63, s62, 1048576
    buffer_load_dwordx4 v227, s[44:47], s63 offen offset:0 lds
    buffer_load_dwordx4 v223, s[44:47], s63 offen offset:1024 lds
    s_add_u32 m0, s60, 116736
    s_xor_b32 s63, s62, 1179648
    buffer_load_dwordx4 v227, s[44:47], s63 offen offset:0 lds
    buffer_load_dwordx4 v223, s[44:47], s63 offen offset:1024 lds
    s_cmp_eq_u32 s33, 0
    v_mul_f32 v4, v4, v36
    v_mul_f32 v5, v5, v36
    v_mul_f32 v6, v6, v36
    v_mul_f32 v7, v7, v36
    v_cvt_pk_bf16_f32 v10, v4, v5
    v_cvt_pk_bf16_f32 v11, v6, v7
    v_and_b32 v8, v216, v10
    v_and_b32 v9, v217, v11
    v_xor_b32 v10, v8, v10
    v_xor_b32 v11, v9, v11
    s_setprio 2
    s_nop 0
    v_mfma_f32_16x16x32_bf16 v[68:71], v[230:233], v[8:11], 0
    v_mfma_f32_16x16x32_bf16 v[72:75], v[240:243], v[8:11], 0
    s_setprio 2
    v_mul_f32 v12, v12, v37
    v_mul_f32 v13, v13, v37
    v_mul_f32 v14, v14, v37
    v_mul_f32 v15, v15, v37
    v_cvt_pk_bf16_f32 v18, v12, v13
    v_cvt_pk_bf16_f32 v19, v14, v15
    v_and_b32 v16, v216, v18
    v_and_b32 v17, v217, v19
    v_xor_b32 v18, v16, v18
    v_xor_b32 v19, v17, v19
    v_cvt_pk_bf16_f32 v108, v68, v69
    v_cvt_pk_bf16_f32 v109, v70, v71
    v_cvt_pk_bf16_f32 v110, v72, v73
    v_cvt_pk_bf16_f32 v111, v74, v75
    s_cbranch_scc1 L_at_noswap0
    v_swap_b32 v108, v110
    v_swap_b32 v109, v111
L_at_noswap0:
    s_mov_b32 s37, 0
    buffer_store_dwordx4 v[108:111], v218, s[40:43], s37 offen sc1
    s_setprio 2
    v_mfma_f32_16x16x32_bf16 v[76:79], v[232:235], v[16:19], 0
    v_mfma_f32_16x16x32_bf16 v[80:83], v[242:245], v[16:19], 0
    s_setprio 2
    v_mul_f32 v20, v20, v38
    v_mul_f32 v21, v21, v38
    v_mul_f32 v22, v22, v38
    v_mul_f32 v23, v23, v38
    v_cvt_pk_bf16_f32 v26, v20, v21
    v_cvt_pk_bf16_f32 v27, v22, v23
    v_and_b32 v24, v216, v26
    v_and_b32 v25, v217, v27
    v_xor_b32 v26, v24, v26
    v_xor_b32 v27, v25, v27
    v_cvt_pk_bf16_f32 v112, v76, v77
    v_cvt_pk_bf16_f32 v113, v78, v79
    v_cvt_pk_bf16_f32 v114, v80, v81
    v_cvt_pk_bf16_f32 v115, v82, v83
    s_cbranch_scc1 L_at_noswap1
    v_swap_b32 v112, v114
    v_swap_b32 v113, v115
L_at_noswap1:
    s_mov_b32 s37, 32768
    buffer_store_dwordx4 v[112:115], v218, s[40:43], s37 offen sc1
    s_setprio 2
    v_mfma_f32_16x16x32_bf16 v[84:87], v[234:237], v[24:27], 0
    v_mfma_f32_16x16x32_bf16 v[88:91], v[244:247], v[24:27], 0
    s_setprio 2
    v_mul_f32 v28, v28, v39
    v_mul_f32 v29, v29, v39
    v_mul_f32 v30, v30, v39
    v_mul_f32 v31, v31, v39
    v_cvt_pk_bf16_f32 v34, v28, v29
    v_cvt_pk_bf16_f32 v35, v30, v31
    v_and_b32 v32, v216, v34
    v_and_b32 v33, v217, v35
    v_xor_b32 v34, v32, v34
    v_xor_b32 v35, v33, v35
    v_cvt_pk_bf16_f32 v116, v84, v85
    v_cvt_pk_bf16_f32 v117, v86, v87
    v_cvt_pk_bf16_f32 v118, v88, v89
    v_cvt_pk_bf16_f32 v119, v90, v91
    s_cbranch_scc1 L_at_noswap2
    v_swap_b32 v116, v118
    v_swap_b32 v117, v119
L_at_noswap2:
    s_mov_b32 s37, 65536
    buffer_store_dwordx4 v[116:119], v218, s[40:43], s37 offen sc1
    s_setprio 2
    v_mfma_f32_16x16x32_bf16 v[92:95], v[236:239], v[32:35], 0
    v_mfma_f32_16x16x32_bf16 v[96:99], v[246:249], v[32:35], 0
    s_setprio 2
    s_nop 5
    v_cvt_pk_bf16_f32 v120, v92, v93
    v_cvt_pk_bf16_f32 v121, v94, v95
    v_cvt_pk_bf16_f32 v122, v96, v97
    v_cvt_pk_bf16_f32 v123, v98, v99
    s_cbranch_scc1 L_at_noswap3
    v_swap_b32 v120, v122
    v_swap_b32 v121, v123
L_at_noswap3:
    s_mov_b32 s37, 98304
    buffer_store_dwordx4 v[120:123], v218, s[40:43], s37 offen sc1
    s_setprio 0
    v_xor_b32 v84, 0, v229
    v_xor_b32 v85, 32, v229
    v_xor_b32 v86, 64, v229
    v_xor_b32 v87, 96, v229
    v_add_u32 v88, 83968, v84
    v_add_u32 v89, 83968, v85
    v_add_u32 v90, 83968, v86
    v_add_u32 v91, 83968, v87
    v_add_u32 v92, 125952, v84
    v_add_u32 v93, 125952, v85
    v_add_u32 v94, 125952, v86
    v_add_u32 v95, 125952, v87
    v_lshl_add_u32 v231, v0, 4, s60
    v_add_u32 v230, 125952, v231
    s_add_u32 s64, s61, 0
    s_and_b32 s64, s64, 7
    s_lshl_b32 s64, s64, 12
    s_add_u32 s65, s61, 1
    s_and_b32 s65, s65, 7
    s_lshl_b32 s65, s65, 12
    s_add_u32 s66, s61, 2
    s_and_b32 s66, s66, 7
    s_lshl_b32 s66, s66, 12
    s_add_u32 s67, s61, 3
    s_and_b32 s67, s67, 7
    s_lshl_b32 s67, s67, 12
    s_add_u32 s68, s61, 4
    s_and_b32 s68, s68, 7
    s_lshl_b32 s68, s68, 12
    s_add_u32 s69, s61, 5
    s_and_b32 s69, s69, 7
    s_lshl_b32 s69, s69, 12
    s_add_u32 s70, s61, 6
    s_and_b32 s70, s70, 7
    s_lshl_b32 s70, s70, 12
    s_add_u32 s71, s61, 7
    s_and_b32 s71, s71, 7
    s_lshl_b32 s71, s71, 12
    s_waitcnt vmcnt(0)
    s_setprio 2
    v_mov_b32 v2, 1
    s_mov_b64 exec, 1
    ds_add_rtn_u32 v1, v228, v2 offset:0
    s_waitcnt lgkmcnt(0)
    v_readfirstlane_b32 s39, v1
    s_nop 0
    s_cmp_eq_u32 s39, 3
    s_cbranch_scc0 L_jo_44a
    s_mov_b64 exec, 0xffff
    v_lshlrev_b32 v1, 8, v0
    buffer_atomic_add v2, v1, s[52:55], s56 offen sc1
L_jo_44a:
    s_mov_b64 exec, -1
    s_setprio 0
    s_xor_b32 s63, s62, 1310720
    buffer_load_dwordx4 v[172:175], v227, s[44:47], s63 offen offset:0
    buffer_load_dwordx4 v[176:179], v223, s[44:47], s63 offen offset:1024
    s_xor_b32 s63, s62, 1441792
    buffer_load_dwordx4 v[180:183], v227, s[44:47], s63 offen offset:0
    buffer_load_dwordx4 v[184:187], v223, s[44:47], s63 offen offset:1024
    s_cmp_eq_u32 s39, 3
    s_cbranch_scc0 L_ps_46
    s_load_dword s37, s[52:53], s57 glc
L_ps_46:
    s_xor_b32 s63, s62, 1572864
    buffer_load_dwordx4 v[188:191], v227, s[44:47], s63 offen offset:0
    buffer_load_dwordx4 v[192:195], v223, s[44:47], s63 offen offset:1024
    s_xor_b32 s63, s62, 1703936
    buffer_load_dwordx4 v[196:199], v227, s[44:47], s63 offen offset:0
    buffer_load_dwordx4 v[200:203], v223, s[44:47], s63 offen offset:1024
    s_xor_b32 s63, s62, 1835008
    buffer_load_dwordx4 v[204:207], v227, s[44:47], s63 offen offset:0
    buffer_load_dwordx4 v[208:211], v223, s[44:47], s63 offen offset:1024
    s_xor_b32 s63, s62, 1966080
    buffer_load_dwordx4 v[212:215], v227, s[44:47], s63 offen offset:0
    buffer_load_dwordx4 v[216:219], v223, s[44:47], s63 offen offset:1024
    s_setprio 0
    s_cmp_eq_u32 s39, 3
    s_cbranch_scc0 L_jo_44
    s_mov_b32 s38, 131072
    s_branch L_sg_chk_49
L_sg_loop_48:
    s_load_dword s37, s[52:53], s57 glc
L_sg_chk_49:
    s_waitcnt lgkmcnt(0)
    s_cmp_ge_u32 s37, 16
    s_cbranch_scc1 L_sg_done_47
    s_sub_u32 s38, s38, 1
    s_cbranch_scc0 L_sg_loop_48
L_sg_done_47:
    v_mov_b32 v1, 16
    s_mov_b64 exec, 1
    ds_add_u32 v228, v1 offset:4
    s_mov_b64 exec, -1
L_jo_44:
    s_waitcnt vmcnt(12)
    s_mov_b64 exec, 1
    ds_add_u32 v228, v2 offset:4
    s_mov_b64 exec, -1
    s_mov_b32 s38, 1048576
L_sl_loop_51:
    ds_read_b32 v1, v228 offset:4
    s_waitcnt lgkmcnt(0)
    v_readfirstlane_b32 s37, v1
    s_nop 0
    s_cmp_ge_u32 s37, 20
    s_cbranch_scc1 L_sl_done_50
    s_sleep 1
    s_sub_u32 s38, s38, 1
    s_cbranch_scc0 L_sl_loop_51
L_sl_done_50:
L_jd_45:
    buffer_load_dwordx4 v[96:99], v224, s[40:43], s64 offen offset:0 sc1
    buffer_load_dwordx4 v[100:103], v225, s[40:43], s64 offen offset:0 sc1
    ds_read_b64_tr_b16 v[36:37], v84 offset:0
    ds_read_b64_tr_b16 v[38:39], v84 offset:2048
    buffer_load_dwordx4 v[104:107], v224, s[40:43], s64 offen offset:1024 sc1
    buffer_load_dwordx4 v[108:111], v225, s[40:43], s64 offen offset:1024 sc1
    ds_read_b64_tr_b16 v[40:41], v85 offset:0
    ds_read_b64_tr_b16 v[42:43], v85 offset:2048
    buffer_load_dwordx4 v[112:115], v224, s[40:43], s64 offen offset:2048 sc1
    buffer_load_dwordx4 v[116:119], v225, s[40:43], s64 offen offset:2048 sc1
    ds_read_b64_tr_b16 v[44:45], v86 offset:0
    ds_read_b64_tr_b16 v[46:47], v86 offset:2048
    buffer_load_dwordx4 v[120:123], v224, s[40:43], s64 offen offset:3072 sc1
    buffer_load_dwordx4 v[124:127], v225, s[40:43], s64 offen offset:3072 sc1
    ds_read_b64_tr_b16 v[48:49], v87 offset:0
    ds_read_b64_tr_b16 v[50:51], v87 offset:2048
    buffer_load_dwordx4 v[128:131], v224, s[40:43], s65 offen offset:0 sc1
    buffer_load_dwordx4 v[132:135], v225, s[40:43], s65 offen offset:0 sc1
    ds_read_b64_tr_b16 v[52:53], v84 offset:4096
    ds_read_b64_tr_b16 v[54:55], v84 offset:6144
    buffer_load_dwordx4 v[136:139], v224, s[40:43], s65 offen offset:1024 sc1
    buffer_load_dwordx4 v[140:143], v225, s[40:43], s65 offen offset:1024 sc1
    ds_read_b64_tr_b16 v[56:57], v85 offset:4096
    ds_read_b64_tr_b16 v[58:59], v85 offset:6144
    ds_read_b64_tr_b16 v[60:61], v86 offset:4096
    ds_read_b64_tr_b16 v[62:63], v86 offset:6144
    s_waitcnt lgkmcnt(12)
    ds_read_b64_tr_b16 v[64:65], v87 offset:4096
    ds_read_b64_tr_b16 v[66:67], v87 offset:6144
    ds_read_b32 v1, v228 offset:36
    s_waitcnt vmcnt(10) lgkmcnt(9)
    v_mfma_f32_16x16x32_bf16 v[4:7], v[36:39], v[96:99], 0
    ds_read_b64_tr_b16 v[68:69], v84 offset:8192
    v_mfma_f32_16x16x32_bf16 v[20:23], v[36:39], v[100:103], 0
    ds_read_b64_tr_b16 v[70:71], v84 offset:10240
    v_mfma_f32_16x16x32_bf16 v[8:11], v[40:43], v[96:99], 0
    ds_read_b64_tr_b16 v[36:37], v85 offset:8192
    v_mfma_f32_16x16x32_bf16 v[24:27], v[40:43], v[100:103], 0
    ds_read_b64_tr_b16 v[38:39], v85 offset:10240
    buffer_load_dwordx4 v[144:147], v224, s[40:43], s65 offen offset:2048 sc1
    v_mfma_f32_16x16x32_bf16 v[12:15], v[44:47], v[96:99], 0
    ds_read_b64_tr_b16 v[40:41], v86 offset:8192
    v_mfma_f32_16x16x32_bf16 v[28:31], v[44:47], v[100:103], 0
    ds_read_b64_tr_b16 v[42:43], v86 offset:10240
    v_mfma_f32_16x16x32_bf16 v[16:19], v[48:51], v[96:99], 0
    ds_read_b64_tr_b16 v[44:45], v87 offset:8192
    v_mfma_f32_16x16x32_bf16 v[32:35], v[48:51], v[100:103], 0
    ds_read_b64_tr_b16 v[46:47], v87 offset:10240
    buffer_load_dwordx4 v[148:151], v225, s[40:43], s65 offen offset:2048 sc1
    s_waitcnt lgkmcnt(8)
    v_readfirstlane_b32 s37, v1
    s_nop 0
    s_cmp_ge_u32 s37, 4
    s_cbranch_scc1 L_sl_done_52
    s_mov_b32 s38, 1048576
L_sl_loop_53:
    ds_read_b32 v1, v228 offset:36
    s_waitcnt lgkmcnt(0)
    v_readfirstlane_b32 s37, v1
    s_nop 0
    s_cmp_ge_u32 s37, 4
    s_cbranch_scc1 L_sl_done_52
    s_sleep 1
    s_sub_u32 s38, s38, 1
    s_cbranch_scc0 L_sl_loop_53
L_sl_done_52:
    ds_write_b128 v230, v[172:175] offset:0
    s_waitcnt vmcnt(10)
    v_mfma_f32_16x16x32_bf16 v[4:7], v[52:55], v[104:107], v[4:7]
    ds_read_b64_tr_b16 v[48:49], v84 offset:12288
    v_mfma_f32_16x16x32_bf16 v[20:23], v[52:55], v[108:111], v[20:23]
    ds_read_b64_tr_b16 v[50:51], v84 offset:14336
    v_mfma_f32_16x16x32_bf16 v[8:11], v[56:59], v[104:107], v[8:11]
    ds_read_b64_tr_b16 v[52:53], v85 offset:12288
    v_mfma_f32_16x16x32_bf16 v[24:27], v[56:59], v[108:111], v[24:27]
    ds_read_b64_tr_b16 v[54:55], v85 offset:14336
    buffer_load_dwordx4 v[96:99], v224, s[40:43], s65 offen offset:3072 sc1
    ds_write_b128 v230, v[176:179] offset:1024
    v_mfma_f32_16x16x32_bf16 v[12:15], v[60:63], v[104:107], v[12:15]
    ds_read_b64_tr_b16 v[56:57], v86 offset:12288
    v_mfma_f32_16x16x32_bf16 v[28:31], v[60:63], v[108:111], v[28:31]
    ds_read_b64_tr_b16 v[58:59], v86 offset:14336
    v_mfma_f32_16x16x32_bf16 v[16:19], v[64:67], v[104:107], v[16:19]
    ds_read_b64_tr_b16 v[60:61], v87 offset:12288
    v_mfma_f32_16x16x32_bf16 v[32:35], v[64:67], v[108:111], v[32:35]
    ds_read_b64_tr_b16 v[62:63], v87 offset:14336
    buffer_load_dwordx4 v[100:103], v225, s[40:43], s65 offen offset:3072 sc1
    ds_write_b128 v230, v[180:183] offset:8448
    s_waitcnt vmcnt(10) lgkmcnt(11)
    v_mfma_f32_16x16x32_bf16 v[4:7], v[68:71], v[112:115], v[4:7]
    ds_read_b64_tr_b16 v[64:65], v84 offset:16384
    v_mfma_f32_16x16x32_bf16 v[20:23], v[68:71], v[116:119], v[20:23]
    ds_read_b64_tr_b16 v[66:67], v84 offset:18432
    v_mfma_f32_16x16x32_bf16 v[8:11], v[36:39], v[112:115], v[8:11]
    ds_read_b64_tr_b16 v[68:69], v85 offset:16384
    v_mfma_f32_16x16x32_bf16 v[24:27], v[36:39], v[116:119], v[24:27]
    ds_read_b64_tr_b16 v[70:71], v85 offset:18432
    buffer_load_dwordx4 v[104:107], v224, s[40:43], s66 offen offset:0 sc1
    ds_write_b128 v230, v[184:187] offset:9472
    v_mfma_f32_16x16x32_bf16 v[12:15], v[40:43], v[112:115], v[12:15]
    ds_read_b64_tr_b16 v[36:37], v86 offset:16384
    v_mfma_f32_16x16x32_bf16 v[28:31], v[40:43], v[116:119], v[28:31]
    ds_read_b64_tr_b16 v[38:39], v86 offset:18432
    v_mfma_f32_16x16x32_bf16 v[16:19], v[44:47], v[112:115], v[16:19]
    ds_read_b64_tr_b16 v[40:41], v87 offset:16384
    v_mfma_f32_16x16x32_bf16 v[32:35], v[44:47], v[116:119], v[32:35]
    ds_read_b64_tr_b16 v[42:43], v87 offset:18432
    buffer_load_dwordx4 v[108:111], v225, s[40:43], s66 offen offset:0 sc1
    ds_write_b128 v230, v[188:191] offset:16896
    s_waitcnt vmcnt(10) lgkmcnt(11)
    v_mfma_f32_16x16x32_bf16 v[4:7], v[48:51], v[120:123], v[4:7]
    ds_read_b64_tr_b16 v[44:45], v84 offset:20480
    v_mfma_f32_16x16x32_bf16 v[20:23], v[48:51], v[124:127], v[20:23]
    ds_read_b64_tr_b16 v[46:47], v84 offset:22528
    v_mfma_f32_16x16x32_bf16 v[8:11], v[52:55], v[120:123], v[8:11]
    ds_read_b64_tr_b16 v[48:49], v85 offset:20480
    v_mfma_f32_16x16x32_bf16 v[24:27], v[52:55], v[124:127], v[24:27]
    ds_read_b64_tr_b16 v[50:51], v85 offset:22528
    buffer_load_dwordx4 v[112:115], v224, s[40:43], s66 offen offset:1024 sc1
    ds_write_b128 v230, v[192:195] offset:17920
    v_mfma_f32_16x16x32_bf16 v[12:15], v[56:59], v[120:123], v[12:15]
    ds_read_b64_tr_b16 v[52:53], v86 offset:20480
    v_mfma_f32_16x16x32_bf16 v[28:31], v[56:59], v[124:127], v[28:31]
    ds_read_b64_tr_b16 v[54:55], v86 offset:22528
    v_mfma_f32_16x16x32_bf16 v[16:19], v[60:63], v[120:123], v[16:19]
    ds_read_b64_tr_b16 v[56:57], v87 offset:20480
    v_mfma_f32_16x16x32_bf16 v[32:35], v[60:63], v[124:127], v[32:35]
    ds_read_b64_tr_b16 v[58:59], v87 offset:22528
    buffer_load_dwordx4 v[116:119], v225, s[40:43], s66 offen offset:1024 sc1
    ds_write_b128 v230, v[196:199] offset:25344
    s_waitcnt vmcnt(10) lgkmcnt(11)
    v_mfma_f32_16x16x32_bf16 v[4:7], v[64:67], v[128:131], v[4:7]
    ds_read_b64_tr_b16 v[60:61], v84 offset:24576
    v_mfma_f32_16x16x32_bf16 v[20:23], v[64:67], v[132:135], v[20:23]
    ds_read_b64_tr_b16 v[62:63], v84 offset:26624
    v_mfma_f32_16x16x32_bf16 v[8:11], v[68:71], v[128:131], v[8:11]
    ds_read_b64_tr_b16 v[64:65], v85 offset:24576
    v_mfma_f32_16x16x32_bf16 v[24:27], v[68:71], v[132:135], v[24:27]
    ds_read_b64_tr_b16 v[66:67], v85 offset:26624
    buffer_load_dwordx4 v[120:123], v224, s[40:43], s66 offen offset:2048 sc1
    ds_write_b128 v230, v[200:203] offset:26368
    v_mfma_f32_16x16x32_bf16 v[12:15], v[36:39], v[128:131], v[12:15]
    ds_read_b64_tr_b16 v[68:69], v86 offset:24576
    v_mfma_f32_16x16x32_bf16 v[28:31], v[36:39], v[132:135], v[28:31]
    ds_read_b64_tr_b16 v[70:71], v86 offset:26624
    v_mfma_f32_16x16x32_bf16 v[16:19], v[40:43], v[128:131], v[16:19]
    ds_read_b64_tr_b16 v[36:37], v87 offset:24576
    v_mfma_f32_16x16x32_bf16 v[32:35], v[40:43], v[132:135], v[32:35]
    ds_read_b64_tr_b16 v[38:39], v87 offset:26624
    buffer_load_dwordx4 v[124:127], v225, s[40:43], s66 offen offset:2048 sc1
    ds_write_b128 v231, v[204:207] offset:41984
    s_waitcnt vmcnt(10) lgkmcnt(11)
    v_mfma_f32_16x16x32_bf16 v[4:7], v[44:47], v[136:139], v[4:7]
    ds_read_b64_tr_b16 v[40:41], v84 offset:28672
    v_mfma_f32_16x16x32_bf16 v[20:23], v[44:47], v[140:143], v[20:23]
    ds_read_b64_tr_b16 v[42:43], v84 offset:30720
    v_mfma_f32_16x16x32_bf16 v[8:11], v[48:51], v[136:139], v[8:11]
    ds_read_b64_tr_b16 v[44:45], v85 offset:28672
    v_mfma_f32_16x16x32_bf16 v[24:27], v[48:51], v[140:143], v[24:27]
    ds_read_b64_tr_b16 v[46:47], v85 offset:30720
    buffer_load_dwordx4 v[128:131], v224, s[40:43], s66 offen offset:3072 sc1
    ds_write_b128 v231, v[208:211] offset:43008
    v_mfma_f32_16x16x32_bf16 v[12:15], v[52:55], v[136:139], v[12:15]
    ds_read_b64_tr_b16 v[48:49], v86 offset:28672
    v_mfma_f32_16x16x32_bf16 v[28:31], v[52:55], v[140:143], v[28:31]
    ds_read_b64_tr_b16 v[50:51], v86 offset:30720
    v_mfma_f32_16x16x32_bf16 v[16:19], v[56:59], v[136:139], v[16:19]
    ds_read_b64_tr_b16 v[52:53], v87 offset:28672
    v_mfma_f32_16x16x32_bf16 v[32:35], v[56:59], v[140:143], v[32:35]
    ds_read_b64_tr_b16 v[54:55], v87 offset:30720
    buffer_load_dwordx4 v[132:135], v225, s[40:43], s66 offen offset:3072 sc1
    ds_write_b128 v231, v[212:215] offset:51200
    s_waitcnt vmcnt(10) lgkmcnt(11)
    v_mfma_f32_16x16x32_bf16 v[4:7], v[60:63], v[144:147], v[4:7]
    ds_read_b64_tr_b16 v[56:57], v84 offset:32768
    v_mfma_f32_16x16x32_bf16 v[20:23], v[60:63], v[148:151], v[20:23]
    ds_read_b64_tr_b16 v[58:59], v84 offset:34816
    v_mfma_f32_16x16x32_bf16 v[8:11], v[64:67], v[144:147], v[8:11]
    ds_read_b64_tr_b16 v[60:61], v85 offset:32768
    v_mfma_f32_16x16x32_bf16 v[24:27], v[64:67], v[148:151], v[24:27]
    ds_read_b64_tr_b16 v[62:63], v85 offset:34816
    buffer_load_dwordx4 v[136:139], v224, s[40:43], s67 offen offset:0 sc1
    ds_write_b128 v231, v[216:219] offset:52224
    s_mov_b64 exec, 1
    ds_add_u32 v228, v2 offset:12
    s_mov_b64 exec, -1
    v_mfma_f32_16x16x32_bf16 v[12:15], v[68:71], v[144:147], v[12:15]
    ds_read_b64_tr_b16 v[64:65], v86 offset:32768
    v_mfma_f32_16x16x32_bf16 v[28:31], v[68:71], v[148:151], v[28:31]
    ds_read_b64_tr_b16 v[66:67], v86 offset:34816
    v_mfma_f32_16x16x32_bf16 v[16:19], v[36:39], v[144:147], v[16:19]
    ds_read_b64_tr_b16 v[68:69], v87 offset:32768
    v_mfma_f32_16x16x32_bf16 v[32:35], v[36:39], v[148:151], v[32:35]
    ds_read_b64_tr_b16 v[70:71], v87 offset:34816
    buffer_load_dwordx4 v[140:143], v225, s[40:43], s67 offen offset:0 sc1
    s_waitcnt vmcnt(10) lgkmcnt(11)
    v_mfma_f32_16x16x32_bf16 v[4:7], v[40:43], v[96:99], v[4:7]
    ds_read_b64_tr_b16 v[36:37], v84 offset:36864
    v_mfma_f32_16x16x32_bf16 v[20:23], v[40:43], v[100:103], v[20:23]
    ds_read_b64_tr_b16 v[38:39], v84 offset:38912
    v_mfma_f32_16x16x32_bf16 v[8:11], v[44:47], v[96:99], v[8:11]
    ds_read_b64_tr_b16 v[40:41], v85 offset:36864
    v_mfma_f32_16x16x32_bf16 v[24:27], v[44:47], v[100:103], v[24:27]
    ds_read_b64_tr_b16 v[42:43], v85 offset:38912
    buffer_load_dwordx4 v[144:147], v224, s[40:43], s67 offen offset:1024 sc1
    v_mfma_f32_16x16x32_bf16 v[12:15], v[48:51], v[96:99], v[12:15]
    ds_read_b64_tr_b16 v[44:45], v86 offset:36864
    v_mfma_f32_16x16x32_bf16 v[28:31], v[48:51], v[100:103], v[28:31]
    ds_read_b64_tr_b16 v[46:47], v86 offset:38912
    v_mfma_f32_16x16x32_bf16 v[16:19], v[52:55], v[96:99], v[16:19]
    ds_read_b64_tr_b16 v[48:49], v87 offset:36864
    v_mfma_f32_16x16x32_bf16 v[32:35], v[52:55], v[100:103], v[32:35]
    ds_read_b64_tr_b16 v[50:51], v87 offset:38912
    buffer_load_dwordx4 v[148:151], v225, s[40:43], s67 offen offset:1024 sc1
    s_waitcnt vmcnt(10) lgkmcnt(8)
    v_mfma_f32_16x16x32_bf16 v[4:7], v[56:59], v[104:107], v[4:7]
    ds_read_b64_tr_b16 v[52:53], v88 offset:0
    v_mfma_f32_16x16x32_bf16 v[20:23], v[56:59], v[108:111], v[20:23]
    ds_read_b64_tr_b16 v[54:55], v88 offset:2048
    v_mfma_f32_16x16x32_bf16 v[8:11], v[60:63], v[104:107], v[8:11]
    ds_read_b64_tr_b16 v[56:57], v89 offset:0
    v_mfma_f32_16x16x32_bf16 v[24:27], v[60:63], v[108:111], v[24:27]
    ds_read_b64_tr_b16 v[58:59], v89 offset:2048
    buffer_load_dwordx4 v[96:99], v224, s[40:43], s67 offen offset:2048 sc1
    v_mfma_f32_16x16x32_bf16 v[12:15], v[64:67], v[104:107], v[12:15]
    ds_read_b64_tr_b16 v[60:61], v90 offset:0
    v_mfma_f32_16x16x32_bf16 v[28:31], v[64:67], v[108:111], v[28:31]
    ds_read_b64_tr_b16 v[62:63], v90 offset:2048
    v_mfma_f32_16x16x32_bf16 v[16:19], v[68:71], v[104:107], v[16:19]
    ds_read_b64_tr_b16 v[64:65], v91 offset:0
    v_mfma_f32_16x16x32_bf16 v[32:35], v[68:71], v[108:111], v[32:35]
    ds_read_b64_tr_b16 v[66:67], v91 offset:2048
    buffer_load_dwordx4 v[100:103], v225, s[40:43], s67 offen offset:2048 sc1
    s_waitcnt vmcnt(10) lgkmcnt(8)
    v_mfma_f32_16x16x32_bf16 v[4:7], v[36:39], v[112:115], v[4:7]
    ds_read_b64_tr_b16 v[68:69], v88 offset:4096
    v_mfma_f32_16x16x32_bf16 v[20:23], v[36:39], v[116:119], v[20:23]
    ds_read_b64_tr_b16 v[70:71], v88 offset:6144
    v_mfma_f32_16x16x32_bf16 v[8:11], v[40:43], v[112:115], v[8:11]
    ds_read_b64_tr_b16 v[36:37], v89 offset:4096
    v_mfma_f32_16x16x32_bf16 v[24:27], v[40:43], v[116:119], v[24:27]
    ds_read_b64_tr_b16 v[38:39], v89 offset:6144
    buffer_load_dwordx4 v[104:107], v224, s[40:43], s67 offen offset:3072 sc1
    v_mfma_f32_16x16x32_bf16 v[12:15], v[44:47], v[112:115], v[12:15]
    ds_read_b64_tr_b16 v[40:41], v90 offset:4096
    v_mfma_f32_16x16x32_bf16 v[28:31], v[44:47], v[116:119], v[28:31]
    ds_read_b64_tr_b16 v[42:43], v90 offset:6144
    v_mfma_f32_16x16x32_bf16 v[16:19], v[48:51], v[112:115], v[16:19]
    ds_read_b64_tr_b16 v[44:45], v91 offset:4096
    v_mfma_f32_16x16x32_bf16 v[32:35], v[48:51], v[116:119], v[32:35]
    ds_read_b64_tr_b16 v[46:47], v91 offset:6144
    buffer_load_dwordx4 v[108:111], v225, s[40:43], s67 offen offset:3072 sc1
    s_waitcnt vmcnt(10) lgkmcnt(8)
    v_mfma_f32_16x16x32_bf16 v[4:7], v[52:55], v[120:123], v[4:7]
    ds_read_b64_tr_b16 v[48:49], v88 offset:8192
    v_mfma_f32_16x16x32_bf16 v[20:23], v[52:55], v[124:127], v[20:23]
    ds_read_b64_tr_b16 v[50:51], v88 offset:10240
    v_mfma_f32_16x16x32_bf16 v[8:11], v[56:59], v[120:123], v[8:11]
    ds_read_b64_tr_b16 v[52:53], v89 offset:8192
    v_mfma_f32_16x16x32_bf16 v[24:27], v[56:59], v[124:127], v[24:27]
    ds_read_b64_tr_b16 v[54:55], v89 offset:10240
    buffer_load_dwordx4 v[112:115], v224, s[40:43], s68 offen offset:0 sc1
    v_mfma_f32_16x16x32_bf16 v[12:15], v[60:63], v[120:123], v[12:15]
    ds_read_b64_tr_b16 v[56:57], v90 offset:8192
    v_mfma_f32_16x16x32_bf16 v[28:31], v[60:63], v[124:127], v[28:31]
    ds_read_b64_tr_b16 v[58:59], v90 offset:10240
    v_mfma_f32_16x16x32_bf16 v[16:19], v[64:67], v[120:123], v[16:19]
    ds_read_b64_tr_b16 v[60:61], v91 offset:8192
    v_mfma_f32_16x16x32_bf16 v[32:35], v[64:67], v[124:127], v[32:35]
    ds_read_b64_tr_b16 v[62:63], v91 offset:10240
    buffer_load_dwordx4 v[116:119], v225, s[40:43], s68 offen offset:0 sc1
    s_waitcnt vmcnt(10) lgkmcnt(8)
    v_mfma_f32_16x16x32_bf16 v[4:7], v[68:71], v[128:131], v[4:7]
    ds_read_b64_tr_b16 v[64:65], v88 offset:12288
    v_mfma_f32_16x16x32_bf16 v[20:23], v[68:71], v[132:135], v[20:23]
    ds_read_b64_tr_b16 v[66:67], v88 offset:14336
    v_mfma_f32_16x16x32_bf16 v[8:11], v[36:39], v[128:131], v[8:11]
    ds_read_b64_tr_b16 v[68:69], v89 offset:12288
    v_mfma_f32_16x16x32_bf16 v[24:27], v[36:39], v[132:135], v[24:27]
    ds_read_b64_tr_b16 v[70:71], v89 offset:14336
    buffer_load_dwordx4 v[120:123], v224, s[40:43], s68 offen offset:1024 sc1
    v_mfma_f32_16x16x32_bf16 v[12:15], v[40:43], v[128:131], v[12:15]
    ds_read_b64_tr_b16 v[36:37], v90 offset:12288
    v_mfma_f32_16x16x32_bf16 v[28:31], v[40:43], v[132:135], v[28:31]
    ds_read_b64_tr_b16 v[38:39], v90 offset:14336
    v_mfma_f32_16x16x32_bf16 v[16:19], v[44:47], v[128:131], v[16:19]
    ds_read_b64_tr_b16 v[40:41], v91 offset:12288
    v_mfma_f32_16x16x32_bf16 v[32:35], v[44:47], v[132:135], v[32:35]
    ds_read_b64_tr_b16 v[42:43], v91 offset:14336
    buffer_load_dwordx4 v[124:127], v225, s[40:43], s68 offen offset:1024 sc1
    s_waitcnt vmcnt(10) lgkmcnt(8)
    v_mfma_f32_16x16x32_bf16 v[4:7], v[48:51], v[136:139], v[4:7]
    ds_read_b64_tr_b16 v[44:45], v88 offset:16384
    v_mfma_f32_16x16x32_bf16 v[20:23], v[48:51], v[140:143], v[20:23]
    ds_read_b64_tr_b16 v[46:47], v88 offset:18432
    v_mfma_f32_16x16x32_bf16 v[8:11], v[52:55], v[136:139], v[8:11]
    ds_read_b64_tr_b16 v[48:49], v89 offset:16384
    v_mfma_f32_16x16x32_bf16 v[24:27], v[52:55], v[140:143], v[24:27]
    ds_read_b64_tr_b16 v[50:51], v89 offset:18432
    buffer_load_dwordx4 v[128:131], v224, s[40:43], s68 offen offset:2048 sc1
    v_mfma_f32_16x16x32_bf16 v[12:15], v[56:59], v[136:139], v[12:15]
    ds_read_b64_tr_b16 v[52:53], v90 offset:16384
    v_mfma_f32_16x16x32_bf16 v[28:31], v[56:59], v[140:143], v[28:31]
    ds_read_b64_tr_b16 v[54:55], v90 offset:18432
    v_mfma_f32_16x16x32_bf16 v[16:19], v[60:63], v[136:139], v[16:19]
    ds_read_b64_tr_b16 v[56:57], v91 offset:16384
    v_mfma_f32_16x16x32_bf16 v[32:35], v[60:63], v[140:143], v[32:35]
    ds_read_b64_tr_b16 v[58:59], v91 offset:18432
    buffer_load_dwordx4 v[132:135], v225, s[40:43], s68 offen offset:2048 sc1
    s_waitcnt vmcnt(10) lgkmcnt(8)
    v_mfma_f32_16x16x32_bf16 v[4:7], v[64:67], v[144:147], v[4:7]
    ds_read_b64_tr_b16 v[60:61], v88 offset:20480
    v_mfma_f32_16x16x32_bf16 v[20:23], v[64:67], v[148:151], v[20:23]
    ds_read_b64_tr_b16 v[62:63], v88 offset:22528
    v_mfma_f32_16x16x32_bf16 v[8:11], v[68:71], v[144:147], v[8:11]
    ds_read_b64_tr_b16 v[64:65], v89 offset:20480
    v_mfma_f32_16x16x32_bf16 v[24:27], v[68:71], v[148:151], v[24:27]
    ds_read_b64_tr_b16 v[66:67], v89 offset:22528
    buffer_load_dwordx4 v[136:139], v224, s[40:43], s68 offen offset:3072 sc1
    v_mfma_f32_16x16x32_bf16 v[12:15], v[36:39], v[144:147], v[12:15]
    ds_read_b64_tr_b16 v[68:69], v90 offset:20480
    v_mfma_f32_16x16x32_bf16 v[28:31], v[36:39], v[148:151], v[28:31]
    ds_read_b64_tr_b16 v[70:71], v90 offset:22528
    v_mfma_f32_16x16x32_bf16 v[16:19], v[40:43], v[144:147], v[16:19]
    ds_read_b64_tr_b16 v[36:37], v91 offset:20480
    v_mfma_f32_16x16x32_bf16 v[32:35], v[40:43], v[148:151], v[32:35]
    ds_read_b64_tr_b16 v[38:39], v91 offset:22528
    buffer_load_dwordx4 v[140:143], v225, s[40:43], s68 offen offset:3072 sc1
    s_waitcnt vmcnt(10) lgkmcnt(8)
    v_mfma_f32_16x16x32_bf16 v[4:7], v[44:47], v[96:99], v[4:7]
    ds_read_b64_tr_b16 v[40:41], v88 offset:24576
    v_mfma_f32_16x16x32_bf16 v[20:23], v[44:47], v[100:103], v[20:23]
    ds_read_b64_tr_b16 v[42:43], v88 offset:26624
    v_mfma_f32_16x16x32_bf16 v[8:11], v[48:51], v[96:99], v[8:11]
    ds_read_b64_tr_b16 v[44:45], v89 offset:24576
    v_mfma_f32_16x16x32_bf16 v[24:27], v[48:51], v[100:103], v[24:27]
    ds_read_b64_tr_b16 v[46:47], v89 offset:26624
    buffer_load_dwordx4 v[144:147], v224, s[40:43], s69 offen offset:0 sc1
    v_mfma_f32_16x16x32_bf16 v[12:15], v[52:55], v[96:99], v[12:15]
    ds_read_b64_tr_b16 v[48:49], v90 offset:24576
    v_mfma_f32_16x16x32_bf16 v[28:31], v[52:55], v[100:103], v[28:31]
    ds_read_b64_tr_b16 v[50:51], v90 offset:26624
    v_mfma_f32_16x16x32_bf16 v[16:19], v[56:59], v[96:99], v[16:19]
    ds_read_b64_tr_b16 v[52:53], v91 offset:24576
    v_mfma_f32_16x16x32_bf16 v[32:35], v[56:59], v[100:103], v[32:35]
    ds_read_b64_tr_b16 v[54:55], v91 offset:26624
    buffer_load_dwordx4 v[148:151], v225, s[40:43], s69 offen offset:0 sc1
    s_waitcnt vmcnt(10) lgkmcnt(8)
    v_mfma_f32_16x16x32_bf16 v[4:7], v[60:63], v[104:107], v[4:7]
    ds_read_b64_tr_b16 v[56:57], v88 offset:28672
    v_mfma_f32_16x16x32_bf16 v[20:23], v[60:63], v[108:111], v[20:23]
    ds_read_b64_tr_b16 v[58:59], v88 offset:30720
    v_mfma_f32_16x16x32_bf16 v[8:11], v[64:67], v[104:107], v[8:11]
    ds_read_b64_tr_b16 v[60:61], v89 offset:28672
    v_mfma_f32_16x16x32_bf16 v[24:27], v[64:67], v[108:111], v[24:27]
    ds_read_b64_tr_b16 v[62:63], v89 offset:30720
    buffer_load_dwordx4 v[96:99], v224, s[40:43], s69 offen offset:1024 sc1
    v_mfma_f32_16x16x32_bf16 v[12:15], v[68:71], v[104:107], v[12:15]
    ds_read_b64_tr_b16 v[64:65], v90 offset:28672
    v_mfma_f32_16x16x32_bf16 v[28:31], v[68:71], v[108:111], v[28:31]
    ds_read_b64_tr_b16 v[66:67], v90 offset:30720
    v_mfma_f32_16x16x32_bf16 v[16:19], v[36:39], v[104:107], v[16:19]
    ds_read_b64_tr_b16 v[68:69], v91 offset:28672
    v_mfma_f32_16x16x32_bf16 v[32:35], v[36:39], v[108:111], v[32:35]
    ds_read_b64_tr_b16 v[70:71], v91 offset:30720
    buffer_load_dwordx4 v[100:103], v225, s[40:43], s69 offen offset:1024 sc1
    s_waitcnt vmcnt(10) lgkmcnt(8)
    v_mfma_f32_16x16x32_bf16 v[4:7], v[40:43], v[112:115], v[4:7]
    ds_read_b64_tr_b16 v[36:37], v88 offset:32768
    v_mfma_f32_16x16x32_bf16 v[20:23], v[40:43], v[116:119], v[20:23]
    ds_read_b64_tr_b16 v[38:39], v88 offset:34816
    v_mfma_f32_16x16x32_bf16 v[8:11], v[44:47], v[112:115], v[8:11]
    ds_read_b64_tr_b16 v[40:41], v89 offset:32768
    v_mfma_f32_16x16x32_bf16 v[24:27], v[44:47], v[116:119], v[24:27]
    ds_read_b64_tr_b16 v[42:43], v89 offset:34816
    buffer_load_dwordx4 v[104:107], v224, s[40:43], s69 offen offset:2048 sc1
    v_mfma_f32_16x16x32_bf16 v[12:15], v[48:51], v[112:115], v[12:15]
    ds_read_b64_tr_b16 v[44:45], v90 offset:32768
    v_mfma_f32_16x16x32_bf16 v[28:31], v[48:51], v[116:119], v[28:31]
    ds_read_b64_tr_b16 v[46:47], v90 offset:34816
    v_mfma_f32_16x16x32_bf16 v[16:19], v[52:55], v[112:115], v[16:19]
    ds_read_b64_tr_b16 v[48:49], v91 offset:32768
    v_mfma_f32_16x16x32_bf16 v[32:35], v[52:55], v[116:119], v[32:35]
    ds_read_b64_tr_b16 v[50:51], v91 offset:34816
    buffer_load_dwordx4 v[108:111], v225, s[40:43], s69 offen offset:2048 sc1
    ds_read_b32 v1, v228 offset:12
    s_waitcnt vmcnt(10) lgkmcnt(9)
    v_mfma_f32_16x16x32_bf16 v[4:7], v[56:59], v[120:123], v[4:7]
    ds_read_b64_tr_b16 v[52:53], v88 offset:36864
    v_mfma_f32_16x16x32_bf16 v[20:23], v[56:59], v[124:127], v[20:23]
    ds_read_b64_tr_b16 v[54:55], v88 offset:38912
    v_mfma_f32_16x16x32_bf16 v[8:11], v[60:63], v[120:123], v[8:11]
    ds_read_b64_tr_b16 v[56:57], v89 offset:36864
    v_mfma_f32_16x16x32_bf16 v[24:27], v[60:63], v[124:127], v[24:27]
    ds_read_b64_tr_b16 v[58:59], v89 offset:38912
    buffer_load_dwordx4 v[112:115], v224, s[40:43], s69 offen offset:3072 sc1
    v_mfma_f32_16x16x32_bf16 v[12:15], v[64:67], v[120:123], v[12:15]
    ds_read_b64_tr_b16 v[60:61], v90 offset:36864
    v_mfma_f32_16x16x32_bf16 v[28:31], v[64:67], v[124:127], v[28:31]
    ds_read_b64_tr_b16 v[62:63], v90 offset:38912
    v_mfma_f32_16x16x32_bf16 v[16:19], v[68:71], v[120:123], v[16:19]
    ds_read_b64_tr_b16 v[64:65], v91 offset:36864
    v_mfma_f32_16x16x32_bf16 v[32:35], v[68:71], v[124:127], v[32:35]
    ds_read_b64_tr_b16 v[66:67], v91 offset:38912
    buffer_load_dwordx4 v[116:119], v225, s[40:43], s69 offen offset:3072 sc1
    s_waitcnt lgkmcnt(8)
    v_readfirstlane_b32 s37, v1
    s_nop 0
    s_cmp_ge_u32 s37, 4
    s_cbranch_scc1 L_sl_done_54
    s_mov_b32 s38, 1048576
L_sl_loop_55:
    ds_read_b32 v1, v228 offset:12
    s_waitcnt lgkmcnt(0)
    v_readfirstlane_b32 s37, v1
    s_nop 0
    s_cmp_ge_u32 s37, 4
    s_cbranch_scc1 L_sl_done_54
    s_sleep 1
    s_sub_u32 s38, s38, 1
    s_cbranch_scc0 L_sl_loop_55
L_sl_done_54:
    s_waitcnt vmcnt(10)
    v_mfma_f32_16x16x32_bf16 v[4:7], v[36:39], v[128:131], v[4:7]
    ds_read_b64_tr_b16 v[68:69], v92 offset:0
    v_mfma_f32_16x16x32_bf16 v[20:23], v[36:39], v[132:135], v[20:23]
    ds_read_b64_tr_b16 v[70:71], v92 offset:2048
    v_mfma_f32_16x16x32_bf16 v[8:11], v[40:43], v[128:131], v[8:11]
    ds_read_b64_tr_b16 v[36:37], v93 offset:0
    v_mfma_f32_16x16x32_bf16 v[24:27], v[40:43], v[132:135], v[24:27]
    ds_read_b64_tr_b16 v[38:39], v93 offset:2048
    buffer_load_dwordx4 v[120:123], v224, s[40:43], s70 offen offset:0 sc1
    v_mfma_f32_16x16x32_bf16 v[12:15], v[44:47], v[128:131], v[12:15]
    ds_read_b64_tr_b16 v[40:41], v94 offset:0
    v_mfma_f32_16x16x32_bf16 v[28:31], v[44:47], v[132:135], v[28:31]
    ds_read_b64_tr_b16 v[42:43], v94 offset:2048
    v_mfma_f32_16x16x32_bf16 v[16:19], v[48:51], v[128:131], v[16:19]
    ds_read_b64_tr_b16 v[44:45], v95 offset:0
    v_mfma_f32_16x16x32_bf16 v[32:35], v[48:51], v[132:135], v[32:35]
    ds_read_b64_tr_b16 v[46:47], v95 offset:2048
    buffer_load_dwordx4 v[124:127], v225, s[40:43], s70 offen offset:0 sc1
    s_waitcnt vmcnt(10) lgkmcnt(8)
    v_mfma_f32_16x16x32_bf16 v[4:7], v[52:55], v[136:139], v[4:7]
    ds_read_b64_tr_b16 v[48:49], v92 offset:4096
    v_mfma_f32_16x16x32_bf16 v[20:23], v[52:55], v[140:143], v[20:23]
    ds_read_b64_tr_b16 v[50:51], v92 offset:6144
    v_mfma_f32_16x16x32_bf16 v[8:11], v[56:59], v[136:139], v[8:11]
    ds_read_b64_tr_b16 v[52:53], v93 offset:4096
    v_mfma_f32_16x16x32_bf16 v[24:27], v[56:59], v[140:143], v[24:27]
    ds_read_b64_tr_b16 v[54:55], v93 offset:6144
    buffer_load_dwordx4 v[128:131], v224, s[40:43], s70 offen offset:1024 sc1
    v_mfma_f32_16x16x32_bf16 v[12:15], v[60:63], v[136:139], v[12:15]
    ds_read_b64_tr_b16 v[56:57], v94 offset:4096
    v_mfma_f32_16x16x32_bf16 v[28:31], v[60:63], v[140:143], v[28:31]
    ds_read_b64_tr_b16 v[58:59], v94 offset:6144
    v_mfma_f32_16x16x32_bf16 v[16:19], v[64:67], v[136:139], v[16:19]
    ds_read_b64_tr_b16 v[60:61], v95 offset:4096
    v_mfma_f32_16x16x32_bf16 v[32:35], v[64:67], v[140:143], v[32:35]
    ds_read_b64_tr_b16 v[62:63], v95 offset:6144
    buffer_load_dwordx4 v[132:135], v225, s[40:43], s70 offen offset:1024 sc1
    s_waitcnt vmcnt(10) lgkmcnt(8)
    v_mfma_f32_16x16x32_bf16 v[4:7], v[68:71], v[144:147], v[4:7]
    ds_read_b64_tr_b16 v[64:65], v92 offset:8448
    v_mfma_f32_16x16x32_bf16 v[20:23], v[68:71], v[148:151], v[20:23]
    ds_read_b64_tr_b16 v[66:67], v92 offset:10496
    v_mfma_f32_16x16x32_bf16 v[8:11], v[36:39], v[144:147], v[8:11]
    ds_read_b64_tr_b16 v[68:69], v93 offset:8448
    v_mfma_f32_16x16x32_bf16 v[24:27], v[36:39], v[148:151], v[24:27]
    ds_read_b64_tr_b16 v[70:71], v93 offset:10496
    buffer_load_dwordx4 v[136:139], v224, s[40:43], s70 offen offset:2048 sc1
    v_mfma_f32_16x16x32_bf16 v[12:15], v[40:43], v[144:147], v[12:15]
    ds_read_b64_tr_b16 v[36:37], v94 offset:8448
    v_mfma_f32_16x16x32_bf16 v[28:31], v[40:43], v[148:151], v[28:31]
    ds_read_b64_tr_b16 v[38:39], v94 offset:10496
    v_mfma_f32_16x16x32_bf16 v[16:19], v[44:47], v[144:147], v[16:19]
    ds_read_b64_tr_b16 v[40:41], v95 offset:8448
    v_mfma_f32_16x16x32_bf16 v[32:35], v[44:47], v[148:151], v[32:35]
    ds_read_b64_tr_b16 v[42:43], v95 offset:10496
    buffer_load_dwordx4 v[140:143], v225, s[40:43], s70 offen offset:2048 sc1
    s_waitcnt vmcnt(10) lgkmcnt(8)
    v_mfma_f32_16x16x32_bf16 v[4:7], v[48:51], v[96:99], v[4:7]
    ds_read_b64_tr_b16 v[44:45], v92 offset:12544
    v_mfma_f32_16x16x32_bf16 v[20:23], v[48:51], v[100:103], v[20:23]
    ds_read_b64_tr_b16 v[46:47], v92 offset:14592
    v_mfma_f32_16x16x32_bf16 v[8:11], v[52:55], v[96:99], v[8:11]
    ds_read_b64_tr_b16 v[48:49], v93 offset:12544
    v_mfma_f32_16x16x32_bf16 v[24:27], v[52:55], v[100:103], v[24:27]
    ds_read_b64_tr_b16 v[50:51], v93 offset:14592
    buffer_load_dwordx4 v[144:147], v224, s[40:43], s70 offen offset:3072 sc1
    v_mfma_f32_16x16x32_bf16 v[12:15], v[56:59], v[96:99], v[12:15]
    ds_read_b64_tr_b16 v[52:53], v94 offset:12544
    v_mfma_f32_16x16x32_bf16 v[28:31], v[56:59], v[100:103], v[28:31]
    ds_read_b64_tr_b16 v[54:55], v94 offset:14592
    v_mfma_f32_16x16x32_bf16 v[16:19], v[60:63], v[96:99], v[16:19]
    ds_read_b64_tr_b16 v[56:57], v95 offset:12544
    v_mfma_f32_16x16x32_bf16 v[32:35], v[60:63], v[100:103], v[32:35]
    ds_read_b64_tr_b16 v[58:59], v95 offset:14592
    buffer_load_dwordx4 v[148:151], v225, s[40:43], s70 offen offset:3072 sc1
    s_waitcnt vmcnt(10) lgkmcnt(8)
    v_mfma_f32_16x16x32_bf16 v[4:7], v[64:67], v[104:107], v[4:7]
    ds_read_b64_tr_b16 v[60:61], v92 offset:16896
    v_mfma_f32_16x16x32_bf16 v[20:23], v[64:67], v[108:111], v[20:23]
    ds_read_b64_tr_b16 v[62:63], v92 offset:18944
    v_mfma_f32_16x16x32_bf16 v[8:11], v[68:71], v[104:107], v[8:11]
    ds_read_b64_tr_b16 v[64:65], v93 offset:16896
    v_mfma_f32_16x16x32_bf16 v[24:27], v[68:71], v[108:111], v[24:27]
    ds_read_b64_tr_b16 v[66:67], v93 offset:18944
    buffer_load_dwordx4 v[96:99], v224, s[40:43], s71 offen offset:0 sc1
    v_mfma_f32_16x16x32_bf16 v[12:15], v[36:39], v[104:107], v[12:15]
    ds_read_b64_tr_b16 v[68:69], v94 offset:16896
    v_mfma_f32_16x16x32_bf16 v[28:31], v[36:39], v[108:111], v[28:31]
    ds_read_b64_tr_b16 v[70:71], v94 offset:18944
    v_mfma_f32_16x16x32_bf16 v[16:19], v[40:43], v[104:107], v[16:19]
    ds_read_b64_tr_b16 v[36:37], v95 offset:16896
    v_mfma_f32_16x16x32_bf16 v[32:35], v[40:43], v[108:111], v[32:35]
    ds_read_b64_tr_b16 v[38:39], v95 offset:18944
    buffer_load_dwordx4 v[100:103], v225, s[40:43], s71 offen offset:0 sc1
    s_waitcnt vmcnt(10) lgkmcnt(8)
    v_mfma_f32_16x16x32_bf16 v[4:7], v[44:47], v[112:115], v[4:7]
    ds_read_b64_tr_b16 v[40:41], v92 offset:20992
    v_mfma_f32_16x16x32_bf16 v[20:23], v[44:47], v[116:119], v[20:23]
    ds_read_b64_tr_b16 v[42:43], v92 offset:23040
    v_mfma_f32_16x16x32_bf16 v[8:11], v[48:51], v[112:115], v[8:11]
    ds_read_b64_tr_b16 v[44:45], v93 offset:20992
    v_mfma_f32_16x16x32_bf16 v[24:27], v[48:51], v[116:119], v[24:27]
    ds_read_b64_tr_b16 v[46:47], v93 offset:23040
    buffer_load_dwordx4 v[104:107], v224, s[40:43], s71 offen offset:1024 sc1
    v_mfma_f32_16x16x32_bf16 v[12:15], v[52:55], v[112:115], v[12:15]
    ds_read_b64_tr_b16 v[48:49], v94 offset:20992
    v_mfma_f32_16x16x32_bf16 v[28:31], v[52:55], v[116:119], v[28:31]
    ds_read_b64_tr_b16 v[50:51], v94 offset:23040
    v_mfma_f32_16x16x32_bf16 v[16:19], v[56:59], v[112:115], v[16:19]
    ds_read_b64_tr_b16 v[52:53], v95 offset:20992
    v_mfma_f32_16x16x32_bf16 v[32:35], v[56:59], v[116:119], v[32:35]
    ds_read_b64_tr_b16 v[54:55], v95 offset:23040
    buffer_load_dwordx4 v[108:111], v225, s[40:43], s71 offen offset:1024 sc1
    s_waitcnt vmcnt(10) lgkmcnt(8)
    v_mfma_f32_16x16x32_bf16 v[4:7], v[60:63], v[120:123], v[4:7]
    ds_read_b64_tr_b16 v[56:57], v92 offset:25344
    v_mfma_f32_16x16x32_bf16 v[20:23], v[60:63], v[124:127], v[20:23]
    ds_read_b64_tr_b16 v[58:59], v92 offset:27392
    v_mfma_f32_16x16x32_bf16 v[8:11], v[64:67], v[120:123], v[8:11]
    ds_read_b64_tr_b16 v[60:61], v93 offset:25344
    v_mfma_f32_16x16x32_bf16 v[24:27], v[64:67], v[124:127], v[24:27]
    ds_read_b64_tr_b16 v[62:63], v93 offset:27392
    buffer_load_dwordx4 v[112:115], v224, s[40:43], s71 offen offset:2048 sc1
    v_mfma_f32_16x16x32_bf16 v[12:15], v[68:71], v[120:123], v[12:15]
    ds_read_b64_tr_b16 v[64:65], v94 offset:25344
    v_mfma_f32_16x16x32_bf16 v[28:31], v[68:71], v[124:127], v[28:31]
    ds_read_b64_tr_b16 v[66:67], v94 offset:27392
    v_mfma_f32_16x16x32_bf16 v[16:19], v[36:39], v[120:123], v[16:19]
    ds_read_b64_tr_b16 v[68:69], v95 offset:25344
    v_mfma_f32_16x16x32_bf16 v[32:35], v[36:39], v[124:127], v[32:35]
    ds_read_b64_tr_b16 v[70:71], v95 offset:27392
    buffer_load_dwordx4 v[116:119], v225, s[40:43], s71 offen offset:2048 sc1
    s_waitcnt vmcnt(10) lgkmcnt(8)
    v_mfma_f32_16x16x32_bf16 v[4:7], v[40:43], v[128:131], v[4:7]
    ds_read_b64_tr_b16 v[36:37], v92 offset:29440
    v_mfma_f32_16x16x32_bf16 v[20:23], v[40:43], v[132:135], v[20:23]
    ds_read_b64_tr_b16 v[38:39], v92 offset:31488
    v_mfma_f32_16x16x32_bf16 v[8:11], v[44:47], v[128:131], v[8:11]
    ds_read_b64_tr_b16 v[40:41], v93 offset:29440
    v_mfma_f32_16x16x32_bf16 v[24:27], v[44:47], v[132:135], v[24:27]
    ds_read_b64_tr_b16 v[42:43], v93 offset:31488
    buffer_load_dwordx4 v[120:123], v224, s[40:43], s71 offen offset:3072 sc1
    v_mfma_f32_16x16x32_bf16 v[12:15], v[48:51], v[128:131], v[12:15]
    ds_read_b64_tr_b16 v[44:45], v94 offset:29440
    v_mfma_f32_16x16x32_bf16 v[28:31], v[48:51], v[132:135], v[28:31]
    ds_read_b64_tr_b16 v[46:47], v94 offset:31488
    v_mfma_f32_16x16x32_bf16 v[16:19], v[52:55], v[128:131], v[16:19]
    ds_read_b64_tr_b16 v[48:49], v95 offset:29440
    v_mfma_f32_16x16x32_bf16 v[32:35], v[52:55], v[132:135], v[32:35]
    ds_read_b64_tr_b16 v[50:51], v95 offset:31488
    buffer_load_dwordx4 v[124:127], v225, s[40:43], s71 offen offset:3072 sc1
    s_waitcnt vmcnt(10) lgkmcnt(8)
    v_mfma_f32_16x16x32_bf16 v[4:7], v[56:59], v[136:139], v[4:7]
    ds_read_b64_tr_b16 v[52:53], v84 offset:41984
    v_mfma_f32_16x16x32_bf16 v[20:23], v[56:59], v[140:143], v[20:23]
    ds_read_b64_tr_b16 v[54:55], v84 offset:44032
    v_mfma_f32_16x16x32_bf16 v[8:11], v[60:63], v[136:139], v[8:11]
    ds_read_b64_tr_b16 v[56:57], v85 offset:41984
    v_mfma_f32_16x16x32_bf16 v[24:27], v[60:63], v[140:143], v[24:27]
    ds_read_b64_tr_b16 v[58:59], v85 offset:44032
    v_mfma_f32_16x16x32_bf16 v[12:15], v[64:67], v[136:139], v[12:15]
    ds_read_b64_tr_b16 v[60:61], v86 offset:41984
    v_mfma_f32_16x16x32_bf16 v[28:31], v[64:67], v[140:143], v[28:31]
    ds_read_b64_tr_b16 v[62:63], v86 offset:44032
    v_mfma_f32_16x16x32_bf16 v[16:19], v[68:71], v[136:139], v[16:19]
    ds_read_b64_tr_b16 v[64:65], v87 offset:41984
    v_mfma_f32_16x16x32_bf16 v[32:35], v[68:71], v[140:143], v[32:35]
    ds_read_b64_tr_b16 v[66:67], v87 offset:44032
    s_waitcnt vmcnt(8) lgkmcnt(8)
    v_mfma_f32_16x16x32_bf16 v[4:7], v[36:39], v[144:147], v[4:7]
    ds_read_b64_tr_b16 v[68:69], v84 offset:46080
    v_mfma_f32_16x16x32_bf16 v[20:23], v[36:39], v[148:151], v[20:23]
    ds_read_b64_tr_b16 v[70:71], v84 offset:48128
    v_mfma_f32_16x16x32_bf16 v[8:11], v[40:43], v[144:147], v[8:11]
    ds_read_b64_tr_b16 v[36:37], v85 offset:46080
    v_mfma_f32_16x16x32_bf16 v[24:27], v[40:43], v[148:151], v[24:27]
    ds_read_b64_tr_b16 v[38:39], v85 offset:48128
    v_mfma_f32_16x16x32_bf16 v[12:15], v[44:47], v[144:147], v[12:15]
    ds_read_b64_tr_b16 v[40:41], v86 offset:46080
    v_mfma_f32_16x16x32_bf16 v[28:31], v[44:47], v[148:151], v[28:31]
    ds_read_b64_tr_b16 v[42:43], v86 offset:48128
    v_mfma_f32_16x16x32_bf16 v[16:19], v[48:51], v[144:147], v[16:19]
    ds_read_b64_tr_b16 v[44:45], v87 offset:46080
    v_mfma_f32_16x16x32_bf16 v[32:35], v[48:51], v[148:151], v[32:35]
    ds_read_b64_tr_b16 v[46:47], v87 offset:48128
    s_waitcnt vmcnt(6) lgkmcnt(8)
    v_mfma_f32_16x16x32_bf16 v[4:7], v[52:55], v[96:99], v[4:7]
    ds_read_b64_tr_b16 v[48:49], v84 offset:51200
    v_mfma_f32_16x16x32_bf16 v[20:23], v[52:55], v[100:103], v[20:23]
    ds_read_b64_tr_b16 v[50:51], v84 offset:53248
    v_mfma_f32_16x16x32_bf16 v[8:11], v[56:59], v[96:99], v[8:11]
    ds_read_b64_tr_b16 v[52:53], v85 offset:51200
    v_mfma_f32_16x16x32_bf16 v[24:27], v[56:59], v[100:103], v[24:27]
    ds_read_b64_tr_b16 v[54:55], v85 offset:53248
    v_mfma_f32_16x16x32_bf16 v[12:15], v[60:63], v[96:99], v[12:15]
    ds_read_b64_tr_b16 v[56:57], v86 offset:51200
    v_mfma_f32_16x16x32_bf16 v[28:31], v[60:63], v[100:103], v[28:31]
    ds_read_b64_tr_b16 v[58:59], v86 offset:53248
    v_mfma_f32_16x16x32_bf16 v[16:19], v[64:67], v[96:99], v[16:19]
    ds_read_b64_tr_b16 v[60:61], v87 offset:51200
    v_mfma_f32_16x16x32_bf16 v[32:35], v[64:67], v[100:103], v[32:35]
    ds_read_b64_tr_b16 v[62:63], v87 offset:53248
    s_waitcnt vmcnt(4) lgkmcnt(8)
    v_mfma_f32_16x16x32_bf16 v[4:7], v[68:71], v[104:107], v[4:7]
    ds_read_b64_tr_b16 v[64:65], v84 offset:55296
    v_mfma_f32_16x16x32_bf16 v[20:23], v[68:71], v[108:111], v[20:23]
    ds_read_b64_tr_b16 v[66:67], v84 offset:57344
    v_mfma_f32_16x16x32_bf16 v[8:11], v[36:39], v[104:107], v[8:11]
    ds_read_b64_tr_b16 v[68:69], v85 offset:55296
    v_mfma_f32_16x16x32_bf16 v[24:27], v[36:39], v[108:111], v[24:27]
    ds_read_b64_tr_b16 v[70:71], v85 offset:57344
    v_mfma_f32_16x16x32_bf16 v[12:15], v[40:43], v[104:107], v[12:15]
    ds_read_b64_tr_b16 v[36:37], v86 offset:55296
    v_mfma_f32_16x16x32_bf16 v[28:31], v[40:43], v[108:111], v[28:31]
    ds_read_b64_tr_b16 v[38:39], v86 offset:57344
    v_mfma_f32_16x16x32_bf16 v[16:19], v[44:47], v[104:107], v[16:19]
    ds_read_b64_tr_b16 v[40:41], v87 offset:55296
    v_mfma_f32_16x16x32_bf16 v[32:35], v[44:47], v[108:111], v[32:35]
    ds_read_b64_tr_b16 v[42:43], v87 offset:57344
    s_waitcnt vmcnt(2) lgkmcnt(8)
    v_mfma_f32_16x16x32_bf16 v[4:7], v[48:51], v[112:115], v[4:7]
    s_mul_i32 s37, s32, 80896
    s_lshl_b32 s38, s33, 11
    v_mfma_f32_16x16x32_bf16 v[20:23], v[48:51], v[116:119], v[20:23]
    s_add_u32 s37, s37, s38
    s_add_u32 s37, s37, 78848
    v_mfma_f32_16x16x32_bf16 v[8:11], v[52:55], v[112:115], v[8:11]
    v_lshrrev_b32 v1, 5, v0
    v_xor_b32 v1, v1, v0
    v_mfma_f32_16x16x32_bf16 v[24:27], v[52:55], v[116:119], v[24:27]
    v_and_b32 v1, 7, v1
    v_lshl_add_u32 v1, v1, 4, s37
    v_mfma_f32_16x16x32_bf16 v[12:15], v[56:59], v[112:115], v[12:15]
    v_bfe_u32 v2, v0, 4, 1
    v_lshl_add_u32 v1, v2, 3, v1
    v_mfma_f32_16x16x32_bf16 v[28:31], v[56:59], v[116:119], v[28:31]
    v_and_b32 v2, 15, v0
    v_lshl_add_u32 v84, v2, 7, v1
    v_mfma_f32_16x16x32_bf16 v[16:19], v[60:63], v[112:115], v[16:19]
    v_xor_b32 v85, 32, v84
    v_xor_b32 v86, 64, v84
    v_mfma_f32_16x16x32_bf16 v[32:35], v[60:63], v[116:119], v[32:35]
    v_xor_b32 v87, 96, v84
    v_lshrrev_b32 v1, 3, v0
    s_waitcnt vmcnt(0) lgkmcnt(0)
    v_mfma_f32_16x16x32_bf16 v[4:7], v[64:67], v[120:123], v[4:7]
    v_xor_b32 v1, v1, v0
    v_and_b32 v1, 7, v1
    v_mfma_f32_16x16x32_bf16 v[20:23], v[64:67], v[124:127], v[20:23]
    v_and_b32 v2, 56, v0
    v_add_u32 v1, v1, v2
    v_mfma_f32_16x16x32_bf16 v[8:11], v[68:71], v[120:123], v[8:11]
    v_lshl_add_u32 v88, v1, 4, s37
    v_mfma_f32_16x16x32_bf16 v[24:27], v[68:71], v[124:127], v[24:27]
    v_mfma_f32_16x16x32_bf16 v[12:15], v[36:39], v[120:123], v[12:15]
    v_mfma_f32_16x16x32_bf16 v[28:31], v[36:39], v[124:127], v[28:31]
    v_mfma_f32_16x16x32_bf16 v[16:19], v[40:43], v[120:123], v[16:19]
    v_mfma_f32_16x16x32_bf16 v[32:35], v[40:43], v[124:127], v[32:35]
    v_cvt_pk_bf16_f32 v36, v4, v5
    v_cvt_pk_bf16_f32 v37, v6, v7
    ds_write_b64 v84, v[36:37]
    v_cvt_pk_bf16_f32 v38, v8, v9
    v_cvt_pk_bf16_f32 v39, v10, v11
    ds_write_b64 v85, v[38:39]
    v_cvt_pk_bf16_f32 v40, v12, v13
    v_cvt_pk_bf16_f32 v41, v14, v15
    ds_write_b64 v86, v[40:41]
    v_cvt_pk_bf16_f32 v42, v16, v17
    v_cvt_pk_bf16_f32 v43, v18, v19
    ds_write_b64 v87, v[42:43]
    ds_read_b128 v[52:55], v88 offset:0
    ds_read_b128 v[56:59], v88 offset:1024
    v_cvt_pk_bf16_f32 v44, v20, v21
    v_cvt_pk_bf16_f32 v45, v22, v23
    ds_write_b64 v84, v[44:45]
    v_cvt_pk_bf16_f32 v46, v24, v25
    v_cvt_pk_bf16_f32 v47, v26, v27
    ds_write_b64 v85, v[46:47]
    v_cvt_pk_bf16_f32 v48, v28, v29
    v_cvt_pk_bf16_f32 v49, v30, v31
    ds_write_b64 v86, v[48:49]
    v_cvt_pk_bf16_f32 v50, v32, v33
    v_cvt_pk_bf16_f32 v51, v34, v35
    ds_write_b64 v87, v[50:51]
    ds_read_b128 v[60:63], v88 offset:0
    ds_read_b128 v[64:67], v88 offset:1024
    s_mov_b32 s37, 0
    s_waitcnt lgkmcnt(7)
    buffer_store_dwordx4 v[52:55], v226, s[48:51], s37 offen nt
    s_mov_b32 s37, 65536
    s_waitcnt lgkmcnt(6)
    buffer_store_dwordx4 v[56:59], v226, s[48:51], s37 offen nt
    s_mov_b32 s37, 131072
    s_waitcnt lgkmcnt(1)
    buffer_store_dwordx4 v[60:63], v226, s[48:51], s37 offen nt
    s_mov_b32 s37, 196608
    s_waitcnt lgkmcnt(0)
    buffer_store_dwordx4 v[64:67], v226, s[48:51], s37 offen nt
    s_endpgm
L_g1_rare:
    s_waitcnt vmcnt(0)
    s_cmp_lg_u32 s36, 1
    s_cbranch_scc1 L_g1_bar
    v_readfirstlane_b32 s38, v1
    s_nop 0
    s_cmp_ge_u32 s38, 4
    s_cbranch_scc1 L_sl_done_56
    s_mov_b32 s39, 1048576
L_sl_loop_57:
    ds_read_b32 v1, v228 offset:24
    s_waitcnt lgkmcnt(0)
    v_readfirstlane_b32 s38, v1
    s_nop 0
    s_cmp_ge_u32 s38, 4
    s_cbranch_scc1 L_sl_done_56
    s_sleep 1
    s_sub_u32 s39, s39, 1
    s_cbranch_scc0 L_sl_loop_57
L_sl_done_56:
    s_branch L_g1_nobar
L_end:
    s_endpgm
.section .rodata,"a"
.p2align 6
.amdhsa_kernel concat_heads__ssm_conv_h3__sliding_local_dilated__prompt_kernel
  .amdhsa_next_free_vgpr 256
  .amdhsa_next_free_sgpr 102
  .amdhsa_accum_offset 256
  .amdhsa_group_segment_fixed_size 0
  .amdhsa_kernarg_size 96
  .amdhsa_user_sgpr_count 2
  .amdhsa_user_sgpr_kernarg_segment_ptr 1
  .amdhsa_system_sgpr_workgroup_id_x 1
  .amdhsa_float_denorm_mode_32 3
.end_amdhsa_kernel
```

```asm
; @launch grid=(256,1,1) block=(512,1,1) lds=163840
.amdgcn_target "amdgcn-amd-amdhsa--gfx950"
.text
.globl concat_heads__ssm_conv_h3__sliding_local_dilated__prompt_kernel
.p2align 8
.type concat_heads__ssm_conv_h3__sliding_local_dilated__prompt_kernel,@function
concat_heads__ssm_conv_h3__sliding_local_dilated__prompt_kernel:
L_entry:
    s_getpc_b64 s[32:33]
    s_cmp_ge_u32 s2, 256
    s_cbranch_scc1 L_end
    s_load_dwordx16 s[8:23], s[0:1], 0
    s_load_dwordx8 s[24:31], s[0:1], 64
    v_lshrrev_b32 v1, 6, v0
    s_and_b32 s4, s2, 1
    v_readfirstlane_b32 s3, v1
    v_and_b32 v0, 63, v0
    s_bfe_u32 s5, s2, 0x30003
    s_bfe_u32 s6, s2, 0x20001
    s_lshr_b32 s7, s2, 6
    s_lshl2_add_u32 s6, s6, s7
    s_cmp_ge_u32 s3, 4
    s_cbranch_scc1 L_crole
    s_bfe_u32 s34, s2, 0x20003
    s_lshl2_add_u32 s34, s34, s3
    s_lshl_b32 s34, s34, 7
    v_lshl_add_u32 v1, v0, 11, s34
    v_min_u32 v1, L_end-L_entry-8, v1
    s_mov_b64 exec, 0xffff
    global_load_dword v249, v1, s[32:33]
    s_mov_b64 exec, -1
    s_and_b32 s84, s2, 3
    s_lshl2_add_u32 s84, s84, s3
    s_lshr_b32 s85, s2, 2
    s_mul_i32 s86, s3, 8448
    s_add_u32 s86, s86, 125952
    s_lshl_b32 s87, s85, 9
    s_add_u32 s87, s87, s84
    s_lshl_b32 s87, s87, 7
    v_and_b32 v231, 7, v0
    v_lshl_add_u32 v231, v231, 4, s87
    v_lshrrev_b32 v230, 3, v0
    v_lshl_add_u32 v230, v230, 13, v231
    v_subrev_u32 v231, 6144, v230
    v_subrev_u32 v232, 4096, v230
    v_subrev_u32 v233, 2048, v230
    v_add_u32 v234, 4096, v230
    v_lshlrev_b32 v235, 4, v0
    s_lshl_b32 s87, s84, 9
    s_add_u32 m0, s86, 4224
    s_waitcnt lgkmcnt(0)
    s_mov_b32 s80, s14
    s_mov_b32 s81, s15
    s_mov_b32 s82, 0x2000
    s_mov_b32 s83, 0x20000
    s_mov_b32 s72, s10
    s_mov_b32 s73, s11
    s_mov_b32 s74, 0x400000
    s_mov_b32 s75, 0x20000
    s_mov_b32 exec_hi, 0
    buffer_load_dwordx4 v235, s[80:83], s87 offen lds
    s_mov_b64 exec, -1
    buffer_load_dwordx4 v[108:111], v231, s[72:75], 0 offen offset:0 nt
    buffer_load_dwordx4 v[112:115], v232, s[72:75], 0 offen offset:0 nt
    buffer_load_dwordx4 v[116:119], v233, s[72:75], 0 offen offset:0 nt
    buffer_load_dwordx4 v[120:123], v230, s[72:75], 0 offen offset:0 nt
    buffer_load_dwordx4 v[124:127], v230, s[72:75], 0 offen offset:2048 nt
    buffer_load_dwordx4 v[128:131], v234, s[72:75], 0 offen offset:0 nt
    buffer_load_dwordx4 v[132:135], v234, s[72:75], 0 offen offset:2048 nt
    s_mov_b32 s76, s12
    s_mov_b32 s77, s13
    s_mov_b32 s78, 0x400000
    s_mov_b32 s79, 0x20000
    buffer_load_dwordx4 v[136:139], v230, s[76:79], 0 offen offset:0 nt
    buffer_load_dwordx4 v[140:143], v230, s[76:79], 0 offen offset:2048 nt
    buffer_load_dwordx4 v[144:147], v234, s[76:79], 0 offen offset:0 nt
    buffer_load_dwordx4 v[148:151], v234, s[76:79], 0 offen offset:2048 nt
    s_branch L_grole
L_crole:
    s_sub_u32 s70, s3, 4
    s_lshl_b32 s43, s70, 12
    s_lshl_b32 s44, s70, 11
    s_add_u32 s44, s44, 17408
    s_lshl_b32 s49, s70, 4
    s_lshl_b64 s[46:47], 0xffff, s49
    v_lshrrev_b32 v13, 3, v0
    v_and_b32 v14, 7, v0
    v_lshrrev_b32 v15, 4, v0
    s_lshl2_add_u32 s50, s5, s70
    s_lshl_b32 s50, s50, 6
    s_add_u32 s50, s50, s4
    s_lshl_b32 s50, s50, 11
    v_lshl_add_u32 v16, v13, 12, s50
    v_xor_b32 v17, v14, v15
    v_lshl_add_u32 v2, v17, 4, v16
    v_xor_b32 v3, 64, v2
    v_add_u32 v3, 31744, v3
    v_add_u32 v4, 63488, v2
    v_add_u32 v5, 63488, v3
    s_lshl_b32 s49, s5, 7
    s_sub_u32 s49, s49, 8
    s_max_i32 s49, s49, 0
    s_lshl1_add_u32 s49, s49, s4
    s_lshl_b32 s49, s49, 11
    v_lshl_add_u32 v16, v13, 12, s49
    v_lshlrev_b32 v17, 1, v15
    v_xor_b32 v18, v14, v13
    v_lshl_add_u32 v6, v18, 4, v16
    s_mul_i32 s49, s70, 768
    s_add_u32 s49, s49, s6
    s_lshl_b32 s49, s49, 7
    v_mul_u32_u24 v16, 6144, v13
    v_and_b32 v17, 2, v17
    v_xor_b32 v17, v14, v17
    v_lshlrev_b32 v17, 4, v17
    v_add3_u32 v7, v17, v16, s49
    v_xor_b32 v8, 64, v7
    v_add_u32 v8, 48128, v8
    v_add_u32 v9, 2048, v7
    v_add_u32 v10, 2048, v8
    v_add_u32 v11, 4096, v7
    v_add_u32 v12, 4096, v8
    s_movk_i32 s40, 0
    s_mov_b32 s41, 0
    s_lshr_b32 s90, s2, 3
    s_and_b32 s91, s3, 3
    s_lshl2_add_u32 s90, s90, s91
    s_and_b32 s91, s2, 6
    s_lshl3_add_u32 s88, s90, s91
    s_lshl1_add_u32 s88, s88, s4
    s_lshl_b32 s88, s88, 11
    s_and_b32 s89, s2, 7
    s_and_b32 s91, s90, 1
    s_lshl1_add_u32 s89, s89, s91
    s_lshr_b32 s90, s90, 1
    s_mul_i32 s90, s90, 48
    s_add_u32 s89, s89, s90
    s_lshl_b32 s89, s89, 7
    v_and_b32 v251, 1, v0
    v_lshlrev_b32 v251, 12, v251
    v_lshrrev_b32 v252, 1, v0
    v_lshl_add_u32 v251, v252, 7, v251
    v_lshrrev_b32 v250, 2, v0
    v_mul_u32_u24 v250, 393216, v250
    v_and_b32 v252, 3, v0
    v_lshl_add_u32 v252, v252, 11, v250
    s_waitcnt lgkmcnt(0)
    s_mov_b32 s32, s20
    s_mov_b32 s33, s21
    s_mov_b32 s34, 0x400000
    s_mov_b32 s35, 0x20000
    s_mov_b32 s36, s22
    s_mov_b32 s37, s23
    s_mov_b32 s38, 0x600000
    s_mov_b32 s39, 0x20000
    s_setprio 0
    s_and_b32 s73, s2, 7
    s_xor_b32 s73, s73, 2
    s_lshr_b32 s74, s2, 7
    s_lshl1_add_u32 s68, s73, s74
    s_bfe_u32 s69, s2, 0x40003
    s_lshl4_add_u32 s71, s68, s69
    s_lshl2_add_u32 s71, s71, s70
    s_mul_i32 s80, s70, 8448
    s_add_u32 s80, s80, 125952
    s_mul_i32 s81, s70, 9216
    s_add_u32 s81, s81, 41984
    s_add_u32 s52, s30, 0xe00000
    s_addc_u32 s53, s31, 0
    s_mov_b32 s54, 0x20000
    s_mov_b32 s55, 0x20000
    s_add_u32 s64, s30, 0x900000
    s_addc_u32 s65, s31, 0
    s_mov_b32 s66, 0x420000
    s_mov_b32 s67, 0x20000
    s_lshl_b32 s84, s71, 12
    s_mul_i32 s85, s71, 4224
    s_add_u32 s85, s85, 4194304
    s_lshr_b32 s72, s71, 1
    s_lshl_b32 s72, s72, 2
    s_load_dword s72, s[18:19], s72
    v_lshlrev_b32 v224, 4, v0
    v_mov_b32 v228, 0
    v_mov_b32 v229, 0
    v_mov_b32 v230, 0
    v_mov_b32 v231, 0
    v_mov_b32 v227, 134352
    v_mov_b32 v244, 1
    s_bfe_u32 s87, s2, 0x10003
    s_mov_b64 exec, 1
    ds_write_b128 v227, v[228:231]
    ds_write_b128 v227, v[228:231] offset:16
    ds_write_b128 v227, v[228:231] offset:32
    s_mov_b64 exec, -1
    s_mov_b32 exec_lo, 0x7777
    s_mov_b32 exec_hi, 0x0
    s_bfe_u32 s7, s89, 0x30007
    s_cmp_lg_u32 s7, 1
    s_cbranch_scc1 L_wx3_1
    buffer_load_dword v250, v252, s[36:39], s89 offen offset:256
L_wx3_1:
    buffer_load_dword v250, v252, s[36:39], s89 offen
    s_mov_b32 exec_lo, 0xff
    s_mov_b32 exec_hi, 0
    buffer_load_dword v250, v251, s[32:35], s88 offen
    s_mov_b64 exec, -1
    s_add_u32 m0, s43, 0
    s_nop 0
    buffer_load_dwordx4 v2, s[32:35], s40 offen offset:0 lds
    s_add_u32 m0, s44, 0
    s_nop 0
    buffer_load_dwordx4 v7, s[36:39], s41 offen offset:0 lds
    buffer_load_dwordx4 v8, s[36:39], s41 offen offset:1024 lds
    s_add_u32 m0, s43, 0
    s_nop 0
    buffer_load_dwordx4 v3, s[32:35], s40 offen offset:1024 lds
    s_add_u32 m0, s44, 8192
    s_nop 0
    buffer_load_dwordx4 v9, s[36:39], s41 offen offset:0 lds
    buffer_load_dwordx4 v10, s[36:39], s41 offen offset:1024 lds
    s_add_u32 m0, s43, 0
    s_nop 0
    buffer_load_dwordx4 v4, s[32:35], s40 offen offset:2048 lds
    s_add_u32 m0, s44, 16384
    s_nop 0
    buffer_load_dwordx4 v11, s[36:39], s41 offen offset:0 lds
    buffer_load_dwordx4 v12, s[36:39], s41 offen offset:1024 lds
    s_add_u32 m0, s43, 0
    s_nop 0
    buffer_load_dwordx4 v5, s[32:35], s40 offen offset:3072 lds
    s_mov_b32 m0, 16384
    s_mov_b64 exec, s[46:47]
    buffer_load_dwordx4 v6, s[32:35], s40 offen lds
    s_mov_b64 exec, -1
    s_movk_i32 s40, 128
    s_mov_b32 s41, 393216
    s_add_u32 m0, s43, 41984
    s_nop 0
    buffer_load_dwordx4 v2, s[32:35], s40 offen offset:0 lds
    s_add_u32 m0, s44, 41984
    s_nop 0
    buffer_load_dwordx4 v7, s[36:39], s41 offen offset:0 lds
    buffer_load_dwordx4 v8, s[36:39], s41 offen offset:1024 lds
    s_add_u32 m0, s43, 41984
    s_nop 0
    buffer_load_dwordx4 v3, s[32:35], s40 offen offset:1024 lds
    s_add_u32 m0, s44, 50176
    s_nop 0
    buffer_load_dwordx4 v9, s[36:39], s41 offen offset:0 lds
    buffer_load_dwordx4 v10, s[36:39], s41 offen offset:1024 lds
    s_add_u32 m0, s43, 41984
    s_nop 0
    buffer_load_dwordx4 v4, s[32:35], s40 offen offset:2048 lds
    s_add_u32 m0, s44, 58368
    s_nop 0
    buffer_load_dwordx4 v11, s[36:39], s41 offen offset:0 lds
    buffer_load_dwordx4 v12, s[36:39], s41 offen offset:1024 lds
    s_add_u32 m0, s43, 41984
    s_nop 0
    buffer_load_dwordx4 v5, s[32:35], s40 offen offset:3072 lds
    s_mov_b32 m0, 58368
    s_mov_b64 exec, s[46:47]
    buffer_load_dwordx4 v6, s[32:35], s40 offen lds
    s_mov_b64 exec, -1
    s_movk_i32 s40, 256
    s_mov_b32 s41, 786432
    s_lshr_b32 s74, s69, 2
    s_and_b32 s75, s69, 3
    s_lshl3_add_u32 s74, s74, s75
    s_lshl3_add_u32 s74, s74, s70
    s_lshl_b32 s74, s74, 3
    v_bfe_u32 v234, v0, 3, 1
    v_lshl_add_u32 v225, v234, 8, s74
    v_bfe_u32 v234, v0, 4, 1
    v_lshl_add_u32 v225, v234, 1, v225
    v_lshrrev_b32 v234, 5, v0
    v_lshl_add_u32 v225, v234, 5, v225
    s_lshl_b32 s74, s68, 7
    v_and_b32 v234, 7, v0
    v_lshl_add_u32 v234, v234, 4, s74
    v_lshl_add_u32 v226, v225, 12, v234
    v_lshl_add_u32 v225, v225, 11, v234
    v_and_b32 v234, 1, v0
    v_xor_b32 v234, 1, v234
    v_mul_u32_u24 v232, 4224, v234
    v_mul_u32_u24 v233, 4576, v234
    v_bfe_u32 v234, v0, 1, 3
    v_lshl_add_u32 v232, v234, 3, v232
    v_xor_b32 v234, 7, v234
    v_lshl_add_u32 v233, v234, 6, v233
    v_lshrrev_b32 v234, 4, v0
    v_lshl_add_u32 v232, v234, 4, v232
    v_lshl_add_u32 v233, v234, 4, v233
    v_add3_u32 v232, v232, s80, 8
    v_add_u32 v233, s81, v233
    s_waitcnt lgkmcnt(0)
    s_bitcmp1_b32 s71, 0
    s_cselect_b32 s74, 0, 16
    s_lshl_b32 s72, s72, s74
    s_and_b32 s72, s72, 0xffff0000
    v_and_b32 v235, 1, v0
    v_lshlrev_b32 v235, 4, v235
    v_lshrrev_b32 v235, v235, s72
    v_bfe_u32 v236, v0, 1, 3
    v_lshl_add_u32 v236, v234, 1, v236
    v_cmp_eq_u32 vcc, 7, v236
    v_mov_b32 v241, 0
    v_mov_b32 v243, 0
    v_cndmask_b32 v240, 0, v235, vcc
    v_cmp_eq_u32 vcc, 6, v236
    s_nop 1
    v_cndmask_b32 v242, 0, v235, vcc
    s_waitcnt vmcnt(11)
    s_barrier
    s_add_u32 m0, s43, 83968
    s_nop 0
    buffer_load_dwordx4 v2, s[32:35], s40 offen offset:0 lds
    s_add_u32 m0, s44, 83968
    s_nop 0
    buffer_load_dwordx4 v7, s[36:39], s41 offen offset:0 lds
    buffer_load_dwordx4 v8, s[36:39], s41 offen offset:1024 lds
    s_add_u32 m0, s43, 83968
    s_nop 0
    buffer_load_dwordx4 v3, s[32:35], s40 offen offset:1024 lds
    s_add_u32 m0, s44, 92160
    s_nop 0
    buffer_load_dwordx4 v9, s[36:39], s41 offen offset:0 lds
    buffer_load_dwordx4 v10, s[36:39], s41 offen offset:1024 lds
    s_add_u32 m0, s43, 83968
    s_nop 0
    buffer_load_dwordx4 v4, s[32:35], s40 offen offset:2048 lds
    s_add_u32 m0, s44, 100352
    s_nop 0
    buffer_load_dwordx4 v11, s[36:39], s41 offen offset:0 lds
    buffer_load_dwordx4 v12, s[36:39], s41 offen offset:1024 lds
    s_add_u32 m0, s43, 83968
    s_nop 0
    buffer_load_dwordx4 v5, s[32:35], s40 offen offset:3072 lds
    s_mov_b32 m0, 100352
    s_mov_b64 exec, s[46:47]
    buffer_load_dwordx4 v6, s[32:35], s40 offen lds
    s_mov_b64 exec, -1
    s_movk_i32 s40, 384
    s_mov_b32 s41, 1179648
    s_waitcnt vmcnt(11)
    s_barrier
    s_add_u32 m0, s43, 0
    s_nop 0
    buffer_load_dwordx4 v2, s[32:35], s40 offen offset:0 lds
    s_add_u32 m0, s44, 0
    s_nop 0
    buffer_load_dwordx4 v7, s[36:39], s41 offen offset:0 lds
    buffer_load_dwordx4 v8, s[36:39], s41 offen offset:1024 lds
    s_add_u32 m0, s43, 0
    s_nop 0
    buffer_load_dwordx4 v3, s[32:35], s40 offen offset:1024 lds
    s_add_u32 m0, s44, 8192
    s_nop 0
    buffer_load_dwordx4 v9, s[36:39], s41 offen offset:0 lds
    buffer_load_dwordx4 v10, s[36:39], s41 offen offset:1024 lds
    s_add_u32 m0, s43, 0
    s_nop 0
    buffer_load_dwordx4 v4, s[32:35], s40 offen offset:2048 lds
    s_add_u32 m0, s44, 16384
    s_nop 0
    buffer_load_dwordx4 v11, s[36:39], s41 offen offset:0 lds
    buffer_load_dwordx4 v12, s[36:39], s41 offen offset:1024 lds
    s_add_u32 m0, s43, 0
    s_nop 0
    buffer_load_dwordx4 v5, s[32:35], s40 offen offset:3072 lds
    s_mov_b32 m0, 16384
    s_mov_b64 exec, s[46:47]
    buffer_load_dwordx4 v6, s[32:35], s40 offen lds
    s_mov_b64 exec, -1
    s_movk_i32 s40, 512
    s_mov_b32 s41, 1572864
    s_mov_b32 exec_lo, 0x77770000
    s_mov_b32 exec_hi, 0x0
    s_bfe_u32 s7, s89, 0x30007
    s_cmp_lg_u32 s7, 1
    s_cbranch_scc1 L_wx3_4
    buffer_load_dword v250, v252, s[36:39], s89 offen offset:256
L_wx3_4:
    buffer_load_dword v250, v252, s[36:39], s89 offen
    s_mov_b32 exec_lo, 0xff00
    s_mov_b32 exec_hi, 0
    buffer_load_dword v250, v251, s[32:35], s88 offen
    s_mov_b64 exec, -1
    s_waitcnt vmcnt(13)
    s_barrier
    s_add_u32 m0, s43, 41984
    s_nop 0
    buffer_load_dwordx4 v2, s[32:35], s40 offen offset:0 lds
    s_add_u32 m0, s44, 41984
    s_nop 0
    buffer_load_dwordx4 v7, s[36:39], s41 offen offset:0 lds
    buffer_load_dwordx4 v8, s[36:39], s41 offen offset:1024 lds
    s_add_u32 m0, s43, 41984
    s_nop 0
    buffer_load_dwordx4 v3, s[32:35], s40 offen offset:1024 lds
    s_add_u32 m0, s44, 50176
    s_nop 0
    buffer_load_dwordx4 v9, s[36:39], s41 offen offset:0 lds
    buffer_load_dwordx4 v10, s[36:39], s41 offen offset:1024 lds
    s_add_u32 m0, s43, 41984
    s_nop 0
    buffer_load_dwordx4 v4, s[32:35], s40 offen offset:2048 lds
    s_add_u32 m0, s44, 58368
    s_nop 0
    buffer_load_dwordx4 v11, s[36:39], s41 offen offset:0 lds
    buffer_load_dwordx4 v12, s[36:39], s41 offen offset:1024 lds
    s_add_u32 m0, s43, 41984
    s_nop 0
    buffer_load_dwordx4 v5, s[32:35], s40 offen offset:3072 lds
    s_mov_b32 m0, 58368
    s_mov_b64 exec, s[46:47]
    buffer_load_dwordx4 v6, s[32:35], s40 offen lds
    s_mov_b64 exec, -1
    s_movk_i32 s40, 640
    s_mov_b32 s41, 1966080
    s_waitcnt vmcnt(13)
    s_barrier
    s_add_u32 m0, s43, 83968
    s_nop 0
    buffer_load_dwordx4 v2, s[32:35], s40 offen offset:0 lds
    s_add_u32 m0, s44, 83968
    s_nop 0
    buffer_load_dwordx4 v7, s[36:39], s41 offen offset:0 lds
    buffer_load_dwordx4 v8, s[36:39], s41 offen offset:1024 lds
    s_add_u32 m0, s43, 83968
    s_nop 0
    buffer_load_dwordx4 v3, s[32:35], s40 offen offset:1024 lds
    s_add_u32 m0, s44, 92160
    s_nop 0
    buffer_load_dwordx4 v9, s[36:39], s41 offen offset:0 lds
    buffer_load_dwordx4 v10, s[36:39], s41 offen offset:1024 lds
    s_add_u32 m0, s43, 83968
    s_nop 0
    buffer_load_dwordx4 v4, s[32:35], s40 offen offset:2048 lds
    s_add_u32 m0, s44, 100352
    s_nop 0
    buffer_load_dwordx4 v11, s[36:39], s41 offen offset:0 lds
    buffer_load_dwordx4 v12, s[36:39], s41 offen offset:1024 lds
    s_add_u32 m0, s43, 83968
    s_nop 0
    buffer_load_dwordx4 v5, s[32:35], s40 offen offset:3072 lds
    s_mov_b32 m0, 100352
    s_mov_b64 exec, s[46:47]
    buffer_load_dwordx4 v6, s[32:35], s40 offen lds
    s_mov_b64 exec, -1
    s_movk_i32 s40, 768
    s_mov_b32 s41, 2359296
    s_cmp_lg_u32 s87, 0
    s_cbranch_scc1 L_stg_7
    s_mov_b32 exec_lo, 0x0
    s_mov_b32 exec_hi, 0x7777
    s_bfe_u32 s7, s89, 0x30007
    s_cmp_lg_u32 s7, 1
    s_cbranch_scc1 L_wx3_8
    buffer_load_dword v250, v252, s[36:39], s89 offen offset:256
L_wx3_8:
    buffer_load_dword v250, v252, s[36:39], s89 offen
    s_mov_b32 exec_lo, 0xff0000
    s_mov_b32 exec_hi, 0
    buffer_load_dword v250, v251, s[32:35], s88 offen
    s_mov_b64 exec, -1
L_stg_7:
    s_waitcnt vmcnt(13)
    s_bitcmp1_b32 1, s87
    s_cbranch_scc1 L_mw_9
    s_waitcnt vmcnt(11)
L_mw_9:
    s_barrier
    s_add_u32 m0, s43, 0
    s_nop 0
    buffer_load_dwordx4 v2, s[32:35], s40 offen offset:0 lds
    s_add_u32 m0, s44, 0
    s_nop 0
    buffer_load_dwordx4 v7, s[36:39], s41 offen offset:0 lds
    buffer_load_dwordx4 v8, s[36:39], s41 offen offset:1024 lds
    s_add_u32 m0, s43, 0
    s_nop 0
    buffer_load_dwordx4 v3, s[32:35], s40 offen offset:1024 lds
    s_add_u32 m0, s44, 8192
    s_nop 0
    buffer_load_dwordx4 v9, s[36:39], s41 offen offset:0 lds
    buffer_load_dwordx4 v10, s[36:39], s41 offen offset:1024 lds
    s_add_u32 m0, s43, 0
    s_nop 0
    buffer_load_dwordx4 v4, s[32:35], s40 offen offset:2048 lds
    s_add_u32 m0, s44, 16384
    s_nop 0
    buffer_load_dwordx4 v11, s[36:39], s41 offen offset:0 lds
    buffer_load_dwordx4 v12, s[36:39], s41 offen offset:1024 lds
    s_add_u32 m0, s43, 0
    s_nop 0
    buffer_load_dwordx4 v5, s[32:35], s40 offen offset:3072 lds
    s_mov_b32 m0, 16384
    s_mov_b64 exec, s[46:47]
    buffer_load_dwordx4 v6, s[32:35], s40 offen lds
    s_mov_b64 exec, -1
    s_movk_i32 s40, 896
    s_mov_b32 s41, 2752512
    s_cmp_lg_u32 s87, 1
    s_cbranch_scc1 L_stg_10
    s_mov_b32 exec_lo, 0x0
    s_mov_b32 exec_hi, 0x7777
    s_bfe_u32 s7, s89, 0x30007
    s_cmp_lg_u32 s7, 1
    s_cbranch_scc1 L_wx3_11
    buffer_load_dword v250, v252, s[36:39], s89 offen offset:256
L_wx3_11:
    buffer_load_dword v250, v252, s[36:39], s89 offen
    s_mov_b32 exec_lo, 0xff0000
    s_mov_b32 exec_hi, 0
    buffer_load_dword v250, v251, s[32:35], s88 offen
    s_mov_b64 exec, -1
L_stg_10:
    s_bfe_u32 s74, s2, 0x20003
    s_lshl2_add_u32 s74, s74, s70
    s_cmp_lg_u32 s74, 0
    s_cbranch_scc1 L_sig_12
    s_mov_b32 s60, s28
    s_mov_b32 s61, s29
    s_mov_b32 s62, 0x100
    s_mov_b32 s63, 0x20000
    s_and_b32 s74, s2, 3
    s_lshl_b32 s74, s74, 6
    s_mov_b64 exec, 1
    buffer_atomic_add v244, off, s[60:63], s74 sc1
    s_mov_b64 exec, -1
L_sig_12:
    s_load_dwordx2 s[90:91], s[16:17], s84 offset:60
    s_load_dwordx2 s[90:91], s[16:17], s84 offset:188
    s_load_dwordx2 s[90:91], s[16:17], s84 offset:316
    s_load_dwordx2 s[90:91], s[16:17], s84 offset:444
    s_waitcnt vmcnt(13)
    s_barrier
    s_add_u32 m0, s43, 41984
    s_nop 0
    buffer_load_dwordx4 v2, s[32:35], s40 offen offset:0 lds
    s_add_u32 m0, s44, 41984
    s_nop 0
    buffer_load_dwordx4 v7, s[36:39], s41 offen offset:0 lds
    buffer_load_dwordx4 v8, s[36:39], s41 offen offset:1024 lds
    s_add_u32 m0, s43, 41984
    s_nop 0
    buffer_load_dwordx4 v3, s[32:35], s40 offen offset:1024 lds
    s_add_u32 m0, s44, 50176
    s_nop 0
    buffer_load_dwordx4 v9, s[36:39], s41 offen offset:0 lds
    buffer_load_dwordx4 v10, s[36:39], s41 offen offset:1024 lds
    s_add_u32 m0, s43, 41984
    s_nop 0
    buffer_load_dwordx4 v4, s[32:35], s40 offen offset:2048 lds
    s_add_u32 m0, s44, 58368
    s_nop 0
    buffer_load_dwordx4 v11, s[36:39], s41 offen offset:0 lds
    buffer_load_dwordx4 v12, s[36:39], s41 offen offset:1024 lds
    s_add_u32 m0, s43, 41984
    s_nop 0
    buffer_load_dwordx4 v5, s[32:35], s40 offen offset:3072 lds
    s_mov_b32 m0, 58368
    s_mov_b64 exec, s[46:47]
    buffer_load_dwordx4 v6, s[32:35], s40 offen lds
    s_mov_b64 exec, -1
    s_movk_i32 s40, 1024
    s_mov_b32 s41, 3145728
    s_bfe_u32 s74, s2, 0x20003
    s_lshl2_add_u32 s74, s74, s70
    s_cmp_lg_u32 s74, 4
    s_cbranch_scc1 L_sig_14
    s_mov_b32 s60, s28
    s_mov_b32 s61, s29
    s_mov_b32 s62, 0x100
    s_mov_b32 s63, 0x20000
    s_and_b32 s74, s2, 3
    s_lshl_b32 s74, s74, 6
    s_mov_b64 exec, 1
    buffer_atomic_add v244, off, s[60:63], s74 sc1
    s_mov_b64 exec, -1
L_sig_14:
    s_load_dwordx2 s[90:91], s[16:17], s84 offset:572
    s_load_dwordx2 s[90:91], s[16:17], s84 offset:700
    s_load_dwordx2 s[90:91], s[16:17], s84 offset:828
    s_load_dwordx2 s[90:91], s[16:17], s84 offset:956
    s_waitcnt vmcnt(13)
    s_bitcmp1_b32 2, s87
    s_cbranch_scc1 L_mw_15
    s_waitcnt vmcnt(11)
L_mw_15:
    s_barrier
    s_add_u32 m0, s43, 83968
    s_nop 0
    buffer_load_dwordx4 v2, s[32:35], s40 offen offset:0 lds
    s_add_u32 m0, s44, 83968
    s_nop 0
    buffer_load_dwordx4 v7, s[36:39], s41 offen offset:0 lds
    buffer_load_dwordx4 v8, s[36:39], s41 offen offset:1024 lds
    s_add_u32 m0, s43, 83968
    s_nop 0
    buffer_load_dwordx4 v3, s[32:35], s40 offen offset:1024 lds
    s_add_u32 m0, s44, 92160
    s_nop 0
    buffer_load_dwordx4 v9, s[36:39], s41 offen offset:0 lds
    buffer_load_dwordx4 v10, s[36:39], s41 offen offset:1024 lds
    s_add_u32 m0, s43, 83968
    s_nop 0
    buffer_load_dwordx4 v4, s[32:35], s40 offen offset:2048 lds
    s_add_u32 m0, s44, 100352
    s_nop 0
    buffer_load_dwordx4 v11, s[36:39], s41 offen offset:0 lds
    buffer_load_dwordx4 v12, s[36:39], s41 offen offset:1024 lds
    s_add_u32 m0, s43, 83968
    s_nop 0
    buffer_load_dwordx4 v5, s[32:35], s40 offen offset:3072 lds
    s_mov_b32 m0, 100352
    s_mov_b64 exec, s[46:47]
    buffer_load_dwordx4 v6, s[32:35], s40 offen lds
    s_mov_b64 exec, -1
    s_movk_i32 s40, 1152
    s_mov_b32 s41, 3538944
    s_bfe_u32 s74, s2, 0x20003
    s_lshl2_add_u32 s74, s74, s70
    s_cmp_lg_u32 s74, 8
    s_cbranch_scc1 L_sig_16
    s_mov_b32 s60, s28
    s_mov_b32 s61, s29
    s_mov_b32 s62, 0x100
    s_mov_b32 s63, 0x20000
    s_and_b32 s74, s2, 3
    s_lshl_b32 s74, s74, 6
    s_mov_b64 exec, 1
    buffer_atomic_add v244, off, s[60:63], s74 sc1
    s_mov_b64 exec, -1
L_sig_16:
    s_load_dwordx2 s[90:91], s[16:17], s84 offset:1084
    s_load_dwordx2 s[90:91], s[16:17], s84 offset:1212
    s_load_dwordx2 s[90:91], s[16:17], s84 offset:1340
    s_load_dwordx2 s[90:91], s[16:17], s84 offset:1468
    s_waitcnt vmcnt(11)
    s_barrier
    s_add_u32 m0, s43, 0
    s_nop 0
    buffer_load_dwordx4 v2, s[32:35], s40 offen offset:0 lds
    s_add_u32 m0, s44, 0
    s_nop 0
    buffer_load_dwordx4 v7, s[36:39], s41 offen offset:0 lds
    buffer_load_dwordx4 v8, s[36:39], s41 offen offset:1024 lds
    s_add_u32 m0, s43, 0
    s_nop 0
    buffer_load_dwordx4 v3, s[32:35], s40 offen offset:1024 lds
    s_add_u32 m0, s44, 8192
    s_nop 0
    buffer_load_dwordx4 v9, s[36:39], s41 offen offset:0 lds
    buffer_load_dwordx4 v10, s[36:39], s41 offen offset:1024 lds
    s_add_u32 m0, s43, 0
    s_nop 0
    buffer_load_dwordx4 v4, s[32:35], s40 offen offset:2048 lds
    s_add_u32 m0, s44, 16384
    s_nop 0
    buffer_load_dwordx4 v11, s[36:39], s41 offen offset:0 lds
    buffer_load_dwordx4 v12, s[36:39], s41 offen offset:1024 lds
    s_add_u32 m0, s43, 0
    s_nop 0
    buffer_load_dwordx4 v5, s[32:35], s40 offen offset:3072 lds
    s_mov_b32 m0, 16384
    s_mov_b64 exec, s[46:47]
    buffer_load_dwordx4 v6, s[32:35], s40 offen lds
    s_mov_b64 exec, -1
    s_movk_i32 s40, 1280
    s_mov_b32 s41, 3932160
    s_cmp_lg_u32 s87, 0
    s_cbranch_scc1 L_stg_18
    s_mov_b32 exec_lo, 0x0
    s_mov_b32 exec_hi, 0x77770000
    s_bfe_u32 s7, s89, 0x30007
    s_cmp_lg_u32 s7, 1
    s_cbranch_scc1 L_wx3_19
    buffer_load_dword v250, v252, s[36:39], s89 offen offset:256
L_wx3_19:
    buffer_load_dword v250, v252, s[36:39], s89 offen
    s_mov_b32 exec_lo, 0xff000000
    s_mov_b32 exec_hi, 0
    buffer_load_dword v250, v251, s[32:35], s88 offen
    s_mov_b64 exec, -1
L_stg_18:
    s_bfe_u32 s74, s2, 0x20003
    s_lshl2_add_u32 s74, s74, s70
    s_cmp_lg_u32 s74, 12
    s_cbranch_scc1 L_sig_20
    s_mov_b32 s60, s28
    s_mov_b32 s61, s29
    s_mov_b32 s62, 0x100
    s_mov_b32 s63, 0x20000
    s_and_b32 s74, s2, 3
    s_lshl_b32 s74, s74, 6
    s_mov_b64 exec, 1
    buffer_atomic_add v244, off, s[60:63], s74 sc1
    s_mov_b64 exec, -1
L_sig_20:
    s_load_dwordx2 s[90:91], s[16:17], s84 offset:1596
    s_load_dwordx2 s[90:91], s[16:17], s84 offset:1724
    s_load_dwordx2 s[90:91], s[16:17], s84 offset:1852
    s_load_dwordx2 s[90:91], s[16:17], s84 offset:1980
    s_waitcnt vmcnt(13)
    s_bitcmp1_b32 1, s87
    s_cbranch_scc1 L_mw_21
    s_waitcnt vmcnt(11)
L_mw_21:
    s_barrier
    s_add_u32 m0, s43, 41984
    s_nop 0
    buffer_load_dwordx4 v2, s[32:35], s40 offen offset:0 lds
    s_add_u32 m0, s44, 41984
    s_nop 0
    buffer_load_dwordx4 v7, s[36:39], s41 offen offset:0 lds
    buffer_load_dwordx4 v8, s[36:39], s41 offen offset:1024 lds
    s_add_u32 m0, s43, 41984
    s_nop 0
    buffer_load_dwordx4 v3, s[32:35], s40 offen offset:1024 lds
    s_add_u32 m0, s44, 50176
    s_nop 0
    buffer_load_dwordx4 v9, s[36:39], s41 offen offset:0 lds
    buffer_load_dwordx4 v10, s[36:39], s41 offen offset:1024 lds
    s_add_u32 m0, s43, 41984
    s_nop 0
    buffer_load_dwordx4 v4, s[32:35], s40 offen offset:2048 lds
    s_add_u32 m0, s44, 58368
    s_nop 0
    buffer_load_dwordx4 v11, s[36:39], s41 offen offset:0 lds
    buffer_load_dwordx4 v12, s[36:39], s41 offen offset:1024 lds
    s_add_u32 m0, s43, 41984
    s_nop 0
    buffer_load_dwordx4 v5, s[32:35], s40 offen offset:3072 lds
    s_mov_b32 m0, 58368
    s_mov_b64 exec, s[46:47]
    buffer_load_dwordx4 v6, s[32:35], s40 offen lds
    s_mov_b64 exec, -1
    s_movk_i32 s40, 1408
    s_mov_b32 s41, 4325376
    s_cmp_lg_u32 s87, 1
    s_cbranch_scc1 L_stg_22
    s_mov_b32 exec_lo, 0x0
    s_mov_b32 exec_hi, 0x77770000
    s_bfe_u32 s7, s89, 0x30007
    s_cmp_lg_u32 s7, 1
    s_cbranch_scc1 L_wx3_23
    buffer_load_dword v250, v252, s[36:39], s89 offen offset:256
L_wx3_23:
    buffer_load_dword v250, v252, s[36:39], s89 offen
    s_mov_b32 exec_lo, 0xff000000
    s_mov_b32 exec_hi, 0
    buffer_load_dword v250, v251, s[32:35], s88 offen
    s_mov_b64 exec, -1
L_stg_22:
    s_load_dwordx2 s[90:91], s[16:17], s84 offset:2108
    s_load_dwordx2 s[90:91], s[16:17], s84 offset:2236
    s_load_dwordx2 s[90:91], s[16:17], s84 offset:2364
    s_load_dwordx2 s[90:91], s[16:17], s84 offset:2492
    s_waitcnt vmcnt(13)
    s_barrier
    s_add_u32 m0, s43, 83968
    s_nop 0
    buffer_load_dwordx4 v2, s[32:35], s40 offen offset:0 lds
    s_add_u32 m0, s44, 83968
    s_nop 0
    buffer_load_dwordx4 v7, s[36:39], s41 offen offset:0 lds
    buffer_load_dwordx4 v8, s[36:39], s41 offen offset:1024 lds
    s_add_u32 m0, s43, 83968
    s_nop 0
    buffer_load_dwordx4 v3, s[32:35], s40 offen offset:1024 lds
    s_add_u32 m0, s44, 92160
    s_nop 0
    buffer_load_dwordx4 v9, s[36:39], s41 offen offset:0 lds
    buffer_load_dwordx4 v10, s[36:39], s41 offen offset:1024 lds
    s_add_u32 m0, s43, 83968
    s_nop 0
    buffer_load_dwordx4 v4, s[32:35], s40 offen offset:2048 lds
    s_add_u32 m0, s44, 100352
    s_nop 0
    buffer_load_dwordx4 v11, s[36:39], s41 offen offset:0 lds
    buffer_load_dwordx4 v12, s[36:39], s41 offen offset:1024 lds
    s_add_u32 m0, s43, 83968
    s_nop 0
    buffer_load_dwordx4 v5, s[32:35], s40 offen offset:3072 lds
    s_mov_b32 m0, 100352
    s_mov_b64 exec, s[46:47]
    buffer_load_dwordx4 v6, s[32:35], s40 offen lds
    s_mov_b64 exec, -1
    s_movk_i32 s40, 1536
    s_mov_b32 s41, 4718592
    s_load_dwordx2 s[90:91], s[16:17], s84 offset:2620
    s_load_dwordx2 s[90:91], s[16:17], s84 offset:2748
    s_load_dwordx2 s[90:91], s[16:17], s84 offset:2876
    s_load_dwordx2 s[90:91], s[16:17], s84 offset:3004
    s_waitcnt vmcnt(13)
    s_bitcmp1_b32 2, s87
    s_cbranch_scc1 L_mw_25
    s_waitcnt vmcnt(11)
L_mw_25:
    s_barrier
    s_add_u32 m0, s43, 0
    s_nop 0
    buffer_load_dwordx4 v2, s[32:35], s40 offen offset:0 lds
    s_add_u32 m0, s44, 0
    s_nop 0
    buffer_load_dwordx4 v7, s[36:39], s41 offen offset:0 lds
    buffer_load_dwordx4 v8, s[36:39], s41 offen offset:1024 lds
    s_add_u32 m0, s43, 0
    s_nop 0
    buffer_load_dwordx4 v3, s[32:35], s40 offen offset:1024 lds
    s_add_u32 m0, s44, 8192
    s_nop 0
    buffer_load_dwordx4 v9, s[36:39], s41 offen offset:0 lds
    buffer_load_dwordx4 v10, s[36:39], s41 offen offset:1024 lds
    s_add_u32 m0, s43, 0
    s_nop 0
    buffer_load_dwordx4 v4, s[32:35], s40 offen offset:2048 lds
    s_add_u32 m0, s44, 16384
    s_nop 0
    buffer_load_dwordx4 v11, s[36:39], s41 offen offset:0 lds
    buffer_load_dwordx4 v12, s[36:39], s41 offen offset:1024 lds
    s_add_u32 m0, s43, 0
    s_nop 0
    buffer_load_dwordx4 v5, s[32:35], s40 offen offset:3072 lds
    s_mov_b32 m0, 16384
    s_mov_b64 exec, s[46:47]
    buffer_load_dwordx4 v6, s[32:35], s40 offen lds
    s_mov_b64 exec, -1
    s_movk_i32 s40, 1664
    s_mov_b32 s41, 5111808
    s_load_dwordx2 s[90:91], s[16:17], s84 offset:3132
    s_load_dwordx2 s[90:91], s[16:17], s84 offset:3260
    s_load_dwordx2 s[90:91], s[16:17], s84 offset:3388
    s_load_dwordx2 s[90:91], s[16:17], s84 offset:3516
    s_waitcnt vmcnt(11)
    s_barrier
    s_add_u32 m0, s43, 41984
    s_nop 0
    buffer_load_dwordx4 v2, s[32:35], s40 offen offset:0 lds
    s_add_u32 m0, s44, 41984
    s_nop 0
    buffer_load_dwordx4 v7, s[36:39], s41 offen offset:0 lds
    buffer_load_dwordx4 v8, s[36:39], s41 offen offset:1024 lds
    s_add_u32 m0, s43, 41984
    s_nop 0
    buffer_load_dwordx4 v3, s[32:35], s40 offen offset:1024 lds
    s_add_u32 m0, s44, 50176
    s_nop 0
    buffer_load_dwordx4 v9, s[36:39], s41 offen offset:0 lds
    buffer_load_dwordx4 v10, s[36:39], s41 offen offset:1024 lds
    s_add_u32 m0, s43, 41984
    s_nop 0
    buffer_load_dwordx4 v4, s[32:35], s40 offen offset:2048 lds
    s_add_u32 m0, s44, 58368
    s_nop 0
    buffer_load_dwordx4 v11, s[36:39], s41 offen offset:0 lds
    buffer_load_dwordx4 v12, s[36:39], s41 offen offset:1024 lds
    s_add_u32 m0, s43, 41984
    s_nop 0
    buffer_load_dwordx4 v5, s[32:35], s40 offen offset:3072 lds
    s_mov_b32 m0, 58368
    s_mov_b64 exec, s[46:47]
    buffer_load_dwordx4 v6, s[32:35], s40 offen lds
    s_mov_b64 exec, -1
    s_movk_i32 s40, 1792
    s_mov_b32 s41, 5505024
    s_load_dwordx2 s[90:91], s[16:17], s84 offset:3644
    s_load_dwordx2 s[90:91], s[16:17], s84 offset:3772
    s_load_dwordx2 s[90:91], s[16:17], s84 offset:3900
    s_load_dwordx2 s[90:91], s[16:17], s84 offset:4028
    s_waitcnt vmcnt(11)
    s_barrier
    s_add_u32 m0, s43, 83968
    s_nop 0
    buffer_load_dwordx4 v2, s[32:35], s40 offen offset:0 lds
    s_add_u32 m0, s44, 83968
    s_nop 0
    buffer_load_dwordx4 v7, s[36:39], s41 offen offset:0 lds
    buffer_load_dwordx4 v8, s[36:39], s41 offen offset:1024 lds
    s_add_u32 m0, s43, 83968
    s_nop 0
    buffer_load_dwordx4 v3, s[32:35], s40 offen offset:1024 lds
    s_add_u32 m0, s44, 92160
    s_nop 0
    buffer_load_dwordx4 v9, s[36:39], s41 offen offset:0 lds
    buffer_load_dwordx4 v10, s[36:39], s41 offen offset:1024 lds
    s_add_u32 m0, s43, 83968
    s_nop 0
    buffer_load_dwordx4 v4, s[32:35], s40 offen offset:2048 lds
    s_add_u32 m0, s44, 100352
    s_nop 0
    buffer_load_dwordx4 v11, s[36:39], s41 offen offset:0 lds
    buffer_load_dwordx4 v12, s[36:39], s41 offen offset:1024 lds
    s_add_u32 m0, s43, 83968
    s_nop 0
    buffer_load_dwordx4 v5, s[32:35], s40 offen offset:3072 lds
    s_mov_b32 m0, 100352
    s_mov_b64 exec, s[46:47]
    buffer_load_dwordx4 v6, s[32:35], s40 offen lds
    s_mov_b64 exec, -1
    s_movk_i32 s40, 1920
    s_mov_b32 s41, 5898240
    s_waitcnt vmcnt(11)
    s_barrier
    s_load_dword s4, s[28:29], 0
    s_load_dword s5, s[28:29], 64
    s_load_dword s6, s[28:29], 128
    s_load_dword s7, s[28:29], 192
    s_add_u32 m0, s43, 0
    s_nop 0
    buffer_load_dwordx4 v2, s[32:35], s40 offen offset:0 lds
    s_add_u32 m0, s44, 0
    s_nop 0
    buffer_load_dwordx4 v7, s[36:39], s41 offen offset:0 lds
    buffer_load_dwordx4 v8, s[36:39], s41 offen offset:1024 lds
    s_add_u32 m0, s43, 0
    s_nop 0
    buffer_load_dwordx4 v3, s[32:35], s40 offen offset:1024 lds
    s_add_u32 m0, s44, 8192
    s_nop 0
    buffer_load_dwordx4 v9, s[36:39], s41 offen offset:0 lds
    buffer_load_dwordx4 v10, s[36:39], s41 offen offset:1024 lds
    s_add_u32 m0, s43, 0
    s_nop 0
    buffer_load_dwordx4 v4, s[32:35], s40 offen offset:2048 lds
    s_add_u32 m0, s44, 16384
    s_nop 0
    buffer_load_dwordx4 v11, s[36:39], s41 offen offset:0 lds
    buffer_load_dwordx4 v12, s[36:39], s41 offen offset:1024 lds
    s_add_u32 m0, s43, 0
    s_nop 0
    buffer_load_dwordx4 v5, s[32:35], s40 offen offset:3072 lds
    s_mov_b32 m0, 16384
    s_mov_b64 exec, s[46:47]
    buffer_load_dwordx4 v6, s[32:35], s40 offen lds
    s_mov_b64 exec, -1
    s_movk_i32 s40, 2048
    s_mov_b32 s41, 6291456
    s_mov_b32 s60, s8
    s_mov_b32 s61, s9
    s_mov_b32 s62, 0x400000
    s_mov_b32 s63, 0x20000
    s_movk_i32 s75, 8192
    buffer_load_dwordx4 v[208:211], v225, s[60:63], 0 offen offset:0 nt
    buffer_load_dwordx4 v[212:215], v225, s[60:63], 0 offen offset:2048 nt
    buffer_load_dwordx4 v[216:219], v225, s[60:63], s75 offen offset:0 nt
    buffer_load_dwordx4 v[220:223], v225, s[60:63], s75 offen offset:2048 nt
    s_cmp_lg_u32 s70, 0
    s_cbranch_scc1 L_pc_done_29
    s_waitcnt lgkmcnt(0)
    s_min_u32 s4, s4, s5
    s_min_u32 s6, s6, s7
    s_min_u32 s4, s4, s6
    s_cmp_ge_u32 s4, 64
    s_cbranch_scc1 L_pc_done_29
    s_mov_b32 s60, s28
    s_mov_b32 s61, s29
    s_mov_b32 s62, 0x100
    s_mov_b32 s63, 0x20000
    v_lshlrev_b32 v20, 6, v0
    s_mov_b32 s74, 131072
    s_mov_b64 exec, 0xf
L_pc_loop_30:
    buffer_load_dword v21, v20, s[60:63], 0 offen sc1
    s_waitcnt vmcnt(0)
    v_cmp_gt_u32 vcc, 64, v21
    s_cbranch_vccz L_pc_done_29
    s_sleep 4
    s_sub_u32 s74, s74, 1
    s_cbranch_scc0 L_pc_loop_30
L_pc_done_29:
    s_mov_b64 exec, -1
    s_waitcnt vmcnt(15)
    s_barrier
    s_waitcnt vmcnt(4)
    s_mov_b64 exec, 1
    ds_add_u32 v227, v244 offset:24
    s_mov_b64 exec, -1
    s_add_u32 s56, s30, s85
    s_addc_u32 s57, s31, 0
    s_movk_i32 s58, 4096
    s_mov_b32 s59, 0x20000
    s_add_u32 m0, s81, 0
    s_nop 0
    buffer_load_dwordx4 v224, s[56:59], 0 offen offset:0 sc1 lds
    buffer_load_dwordx4 v224, s[56:59], 0 offen offset:1024 sc1 lds
    buffer_load_dwordx4 v224, s[56:59], 0 offen offset:2048 sc1 lds
    buffer_load_dwordx4 v224, s[56:59], 0 offen offset:3072 sc1 lds
    s_add_u32 m0, s81, 4572
    s_nop 0
    buffer_load_dwordx4 v224, s[56:59], 0 offen offset:0 sc1 lds
    buffer_load_dwordx4 v224, s[56:59], 0 offen offset:1024 sc1 lds
    buffer_load_dwordx4 v224, s[56:59], 0 offen offset:2048 sc1 lds
    buffer_load_dwordx4 v224, s[56:59], 0 offen offset:3072 sc1 lds
    s_add_u32 s56, s16, s84
    s_addc_u32 s57, s17, 0
    s_movk_i32 s58, 4096
    s_mov_b32 s59, 0x20000
    s_add_u32 m0, s80, 64
    v_mov_b32 v132, 0
    v_mov_b32 v133, 0
    v_mov_b32 v134, 0
    v_mov_b32 v135, 0
    buffer_load_dwordx4 v224, s[56:59], 0 offen offset:0 lds
    buffer_load_dwordx4 v224, s[56:59], 0 offen offset:1024 lds
    buffer_load_dwordx4 v224, s[56:59], 0 offen offset:2048 lds
    buffer_load_dwordx4 v224, s[56:59], 0 offen offset:3072 lds
    s_add_u32 m0, s80, 4304
    s_mov_b64 exec, 0x100
    buffer_load_dwordx4 v[132:135], off, s[56:59], 0
    s_mov_b64 exec, -1
    buffer_load_dwordx4 v224, s[56:59], 14 offen offset:0 lds
    buffer_load_dwordx4 v224, s[56:59], 14 offen offset:1024 lds
    buffer_load_dwordx4 v224, s[56:59], 14 offen offset:2048 lds
    buffer_load_dwordx4 v224, s[56:59], 14 offen offset:3072 lds
    v_lshrrev_b32 v234, 5, v0
    v_mul_u32_u24 v234, 4064, v234
    v_add3_u32 v234, v234, v224, s81
    s_mov_b32 exec_lo, 0xfffffff
    s_mov_b32 exec_hi, 0xfffffff
    ds_write_b128 v234, v[228:231] offset:4096
    s_mov_b64 exec, 1
    ds_write_b32 v234, v228 offset:8668
    s_mov_b64 exec, -1
    s_setprio 3
    s_waitcnt vmcnt(9)
    s_mov_b32 s60, s24
    s_mov_b32 s61, s25
    s_mov_b32 s62, 0x200000
    s_mov_b32 s63, 0x20000
    s_lshr_b32 s74, s2, 3
    s_lshl2_add_u32 s74, s74, s70
    s_bfe_u32 s75, s2, 0x10002
    s_lshl4_add_u32 s74, s74, s75
    s_lshl_b32 s74, s74, 10
    v_lshrrev_b32 v234, 3, v0
    v_and_b32 v235, 7, v0
    v_lshlrev_b32 v235, 7, v235
    v_lshl_add_u32 v234, v234, 11, v235
    buffer_load_dword v250, v234, s[60:63], s74 offen
    s_waitcnt vmcnt(1)
    v_cmp_lt_u32 vcc, 3, v0
    v_mov_b32 v140, 4160
    v_lshlrev_b32 v136, 16, v132
    v_cndmask_b32 v140, 0, v140, vcc
    v_alignbit_b32 v137, v133, v132, 16
    v_alignbit_b32 v138, v134, v133, 16
    v_alignbit_b32 v139, v135, v134, 16
    v_add3_u32 v140, v140, v224, s80
    s_mov_b64 exec, 0x1ff
    ds_write_b128 v140, v[136:139]
    s_mov_b64 exec, -1
    ds_read_b128 v[112:115], v233 offset:3584
    ds_read_b64 v[48:49], v232 offset:0
    ds_read_b64 v[50:51], v232 offset:8
    ds_read_b128 v[116:119], v233 offset:3072
    ds_read_b64 v[52:53], v232 offset:512
    ds_read_b64 v[54:55], v232 offset:520
    ds_read_b128 v[120:123], v233 offset:2560
    ds_read_b64 v[56:57], v232 offset:1024
    ds_read_b64 v[58:59], v232 offset:1032
    ds_read_b128 v[124:127], v233 offset:2048
    ds_read_b64 v[60:61], v232 offset:1536
    ds_read_b64 v[62:63], v232 offset:1544
    ds_read_b128 v[128:131], v233 offset:1536
    ds_read_b64 v[64:65], v232 offset:2048
    ds_read_b64 v[66:67], v232 offset:2056
    ds_read_b128 v[132:135], v233 offset:1024
    ds_read_b64 v[68:69], v232 offset:2560
    ds_read_b64 v[70:71], v232 offset:2568
    ds_read_b128 v[136:139], v233 offset:512
    ds_read_b64 v[72:73], v232 offset:3072
    ds_read_b64 v[74:75], v232 offset:3080
    ds_read_b128 v[140:143], v233 offset:0
    ds_read_b64 v[76:77], v232 offset:3584
    ds_read_b64 v[78:79], v232 offset:3592
    s_setprio 1
    s_mov_b32 s74, 3
    s_waitcnt lgkmcnt(0)
    v_mfma_f32_16x16x32_bf16 v[16:19], v[240:243], v[112:115], 0
    v_mfma_f32_16x16x32_bf16 v[20:23], v[240:243], v[116:119], 0
    v_mfma_f32_16x16x32_bf16 v[24:27], v[240:243], v[120:123], 0
    v_mfma_f32_16x16x32_bf16 v[28:31], v[240:243], v[124:127], 0
    v_mfma_f32_16x16x32_bf16 v[32:35], v[240:243], v[128:131], 0
    v_mfma_f32_16x16x32_bf16 v[36:39], v[240:243], v[132:135], 0
    v_mfma_f32_16x16x32_bf16 v[40:43], v[240:243], v[136:139], 0
    v_mfma_f32_16x16x32_bf16 v[44:47], v[240:243], v[140:143], 0
L_conv:
    v_mfma_f32_16x16x32_bf16 v[16:19], v[48:51], v[112:115], v[16:19]
    ds_read_b128 v[144:147], v233 offset:3648
    v_mfma_f32_16x16x32_bf16 v[20:23], v[48:51], v[116:119], v[20:23]
    ds_read_b64 v[80:81], v232 offset:64
    v_mfma_f32_16x16x32_bf16 v[20:23], v[52:55], v[112:115], v[20:23]
    ds_read_b64 v[82:83], v232 offset:72
    v_mfma_f32_16x16x32_bf16 v[24:27], v[48:51], v[120:123], v[24:27]
    ds_read_b128 v[148:151], v233 offset:3136
    v_mfma_f32_16x16x32_bf16 v[24:27], v[52:55], v[116:119], v[24:27]
    ds_read_b64 v[84:85], v232 offset:576
    v_mfma_f32_16x16x32_bf16 v[24:27], v[56:59], v[112:115], v[24:27]
    ds_read_b64 v[86:87], v232 offset:584
    v_mfma_f32_16x16x32_bf16 v[28:31], v[48:51], v[124:127], v[28:31]
    ds_read_b128 v[152:155], v233 offset:2624
    v_mfma_f32_16x16x32_bf16 v[28:31], v[52:55], v[120:123], v[28:31]
    ds_read_b64 v[88:89], v232 offset:1088
    v_mfma_f32_16x16x32_bf16 v[28:31], v[56:59], v[116:119], v[28:31]
    ds_read_b64 v[90:91], v232 offset:1096
    v_mfma_f32_16x16x32_bf16 v[28:31], v[60:63], v[112:115], v[28:31]
    ds_read_b128 v[156:159], v233 offset:2112
    v_mfma_f32_16x16x32_bf16 v[32:35], v[48:51], v[128:131], v[32:35]
    ds_read_b64 v[92:93], v232 offset:1600
    v_mfma_f32_16x16x32_bf16 v[32:35], v[52:55], v[124:127], v[32:35]
    ds_read_b64 v[94:95], v232 offset:1608
    v_mfma_f32_16x16x32_bf16 v[32:35], v[56:59], v[120:123], v[32:35]
    ds_read_b128 v[160:163], v233 offset:1600
    v_mfma_f32_16x16x32_bf16 v[32:35], v[60:63], v[116:119], v[32:35]
    ds_read_b64 v[96:97], v232 offset:2112
    v_mfma_f32_16x16x32_bf16 v[32:35], v[64:67], v[112:115], v[32:35]
    ds_read_b64 v[98:99], v232 offset:2120
    v_mfma_f32_16x16x32_bf16 v[36:39], v[48:51], v[132:135], v[36:39]
    ds_read_b128 v[164:167], v233 offset:1088
    v_mfma_f32_16x16x32_bf16 v[36:39], v[52:55], v[128:131], v[36:39]
    ds_read_b64 v[100:101], v232 offset:2624
    v_mfma_f32_16x16x32_bf16 v[36:39], v[56:59], v[124:127], v[36:39]
    ds_read_b64 v[102:103], v232 offset:2632
    v_mfma_f32_16x16x32_bf16 v[36:39], v[60:63], v[120:123], v[36:39]
    ds_read_b128 v[168:171], v233 offset:576
    v_mfma_f32_16x16x32_bf16 v[36:39], v[64:67], v[116:119], v[36:39]
    ds_read_b64 v[104:105], v232 offset:3136
    v_mfma_f32_16x16x32_bf16 v[36:39], v[68:71], v[112:115], v[36:39]
    ds_read_b64 v[106:107], v232 offset:3144
    v_mfma_f32_16x16x32_bf16 v[40:43], v[48:51], v[136:139], v[40:43]
    ds_read_b128 v[172:175], v233 offset:64
    v_mfma_f32_16x16x32_bf16 v[40:43], v[52:55], v[132:135], v[40:43]
    ds_read_b64 v[108:109], v232 offset:3648
    v_mfma_f32_16x16x32_bf16 v[40:43], v[56:59], v[128:131], v[40:43]
    ds_read_b64 v[110:111], v232 offset:3656
    v_mfma_f32_16x16x32_bf16 v[40:43], v[60:63], v[124:127], v[40:43]
    v_mfma_f32_16x16x32_bf16 v[40:43], v[64:67], v[120:123], v[40:43]
    v_mfma_f32_16x16x32_bf16 v[40:43], v[68:71], v[116:119], v[40:43]
    v_mfma_f32_16x16x32_bf16 v[40:43], v[72:75], v[112:115], v[40:43]
    v_mfma_f32_16x16x32_bf16 v[44:47], v[48:51], v[140:143], v[44:47]
    v_mfma_f32_16x16x32_bf16 v[44:47], v[52:55], v[136:139], v[44:47]
    v_mfma_f32_16x16x32_bf16 v[44:47], v[56:59], v[132:135], v[44:47]
    v_mfma_f32_16x16x32_bf16 v[44:47], v[60:63], v[128:131], v[44:47]
    v_mfma_f32_16x16x32_bf16 v[44:47], v[64:67], v[124:127], v[44:47]
    v_mfma_f32_16x16x32_bf16 v[44:47], v[68:71], v[120:123], v[44:47]
    v_mfma_f32_16x16x32_bf16 v[44:47], v[72:75], v[116:119], v[44:47]
    v_mfma_f32_16x16x32_bf16 v[44:47], v[76:79], v[112:115], v[44:47]
    s_waitcnt lgkmcnt(0)
    v_mfma_f32_16x16x32_bf16 v[16:19], v[80:83], v[144:147], v[16:19]
    ds_read_b128 v[112:115], v233 offset:3712
    v_mfma_f32_16x16x32_bf16 v[20:23], v[80:83], v[148:151], v[20:23]
    ds_read_b64 v[48:49], v232 offset:128
    v_mfma_f32_16x16x32_bf16 v[20:23], v[84:87], v[144:147], v[20:23]
    ds_read_b64 v[50:51], v232 offset:136
    v_mfma_f32_16x16x32_bf16 v[24:27], v[80:83], v[152:155], v[24:27]
    ds_read_b128 v[116:119], v233 offset:3200
    v_mfma_f32_16x16x32_bf16 v[24:27], v[84:87], v[148:151], v[24:27]
    ds_read_b64 v[52:53], v232 offset:640
    v_mfma_f32_16x16x32_bf16 v[24:27], v[88:91], v[144:147], v[24:27]
    ds_read_b64 v[54:55], v232 offset:648
    v_mfma_f32_16x16x32_bf16 v[28:31], v[80:83], v[156:159], v[28:31]
    ds_read_b128 v[120:123], v233 offset:2688
    v_mfma_f32_16x16x32_bf16 v[28:31], v[84:87], v[152:155], v[28:31]
    ds_read_b64 v[56:57], v232 offset:1152
    v_mfma_f32_16x16x32_bf16 v[28:31], v[88:91], v[148:151], v[28:31]
    ds_read_b64 v[58:59], v232 offset:1160
    v_mfma_f32_16x16x32_bf16 v[28:31], v[92:95], v[144:147], v[28:31]
    ds_read_b128 v[124:127], v233 offset:2176
    v_mfma_f32_16x16x32_bf16 v[32:35], v[80:83], v[160:163], v[32:35]
    ds_read_b64 v[60:61], v232 offset:1664
    v_mfma_f32_16x16x32_bf16 v[32:35], v[84:87], v[156:159], v[32:35]
    ds_read_b64 v[62:63], v232 offset:1672
    v_mfma_f32_16x16x32_bf16 v[32:35], v[88:91], v[152:155], v[32:35]
    ds_read_b128 v[128:131], v233 offset:1664
    v_mfma_f32_16x16x32_bf16 v[32:35], v[92:95], v[148:151], v[32:35]
    ds_read_b64 v[64:65], v232 offset:2176
    v_mfma_f32_16x16x32_bf16 v[32:35], v[96:99], v[144:147], v[32:35]
    ds_read_b64 v[66:67], v232 offset:2184
    v_mfma_f32_16x16x32_bf16 v[36:39], v[80:83], v[164:167], v[36:39]
    ds_read_b128 v[132:135], v233 offset:1152
    v_mfma_f32_16x16x32_bf16 v[36:39], v[84:87], v[160:163], v[36:39]
    ds_read_b64 v[68:69], v232 offset:2688
    v_mfma_f32_16x16x32_bf16 v[36:39], v[88:91], v[156:159], v[36:39]
    ds_read_b64 v[70:71], v232 offset:2696
    v_mfma_f32_16x16x32_bf16 v[36:39], v[92:95], v[152:155], v[36:39]
    ds_read_b128 v[136:139], v233 offset:640
    v_mfma_f32_16x16x32_bf16 v[36:39], v[96:99], v[148:151], v[36:39]
    ds_read_b64 v[72:73], v232 offset:3200
    v_mfma_f32_16x16x32_bf16 v[36:39], v[100:103], v[144:147], v[36:39]
    ds_read_b64 v[74:75], v232 offset:3208
    v_mfma_f32_16x16x32_bf16 v[40:43], v[80:83], v[168:171], v[40:43]
    ds_read_b128 v[140:143], v233 offset:128
    v_mfma_f32_16x16x32_bf16 v[40:43], v[84:87], v[164:167], v[40:43]
    ds_read_b64 v[76:77], v232 offset:3712
    v_mfma_f32_16x16x32_bf16 v[40:43], v[88:91], v[160:163], v[40:43]
    ds_read_b64 v[78:79], v232 offset:3720
    v_mfma_f32_16x16x32_bf16 v[40:43], v[92:95], v[156:159], v[40:43]
    v_add_u32 v232, 128, v232
    v_mfma_f32_16x16x32_bf16 v[40:43], v[96:99], v[152:155], v[40:43]
    v_add_u32 v233, 128, v233
    v_mfma_f32_16x16x32_bf16 v[40:43], v[100:103], v[148:151], v[40:43]
    s_sub_u32 s74, s74, 1
    v_mfma_f32_16x16x32_bf16 v[40:43], v[104:107], v[144:147], v[40:43]
    s_cmp_lg_u32 s74, 0
    v_mfma_f32_16x16x32_bf16 v[44:47], v[80:83], v[172:175], v[44:47]
    v_mfma_f32_16x16x32_bf16 v[44:47], v[84:87], v[168:171], v[44:47]
    v_mfma_f32_16x16x32_bf16 v[44:47], v[88:91], v[164:167], v[44:47]
    v_mfma_f32_16x16x32_bf16 v[44:47], v[92:95], v[160:163], v[44:47]
    v_mfma_f32_16x16x32_bf16 v[44:47], v[96:99], v[156:159], v[44:47]
    v_mfma_f32_16x16x32_bf16 v[44:47], v[100:103], v[152:155], v[44:47]
    v_mfma_f32_16x16x32_bf16 v[44:47], v[104:107], v[148:151], v[44:47]
    v_mfma_f32_16x16x32_bf16 v[44:47], v[108:111], v[144:147], v[44:47]
    s_waitcnt lgkmcnt(0)
    s_cbranch_scc1 L_conv
    v_mfma_f32_16x16x32_bf16 v[16:19], v[48:51], v[112:115], v[16:19]
    ds_read_b128 v[144:147], v233 offset:3648
    v_mfma_f32_16x16x32_bf16 v[20:23], v[48:51], v[116:119], v[20:23]
    ds_read_b64 v[80:81], v232 offset:64
    v_mfma_f32_16x16x32_bf16 v[20:23], v[52:55], v[112:115], v[20:23]
    ds_read_b64 v[82:83], v232 offset:72
    v_mfma_f32_16x16x32_bf16 v[24:27], v[48:51], v[120:123], v[24:27]
    ds_read_b128 v[148:151], v233 offset:3136
    v_mfma_f32_16x16x32_bf16 v[24:27], v[52:55], v[116:119], v[24:27]
    ds_read_b64 v[84:85], v232 offset:576
    v_mfma_f32_16x16x32_bf16 v[24:27], v[56:59], v[112:115], v[24:27]
    ds_read_b64 v[86:87], v232 offset:584
    v_mfma_f32_16x16x32_bf16 v[28:31], v[48:51], v[124:127], v[28:31]
    ds_read_b128 v[152:155], v233 offset:2624
    v_mfma_f32_16x16x32_bf16 v[28:31], v[52:55], v[120:123], v[28:31]
    ds_read_b64 v[88:89], v232 offset:1088
    v_mfma_f32_16x16x32_bf16 v[28:31], v[56:59], v[116:119], v[28:31]
    ds_read_b64 v[90:91], v232 offset:1096
    v_mfma_f32_16x16x32_bf16 v[28:31], v[60:63], v[112:115], v[28:31]
    ds_read_b128 v[156:159], v233 offset:2112
    v_mfma_f32_16x16x32_bf16 v[32:35], v[48:51], v[128:131], v[32:35]
    ds_read_b64 v[92:93], v232 offset:1600
    v_mfma_f32_16x16x32_bf16 v[32:35], v[52:55], v[124:127], v[32:35]
    ds_read_b64 v[94:95], v232 offset:1608
    v_mfma_f32_16x16x32_bf16 v[32:35], v[56:59], v[120:123], v[32:35]
    ds_read_b128 v[160:163], v233 offset:1600
    v_mfma_f32_16x16x32_bf16 v[32:35], v[60:63], v[116:119], v[32:35]
    ds_read_b64 v[96:97], v232 offset:2112
    v_mfma_f32_16x16x32_bf16 v[32:35], v[64:67], v[112:115], v[32:35]
    ds_read_b64 v[98:99], v232 offset:2120
    v_mfma_f32_16x16x32_bf16 v[36:39], v[48:51], v[132:135], v[36:39]
    ds_read_b128 v[164:167], v233 offset:1088
    v_mfma_f32_16x16x32_bf16 v[36:39], v[52:55], v[128:131], v[36:39]
    ds_read_b64 v[100:101], v232 offset:2624
    v_mfma_f32_16x16x32_bf16 v[36:39], v[56:59], v[124:127], v[36:39]
    ds_read_b64 v[102:103], v232 offset:2632
    v_mfma_f32_16x16x32_bf16 v[36:39], v[60:63], v[120:123], v[36:39]
    ds_read_b128 v[168:171], v233 offset:576
    v_mfma_f32_16x16x32_bf16 v[36:39], v[64:67], v[116:119], v[36:39]
    ds_read_b64 v[104:105], v232 offset:3136
    v_mfma_f32_16x16x32_bf16 v[36:39], v[68:71], v[112:115], v[36:39]
    ds_read_b64 v[106:107], v232 offset:3144
    v_mfma_f32_16x16x32_bf16 v[40:43], v[48:51], v[136:139], v[40:43]
    ds_read_b128 v[172:175], v233 offset:64
    v_mfma_f32_16x16x32_bf16 v[40:43], v[52:55], v[132:135], v[40:43]
    ds_read_b64 v[108:109], v232 offset:3648
    v_mfma_f32_16x16x32_bf16 v[40:43], v[56:59], v[128:131], v[40:43]
    ds_read_b64 v[110:111], v232 offset:3656
    v_mfma_f32_16x16x32_bf16 v[40:43], v[60:63], v[124:127], v[40:43]
    s_mul_i32 s74, s68, 4224
    v_mfma_f32_16x16x32_bf16 v[40:43], v[64:67], v[120:123], v[40:43]
    s_and_b32 s75, s71, 63
    v_mfma_f32_16x16x32_bf16 v[40:43], v[68:71], v[116:119], v[40:43]
    s_add_u32 s74, s74, s75
    v_mfma_f32_16x16x32_bf16 v[40:43], v[72:75], v[112:115], v[40:43]
    s_lshl_b32 s74, s74, 6
    v_mfma_f32_16x16x32_bf16 v[44:47], v[48:51], v[140:143], v[44:47]
    v_and_b32 v234, 3, v0
    v_mfma_f32_16x16x32_bf16 v[44:47], v[52:55], v[136:139], v[44:47]
    v_lshl_add_u32 v234, v234, 4, s74
    v_mfma_f32_16x16x32_bf16 v[44:47], v[56:59], v[132:135], v[44:47]
    v_and_b32 v235, 12, v0
    v_mfma_f32_16x16x32_bf16 v[44:47], v[60:63], v[128:131], v[44:47]
    v_lshrrev_b32 v236, 4, v0
    v_mfma_f32_16x16x32_bf16 v[44:47], v[64:67], v[124:127], v[44:47]
    v_add_u32 v235, v235, v236
    v_mfma_f32_16x16x32_bf16 v[44:47], v[68:71], v[120:123], v[44:47]
    v_mul_u32_u24 v235, 4224, v235
    v_mfma_f32_16x16x32_bf16 v[44:47], v[72:75], v[116:119], v[44:47]
    v_add_u32 v234, v234, v235
    v_mfma_f32_16x16x32_bf16 v[44:47], v[76:79], v[112:115], v[44:47]
    s_waitcnt lgkmcnt(0)
    s_mov_b64 exec, 1
    ds_add_u32 v227, v244 offset:36
    s_mov_b64 exec, -1
    v_mfma_f32_16x16x32_bf16 v[16:19], v[80:83], v[144:147], v[16:19]
    s_lshl4_add_u32 s73, s68, 256
    s_add_u32 s45, s73, s69
    v_mfma_f32_16x16x32_bf16 v[20:23], v[80:83], v[148:151], v[20:23]
    s_lshl_b32 s73, s73, 8
    s_lshl_b32 s45, s45, 8
    v_mfma_f32_16x16x32_bf16 v[20:23], v[84:87], v[144:147], v[20:23]
    v_mfma_f32_16x16x32_bf16 v[24:27], v[80:83], v[152:155], v[24:27]
    v_mfma_f32_16x16x32_bf16 v[24:27], v[84:87], v[148:151], v[24:27]
    v_mfma_f32_16x16x32_bf16 v[24:27], v[88:91], v[144:147], v[24:27]
    v_mfma_f32_16x16x32_bf16 v[28:31], v[80:83], v[156:159], v[28:31]
    v_cvt_pk_bf16_f32 v48, v16, v17
    v_cvt_pk_bf16_f32 v49, v18, v19
    v_mfma_f32_16x16x32_bf16 v[28:31], v[84:87], v[152:155], v[28:31]
    v_mfma_f32_16x16x32_bf16 v[28:31], v[88:91], v[148:151], v[28:31]
    v_cvt_pk_bf16_f32 v50, v20, v21
    v_cvt_pk_bf16_f32 v51, v22, v23
    v_mfma_f32_16x16x32_bf16 v[28:31], v[92:95], v[144:147], v[28:31]
    s_mov_b32 s76, 0
    buffer_store_dwordx4 v[48:51], v234, s[64:67], s76 offen sc1
    v_mfma_f32_16x16x32_bf16 v[32:35], v[80:83], v[160:163], v[32:35]
    v_cvt_pk_bf16_f32 v52, v24, v25
    v_cvt_pk_bf16_f32 v53, v26, v27
    v_mfma_f32_16x16x32_bf16 v[32:35], v[84:87], v[156:159], v[32:35]
    v_mfma_f32_16x16x32_bf16 v[32:35], v[88:91], v[152:155], v[32:35]
    v_mfma_f32_16x16x32_bf16 v[32:35], v[92:95], v[148:151], v[32:35]
    v_cvt_pk_bf16_f32 v54, v28, v29
    v_cvt_pk_bf16_f32 v55, v30, v31
    v_mfma_f32_16x16x32_bf16 v[32:35], v[96:99], v[144:147], v[32:35]
    s_mov_b32 s76, 67584
    buffer_store_dwordx4 v[52:55], v234, s[64:67], s76 offen sc1
    v_mfma_f32_16x16x32_bf16 v[36:39], v[80:83], v[164:167], v[36:39]
    v_mfma_f32_16x16x32_bf16 v[36:39], v[84:87], v[160:163], v[36:39]
    v_mfma_f32_16x16x32_bf16 v[36:39], v[88:91], v[156:159], v[36:39]
    v_mfma_f32_16x16x32_bf16 v[36:39], v[92:95], v[152:155], v[36:39]
    v_mfma_f32_16x16x32_bf16 v[36:39], v[96:99], v[148:151], v[36:39]
    v_mfma_f32_16x16x32_bf16 v[36:39], v[100:103], v[144:147], v[36:39]
    v_cvt_pk_bf16_f32 v56, v32, v33
    v_cvt_pk_bf16_f32 v57, v34, v35
    v_mfma_f32_16x16x32_bf16 v[40:43], v[80:83], v[168:171], v[40:43]
    v_mfma_f32_16x16x32_bf16 v[40:43], v[84:87], v[164:167], v[40:43]
    v_mfma_f32_16x16x32_bf16 v[40:43], v[88:91], v[160:163], v[40:43]
    v_mfma_f32_16x16x32_bf16 v[40:43], v[92:95], v[156:159], v[40:43]
    v_mfma_f32_16x16x32_bf16 v[40:43], v[96:99], v[152:155], v[40:43]
    v_mfma_f32_16x16x32_bf16 v[40:43], v[100:103], v[148:151], v[40:43]
    v_cvt_pk_bf16_f32 v58, v36, v37
    v_cvt_pk_bf16_f32 v59, v38, v39
    v_mfma_f32_16x16x32_bf16 v[40:43], v[104:107], v[144:147], v[40:43]
    s_mov_b32 s76, 135168
    buffer_store_dwordx4 v[56:59], v234, s[64:67], s76 offen sc1
    v_mfma_f32_16x16x32_bf16 v[44:47], v[80:83], v[172:175], v[44:47]
    v_mfma_f32_16x16x32_bf16 v[44:47], v[84:87], v[168:171], v[44:47]
    v_mfma_f32_16x16x32_bf16 v[44:47], v[88:91], v[164:167], v[44:47]
    v_mfma_f32_16x16x32_bf16 v[44:47], v[92:95], v[160:163], v[44:47]
    v_mfma_f32_16x16x32_bf16 v[44:47], v[96:99], v[156:159], v[44:47]
    v_mfma_f32_16x16x32_bf16 v[44:47], v[100:103], v[152:155], v[44:47]
    v_cvt_pk_bf16_f32 v60, v40, v41
    v_cvt_pk_bf16_f32 v61, v42, v43
    v_mfma_f32_16x16x32_bf16 v[44:47], v[104:107], v[148:151], v[44:47]
    v_mfma_f32_16x16x32_bf16 v[44:47], v[108:111], v[144:147], v[44:47]
    s_nop 7
    v_cvt_pk_bf16_f32 v62, v44, v45
    v_cvt_pk_bf16_f32 v63, v46, v47
    s_mov_b32 s76, 202752
    buffer_store_dwordx4 v[60:63], v234, s[64:67], s76 offen sc1
    s_setprio 1
    s_waitcnt vmcnt(0)
    v_mov_b32 v238, 1
    s_mov_b64 exec, 1
    ds_add_rtn_u32 v237, v227, v238 offset:8
    s_waitcnt lgkmcnt(0)
    v_readfirstlane_b32 s76, v237
    s_nop 0
    s_cmp_eq_u32 s76, 3
    s_cbranch_scc0 L_jo_35a
    s_mov_b64 exec, 0xffff
    v_lshlrev_b32 v237, 8, v0
    buffer_atomic_add v238, v237, s[52:55], s73 offen sc1
L_jo_35a:
    s_mov_b64 exec, -1
    v_lshlrev_b32 v112, 16, v208
    v_and_b32 v113, 0xffff0000, v208
    v_lshlrev_b32 v114, 16, v209
    v_and_b32 v115, 0xffff0000, v209
    v_lshlrev_b32 v116, 16, v210
    v_and_b32 v117, 0xffff0000, v210
    v_lshlrev_b32 v118, 16, v211
    v_and_b32 v119, 0xffff0000, v211
    v_lshlrev_b32 v120, 16, v212
    v_and_b32 v121, 0xffff0000, v212
    v_lshlrev_b32 v122, 16, v213
    v_and_b32 v123, 0xffff0000, v213
    v_lshlrev_b32 v124, 16, v214
    v_and_b32 v125, 0xffff0000, v214
    v_lshlrev_b32 v126, 16, v215
    v_and_b32 v127, 0xffff0000, v215
    v_lshlrev_b32 v128, 16, v216
    v_and_b32 v129, 0xffff0000, v216
    v_lshlrev_b32 v130, 16, v217
    v_and_b32 v131, 0xffff0000, v217
    v_lshlrev_b32 v132, 16, v218
    v_and_b32 v133, 0xffff0000, v218
    v_lshlrev_b32 v134, 16, v219
    v_and_b32 v135, 0xffff0000, v219
    v_lshlrev_b32 v136, 16, v220
    v_and_b32 v137, 0xffff0000, v220
    v_lshlrev_b32 v138, 16, v221
    v_and_b32 v139, 0xffff0000, v221
    v_lshlrev_b32 v140, 16, v222
    v_and_b32 v141, 0xffff0000, v222
    v_lshlrev_b32 v142, 16, v223
    v_and_b32 v143, 0xffff0000, v223
    s_setprio 1
    s_setprio 1
    s_mul_i32 s77, s70, 4352
    s_add_u32 s77, s77, 60416
    v_lshrrev_b32 v234, 5, v0
    v_lshl_add_u32 v234, v234, 1, v0
    v_lshl_add_u32 v234, v234, 4, s77
    v_and_b32 v235, 7, v0
    v_mul_u32_u24 v235, 544, v235
    v_lshrrev_b32 v236, 3, v0
    v_lshl_add_u32 v235, v236, 3, v235
    v_add_u32 v235, s77, v235
    s_mul_i32 s77, s71, 4224
    s_mov_b32 s60, s26
    s_mov_b32 s61, s27
    s_mov_b32 s62, 0x800000
    s_mov_b32 s63, 0x20000
    s_cmp_eq_u32 s76, 3
    s_cbranch_scc0 L_jo_35
    s_mov_b32 s75, 131072
L_sg_loop_38:
    s_load_dword s74, s[52:53], s45 glc
L_sg_chk_39:
    s_waitcnt lgkmcnt(0)
    s_cmp_ge_u32 s74, 16
    s_cbranch_scc1 L_sg_done_37
    s_sub_u32 s75, s75, 1
    s_cbranch_scc0 L_sg_loop_38
L_sg_done_37:
    v_mov_b32 v237, 16
    s_mov_b64 exec, 1
    ds_add_u32 v227, v237 offset:16
    s_mov_b64 exec, -1
    s_branch L_jd_36
L_jo_35:
    s_mov_b32 s75, 1048576
L_sl_loop_41:
    ds_read_b32 v237, v227 offset:16
    s_waitcnt lgkmcnt(0)
    v_readfirstlane_b32 s74, v237
    s_nop 0
    s_cmp_ge_u32 s74, 16
    s_cbranch_scc1 L_sl_done_40
    s_sleep 1
    s_sub_u32 s75, s75, 1
    s_cbranch_scc0 L_sl_loop_41
L_sl_done_40:
L_jd_36:
    buffer_load_dwordx4 v[48:51], v224, s[64:67], s77 offen offset:0 sc1
    buffer_load_dwordx4 v[52:55], v224, s[64:67], s77 offen offset:1024 sc1
    buffer_load_dwordx4 v[56:59], v224, s[64:67], s77 offen offset:2048 sc1
    buffer_load_dwordx4 v[60:63], v224, s[64:67], s77 offen offset:3072 sc1
    s_waitcnt vmcnt(3)
    ds_write_b128 v234, v[48:51] offset:0
    s_waitcnt vmcnt(2)
    ds_write_b128 v234, v[52:55] offset:1088
    s_waitcnt vmcnt(1)
    ds_write_b128 v234, v[56:59] offset:2176
    s_waitcnt vmcnt(0)
    ds_write_b128 v234, v[60:63] offset:3264
    ds_read_b64 v[64:65], v235 offset:0
    ds_read_b64 v[66:67], v235 offset:64
    ds_read_b64 v[68:69], v235 offset:128
    ds_read_b64 v[70:71], v235 offset:192
    ds_read_b64 v[72:73], v235 offset:256
    ds_read_b64 v[74:75], v235 offset:320
    ds_read_b64 v[76:77], v235 offset:384
    ds_read_b64 v[78:79], v235 offset:448
    s_waitcnt lgkmcnt(7)
    v_lshlrev_b32 v16, 16, v64
    v_and_b32 v24, 0xffff0000, v64
    v_lshlrev_b32 v32, 16, v65
    v_and_b32 v40, 0xffff0000, v65
    s_waitcnt lgkmcnt(6)
    v_lshlrev_b32 v17, 16, v66
    v_and_b32 v25, 0xffff0000, v66
    v_lshlrev_b32 v33, 16, v67
    v_and_b32 v41, 0xffff0000, v67
    s_waitcnt lgkmcnt(5)
    v_lshlrev_b32 v18, 16, v68
    v_and_b32 v26, 0xffff0000, v68
    v_lshlrev_b32 v34, 16, v69
    v_and_b32 v42, 0xffff0000, v69
    s_waitcnt lgkmcnt(4)
    v_lshlrev_b32 v19, 16, v70
    v_and_b32 v27, 0xffff0000, v70
    v_lshlrev_b32 v35, 16, v71
    v_and_b32 v43, 0xffff0000, v71
    s_waitcnt lgkmcnt(3)
    v_lshlrev_b32 v20, 16, v72
    v_and_b32 v28, 0xffff0000, v72
    v_lshlrev_b32 v36, 16, v73
    v_and_b32 v44, 0xffff0000, v73
    s_waitcnt lgkmcnt(2)
    v_lshlrev_b32 v21, 16, v74
    v_and_b32 v29, 0xffff0000, v74
    v_lshlrev_b32 v37, 16, v75
    v_and_b32 v45, 0xffff0000, v75
    s_waitcnt lgkmcnt(1)
    v_lshlrev_b32 v22, 16, v76
    v_and_b32 v30, 0xffff0000, v76
    v_lshlrev_b32 v38, 16, v77
    v_and_b32 v46, 0xffff0000, v77
    s_waitcnt lgkmcnt(0)
    v_lshlrev_b32 v23, 16, v78
    v_and_b32 v31, 0xffff0000, v78
    v_lshlrev_b32 v39, 16, v79
    v_and_b32 v47, 0xffff0000, v79
    v_mul_f32 v16, v16, v112
    v_mul_f32 v17, v17, v113
    v_mul_f32 v18, v18, v114
    v_mul_f32 v19, v19, v115
    v_mul_f32 v20, v20, v116
    v_mul_f32 v21, v21, v117
    v_mul_f32 v22, v22, v118
    v_mul_f32 v23, v23, v119
    v_cvt_pk_bf16_f32 v48, v16, v17
    v_cvt_pk_bf16_f32 v49, v18, v19
    v_cvt_pk_bf16_f32 v50, v20, v21
    v_cvt_pk_bf16_f32 v51, v22, v23
    s_mov_b32 s74, 0
    buffer_store_dwordx4 v[48:51], v226, s[60:63], s74 offen nt
    v_mul_f32 v24, v24, v120
    v_mul_f32 v25, v25, v121
    v_mul_f32 v26, v26, v122
    v_mul_f32 v27, v27, v123
    v_mul_f32 v28, v28, v124
    v_mul_f32 v29, v29, v125
    v_mul_f32 v30, v30, v126
    v_mul_f32 v31, v31, v127
    v_cvt_pk_bf16_f32 v52, v24, v25
    v_cvt_pk_bf16_f32 v53, v26, v27
    v_cvt_pk_bf16_f32 v54, v28, v29
    v_cvt_pk_bf16_f32 v55, v30, v31
    s_mov_b32 s74, 4096
    buffer_store_dwordx4 v[52:55], v226, s[60:63], s74 offen nt
    v_mul_f32 v32, v32, v128
    v_mul_f32 v33, v33, v129
    v_mul_f32 v34, v34, v130
    v_mul_f32 v35, v35, v131
    v_mul_f32 v36, v36, v132
    v_mul_f32 v37, v37, v133
    v_mul_f32 v38, v38, v134
    v_mul_f32 v39, v39, v135
    v_cvt_pk_bf16_f32 v56, v32, v33
    v_cvt_pk_bf16_f32 v57, v34, v35
    v_cvt_pk_bf16_f32 v58, v36, v37
    v_cvt_pk_bf16_f32 v59, v38, v39
    s_mov_b32 s74, 16384
    buffer_store_dwordx4 v[56:59], v226, s[60:63], s74 offen nt
    v_mul_f32 v40, v40, v136
    v_mul_f32 v41, v41, v137
    v_mul_f32 v42, v42, v138
    v_mul_f32 v43, v43, v139
    v_mul_f32 v44, v44, v140
    v_mul_f32 v45, v45, v141
    v_mul_f32 v46, v46, v142
    v_mul_f32 v47, v47, v143
    v_cvt_pk_bf16_f32 v60, v40, v41
    v_cvt_pk_bf16_f32 v61, v42, v43
    v_cvt_pk_bf16_f32 v62, v44, v45
    v_cvt_pk_bf16_f32 v63, v46, v47
    s_mov_b32 s74, 20480
    buffer_store_dwordx4 v[60:63], v226, s[60:63], s74 offen nt
    s_endpgm
L_grole:
    s_setprio 2
    s_add_u32 s52, s30, 0xe00000
    s_addc_u32 s53, s31, 0
    s_mov_b32 s54, 0x20000
    s_mov_b32 s55, 0x20000
    s_lshr_b32 s32, s3, 1
    s_and_b32 s33, s3, 1
    v_and_b32 v1, 15, v0
    v_lshrrev_b32 v2, 4, v0
    v_lshrrev_b32 v3, 1, v1
    v_xor_b32 v3, v2, v3
    v_lshlrev_b32 v3, 4, v3
    v_lshl_add_u32 v3, v1, 7, v3
    s_lshl_b32 s37, s33, 13
    v_add_u32 v196, s37, v3
    v_xor_b32 v197, 64, v196
    v_and_b32 v198, 7, v1
    v_lshlrev_b32 v3, 1, v2
    v_xor_b32 v3, v3, v198
    v_lshlrev_b32 v3, 4, v3
    v_lshl_add_u32 v3, v198, 7, v3
    v_lshrrev_b32 v202, 3, v1
    v_lshl_add_u32 v3, v202, 2, v3
    v_add_u32 v198, 16384, v3
    v_xor_b32 v199, 16, v198
    v_mul_u32_u24 v202, 0xaaaa, v202
    v_add_u32 v202, 0x4444, v202
    v_bfe_u32 v3, v0, 2, 2
    v_lshl_add_u32 v200, v2, 3, v3
    v_lshlrev_b32 v200, 7, v200
    v_bfe_u32 v3, v0, 3, 2
    v_xor_b32 v3, s3, v3
    v_lshl_add_u32 v200, v3, 5, v200
    v_and_b32 v3, 3, v0
    v_lshl_add_u32 v200, v3, 3, v200
    v_add_u32 v200, 17408, v200
    v_xor_b32 v201, 32, v200
    v_mov_b64 v[52:53], 0
    v_mov_b64 v[54:55], 0
    v_mov_b64 v[56:57], 0
    v_mov_b64 v[58:59], 0
    v_mov_b64 v[60:61], 0
    v_mov_b64 v[62:63], 0
    v_mov_b64 v[64:65], 0
    v_mov_b64 v[66:67], 0
    v_mov_b64 v[68:69], 0
    v_mov_b64 v[70:71], 0
    v_mov_b64 v[72:73], 0
    v_mov_b64 v[74:75], 0
    v_mov_b64 v[76:77], 0
    v_mov_b64 v[78:79], 0
    v_mov_b64 v[80:81], 0
    v_mov_b64 v[82:83], 0
    v_mov_b64 v[84:85], 0
    v_mov_b64 v[86:87], 0
    v_mov_b64 v[88:89], 0
    v_mov_b64 v[90:91], 0
    v_mov_b64 v[92:93], 0
    v_mov_b64 v[94:95], 0
    v_mov_b64 v[96:97], 0
    v_mov_b64 v[98:99], 0
    v_mov_b64 v[100:101], 0
    v_mov_b64 v[102:103], 0
    v_mov_b64 v[104:105], 0
    v_mov_b64 v[106:107], 0
    s_mov_b32 s34, 0
    v_mov_b32 v228, 134352
    v_and_b32 v1, 15, v0
    v_lshrrev_b32 v2, 4, v0
    v_lshlrev_b32 v2, 2, v2
    v_sub_u32 v1, v1, v2
    s_mov_b32 s37, 0xf149f2ca
    v_mov_b32 v3, s37
    s_or_b32 s38, s5, s33
    s_cmp_eq_u32 s38, 0
    s_cselect_b32 s38, s37, 0
    v_subrev_u32 v2, 0, v1
    v_cmp_gt_u32 vcc, 8, v2
    v_cmp_gt_i32 s[64:65], -8, v2
    v_ashrrev_i32 v2, 31, v2
    v_cndmask_b32 v204, v3, 0, vcc
    v_cndmask_b32 v208, v3, 0, s[64:65]
    v_mov_b32 v216, v2
    v_min_f32 v212, s38, v208
    v_subrev_u32 v2, 1, v1
    v_cmp_gt_u32 vcc, 8, v2
    v_cmp_gt_i32 s[64:65], -8, v2
    v_ashrrev_i32 v2, 31, v2
    v_cndmask_b32 v205, v3, 0, vcc
    v_cndmask_b32 v209, v3, 0, s[64:65]
    v_alignbit_b32 v216, v2, v216, 16
    v_min_f32 v213, s38, v209
    v_subrev_u32 v2, 2, v1
    v_cmp_gt_u32 vcc, 8, v2
    v_cmp_gt_i32 s[64:65], -8, v2
    v_ashrrev_i32 v2, 31, v2
    v_cndmask_b32 v206, v3, 0, vcc
    v_cndmask_b32 v210, v3, 0, s[64:65]
    v_mov_b32 v217, v2
    v_min_f32 v214, s38, v210
    v_subrev_u32 v2, 3, v1
    v_cmp_gt_u32 vcc, 8, v2
    v_cmp_gt_i32 s[64:65], -8, v2
    v_ashrrev_i32 v2, 31, v2
    v_cndmask_b32 v207, v3, 0, vcc
    v_cndmask_b32 v211, v3, 0, s[64:65]
    v_alignbit_b32 v217, v2, v217, 16
    v_min_f32 v215, s38, v211
    s_mul_i32 s37, s32, 80896
    s_add_u32 s37, s37, 78848
    v_lshl_add_u32 v220, v0, 3, s37
    s_lshl_b32 s38, s33, 9
    v_add_u32 v219, s38, v220
    s_add_u32 s38, s38, s37
    v_and_b32 v1, 3, v0
    v_lshl_add_u32 v1, v1, 1, s38
    v_bfe_u32 v2, v0, 2, 2
    v_lshl_add_u32 v1, v2, 7, v1
    v_lshrrev_b32 v2, 4, v0
    v_xor_b32 v2, 2, v2
    v_lshl_add_u32 v203, v2, 5, v1
    s_mul_i32 s38, s33, 2560
    v_add_u32 v221, s38, v220
    v_xor_b32 v222, 512, v221
    s_lshl3_add_u32 s37, s4, s5
    s_lshl1_add_u32 s37, s37, s33
    s_lshl_b32 s37, s37, 7
    s_lshl1_add_u32 s38, s6, s32
    s_add_u32 s37, s37, s38
    s_lshl_b32 s37, s37, 10
    v_lshl_add_u32 v218, v0, 4, s37
    s_mov_b32 s40, s30
    s_mov_b32 s41, s31
    s_mov_b32 s42, 0x400000
    s_mov_b32 s43, 0x20000
    s_and_b32 s58, s2, 3
    s_bfe_u32 s37, s2, 0x20003
    s_lshl2_add_u32 s58, s58, s37
    s_bfe_u32 s59, s2, 0x10002
    s_lshr_b32 s37, s2, 5
    s_lshl3_add_u32 s59, s59, s37
    s_mov_b32 s44, s24
    s_mov_b32 s45, s25
    s_mov_b32 s46, 0x200000
    s_mov_b32 s47, 0x20000
    s_mov_b32 s48, s26
    s_mov_b32 s49, s27
    s_mov_b32 s50, 0x800000
    s_mov_b32 s51, 0x20000
    s_lshl3_add_u32 s56, s4, s5
    s_lshl4_add_u32 s56, s56, 0
    s_lshl_b32 s56, s56, 8
    s_lshl4_add_u32 s57, s58, 0
    s_add_u32 s57, s57, s59
    s_lshl_b32 s57, s57, 8
    s_lshl2_add_u32 s37, s58, s3
    s_lshl_b32 s38, s37, 16
    v_lshl_add_u32 v224, v0, 4, s38
    v_add_u32 v225, 0x8000, v224
    s_and_b32 s37, s37, 31
    s_lshl_b32 s37, s37, 6
    s_lshr_b32 s38, s58, 3
    s_add_u32 s37, s37, s38
    s_lshl_b32 s37, s37, 5
    s_add_u32 s37, s37, s59
    s_add_u32 s37, s37, 16
    s_lshl_b32 s37, s37, 7
    v_lshrrev_b32 v1, 3, v0
    v_lshl_add_u32 v1, v1, 13, s37
    v_and_b32 v2, 7, v0
    v_lshl_add_u32 v226, v2, 4, v1
    v_lshrrev_b32 v1, 4, v0
    v_lshlrev_b32 v1, 1, v1
    v_xor_b32 v1, v0, v1
    v_and_b32 v1, 7, v1
    s_lshl_b32 s37, s59, 7
    v_lshl_add_u32 v1, v1, 4, s37
    v_lshrrev_b32 v227, 3, v0
    v_lshl_add_u32 v227, v227, 11, v1
    v_add_u32 v223, 15360, v227
    s_lshl_b32 s60, s3, 11
    s_mul_i32 s61, s59, 4
    s_and_b32 s61, s61, 7
    s_lshl3_add_u32 s62, s61, s3
    s_lshl_b32 s62, s62, 15
    v_lshrrev_b32 v1, 2, v0
    v_lshlrev_b32 v1, 7, v1
    v_bfe_u32 v2, v0, 3, 2
    v_lshl_add_u32 v1, v2, 5, v1
    v_and_b32 v2, 3, v0
    v_lshl_add_u32 v229, v2, 3, v1
    v_and_b32 v231, 7, v0
    v_lshl_add_u32 v230, v231, 6, s86
    v_mul_u32_u24 v231, 528, v231
    v_lshrrev_b32 v232, 3, v0
    v_xor_b32 v232, 7, v232
    v_lshl_add_u32 v231, v232, 3, v231
    v_add_u32 v231, s86, v231
    v_lshrrev_b32 v232, 5, v0
    v_add_u32 v232, v0, v232
    v_lshl_add_u32 v232, v232, 4, s86
    s_mul_i32 s87, s84, 4224
    s_sub_u32 s87, s87, s85
    s_lshl_b32 s87, s87, 6
    s_add_u32 s87, s87, 4032
    v_and_b32 v233, 3, v0
    v_lshl_add_u32 v233, v233, 4, s87
    v_lshrrev_b32 v234, 2, v0
    v_mul_u32_u24 v234, 4224, v234
    v_add_u32 v233, v233, v234
    s_add_u32 s80, s30, 0x400000
    s_addc_u32 s81, s31, 0
    s_mov_b32 s82, 0x420000
    s_mov_b32 s83, 0x20000
    s_waitcnt vmcnt(11)
    ds_read_b128 v[36:39], v230 offset:4224
    ds_read_b128 v[40:43], v230 offset:4240
    ds_read_b128 v[44:47], v230 offset:4256
    ds_read_b128 v[48:51], v230 offset:4272
    s_waitcnt lgkmcnt(3)
    v_lshlrev_b32 v152, 16, v36
    v_and_b32 v154, 0xffff0000, v36
    v_lshlrev_b32 v156, 16, v37
    v_and_b32 v158, 0xffff0000, v37
    v_lshlrev_b32 v153, 16, v38
    v_and_b32 v155, 0xffff0000, v38
    v_lshlrev_b32 v157, 16, v39
    v_and_b32 v159, 0xffff0000, v39
    s_waitcnt lgkmcnt(2)
    v_lshlrev_b32 v160, 16, v40
    v_and_b32 v162, 0xffff0000, v40
    v_lshlrev_b32 v164, 16, v41
    v_and_b32 v166, 0xffff0000, v41
    v_lshlrev_b32 v161, 16, v42
    v_and_b32 v163, 0xffff0000, v42
    v_lshlrev_b32 v165, 16, v43
    v_and_b32 v167, 0xffff0000, v43
    s_waitcnt lgkmcnt(1)
    v_lshlrev_b32 v168, 16, v44
    v_and_b32 v170, 0xffff0000, v44
    v_lshlrev_b32 v172, 16, v45
    v_and_b32 v174, 0xffff0000, v45
    v_lshlrev_b32 v169, 16, v46
    v_and_b32 v171, 0xffff0000, v46
    v_lshlrev_b32 v173, 16, v47
    v_and_b32 v175, 0xffff0000, v47
    s_waitcnt lgkmcnt(0)
    v_lshlrev_b32 v176, 16, v48
    v_and_b32 v178, 0xffff0000, v48
    v_lshlrev_b32 v180, 16, v49
    v_and_b32 v182, 0xffff0000, v49
    v_lshlrev_b32 v177, 16, v50
    v_and_b32 v179, 0xffff0000, v50
    v_lshlrev_b32 v181, 16, v51
    v_and_b32 v183, 0xffff0000, v51
    v_mov_b64 v[36:37], 0
    v_mov_b64 v[38:39], 0
    v_mov_b64 v[40:41], 0
    v_mov_b64 v[42:43], 0
    v_mov_b64 v[44:45], 0
    v_mov_b64 v[46:47], 0
    v_mov_b64 v[48:49], 0
    v_mov_b64 v[50:51], 0
    s_waitcnt vmcnt(10)
    v_lshlrev_b32 v184, 16, v108
    v_and_b32 v185, 0xffff0000, v108
    v_lshlrev_b32 v186, 16, v109
    v_and_b32 v187, 0xffff0000, v109
    v_lshlrev_b32 v188, 16, v110
    v_and_b32 v189, 0xffff0000, v110
    v_lshlrev_b32 v190, 16, v111
    v_and_b32 v191, 0xffff0000, v111
    v_pk_mul_f32 v[4:5], v[184:185], v[158:159]
    v_pk_mul_f32 v[12:13], v[186:187], v[166:167]
    v_pk_mul_f32 v[20:21], v[188:189], v[174:175]
    v_pk_mul_f32 v[28:29], v[190:191], v[182:183]
    s_waitcnt vmcnt(9)
    v_lshlrev_b32 v184, 16, v112
    v_and_b32 v185, 0xffff0000, v112
    v_lshlrev_b32 v186, 16, v113
    v_and_b32 v187, 0xffff0000, v113
    v_lshlrev_b32 v188, 16, v114
    v_and_b32 v189, 0xffff0000, v114
    v_lshlrev_b32 v190, 16, v115
    v_and_b32 v191, 0xffff0000, v115
    v_pk_fma_f32 v[4:5], v[184:185], v[156:157], v[4:5]
    v_pk_fma_f32 v[12:13], v[186:187], v[164:165], v[12:13]
    v_pk_fma_f32 v[20:21], v[188:189], v[172:173], v[20:21]
    v_pk_fma_f32 v[28:29], v[190:191], v[180:181], v[28:29]
    v_pk_mul_f32 v[6:7], v[184:185], v[158:159]
    v_pk_mul_f32 v[14:15], v[186:187], v[166:167]
    v_pk_mul_f32 v[22:23], v[188:189], v[174:175]
    v_pk_mul_f32 v[30:31], v[190:191], v[182:183]
    s_waitcnt vmcnt(8)
    v_lshlrev_b32 v184, 16, v116
    v_and_b32 v185, 0xffff0000, v116
    v_lshlrev_b32 v186, 16, v117
    v_and_b32 v187, 0xffff0000, v117
    v_lshlrev_b32 v188, 16, v118
    v_and_b32 v189, 0xffff0000, v118
    v_lshlrev_b32 v190, 16, v119
    v_and_b32 v191, 0xffff0000, v119
    v_pk_fma_f32 v[4:5], v[184:185], v[154:155], v[4:5]
    v_pk_fma_f32 v[12:13], v[186:187], v[162:163], v[12:13]
    v_pk_fma_f32 v[20:21], v[188:189], v[170:171], v[20:21]
    v_pk_fma_f32 v[28:29], v[190:191], v[178:179], v[28:29]
    v_pk_fma_f32 v[6:7], v[184:185], v[156:157], v[6:7]
    v_pk_fma_f32 v[14:15], v[186:187], v[164:165], v[14:15]
    v_pk_fma_f32 v[22:23], v[188:189], v[172:173], v[22:23]
    v_pk_fma_f32 v[30:31], v[190:191], v[180:181], v[30:31]
    v_pk_mul_f32 v[8:9], v[184:185], v[158:159]
    v_pk_mul_f32 v[16:17], v[186:187], v[166:167]
    v_pk_mul_f32 v[24:25], v[188:189], v[174:175]
    v_pk_mul_f32 v[32:33], v[190:191], v[182:183]
    s_waitcnt vmcnt(7)
    v_lshlrev_b32 v184, 16, v120
    v_and_b32 v185, 0xffff0000, v120
    v_lshlrev_b32 v186, 16, v121
    v_and_b32 v187, 0xffff0000, v121
    v_lshlrev_b32 v188, 16, v122
    v_and_b32 v189, 0xffff0000, v122
    v_lshlrev_b32 v190, 16, v123
    v_and_b32 v191, 0xffff0000, v123
    v_pk_fma_f32 v[4:5], v[184:185], v[152:153], v[4:5]
    v_pk_fma_f32 v[12:13], v[186:187], v[160:161], v[12:13]
    v_pk_fma_f32 v[20:21], v[188:189], v[168:169], v[20:21]
    v_pk_fma_f32 v[28:29], v[190:191], v[176:177], v[28:29]
    v_pk_fma_f32 v[6:7], v[184:185], v[154:155], v[6:7]
    v_pk_fma_f32 v[14:15], v[186:187], v[162:163], v[14:15]
    v_pk_fma_f32 v[22:23], v[188:189], v[170:171], v[22:23]
    v_pk_fma_f32 v[30:31], v[190:191], v[178:179], v[30:31]
    v_pk_fma_f32 v[8:9], v[184:185], v[156:157], v[8:9]
    v_pk_fma_f32 v[16:17], v[186:187], v[164:165], v[16:17]
    v_pk_fma_f32 v[24:25], v[188:189], v[172:173], v[24:25]
    v_pk_fma_f32 v[32:33], v[190:191], v[180:181], v[32:33]
    v_pk_mul_f32 v[10:11], v[184:185], v[158:159]
    v_pk_mul_f32 v[18:19], v[186:187], v[166:167]
    v_pk_mul_f32 v[26:27], v[188:189], v[174:175]
    v_pk_mul_f32 v[34:35], v[190:191], v[182:183]
    s_waitcnt vmcnt(6)
    v_lshlrev_b32 v184, 16, v124
    v_and_b32 v185, 0xffff0000, v124
    v_lshlrev_b32 v186, 16, v125
    v_and_b32 v187, 0xffff0000, v125
    v_lshlrev_b32 v188, 16, v126
    v_and_b32 v189, 0xffff0000, v126
    v_lshlrev_b32 v190, 16, v127
    v_and_b32 v191, 0xffff0000, v127
    v_pk_fma_f32 v[6:7], v[184:185], v[152:153], v[6:7]
    v_pk_fma_f32 v[14:15], v[186:187], v[160:161], v[14:15]
    v_pk_fma_f32 v[22:23], v[188:189], v[168:169], v[22:23]
    v_pk_fma_f32 v[30:31], v[190:191], v[176:177], v[30:31]
    v_pk_fma_f32 v[8:9], v[184:185], v[154:155], v[8:9]
    v_pk_fma_f32 v[16:17], v[186:187], v[162:163], v[16:17]
    v_pk_fma_f32 v[24:25], v[188:189], v[170:171], v[24:25]
    v_pk_fma_f32 v[32:33], v[190:191], v[178:179], v[32:33]
    v_pk_fma_f32 v[10:11], v[184:185], v[156:157], v[10:11]
    v_pk_fma_f32 v[18:19], v[186:187], v[164:165], v[18:19]
    v_pk_fma_f32 v[26:27], v[188:189], v[172:173], v[26:27]
    v_pk_fma_f32 v[34:35], v[190:191], v[180:181], v[34:35]
    s_waitcnt vmcnt(5)
    v_lshlrev_b32 v184, 16, v128
    v_and_b32 v185, 0xffff0000, v128
    v_lshlrev_b32 v186, 16, v129
    v_and_b32 v187, 0xffff0000, v129
    v_lshlrev_b32 v188, 16, v130
    v_and_b32 v189, 0xffff0000, v130
    v_lshlrev_b32 v190, 16, v131
    v_and_b32 v191, 0xffff0000, v131
    v_pk_fma_f32 v[8:9], v[184:185], v[152:153], v[8:9]
    v_pk_fma_f32 v[16:17], v[186:187], v[160:161], v[16:17]
    v_pk_fma_f32 v[24:25], v[188:189], v[168:169], v[24:25]
    v_pk_fma_f32 v[32:33], v[190:191], v[176:177], v[32:33]
    v_pk_fma_f32 v[10:11], v[184:185], v[154:155], v[10:11]
    v_pk_fma_f32 v[18:19], v[186:187], v[162:163], v[18:19]
    v_pk_fma_f32 v[26:27], v[188:189], v[170:171], v[26:27]
    v_pk_fma_f32 v[34:35], v[190:191], v[178:179], v[34:35]
    s_waitcnt vmcnt(4)
    v_lshlrev_b32 v184, 16, v132
    v_and_b32 v185, 0xffff0000, v132
    v_lshlrev_b32 v186, 16, v133
    v_and_b32 v187, 0xffff0000, v133
    v_lshlrev_b32 v188, 16, v134
    v_and_b32 v189, 0xffff0000, v134
    v_lshlrev_b32 v190, 16, v135
    v_and_b32 v191, 0xffff0000, v135
    v_pk_fma_f32 v[10:11], v[184:185], v[152:153], v[10:11]
    v_pk_fma_f32 v[18:19], v[186:187], v[160:161], v[18:19]
    v_pk_fma_f32 v[26:27], v[188:189], v[168:169], v[26:27]
    v_pk_fma_f32 v[34:35], v[190:191], v[176:177], v[34:35]
    s_waitcnt vmcnt(3)
    v_lshlrev_b32 v184, 16, v136
    v_and_b32 v185, 0xffff0000, v136
    v_lshlrev_b32 v186, 16, v137
    v_and_b32 v187, 0xffff0000, v137
    v_lshlrev_b32 v188, 16, v138
    v_and_b32 v189, 0xffff0000, v138
    v_lshlrev_b32 v190, 16, v139
    v_and_b32 v191, 0xffff0000, v139
    v_pk_mul_f32 v[4:5], v[4:5], v[184:185]
    v_pk_mul_f32 v[12:13], v[12:13], v[186:187]
    v_pk_mul_f32 v[20:21], v[20:21], v[188:189]
    v_pk_mul_f32 v[28:29], v[28:29], v[190:191]
    s_waitcnt vmcnt(2)
    v_lshlrev_b32 v184, 16, v140
    v_and_b32 v185, 0xffff0000, v140
    v_lshlrev_b32 v186, 16, v141
    v_and_b32 v187, 0xffff0000, v141
    v_lshlrev_b32 v188, 16, v142
    v_and_b32 v189, 0xffff0000, v142
    v_lshlrev_b32 v190, 16, v143
    v_and_b32 v191, 0xffff0000, v143
    v_pk_mul_f32 v[6:7], v[6:7], v[184:185]
    v_pk_mul_f32 v[14:15], v[14:15], v[186:187]
    v_pk_mul_f32 v[22:23], v[22:23], v[188:189]
    v_pk_mul_f32 v[30:31], v[30:31], v[190:191]
    s_waitcnt vmcnt(1)
    v_lshlrev_b32 v184, 16, v144
    v_and_b32 v185, 0xffff0000, v144
    v_lshlrev_b32 v186, 16, v145
    v_and_b32 v187, 0xffff0000, v145
    v_lshlrev_b32 v188, 16, v146
    v_and_b32 v189, 0xffff0000, v146
    v_lshlrev_b32 v190, 16, v147
    v_and_b32 v191, 0xffff0000, v147
    v_pk_mul_f32 v[8:9], v[8:9], v[184:185]
    v_pk_mul_f32 v[16:17], v[16:17], v[186:187]
    v_pk_mul_f32 v[24:25], v[24:25], v[188:189]
    v_pk_mul_f32 v[32:33], v[32:33], v[190:191]
    s_waitcnt vmcnt(0)
    v_lshlrev_b32 v184, 16, v148
    v_and_b32 v185, 0xffff0000, v148
    v_lshlrev_b32 v186, 16, v149
    v_and_b32 v187, 0xffff0000, v149
    v_lshlrev_b32 v188, 16, v150
    v_and_b32 v189, 0xffff0000, v150
    v_lshlrev_b32 v190, 16, v151
    v_and_b32 v191, 0xffff0000, v151
    v_pk_mul_f32 v[10:11], v[10:11], v[184:185]
    v_pk_mul_f32 v[18:19], v[18:19], v[186:187]
    v_pk_mul_f32 v[26:27], v[26:27], v[188:189]
    v_pk_mul_f32 v[34:35], v[34:35], v[190:191]
    v_cvt_pk_bf16_f32 v108, v10, v8
    v_cvt_pk_bf16_f32 v109, v6, v4
    ds_write_b64 v231, v[108:109] offset:0
    v_cvt_pk_bf16_f32 v110, v11, v9
    v_cvt_pk_bf16_f32 v111, v7, v5
    ds_write_b64 v231, v[110:111] offset:64
    v_cvt_pk_bf16_f32 v112, v18, v16
    v_cvt_pk_bf16_f32 v113, v14, v12
    ds_write_b64 v231, v[112:113] offset:128
    v_cvt_pk_bf16_f32 v114, v19, v17
    v_cvt_pk_bf16_f32 v115, v15, v13
    ds_write_b64 v231, v[114:115] offset:192
    v_cvt_pk_bf16_f32 v116, v26, v24
    v_cvt_pk_bf16_f32 v117, v22, v20
    ds_write_b64 v231, v[116:117] offset:256
    v_cvt_pk_bf16_f32 v118, v27, v25
    v_cvt_pk_bf16_f32 v119, v23, v21
    ds_write_b64 v231, v[118:119] offset:320
    v_cvt_pk_bf16_f32 v120, v34, v32
    v_cvt_pk_bf16_f32 v121, v30, v28
    ds_write_b64 v231, v[120:121] offset:384
    v_cvt_pk_bf16_f32 v122, v35, v33
    v_cvt_pk_bf16_f32 v123, v31, v29
    ds_write_b64 v231, v[122:123] offset:448
    ds_read_b128 v[234:237], v232 offset:0
    ds_read_b128 v[238:241], v232 offset:1056
    ds_read_b128 v[242:245], v232 offset:2112
    ds_read_b128 v[246:249], v232 offset:3168
    v_mov_b64 v[4:5], 0
    v_mov_b64 v[6:7], 0
    v_mov_b64 v[8:9], 0
    v_mov_b64 v[10:11], 0
    v_mov_b64 v[12:13], 0
    v_mov_b64 v[14:15], 0
    v_mov_b64 v[16:17], 0
    v_mov_b64 v[18:19], 0
    v_mov_b64 v[20:21], 0
    v_mov_b64 v[22:23], 0
    v_mov_b64 v[24:25], 0
    v_mov_b64 v[26:27], 0
    v_mov_b64 v[28:29], 0
    v_mov_b64 v[30:31], 0
    v_mov_b64 v[32:33], 0
    v_mov_b64 v[34:35], 0
    s_waitcnt lgkmcnt(0)
    s_and_b32 s37, s2, 7
    s_xor_b32 s37, s37, 2
    s_lshl_b32 s37, s37, 5
    s_lshr_b32 s38, s2, 3
    s_add_u32 s37, s37, s38
    s_add_u32 s37, s37, 256
    s_lshl_b32 s37, s37, 8
    s_cmp_eq_u32 s33, 0
    s_cselect_b32 s37, s37, s57
    s_cmp_eq_u32 s32, 0
    s_cbranch_scc0 L_noclear
    s_mov_b64 exec, 1
    buffer_store_dword v4, off, s[52:55], s37 sc1
    s_mov_b64 exec, -1
L_noclear:
    s_mov_b32 s37, 41984
    s_mov_b32 s36, 15
    s_barrier
    ds_read_b128 v[108:111], v196 offset:0
    ds_read_b64_tr_b16 v[124:125], v200 offset:0
    ds_read_b64_tr_b16 v[126:127], v200 offset:512
    ds_read_b128 v[112:115], v196 offset:2048
    ds_read_b64_tr_b16 v[128:129], v201 offset:0
    ds_read_b64_tr_b16 v[130:131], v201 offset:512
    ds_read_b128 v[116:119], v196 offset:4096
    ds_read_b64_tr_b16 v[148:149], v200 offset:8192
    ds_read_b64_tr_b16 v[150:151], v200 offset:8704
    ds_read_b128 v[120:123], v196 offset:6144
    ds_read_b64_tr_b16 v[132:133], v201 offset:8192
    ds_read_b64_tr_b16 v[134:135], v201 offset:8704
    ds_read_b64_tr_b16 v[156:157], v200 offset:16384
    ds_read_b64_tr_b16 v[158:159], v200 offset:16896
    ds_read_b64_tr_b16 v[136:137], v201 offset:16384
    ds_read_b64_tr_b16 v[138:139], v201 offset:16896
    s_mov_b32 s87, 0
    buffer_store_dwordx4 v[234:237], v233, s[80:83], s87 offen sc1
    s_mov_b32 s87, 67584
    buffer_store_dwordx4 v[238:241], v233, s[80:83], s87 offen sc1
    s_mov_b32 s87, 135168
    buffer_store_dwordx4 v[242:245], v233, s[80:83], s87 offen sc1
    s_mov_b32 s87, 202752
    buffer_store_dwordx4 v[246:249], v233, s[80:83], s87 offen sc1
    s_branch L_g1_head
.p2align 6
L_g1_head:
    s_waitcnt lgkmcnt(0)
L_g1_loop:
    v_mfma_f32_16x16x32_bf16 v[4:7], v[124:127], v[108:111], v[4:7]
    ds_read_b128 v[164:167], v197 offset:0
    v_mfma_f32_16x16x32_bf16 v[12:15], v[124:127], v[112:115], v[12:15]
    ds_read_b64_tr_b16 v[180:181], v200 offset:4096
    v_mfma_f32_16x16x32_bf16 v[20:23], v[124:127], v[116:119], v[20:23]
    ds_read_b64_tr_b16 v[182:183], v200 offset:4608
    v_mfma_f32_16x16x32_bf16 v[28:31], v[124:127], v[120:123], v[28:31]
    ds_read_b128 v[168:171], v197 offset:2048
    v_mfma_f32_16x16x32_bf16 v[32:35], v[128:131], v[120:123], v[32:35]
    ds_read_b64_tr_b16 v[184:185], v201 offset:4096
    v_mfma_f32_16x16x32_bf16 v[24:27], v[128:131], v[116:119], v[24:27]
    ds_read_b64_tr_b16 v[186:187], v201 offset:4608
    v_mfma_f32_16x16x32_bf16 v[16:19], v[128:131], v[112:115], v[16:19]
    ds_read_b128 v[172:175], v197 offset:4096
    v_mfma_f32_16x16x32_bf16 v[8:11], v[128:131], v[108:111], v[8:11]
    ds_read_b64_tr_b16 v[152:153], v200 offset:12288
    v_mfma_f32_16x16x32_bf16 v[40:43], v[132:135], v[108:111], v[40:43]
    ds_read_b64_tr_b16 v[154:155], v200 offset:12800
    v_mfma_f32_16x16x32_bf16 v[48:51], v[132:135], v[112:115], v[48:51]
    ds_read_b128 v[176:179], v197 offset:6144
    v_mfma_f32_16x16x32_bf16 v[56:59], v[132:135], v[116:119], v[56:59]
    ds_read_b64_tr_b16 v[188:189], v201 offset:12288
    v_mfma_f32_16x16x32_bf16 v[64:67], v[132:135], v[120:123], v[64:67]
    ds_read_b64_tr_b16 v[190:191], v201 offset:12800
    v_mfma_f32_16x16x32_bf16 v[60:63], v[148:151], v[120:123], v[60:63]
    ds_read2_b32 v[140:141], v198 offset1:2
    v_mfma_f32_16x16x32_bf16 v[52:55], v[148:151], v[116:119], v[52:55]
    ds_read2_b32 v[142:143], v199 offset1:2
    v_mfma_f32_16x16x32_bf16 v[44:47], v[148:151], v[112:115], v[44:47]
    ds_read_b64_tr_b16 v[160:161], v200 offset:20480
    v_mfma_f32_16x16x32_bf16 v[36:39], v[148:151], v[108:111], v[36:39]
    ds_read_b64_tr_b16 v[162:163], v200 offset:20992
    v_mfma_f32_16x16x32_bf16 v[68:71], v[108:111], v[156:159], v[68:71]
    ds_read_b64_tr_b16 v[192:193], v201 offset:20480
    ds_read_b64_tr_b16 v[194:195], v201 offset:20992
    v_mfma_f32_16x16x32_bf16 v[76:79], v[112:115], v[156:159], v[76:79]
    ds_read_b32 v1, v228 offset:24
    s_add_u32 s34, s34, 41984
    v_mfma_f32_16x16x32_bf16 v[84:87], v[116:119], v[156:159], v[84:87]
    s_cmp_eq_u32 s34, 125952
    s_cselect_b32 s35, -83968, s37
    v_mfma_f32_16x16x32_bf16 v[92:95], v[120:123], v[156:159], v[92:95]
    s_cselect_b32 s34, 0, s34
    s_bitcmp1_b32 0x1002, s36
    v_mfma_f32_16x16x32_bf16 v[96:99], v[120:123], v[136:139], v[96:99]
    v_add_u32 v196, s35, v196
    v_add_u32 v197, s35, v197
    v_mfma_f32_16x16x32_bf16 v[88:91], v[116:119], v[136:139], v[88:91]
    v_add_u32 v198, s35, v198
    v_add_u32 v199, s35, v199
    v_mfma_f32_16x16x32_bf16 v[80:83], v[112:115], v[136:139], v[80:83]
    v_add_u32 v200, s35, v200
    v_add_u32 v201, s35, v201
    v_mfma_f32_16x16x32_bf16 v[72:75], v[108:111], v[136:139], v[72:75]
    s_waitcnt lgkmcnt(0)
    v_smfmac_f32_16x16x64_bf16 v[100:103], v[140:143], v[148:155], v202
    v_smfmac_f32_16x16x64_bf16 v[104:107], v[140:143], v[156:163], v202
    s_cbranch_scc1 L_g1_rare
L_g1_bar:
    s_barrier
L_g1_nobar:
    v_mfma_f32_16x16x32_bf16 v[4:7], v[180:183], v[164:167], v[4:7]
    ds_read_b128 v[108:111], v196 offset:0
    v_mfma_f32_16x16x32_bf16 v[12:15], v[180:183], v[168:171], v[12:15]
    ds_read_b64_tr_b16 v[124:125], v200 offset:0
    v_mfma_f32_16x16x32_bf16 v[20:23], v[180:183], v[172:175], v[20:23]
    ds_read_b64_tr_b16 v[126:127], v200 offset:512
    v_mfma_f32_16x16x32_bf16 v[28:31], v[180:183], v[176:179], v[28:31]
    ds_read_b128 v[112:115], v196 offset:2048
    v_mfma_f32_16x16x32_bf16 v[32:35], v[184:187], v[176:179], v[32:35]
    ds_read_b64_tr_b16 v[128:129], v201 offset:0
    v_mfma_f32_16x16x32_bf16 v[24:27], v[184:187], v[172:175], v[24:27]
    ds_read_b64_tr_b16 v[130:131], v201 offset:512
    v_mfma_f32_16x16x32_bf16 v[16:19], v[184:187], v[168:171], v[16:19]
    ds_read_b128 v[116:119], v196 offset:4096
    v_mfma_f32_16x16x32_bf16 v[8:11], v[184:187], v[164:167], v[8:11]
    ds_read_b64_tr_b16 v[148:149], v200 offset:8192
    v_mfma_f32_16x16x32_bf16 v[40:43], v[188:191], v[164:167], v[40:43]
    ds_read_b64_tr_b16 v[150:151], v200 offset:8704
    v_mfma_f32_16x16x32_bf16 v[48:51], v[188:191], v[168:171], v[48:51]
    ds_read_b128 v[120:123], v196 offset:6144
    v_mfma_f32_16x16x32_bf16 v[56:59], v[188:191], v[172:175], v[56:59]
    ds_read_b64_tr_b16 v[132:133], v201 offset:8192
    v_mfma_f32_16x16x32_bf16 v[64:67], v[188:191], v[176:179], v[64:67]
    ds_read_b64_tr_b16 v[134:135], v201 offset:8704
    v_mfma_f32_16x16x32_bf16 v[60:63], v[152:155], v[176:179], v[60:63]
    ds_read_b64_tr_b16 v[156:157], v200 offset:16384
    v_mfma_f32_16x16x32_bf16 v[52:55], v[152:155], v[172:175], v[52:55]
    ds_read_b64_tr_b16 v[158:159], v200 offset:16896
    v_mfma_f32_16x16x32_bf16 v[44:47], v[152:155], v[168:171], v[44:47]
    ds_read_b64_tr_b16 v[136:137], v201 offset:16384
    v_mfma_f32_16x16x32_bf16 v[36:39], v[152:155], v[164:167], v[36:39]
    ds_read_b64_tr_b16 v[138:139], v201 offset:16896
    v_mfma_f32_16x16x32_bf16 v[68:71], v[164:167], v[160:163], v[68:71]
    s_sub_u32 s36, s36, 1
    v_mfma_f32_16x16x32_bf16 v[76:79], v[168:171], v[160:163], v[76:79]
    s_cmp_lg_u32 s36, 0
    v_mfma_f32_16x16x32_bf16 v[84:87], v[172:175], v[160:163], v[84:87]
    v_mfma_f32_16x16x32_bf16 v[92:95], v[176:179], v[160:163], v[92:95]
    v_mfma_f32_16x16x32_bf16 v[96:99], v[176:179], v[192:195], v[96:99]
    v_mfma_f32_16x16x32_bf16 v[88:91], v[172:175], v[192:195], v[88:91]
    v_mfma_f32_16x16x32_bf16 v[80:83], v[168:171], v[192:195], v[80:83]
    s_waitcnt lgkmcnt(0)
    v_mfma_f32_16x16x32_bf16 v[72:75], v[164:167], v[192:195], v[72:75]
    s_cbranch_scc1 L_g1_loop
    v_mfma_f32_16x16x32_bf16 v[4:7], v[124:127], v[108:111], v[4:7]
    ds_read_b128 v[164:167], v197 offset:0
    v_mfma_f32_16x16x32_bf16 v[12:15], v[124:127], v[112:115], v[12:15]
    ds_read_b64_tr_b16 v[180:181], v200 offset:4096
    v_mfma_f32_16x16x32_bf16 v[20:23], v[124:127], v[116:119], v[20:23]
    ds_read_b64_tr_b16 v[182:183], v200 offset:4608
    v_mfma_f32_16x16x32_bf16 v[28:31], v[124:127], v[120:123], v[28:31]
    ds_read_b128 v[168:171], v197 offset:2048
    v_mfma_f32_16x16x32_bf16 v[32:35], v[128:131], v[120:123], v[32:35]
    ds_read_b64_tr_b16 v[184:185], v201 offset:4096
    v_mfma_f32_16x16x32_bf16 v[24:27], v[128:131], v[116:119], v[24:27]
    ds_read_b64_tr_b16 v[186:187], v201 offset:4608
    v_mfma_f32_16x16x32_bf16 v[16:19], v[128:131], v[112:115], v[16:19]
    ds_read_b128 v[172:175], v197 offset:4096
    v_mfma_f32_16x16x32_bf16 v[8:11], v[128:131], v[108:111], v[8:11]
    ds_read_b64_tr_b16 v[152:153], v200 offset:12288
    v_mfma_f32_16x16x32_bf16 v[40:43], v[132:135], v[108:111], v[40:43]
    ds_read_b64_tr_b16 v[154:155], v200 offset:12800
    v_mfma_f32_16x16x32_bf16 v[48:51], v[132:135], v[112:115], v[48:51]
    ds_read_b128 v[176:179], v197 offset:6144
    v_mfma_f32_16x16x32_bf16 v[56:59], v[132:135], v[116:119], v[56:59]
    ds_read_b64_tr_b16 v[188:189], v201 offset:12288
    v_mfma_f32_16x16x32_bf16 v[64:67], v[132:135], v[120:123], v[64:67]
    ds_read_b64_tr_b16 v[190:191], v201 offset:12800
    v_mfma_f32_16x16x32_bf16 v[60:63], v[148:151], v[120:123], v[60:63]
    ds_read2_b32 v[140:141], v198 offset1:2
    v_mfma_f32_16x16x32_bf16 v[52:55], v[148:151], v[116:119], v[52:55]
    ds_read2_b32 v[142:143], v199 offset1:2
    v_mfma_f32_16x16x32_bf16 v[44:47], v[148:151], v[112:115], v[44:47]
    ds_read_b64_tr_b16 v[160:161], v200 offset:20480
    v_mfma_f32_16x16x32_bf16 v[36:39], v[148:151], v[108:111], v[36:39]
    ds_read_b64_tr_b16 v[162:163], v200 offset:20992
    v_mfma_f32_16x16x32_bf16 v[68:71], v[108:111], v[156:159], v[68:71]
    ds_read_b64_tr_b16 v[192:193], v201 offset:20480
    v_mfma_f32_16x16x32_bf16 v[76:79], v[112:115], v[156:159], v[76:79]
    ds_read_b64_tr_b16 v[194:195], v201 offset:20992
    v_mfma_f32_16x16x32_bf16 v[84:87], v[116:119], v[156:159], v[84:87]
    v_mfma_f32_16x16x32_bf16 v[92:95], v[120:123], v[156:159], v[92:95]
    v_mfma_f32_16x16x32_bf16 v[96:99], v[120:123], v[136:139], v[96:99]
    v_mfma_f32_16x16x32_bf16 v[88:91], v[116:119], v[136:139], v[88:91]
    v_mfma_f32_16x16x32_bf16 v[80:83], v[112:115], v[136:139], v[80:83]
    v_mfma_f32_16x16x32_bf16 v[72:75], v[108:111], v[136:139], v[72:75]
    s_waitcnt lgkmcnt(0)
    s_setprio 2
    v_mov_b32 v2, 1
    v_smfmac_f32_16x16x64_bf16 v[100:103], v[140:143], v[148:155], v202
    v_smfmac_f32_16x16x64_bf16 v[104:107], v[140:143], v[156:163], v202
    v_mfma_f32_16x16x32_bf16 v[60:63], v[152:155], v[176:179], v[60:63]
    v_mfma_f32_16x16x32_bf16 v[64:67], v[188:191], v[176:179], v[64:67]
    v_mfma_f32_16x16x32_bf16 v[92:95], v[176:179], v[160:163], v[92:95]
    v_mfma_f32_16x16x32_bf16 v[96:99], v[176:179], v[192:195], v[96:99]
    v_mfma_f32_16x16x32_bf16 v[28:31], v[180:183], v[176:179], v[28:31]
    v_mfma_f32_16x16x32_bf16 v[32:35], v[184:187], v[176:179], v[32:35]
    v_mfma_f32_16x16x32_bf16 v[52:55], v[152:155], v[172:175], v[52:55]
    v_mfma_f32_16x16x32_bf16 v[56:59], v[188:191], v[172:175], v[56:59]
    s_nop 3
    v_permlane32_swap_b32 v100, v104
    v_permlane32_swap_b32 v101, v105
    v_mfma_f32_16x16x32_bf16 v[20:23], v[180:183], v[172:175], v[20:23]
    v_permlane32_swap_b32 v102, v106
    v_permlane32_swap_b32 v103, v107
    v_mfma_f32_16x16x32_bf16 v[24:27], v[184:187], v[172:175], v[24:27]
    v_add_f32 v100, v100, v104
    v_add_f32 v101, v101, v105
    v_mfma_f32_16x16x32_bf16 v[44:47], v[152:155], v[168:171], v[44:47]
    v_add_f32 v102, v102, v106
    v_add_f32 v103, v103, v107
    v_mfma_f32_16x16x32_bf16 v[48:51], v[188:191], v[168:171], v[48:51]
    v_cvt_pk_bf16_f32 v144, v100, v101
    v_cvt_pk_bf16_f32 v145, v102, v103
    v_mfma_f32_16x16x32_bf16 v[12:15], v[180:183], v[168:171], v[12:15]
    ds_write_b64 v219, v[144:145] offset:1024
    ds_write_b16 v203, v144 offset:0
    v_mfma_f32_16x16x32_bf16 v[16:19], v[184:187], v[168:171], v[16:19]
    ds_write_b16_d16_hi v203, v144 offset:8
    ds_write_b16 v203, v145 offset:16
    v_mfma_f32_16x16x32_bf16 v[36:39], v[152:155], v[164:167], v[36:39]
    ds_write_b16_d16_hi v203, v145 offset:24
    v_cvt_pk_bf16_f32 v140, v60, v61
    v_mfma_f32_16x16x32_bf16 v[40:43], v[188:191], v[164:167], v[40:43]
    v_cvt_pk_bf16_f32 v141, v62, v63
    v_cvt_pk_bf16_f32 v142, v64, v65
    v_mfma_f32_16x16x32_bf16 v[4:7], v[180:183], v[164:167], v[4:7]
    v_cvt_pk_bf16_f32 v143, v66, v67
    v_cvt_pk_bf16_f32 v238, v92, v93
    v_mfma_f32_16x16x32_bf16 v[8:11], v[184:187], v[164:167], v[8:11]
    v_cvt_pk_bf16_f32 v239, v94, v95
    v_cvt_pk_bf16_f32 v248, v96, v97
    v_mfma_f32_16x16x32_bf16 v[84:87], v[172:175], v[160:163], v[84:87]
    v_cvt_pk_bf16_f32 v249, v98, v99
    s_cmp_eq_u32 s33, 0
    s_cbranch_scc0 L_at_nopub
    ds_write_b64 v220, v[140:141] offset:2048
    ds_write_b64 v220, v[238:239] offset:3072
    ds_write_b64 v220, v[142:143] offset:2560
    ds_write_b64 v220, v[248:249] offset:3584
L_at_nopub:
    s_mov_b64 exec, 1
    ds_add_u32 v228, v2 offset:20
    s_mov_b64 exec, -1
    v_mfma_f32_16x16x32_bf16 v[88:91], v[172:175], v[192:195], v[88:91]
    v_cvt_pk_bf16_f32 v120, v28, v29
    v_cvt_pk_bf16_f32 v121, v30, v31
    v_mfma_f32_16x16x32_bf16 v[76:79], v[168:171], v[160:163], v[76:79]
    v_cvt_pk_bf16_f32 v122, v32, v33
    v_cvt_pk_bf16_f32 v123, v34, v35
    v_mfma_f32_16x16x32_bf16 v[80:83], v[168:171], v[192:195], v[80:83]
    v_cvt_pk_bf16_f32 v136, v52, v53
    v_cvt_pk_bf16_f32 v137, v54, v55
    v_mfma_f32_16x16x32_bf16 v[68:71], v[164:167], v[160:163], v[68:71]
    v_cvt_pk_bf16_f32 v138, v56, v57
    v_cvt_pk_bf16_f32 v139, v58, v59
    v_mfma_f32_16x16x32_bf16 v[72:75], v[164:167], v[192:195], v[72:75]
    v_cvt_pk_bf16_f32 v116, v20, v21
    v_cvt_pk_bf16_f32 v117, v22, v23
    v_mfma_f32_16x16x32_bf16 v[28:31], v[140:143], v[120:123], v[204:207]
    v_cvt_pk_bf16_f32 v118, v24, v25
    v_cvt_pk_bf16_f32 v119, v26, v27
    v_mfma_f32_16x16x32_bf16 v[32:35], v[136:139], v[120:123], v[208:211]
    v_cvt_pk_bf16_f32 v132, v44, v45
    v_cvt_pk_bf16_f32 v133, v46, v47
    v_mfma_f32_16x16x32_bf16 v[20:23], v[136:139], v[116:119], v[204:207]
    v_cvt_pk_bf16_f32 v134, v48, v49
    v_cvt_pk_bf16_f32 v135, v50, v51
    s_nop 1
    v_mfma_f32_16x16x32_bf16 v[24:27], v[132:135], v[116:119], v[208:211]
    v_cvt_pk_bf16_f32 v112, v12, v13
    v_cvt_pk_bf16_f32 v113, v14, v15
    v_cvt_pk_bf16_f32 v114, v16, v17
    v_cvt_pk_bf16_f32 v115, v18, v19
    s_nop 1
    v_mfma_f32_16x16x32_bf16 v[12:15], v[132:135], v[112:115], v[204:207]
    v_cvt_pk_bf16_f32 v128, v36, v37
    v_cvt_pk_bf16_f32 v129, v38, v39
    v_cvt_pk_bf16_f32 v130, v40, v41
    v_cvt_pk_bf16_f32 v131, v42, v43
    s_nop 1
    v_mfma_f32_16x16x32_bf16 v[16:19], v[128:131], v[112:115], v[208:211]
    v_cvt_pk_bf16_f32 v108, v4, v5
    v_cvt_pk_bf16_f32 v109, v6, v7
    v_cvt_pk_bf16_f32 v110, v8, v9
    v_cvt_pk_bf16_f32 v111, v10, v11
    s_nop 1
    v_mfma_f32_16x16x32_bf16 v[4:7], v[128:131], v[108:111], v[204:207]
    v_cvt_pk_bf16_f32 v236, v84, v85
    v_cvt_pk_bf16_f32 v237, v86, v87
    v_cvt_pk_bf16_f32 v246, v88, v89
    v_cvt_pk_bf16_f32 v247, v90, v91
    v_cvt_pk_bf16_f32 v234, v76, v77
    v_cvt_pk_bf16_f32 v235, v78, v79
    ds_read_b32 v1, v228 offset:20
    v_cvt_pk_bf16_f32 v244, v80, v81
    v_cvt_pk_bf16_f32 v245, v82, v83
    v_cvt_pk_bf16_f32 v232, v68, v69
    v_cvt_pk_bf16_f32 v233, v70, v71
    v_cvt_pk_bf16_f32 v242, v72, v73
    v_cvt_pk_bf16_f32 v243, v74, v75
    s_waitcnt lgkmcnt(0)
    v_readfirstlane_b32 s37, v1
    s_nop 0
    s_cmp_ge_u32 s37, 4
    s_cbranch_scc1 L_sl_done_42
    s_mov_b32 s38, 1048576
L_sl_loop_43:
    ds_read_b32 v1, v228 offset:20
    s_waitcnt lgkmcnt(0)
    v_readfirstlane_b32 s37, v1
    s_nop 0
    s_cmp_ge_u32 s37, 4
    s_cbranch_scc1 L_sl_done_42
    s_sleep 1
    s_sub_u32 s38, s38, 1
    s_cbranch_scc0 L_sl_loop_43
L_sl_done_42:
    ds_read_b64 v[124:125], v221
    ds_read_b64 v[126:127], v222
    ds_read_b64 v[230:231], v221 offset:1024
    ds_read_b64 v[240:241], v222 offset:1024
    v_max_f32 v28, v28, v32
    v_max_f32 v29, v29, v33
    v_max_f32 v30, v30, v34
    v_max_f32 v31, v31, v35
    v_max3_f32 v39, v28, v29, v30
    v_max_f32 v39, v39, v31
    v_max_f32 v20, v20, v24
    v_max_f32 v21, v21, v25
    v_max_f32 v22, v22, v26
    v_max_f32 v23, v23, v27
    v_max3_f32 v38, v20, v21, v22
    v_max_f32 v38, v38, v23
    s_waitcnt lgkmcnt(2)
    v_mfma_f32_16x16x32_bf16 v[8:11], v[124:127], v[108:111], v[212:215]
    s_setprio 2
    s_mov_b32 s37, 0x3e8293ee
    v_max_f32 v12, v12, v16
    v_max_f32 v13, v13, v17
    v_max_f32 v14, v14, v18
    v_max_f32 v15, v15, v19
    v_max3_f32 v37, v12, v13, v14
    v_max_f32 v37, v37, v15
    v_max_f32 v4, v4, v8
    v_max_f32 v5, v5, v9
    v_max_f32 v6, v6, v10
    v_max_f32 v7, v7, v11
    v_max3_f32 v36, v4, v5, v6
    v_max_f32 v36, v36, v7
    v_permlane32_swap_b32 v38, v39
    s_nop 0
    v_permlane32_swap_b32 v36, v37
    v_max_f32 v38, v38, v39
    v_max_f32 v36, v36, v37
    s_nop 1
    v_permlane16_swap_b32 v36, v38
    v_max_f32 v36, v36, v38
    v_mul_f32 v38, s37, v36
    v_mul_f32 v36, s37, v36
    s_nop 1
    v_permlane16_swap_b32 v36, v38
    v_mov_b32 v37, v36
    s_add_u32 m0, s60, 0
    v_mov_b32 v39, v38
    v_permlane32_swap_b32 v36, v37
    s_xor_b32 s63, s62, 0
    v_permlane32_swap_b32 v38, v39
    v_fma_f32 v4, v4, s37, -v36
    buffer_load_dwordx4 v227, s[44:47], s63 offen offset:0 lds
    v_fma_f32 v5, v5, s37, -v36
    v_fma_f32 v6, v6, s37, -v36
    buffer_load_dwordx4 v223, s[44:47], s63 offen offset:1024 lds
    v_fma_f32 v7, v7, s37, -v36
    v_fma_f32 v12, v12, s37, -v37
    s_add_u32 m0, s60, 8192
    v_fma_f32 v13, v13, s37, -v37
    v_fma_f32 v14, v14, s37, -v37
    s_xor_b32 s63, s62, 131072
    v_fma_f32 v15, v15, s37, -v37
    v_fma_f32 v20, v20, s37, -v38
    buffer_load_dwordx4 v227, s[44:47], s63 offen offset:0 lds
    v_fma_f32 v21, v21, s37, -v38
    v_fma_f32 v22, v22, s37, -v38
    buffer_load_dwordx4 v223, s[44:47], s63 offen offset:1024 lds
    v_fma_f32 v23, v23, s37, -v38
    v_fma_f32 v28, v28, s37, -v39
    s_add_u32 m0, s60, 16384
    v_fma_f32 v29, v29, s37, -v39
    v_fma_f32 v30, v30, s37, -v39
    s_xor_b32 s63, s62, 262144
    v_fma_f32 v31, v31, s37, -v39
    v_exp_f32 v28, v28
    buffer_load_dwordx4 v227, s[44:47], s63 offen offset:0 lds
    v_exp_f32 v29, v29
    v_exp_f32 v30, v30
    buffer_load_dwordx4 v223, s[44:47], s63 offen offset:1024 lds
    v_exp_f32 v31, v31
    v_exp_f32 v20, v20
    s_add_u32 m0, s60, 24576
    v_exp_f32 v21, v21
    v_exp_f32 v22, v22
    s_xor_b32 s63, s62, 393216
    v_exp_f32 v23, v23
    v_exp_f32 v12, v12
    buffer_load_dwordx4 v227, s[44:47], s63 offen offset:0 lds
    v_exp_f32 v13, v13
    v_exp_f32 v14, v14
    buffer_load_dwordx4 v223, s[44:47], s63 offen offset:1024 lds
    v_exp_f32 v15, v15
    v_exp_f32 v4, v4
    s_add_u32 m0, s60, 32768
    v_exp_f32 v5, v5
    v_exp_f32 v6, v6
    s_xor_b32 s63, s62, 524288
    v_exp_f32 v7, v7
    v_add_f32 v39, v28, v29
    buffer_load_dwordx4 v227, s[44:47], s63 offen offset:0 lds
    v_add_f32 v32, v30, v31
    v_add_f32 v39, v39, v32
    buffer_load_dwordx4 v223, s[44:47], s63 offen offset:1024 lds
    v_add_f32 v38, v20, v21
    v_add_f32 v24, v22, v23
    s_add_u32 m0, s60, 83968
    v_add_f32 v38, v38, v24
    v_add_f32 v37, v12, v13
    s_xor_b32 s63, s62, 655360
    v_add_f32 v16, v14, v15
    v_add_f32 v37, v37, v16
    buffer_load_dwordx4 v227, s[44:47], s63 offen offset:0 lds
    v_add_f32 v36, v4, v5
    v_add_f32 v8, v6, v7
    buffer_load_dwordx4 v223, s[44:47], s63 offen offset:1024 lds
    v_add_f32 v36, v36, v8
    v_permlane32_swap_b32 v38, v39
    s_add_u32 m0, s60, 92160
    v_permlane32_swap_b32 v36, v37
    v_add_f32 v38, v38, v39
    s_xor_b32 s63, s62, 786432
    v_add_f32 v36, v36, v37
    s_nop 1
    v_permlane16_swap_b32 v36, v38
    buffer_load_dwordx4 v227, s[44:47], s63 offen offset:0 lds
    v_add_f32 v36, v36, v38
    v_rcp_f32 v38, v36
    buffer_load_dwordx4 v223, s[44:47], s63 offen offset:1024 lds
    v_rcp_f32 v36, v36
    s_nop 1
    v_permlane16_swap_b32 v36, v38
    s_add_u32 m0, s60, 100352
    v_mov_b32 v37, v36
    v_mov_b32 v39, v38
    s_xor_b32 s63, s62, 917504
    v_permlane32_swap_b32 v36, v37
    v_permlane32_swap_b32 v38, v39
    buffer_load_dwordx4 v227, s[44:47], s63 offen offset:0 lds
    s_waitcnt lgkmcnt(0)
    buffer_load_dwordx4 v223, s[44:47], s63 offen offset:1024 lds
    s_add_u32 m0, s60, 108544
    s_xor_b32 s63, s62, 1048576
    buffer_load_dwordx4 v227, s[44:47], s63 offen offset:0 lds
    buffer_load_dwordx4 v223, s[44:47], s63 offen offset:1024 lds
    s_add_u32 m0, s60, 116736
    s_xor_b32 s63, s62, 1179648
    buffer_load_dwordx4 v227, s[44:47], s63 offen offset:0 lds
    buffer_load_dwordx4 v223, s[44:47], s63 offen offset:1024 lds
    s_cmp_eq_u32 s33, 0
    v_mul_f32 v4, v4, v36
    v_mul_f32 v5, v5, v36
    v_mul_f32 v6, v6, v36
    v_mul_f32 v7, v7, v36
    v_cvt_pk_bf16_f32 v10, v4, v5
    v_cvt_pk_bf16_f32 v11, v6, v7
    v_and_b32 v8, v216, v10
    v_and_b32 v9, v217, v11
    v_xor_b32 v10, v8, v10
    v_xor_b32 v11, v9, v11
    s_setprio 2
    s_nop 0
    v_mfma_f32_16x16x32_bf16 v[68:71], v[230:233], v[8:11], 0
    v_mfma_f32_16x16x32_bf16 v[72:75], v[240:243], v[8:11], 0
    s_setprio 2
    v_mul_f32 v12, v12, v37
    v_mul_f32 v13, v13, v37
    v_mul_f32 v14, v14, v37
    v_mul_f32 v15, v15, v37
    v_cvt_pk_bf16_f32 v18, v12, v13
    v_cvt_pk_bf16_f32 v19, v14, v15
    v_and_b32 v16, v216, v18
    v_and_b32 v17, v217, v19
    v_xor_b32 v18, v16, v18
    v_xor_b32 v19, v17, v19
    v_cvt_pk_bf16_f32 v108, v68, v69
    v_cvt_pk_bf16_f32 v109, v70, v71
    v_cvt_pk_bf16_f32 v110, v72, v73
    v_cvt_pk_bf16_f32 v111, v74, v75
    s_cbranch_scc1 L_at_noswap0
    v_swap_b32 v108, v110
    v_swap_b32 v109, v111
L_at_noswap0:
    s_mov_b32 s37, 0
    buffer_store_dwordx4 v[108:111], v218, s[40:43], s37 offen sc1
    s_setprio 2
    v_mfma_f32_16x16x32_bf16 v[76:79], v[232:235], v[16:19], 0
    v_mfma_f32_16x16x32_bf16 v[80:83], v[242:245], v[16:19], 0
    s_setprio 2
    v_mul_f32 v20, v20, v38
    v_mul_f32 v21, v21, v38
    v_mul_f32 v22, v22, v38
    v_mul_f32 v23, v23, v38
    v_cvt_pk_bf16_f32 v26, v20, v21
    v_cvt_pk_bf16_f32 v27, v22, v23
    v_and_b32 v24, v216, v26
    v_and_b32 v25, v217, v27
    v_xor_b32 v26, v24, v26
    v_xor_b32 v27, v25, v27
    v_cvt_pk_bf16_f32 v112, v76, v77
    v_cvt_pk_bf16_f32 v113, v78, v79
    v_cvt_pk_bf16_f32 v114, v80, v81
    v_cvt_pk_bf16_f32 v115, v82, v83
    s_cbranch_scc1 L_at_noswap1
    v_swap_b32 v112, v114
    v_swap_b32 v113, v115
L_at_noswap1:
    s_mov_b32 s37, 32768
    buffer_store_dwordx4 v[112:115], v218, s[40:43], s37 offen sc1
    s_setprio 2
    v_mfma_f32_16x16x32_bf16 v[84:87], v[234:237], v[24:27], 0
    v_mfma_f32_16x16x32_bf16 v[88:91], v[244:247], v[24:27], 0
    s_setprio 2
    v_mul_f32 v28, v28, v39
    v_mul_f32 v29, v29, v39
    v_mul_f32 v30, v30, v39
    v_mul_f32 v31, v31, v39
    v_cvt_pk_bf16_f32 v34, v28, v29
    v_cvt_pk_bf16_f32 v35, v30, v31
    v_and_b32 v32, v216, v34
    v_and_b32 v33, v217, v35
    v_xor_b32 v34, v32, v34
    v_xor_b32 v35, v33, v35
    v_cvt_pk_bf16_f32 v116, v84, v85
    v_cvt_pk_bf16_f32 v117, v86, v87
    v_cvt_pk_bf16_f32 v118, v88, v89
    v_cvt_pk_bf16_f32 v119, v90, v91
    s_cbranch_scc1 L_at_noswap2
    v_swap_b32 v116, v118
    v_swap_b32 v117, v119
L_at_noswap2:
    s_mov_b32 s37, 65536
    buffer_store_dwordx4 v[116:119], v218, s[40:43], s37 offen sc1
    s_setprio 2
    v_mfma_f32_16x16x32_bf16 v[92:95], v[236:239], v[32:35], 0
    v_mfma_f32_16x16x32_bf16 v[96:99], v[246:249], v[32:35], 0
    s_setprio 2
    s_nop 5
    v_cvt_pk_bf16_f32 v120, v92, v93
    v_cvt_pk_bf16_f32 v121, v94, v95
    v_cvt_pk_bf16_f32 v122, v96, v97
    v_cvt_pk_bf16_f32 v123, v98, v99
    s_cbranch_scc1 L_at_noswap3
    v_swap_b32 v120, v122
    v_swap_b32 v121, v123
L_at_noswap3:
    s_mov_b32 s37, 98304
    buffer_store_dwordx4 v[120:123], v218, s[40:43], s37 offen sc1
    s_setprio 0
    v_xor_b32 v84, 0, v229
    v_xor_b32 v85, 32, v229
    v_xor_b32 v86, 64, v229
    v_xor_b32 v87, 96, v229
    v_add_u32 v88, 83968, v84
    v_add_u32 v89, 83968, v85
    v_add_u32 v90, 83968, v86
    v_add_u32 v91, 83968, v87
    v_add_u32 v92, 125952, v84
    v_add_u32 v93, 125952, v85
    v_add_u32 v94, 125952, v86
    v_add_u32 v95, 125952, v87
    v_lshl_add_u32 v231, v0, 4, s60
    v_add_u32 v230, 125952, v231
    s_add_u32 s64, s61, 0
    s_and_b32 s64, s64, 7
    s_lshl_b32 s64, s64, 12
    s_add_u32 s65, s61, 1
    s_and_b32 s65, s65, 7
    s_lshl_b32 s65, s65, 12
    s_add_u32 s66, s61, 2
    s_and_b32 s66, s66, 7
    s_lshl_b32 s66, s66, 12
    s_add_u32 s67, s61, 3
    s_and_b32 s67, s67, 7
    s_lshl_b32 s67, s67, 12
    s_add_u32 s68, s61, 4
    s_and_b32 s68, s68, 7
    s_lshl_b32 s68, s68, 12
    s_add_u32 s69, s61, 5
    s_and_b32 s69, s69, 7
    s_lshl_b32 s69, s69, 12
    s_add_u32 s70, s61, 6
    s_and_b32 s70, s70, 7
    s_lshl_b32 s70, s70, 12
    s_add_u32 s71, s61, 7
    s_and_b32 s71, s71, 7
    s_lshl_b32 s71, s71, 12
    s_waitcnt vmcnt(0)
    s_setprio 2
    v_mov_b32 v2, 1
    s_mov_b64 exec, 1
    ds_add_rtn_u32 v1, v228, v2 offset:0
    s_waitcnt lgkmcnt(0)
    v_readfirstlane_b32 s39, v1
    s_nop 0
    s_cmp_eq_u32 s39, 3
    s_cbranch_scc0 L_jo_44a
    s_mov_b64 exec, 0xffff
    v_lshlrev_b32 v1, 8, v0
    buffer_atomic_add v2, v1, s[52:55], s56 offen sc1
L_jo_44a:
    s_mov_b64 exec, -1
    s_setprio 0
    s_xor_b32 s63, s62, 1310720
    buffer_load_dwordx4 v[172:175], v227, s[44:47], s63 offen offset:0
    buffer_load_dwordx4 v[176:179], v223, s[44:47], s63 offen offset:1024
    s_xor_b32 s63, s62, 1441792
    buffer_load_dwordx4 v[180:183], v227, s[44:47], s63 offen offset:0
    buffer_load_dwordx4 v[184:187], v223, s[44:47], s63 offen offset:1024
    s_cmp_eq_u32 s39, 3
    s_cbranch_scc0 L_ps_46
    s_load_dword s37, s[52:53], s57 glc
L_ps_46:
    s_xor_b32 s63, s62, 1572864
    buffer_load_dwordx4 v[188:191], v227, s[44:47], s63 offen offset:0
    buffer_load_dwordx4 v[192:195], v223, s[44:47], s63 offen offset:1024
    s_xor_b32 s63, s62, 1703936
    buffer_load_dwordx4 v[196:199], v227, s[44:47], s63 offen offset:0
    buffer_load_dwordx4 v[200:203], v223, s[44:47], s63 offen offset:1024
    s_xor_b32 s63, s62, 1835008
    buffer_load_dwordx4 v[204:207], v227, s[44:47], s63 offen offset:0
    buffer_load_dwordx4 v[208:211], v223, s[44:47], s63 offen offset:1024
    s_xor_b32 s63, s62, 1966080
    buffer_load_dwordx4 v[212:215], v227, s[44:47], s63 offen offset:0
    buffer_load_dwordx4 v[216:219], v223, s[44:47], s63 offen offset:1024
    s_setprio 0
    s_cmp_eq_u32 s39, 3
    s_cbranch_scc0 L_jo_44
    s_mov_b32 s38, 131072
    s_branch L_sg_chk_49
L_sg_loop_48:
    s_load_dword s37, s[52:53], s57 glc
L_sg_chk_49:
    s_waitcnt lgkmcnt(0)
    s_cmp_ge_u32 s37, 16
    s_cbranch_scc1 L_sg_done_47
    s_sub_u32 s38, s38, 1
    s_cbranch_scc0 L_sg_loop_48
L_sg_done_47:
    v_mov_b32 v1, 16
    s_mov_b64 exec, 1
    ds_add_u32 v228, v1 offset:4
    s_mov_b64 exec, -1
L_jo_44:
    s_waitcnt vmcnt(12)
    s_mov_b64 exec, 1
    ds_add_u32 v228, v2 offset:4
    s_mov_b64 exec, -1
    s_mov_b32 s38, 1048576
L_sl_loop_51:
    ds_read_b32 v1, v228 offset:4
    s_waitcnt lgkmcnt(0)
    v_readfirstlane_b32 s37, v1
    s_nop 0
    s_cmp_ge_u32 s37, 20
    s_cbranch_scc1 L_sl_done_50
    s_sleep 1
    s_sub_u32 s38, s38, 1
    s_cbranch_scc0 L_sl_loop_51
L_sl_done_50:
L_jd_45:
    buffer_load_dwordx4 v[96:99], v224, s[40:43], s64 offen offset:0 sc1
    buffer_load_dwordx4 v[100:103], v225, s[40:43], s64 offen offset:0 sc1
    ds_read_b64_tr_b16 v[36:37], v84 offset:0
    ds_read_b64_tr_b16 v[38:39], v84 offset:2048
    buffer_load_dwordx4 v[104:107], v224, s[40:43], s64 offen offset:1024 sc1
    buffer_load_dwordx4 v[108:111], v225, s[40:43], s64 offen offset:1024 sc1
    ds_read_b64_tr_b16 v[40:41], v85 offset:0
    ds_read_b64_tr_b16 v[42:43], v85 offset:2048
    buffer_load_dwordx4 v[112:115], v224, s[40:43], s64 offen offset:2048 sc1
    buffer_load_dwordx4 v[116:119], v225, s[40:43], s64 offen offset:2048 sc1
    ds_read_b64_tr_b16 v[44:45], v86 offset:0
    ds_read_b64_tr_b16 v[46:47], v86 offset:2048
    buffer_load_dwordx4 v[120:123], v224, s[40:43], s64 offen offset:3072 sc1
    buffer_load_dwordx4 v[124:127], v225, s[40:43], s64 offen offset:3072 sc1
    ds_read_b64_tr_b16 v[48:49], v87 offset:0
    ds_read_b64_tr_b16 v[50:51], v87 offset:2048
    buffer_load_dwordx4 v[128:131], v224, s[40:43], s65 offen offset:0 sc1
    buffer_load_dwordx4 v[132:135], v225, s[40:43], s65 offen offset:0 sc1
    ds_read_b64_tr_b16 v[52:53], v84 offset:4096
    ds_read_b64_tr_b16 v[54:55], v84 offset:6144
    buffer_load_dwordx4 v[136:139], v224, s[40:43], s65 offen offset:1024 sc1
    buffer_load_dwordx4 v[140:143], v225, s[40:43], s65 offen offset:1024 sc1
    ds_read_b64_tr_b16 v[56:57], v85 offset:4096
    ds_read_b64_tr_b16 v[58:59], v85 offset:6144
    ds_read_b64_tr_b16 v[60:61], v86 offset:4096
    ds_read_b64_tr_b16 v[62:63], v86 offset:6144
    s_waitcnt lgkmcnt(12)
    ds_read_b64_tr_b16 v[64:65], v87 offset:4096
    ds_read_b64_tr_b16 v[66:67], v87 offset:6144
    ds_read_b32 v1, v228 offset:36
    s_waitcnt vmcnt(10) lgkmcnt(9)
    v_mfma_f32_16x16x32_bf16 v[4:7], v[36:39], v[96:99], 0
    ds_read_b64_tr_b16 v[68:69], v84 offset:8192
    v_mfma_f32_16x16x32_bf16 v[20:23], v[36:39], v[100:103], 0
    ds_read_b64_tr_b16 v[70:71], v84 offset:10240
    v_mfma_f32_16x16x32_bf16 v[8:11], v[40:43], v[96:99], 0
    ds_read_b64_tr_b16 v[36:37], v85 offset:8192
    v_mfma_f32_16x16x32_bf16 v[24:27], v[40:43], v[100:103], 0
    ds_read_b64_tr_b16 v[38:39], v85 offset:10240
    buffer_load_dwordx4 v[144:147], v224, s[40:43], s65 offen offset:2048 sc1
    v_mfma_f32_16x16x32_bf16 v[12:15], v[44:47], v[96:99], 0
    ds_read_b64_tr_b16 v[40:41], v86 offset:8192
    v_mfma_f32_16x16x32_bf16 v[28:31], v[44:47], v[100:103], 0
    ds_read_b64_tr_b16 v[42:43], v86 offset:10240
    v_mfma_f32_16x16x32_bf16 v[16:19], v[48:51], v[96:99], 0
    ds_read_b64_tr_b16 v[44:45], v87 offset:8192
    v_mfma_f32_16x16x32_bf16 v[32:35], v[48:51], v[100:103], 0
    ds_read_b64_tr_b16 v[46:47], v87 offset:10240
    buffer_load_dwordx4 v[148:151], v225, s[40:43], s65 offen offset:2048 sc1
    s_waitcnt lgkmcnt(8)
    v_readfirstlane_b32 s37, v1
    s_nop 0
    s_cmp_ge_u32 s37, 4
    s_cbranch_scc1 L_sl_done_52
    s_mov_b32 s38, 1048576
L_sl_loop_53:
    ds_read_b32 v1, v228 offset:36
    s_waitcnt lgkmcnt(0)
    v_readfirstlane_b32 s37, v1
    s_nop 0
    s_cmp_ge_u32 s37, 4
    s_cbranch_scc1 L_sl_done_52
    s_sleep 1
    s_sub_u32 s38, s38, 1
    s_cbranch_scc0 L_sl_loop_53
L_sl_done_52:
    ds_write_b128 v230, v[172:175] offset:0
    s_waitcnt vmcnt(10)
    v_mfma_f32_16x16x32_bf16 v[4:7], v[52:55], v[104:107], v[4:7]
    ds_read_b64_tr_b16 v[48:49], v84 offset:12288
    v_mfma_f32_16x16x32_bf16 v[20:23], v[52:55], v[108:111], v[20:23]
    ds_read_b64_tr_b16 v[50:51], v84 offset:14336
    v_mfma_f32_16x16x32_bf16 v[8:11], v[56:59], v[104:107], v[8:11]
    ds_read_b64_tr_b16 v[52:53], v85 offset:12288
    v_mfma_f32_16x16x32_bf16 v[24:27], v[56:59], v[108:111], v[24:27]
    ds_read_b64_tr_b16 v[54:55], v85 offset:14336
    buffer_load_dwordx4 v[96:99], v224, s[40:43], s65 offen offset:3072 sc1
    ds_write_b128 v230, v[176:179] offset:1024
    v_mfma_f32_16x16x32_bf16 v[12:15], v[60:63], v[104:107], v[12:15]
    ds_read_b64_tr_b16 v[56:57], v86 offset:12288
    v_mfma_f32_16x16x32_bf16 v[28:31], v[60:63], v[108:111], v[28:31]
    ds_read_b64_tr_b16 v[58:59], v86 offset:14336
    v_mfma_f32_16x16x32_bf16 v[16:19], v[64:67], v[104:107], v[16:19]
    ds_read_b64_tr_b16 v[60:61], v87 offset:12288
    v_mfma_f32_16x16x32_bf16 v[32:35], v[64:67], v[108:111], v[32:35]
    ds_read_b64_tr_b16 v[62:63], v87 offset:14336
    buffer_load_dwordx4 v[100:103], v225, s[40:43], s65 offen offset:3072 sc1
    ds_write_b128 v230, v[180:183] offset:8448
    s_waitcnt vmcnt(10) lgkmcnt(11)
    v_mfma_f32_16x16x32_bf16 v[4:7], v[68:71], v[112:115], v[4:7]
    ds_read_b64_tr_b16 v[64:65], v84 offset:16384
    v_mfma_f32_16x16x32_bf16 v[20:23], v[68:71], v[116:119], v[20:23]
    ds_read_b64_tr_b16 v[66:67], v84 offset:18432
    v_mfma_f32_16x16x32_bf16 v[8:11], v[36:39], v[112:115], v[8:11]
    ds_read_b64_tr_b16 v[68:69], v85 offset:16384
    v_mfma_f32_16x16x32_bf16 v[24:27], v[36:39], v[116:119], v[24:27]
    ds_read_b64_tr_b16 v[70:71], v85 offset:18432
    buffer_load_dwordx4 v[104:107], v224, s[40:43], s66 offen offset:0 sc1
    ds_write_b128 v230, v[184:187] offset:9472
    v_mfma_f32_16x16x32_bf16 v[12:15], v[40:43], v[112:115], v[12:15]
    ds_read_b64_tr_b16 v[36:37], v86 offset:16384
    v_mfma_f32_16x16x32_bf16 v[28:31], v[40:43], v[116:119], v[28:31]
    ds_read_b64_tr_b16 v[38:39], v86 offset:18432
    v_mfma_f32_16x16x32_bf16 v[16:19], v[44:47], v[112:115], v[16:19]
    ds_read_b64_tr_b16 v[40:41], v87 offset:16384
    v_mfma_f32_16x16x32_bf16 v[32:35], v[44:47], v[116:119], v[32:35]
    ds_read_b64_tr_b16 v[42:43], v87 offset:18432
    buffer_load_dwordx4 v[108:111], v225, s[40:43], s66 offen offset:0 sc1
    ds_write_b128 v230, v[188:191] offset:16896
    s_waitcnt vmcnt(10) lgkmcnt(11)
    v_mfma_f32_16x16x32_bf16 v[4:7], v[48:51], v[120:123], v[4:7]
    ds_read_b64_tr_b16 v[44:45], v84 offset:20480
    v_mfma_f32_16x16x32_bf16 v[20:23], v[48:51], v[124:127], v[20:23]
    ds_read_b64_tr_b16 v[46:47], v84 offset:22528
    v_mfma_f32_16x16x32_bf16 v[8:11], v[52:55], v[120:123], v[8:11]
    ds_read_b64_tr_b16 v[48:49], v85 offset:20480
    v_mfma_f32_16x16x32_bf16 v[24:27], v[52:55], v[124:127], v[24:27]
    ds_read_b64_tr_b16 v[50:51], v85 offset:22528
    buffer_load_dwordx4 v[112:115], v224, s[40:43], s66 offen offset:1024 sc1
    ds_write_b128 v230, v[192:195] offset:17920
    v_mfma_f32_16x16x32_bf16 v[12:15], v[56:59], v[120:123], v[12:15]
    ds_read_b64_tr_b16 v[52:53], v86 offset:20480
    v_mfma_f32_16x16x32_bf16 v[28:31], v[56:59], v[124:127], v[28:31]
    ds_read_b64_tr_b16 v[54:55], v86 offset:22528
    v_mfma_f32_16x16x32_bf16 v[16:19], v[60:63], v[120:123], v[16:19]
    ds_read_b64_tr_b16 v[56:57], v87 offset:20480
    v_mfma_f32_16x16x32_bf16 v[32:35], v[60:63], v[124:127], v[32:35]
    ds_read_b64_tr_b16 v[58:59], v87 offset:22528
    buffer_load_dwordx4 v[116:119], v225, s[40:43], s66 offen offset:1024 sc1
    ds_write_b128 v230, v[196:199] offset:25344
    s_waitcnt vmcnt(10) lgkmcnt(11)
    v_mfma_f32_16x16x32_bf16 v[4:7], v[64:67], v[128:131], v[4:7]
    ds_read_b64_tr_b16 v[60:61], v84 offset:24576
    v_mfma_f32_16x16x32_bf16 v[20:23], v[64:67], v[132:135], v[20:23]
    ds_read_b64_tr_b16 v[62:63], v84 offset:26624
    v_mfma_f32_16x16x32_bf16 v[8:11], v[68:71], v[128:131], v[8:11]
    ds_read_b64_tr_b16 v[64:65], v85 offset:24576
    v_mfma_f32_16x16x32_bf16 v[24:27], v[68:71], v[132:135], v[24:27]
    ds_read_b64_tr_b16 v[66:67], v85 offset:26624
    buffer_load_dwordx4 v[120:123], v224, s[40:43], s66 offen offset:2048 sc1
    ds_write_b128 v230, v[200:203] offset:26368
    v_mfma_f32_16x16x32_bf16 v[12:15], v[36:39], v[128:131], v[12:15]
    ds_read_b64_tr_b16 v[68:69], v86 offset:24576
    v_mfma_f32_16x16x32_bf16 v[28:31], v[36:39], v[132:135], v[28:31]
    ds_read_b64_tr_b16 v[70:71], v86 offset:26624
    v_mfma_f32_16x16x32_bf16 v[16:19], v[40:43], v[128:131], v[16:19]
    ds_read_b64_tr_b16 v[36:37], v87 offset:24576
    v_mfma_f32_16x16x32_bf16 v[32:35], v[40:43], v[132:135], v[32:35]
    ds_read_b64_tr_b16 v[38:39], v87 offset:26624
    buffer_load_dwordx4 v[124:127], v225, s[40:43], s66 offen offset:2048 sc1
    ds_write_b128 v231, v[204:207] offset:41984
    s_waitcnt vmcnt(10) lgkmcnt(11)
    v_mfma_f32_16x16x32_bf16 v[4:7], v[44:47], v[136:139], v[4:7]
    ds_read_b64_tr_b16 v[40:41], v84 offset:28672
    v_mfma_f32_16x16x32_bf16 v[20:23], v[44:47], v[140:143], v[20:23]
    ds_read_b64_tr_b16 v[42:43], v84 offset:30720
    v_mfma_f32_16x16x32_bf16 v[8:11], v[48:51], v[136:139], v[8:11]
    ds_read_b64_tr_b16 v[44:45], v85 offset:28672
    v_mfma_f32_16x16x32_bf16 v[24:27], v[48:51], v[140:143], v[24:27]
    ds_read_b64_tr_b16 v[46:47], v85 offset:30720
    buffer_load_dwordx4 v[128:131], v224, s[40:43], s66 offen offset:3072 sc1
    ds_write_b128 v231, v[208:211] offset:43008
    v_mfma_f32_16x16x32_bf16 v[12:15], v[52:55], v[136:139], v[12:15]
    ds_read_b64_tr_b16 v[48:49], v86 offset:28672
    v_mfma_f32_16x16x32_bf16 v[28:31], v[52:55], v[140:143], v[28:31]
    ds_read_b64_tr_b16 v[50:51], v86 offset:30720
    v_mfma_f32_16x16x32_bf16 v[16:19], v[56:59], v[136:139], v[16:19]
    ds_read_b64_tr_b16 v[52:53], v87 offset:28672
    v_mfma_f32_16x16x32_bf16 v[32:35], v[56:59], v[140:143], v[32:35]
    ds_read_b64_tr_b16 v[54:55], v87 offset:30720
    buffer_load_dwordx4 v[132:135], v225, s[40:43], s66 offen offset:3072 sc1
    ds_write_b128 v231, v[212:215] offset:51200
    s_waitcnt vmcnt(10) lgkmcnt(11)
    v_mfma_f32_16x16x32_bf16 v[4:7], v[60:63], v[144:147], v[4:7]
    ds_read_b64_tr_b16 v[56:57], v84 offset:32768
    v_mfma_f32_16x16x32_bf16 v[20:23], v[60:63], v[148:151], v[20:23]
    ds_read_b64_tr_b16 v[58:59], v84 offset:34816
    v_mfma_f32_16x16x32_bf16 v[8:11], v[64:67], v[144:147], v[8:11]
    ds_read_b64_tr_b16 v[60:61], v85 offset:32768
    v_mfma_f32_16x16x32_bf16 v[24:27], v[64:67], v[148:151], v[24:27]
    ds_read_b64_tr_b16 v[62:63], v85 offset:34816
    buffer_load_dwordx4 v[136:139], v224, s[40:43], s67 offen offset:0 sc1
    ds_write_b128 v231, v[216:219] offset:52224
    s_mov_b64 exec, 1
    ds_add_u32 v228, v2 offset:12
    s_mov_b64 exec, -1
    v_mfma_f32_16x16x32_bf16 v[12:15], v[68:71], v[144:147], v[12:15]
    ds_read_b64_tr_b16 v[64:65], v86 offset:32768
    v_mfma_f32_16x16x32_bf16 v[28:31], v[68:71], v[148:151], v[28:31]
    ds_read_b64_tr_b16 v[66:67], v86 offset:34816
    v_mfma_f32_16x16x32_bf16 v[16:19], v[36:39], v[144:147], v[16:19]
    ds_read_b64_tr_b16 v[68:69], v87 offset:32768
    v_mfma_f32_16x16x32_bf16 v[32:35], v[36:39], v[148:151], v[32:35]
    ds_read_b64_tr_b16 v[70:71], v87 offset:34816
    buffer_load_dwordx4 v[140:143], v225, s[40:43], s67 offen offset:0 sc1
    s_waitcnt vmcnt(10) lgkmcnt(11)
    v_mfma_f32_16x16x32_bf16 v[4:7], v[40:43], v[96:99], v[4:7]
    ds_read_b64_tr_b16 v[36:37], v84 offset:36864
    v_mfma_f32_16x16x32_bf16 v[20:23], v[40:43], v[100:103], v[20:23]
    ds_read_b64_tr_b16 v[38:39], v84 offset:38912
    v_mfma_f32_16x16x32_bf16 v[8:11], v[44:47], v[96:99], v[8:11]
    ds_read_b64_tr_b16 v[40:41], v85 offset:36864
    v_mfma_f32_16x16x32_bf16 v[24:27], v[44:47], v[100:103], v[24:27]
    ds_read_b64_tr_b16 v[42:43], v85 offset:38912
    buffer_load_dwordx4 v[144:147], v224, s[40:43], s67 offen offset:1024 sc1
    v_mfma_f32_16x16x32_bf16 v[12:15], v[48:51], v[96:99], v[12:15]
    ds_read_b64_tr_b16 v[44:45], v86 offset:36864
    v_mfma_f32_16x16x32_bf16 v[28:31], v[48:51], v[100:103], v[28:31]
    ds_read_b64_tr_b16 v[46:47], v86 offset:38912
    v_mfma_f32_16x16x32_bf16 v[16:19], v[52:55], v[96:99], v[16:19]
    ds_read_b64_tr_b16 v[48:49], v87 offset:36864
    v_mfma_f32_16x16x32_bf16 v[32:35], v[52:55], v[100:103], v[32:35]
    ds_read_b64_tr_b16 v[50:51], v87 offset:38912
    buffer_load_dwordx4 v[148:151], v225, s[40:43], s67 offen offset:1024 sc1
    s_waitcnt vmcnt(10) lgkmcnt(8)
    v_mfma_f32_16x16x32_bf16 v[4:7], v[56:59], v[104:107], v[4:7]
    ds_read_b64_tr_b16 v[52:53], v88 offset:0
    v_mfma_f32_16x16x32_bf16 v[20:23], v[56:59], v[108:111], v[20:23]
    ds_read_b64_tr_b16 v[54:55], v88 offset:2048
    v_mfma_f32_16x16x32_bf16 v[8:11], v[60:63], v[104:107], v[8:11]
    ds_read_b64_tr_b16 v[56:57], v89 offset:0
    v_mfma_f32_16x16x32_bf16 v[24:27], v[60:63], v[108:111], v[24:27]
    ds_read_b64_tr_b16 v[58:59], v89 offset:2048
    buffer_load_dwordx4 v[96:99], v224, s[40:43], s67 offen offset:2048 sc1
    v_mfma_f32_16x16x32_bf16 v[12:15], v[64:67], v[104:107], v[12:15]
    ds_read_b64_tr_b16 v[60:61], v90 offset:0
    v_mfma_f32_16x16x32_bf16 v[28:31], v[64:67], v[108:111], v[28:31]
    ds_read_b64_tr_b16 v[62:63], v90 offset:2048
    v_mfma_f32_16x16x32_bf16 v[16:19], v[68:71], v[104:107], v[16:19]
    ds_read_b64_tr_b16 v[64:65], v91 offset:0
    v_mfma_f32_16x16x32_bf16 v[32:35], v[68:71], v[108:111], v[32:35]
    ds_read_b64_tr_b16 v[66:67], v91 offset:2048
    buffer_load_dwordx4 v[100:103], v225, s[40:43], s67 offen offset:2048 sc1
    s_waitcnt vmcnt(10) lgkmcnt(8)
    v_mfma_f32_16x16x32_bf16 v[4:7], v[36:39], v[112:115], v[4:7]
    ds_read_b64_tr_b16 v[68:69], v88 offset:4096
    v_mfma_f32_16x16x32_bf16 v[20:23], v[36:39], v[116:119], v[20:23]
    ds_read_b64_tr_b16 v[70:71], v88 offset:6144
    v_mfma_f32_16x16x32_bf16 v[8:11], v[40:43], v[112:115], v[8:11]
    ds_read_b64_tr_b16 v[36:37], v89 offset:4096
    v_mfma_f32_16x16x32_bf16 v[24:27], v[40:43], v[116:119], v[24:27]
    ds_read_b64_tr_b16 v[38:39], v89 offset:6144
    buffer_load_dwordx4 v[104:107], v224, s[40:43], s67 offen offset:3072 sc1
    v_mfma_f32_16x16x32_bf16 v[12:15], v[44:47], v[112:115], v[12:15]
    ds_read_b64_tr_b16 v[40:41], v90 offset:4096
    v_mfma_f32_16x16x32_bf16 v[28:31], v[44:47], v[116:119], v[28:31]
    ds_read_b64_tr_b16 v[42:43], v90 offset:6144
    v_mfma_f32_16x16x32_bf16 v[16:19], v[48:51], v[112:115], v[16:19]
    ds_read_b64_tr_b16 v[44:45], v91 offset:4096
    v_mfma_f32_16x16x32_bf16 v[32:35], v[48:51], v[116:119], v[32:35]
    ds_read_b64_tr_b16 v[46:47], v91 offset:6144
    buffer_load_dwordx4 v[108:111], v225, s[40:43], s67 offen offset:3072 sc1
    s_waitcnt vmcnt(10) lgkmcnt(8)
    v_mfma_f32_16x16x32_bf16 v[4:7], v[52:55], v[120:123], v[4:7]
    ds_read_b64_tr_b16 v[48:49], v88 offset:8192
    v_mfma_f32_16x16x32_bf16 v[20:23], v[52:55], v[124:127], v[20:23]
    ds_read_b64_tr_b16 v[50:51], v88 offset:10240
    v_mfma_f32_16x16x32_bf16 v[8:11], v[56:59], v[120:123], v[8:11]
    ds_read_b64_tr_b16 v[52:53], v89 offset:8192
    v_mfma_f32_16x16x32_bf16 v[24:27], v[56:59], v[124:127], v[24:27]
    ds_read_b64_tr_b16 v[54:55], v89 offset:10240
    buffer_load_dwordx4 v[112:115], v224, s[40:43], s68 offen offset:0 sc1
    v_mfma_f32_16x16x32_bf16 v[12:15], v[60:63], v[120:123], v[12:15]
    ds_read_b64_tr_b16 v[56:57], v90 offset:8192
    v_mfma_f32_16x16x32_bf16 v[28:31], v[60:63], v[124:127], v[28:31]
    ds_read_b64_tr_b16 v[58:59], v90 offset:10240
    v_mfma_f32_16x16x32_bf16 v[16:19], v[64:67], v[120:123], v[16:19]
    ds_read_b64_tr_b16 v[60:61], v91 offset:8192
    v_mfma_f32_16x16x32_bf16 v[32:35], v[64:67], v[124:127], v[32:35]
    ds_read_b64_tr_b16 v[62:63], v91 offset:10240
    buffer_load_dwordx4 v[116:119], v225, s[40:43], s68 offen offset:0 sc1
    s_waitcnt vmcnt(10) lgkmcnt(8)
    v_mfma_f32_16x16x32_bf16 v[4:7], v[68:71], v[128:131], v[4:7]
    ds_read_b64_tr_b16 v[64:65], v88 offset:12288
    v_mfma_f32_16x16x32_bf16 v[20:23], v[68:71], v[132:135], v[20:23]
    ds_read_b64_tr_b16 v[66:67], v88 offset:14336
    v_mfma_f32_16x16x32_bf16 v[8:11], v[36:39], v[128:131], v[8:11]
    ds_read_b64_tr_b16 v[68:69], v89 offset:12288
    v_mfma_f32_16x16x32_bf16 v[24:27], v[36:39], v[132:135], v[24:27]
    ds_read_b64_tr_b16 v[70:71], v89 offset:14336
    buffer_load_dwordx4 v[120:123], v224, s[40:43], s68 offen offset:1024 sc1
    v_mfma_f32_16x16x32_bf16 v[12:15], v[40:43], v[128:131], v[12:15]
    ds_read_b64_tr_b16 v[36:37], v90 offset:12288
    v_mfma_f32_16x16x32_bf16 v[28:31], v[40:43], v[132:135], v[28:31]
    ds_read_b64_tr_b16 v[38:39], v90 offset:14336
    v_mfma_f32_16x16x32_bf16 v[16:19], v[44:47], v[128:131], v[16:19]
    ds_read_b64_tr_b16 v[40:41], v91 offset:12288
    v_mfma_f32_16x16x32_bf16 v[32:35], v[44:47], v[132:135], v[32:35]
    ds_read_b64_tr_b16 v[42:43], v91 offset:14336
    buffer_load_dwordx4 v[124:127], v225, s[40:43], s68 offen offset:1024 sc1
    s_waitcnt vmcnt(10) lgkmcnt(8)
    v_mfma_f32_16x16x32_bf16 v[4:7], v[48:51], v[136:139], v[4:7]
    ds_read_b64_tr_b16 v[44:45], v88 offset:16384
    v_mfma_f32_16x16x32_bf16 v[20:23], v[48:51], v[140:143], v[20:23]
    ds_read_b64_tr_b16 v[46:47], v88 offset:18432
    v_mfma_f32_16x16x32_bf16 v[8:11], v[52:55], v[136:139], v[8:11]
    ds_read_b64_tr_b16 v[48:49], v89 offset:16384
    v_mfma_f32_16x16x32_bf16 v[24:27], v[52:55], v[140:143], v[24:27]
    ds_read_b64_tr_b16 v[50:51], v89 offset:18432
    buffer_load_dwordx4 v[128:131], v224, s[40:43], s68 offen offset:2048 sc1
    v_mfma_f32_16x16x32_bf16 v[12:15], v[56:59], v[136:139], v[12:15]
    ds_read_b64_tr_b16 v[52:53], v90 offset:16384
    v_mfma_f32_16x16x32_bf16 v[28:31], v[56:59], v[140:143], v[28:31]
    ds_read_b64_tr_b16 v[54:55], v90 offset:18432
    v_mfma_f32_16x16x32_bf16 v[16:19], v[60:63], v[136:139], v[16:19]
    ds_read_b64_tr_b16 v[56:57], v91 offset:16384
    v_mfma_f32_16x16x32_bf16 v[32:35], v[60:63], v[140:143], v[32:35]
    ds_read_b64_tr_b16 v[58:59], v91 offset:18432
    buffer_load_dwordx4 v[132:135], v225, s[40:43], s68 offen offset:2048 sc1
    s_waitcnt vmcnt(10) lgkmcnt(8)
    v_mfma_f32_16x16x32_bf16 v[4:7], v[64:67], v[144:147], v[4:7]
    ds_read_b64_tr_b16 v[60:61], v88 offset:20480
    v_mfma_f32_16x16x32_bf16 v[20:23], v[64:67], v[148:151], v[20:23]
    ds_read_b64_tr_b16 v[62:63], v88 offset:22528
    v_mfma_f32_16x16x32_bf16 v[8:11], v[68:71], v[144:147], v[8:11]
    ds_read_b64_tr_b16 v[64:65], v89 offset:20480
    v_mfma_f32_16x16x32_bf16 v[24:27], v[68:71], v[148:151], v[24:27]
    ds_read_b64_tr_b16 v[66:67], v89 offset:22528
    buffer_load_dwordx4 v[136:139], v224, s[40:43], s68 offen offset:3072 sc1
    v_mfma_f32_16x16x32_bf16 v[12:15], v[36:39], v[144:147], v[12:15]
    ds_read_b64_tr_b16 v[68:69], v90 offset:20480
    v_mfma_f32_16x16x32_bf16 v[28:31], v[36:39], v[148:151], v[28:31]
    ds_read_b64_tr_b16 v[70:71], v90 offset:22528
    v_mfma_f32_16x16x32_bf16 v[16:19], v[40:43], v[144:147], v[16:19]
    ds_read_b64_tr_b16 v[36:37], v91 offset:20480
    v_mfma_f32_16x16x32_bf16 v[32:35], v[40:43], v[148:151], v[32:35]
    ds_read_b64_tr_b16 v[38:39], v91 offset:22528
    buffer_load_dwordx4 v[140:143], v225, s[40:43], s68 offen offset:3072 sc1
    s_waitcnt vmcnt(10) lgkmcnt(8)
    v_mfma_f32_16x16x32_bf16 v[4:7], v[44:47], v[96:99], v[4:7]
    ds_read_b64_tr_b16 v[40:41], v88 offset:24576
    v_mfma_f32_16x16x32_bf16 v[20:23], v[44:47], v[100:103], v[20:23]
    ds_read_b64_tr_b16 v[42:43], v88 offset:26624
    v_mfma_f32_16x16x32_bf16 v[8:11], v[48:51], v[96:99], v[8:11]
    ds_read_b64_tr_b16 v[44:45], v89 offset:24576
    v_mfma_f32_16x16x32_bf16 v[24:27], v[48:51], v[100:103], v[24:27]
    ds_read_b64_tr_b16 v[46:47], v89 offset:26624
    buffer_load_dwordx4 v[144:147], v224, s[40:43], s69 offen offset:0 sc1
    v_mfma_f32_16x16x32_bf16 v[12:15], v[52:55], v[96:99], v[12:15]
    ds_read_b64_tr_b16 v[48:49], v90 offset:24576
    v_mfma_f32_16x16x32_bf16 v[28:31], v[52:55], v[100:103], v[28:31]
    ds_read_b64_tr_b16 v[50:51], v90 offset:26624
    v_mfma_f32_16x16x32_bf16 v[16:19], v[56:59], v[96:99], v[16:19]
    ds_read_b64_tr_b16 v[52:53], v91 offset:24576
    v_mfma_f32_16x16x32_bf16 v[32:35], v[56:59], v[100:103], v[32:35]
    ds_read_b64_tr_b16 v[54:55], v91 offset:26624
    buffer_load_dwordx4 v[148:151], v225, s[40:43], s69 offen offset:0 sc1
    s_waitcnt vmcnt(10) lgkmcnt(8)
    v_mfma_f32_16x16x32_bf16 v[4:7], v[60:63], v[104:107], v[4:7]
    ds_read_b64_tr_b16 v[56:57], v88 offset:28672
    v_mfma_f32_16x16x32_bf16 v[20:23], v[60:63], v[108:111], v[20:23]
    ds_read_b64_tr_b16 v[58:59], v88 offset:30720
    v_mfma_f32_16x16x32_bf16 v[8:11], v[64:67], v[104:107], v[8:11]
    ds_read_b64_tr_b16 v[60:61], v89 offset:28672
    v_mfma_f32_16x16x32_bf16 v[24:27], v[64:67], v[108:111], v[24:27]
    ds_read_b64_tr_b16 v[62:63], v89 offset:30720
    buffer_load_dwordx4 v[96:99], v224, s[40:43], s69 offen offset:1024 sc1
    v_mfma_f32_16x16x32_bf16 v[12:15], v[68:71], v[104:107], v[12:15]
    ds_read_b64_tr_b16 v[64:65], v90 offset:28672
    v_mfma_f32_16x16x32_bf16 v[28:31], v[68:71], v[108:111], v[28:31]
    ds_read_b64_tr_b16 v[66:67], v90 offset:30720
    v_mfma_f32_16x16x32_bf16 v[16:19], v[36:39], v[104:107], v[16:19]
    ds_read_b64_tr_b16 v[68:69], v91 offset:28672
    v_mfma_f32_16x16x32_bf16 v[32:35], v[36:39], v[108:111], v[32:35]
    ds_read_b64_tr_b16 v[70:71], v91 offset:30720
    buffer_load_dwordx4 v[100:103], v225, s[40:43], s69 offen offset:1024 sc1
    s_waitcnt vmcnt(10) lgkmcnt(8)
    v_mfma_f32_16x16x32_bf16 v[4:7], v[40:43], v[112:115], v[4:7]
    ds_read_b64_tr_b16 v[36:37], v88 offset:32768
    v_mfma_f32_16x16x32_bf16 v[20:23], v[40:43], v[116:119], v[20:23]
    ds_read_b64_tr_b16 v[38:39], v88 offset:34816
    v_mfma_f32_16x16x32_bf16 v[8:11], v[44:47], v[112:115], v[8:11]
    ds_read_b64_tr_b16 v[40:41], v89 offset:32768
    v_mfma_f32_16x16x32_bf16 v[24:27], v[44:47], v[116:119], v[24:27]
    ds_read_b64_tr_b16 v[42:43], v89 offset:34816
    buffer_load_dwordx4 v[104:107], v224, s[40:43], s69 offen offset:2048 sc1
    v_mfma_f32_16x16x32_bf16 v[12:15], v[48:51], v[112:115], v[12:15]
    ds_read_b64_tr_b16 v[44:45], v90 offset:32768
    v_mfma_f32_16x16x32_bf16 v[28:31], v[48:51], v[116:119], v[28:31]
    ds_read_b64_tr_b16 v[46:47], v90 offset:34816
    v_mfma_f32_16x16x32_bf16 v[16:19], v[52:55], v[112:115], v[16:19]
    ds_read_b64_tr_b16 v[48:49], v91 offset:32768
    v_mfma_f32_16x16x32_bf16 v[32:35], v[52:55], v[116:119], v[32:35]
    ds_read_b64_tr_b16 v[50:51], v91 offset:34816
    buffer_load_dwordx4 v[108:111], v225, s[40:43], s69 offen offset:2048 sc1
    ds_read_b32 v1, v228 offset:12
    s_waitcnt vmcnt(10) lgkmcnt(9)
    v_mfma_f32_16x16x32_bf16 v[4:7], v[56:59], v[120:123], v[4:7]
    ds_read_b64_tr_b16 v[52:53], v88 offset:36864
    v_mfma_f32_16x16x32_bf16 v[20:23], v[56:59], v[124:127], v[20:23]
    ds_read_b64_tr_b16 v[54:55], v88 offset:38912
    v_mfma_f32_16x16x32_bf16 v[8:11], v[60:63], v[120:123], v[8:11]
    ds_read_b64_tr_b16 v[56:57], v89 offset:36864
    v_mfma_f32_16x16x32_bf16 v[24:27], v[60:63], v[124:127], v[24:27]
    ds_read_b64_tr_b16 v[58:59], v89 offset:38912
    buffer_load_dwordx4 v[112:115], v224, s[40:43], s69 offen offset:3072 sc1
    v_mfma_f32_16x16x32_bf16 v[12:15], v[64:67], v[120:123], v[12:15]
    ds_read_b64_tr_b16 v[60:61], v90 offset:36864
    v_mfma_f32_16x16x32_bf16 v[28:31], v[64:67], v[124:127], v[28:31]
    ds_read_b64_tr_b16 v[62:63], v90 offset:38912
    v_mfma_f32_16x16x32_bf16 v[16:19], v[68:71], v[120:123], v[16:19]
    ds_read_b64_tr_b16 v[64:65], v91 offset:36864
    v_mfma_f32_16x16x32_bf16 v[32:35], v[68:71], v[124:127], v[32:35]
    ds_read_b64_tr_b16 v[66:67], v91 offset:38912
    buffer_load_dwordx4 v[116:119], v225, s[40:43], s69 offen offset:3072 sc1
    s_waitcnt lgkmcnt(8)
    v_readfirstlane_b32 s37, v1
    s_nop 0
    s_cmp_ge_u32 s37, 4
    s_cbranch_scc1 L_sl_done_54
    s_mov_b32 s38, 1048576
L_sl_loop_55:
    ds_read_b32 v1, v228 offset:12
    s_waitcnt lgkmcnt(0)
    v_readfirstlane_b32 s37, v1
    s_nop 0
    s_cmp_ge_u32 s37, 4
    s_cbranch_scc1 L_sl_done_54
    s_sleep 1
    s_sub_u32 s38, s38, 1
    s_cbranch_scc0 L_sl_loop_55
L_sl_done_54:
    s_waitcnt vmcnt(10)
    v_mfma_f32_16x16x32_bf16 v[4:7], v[36:39], v[128:131], v[4:7]
    ds_read_b64_tr_b16 v[68:69], v92 offset:0
    v_mfma_f32_16x16x32_bf16 v[20:23], v[36:39], v[132:135], v[20:23]
    ds_read_b64_tr_b16 v[70:71], v92 offset:2048
    v_mfma_f32_16x16x32_bf16 v[8:11], v[40:43], v[128:131], v[8:11]
    ds_read_b64_tr_b16 v[36:37], v93 offset:0
    v_mfma_f32_16x16x32_bf16 v[24:27], v[40:43], v[132:135], v[24:27]
    ds_read_b64_tr_b16 v[38:39], v93 offset:2048
    buffer_load_dwordx4 v[120:123], v224, s[40:43], s70 offen offset:0 sc1
    v_mfma_f32_16x16x32_bf16 v[12:15], v[44:47], v[128:131], v[12:15]
    ds_read_b64_tr_b16 v[40:41], v94 offset:0
    v_mfma_f32_16x16x32_bf16 v[28:31], v[44:47], v[132:135], v[28:31]
    ds_read_b64_tr_b16 v[42:43], v94 offset:2048
    v_mfma_f32_16x16x32_bf16 v[16:19], v[48:51], v[128:131], v[16:19]
    ds_read_b64_tr_b16 v[44:45], v95 offset:0
    v_mfma_f32_16x16x32_bf16 v[32:35], v[48:51], v[132:135], v[32:35]
    ds_read_b64_tr_b16 v[46:47], v95 offset:2048
    buffer_load_dwordx4 v[124:127], v225, s[40:43], s70 offen offset:0 sc1
    s_waitcnt vmcnt(10) lgkmcnt(8)
    v_mfma_f32_16x16x32_bf16 v[4:7], v[52:55], v[136:139], v[4:7]
    ds_read_b64_tr_b16 v[48:49], v92 offset:4096
    v_mfma_f32_16x16x32_bf16 v[20:23], v[52:55], v[140:143], v[20:23]
    ds_read_b64_tr_b16 v[50:51], v92 offset:6144
    v_mfma_f32_16x16x32_bf16 v[8:11], v[56:59], v[136:139], v[8:11]
    ds_read_b64_tr_b16 v[52:53], v93 offset:4096
    v_mfma_f32_16x16x32_bf16 v[24:27], v[56:59], v[140:143], v[24:27]
    ds_read_b64_tr_b16 v[54:55], v93 offset:6144
    buffer_load_dwordx4 v[128:131], v224, s[40:43], s70 offen offset:1024 sc1
    v_mfma_f32_16x16x32_bf16 v[12:15], v[60:63], v[136:139], v[12:15]
    ds_read_b64_tr_b16 v[56:57], v94 offset:4096
    v_mfma_f32_16x16x32_bf16 v[28:31], v[60:63], v[140:143], v[28:31]
    ds_read_b64_tr_b16 v[58:59], v94 offset:6144
    v_mfma_f32_16x16x32_bf16 v[16:19], v[64:67], v[136:139], v[16:19]
    ds_read_b64_tr_b16 v[60:61], v95 offset:4096
    v_mfma_f32_16x16x32_bf16 v[32:35], v[64:67], v[140:143], v[32:35]
    ds_read_b64_tr_b16 v[62:63], v95 offset:6144
    buffer_load_dwordx4 v[132:135], v225, s[40:43], s70 offen offset:1024 sc1
    s_waitcnt vmcnt(10) lgkmcnt(8)
    v_mfma_f32_16x16x32_bf16 v[4:7], v[68:71], v[144:147], v[4:7]
    ds_read_b64_tr_b16 v[64:65], v92 offset:8448
    v_mfma_f32_16x16x32_bf16 v[20:23], v[68:71], v[148:151], v[20:23]
    ds_read_b64_tr_b16 v[66:67], v92 offset:10496
    v_mfma_f32_16x16x32_bf16 v[8:11], v[36:39], v[144:147], v[8:11]
    ds_read_b64_tr_b16 v[68:69], v93 offset:8448
    v_mfma_f32_16x16x32_bf16 v[24:27], v[36:39], v[148:151], v[24:27]
    ds_read_b64_tr_b16 v[70:71], v93 offset:10496
    buffer_load_dwordx4 v[136:139], v224, s[40:43], s70 offen offset:2048 sc1
    v_mfma_f32_16x16x32_bf16 v[12:15], v[40:43], v[144:147], v[12:15]
    ds_read_b64_tr_b16 v[36:37], v94 offset:8448
    v_mfma_f32_16x16x32_bf16 v[28:31], v[40:43], v[148:151], v[28:31]
    ds_read_b64_tr_b16 v[38:39], v94 offset:10496
    v_mfma_f32_16x16x32_bf16 v[16:19], v[44:47], v[144:147], v[16:19]
    ds_read_b64_tr_b16 v[40:41], v95 offset:8448
    v_mfma_f32_16x16x32_bf16 v[32:35], v[44:47], v[148:151], v[32:35]
    ds_read_b64_tr_b16 v[42:43], v95 offset:10496
    buffer_load_dwordx4 v[140:143], v225, s[40:43], s70 offen offset:2048 sc1
    s_waitcnt vmcnt(10) lgkmcnt(8)
    v_mfma_f32_16x16x32_bf16 v[4:7], v[48:51], v[96:99], v[4:7]
    ds_read_b64_tr_b16 v[44:45], v92 offset:12544
    v_mfma_f32_16x16x32_bf16 v[20:23], v[48:51], v[100:103], v[20:23]
    ds_read_b64_tr_b16 v[46:47], v92 offset:14592
    v_mfma_f32_16x16x32_bf16 v[8:11], v[52:55], v[96:99], v[8:11]
    ds_read_b64_tr_b16 v[48:49], v93 offset:12544
    v_mfma_f32_16x16x32_bf16 v[24:27], v[52:55], v[100:103], v[24:27]
    ds_read_b64_tr_b16 v[50:51], v93 offset:14592
    buffer_load_dwordx4 v[144:147], v224, s[40:43], s70 offen offset:3072 sc1
    v_mfma_f32_16x16x32_bf16 v[12:15], v[56:59], v[96:99], v[12:15]
    ds_read_b64_tr_b16 v[52:53], v94 offset:12544
    v_mfma_f32_16x16x32_bf16 v[28:31], v[56:59], v[100:103], v[28:31]
    ds_read_b64_tr_b16 v[54:55], v94 offset:14592
    v_mfma_f32_16x16x32_bf16 v[16:19], v[60:63], v[96:99], v[16:19]
    ds_read_b64_tr_b16 v[56:57], v95 offset:12544
    v_mfma_f32_16x16x32_bf16 v[32:35], v[60:63], v[100:103], v[32:35]
    ds_read_b64_tr_b16 v[58:59], v95 offset:14592
    buffer_load_dwordx4 v[148:151], v225, s[40:43], s70 offen offset:3072 sc1
    s_waitcnt vmcnt(10) lgkmcnt(8)
    v_mfma_f32_16x16x32_bf16 v[4:7], v[64:67], v[104:107], v[4:7]
    ds_read_b64_tr_b16 v[60:61], v92 offset:16896
    v_mfma_f32_16x16x32_bf16 v[20:23], v[64:67], v[108:111], v[20:23]
    ds_read_b64_tr_b16 v[62:63], v92 offset:18944
    v_mfma_f32_16x16x32_bf16 v[8:11], v[68:71], v[104:107], v[8:11]
    ds_read_b64_tr_b16 v[64:65], v93 offset:16896
    v_mfma_f32_16x16x32_bf16 v[24:27], v[68:71], v[108:111], v[24:27]
    ds_read_b64_tr_b16 v[66:67], v93 offset:18944
    buffer_load_dwordx4 v[96:99], v224, s[40:43], s71 offen offset:0 sc1
    v_mfma_f32_16x16x32_bf16 v[12:15], v[36:39], v[104:107], v[12:15]
    ds_read_b64_tr_b16 v[68:69], v94 offset:16896
    v_mfma_f32_16x16x32_bf16 v[28:31], v[36:39], v[108:111], v[28:31]
    ds_read_b64_tr_b16 v[70:71], v94 offset:18944
    v_mfma_f32_16x16x32_bf16 v[16:19], v[40:43], v[104:107], v[16:19]
    ds_read_b64_tr_b16 v[36:37], v95 offset:16896
    v_mfma_f32_16x16x32_bf16 v[32:35], v[40:43], v[108:111], v[32:35]
    ds_read_b64_tr_b16 v[38:39], v95 offset:18944
    buffer_load_dwordx4 v[100:103], v225, s[40:43], s71 offen offset:0 sc1
    s_waitcnt vmcnt(10) lgkmcnt(8)
    v_mfma_f32_16x16x32_bf16 v[4:7], v[44:47], v[112:115], v[4:7]
    ds_read_b64_tr_b16 v[40:41], v92 offset:20992
    v_mfma_f32_16x16x32_bf16 v[20:23], v[44:47], v[116:119], v[20:23]
    ds_read_b64_tr_b16 v[42:43], v92 offset:23040
    v_mfma_f32_16x16x32_bf16 v[8:11], v[48:51], v[112:115], v[8:11]
    ds_read_b64_tr_b16 v[44:45], v93 offset:20992
    v_mfma_f32_16x16x32_bf16 v[24:27], v[48:51], v[116:119], v[24:27]
    ds_read_b64_tr_b16 v[46:47], v93 offset:23040
    buffer_load_dwordx4 v[104:107], v224, s[40:43], s71 offen offset:1024 sc1
    v_mfma_f32_16x16x32_bf16 v[12:15], v[52:55], v[112:115], v[12:15]
    ds_read_b64_tr_b16 v[48:49], v94 offset:20992
    v_mfma_f32_16x16x32_bf16 v[28:31], v[52:55], v[116:119], v[28:31]
    ds_read_b64_tr_b16 v[50:51], v94 offset:23040
    v_mfma_f32_16x16x32_bf16 v[16:19], v[56:59], v[112:115], v[16:19]
    ds_read_b64_tr_b16 v[52:53], v95 offset:20992
    v_mfma_f32_16x16x32_bf16 v[32:35], v[56:59], v[116:119], v[32:35]
    ds_read_b64_tr_b16 v[54:55], v95 offset:23040
    buffer_load_dwordx4 v[108:111], v225, s[40:43], s71 offen offset:1024 sc1
    s_waitcnt vmcnt(10) lgkmcnt(8)
    v_mfma_f32_16x16x32_bf16 v[4:7], v[60:63], v[120:123], v[4:7]
    ds_read_b64_tr_b16 v[56:57], v92 offset:25344
    v_mfma_f32_16x16x32_bf16 v[20:23], v[60:63], v[124:127], v[20:23]
    ds_read_b64_tr_b16 v[58:59], v92 offset:27392
    v_mfma_f32_16x16x32_bf16 v[8:11], v[64:67], v[120:123], v[8:11]
    ds_read_b64_tr_b16 v[60:61], v93 offset:25344
    v_mfma_f32_16x16x32_bf16 v[24:27], v[64:67], v[124:127], v[24:27]
    ds_read_b64_tr_b16 v[62:63], v93 offset:27392
    buffer_load_dwordx4 v[112:115], v224, s[40:43], s71 offen offset:2048 sc1
    v_mfma_f32_16x16x32_bf16 v[12:15], v[68:71], v[120:123], v[12:15]
    ds_read_b64_tr_b16 v[64:65], v94 offset:25344
    v_mfma_f32_16x16x32_bf16 v[28:31], v[68:71], v[124:127], v[28:31]
    ds_read_b64_tr_b16 v[66:67], v94 offset:27392
    v_mfma_f32_16x16x32_bf16 v[16:19], v[36:39], v[120:123], v[16:19]
    ds_read_b64_tr_b16 v[68:69], v95 offset:25344
    v_mfma_f32_16x16x32_bf16 v[32:35], v[36:39], v[124:127], v[32:35]
    ds_read_b64_tr_b16 v[70:71], v95 offset:27392
    buffer_load_dwordx4 v[116:119], v225, s[40:43], s71 offen offset:2048 sc1
    s_waitcnt vmcnt(10) lgkmcnt(8)
    v_mfma_f32_16x16x32_bf16 v[4:7], v[40:43], v[128:131], v[4:7]
    ds_read_b64_tr_b16 v[36:37], v92 offset:29440
    v_mfma_f32_16x16x32_bf16 v[20:23], v[40:43], v[132:135], v[20:23]
    ds_read_b64_tr_b16 v[38:39], v92 offset:31488
    v_mfma_f32_16x16x32_bf16 v[8:11], v[44:47], v[128:131], v[8:11]
    ds_read_b64_tr_b16 v[40:41], v93 offset:29440
    v_mfma_f32_16x16x32_bf16 v[24:27], v[44:47], v[132:135], v[24:27]
    ds_read_b64_tr_b16 v[42:43], v93 offset:31488
    buffer_load_dwordx4 v[120:123], v224, s[40:43], s71 offen offset:3072 sc1
    v_mfma_f32_16x16x32_bf16 v[12:15], v[48:51], v[128:131], v[12:15]
    ds_read_b64_tr_b16 v[44:45], v94 offset:29440
    v_mfma_f32_16x16x32_bf16 v[28:31], v[48:51], v[132:135], v[28:31]
    ds_read_b64_tr_b16 v[46:47], v94 offset:31488
    v_mfma_f32_16x16x32_bf16 v[16:19], v[52:55], v[128:131], v[16:19]
    ds_read_b64_tr_b16 v[48:49], v95 offset:29440
    v_mfma_f32_16x16x32_bf16 v[32:35], v[52:55], v[132:135], v[32:35]
    ds_read_b64_tr_b16 v[50:51], v95 offset:31488
    buffer_load_dwordx4 v[124:127], v225, s[40:43], s71 offen offset:3072 sc1
    s_waitcnt vmcnt(10) lgkmcnt(8)
    v_mfma_f32_16x16x32_bf16 v[4:7], v[56:59], v[136:139], v[4:7]
    ds_read_b64_tr_b16 v[52:53], v84 offset:41984
    v_mfma_f32_16x16x32_bf16 v[20:23], v[56:59], v[140:143], v[20:23]
    ds_read_b64_tr_b16 v[54:55], v84 offset:44032
    v_mfma_f32_16x16x32_bf16 v[8:11], v[60:63], v[136:139], v[8:11]
    ds_read_b64_tr_b16 v[56:57], v85 offset:41984
    v_mfma_f32_16x16x32_bf16 v[24:27], v[60:63], v[140:143], v[24:27]
    ds_read_b64_tr_b16 v[58:59], v85 offset:44032
    v_mfma_f32_16x16x32_bf16 v[12:15], v[64:67], v[136:139], v[12:15]
    ds_read_b64_tr_b16 v[60:61], v86 offset:41984
    v_mfma_f32_16x16x32_bf16 v[28:31], v[64:67], v[140:143], v[28:31]
    ds_read_b64_tr_b16 v[62:63], v86 offset:44032
    v_mfma_f32_16x16x32_bf16 v[16:19], v[68:71], v[136:139], v[16:19]
    ds_read_b64_tr_b16 v[64:65], v87 offset:41984
    v_mfma_f32_16x16x32_bf16 v[32:35], v[68:71], v[140:143], v[32:35]
    ds_read_b64_tr_b16 v[66:67], v87 offset:44032
    s_waitcnt vmcnt(8) lgkmcnt(8)
    v_mfma_f32_16x16x32_bf16 v[4:7], v[36:39], v[144:147], v[4:7]
    ds_read_b64_tr_b16 v[68:69], v84 offset:46080
    v_mfma_f32_16x16x32_bf16 v[20:23], v[36:39], v[148:151], v[20:23]
    ds_read_b64_tr_b16 v[70:71], v84 offset:48128
    v_mfma_f32_16x16x32_bf16 v[8:11], v[40:43], v[144:147], v[8:11]
    ds_read_b64_tr_b16 v[36:37], v85 offset:46080
    v_mfma_f32_16x16x32_bf16 v[24:27], v[40:43], v[148:151], v[24:27]
    ds_read_b64_tr_b16 v[38:39], v85 offset:48128
    v_mfma_f32_16x16x32_bf16 v[12:15], v[44:47], v[144:147], v[12:15]
    ds_read_b64_tr_b16 v[40:41], v86 offset:46080
    v_mfma_f32_16x16x32_bf16 v[28:31], v[44:47], v[148:151], v[28:31]
    ds_read_b64_tr_b16 v[42:43], v86 offset:48128
    v_mfma_f32_16x16x32_bf16 v[16:19], v[48:51], v[144:147], v[16:19]
    ds_read_b64_tr_b16 v[44:45], v87 offset:46080
    v_mfma_f32_16x16x32_bf16 v[32:35], v[48:51], v[148:151], v[32:35]
    ds_read_b64_tr_b16 v[46:47], v87 offset:48128
    s_waitcnt vmcnt(6) lgkmcnt(8)
    v_mfma_f32_16x16x32_bf16 v[4:7], v[52:55], v[96:99], v[4:7]
    ds_read_b64_tr_b16 v[48:49], v84 offset:51200
    v_mfma_f32_16x16x32_bf16 v[20:23], v[52:55], v[100:103], v[20:23]
    ds_read_b64_tr_b16 v[50:51], v84 offset:53248
    v_mfma_f32_16x16x32_bf16 v[8:11], v[56:59], v[96:99], v[8:11]
    ds_read_b64_tr_b16 v[52:53], v85 offset:51200
    v_mfma_f32_16x16x32_bf16 v[24:27], v[56:59], v[100:103], v[24:27]
    ds_read_b64_tr_b16 v[54:55], v85 offset:53248
    v_mfma_f32_16x16x32_bf16 v[12:15], v[60:63], v[96:99], v[12:15]
    ds_read_b64_tr_b16 v[56:57], v86 offset:51200
    v_mfma_f32_16x16x32_bf16 v[28:31], v[60:63], v[100:103], v[28:31]
    ds_read_b64_tr_b16 v[58:59], v86 offset:53248
    v_mfma_f32_16x16x32_bf16 v[16:19], v[64:67], v[96:99], v[16:19]
    ds_read_b64_tr_b16 v[60:61], v87 offset:51200
    v_mfma_f32_16x16x32_bf16 v[32:35], v[64:67], v[100:103], v[32:35]
    ds_read_b64_tr_b16 v[62:63], v87 offset:53248
    s_waitcnt vmcnt(4) lgkmcnt(8)
    v_mfma_f32_16x16x32_bf16 v[4:7], v[68:71], v[104:107], v[4:7]
    ds_read_b64_tr_b16 v[64:65], v84 offset:55296
    v_mfma_f32_16x16x32_bf16 v[20:23], v[68:71], v[108:111], v[20:23]
    ds_read_b64_tr_b16 v[66:67], v84 offset:57344
    v_mfma_f32_16x16x32_bf16 v[8:11], v[36:39], v[104:107], v[8:11]
    ds_read_b64_tr_b16 v[68:69], v85 offset:55296
    v_mfma_f32_16x16x32_bf16 v[24:27], v[36:39], v[108:111], v[24:27]
    ds_read_b64_tr_b16 v[70:71], v85 offset:57344
    v_mfma_f32_16x16x32_bf16 v[12:15], v[40:43], v[104:107], v[12:15]
    ds_read_b64_tr_b16 v[36:37], v86 offset:55296
    v_mfma_f32_16x16x32_bf16 v[28:31], v[40:43], v[108:111], v[28:31]
    ds_read_b64_tr_b16 v[38:39], v86 offset:57344
    v_mfma_f32_16x16x32_bf16 v[16:19], v[44:47], v[104:107], v[16:19]
    ds_read_b64_tr_b16 v[40:41], v87 offset:55296
    v_mfma_f32_16x16x32_bf16 v[32:35], v[44:47], v[108:111], v[32:35]
    ds_read_b64_tr_b16 v[42:43], v87 offset:57344
    s_waitcnt vmcnt(2) lgkmcnt(8)
    v_mfma_f32_16x16x32_bf16 v[4:7], v[48:51], v[112:115], v[4:7]
    s_mul_i32 s37, s32, 80896
    s_lshl_b32 s38, s33, 11
    v_mfma_f32_16x16x32_bf16 v[20:23], v[48:51], v[116:119], v[20:23]
    s_add_u32 s37, s37, s38
    s_add_u32 s37, s37, 78848
    v_mfma_f32_16x16x32_bf16 v[8:11], v[52:55], v[112:115], v[8:11]
    v_lshrrev_b32 v1, 5, v0
    v_xor_b32 v1, v1, v0
    v_mfma_f32_16x16x32_bf16 v[24:27], v[52:55], v[116:119], v[24:27]
    v_and_b32 v1, 7, v1
    v_lshl_add_u32 v1, v1, 4, s37
    v_mfma_f32_16x16x32_bf16 v[12:15], v[56:59], v[112:115], v[12:15]
    v_bfe_u32 v2, v0, 4, 1
    v_lshl_add_u32 v1, v2, 3, v1
    v_mfma_f32_16x16x32_bf16 v[28:31], v[56:59], v[116:119], v[28:31]
    v_and_b32 v2, 15, v0
    v_lshl_add_u32 v84, v2, 7, v1
    v_mfma_f32_16x16x32_bf16 v[16:19], v[60:63], v[112:115], v[16:19]
    v_xor_b32 v85, 32, v84
    v_xor_b32 v86, 64, v84
    v_mfma_f32_16x16x32_bf16 v[32:35], v[60:63], v[116:119], v[32:35]
    v_xor_b32 v87, 96, v84
    v_lshrrev_b32 v1, 3, v0
    s_waitcnt vmcnt(0) lgkmcnt(0)
    v_mfma_f32_16x16x32_bf16 v[4:7], v[64:67], v[120:123], v[4:7]
    v_xor_b32 v1, v1, v0
    v_and_b32 v1, 7, v1
    v_mfma_f32_16x16x32_bf16 v[20:23], v[64:67], v[124:127], v[20:23]
    v_and_b32 v2, 56, v0
    v_add_u32 v1, v1, v2
    v_mfma_f32_16x16x32_bf16 v[8:11], v[68:71], v[120:123], v[8:11]
    v_lshl_add_u32 v88, v1, 4, s37
    v_mfma_f32_16x16x32_bf16 v[24:27], v[68:71], v[124:127], v[24:27]
    v_mfma_f32_16x16x32_bf16 v[12:15], v[36:39], v[120:123], v[12:15]
    v_mfma_f32_16x16x32_bf16 v[28:31], v[36:39], v[124:127], v[28:31]
    v_mfma_f32_16x16x32_bf16 v[16:19], v[40:43], v[120:123], v[16:19]
    v_mfma_f32_16x16x32_bf16 v[32:35], v[40:43], v[124:127], v[32:35]
    v_cvt_pk_bf16_f32 v36, v4, v5
    v_cvt_pk_bf16_f32 v37, v6, v7
    ds_write_b64 v84, v[36:37]
    v_cvt_pk_bf16_f32 v38, v8, v9
    v_cvt_pk_bf16_f32 v39, v10, v11
    ds_write_b64 v85, v[38:39]
    v_cvt_pk_bf16_f32 v40, v12, v13
    v_cvt_pk_bf16_f32 v41, v14, v15
    ds_write_b64 v86, v[40:41]
    v_cvt_pk_bf16_f32 v42, v16, v17
    v_cvt_pk_bf16_f32 v43, v18, v19
    ds_write_b64 v87, v[42:43]
    ds_read_b128 v[52:55], v88 offset:0
    ds_read_b128 v[56:59], v88 offset:1024
    v_cvt_pk_bf16_f32 v44, v20, v21
    v_cvt_pk_bf16_f32 v45, v22, v23
    ds_write_b64 v84, v[44:45]
    v_cvt_pk_bf16_f32 v46, v24, v25
    v_cvt_pk_bf16_f32 v47, v26, v27
    ds_write_b64 v85, v[46:47]
    v_cvt_pk_bf16_f32 v48, v28, v29
    v_cvt_pk_bf16_f32 v49, v30, v31
    ds_write_b64 v86, v[48:49]
    v_cvt_pk_bf16_f32 v50, v32, v33
    v_cvt_pk_bf16_f32 v51, v34, v35
    ds_write_b64 v87, v[50:51]
    ds_read_b128 v[60:63], v88 offset:0
    ds_read_b128 v[64:67], v88 offset:1024
    s_mov_b32 s37, 0
    s_waitcnt lgkmcnt(7)
    buffer_store_dwordx4 v[52:55], v226, s[48:51], s37 offen nt
    s_mov_b32 s37, 65536
    s_waitcnt lgkmcnt(6)
    buffer_store_dwordx4 v[56:59], v226, s[48:51], s37 offen nt
    s_mov_b32 s37, 131072
    s_waitcnt lgkmcnt(1)
    buffer_store_dwordx4 v[60:63], v226, s[48:51], s37 offen nt
    s_mov_b32 s37, 196608
    s_waitcnt lgkmcnt(0)
    buffer_store_dwordx4 v[64:67], v226, s[48:51], s37 offen nt
    s_endpgm
L_g1_rare:
    s_waitcnt vmcnt(0)
    s_cmp_lg_u32 s36, 1
    s_cbranch_scc1 L_g1_bar
    v_readfirstlane_b32 s38, v1
    s_nop 0
    s_cmp_ge_u32 s38, 4
    s_cbranch_scc1 L_sl_done_56
    s_mov_b32 s39, 1048576
L_sl_loop_57:
    ds_read_b32 v1, v228 offset:24
    s_waitcnt lgkmcnt(0)
    v_readfirstlane_b32 s38, v1
    s_nop 0
    s_cmp_ge_u32 s38, 4
    s_cbranch_scc1 L_sl_done_56
    s_sleep 1
    s_sub_u32 s39, s39, 1
    s_cbranch_scc0 L_sl_loop_57
L_sl_done_56:
    s_branch L_g1_nobar
L_end:
    s_endpgm
.section .rodata,"a"
.p2align 6
.amdhsa_kernel concat_heads__ssm_conv_h3__sliding_local_dilated__prompt_kernel
  .amdhsa_next_free_vgpr 256
  .amdhsa_next_free_sgpr 102
  .amdhsa_accum_offset 256
  .amdhsa_group_segment_fixed_size 0
  .amdhsa_kernarg_size 96
  .amdhsa_user_sgpr_count 2
  .amdhsa_user_sgpr_kernarg_segment_ptr 1
  .amdhsa_system_sgpr_workgroup_id_x 1
  .amdhsa_float_denorm_mode_32 3
.end_amdhsa_kernel
```

```asm
; @launch grid=(256,1,1) block=(512,1,1) lds=163840
.amdgcn_target "amdgcn-amd-amdhsa--gfx950"
.text
.globl concat_heads__ssm_conv_h3__sliding_local_dilated__prompt_kernel
.p2align 8
.type concat_heads__ssm_conv_h3__sliding_local_dilated__prompt_kernel,@function
concat_heads__ssm_conv_h3__sliding_local_dilated__prompt_kernel:
L_entry:
    s_getpc_b64 s[32:33]
    s_cmp_ge_u32 s2, 256
    s_cbranch_scc1 L_end
    s_load_dwordx16 s[8:23], s[0:1], 0
    s_load_dwordx8 s[24:31], s[0:1], 64
    v_lshrrev_b32 v1, 6, v0
    s_and_b32 s4, s2, 1
    v_readfirstlane_b32 s3, v1
    v_and_b32 v0, 63, v0
    s_bfe_u32 s5, s2, 0x30003
    s_bfe_u32 s6, s2, 0x20001
    s_lshr_b32 s7, s2, 6
    s_lshl2_add_u32 s6, s6, s7
    s_cmp_ge_u32 s3, 4
    s_cbranch_scc1 L_crole
    s_bfe_u32 s34, s2, 0x20003
    s_lshl2_add_u32 s34, s34, s3
    s_lshl_b32 s34, s34, 7
    v_lshl_add_u32 v1, v0, 11, s34
    v_min_u32 v1, L_end-L_entry-8, v1
    s_mov_b64 exec, 0xffff
    global_load_dword v249, v1, s[32:33]
    s_mov_b64 exec, -1
    s_and_b32 s84, s2, 3
    s_lshl2_add_u32 s84, s84, s3
    s_lshr_b32 s85, s2, 2
    s_mul_i32 s86, s3, 8448
    s_add_u32 s86, s86, 125952
    s_lshl_b32 s87, s85, 9
    s_add_u32 s87, s87, s84
    s_lshl_b32 s87, s87, 7
    v_and_b32 v231, 7, v0
    v_lshl_add_u32 v231, v231, 4, s87
    v_lshrrev_b32 v230, 3, v0
    v_lshl_add_u32 v230, v230, 13, v231
    v_subrev_u32 v231, 6144, v230
    v_subrev_u32 v232, 4096, v230
    v_subrev_u32 v233, 2048, v230
    v_add_u32 v234, 4096, v230
    v_lshlrev_b32 v235, 4, v0
    s_lshl_b32 s87, s84, 9
    s_add_u32 m0, s86, 4224
    s_waitcnt lgkmcnt(0)
    s_mov_b32 s80, s14
    s_mov_b32 s81, s15
    s_mov_b32 s82, 0x2000
    s_mov_b32 s83, 0x20000
    s_mov_b32 s72, s10
    s_mov_b32 s73, s11
    s_mov_b32 s74, 0x400000
    s_mov_b32 s75, 0x20000
    s_mov_b32 exec_hi, 0
    buffer_load_dwordx4 v235, s[80:83], s87 offen lds
    s_mov_b64 exec, -1
    buffer_load_dwordx4 v[108:111], v231, s[72:75], 0 offen offset:0 nt
    buffer_load_dwordx4 v[112:115], v232, s[72:75], 0 offen offset:0 nt
    buffer_load_dwordx4 v[116:119], v233, s[72:75], 0 offen offset:0 nt
    buffer_load_dwordx4 v[120:123], v230, s[72:75], 0 offen offset:0 nt
    buffer_load_dwordx4 v[124:127], v230, s[72:75], 0 offen offset:2048 nt
    buffer_load_dwordx4 v[128:131], v234, s[72:75], 0 offen offset:0 nt
    buffer_load_dwordx4 v[132:135], v234, s[72:75], 0 offen offset:2048 nt
    s_mov_b32 s76, s12
    s_mov_b32 s77, s13
    s_mov_b32 s78, 0x400000
    s_mov_b32 s79, 0x20000
    buffer_load_dwordx4 v[136:139], v230, s[76:79], 0 offen offset:0 nt
    buffer_load_dwordx4 v[140:143], v230, s[76:79], 0 offen offset:2048 nt
    buffer_load_dwordx4 v[144:147], v234, s[76:79], 0 offen offset:0 nt
    buffer_load_dwordx4 v[148:151], v234, s[76:79], 0 offen offset:2048 nt
    s_branch L_grole
L_crole:
    s_sub_u32 s70, s3, 4
    s_lshl_b32 s43, s70, 12
    s_lshl_b32 s44, s70, 11
    s_add_u32 s44, s44, 17408
    s_lshl_b32 s49, s70, 4
    s_lshl_b64 s[46:47], 0xffff, s49
    v_lshrrev_b32 v13, 3, v0
    v_and_b32 v14, 7, v0
    v_lshrrev_b32 v15, 4, v0
    s_lshl2_add_u32 s50, s5, s70
    s_lshl_b32 s50, s50, 6
    s_add_u32 s50, s50, s4
    s_lshl_b32 s50, s50, 11
    v_lshl_add_u32 v16, v13, 12, s50
    v_xor_b32 v17, v14, v15
    v_lshl_add_u32 v2, v17, 4, v16
    v_xor_b32 v3, 64, v2
    v_add_u32 v3, 31744, v3
    v_add_u32 v4, 63488, v2
    v_add_u32 v5, 63488, v3
    s_lshl_b32 s49, s5, 7
    s_sub_u32 s49, s49, 8
    s_max_i32 s49, s49, 0
    s_lshl1_add_u32 s49, s49, s4
    s_lshl_b32 s49, s49, 11
    v_lshl_add_u32 v16, v13, 12, s49
    v_lshlrev_b32 v17, 1, v15
    v_xor_b32 v18, v14, v13
    v_lshl_add_u32 v6, v18, 4, v16
    s_mul_i32 s49, s70, 768
    s_add_u32 s49, s49, s6
    s_lshl_b32 s49, s49, 7
    v_mul_u32_u24 v16, 6144, v13
    v_and_b32 v17, 2, v17
    v_xor_b32 v17, v14, v17
    v_lshlrev_b32 v17, 4, v17
    v_add3_u32 v7, v17, v16, s49
    v_xor_b32 v8, 64, v7
    v_add_u32 v8, 48128, v8
    v_add_u32 v9, 2048, v7
    v_add_u32 v10, 2048, v8
    v_add_u32 v11, 4096, v7
    v_add_u32 v12, 4096, v8
    s_movk_i32 s40, 0
    s_mov_b32 s41, 0
    s_lshr_b32 s90, s2, 3
    s_and_b32 s91, s3, 3
    s_lshl2_add_u32 s90, s90, s91
    s_and_b32 s91, s2, 6
    s_lshl3_add_u32 s88, s90, s91
    s_lshl1_add_u32 s88, s88, s4
    s_lshl_b32 s88, s88, 11
    s_and_b32 s89, s2, 7
    s_and_b32 s91, s90, 1
    s_lshl1_add_u32 s89, s89, s91
    s_lshr_b32 s90, s90, 1
    s_mul_i32 s90, s90, 48
    s_add_u32 s89, s89, s90
    s_lshl_b32 s89, s89, 7
    v_and_b32 v251, 1, v0
    v_lshlrev_b32 v251, 12, v251
    v_lshrrev_b32 v252, 1, v0
    v_lshl_add_u32 v251, v252, 7, v251
    v_lshrrev_b32 v250, 2, v0
    v_mul_u32_u24 v250, 393216, v250
    v_and_b32 v252, 3, v0
    v_lshl_add_u32 v252, v252, 11, v250
    s_waitcnt lgkmcnt(0)
    s_mov_b32 s32, s20
    s_mov_b32 s33, s21
    s_mov_b32 s34, 0x400000
    s_mov_b32 s35, 0x20000
    s_mov_b32 s36, s22
    s_mov_b32 s37, s23
    s_mov_b32 s38, 0x600000
    s_mov_b32 s39, 0x20000
    s_setprio 0
    s_and_b32 s73, s2, 7
    s_xor_b32 s73, s73, 2
    s_lshr_b32 s74, s2, 7
    s_lshl1_add_u32 s68, s73, s74
    s_bfe_u32 s69, s2, 0x40003
    s_lshl4_add_u32 s71, s68, s69
    s_lshl2_add_u32 s71, s71, s70
    s_mul_i32 s80, s70, 8448
    s_add_u32 s80, s80, 125952
    s_mul_i32 s81, s70, 9216
    s_add_u32 s81, s81, 41984
    s_add_u32 s52, s30, 0xe00000
    s_addc_u32 s53, s31, 0
    s_mov_b32 s54, 0x20000
    s_mov_b32 s55, 0x20000
    s_add_u32 s64, s30, 0x900000
    s_addc_u32 s65, s31, 0
    s_mov_b32 s66, 0x420000
    s_mov_b32 s67, 0x20000
    s_lshl_b32 s84, s71, 12
    s_mul_i32 s85, s71, 4224
    s_add_u32 s85, s85, 4194304
    s_lshr_b32 s72, s71, 1
    s_lshl_b32 s72, s72, 2
    s_load_dword s72, s[18:19], s72
    v_lshlrev_b32 v224, 4, v0
    v_mov_b32 v228, 0
    v_mov_b32 v229, 0
    v_mov_b32 v230, 0
    v_mov_b32 v231, 0
    v_mov_b32 v227, 134352
    v_mov_b32 v244, 1
    s_bfe_u32 s87, s2, 0x20006
    s_mov_b64 exec, 1
    ds_write_b128 v227, v[228:231]
    ds_write_b128 v227, v[228:231] offset:16
    ds_write_b128 v227, v[228:231] offset:32
    s_mov_b64 exec, -1
    s_mov_b32 exec_lo, 0x7777
    s_mov_b32 exec_hi, 0x0
    s_bfe_u32 s7, s89, 0x30007
    s_cmp_lg_u32 s7, 1
    s_cbranch_scc1 L_wx3_1
    buffer_load_dword v250, v252, s[36:39], s89 offen offset:256
L_wx3_1:
    buffer_load_dword v250, v252, s[36:39], s89 offen
    s_mov_b32 exec_lo, 0xff
    s_mov_b32 exec_hi, 0
    buffer_load_dword v250, v251, s[32:35], s88 offen
    s_mov_b64 exec, -1
    s_add_u32 m0, s43, 0
    s_nop 0
    buffer_load_dwordx4 v2, s[32:35], s40 offen offset:0 lds
    s_add_u32 m0, s44, 0
    s_nop 0
    buffer_load_dwordx4 v7, s[36:39], s41 offen offset:0 lds
    buffer_load_dwordx4 v8, s[36:39], s41 offen offset:1024 lds
    s_add_u32 m0, s43, 0
    s_nop 0
    buffer_load_dwordx4 v3, s[32:35], s40 offen offset:1024 lds
    s_add_u32 m0, s44, 8192
    s_nop 0
    buffer_load_dwordx4 v9, s[36:39], s41 offen offset:0 lds
    buffer_load_dwordx4 v10, s[36:39], s41 offen offset:1024 lds
    s_add_u32 m0, s43, 0
    s_nop 0
    buffer_load_dwordx4 v4, s[32:35], s40 offen offset:2048 lds
    s_add_u32 m0, s44, 16384
    s_nop 0
    buffer_load_dwordx4 v11, s[36:39], s41 offen offset:0 lds
    buffer_load_dwordx4 v12, s[36:39], s41 offen offset:1024 lds
    s_add_u32 m0, s43, 0
    s_nop 0
    buffer_load_dwordx4 v5, s[32:35], s40 offen offset:3072 lds
    s_mov_b32 m0, 16384
    s_mov_b64 exec, s[46:47]
    buffer_load_dwordx4 v6, s[32:35], s40 offen lds
    s_mov_b64 exec, -1
    s_movk_i32 s40, 128
    s_mov_b32 s41, 393216
    s_add_u32 m0, s43, 41984
    s_nop 0
    buffer_load_dwordx4 v2, s[32:35], s40 offen offset:0 lds
    s_add_u32 m0, s44, 41984
    s_nop 0
    buffer_load_dwordx4 v7, s[36:39], s41 offen offset:0 lds
    buffer_load_dwordx4 v8, s[36:39], s41 offen offset:1024 lds
    s_add_u32 m0, s43, 41984
    s_nop 0
    buffer_load_dwordx4 v3, s[32:35], s40 offen offset:1024 lds
    s_add_u32 m0, s44, 50176
    s_nop 0
    buffer_load_dwordx4 v9, s[36:39], s41 offen offset:0 lds
    buffer_load_dwordx4 v10, s[36:39], s41 offen offset:1024 lds
    s_add_u32 m0, s43, 41984
    s_nop 0
    buffer_load_dwordx4 v4, s[32:35], s40 offen offset:2048 lds
    s_add_u32 m0, s44, 58368
    s_nop 0
    buffer_load_dwordx4 v11, s[36:39], s41 offen offset:0 lds
    buffer_load_dwordx4 v12, s[36:39], s41 offen offset:1024 lds
    s_add_u32 m0, s43, 41984
    s_nop 0
    buffer_load_dwordx4 v5, s[32:35], s40 offen offset:3072 lds
    s_mov_b32 m0, 58368
    s_mov_b64 exec, s[46:47]
    buffer_load_dwordx4 v6, s[32:35], s40 offen lds
    s_mov_b64 exec, -1
    s_movk_i32 s40, 256
    s_mov_b32 s41, 786432
    s_lshr_b32 s74, s69, 2
    s_and_b32 s75, s69, 3
    s_lshl3_add_u32 s74, s74, s75
    s_lshl3_add_u32 s74, s74, s70
    s_lshl_b32 s74, s74, 3
    v_bfe_u32 v234, v0, 3, 1
    v_lshl_add_u32 v225, v234, 8, s74
    v_bfe_u32 v234, v0, 4, 1
    v_lshl_add_u32 v225, v234, 1, v225
    v_lshrrev_b32 v234, 5, v0
    v_lshl_add_u32 v225, v234, 5, v225
    s_lshl_b32 s74, s68, 7
    v_and_b32 v234, 7, v0
    v_lshl_add_u32 v234, v234, 4, s74
    v_lshl_add_u32 v226, v225, 12, v234
    v_lshl_add_u32 v225, v225, 11, v234
    v_and_b32 v234, 1, v0
    v_xor_b32 v234, 1, v234
    v_mul_u32_u24 v232, 4224, v234
    v_mul_u32_u24 v233, 4576, v234
    v_bfe_u32 v234, v0, 1, 3
    v_lshl_add_u32 v232, v234, 3, v232
    v_xor_b32 v234, 7, v234
    v_lshl_add_u32 v233, v234, 6, v233
    v_lshrrev_b32 v234, 4, v0
    v_lshl_add_u32 v232, v234, 4, v232
    v_lshl_add_u32 v233, v234, 4, v233
    v_add3_u32 v232, v232, s80, 8
    v_add_u32 v233, s81, v233
    s_waitcnt lgkmcnt(0)
    s_bitcmp1_b32 s71, 0
    s_cselect_b32 s74, 0, 16
    s_lshl_b32 s72, s72, s74
    s_and_b32 s72, s72, 0xffff0000
    v_and_b32 v235, 1, v0
    v_lshlrev_b32 v235, 4, v235
    v_lshrrev_b32 v235, v235, s72
    v_bfe_u32 v236, v0, 1, 3
    v_lshl_add_u32 v236, v234, 1, v236
    v_cmp_eq_u32 vcc, 7, v236
    v_mov_b32 v241, 0
    v_mov_b32 v243, 0
    v_cndmask_b32 v240, 0, v235, vcc
    v_cmp_eq_u32 vcc, 6, v236
    s_nop 1
    v_cndmask_b32 v242, 0, v235, vcc
    s_lshr_b32 s7, s2, 6
    s_mul_i32 s90, s7, 1048576
    s_sub_u32 s88, s88, s90
    s_mul_i32 s90, s7, 98304
    s_sub_u32 s89, s89, s90
    v_lshrrev_b32 v20, 3, v0
    v_mul_u32_u24 v20, 1048064, v20
    v_add_u32 v251, v251, v20
    v_lshrrev_b32 v20, 4, v0
    v_mul_u32_u24 v20, 1474560, v20
    v_sub_u32 v252, v252, v20
    s_waitcnt vmcnt(11)
    s_barrier
    s_add_u32 m0, s43, 83968
    s_nop 0
    buffer_load_dwordx4 v2, s[32:35], s40 offen offset:0 lds
    s_add_u32 m0, s44, 83968
    s_nop 0
    buffer_load_dwordx4 v7, s[36:39], s41 offen offset:0 lds
    buffer_load_dwordx4 v8, s[36:39], s41 offen offset:1024 lds
    s_add_u32 m0, s43, 83968
    s_nop 0
    buffer_load_dwordx4 v3, s[32:35], s40 offen offset:1024 lds
    s_add_u32 m0, s44, 92160
    s_nop 0
    buffer_load_dwordx4 v9, s[36:39], s41 offen offset:0 lds
    buffer_load_dwordx4 v10, s[36:39], s41 offen offset:1024 lds
    s_add_u32 m0, s43, 83968
    s_nop 0
    buffer_load_dwordx4 v4, s[32:35], s40 offen offset:2048 lds
    s_add_u32 m0, s44, 100352
    s_nop 0
    buffer_load_dwordx4 v11, s[36:39], s41 offen offset:0 lds
    buffer_load_dwordx4 v12, s[36:39], s41 offen offset:1024 lds
    s_add_u32 m0, s43, 83968
    s_nop 0
    buffer_load_dwordx4 v5, s[32:35], s40 offen offset:3072 lds
    s_mov_b32 m0, 100352
    s_mov_b64 exec, s[46:47]
    buffer_load_dwordx4 v6, s[32:35], s40 offen lds
    s_mov_b64 exec, -1
    s_movk_i32 s40, 384
    s_mov_b32 s41, 1179648
    s_cmp_lg_u32 s87, 0
    s_cbranch_scc1 L_stg_3
    s_add_u32 s6, s89, 1572864
    s_mov_b32 exec_lo, 0x770077
    s_mov_b32 exec_hi, 0x770077
    s_bfe_u32 s7, s89, 0x30007
    s_cmp_lg_u32 s7, 1
    s_cbranch_scc1 L_wx3_4
    buffer_load_dword v250, v252, s[36:39], s6 offen offset:256
L_wx3_4:
    buffer_load_dword v250, v252, s[36:39], s6 offen
    s_mov_b32 exec_lo, 0xf0f0f0f
    s_mov_b32 exec_hi, 0
    buffer_load_dword v250, v251, s[32:35], s88 offen offset:512
    s_mov_b64 exec, -1
L_stg_3:
    s_waitcnt vmcnt(13)
    s_bitcmp1_b32 1, s87
    s_cbranch_scc1 L_mw_5
    s_waitcnt vmcnt(11)
L_mw_5:
    s_barrier
    s_add_u32 m0, s43, 0
    s_nop 0
    buffer_load_dwordx4 v2, s[32:35], s40 offen offset:0 lds
    s_add_u32 m0, s44, 0
    s_nop 0
    buffer_load_dwordx4 v7, s[36:39], s41 offen offset:0 lds
    buffer_load_dwordx4 v8, s[36:39], s41 offen offset:1024 lds
    s_add_u32 m0, s43, 0
    s_nop 0
    buffer_load_dwordx4 v3, s[32:35], s40 offen offset:1024 lds
    s_add_u32 m0, s44, 8192
    s_nop 0
    buffer_load_dwordx4 v9, s[36:39], s41 offen offset:0 lds
    buffer_load_dwordx4 v10, s[36:39], s41 offen offset:1024 lds
    s_add_u32 m0, s43, 0
    s_nop 0
    buffer_load_dwordx4 v4, s[32:35], s40 offen offset:2048 lds
    s_add_u32 m0, s44, 16384
    s_nop 0
    buffer_load_dwordx4 v11, s[36:39], s41 offen offset:0 lds
    buffer_load_dwordx4 v12, s[36:39], s41 offen offset:1024 lds
    s_add_u32 m0, s43, 0
    s_nop 0
    buffer_load_dwordx4 v5, s[32:35], s40 offen offset:3072 lds
    s_mov_b32 m0, 16384
    s_mov_b64 exec, s[46:47]
    buffer_load_dwordx4 v6, s[32:35], s40 offen lds
    s_mov_b64 exec, -1
    s_movk_i32 s40, 512
    s_mov_b32 s41, 1572864
    s_cmp_lg_u32 s87, 1
    s_cbranch_scc1 L_stg_6
    s_add_u32 s6, s89, 2359296
    s_mov_b32 exec_lo, 0x770077
    s_mov_b32 exec_hi, 0x770077
    s_bfe_u32 s7, s89, 0x30007
    s_cmp_lg_u32 s7, 1
    s_cbranch_scc1 L_wx3_7
    buffer_load_dword v250, v252, s[36:39], s6 offen offset:256
L_wx3_7:
    buffer_load_dword v250, v252, s[36:39], s6 offen
    s_mov_b32 exec_lo, 0xf0f0f0f
    s_mov_b32 exec_hi, 0
    buffer_load_dword v250, v251, s[32:35], s88 offen offset:768
    s_mov_b64 exec, -1
L_stg_6:
    s_waitcnt vmcnt(13)
    s_bitcmp1_b32 3, s87
    s_cbranch_scc1 L_mw_8
    s_waitcnt vmcnt(11)
L_mw_8:
    s_barrier
    s_add_u32 m0, s43, 41984
    s_nop 0
    buffer_load_dwordx4 v2, s[32:35], s40 offen offset:0 lds
    s_add_u32 m0, s44, 41984
    s_nop 0
    buffer_load_dwordx4 v7, s[36:39], s41 offen offset:0 lds
    buffer_load_dwordx4 v8, s[36:39], s41 offen offset:1024 lds
    s_add_u32 m0, s43, 41984
    s_nop 0
    buffer_load_dwordx4 v3, s[32:35], s40 offen offset:1024 lds
    s_add_u32 m0, s44, 50176
    s_nop 0
    buffer_load_dwordx4 v9, s[36:39], s41 offen offset:0 lds
    buffer_load_dwordx4 v10, s[36:39], s41 offen offset:1024 lds
    s_add_u32 m0, s43, 41984
    s_nop 0
    buffer_load_dwordx4 v4, s[32:35], s40 offen offset:2048 lds
    s_add_u32 m0, s44, 58368
    s_nop 0
    buffer_load_dwordx4 v11, s[36:39], s41 offen offset:0 lds
    buffer_load_dwordx4 v12, s[36:39], s41 offen offset:1024 lds
    s_add_u32 m0, s43, 41984
    s_nop 0
    buffer_load_dwordx4 v5, s[32:35], s40 offen offset:3072 lds
    s_mov_b32 m0, 58368
    s_mov_b64 exec, s[46:47]
    buffer_load_dwordx4 v6, s[32:35], s40 offen lds
    s_mov_b64 exec, -1
    s_movk_i32 s40, 640
    s_mov_b32 s41, 1966080
    s_waitcnt vmcnt(13)
    s_bitcmp1_b32 2, s87
    s_cbranch_scc1 L_mw_9
    s_waitcnt vmcnt(11)
L_mw_9:
    s_barrier
    s_add_u32 m0, s43, 83968
    s_nop 0
    buffer_load_dwordx4 v2, s[32:35], s40 offen offset:0 lds
    s_add_u32 m0, s44, 83968
    s_nop 0
    buffer_load_dwordx4 v7, s[36:39], s41 offen offset:0 lds
    buffer_load_dwordx4 v8, s[36:39], s41 offen offset:1024 lds
    s_add_u32 m0, s43, 83968
    s_nop 0
    buffer_load_dwordx4 v3, s[32:35], s40 offen offset:1024 lds
    s_add_u32 m0, s44, 92160
    s_nop 0
    buffer_load_dwordx4 v9, s[36:39], s41 offen offset:0 lds
    buffer_load_dwordx4 v10, s[36:39], s41 offen offset:1024 lds
    s_add_u32 m0, s43, 83968
    s_nop 0
    buffer_load_dwordx4 v4, s[32:35], s40 offen offset:2048 lds
    s_add_u32 m0, s44, 100352
    s_nop 0
    buffer_load_dwordx4 v11, s[36:39], s41 offen offset:0 lds
    buffer_load_dwordx4 v12, s[36:39], s41 offen offset:1024 lds
    s_add_u32 m0, s43, 83968
    s_nop 0
    buffer_load_dwordx4 v5, s[32:35], s40 offen offset:3072 lds
    s_mov_b32 m0, 100352
    s_mov_b64 exec, s[46:47]
    buffer_load_dwordx4 v6, s[32:35], s40 offen lds
    s_mov_b64 exec, -1
    s_movk_i32 s40, 768
    s_mov_b32 s41, 2359296
    s_cmp_lg_u32 s87, 2
    s_cbranch_scc1 L_stg_10
    s_add_u32 s6, s89, 3145728
    s_mov_b32 exec_lo, 0x770077
    s_mov_b32 exec_hi, 0x770077
    s_bfe_u32 s7, s89, 0x30007
    s_cmp_lg_u32 s7, 1
    s_cbranch_scc1 L_wx3_11
    buffer_load_dword v250, v252, s[36:39], s6 offen offset:256
L_wx3_11:
    buffer_load_dword v250, v252, s[36:39], s6 offen
    s_mov_b32 exec_lo, 0xf0f0f0f
    s_mov_b32 exec_hi, 0
    buffer_load_dword v250, v251, s[32:35], s88 offen offset:1024
    s_mov_b64 exec, -1
L_stg_10:
    s_waitcnt vmcnt(13)
    s_bitcmp1_b32 4, s87
    s_cbranch_scc1 L_mw_12
    s_waitcnt vmcnt(11)
L_mw_12:
    s_barrier
    s_add_u32 m0, s43, 0
    s_nop 0
    buffer_load_dwordx4 v2, s[32:35], s40 offen offset:0 lds
    s_add_u32 m0, s44, 0
    s_nop 0
    buffer_load_dwordx4 v7, s[36:39], s41 offen offset:0 lds
    buffer_load_dwordx4 v8, s[36:39], s41 offen offset:1024 lds
    s_add_u32 m0, s43, 0
    s_nop 0
    buffer_load_dwordx4 v3, s[32:35], s40 offen offset:1024 lds
    s_add_u32 m0, s44, 8192
    s_nop 0
    buffer_load_dwordx4 v9, s[36:39], s41 offen offset:0 lds
    buffer_load_dwordx4 v10, s[36:39], s41 offen offset:1024 lds
    s_add_u32 m0, s43, 0
    s_nop 0
    buffer_load_dwordx4 v4, s[32:35], s40 offen offset:2048 lds
    s_add_u32 m0, s44, 16384
    s_nop 0
    buffer_load_dwordx4 v11, s[36:39], s41 offen offset:0 lds
    buffer_load_dwordx4 v12, s[36:39], s41 offen offset:1024 lds
    s_add_u32 m0, s43, 0
    s_nop 0
    buffer_load_dwordx4 v5, s[32:35], s40 offen offset:3072 lds
    s_mov_b32 m0, 16384
    s_mov_b64 exec, s[46:47]
    buffer_load_dwordx4 v6, s[32:35], s40 offen lds
    s_mov_b64 exec, -1
    s_movk_i32 s40, 896
    s_mov_b32 s41, 2752512
    s_bfe_u32 s74, s2, 0x20003
    s_lshl2_add_u32 s74, s74, s70
    s_cmp_lg_u32 s74, 0
    s_cbranch_scc1 L_sig_13
    s_mov_b32 s60, s28
    s_mov_b32 s61, s29
    s_mov_b32 s62, 0x100
    s_mov_b32 s63, 0x20000
    s_and_b32 s74, s2, 3
    s_lshl_b32 s74, s74, 6
    s_mov_b64 exec, 1
    buffer_atomic_add v244, off, s[60:63], s74 sc1
    s_mov_b64 exec, -1
L_sig_13:
    s_load_dwordx2 s[90:91], s[16:17], s84 offset:60
    s_load_dwordx2 s[90:91], s[16:17], s84 offset:188
    s_load_dwordx2 s[90:91], s[16:17], s84 offset:316
    s_load_dwordx2 s[90:91], s[16:17], s84 offset:444
    s_waitcnt vmcnt(13)
    s_bitcmp1_b32 4, s87
    s_cbranch_scc1 L_mw_14
    s_waitcnt vmcnt(11)
L_mw_14:
    s_barrier
    s_add_u32 m0, s43, 41984
    s_nop 0
    buffer_load_dwordx4 v2, s[32:35], s40 offen offset:0 lds
    s_add_u32 m0, s44, 41984
    s_nop 0
    buffer_load_dwordx4 v7, s[36:39], s41 offen offset:0 lds
    buffer_load_dwordx4 v8, s[36:39], s41 offen offset:1024 lds
    s_add_u32 m0, s43, 41984
    s_nop 0
    buffer_load_dwordx4 v3, s[32:35], s40 offen offset:1024 lds
    s_add_u32 m0, s44, 50176
    s_nop 0
    buffer_load_dwordx4 v9, s[36:39], s41 offen offset:0 lds
    buffer_load_dwordx4 v10, s[36:39], s41 offen offset:1024 lds
    s_add_u32 m0, s43, 41984
    s_nop 0
    buffer_load_dwordx4 v4, s[32:35], s40 offen offset:2048 lds
    s_add_u32 m0, s44, 58368
    s_nop 0
    buffer_load_dwordx4 v11, s[36:39], s41 offen offset:0 lds
    buffer_load_dwordx4 v12, s[36:39], s41 offen offset:1024 lds
    s_add_u32 m0, s43, 41984
    s_nop 0
    buffer_load_dwordx4 v5, s[32:35], s40 offen offset:3072 lds
    s_mov_b32 m0, 58368
    s_mov_b64 exec, s[46:47]
    buffer_load_dwordx4 v6, s[32:35], s40 offen lds
    s_mov_b64 exec, -1
    s_movk_i32 s40, 1024
    s_mov_b32 s41, 3145728
    s_cmp_lg_u32 s87, 3
    s_cbranch_scc1 L_stg_15
    s_add_u32 s6, s89, 3932160
    s_mov_b32 exec_lo, 0x770077
    s_mov_b32 exec_hi, 0x770077
    s_bfe_u32 s7, s89, 0x30007
    s_cmp_lg_u32 s7, 1
    s_cbranch_scc1 L_wx3_16
    buffer_load_dword v250, v252, s[36:39], s6 offen offset:256
L_wx3_16:
    buffer_load_dword v250, v252, s[36:39], s6 offen
    s_mov_b32 exec_lo, 0xf0f0f0f
    s_mov_b32 exec_hi, 0
    buffer_load_dword v250, v251, s[32:35], s88 offen offset:1280
    s_mov_b64 exec, -1
L_stg_15:
    s_bfe_u32 s74, s2, 0x20003
    s_lshl2_add_u32 s74, s74, s70
    s_cmp_lg_u32 s74, 4
    s_cbranch_scc1 L_sig_17
    s_mov_b32 s60, s28
    s_mov_b32 s61, s29
    s_mov_b32 s62, 0x100
    s_mov_b32 s63, 0x20000
    s_and_b32 s74, s2, 3
    s_lshl_b32 s74, s74, 6
    s_mov_b64 exec, 1
    buffer_atomic_add v244, off, s[60:63], s74 sc1
    s_mov_b64 exec, -1
L_sig_17:
    s_load_dwordx2 s[90:91], s[16:17], s84 offset:572
    s_load_dwordx2 s[90:91], s[16:17], s84 offset:700
    s_load_dwordx2 s[90:91], s[16:17], s84 offset:828
    s_load_dwordx2 s[90:91], s[16:17], s84 offset:956
    s_waitcnt vmcnt(13)
    s_bitcmp1_b32 8, s87
    s_cbranch_scc1 L_mw_18
    s_waitcnt vmcnt(11)
L_mw_18:
    s_barrier
    s_add_u32 m0, s43, 83968
    s_nop 0
    buffer_load_dwordx4 v2, s[32:35], s40 offen offset:0 lds
    s_add_u32 m0, s44, 83968
    s_nop 0
    buffer_load_dwordx4 v7, s[36:39], s41 offen offset:0 lds
    buffer_load_dwordx4 v8, s[36:39], s41 offen offset:1024 lds
    s_add_u32 m0, s43, 83968
    s_nop 0
    buffer_load_dwordx4 v3, s[32:35], s40 offen offset:1024 lds
    s_add_u32 m0, s44, 92160
    s_nop 0
    buffer_load_dwordx4 v9, s[36:39], s41 offen offset:0 lds
    buffer_load_dwordx4 v10, s[36:39], s41 offen offset:1024 lds
    s_add_u32 m0, s43, 83968
    s_nop 0
    buffer_load_dwordx4 v4, s[32:35], s40 offen offset:2048 lds
    s_add_u32 m0, s44, 100352
    s_nop 0
    buffer_load_dwordx4 v11, s[36:39], s41 offen offset:0 lds
    buffer_load_dwordx4 v12, s[36:39], s41 offen offset:1024 lds
    s_add_u32 m0, s43, 83968
    s_nop 0
    buffer_load_dwordx4 v5, s[32:35], s40 offen offset:3072 lds
    s_mov_b32 m0, 100352
    s_mov_b64 exec, s[46:47]
    buffer_load_dwordx4 v6, s[32:35], s40 offen lds
    s_mov_b64 exec, -1
    s_movk_i32 s40, 1152
    s_mov_b32 s41, 3538944
    s_bfe_u32 s74, s2, 0x20003
    s_lshl2_add_u32 s74, s74, s70
    s_cmp_lg_u32 s74, 8
    s_cbranch_scc1 L_sig_19
    s_mov_b32 s60, s28
    s_mov_b32 s61, s29
    s_mov_b32 s62, 0x100
    s_mov_b32 s63, 0x20000
    s_and_b32 s74, s2, 3
    s_lshl_b32 s74, s74, 6
    s_mov_b64 exec, 1
    buffer_atomic_add v244, off, s[60:63], s74 sc1
    s_mov_b64 exec, -1
L_sig_19:
    s_load_dwordx2 s[90:91], s[16:17], s84 offset:1084
    s_load_dwordx2 s[90:91], s[16:17], s84 offset:1212
    s_load_dwordx2 s[90:91], s[16:17], s84 offset:1340
    s_load_dwordx2 s[90:91], s[16:17], s84 offset:1468
    s_waitcnt vmcnt(13)
    s_bitcmp1_b32 8, s87
    s_cbranch_scc1 L_mw_20
    s_waitcnt vmcnt(11)
L_mw_20:
    s_barrier
    s_add_u32 m0, s43, 0
    s_nop 0
    buffer_load_dwordx4 v2, s[32:35], s40 offen offset:0 lds
    s_add_u32 m0, s44, 0
    s_nop 0
    buffer_load_dwordx4 v7, s[36:39], s41 offen offset:0 lds
    buffer_load_dwordx4 v8, s[36:39], s41 offen offset:1024 lds
    s_add_u32 m0, s43, 0
    s_nop 0
    buffer_load_dwordx4 v3, s[32:35], s40 offen offset:1024 lds
    s_add_u32 m0, s44, 8192
    s_nop 0
    buffer_load_dwordx4 v9, s[36:39], s41 offen offset:0 lds
    buffer_load_dwordx4 v10, s[36:39], s41 offen offset:1024 lds
    s_add_u32 m0, s43, 0
    s_nop 0
    buffer_load_dwordx4 v4, s[32:35], s40 offen offset:2048 lds
    s_add_u32 m0, s44, 16384
    s_nop 0
    buffer_load_dwordx4 v11, s[36:39], s41 offen offset:0 lds
    buffer_load_dwordx4 v12, s[36:39], s41 offen offset:1024 lds
    s_add_u32 m0, s43, 0
    s_nop 0
    buffer_load_dwordx4 v5, s[32:35], s40 offen offset:3072 lds
    s_mov_b32 m0, 16384
    s_mov_b64 exec, s[46:47]
    buffer_load_dwordx4 v6, s[32:35], s40 offen lds
    s_mov_b64 exec, -1
    s_movk_i32 s40, 1280
    s_mov_b32 s41, 3932160
    s_cmp_lg_u32 s87, 0
    s_cbranch_scc1 L_stg_21
    s_add_u32 s6, s89, 4718592
    s_mov_b32 exec_lo, 0x770077
    s_mov_b32 exec_hi, 0x770077
    s_bfe_u32 s7, s89, 0x30007
    s_cmp_lg_u32 s7, 1
    s_cbranch_scc1 L_wx3_22
    buffer_load_dword v250, v252, s[36:39], s6 offen offset:256
L_wx3_22:
    buffer_load_dword v250, v252, s[36:39], s6 offen
    s_mov_b32 exec_lo, 0xf0f0f0f
    s_mov_b32 exec_hi, 0
    buffer_load_dword v250, v251, s[32:35], s88 offen offset:1536
    s_mov_b64 exec, -1
L_stg_21:
    s_bfe_u32 s74, s2, 0x20003
    s_lshl2_add_u32 s74, s74, s70
    s_cmp_lg_u32 s74, 12
    s_cbranch_scc1 L_sig_23
    s_mov_b32 s60, s28
    s_mov_b32 s61, s29
    s_mov_b32 s62, 0x100
    s_mov_b32 s63, 0x20000
    s_and_b32 s74, s2, 3
    s_lshl_b32 s74, s74, 6
    s_mov_b64 exec, 1
    buffer_atomic_add v244, off, s[60:63], s74 sc1
    s_mov_b64 exec, -1
L_sig_23:
    s_load_dwordx2 s[90:91], s[16:17], s84 offset:1596
    s_load_dwordx2 s[90:91], s[16:17], s84 offset:1724
    s_load_dwordx2 s[90:91], s[16:17], s84 offset:1852
    s_load_dwordx2 s[90:91], s[16:17], s84 offset:1980
    s_waitcnt vmcnt(13)
    s_bitcmp1_b32 1, s87
    s_cbranch_scc1 L_mw_24
    s_waitcnt vmcnt(11)
L_mw_24:
    s_barrier
    s_add_u32 m0, s43, 41984
    s_nop 0
    buffer_load_dwordx4 v2, s[32:35], s40 offen offset:0 lds
    s_add_u32 m0, s44, 41984
    s_nop 0
    buffer_load_dwordx4 v7, s[36:39], s41 offen offset:0 lds
    buffer_load_dwordx4 v8, s[36:39], s41 offen offset:1024 lds
    s_add_u32 m0, s43, 41984
    s_nop 0
    buffer_load_dwordx4 v3, s[32:35], s40 offen offset:1024 lds
    s_add_u32 m0, s44, 50176
    s_nop 0
    buffer_load_dwordx4 v9, s[36:39], s41 offen offset:0 lds
    buffer_load_dwordx4 v10, s[36:39], s41 offen offset:1024 lds
    s_add_u32 m0, s43, 41984
    s_nop 0
    buffer_load_dwordx4 v4, s[32:35], s40 offen offset:2048 lds
    s_add_u32 m0, s44, 58368
    s_nop 0
    buffer_load_dwordx4 v11, s[36:39], s41 offen offset:0 lds
    buffer_load_dwordx4 v12, s[36:39], s41 offen offset:1024 lds
    s_add_u32 m0, s43, 41984
    s_nop 0
    buffer_load_dwordx4 v5, s[32:35], s40 offen offset:3072 lds
    s_mov_b32 m0, 58368
    s_mov_b64 exec, s[46:47]
    buffer_load_dwordx4 v6, s[32:35], s40 offen lds
    s_mov_b64 exec, -1
    s_movk_i32 s40, 1408
    s_mov_b32 s41, 4325376
    s_load_dwordx2 s[90:91], s[16:17], s84 offset:2108
    s_load_dwordx2 s[90:91], s[16:17], s84 offset:2236
    s_load_dwordx2 s[90:91], s[16:17], s84 offset:2364
    s_load_dwordx2 s[90:91], s[16:17], s84 offset:2492
    s_waitcnt vmcnt(13)
    s_bitcmp1_b32 1, s87
    s_cbranch_scc1 L_mw_25
    s_waitcnt vmcnt(11)
L_mw_25:
    s_barrier
    s_add_u32 m0, s43, 83968
    s_nop 0
    buffer_load_dwordx4 v2, s[32:35], s40 offen offset:0 lds
    s_add_u32 m0, s44, 83968
    s_nop 0
    buffer_load_dwordx4 v7, s[36:39], s41 offen offset:0 lds
    buffer_load_dwordx4 v8, s[36:39], s41 offen offset:1024 lds
    s_add_u32 m0, s43, 83968
    s_nop 0
    buffer_load_dwordx4 v3, s[32:35], s40 offen offset:1024 lds
    s_add_u32 m0, s44, 92160
    s_nop 0
    buffer_load_dwordx4 v9, s[36:39], s41 offen offset:0 lds
    buffer_load_dwordx4 v10, s[36:39], s41 offen offset:1024 lds
    s_add_u32 m0, s43, 83968
    s_nop 0
    buffer_load_dwordx4 v4, s[32:35], s40 offen offset:2048 lds
    s_add_u32 m0, s44, 100352
    s_nop 0
    buffer_load_dwordx4 v11, s[36:39], s41 offen offset:0 lds
    buffer_load_dwordx4 v12, s[36:39], s41 offen offset:1024 lds
    s_add_u32 m0, s43, 83968
    s_nop 0
    buffer_load_dwordx4 v5, s[32:35], s40 offen offset:3072 lds
    s_mov_b32 m0, 100352
    s_mov_b64 exec, s[46:47]
    buffer_load_dwordx4 v6, s[32:35], s40 offen lds
    s_mov_b64 exec, -1
    s_movk_i32 s40, 1536
    s_mov_b32 s41, 4718592
    s_cmp_lg_u32 s87, 1
    s_cbranch_scc1 L_stg_26
    s_add_u32 s6, s89, 5505024
    s_mov_b32 exec_lo, 0x770077
    s_mov_b32 exec_hi, 0x770077
    s_bfe_u32 s7, s89, 0x30007
    s_cmp_lg_u32 s7, 1
    s_cbranch_scc1 L_wx3_27
    buffer_load_dword v250, v252, s[36:39], s6 offen offset:256
L_wx3_27:
    buffer_load_dword v250, v252, s[36:39], s6 offen
    s_mov_b32 exec_lo, 0xf0f0f0f
    s_mov_b32 exec_hi, 0
    buffer_load_dword v250, v251, s[32:35], s88 offen offset:1792
    s_mov_b64 exec, -1
L_stg_26:
    s_load_dwordx2 s[90:91], s[16:17], s84 offset:2620
    s_load_dwordx2 s[90:91], s[16:17], s84 offset:2748
    s_load_dwordx2 s[90:91], s[16:17], s84 offset:2876
    s_load_dwordx2 s[90:91], s[16:17], s84 offset:3004
    s_waitcnt vmcnt(13)
    s_bitcmp1_b32 2, s87
    s_cbranch_scc1 L_mw_28
    s_waitcnt vmcnt(11)
L_mw_28:
    s_barrier
    s_add_u32 m0, s43, 0
    s_nop 0
    buffer_load_dwordx4 v2, s[32:35], s40 offen offset:0 lds
    s_add_u32 m0, s44, 0
    s_nop 0
    buffer_load_dwordx4 v7, s[36:39], s41 offen offset:0 lds
    buffer_load_dwordx4 v8, s[36:39], s41 offen offset:1024 lds
    s_add_u32 m0, s43, 0
    s_nop 0
    buffer_load_dwordx4 v3, s[32:35], s40 offen offset:1024 lds
    s_add_u32 m0, s44, 8192
    s_nop 0
    buffer_load_dwordx4 v9, s[36:39], s41 offen offset:0 lds
    buffer_load_dwordx4 v10, s[36:39], s41 offen offset:1024 lds
    s_add_u32 m0, s43, 0
    s_nop 0
    buffer_load_dwordx4 v4, s[32:35], s40 offen offset:2048 lds
    s_add_u32 m0, s44, 16384
    s_nop 0
    buffer_load_dwordx4 v11, s[36:39], s41 offen offset:0 lds
    buffer_load_dwordx4 v12, s[36:39], s41 offen offset:1024 lds
    s_add_u32 m0, s43, 0
    s_nop 0
    buffer_load_dwordx4 v5, s[32:35], s40 offen offset:3072 lds
    s_mov_b32 m0, 16384
    s_mov_b64 exec, s[46:47]
    buffer_load_dwordx4 v6, s[32:35], s40 offen lds
    s_mov_b64 exec, -1
    s_movk_i32 s40, 1664
    s_mov_b32 s41, 5111808
    s_load_dwordx2 s[90:91], s[16:17], s84 offset:3132
    s_load_dwordx2 s[90:91], s[16:17], s84 offset:3260
    s_load_dwordx2 s[90:91], s[16:17], s84 offset:3388
    s_load_dwordx2 s[90:91], s[16:17], s84 offset:3516
    s_waitcnt vmcnt(13)
    s_bitcmp1_b32 2, s87
    s_cbranch_scc1 L_mw_29
    s_waitcnt vmcnt(11)
L_mw_29:
    s_barrier
    s_add_u32 m0, s43, 41984
    s_nop 0
    buffer_load_dwordx4 v2, s[32:35], s40 offen offset:0 lds
    s_add_u32 m0, s44, 41984
    s_nop 0
    buffer_load_dwordx4 v7, s[36:39], s41 offen offset:0 lds
    buffer_load_dwordx4 v8, s[36:39], s41 offen offset:1024 lds
    s_add_u32 m0, s43, 41984
    s_nop 0
    buffer_load_dwordx4 v3, s[32:35], s40 offen offset:1024 lds
    s_add_u32 m0, s44, 50176
    s_nop 0
    buffer_load_dwordx4 v9, s[36:39], s41 offen offset:0 lds
    buffer_load_dwordx4 v10, s[36:39], s41 offen offset:1024 lds
    s_add_u32 m0, s43, 41984
    s_nop 0
    buffer_load_dwordx4 v4, s[32:35], s40 offen offset:2048 lds
    s_add_u32 m0, s44, 58368
    s_nop 0
    buffer_load_dwordx4 v11, s[36:39], s41 offen offset:0 lds
    buffer_load_dwordx4 v12, s[36:39], s41 offen offset:1024 lds
    s_add_u32 m0, s43, 41984
    s_nop 0
    buffer_load_dwordx4 v5, s[32:35], s40 offen offset:3072 lds
    s_mov_b32 m0, 58368
    s_mov_b64 exec, s[46:47]
    buffer_load_dwordx4 v6, s[32:35], s40 offen lds
    s_mov_b64 exec, -1
    s_movk_i32 s40, 1792
    s_mov_b32 s41, 5505024
    s_load_dwordx2 s[90:91], s[16:17], s84 offset:3644
    s_load_dwordx2 s[90:91], s[16:17], s84 offset:3772
    s_load_dwordx2 s[90:91], s[16:17], s84 offset:3900
    s_load_dwordx2 s[90:91], s[16:17], s84 offset:4028
    s_waitcnt vmcnt(11)
    s_barrier
    s_add_u32 m0, s43, 83968
    s_nop 0
    buffer_load_dwordx4 v2, s[32:35], s40 offen offset:0 lds
    s_add_u32 m0, s44, 83968
    s_nop 0
    buffer_load_dwordx4 v7, s[36:39], s41 offen offset:0 lds
    buffer_load_dwordx4 v8, s[36:39], s41 offen offset:1024 lds
    s_add_u32 m0, s43, 83968
    s_nop 0
    buffer_load_dwordx4 v3, s[32:35], s40 offen offset:1024 lds
    s_add_u32 m0, s44, 92160
    s_nop 0
    buffer_load_dwordx4 v9, s[36:39], s41 offen offset:0 lds
    buffer_load_dwordx4 v10, s[36:39], s41 offen offset:1024 lds
    s_add_u32 m0, s43, 83968
    s_nop 0
    buffer_load_dwordx4 v4, s[32:35], s40 offen offset:2048 lds
    s_add_u32 m0, s44, 100352
    s_nop 0
    buffer_load_dwordx4 v11, s[36:39], s41 offen offset:0 lds
    buffer_load_dwordx4 v12, s[36:39], s41 offen offset:1024 lds
    s_add_u32 m0, s43, 83968
    s_nop 0
    buffer_load_dwordx4 v5, s[32:35], s40 offen offset:3072 lds
    s_mov_b32 m0, 100352
    s_mov_b64 exec, s[46:47]
    buffer_load_dwordx4 v6, s[32:35], s40 offen lds
    s_mov_b64 exec, -1
    s_movk_i32 s40, 1920
    s_mov_b32 s41, 5898240
    s_waitcnt vmcnt(11)
    s_barrier
    s_load_dword s4, s[28:29], 0
    s_load_dword s5, s[28:29], 64
    s_load_dword s6, s[28:29], 128
    s_load_dword s7, s[28:29], 192
    s_add_u32 m0, s43, 0
    s_nop 0
    buffer_load_dwordx4 v2, s[32:35], s40 offen offset:0 lds
    s_add_u32 m0, s44, 0
    s_nop 0
    buffer_load_dwordx4 v7, s[36:39], s41 offen offset:0 lds
    buffer_load_dwordx4 v8, s[36:39], s41 offen offset:1024 lds
    s_add_u32 m0, s43, 0
    s_nop 0
    buffer_load_dwordx4 v3, s[32:35], s40 offen offset:1024 lds
    s_add_u32 m0, s44, 8192
    s_nop 0
    buffer_load_dwordx4 v9, s[36:39], s41 offen offset:0 lds
    buffer_load_dwordx4 v10, s[36:39], s41 offen offset:1024 lds
    s_add_u32 m0, s43, 0
    s_nop 0
    buffer_load_dwordx4 v4, s[32:35], s40 offen offset:2048 lds
    s_add_u32 m0, s44, 16384
    s_nop 0
    buffer_load_dwordx4 v11, s[36:39], s41 offen offset:0 lds
    buffer_load_dwordx4 v12, s[36:39], s41 offen offset:1024 lds
    s_add_u32 m0, s43, 0
    s_nop 0
    buffer_load_dwordx4 v5, s[32:35], s40 offen offset:3072 lds
    s_mov_b32 m0, 16384
    s_mov_b64 exec, s[46:47]
    buffer_load_dwordx4 v6, s[32:35], s40 offen lds
    s_mov_b64 exec, -1
    s_movk_i32 s40, 2048
    s_mov_b32 s41, 6291456
    s_mov_b32 s60, s8
    s_mov_b32 s61, s9
    s_mov_b32 s62, 0x400000
    s_mov_b32 s63, 0x20000
    s_movk_i32 s75, 8192
    buffer_load_dwordx4 v[208:211], v225, s[60:63], 0 offen offset:0 nt
    buffer_load_dwordx4 v[212:215], v225, s[60:63], 0 offen offset:2048 nt
    buffer_load_dwordx4 v[216:219], v225, s[60:63], s75 offen offset:0 nt
    buffer_load_dwordx4 v[220:223], v225, s[60:63], s75 offen offset:2048 nt
    s_cmp_lg_u32 s70, 0
    s_cbranch_scc1 L_pc_done_32
    s_waitcnt lgkmcnt(0)
    s_min_u32 s4, s4, s5
    s_min_u32 s6, s6, s7
    s_min_u32 s4, s4, s6
    s_cmp_ge_u32 s4, 64
    s_cbranch_scc1 L_pc_done_32
    s_mov_b32 s60, s28
    s_mov_b32 s61, s29
    s_mov_b32 s62, 0x100
    s_mov_b32 s63, 0x20000
    v_lshlrev_b32 v20, 6, v0
    s_mov_b32 s74, 131072
    s_mov_b64 exec, 0xf
L_pc_loop_33:
    buffer_load_dword v21, v20, s[60:63], 0 offen sc1
    s_waitcnt vmcnt(0)
    v_cmp_gt_u32 vcc, 64, v21
    s_cbranch_vccz L_pc_done_32
    s_sleep 4
    s_sub_u32 s74, s74, 1
    s_cbranch_scc0 L_pc_loop_33
L_pc_done_32:
    s_mov_b64 exec, -1
    s_waitcnt vmcnt(15)
    s_barrier
    s_waitcnt vmcnt(4)
    s_mov_b64 exec, 1
    ds_add_u32 v227, v244 offset:24
    s_mov_b64 exec, -1
    s_add_u32 s56, s30, s85
    s_addc_u32 s57, s31, 0
    s_movk_i32 s58, 4096
    s_mov_b32 s59, 0x20000
    s_add_u32 m0, s81, 0
    s_nop 0
    buffer_load_dwordx4 v224, s[56:59], 0 offen offset:0 sc1 lds
    buffer_load_dwordx4 v224, s[56:59], 0 offen offset:1024 sc1 lds
    buffer_load_dwordx4 v224, s[56:59], 0 offen offset:2048 sc1 lds
    buffer_load_dwordx4 v224, s[56:59], 0 offen offset:3072 sc1 lds
    s_add_u32 m0, s81, 4572
    s_nop 0
    buffer_load_dwordx4 v224, s[56:59], 0 offen offset:0 sc1 lds
    buffer_load_dwordx4 v224, s[56:59], 0 offen offset:1024 sc1 lds
    buffer_load_dwordx4 v224, s[56:59], 0 offen offset:2048 sc1 lds
    buffer_load_dwordx4 v224, s[56:59], 0 offen offset:3072 sc1 lds
    s_add_u32 s56, s16, s84
    s_addc_u32 s57, s17, 0
    s_movk_i32 s58, 4096
    s_mov_b32 s59, 0x20000
    s_add_u32 m0, s80, 64
    v_mov_b32 v180, 0
    v_mov_b32 v181, 0
    v_mov_b32 v182, 0
    v_mov_b32 v183, 0
    buffer_load_dwordx4 v224, s[56:59], 0 offen offset:0 lds
    buffer_load_dwordx4 v224, s[56:59], 0 offen offset:1024 lds
    buffer_load_dwordx4 v224, s[56:59], 0 offen offset:2048 lds
    buffer_load_dwordx4 v224, s[56:59], 0 offen offset:3072 lds
    s_add_u32 m0, s80, 4304
    s_mov_b64 exec, 0x100
    buffer_load_dwordx4 v[180:183], off, s[56:59], 0
    s_mov_b64 exec, -1
    buffer_load_dwordx4 v224, s[56:59], 14 offen offset:0 lds
    buffer_load_dwordx4 v224, s[56:59], 14 offen offset:1024 lds
    buffer_load_dwordx4 v224, s[56:59], 14 offen offset:2048 lds
    buffer_load_dwordx4 v224, s[56:59], 14 offen offset:3072 lds
    v_lshrrev_b32 v234, 5, v0
    v_mul_u32_u24 v234, 4064, v234
    v_add3_u32 v234, v234, v224, s81
    s_mov_b32 exec_lo, 0xfffffff
    s_mov_b32 exec_hi, 0xfffffff
    ds_write_b128 v234, v[228:231] offset:4096
    s_mov_b64 exec, 1
    ds_write_b32 v234, v228 offset:8668
    s_mov_b64 exec, -1
    s_setprio 3
    s_waitcnt vmcnt(9)
    s_mov_b32 s60, s24
    s_mov_b32 s61, s25
    s_mov_b32 s62, 0x200000
    s_mov_b32 s63, 0x20000
    s_lshr_b32 s74, s2, 3
    s_lshl2_add_u32 s74, s74, s70
    s_bfe_u32 s75, s2, 0x10002
    s_lshl4_add_u32 s74, s74, s75
    s_lshl_b32 s74, s74, 10
    v_lshrrev_b32 v234, 3, v0
    v_and_b32 v235, 7, v0
    v_lshlrev_b32 v235, 7, v235
    v_lshl_add_u32 v234, v234, 11, v235
    buffer_load_dword v250, v234, s[60:63], s74 offen
    s_waitcnt vmcnt(1)
    v_cmp_lt_u32 vcc, 3, v0
    v_mov_b32 v188, 4160
    v_lshlrev_b32 v184, 16, v180
    v_cndmask_b32 v188, 0, v188, vcc
    v_alignbit_b32 v185, v181, v180, 16
    v_alignbit_b32 v186, v182, v181, 16
    v_alignbit_b32 v187, v183, v182, 16
    v_add3_u32 v188, v188, v224, s80
    s_mov_b64 exec, 0x1ff
    ds_write_b128 v188, v[184:187]
    s_mov_b64 exec, -1
    ds_read_b128 v[112:115], v233 offset:3584
    ds_read_b128 v[116:119], v233 offset:3072
    ds_read_b128 v[120:123], v233 offset:2560
    ds_read_b128 v[124:127], v233 offset:2048
    ds_read_b128 v[128:131], v233 offset:1536
    ds_read_b128 v[132:135], v233 offset:1024
    ds_read_b128 v[136:139], v233 offset:512
    ds_read_b128 v[140:143], v233 offset:0
    ds_read_b64 v[48:49], v232 offset:0
    ds_read_b64 v[50:51], v232 offset:8
    ds_read_b64 v[52:53], v232 offset:512
    ds_read_b64 v[54:55], v232 offset:520
    ds_read_b64 v[56:57], v232 offset:1024
    ds_read_b64 v[58:59], v232 offset:1032
    ds_read_b64 v[60:61], v232 offset:1536
    ds_read_b64 v[62:63], v232 offset:1544
    ds_read_b64 v[64:65], v232 offset:2048
    ds_read_b64 v[66:67], v232 offset:2056
    ds_read_b64 v[68:69], v232 offset:2560
    ds_read_b64 v[70:71], v232 offset:2568
    ds_read_b64 v[72:73], v232 offset:3072
    ds_read_b64 v[74:75], v232 offset:3080
    ds_read_b64 v[76:77], v232 offset:3584
    ds_read_b64 v[78:79], v232 offset:3592
    s_setprio 1
    s_mov_b32 s74, 3
    s_waitcnt lgkmcnt(15)
    v_mfma_f32_16x16x32_bf16 v[16:19], v[240:243], v[112:115], 0
    v_mfma_f32_16x16x32_bf16 v[20:23], v[240:243], v[116:119], 0
    v_mfma_f32_16x16x32_bf16 v[24:27], v[240:243], v[120:123], 0
    v_mfma_f32_16x16x32_bf16 v[28:31], v[240:243], v[124:127], 0
    v_mfma_f32_16x16x32_bf16 v[32:35], v[240:243], v[128:131], 0
    v_mfma_f32_16x16x32_bf16 v[36:39], v[240:243], v[132:135], 0
    v_mfma_f32_16x16x32_bf16 v[40:43], v[240:243], v[136:139], 0
    v_mfma_f32_16x16x32_bf16 v[44:47], v[240:243], v[140:143], 0
    s_waitcnt lgkmcnt(0)
L_conv:
    v_mfma_f32_16x16x32_bf16 v[16:19], v[48:51], v[112:115], v[16:19]
    ds_read_b128 v[144:147], v233 offset:3648
    v_mfma_f32_16x16x32_bf16 v[20:23], v[48:51], v[116:119], v[20:23]
    ds_read_b64 v[80:81], v232 offset:64
    v_mfma_f32_16x16x32_bf16 v[20:23], v[52:55], v[112:115], v[20:23]
    ds_read_b64 v[82:83], v232 offset:72
    v_mfma_f32_16x16x32_bf16 v[24:27], v[48:51], v[120:123], v[24:27]
    ds_read_b128 v[148:151], v233 offset:3136
    v_mfma_f32_16x16x32_bf16 v[24:27], v[52:55], v[116:119], v[24:27]
    ds_read_b64 v[84:85], v232 offset:576
    v_mfma_f32_16x16x32_bf16 v[24:27], v[56:59], v[112:115], v[24:27]
    ds_read_b64 v[86:87], v232 offset:584
    v_mfma_f32_16x16x32_bf16 v[28:31], v[48:51], v[124:127], v[28:31]
    ds_read_b128 v[152:155], v233 offset:2624
    v_mfma_f32_16x16x32_bf16 v[28:31], v[52:55], v[120:123], v[28:31]
    ds_read_b64 v[88:89], v232 offset:1088
    v_mfma_f32_16x16x32_bf16 v[28:31], v[56:59], v[116:119], v[28:31]
    ds_read_b64 v[90:91], v232 offset:1096
    v_mfma_f32_16x16x32_bf16 v[28:31], v[60:63], v[112:115], v[28:31]
    ds_read_b128 v[156:159], v233 offset:2112
    v_mfma_f32_16x16x32_bf16 v[32:35], v[48:51], v[128:131], v[32:35]
    ds_read_b64 v[92:93], v232 offset:1600
    v_mfma_f32_16x16x32_bf16 v[32:35], v[52:55], v[124:127], v[32:35]
    ds_read_b64 v[94:95], v232 offset:1608
    v_mfma_f32_16x16x32_bf16 v[32:35], v[56:59], v[120:123], v[32:35]
    ds_read_b128 v[160:163], v233 offset:1600
    v_mfma_f32_16x16x32_bf16 v[32:35], v[60:63], v[116:119], v[32:35]
    ds_read_b64 v[96:97], v232 offset:2112
    v_mfma_f32_16x16x32_bf16 v[32:35], v[64:67], v[112:115], v[32:35]
    ds_read_b64 v[98:99], v232 offset:2120
    v_mfma_f32_16x16x32_bf16 v[36:39], v[48:51], v[132:135], v[36:39]
    ds_read_b128 v[164:167], v233 offset:1088
    v_mfma_f32_16x16x32_bf16 v[36:39], v[52:55], v[128:131], v[36:39]
    ds_read_b64 v[100:101], v232 offset:2624
    v_mfma_f32_16x16x32_bf16 v[36:39], v[56:59], v[124:127], v[36:39]
    ds_read_b64 v[102:103], v232 offset:2632
    v_mfma_f32_16x16x32_bf16 v[36:39], v[60:63], v[120:123], v[36:39]
    ds_read_b128 v[168:171], v233 offset:576
    v_mfma_f32_16x16x32_bf16 v[36:39], v[64:67], v[116:119], v[36:39]
    ds_read_b64 v[104:105], v232 offset:3136
    v_mfma_f32_16x16x32_bf16 v[36:39], v[68:71], v[112:115], v[36:39]
    ds_read_b64 v[106:107], v232 offset:3144
    v_mfma_f32_16x16x32_bf16 v[40:43], v[48:51], v[136:139], v[40:43]
    ds_read_b128 v[172:175], v233 offset:64
    v_mfma_f32_16x16x32_bf16 v[40:43], v[52:55], v[132:135], v[40:43]
    ds_read_b64 v[108:109], v232 offset:3648
    v_mfma_f32_16x16x32_bf16 v[40:43], v[56:59], v[128:131], v[40:43]
    ds_read_b64 v[110:111], v232 offset:3656
    v_mfma_f32_16x16x32_bf16 v[40:43], v[60:63], v[124:127], v[40:43]
    v_mfma_f32_16x16x32_bf16 v[40:43], v[64:67], v[120:123], v[40:43]
    v_mfma_f32_16x16x32_bf16 v[40:43], v[68:71], v[116:119], v[40:43]
    v_mfma_f32_16x16x32_bf16 v[40:43], v[72:75], v[112:115], v[40:43]
    v_mfma_f32_16x16x32_bf16 v[44:47], v[48:51], v[140:143], v[44:47]
    v_mfma_f32_16x16x32_bf16 v[44:47], v[52:55], v[136:139], v[44:47]
    v_mfma_f32_16x16x32_bf16 v[44:47], v[56:59], v[132:135], v[44:47]
    v_mfma_f32_16x16x32_bf16 v[44:47], v[60:63], v[128:131], v[44:47]
    v_mfma_f32_16x16x32_bf16 v[44:47], v[64:67], v[124:127], v[44:47]
    v_mfma_f32_16x16x32_bf16 v[44:47], v[68:71], v[120:123], v[44:47]
    v_mfma_f32_16x16x32_bf16 v[44:47], v[72:75], v[116:119], v[44:47]
    v_mfma_f32_16x16x32_bf16 v[44:47], v[76:79], v[112:115], v[44:47]
    s_waitcnt lgkmcnt(0)
    v_mfma_f32_16x16x32_bf16 v[16:19], v[80:83], v[144:147], v[16:19]
    ds_read_b128 v[112:115], v233 offset:3712
    v_mfma_f32_16x16x32_bf16 v[20:23], v[80:83], v[148:151], v[20:23]
    ds_read_b64 v[48:49], v232 offset:128
    v_mfma_f32_16x16x32_bf16 v[20:23], v[84:87], v[144:147], v[20:23]
    ds_read_b64 v[50:51], v232 offset:136
    v_mfma_f32_16x16x32_bf16 v[24:27], v[80:83], v[152:155], v[24:27]
    ds_read_b128 v[116:119], v233 offset:3200
    v_mfma_f32_16x16x32_bf16 v[24:27], v[84:87], v[148:151], v[24:27]
    ds_read_b64 v[52:53], v232 offset:640
    v_mfma_f32_16x16x32_bf16 v[24:27], v[88:91], v[144:147], v[24:27]
    ds_read_b64 v[54:55], v232 offset:648
    v_mfma_f32_16x16x32_bf16 v[28:31], v[80:83], v[156:159], v[28:31]
    ds_read_b128 v[120:123], v233 offset:2688
    v_mfma_f32_16x16x32_bf16 v[28:31], v[84:87], v[152:155], v[28:31]
    ds_read_b64 v[56:57], v232 offset:1152
    v_mfma_f32_16x16x32_bf16 v[28:31], v[88:91], v[148:151], v[28:31]
    ds_read_b64 v[58:59], v232 offset:1160
    v_mfma_f32_16x16x32_bf16 v[28:31], v[92:95], v[144:147], v[28:31]
    ds_read_b128 v[124:127], v233 offset:2176
    v_mfma_f32_16x16x32_bf16 v[32:35], v[80:83], v[160:163], v[32:35]
    ds_read_b64 v[60:61], v232 offset:1664
    v_mfma_f32_16x16x32_bf16 v[32:35], v[84:87], v[156:159], v[32:35]
    ds_read_b64 v[62:63], v232 offset:1672
    v_mfma_f32_16x16x32_bf16 v[32:35], v[88:91], v[152:155], v[32:35]
    ds_read_b128 v[128:131], v233 offset:1664
    v_mfma_f32_16x16x32_bf16 v[32:35], v[92:95], v[148:151], v[32:35]
    ds_read_b64 v[64:65], v232 offset:2176
    v_mfma_f32_16x16x32_bf16 v[32:35], v[96:99], v[144:147], v[32:35]
    ds_read_b64 v[66:67], v232 offset:2184
    v_mfma_f32_16x16x32_bf16 v[36:39], v[80:83], v[164:167], v[36:39]
    ds_read_b128 v[132:135], v233 offset:1152
    v_mfma_f32_16x16x32_bf16 v[36:39], v[84:87], v[160:163], v[36:39]
    ds_read_b64 v[68:69], v232 offset:2688
    v_mfma_f32_16x16x32_bf16 v[36:39], v[88:91], v[156:159], v[36:39]
    ds_read_b64 v[70:71], v232 offset:2696
    v_mfma_f32_16x16x32_bf16 v[36:39], v[92:95], v[152:155], v[36:39]
    ds_read_b128 v[136:139], v233 offset:640
    v_mfma_f32_16x16x32_bf16 v[36:39], v[96:99], v[148:151], v[36:39]
    ds_read_b64 v[72:73], v232 offset:3200
    v_mfma_f32_16x16x32_bf16 v[36:39], v[100:103], v[144:147], v[36:39]
    ds_read_b64 v[74:75], v232 offset:3208
    v_mfma_f32_16x16x32_bf16 v[40:43], v[80:83], v[168:171], v[40:43]
    ds_read_b128 v[140:143], v233 offset:128
    v_mfma_f32_16x16x32_bf16 v[40:43], v[84:87], v[164:167], v[40:43]
    ds_read_b64 v[76:77], v232 offset:3712
    v_mfma_f32_16x16x32_bf16 v[40:43], v[88:91], v[160:163], v[40:43]
    ds_read_b64 v[78:79], v232 offset:3720
    v_mfma_f32_16x16x32_bf16 v[40:43], v[92:95], v[156:159], v[40:43]
    v_add_u32 v232, 128, v232
    v_mfma_f32_16x16x32_bf16 v[40:43], v[96:99], v[152:155], v[40:43]
    v_add_u32 v233, 128, v233
    v_mfma_f32_16x16x32_bf16 v[40:43], v[100:103], v[148:151], v[40:43]
    s_sub_u32 s74, s74, 1
    v_mfma_f32_16x16x32_bf16 v[40:43], v[104:107], v[144:147], v[40:43]
    s_cmp_lg_u32 s74, 0
    v_mfma_f32_16x16x32_bf16 v[44:47], v[80:83], v[172:175], v[44:47]
    v_mfma_f32_16x16x32_bf16 v[44:47], v[84:87], v[168:171], v[44:47]
    v_mfma_f32_16x16x32_bf16 v[44:47], v[88:91], v[164:167], v[44:47]
    v_mfma_f32_16x16x32_bf16 v[44:47], v[92:95], v[160:163], v[44:47]
    v_mfma_f32_16x16x32_bf16 v[44:47], v[96:99], v[156:159], v[44:47]
    v_mfma_f32_16x16x32_bf16 v[44:47], v[100:103], v[152:155], v[44:47]
    v_mfma_f32_16x16x32_bf16 v[44:47], v[104:107], v[148:151], v[44:47]
    v_mfma_f32_16x16x32_bf16 v[44:47], v[108:111], v[144:147], v[44:47]
    s_waitcnt lgkmcnt(0)
    s_cbranch_scc1 L_conv
    v_mfma_f32_16x16x32_bf16 v[16:19], v[48:51], v[112:115], v[16:19]
    ds_read_b128 v[144:147], v233 offset:3648
    ds_read_b64 v[80:81], v232 offset:64
    v_mfma_f32_16x16x32_bf16 v[20:23], v[48:51], v[116:119], v[20:23]
    ds_read_b64 v[82:83], v232 offset:72
    ds_read_b128 v[148:151], v233 offset:3136
    v_mfma_f32_16x16x32_bf16 v[20:23], v[52:55], v[112:115], v[20:23]
    ds_read_b64 v[84:85], v232 offset:576
    ds_read_b64 v[86:87], v232 offset:584
    v_mfma_f32_16x16x32_bf16 v[24:27], v[48:51], v[120:123], v[24:27]
    ds_read_b128 v[152:155], v233 offset:2624
    ds_read_b64 v[88:89], v232 offset:1088
    v_mfma_f32_16x16x32_bf16 v[24:27], v[52:55], v[116:119], v[24:27]
    ds_read_b64 v[90:91], v232 offset:1096
    ds_read_b128 v[156:159], v233 offset:2112
    v_mfma_f32_16x16x32_bf16 v[24:27], v[56:59], v[112:115], v[24:27]
    ds_read_b64 v[92:93], v232 offset:1600
    ds_read_b64 v[94:95], v232 offset:1608
    v_mfma_f32_16x16x32_bf16 v[28:31], v[48:51], v[124:127], v[28:31]
    ds_read_b128 v[160:163], v233 offset:1600
    ds_read_b64 v[96:97], v232 offset:2112
    v_mfma_f32_16x16x32_bf16 v[28:31], v[52:55], v[120:123], v[28:31]
    ds_read_b64 v[98:99], v232 offset:2120
    ds_read_b128 v[164:167], v233 offset:1088
    v_mfma_f32_16x16x32_bf16 v[28:31], v[56:59], v[116:119], v[28:31]
    ds_read_b64 v[100:101], v232 offset:2624
    ds_read_b64 v[102:103], v232 offset:2632
    v_mfma_f32_16x16x32_bf16 v[28:31], v[60:63], v[112:115], v[28:31]
    ds_read_b128 v[168:171], v233 offset:576
    ds_read_b64 v[104:105], v232 offset:3136
    v_mfma_f32_16x16x32_bf16 v[32:35], v[48:51], v[128:131], v[32:35]
    ds_read_b64 v[106:107], v232 offset:3144
    ds_read_b128 v[172:175], v233 offset:64
    v_mfma_f32_16x16x32_bf16 v[32:35], v[52:55], v[124:127], v[32:35]
    ds_read_b64 v[108:109], v232 offset:3648
    ds_read_b64 v[110:111], v232 offset:3656
    v_mfma_f32_16x16x32_bf16 v[32:35], v[56:59], v[120:123], v[32:35]
    s_mul_i32 s74, s68, 4224
    s_and_b32 s75, s71, 63
    v_mfma_f32_16x16x32_bf16 v[32:35], v[60:63], v[116:119], v[32:35]
    s_add_u32 s74, s74, s75
    s_lshl_b32 s74, s74, 6
    v_mfma_f32_16x16x32_bf16 v[32:35], v[64:67], v[112:115], v[32:35]
    v_and_b32 v234, 3, v0
    v_lshl_add_u32 v234, v234, 4, s74
    v_mfma_f32_16x16x32_bf16 v[36:39], v[48:51], v[132:135], v[36:39]
    v_and_b32 v235, 12, v0
    v_lshrrev_b32 v236, 4, v0
    v_mfma_f32_16x16x32_bf16 v[36:39], v[52:55], v[128:131], v[36:39]
    v_add_u32 v235, v235, v236
    v_mul_u32_u24 v235, 4224, v235
    v_mfma_f32_16x16x32_bf16 v[36:39], v[56:59], v[124:127], v[36:39]
    v_add_u32 v234, v234, v235
    v_mfma_f32_16x16x32_bf16 v[36:39], v[60:63], v[120:123], v[36:39]
    v_mfma_f32_16x16x32_bf16 v[36:39], v[64:67], v[116:119], v[36:39]
    v_mfma_f32_16x16x32_bf16 v[36:39], v[68:71], v[112:115], v[36:39]
    s_waitcnt lgkmcnt(0)
    s_mov_b64 exec, 1
    ds_add_u32 v227, v244 offset:36
    s_mov_b64 exec, -1
    v_mfma_f32_16x16x32_bf16 v[16:19], v[80:83], v[144:147], v[16:19]
    s_lshl4_add_u32 s73, s68, 256
    s_add_u32 s45, s73, s69
    v_mfma_f32_16x16x32_bf16 v[20:23], v[80:83], v[148:151], v[20:23]
    s_lshl_b32 s73, s73, 8
    s_lshl_b32 s45, s45, 8
    v_mfma_f32_16x16x32_bf16 v[20:23], v[84:87], v[144:147], v[20:23]
    v_mfma_f32_16x16x32_bf16 v[24:27], v[80:83], v[152:155], v[24:27]
    v_mfma_f32_16x16x32_bf16 v[24:27], v[84:87], v[148:151], v[24:27]
    v_mfma_f32_16x16x32_bf16 v[24:27], v[88:91], v[144:147], v[24:27]
    v_mfma_f32_16x16x32_bf16 v[28:31], v[80:83], v[156:159], v[28:31]
    v_cvt_pk_bf16_f32 v176, v16, v17
    v_cvt_pk_bf16_f32 v177, v18, v19
    v_mfma_f32_16x16x32_bf16 v[28:31], v[84:87], v[152:155], v[28:31]
    v_mfma_f32_16x16x32_bf16 v[28:31], v[88:91], v[148:151], v[28:31]
    v_cvt_pk_bf16_f32 v178, v20, v21
    v_cvt_pk_bf16_f32 v179, v22, v23
    v_mfma_f32_16x16x32_bf16 v[28:31], v[92:95], v[144:147], v[28:31]
    s_mov_b32 s76, 0
    buffer_store_dwordx4 v[176:179], v234, s[64:67], s76 offen sc1
    v_mfma_f32_16x16x32_bf16 v[32:35], v[80:83], v[160:163], v[32:35]
    v_cvt_pk_bf16_f32 v180, v24, v25
    v_cvt_pk_bf16_f32 v181, v26, v27
    v_mfma_f32_16x16x32_bf16 v[32:35], v[84:87], v[156:159], v[32:35]
    v_mfma_f32_16x16x32_bf16 v[32:35], v[88:91], v[152:155], v[32:35]
    v_mfma_f32_16x16x32_bf16 v[32:35], v[92:95], v[148:151], v[32:35]
    v_cvt_pk_bf16_f32 v182, v28, v29
    v_cvt_pk_bf16_f32 v183, v30, v31
    v_mfma_f32_16x16x32_bf16 v[32:35], v[96:99], v[144:147], v[32:35]
    s_mov_b32 s76, 67584
    buffer_store_dwordx4 v[180:183], v234, s[64:67], s76 offen sc1
    v_mfma_f32_16x16x32_bf16 v[36:39], v[80:83], v[164:167], v[36:39]
    v_mfma_f32_16x16x32_bf16 v[36:39], v[84:87], v[160:163], v[36:39]
    v_mfma_f32_16x16x32_bf16 v[36:39], v[88:91], v[156:159], v[36:39]
    v_mfma_f32_16x16x32_bf16 v[36:39], v[92:95], v[152:155], v[36:39]
    v_mfma_f32_16x16x32_bf16 v[36:39], v[96:99], v[148:151], v[36:39]
    v_mfma_f32_16x16x32_bf16 v[36:39], v[100:103], v[144:147], v[36:39]
    v_cvt_pk_bf16_f32 v184, v32, v33
    v_cvt_pk_bf16_f32 v185, v34, v35
    v_mfma_f32_16x16x32_bf16 v[40:43], v[48:51], v[136:139], v[40:43]
    v_mfma_f32_16x16x32_bf16 v[40:43], v[52:55], v[132:135], v[40:43]
    v_mfma_f32_16x16x32_bf16 v[40:43], v[56:59], v[128:131], v[40:43]
    v_mfma_f32_16x16x32_bf16 v[40:43], v[60:63], v[124:127], v[40:43]
    v_mfma_f32_16x16x32_bf16 v[40:43], v[64:67], v[120:123], v[40:43]
    v_mfma_f32_16x16x32_bf16 v[40:43], v[68:71], v[116:119], v[40:43]
    v_cvt_pk_bf16_f32 v186, v36, v37
    v_cvt_pk_bf16_f32 v187, v38, v39
    v_mfma_f32_16x16x32_bf16 v[40:43], v[72:75], v[112:115], v[40:43]
    s_mov_b32 s76, 135168
    buffer_store_dwordx4 v[184:187], v234, s[64:67], s76 offen sc1
    v_mfma_f32_16x16x32_bf16 v[44:47], v[48:51], v[140:143], v[44:47]
    v_mfma_f32_16x16x32_bf16 v[44:47], v[52:55], v[136:139], v[44:47]
    v_mfma_f32_16x16x32_bf16 v[44:47], v[56:59], v[132:135], v[44:47]
    v_mfma_f32_16x16x32_bf16 v[44:47], v[60:63], v[128:131], v[44:47]
    v_mfma_f32_16x16x32_bf16 v[44:47], v[64:67], v[124:127], v[44:47]
    v_mfma_f32_16x16x32_bf16 v[44:47], v[68:71], v[120:123], v[44:47]
    v_mfma_f32_16x16x32_bf16 v[44:47], v[72:75], v[116:119], v[44:47]
    v_mfma_f32_16x16x32_bf16 v[44:47], v[76:79], v[112:115], v[44:47]
    v_mfma_f32_16x16x32_bf16 v[40:43], v[80:83], v[168:171], v[40:43]
    v_mfma_f32_16x16x32_bf16 v[40:43], v[84:87], v[164:167], v[40:43]
    v_mfma_f32_16x16x32_bf16 v[40:43], v[88:91], v[160:163], v[40:43]
    v_mfma_f32_16x16x32_bf16 v[40:43], v[92:95], v[156:159], v[40:43]
    v_mfma_f32_16x16x32_bf16 v[40:43], v[96:99], v[152:155], v[40:43]
    v_mfma_f32_16x16x32_bf16 v[40:43], v[100:103], v[148:151], v[40:43]
    v_mfma_f32_16x16x32_bf16 v[40:43], v[104:107], v[144:147], v[40:43]
    v_mfma_f32_16x16x32_bf16 v[44:47], v[80:83], v[172:175], v[44:47]
    v_mfma_f32_16x16x32_bf16 v[44:47], v[84:87], v[168:171], v[44:47]
    v_mfma_f32_16x16x32_bf16 v[44:47], v[88:91], v[164:167], v[44:47]
    v_mfma_f32_16x16x32_bf16 v[44:47], v[92:95], v[160:163], v[44:47]
    v_mfma_f32_16x16x32_bf16 v[44:47], v[96:99], v[156:159], v[44:47]
    v_mfma_f32_16x16x32_bf16 v[44:47], v[100:103], v[152:155], v[44:47]
    v_mfma_f32_16x16x32_bf16 v[44:47], v[104:107], v[148:151], v[44:47]
    v_mfma_f32_16x16x32_bf16 v[44:47], v[108:111], v[144:147], v[44:47]
    v_cvt_pk_bf16_f32 v188, v40, v41
    v_cvt_pk_bf16_f32 v189, v42, v43
    s_nop 5
    v_cvt_pk_bf16_f32 v190, v44, v45
    v_cvt_pk_bf16_f32 v191, v46, v47
    s_mov_b32 s76, 202752
    buffer_store_dwordx4 v[188:191], v234, s[64:67], s76 offen sc1
    s_setprio 1
    s_waitcnt vmcnt(0)
    v_mov_b32 v238, 1
    s_mov_b64 exec, 1
    ds_add_rtn_u32 v237, v227, v238 offset:8
    s_waitcnt lgkmcnt(0)
    v_readfirstlane_b32 s76, v237
    s_nop 0
    s_cmp_eq_u32 s76, 3
    s_cbranch_scc0 L_jo_38a
    s_mov_b64 exec, 0xffff
    v_lshlrev_b32 v237, 8, v0
    buffer_atomic_add v238, v237, s[52:55], s73 offen sc1
L_jo_38a:
    s_mov_b64 exec, -1
    v_lshlrev_b32 v112, 16, v208
    v_and_b32 v113, 0xffff0000, v208
    v_lshlrev_b32 v114, 16, v209
    v_and_b32 v115, 0xffff0000, v209
    v_lshlrev_b32 v116, 16, v210
    v_and_b32 v117, 0xffff0000, v210
    v_lshlrev_b32 v118, 16, v211
    v_and_b32 v119, 0xffff0000, v211
    v_lshlrev_b32 v120, 16, v212
    v_and_b32 v121, 0xffff0000, v212
    v_lshlrev_b32 v122, 16, v213
    v_and_b32 v123, 0xffff0000, v213
    v_lshlrev_b32 v124, 16, v214
    v_and_b32 v125, 0xffff0000, v214
    v_lshlrev_b32 v126, 16, v215
    v_and_b32 v127, 0xffff0000, v215
    v_lshlrev_b32 v128, 16, v216
    v_and_b32 v129, 0xffff0000, v216
    v_lshlrev_b32 v130, 16, v217
    v_and_b32 v131, 0xffff0000, v217
    v_lshlrev_b32 v132, 16, v218
    v_and_b32 v133, 0xffff0000, v218
    v_lshlrev_b32 v134, 16, v219
    v_and_b32 v135, 0xffff0000, v219
    v_lshlrev_b32 v136, 16, v220
    v_and_b32 v137, 0xffff0000, v220
    v_lshlrev_b32 v138, 16, v221
    v_and_b32 v139, 0xffff0000, v221
    v_lshlrev_b32 v140, 16, v222
    v_and_b32 v141, 0xffff0000, v222
    v_lshlrev_b32 v142, 16, v223
    v_and_b32 v143, 0xffff0000, v223
    s_setprio 1
    s_setprio 1
    s_mul_i32 s77, s70, 4352
    s_add_u32 s77, s77, 60416
    v_lshrrev_b32 v234, 5, v0
    v_lshl_add_u32 v234, v234, 1, v0
    v_lshl_add_u32 v234, v234, 4, s77
    v_and_b32 v235, 7, v0
    v_mul_u32_u24 v235, 544, v235
    v_lshrrev_b32 v236, 3, v0
    v_lshl_add_u32 v235, v236, 3, v235
    v_add_u32 v235, s77, v235
    s_mul_i32 s77, s71, 4224
    s_mov_b32 s60, s26
    s_mov_b32 s61, s27
    s_mov_b32 s62, 0x800000
    s_mov_b32 s63, 0x20000
    s_cmp_eq_u32 s76, 3
    s_cbranch_scc0 L_jo_38
    s_mov_b32 s75, 131072
L_sg_loop_41:
    s_load_dword s74, s[52:53], s45 glc
L_sg_chk_42:
    s_waitcnt lgkmcnt(0)
    s_cmp_ge_u32 s74, 16
    s_cbranch_scc1 L_sg_done_40
    s_sub_u32 s75, s75, 1
    s_cbranch_scc0 L_sg_loop_41
L_sg_done_40:
    v_mov_b32 v237, 16
    s_mov_b64 exec, 1
    ds_add_u32 v227, v237 offset:16
    s_mov_b64 exec, -1
    s_branch L_jd_39
L_jo_38:
    s_mov_b32 s75, 1048576
L_sl_loop_44:
    ds_read_b32 v237, v227 offset:16
    s_waitcnt lgkmcnt(0)
    v_readfirstlane_b32 s74, v237
    s_nop 0
    s_cmp_ge_u32 s74, 16
    s_cbranch_scc1 L_sl_done_43
    s_sleep 1
    s_sub_u32 s75, s75, 1
    s_cbranch_scc0 L_sl_loop_44
L_sl_done_43:
L_jd_39:
    buffer_load_dwordx4 v[48:51], v224, s[64:67], s77 offen offset:0 sc1
    buffer_load_dwordx4 v[52:55], v224, s[64:67], s77 offen offset:1024 sc1
    buffer_load_dwordx4 v[56:59], v224, s[64:67], s77 offen offset:2048 sc1
    buffer_load_dwordx4 v[60:63], v224, s[64:67], s77 offen offset:3072 sc1
    s_waitcnt vmcnt(3)
    ds_write_b128 v234, v[48:51] offset:0
    s_waitcnt vmcnt(2)
    ds_write_b128 v234, v[52:55] offset:1088
    s_waitcnt vmcnt(1)
    ds_write_b128 v234, v[56:59] offset:2176
    s_waitcnt vmcnt(0)
    ds_write_b128 v234, v[60:63] offset:3264
    ds_read_b64 v[64:65], v235 offset:0
    ds_read_b64 v[66:67], v235 offset:64
    ds_read_b64 v[68:69], v235 offset:128
    ds_read_b64 v[70:71], v235 offset:192
    ds_read_b64 v[72:73], v235 offset:256
    ds_read_b64 v[74:75], v235 offset:320
    ds_read_b64 v[76:77], v235 offset:384
    ds_read_b64 v[78:79], v235 offset:448
    s_waitcnt lgkmcnt(7)
    v_lshlrev_b32 v16, 16, v64
    v_and_b32 v24, 0xffff0000, v64
    v_lshlrev_b32 v32, 16, v65
    v_and_b32 v40, 0xffff0000, v65
    s_waitcnt lgkmcnt(6)
    v_lshlrev_b32 v17, 16, v66
    v_and_b32 v25, 0xffff0000, v66
    v_lshlrev_b32 v33, 16, v67
    v_and_b32 v41, 0xffff0000, v67
    s_waitcnt lgkmcnt(5)
    v_lshlrev_b32 v18, 16, v68
    v_and_b32 v26, 0xffff0000, v68
    v_lshlrev_b32 v34, 16, v69
    v_and_b32 v42, 0xffff0000, v69
    s_waitcnt lgkmcnt(4)
    v_lshlrev_b32 v19, 16, v70
    v_and_b32 v27, 0xffff0000, v70
    v_lshlrev_b32 v35, 16, v71
    v_and_b32 v43, 0xffff0000, v71
    s_waitcnt lgkmcnt(3)
    v_lshlrev_b32 v20, 16, v72
    v_and_b32 v28, 0xffff0000, v72
    v_lshlrev_b32 v36, 16, v73
    v_and_b32 v44, 0xffff0000, v73
    s_waitcnt lgkmcnt(2)
    v_lshlrev_b32 v21, 16, v74
    v_and_b32 v29, 0xffff0000, v74
    v_lshlrev_b32 v37, 16, v75
    v_and_b32 v45, 0xffff0000, v75
    s_waitcnt lgkmcnt(1)
    v_lshlrev_b32 v22, 16, v76
    v_and_b32 v30, 0xffff0000, v76
    v_lshlrev_b32 v38, 16, v77
    v_and_b32 v46, 0xffff0000, v77
    s_waitcnt lgkmcnt(0)
    v_lshlrev_b32 v23, 16, v78
    v_and_b32 v31, 0xffff0000, v78
    v_lshlrev_b32 v39, 16, v79
    v_and_b32 v47, 0xffff0000, v79
    v_mul_f32 v16, v16, v112
    v_mul_f32 v17, v17, v113
    v_mul_f32 v18, v18, v114
    v_mul_f32 v19, v19, v115
    v_mul_f32 v20, v20, v116
    v_mul_f32 v21, v21, v117
    v_mul_f32 v22, v22, v118
    v_mul_f32 v23, v23, v119
    v_cvt_pk_bf16_f32 v48, v16, v17
    v_cvt_pk_bf16_f32 v49, v18, v19
    v_cvt_pk_bf16_f32 v50, v20, v21
    v_cvt_pk_bf16_f32 v51, v22, v23
    s_mov_b32 s74, 0
    buffer_store_dwordx4 v[48:51], v226, s[60:63], s74 offen nt
    v_mul_f32 v24, v24, v120
    v_mul_f32 v25, v25, v121
    v_mul_f32 v26, v26, v122
    v_mul_f32 v27, v27, v123
    v_mul_f32 v28, v28, v124
    v_mul_f32 v29, v29, v125
    v_mul_f32 v30, v30, v126
    v_mul_f32 v31, v31, v127
    v_cvt_pk_bf16_f32 v52, v24, v25
    v_cvt_pk_bf16_f32 v53, v26, v27
    v_cvt_pk_bf16_f32 v54, v28, v29
    v_cvt_pk_bf16_f32 v55, v30, v31
    s_mov_b32 s74, 4096
    buffer_store_dwordx4 v[52:55], v226, s[60:63], s74 offen nt
    v_mul_f32 v32, v32, v128
    v_mul_f32 v33, v33, v129
    v_mul_f32 v34, v34, v130
    v_mul_f32 v35, v35, v131
    v_mul_f32 v36, v36, v132
    v_mul_f32 v37, v37, v133
    v_mul_f32 v38, v38, v134
    v_mul_f32 v39, v39, v135
    v_cvt_pk_bf16_f32 v56, v32, v33
    v_cvt_pk_bf16_f32 v57, v34, v35
    v_cvt_pk_bf16_f32 v58, v36, v37
    v_cvt_pk_bf16_f32 v59, v38, v39
    s_mov_b32 s74, 16384
    buffer_store_dwordx4 v[56:59], v226, s[60:63], s74 offen nt
    v_mul_f32 v40, v40, v136
    v_mul_f32 v41, v41, v137
    v_mul_f32 v42, v42, v138
    v_mul_f32 v43, v43, v139
    v_mul_f32 v44, v44, v140
    v_mul_f32 v45, v45, v141
    v_mul_f32 v46, v46, v142
    v_mul_f32 v47, v47, v143
    v_cvt_pk_bf16_f32 v60, v40, v41
    v_cvt_pk_bf16_f32 v61, v42, v43
    v_cvt_pk_bf16_f32 v62, v44, v45
    v_cvt_pk_bf16_f32 v63, v46, v47
    s_mov_b32 s74, 20480
    buffer_store_dwordx4 v[60:63], v226, s[60:63], s74 offen nt
    s_endpgm
L_grole:
    s_setprio 2
    s_add_u32 s52, s30, 0xe00000
    s_addc_u32 s53, s31, 0
    s_mov_b32 s54, 0x20000
    s_mov_b32 s55, 0x20000
    s_lshr_b32 s32, s3, 1
    s_and_b32 s33, s3, 1
    v_and_b32 v1, 15, v0
    v_lshrrev_b32 v2, 4, v0
    v_lshrrev_b32 v3, 1, v1
    v_xor_b32 v3, v2, v3
    v_lshlrev_b32 v3, 4, v3
    v_lshl_add_u32 v3, v1, 7, v3
    s_lshl_b32 s37, s33, 13
    v_add_u32 v196, s37, v3
    v_xor_b32 v197, 64, v196
    v_and_b32 v198, 7, v1
    v_lshlrev_b32 v3, 1, v2
    v_xor_b32 v3, v3, v198
    v_lshlrev_b32 v3, 4, v3
    v_lshl_add_u32 v3, v198, 7, v3
    v_lshrrev_b32 v202, 3, v1
    v_lshl_add_u32 v3, v202, 2, v3
    v_add_u32 v198, 16384, v3
    v_xor_b32 v199, 16, v198
    v_mul_u32_u24 v202, 0xaaaa, v202
    v_add_u32 v202, 0x4444, v202
    v_bfe_u32 v3, v0, 2, 2
    v_lshl_add_u32 v200, v2, 3, v3
    v_lshlrev_b32 v200, 7, v200
    v_bfe_u32 v3, v0, 3, 2
    v_xor_b32 v3, s3, v3
    v_lshl_add_u32 v200, v3, 5, v200
    v_and_b32 v3, 3, v0
    v_lshl_add_u32 v200, v3, 3, v200
    v_add_u32 v200, 17408, v200
    v_xor_b32 v201, 32, v200
    v_mov_b64 v[52:53], 0
    v_mov_b64 v[54:55], 0
    v_mov_b64 v[56:57], 0
    v_mov_b64 v[58:59], 0
    v_mov_b64 v[60:61], 0
    v_mov_b64 v[62:63], 0
    v_mov_b64 v[64:65], 0
    v_mov_b64 v[66:67], 0
    v_mov_b64 v[68:69], 0
    v_mov_b64 v[70:71], 0
    v_mov_b64 v[72:73], 0
    v_mov_b64 v[74:75], 0
    v_mov_b64 v[76:77], 0
    v_mov_b64 v[78:79], 0
    v_mov_b64 v[80:81], 0
    v_mov_b64 v[82:83], 0
    v_mov_b64 v[84:85], 0
    v_mov_b64 v[86:87], 0
    v_mov_b64 v[88:89], 0
    v_mov_b64 v[90:91], 0
    v_mov_b64 v[92:93], 0
    v_mov_b64 v[94:95], 0
    v_mov_b64 v[96:97], 0
    v_mov_b64 v[98:99], 0
    v_mov_b64 v[100:101], 0
    v_mov_b64 v[102:103], 0
    v_mov_b64 v[104:105], 0
    v_mov_b64 v[106:107], 0
    s_mov_b32 s34, 0
    v_mov_b32 v228, 134352
    v_and_b32 v1, 15, v0
    v_lshrrev_b32 v2, 4, v0
    v_lshlrev_b32 v2, 2, v2
    v_sub_u32 v1, v1, v2
    s_mov_b32 s37, 0xf149f2ca
    v_mov_b32 v3, s37
    s_or_b32 s38, s5, s33
    s_cmp_eq_u32 s38, 0
    s_cselect_b32 s38, s37, 0
    v_subrev_u32 v2, 0, v1
    v_cmp_gt_u32 vcc, 8, v2
    v_cmp_gt_i32 s[64:65], -8, v2
    v_ashrrev_i32 v2, 31, v2
    v_cndmask_b32 v204, v3, 0, vcc
    v_cndmask_b32 v208, v3, 0, s[64:65]
    v_mov_b32 v216, v2
    v_min_f32 v212, s38, v208
    v_subrev_u32 v2, 1, v1
    v_cmp_gt_u32 vcc, 8, v2
    v_cmp_gt_i32 s[64:65], -8, v2
    v_ashrrev_i32 v2, 31, v2
    v_cndmask_b32 v205, v3, 0, vcc
    v_cndmask_b32 v209, v3, 0, s[64:65]
    v_alignbit_b32 v216, v2, v216, 16
    v_min_f32 v213, s38, v209
    v_subrev_u32 v2, 2, v1
    v_cmp_gt_u32 vcc, 8, v2
    v_cmp_gt_i32 s[64:65], -8, v2
    v_ashrrev_i32 v2, 31, v2
    v_cndmask_b32 v206, v3, 0, vcc
    v_cndmask_b32 v210, v3, 0, s[64:65]
    v_mov_b32 v217, v2
    v_min_f32 v214, s38, v210
    v_subrev_u32 v2, 3, v1
    v_cmp_gt_u32 vcc, 8, v2
    v_cmp_gt_i32 s[64:65], -8, v2
    v_ashrrev_i32 v2, 31, v2
    v_cndmask_b32 v207, v3, 0, vcc
    v_cndmask_b32 v211, v3, 0, s[64:65]
    v_alignbit_b32 v217, v2, v217, 16
    v_min_f32 v215, s38, v211
    s_mul_i32 s37, s32, 80896
    s_add_u32 s37, s37, 78848
    v_lshl_add_u32 v220, v0, 3, s37
    s_lshl_b32 s38, s33, 9
    v_add_u32 v219, s38, v220
    s_add_u32 s38, s38, s37
    v_and_b32 v1, 3, v0
    v_lshl_add_u32 v1, v1, 1, s38
    v_bfe_u32 v2, v0, 2, 2
    v_lshl_add_u32 v1, v2, 7, v1
    v_lshrrev_b32 v2, 4, v0
    v_xor_b32 v2, 2, v2
    v_lshl_add_u32 v203, v2, 5, v1
    s_mul_i32 s38, s33, 2560
    v_add_u32 v221, s38, v220
    v_xor_b32 v222, 512, v221
    s_lshl3_add_u32 s37, s4, s5
    s_lshl1_add_u32 s37, s37, s33
    s_lshl_b32 s37, s37, 7
    s_lshl1_add_u32 s38, s6, s32
    s_add_u32 s37, s37, s38
    s_lshl_b32 s37, s37, 10
    v_lshl_add_u32 v218, v0, 4, s37
    s_mov_b32 s40, s30
    s_mov_b32 s41, s31
    s_mov_b32 s42, 0x400000
    s_mov_b32 s43, 0x20000
    s_and_b32 s58, s2, 3
    s_bfe_u32 s37, s2, 0x20003
    s_lshl2_add_u32 s58, s58, s37
    s_bfe_u32 s59, s2, 0x10002
    s_lshr_b32 s37, s2, 5
    s_lshl3_add_u32 s59, s59, s37
    s_mov_b32 s44, s24
    s_mov_b32 s45, s25
    s_mov_b32 s46, 0x200000
    s_mov_b32 s47, 0x20000
    s_mov_b32 s48, s26
    s_mov_b32 s49, s27
    s_mov_b32 s50, 0x800000
    s_mov_b32 s51, 0x20000
    s_lshl3_add_u32 s56, s4, s5
    s_lshl4_add_u32 s56, s56, 0
    s_lshl_b32 s56, s56, 8
    s_lshl4_add_u32 s57, s58, 0
    s_add_u32 s57, s57, s59
    s_lshl_b32 s57, s57, 8
    s_lshl2_add_u32 s37, s58, s3
    s_lshl_b32 s38, s37, 16
    v_lshl_add_u32 v224, v0, 4, s38
    v_add_u32 v225, 0x8000, v224
    s_and_b32 s37, s37, 31
    s_lshl_b32 s37, s37, 6
    s_lshr_b32 s38, s58, 3
    s_add_u32 s37, s37, s38
    s_lshl_b32 s37, s37, 5
    s_add_u32 s37, s37, s59
    s_add_u32 s37, s37, 16
    s_lshl_b32 s37, s37, 7
    v_lshrrev_b32 v1, 3, v0
    v_lshl_add_u32 v1, v1, 13, s37
    v_and_b32 v2, 7, v0
    v_lshl_add_u32 v226, v2, 4, v1
    v_lshrrev_b32 v1, 4, v0
    v_lshlrev_b32 v1, 1, v1
    v_xor_b32 v1, v0, v1
    v_and_b32 v1, 7, v1
    s_lshl_b32 s37, s59, 7
    v_lshl_add_u32 v1, v1, 4, s37
    v_lshrrev_b32 v227, 3, v0
    v_lshl_add_u32 v227, v227, 11, v1
    v_add_u32 v223, 15360, v227
    s_lshl_b32 s60, s3, 11
    s_mul_i32 s61, s59, 0
    s_and_b32 s61, s61, 7
    s_lshl3_add_u32 s62, s61, s3
    s_lshl_b32 s62, s62, 15
    v_lshrrev_b32 v1, 2, v0
    v_lshlrev_b32 v1, 7, v1
    v_bfe_u32 v2, v0, 3, 2
    v_lshl_add_u32 v1, v2, 5, v1
    v_and_b32 v2, 3, v0
    v_lshl_add_u32 v229, v2, 3, v1
    v_and_b32 v231, 7, v0
    v_lshl_add_u32 v230, v231, 6, s86
    v_mul_u32_u24 v231, 528, v231
    v_lshrrev_b32 v232, 3, v0
    v_xor_b32 v232, 7, v232
    v_lshl_add_u32 v231, v232, 3, v231
    v_add_u32 v231, s86, v231
    v_lshrrev_b32 v232, 5, v0
    v_add_u32 v232, v0, v232
    v_lshl_add_u32 v232, v232, 4, s86
    s_mul_i32 s87, s84, 4224
    s_sub_u32 s87, s87, s85
    s_lshl_b32 s87, s87, 6
    s_add_u32 s87, s87, 4032
    v_and_b32 v233, 3, v0
    v_lshl_add_u32 v233, v233, 4, s87
    v_lshrrev_b32 v234, 2, v0
    v_mul_u32_u24 v234, 4224, v234
    v_add_u32 v233, v233, v234
    s_add_u32 s80, s30, 0x400000
    s_addc_u32 s81, s31, 0
    s_mov_b32 s82, 0x420000
    s_mov_b32 s83, 0x20000
    s_waitcnt vmcnt(11)
    ds_read_b128 v[36:39], v230 offset:4224
    ds_read_b128 v[40:43], v230 offset:4240
    ds_read_b128 v[44:47], v230 offset:4256
    ds_read_b128 v[48:51], v230 offset:4272
    s_waitcnt lgkmcnt(3)
    v_lshlrev_b32 v152, 16, v36
    v_and_b32 v154, 0xffff0000, v36
    v_lshlrev_b32 v156, 16, v37
    v_and_b32 v158, 0xffff0000, v37
    v_lshlrev_b32 v153, 16, v38
    v_and_b32 v155, 0xffff0000, v38
    v_lshlrev_b32 v157, 16, v39
    v_and_b32 v159, 0xffff0000, v39
    s_waitcnt lgkmcnt(2)
    v_lshlrev_b32 v160, 16, v40
    v_and_b32 v162, 0xffff0000, v40
    v_lshlrev_b32 v164, 16, v41
    v_and_b32 v166, 0xffff0000, v41
    v_lshlrev_b32 v161, 16, v42
    v_and_b32 v163, 0xffff0000, v42
    v_lshlrev_b32 v165, 16, v43
    v_and_b32 v167, 0xffff0000, v43
    s_waitcnt lgkmcnt(1)
    v_lshlrev_b32 v168, 16, v44
    v_and_b32 v170, 0xffff0000, v44
    v_lshlrev_b32 v172, 16, v45
    v_and_b32 v174, 0xffff0000, v45
    v_lshlrev_b32 v169, 16, v46
    v_and_b32 v171, 0xffff0000, v46
    v_lshlrev_b32 v173, 16, v47
    v_and_b32 v175, 0xffff0000, v47
    s_waitcnt lgkmcnt(0)
    v_lshlrev_b32 v176, 16, v48
    v_and_b32 v178, 0xffff0000, v48
    v_lshlrev_b32 v180, 16, v49
    v_and_b32 v182, 0xffff0000, v49
    v_lshlrev_b32 v177, 16, v50
    v_and_b32 v179, 0xffff0000, v50
    v_lshlrev_b32 v181, 16, v51
    v_and_b32 v183, 0xffff0000, v51
    v_mov_b64 v[36:37], 0
    v_mov_b64 v[38:39], 0
    v_mov_b64 v[40:41], 0
    v_mov_b64 v[42:43], 0
    v_mov_b64 v[44:45], 0
    v_mov_b64 v[46:47], 0
    v_mov_b64 v[48:49], 0
    v_mov_b64 v[50:51], 0
    s_waitcnt vmcnt(10)
    v_lshlrev_b32 v184, 16, v108
    v_and_b32 v185, 0xffff0000, v108
    v_lshlrev_b32 v186, 16, v109
    v_and_b32 v187, 0xffff0000, v109
    v_lshlrev_b32 v188, 16, v110
    v_and_b32 v189, 0xffff0000, v110
    v_lshlrev_b32 v190, 16, v111
    v_and_b32 v191, 0xffff0000, v111
    v_pk_mul_f32 v[4:5], v[184:185], v[158:159]
    v_pk_mul_f32 v[12:13], v[186:187], v[166:167]
    v_pk_mul_f32 v[20:21], v[188:189], v[174:175]
    v_pk_mul_f32 v[28:29], v[190:191], v[182:183]
    s_waitcnt vmcnt(9)
    v_lshlrev_b32 v184, 16, v112
    v_and_b32 v185, 0xffff0000, v112
    v_lshlrev_b32 v186, 16, v113
    v_and_b32 v187, 0xffff0000, v113
    v_lshlrev_b32 v188, 16, v114
    v_and_b32 v189, 0xffff0000, v114
    v_lshlrev_b32 v190, 16, v115
    v_and_b32 v191, 0xffff0000, v115
    v_pk_fma_f32 v[4:5], v[184:185], v[156:157], v[4:5]
    v_pk_fma_f32 v[12:13], v[186:187], v[164:165], v[12:13]
    v_pk_fma_f32 v[20:21], v[188:189], v[172:173], v[20:21]
    v_pk_fma_f32 v[28:29], v[190:191], v[180:181], v[28:29]
    v_pk_mul_f32 v[6:7], v[184:185], v[158:159]
    v_pk_mul_f32 v[14:15], v[186:187], v[166:167]
    v_pk_mul_f32 v[22:23], v[188:189], v[174:175]
    v_pk_mul_f32 v[30:31], v[190:191], v[182:183]
    s_waitcnt vmcnt(8)
    v_lshlrev_b32 v184, 16, v116
    v_and_b32 v185, 0xffff0000, v116
    v_lshlrev_b32 v186, 16, v117
    v_and_b32 v187, 0xffff0000, v117
    v_lshlrev_b32 v188, 16, v118
    v_and_b32 v189, 0xffff0000, v118
    v_lshlrev_b32 v190, 16, v119
    v_and_b32 v191, 0xffff0000, v119
    v_pk_fma_f32 v[4:5], v[184:185], v[154:155], v[4:5]
    v_pk_fma_f32 v[12:13], v[186:187], v[162:163], v[12:13]
    v_pk_fma_f32 v[20:21], v[188:189], v[170:171], v[20:21]
    v_pk_fma_f32 v[28:29], v[190:191], v[178:179], v[28:29]
    v_pk_fma_f32 v[6:7], v[184:185], v[156:157], v[6:7]
    v_pk_fma_f32 v[14:15], v[186:187], v[164:165], v[14:15]
    v_pk_fma_f32 v[22:23], v[188:189], v[172:173], v[22:23]
    v_pk_fma_f32 v[30:31], v[190:191], v[180:181], v[30:31]
    v_pk_mul_f32 v[8:9], v[184:185], v[158:159]
    v_pk_mul_f32 v[16:17], v[186:187], v[166:167]
    v_pk_mul_f32 v[24:25], v[188:189], v[174:175]
    v_pk_mul_f32 v[32:33], v[190:191], v[182:183]
    s_waitcnt vmcnt(7)
    v_lshlrev_b32 v184, 16, v120
    v_and_b32 v185, 0xffff0000, v120
    v_lshlrev_b32 v186, 16, v121
    v_and_b32 v187, 0xffff0000, v121
    v_lshlrev_b32 v188, 16, v122
    v_and_b32 v189, 0xffff0000, v122
    v_lshlrev_b32 v190, 16, v123
    v_and_b32 v191, 0xffff0000, v123
    v_pk_fma_f32 v[4:5], v[184:185], v[152:153], v[4:5]
    v_pk_fma_f32 v[12:13], v[186:187], v[160:161], v[12:13]
    v_pk_fma_f32 v[20:21], v[188:189], v[168:169], v[20:21]
    v_pk_fma_f32 v[28:29], v[190:191], v[176:177], v[28:29]
    v_pk_fma_f32 v[6:7], v[184:185], v[154:155], v[6:7]
    v_pk_fma_f32 v[14:15], v[186:187], v[162:163], v[14:15]
    v_pk_fma_f32 v[22:23], v[188:189], v[170:171], v[22:23]
    v_pk_fma_f32 v[30:31], v[190:191], v[178:179], v[30:31]
    v_pk_fma_f32 v[8:9], v[184:185], v[156:157], v[8:9]
    v_pk_fma_f32 v[16:17], v[186:187], v[164:165], v[16:17]
    v_pk_fma_f32 v[24:25], v[188:189], v[172:173], v[24:25]
    v_pk_fma_f32 v[32:33], v[190:191], v[180:181], v[32:33]
    v_pk_mul_f32 v[10:11], v[184:185], v[158:159]
    v_pk_mul_f32 v[18:19], v[186:187], v[166:167]
    v_pk_mul_f32 v[26:27], v[188:189], v[174:175]
    v_pk_mul_f32 v[34:35], v[190:191], v[182:183]
    s_waitcnt vmcnt(6)
    v_lshlrev_b32 v184, 16, v124
    v_and_b32 v185, 0xffff0000, v124
    v_lshlrev_b32 v186, 16, v125
    v_and_b32 v187, 0xffff0000, v125
    v_lshlrev_b32 v188, 16, v126
    v_and_b32 v189, 0xffff0000, v126
    v_lshlrev_b32 v190, 16, v127
    v_and_b32 v191, 0xffff0000, v127
    v_pk_fma_f32 v[6:7], v[184:185], v[152:153], v[6:7]
    v_pk_fma_f32 v[14:15], v[186:187], v[160:161], v[14:15]
    v_pk_fma_f32 v[22:23], v[188:189], v[168:169], v[22:23]
    v_pk_fma_f32 v[30:31], v[190:191], v[176:177], v[30:31]
    v_pk_fma_f32 v[8:9], v[184:185], v[154:155], v[8:9]
    v_pk_fma_f32 v[16:17], v[186:187], v[162:163], v[16:17]
    v_pk_fma_f32 v[24:25], v[188:189], v[170:171], v[24:25]
    v_pk_fma_f32 v[32:33], v[190:191], v[178:179], v[32:33]
    v_pk_fma_f32 v[10:11], v[184:185], v[156:157], v[10:11]
    v_pk_fma_f32 v[18:19], v[186:187], v[164:165], v[18:19]
    v_pk_fma_f32 v[26:27], v[188:189], v[172:173], v[26:27]
    v_pk_fma_f32 v[34:35], v[190:191], v[180:181], v[34:35]
    s_waitcnt vmcnt(5)
    v_lshlrev_b32 v184, 16, v128
    v_and_b32 v185, 0xffff0000, v128
    v_lshlrev_b32 v186, 16, v129
    v_and_b32 v187, 0xffff0000, v129
    v_lshlrev_b32 v188, 16, v130
    v_and_b32 v189, 0xffff0000, v130
    v_lshlrev_b32 v190, 16, v131
    v_and_b32 v191, 0xffff0000, v131
    v_pk_fma_f32 v[8:9], v[184:185], v[152:153], v[8:9]
    v_pk_fma_f32 v[16:17], v[186:187], v[160:161], v[16:17]
    v_pk_fma_f32 v[24:25], v[188:189], v[168:169], v[24:25]
    v_pk_fma_f32 v[32:33], v[190:191], v[176:177], v[32:33]
    v_pk_fma_f32 v[10:11], v[184:185], v[154:155], v[10:11]
    v_pk_fma_f32 v[18:19], v[186:187], v[162:163], v[18:19]
    v_pk_fma_f32 v[26:27], v[188:189], v[170:171], v[26:27]
    v_pk_fma_f32 v[34:35], v[190:191], v[178:179], v[34:35]
    s_waitcnt vmcnt(4)
    v_lshlrev_b32 v184, 16, v132
    v_and_b32 v185, 0xffff0000, v132
    v_lshlrev_b32 v186, 16, v133
    v_and_b32 v187, 0xffff0000, v133
    v_lshlrev_b32 v188, 16, v134
    v_and_b32 v189, 0xffff0000, v134
    v_lshlrev_b32 v190, 16, v135
    v_and_b32 v191, 0xffff0000, v135
    v_pk_fma_f32 v[10:11], v[184:185], v[152:153], v[10:11]
    v_pk_fma_f32 v[18:19], v[186:187], v[160:161], v[18:19]
    v_pk_fma_f32 v[26:27], v[188:189], v[168:169], v[26:27]
    v_pk_fma_f32 v[34:35], v[190:191], v[176:177], v[34:35]
    s_waitcnt vmcnt(3)
    v_lshlrev_b32 v184, 16, v136
    v_and_b32 v185, 0xffff0000, v136
    v_lshlrev_b32 v186, 16, v137
    v_and_b32 v187, 0xffff0000, v137
    v_lshlrev_b32 v188, 16, v138
    v_and_b32 v189, 0xffff0000, v138
    v_lshlrev_b32 v190, 16, v139
    v_and_b32 v191, 0xffff0000, v139
    v_pk_mul_f32 v[4:5], v[4:5], v[184:185]
    v_pk_mul_f32 v[12:13], v[12:13], v[186:187]
    v_pk_mul_f32 v[20:21], v[20:21], v[188:189]
    v_pk_mul_f32 v[28:29], v[28:29], v[190:191]
    s_waitcnt vmcnt(2)
    v_lshlrev_b32 v184, 16, v140
    v_and_b32 v185, 0xffff0000, v140
    v_lshlrev_b32 v186, 16, v141
    v_and_b32 v187, 0xffff0000, v141
    v_lshlrev_b32 v188, 16, v142
    v_and_b32 v189, 0xffff0000, v142
    v_lshlrev_b32 v190, 16, v143
    v_and_b32 v191, 0xffff0000, v143
    v_pk_mul_f32 v[6:7], v[6:7], v[184:185]
    v_pk_mul_f32 v[14:15], v[14:15], v[186:187]
    v_pk_mul_f32 v[22:23], v[22:23], v[188:189]
    v_pk_mul_f32 v[30:31], v[30:31], v[190:191]
    s_waitcnt vmcnt(1)
    v_lshlrev_b32 v184, 16, v144
    v_and_b32 v185, 0xffff0000, v144
    v_lshlrev_b32 v186, 16, v145
    v_and_b32 v187, 0xffff0000, v145
    v_lshlrev_b32 v188, 16, v146
    v_and_b32 v189, 0xffff0000, v146
    v_lshlrev_b32 v190, 16, v147
    v_and_b32 v191, 0xffff0000, v147
    v_pk_mul_f32 v[8:9], v[8:9], v[184:185]
    v_pk_mul_f32 v[16:17], v[16:17], v[186:187]
    v_pk_mul_f32 v[24:25], v[24:25], v[188:189]
    v_pk_mul_f32 v[32:33], v[32:33], v[190:191]
    s_waitcnt vmcnt(0)
    v_lshlrev_b32 v184, 16, v148
    v_and_b32 v185, 0xffff0000, v148
    v_lshlrev_b32 v186, 16, v149
    v_and_b32 v187, 0xffff0000, v149
    v_lshlrev_b32 v188, 16, v150
    v_and_b32 v189, 0xffff0000, v150
    v_lshlrev_b32 v190, 16, v151
    v_and_b32 v191, 0xffff0000, v151
    v_pk_mul_f32 v[10:11], v[10:11], v[184:185]
    v_pk_mul_f32 v[18:19], v[18:19], v[186:187]
    v_pk_mul_f32 v[26:27], v[26:27], v[188:189]
    v_pk_mul_f32 v[34:35], v[34:35], v[190:191]
    v_cvt_pk_bf16_f32 v108, v10, v8
    v_cvt_pk_bf16_f32 v109, v6, v4
    ds_write_b64 v231, v[108:109] offset:0
    v_cvt_pk_bf16_f32 v110, v11, v9
    v_cvt_pk_bf16_f32 v111, v7, v5
    ds_write_b64 v231, v[110:111] offset:64
    v_cvt_pk_bf16_f32 v112, v18, v16
    v_cvt_pk_bf16_f32 v113, v14, v12
    ds_write_b64 v231, v[112:113] offset:128
    v_cvt_pk_bf16_f32 v114, v19, v17
    v_cvt_pk_bf16_f32 v115, v15, v13
    ds_write_b64 v231, v[114:115] offset:192
    v_cvt_pk_bf16_f32 v116, v26, v24
    v_cvt_pk_bf16_f32 v117, v22, v20
    ds_write_b64 v231, v[116:117] offset:256
    v_cvt_pk_bf16_f32 v118, v27, v25
    v_cvt_pk_bf16_f32 v119, v23, v21
    ds_write_b64 v231, v[118:119] offset:320
    v_cvt_pk_bf16_f32 v120, v34, v32
    v_cvt_pk_bf16_f32 v121, v30, v28
    ds_write_b64 v231, v[120:121] offset:384
    v_cvt_pk_bf16_f32 v122, v35, v33
    v_cvt_pk_bf16_f32 v123, v31, v29
    ds_write_b64 v231, v[122:123] offset:448
    ds_read_b128 v[234:237], v232 offset:0
    ds_read_b128 v[238:241], v232 offset:1056
    ds_read_b128 v[242:245], v232 offset:2112
    ds_read_b128 v[246:249], v232 offset:3168
    v_mov_b64 v[4:5], 0
    v_mov_b64 v[6:7], 0
    v_mov_b64 v[8:9], 0
    v_mov_b64 v[10:11], 0
    v_mov_b64 v[12:13], 0
    v_mov_b64 v[14:15], 0
    v_mov_b64 v[16:17], 0
    v_mov_b64 v[18:19], 0
    v_mov_b64 v[20:21], 0
    v_mov_b64 v[22:23], 0
    v_mov_b64 v[24:25], 0
    v_mov_b64 v[26:27], 0
    v_mov_b64 v[28:29], 0
    v_mov_b64 v[30:31], 0
    v_mov_b64 v[32:33], 0
    v_mov_b64 v[34:35], 0
    s_waitcnt lgkmcnt(0)
    s_and_b32 s37, s2, 7
    s_xor_b32 s37, s37, 2
    s_lshl_b32 s37, s37, 5
    s_lshr_b32 s38, s2, 3
    s_add_u32 s37, s37, s38
    s_add_u32 s37, s37, 256
    s_lshl_b32 s37, s37, 8
    s_cmp_eq_u32 s33, 0
    s_cselect_b32 s37, s37, s57
    s_cmp_eq_u32 s32, 0
    s_cbranch_scc0 L_noclear
    s_mov_b64 exec, 1
    buffer_store_dword v4, off, s[52:55], s37 sc1
    s_mov_b64 exec, -1
L_noclear:
    s_mov_b32 s37, 41984
    s_mov_b32 s36, 15
    s_barrier
    ds_read_b128 v[108:111], v196 offset:0
    ds_read_b64_tr_b16 v[124:125], v200 offset:0
    ds_read_b64_tr_b16 v[126:127], v200 offset:512
    ds_read_b128 v[112:115], v196 offset:2048
    ds_read_b64_tr_b16 v[128:129], v201 offset:0
    ds_read_b64_tr_b16 v[130:131], v201 offset:512
    ds_read_b128 v[116:119], v196 offset:4096
    ds_read_b64_tr_b16 v[148:149], v200 offset:8192
    ds_read_b64_tr_b16 v[150:151], v200 offset:8704
    ds_read_b128 v[120:123], v196 offset:6144
    ds_read_b64_tr_b16 v[132:133], v201 offset:8192
    ds_read_b64_tr_b16 v[134:135], v201 offset:8704
    ds_read_b64_tr_b16 v[156:157], v200 offset:16384
    ds_read_b64_tr_b16 v[158:159], v200 offset:16896
    ds_read_b64_tr_b16 v[136:137], v201 offset:16384
    ds_read_b64_tr_b16 v[138:139], v201 offset:16896
    s_mov_b32 s87, 0
    buffer_store_dwordx4 v[234:237], v233, s[80:83], s87 offen sc1
    s_mov_b32 s87, 67584
    buffer_store_dwordx4 v[238:241], v233, s[80:83], s87 offen sc1
    s_mov_b32 s87, 135168
    buffer_store_dwordx4 v[242:245], v233, s[80:83], s87 offen sc1
    s_mov_b32 s87, 202752
    buffer_store_dwordx4 v[246:249], v233, s[80:83], s87 offen sc1
    s_branch L_g1_head
.p2align 6
L_g1_head:
    s_waitcnt lgkmcnt(0)
L_g1_loop:
    v_mfma_f32_16x16x32_bf16 v[4:7], v[124:127], v[108:111], v[4:7]
    ds_read_b128 v[164:167], v197 offset:0
    v_mfma_f32_16x16x32_bf16 v[12:15], v[124:127], v[112:115], v[12:15]
    ds_read_b64_tr_b16 v[180:181], v200 offset:4096
    v_mfma_f32_16x16x32_bf16 v[20:23], v[124:127], v[116:119], v[20:23]
    ds_read_b64_tr_b16 v[182:183], v200 offset:4608
    v_mfma_f32_16x16x32_bf16 v[28:31], v[124:127], v[120:123], v[28:31]
    ds_read_b128 v[168:171], v197 offset:2048
    v_mfma_f32_16x16x32_bf16 v[32:35], v[128:131], v[120:123], v[32:35]
    ds_read_b64_tr_b16 v[184:185], v201 offset:4096
    v_mfma_f32_16x16x32_bf16 v[24:27], v[128:131], v[116:119], v[24:27]
    ds_read_b64_tr_b16 v[186:187], v201 offset:4608
    v_mfma_f32_16x16x32_bf16 v[16:19], v[128:131], v[112:115], v[16:19]
    ds_read_b128 v[172:175], v197 offset:4096
    v_mfma_f32_16x16x32_bf16 v[8:11], v[128:131], v[108:111], v[8:11]
    ds_read_b64_tr_b16 v[152:153], v200 offset:12288
    v_mfma_f32_16x16x32_bf16 v[40:43], v[132:135], v[108:111], v[40:43]
    ds_read_b64_tr_b16 v[154:155], v200 offset:12800
    v_mfma_f32_16x16x32_bf16 v[48:51], v[132:135], v[112:115], v[48:51]
    ds_read_b128 v[176:179], v197 offset:6144
    v_mfma_f32_16x16x32_bf16 v[56:59], v[132:135], v[116:119], v[56:59]
    ds_read_b64_tr_b16 v[188:189], v201 offset:12288
    v_mfma_f32_16x16x32_bf16 v[64:67], v[132:135], v[120:123], v[64:67]
    ds_read_b64_tr_b16 v[190:191], v201 offset:12800
    v_mfma_f32_16x16x32_bf16 v[60:63], v[148:151], v[120:123], v[60:63]
    ds_read2_b32 v[140:141], v198 offset1:2
    v_mfma_f32_16x16x32_bf16 v[52:55], v[148:151], v[116:119], v[52:55]
    ds_read2_b32 v[142:143], v199 offset1:2
    v_mfma_f32_16x16x32_bf16 v[44:47], v[148:151], v[112:115], v[44:47]
    ds_read_b64_tr_b16 v[160:161], v200 offset:20480
    v_mfma_f32_16x16x32_bf16 v[36:39], v[148:151], v[108:111], v[36:39]
    ds_read_b64_tr_b16 v[162:163], v200 offset:20992
    v_mfma_f32_16x16x32_bf16 v[68:71], v[108:111], v[156:159], v[68:71]
    ds_read_b64_tr_b16 v[192:193], v201 offset:20480
    ds_read_b64_tr_b16 v[194:195], v201 offset:20992
    v_mfma_f32_16x16x32_bf16 v[76:79], v[112:115], v[156:159], v[76:79]
    ds_read_b32 v1, v228 offset:24
    s_add_u32 s34, s34, 41984
    v_mfma_f32_16x16x32_bf16 v[84:87], v[116:119], v[156:159], v[84:87]
    s_cmp_eq_u32 s34, 125952
    s_cselect_b32 s35, -83968, s37
    v_mfma_f32_16x16x32_bf16 v[92:95], v[120:123], v[156:159], v[92:95]
    s_cselect_b32 s34, 0, s34
    s_bitcmp1_b32 0x1002, s36
    v_mfma_f32_16x16x32_bf16 v[96:99], v[120:123], v[136:139], v[96:99]
    v_add_u32 v196, s35, v196
    v_add_u32 v197, s35, v197
    v_mfma_f32_16x16x32_bf16 v[88:91], v[116:119], v[136:139], v[88:91]
    v_add_u32 v198, s35, v198
    v_add_u32 v199, s35, v199
    v_mfma_f32_16x16x32_bf16 v[80:83], v[112:115], v[136:139], v[80:83]
    v_add_u32 v200, s35, v200
    v_add_u32 v201, s35, v201
    v_mfma_f32_16x16x32_bf16 v[72:75], v[108:111], v[136:139], v[72:75]
    s_waitcnt lgkmcnt(0)
    v_smfmac_f32_16x16x64_bf16 v[100:103], v[140:143], v[148:155], v202
    v_smfmac_f32_16x16x64_bf16 v[104:107], v[140:143], v[156:163], v202
    s_cbranch_scc1 L_g1_rare
L_g1_bar:
    s_barrier
L_g1_nobar:
    v_mfma_f32_16x16x32_bf16 v[4:7], v[180:183], v[164:167], v[4:7]
    ds_read_b128 v[108:111], v196 offset:0
    v_mfma_f32_16x16x32_bf16 v[12:15], v[180:183], v[168:171], v[12:15]
    ds_read_b64_tr_b16 v[124:125], v200 offset:0
    v_mfma_f32_16x16x32_bf16 v[20:23], v[180:183], v[172:175], v[20:23]
    ds_read_b64_tr_b16 v[126:127], v200 offset:512
    v_mfma_f32_16x16x32_bf16 v[28:31], v[180:183], v[176:179], v[28:31]
    ds_read_b128 v[112:115], v196 offset:2048
    v_mfma_f32_16x16x32_bf16 v[32:35], v[184:187], v[176:179], v[32:35]
    ds_read_b64_tr_b16 v[128:129], v201 offset:0
    v_mfma_f32_16x16x32_bf16 v[24:27], v[184:187], v[172:175], v[24:27]
    ds_read_b64_tr_b16 v[130:131], v201 offset:512
    v_mfma_f32_16x16x32_bf16 v[16:19], v[184:187], v[168:171], v[16:19]
    ds_read_b128 v[116:119], v196 offset:4096
    v_mfma_f32_16x16x32_bf16 v[8:11], v[184:187], v[164:167], v[8:11]
    ds_read_b64_tr_b16 v[148:149], v200 offset:8192
    v_mfma_f32_16x16x32_bf16 v[40:43], v[188:191], v[164:167], v[40:43]
    ds_read_b64_tr_b16 v[150:151], v200 offset:8704
    v_mfma_f32_16x16x32_bf16 v[48:51], v[188:191], v[168:171], v[48:51]
    ds_read_b128 v[120:123], v196 offset:6144
    v_mfma_f32_16x16x32_bf16 v[56:59], v[188:191], v[172:175], v[56:59]
    ds_read_b64_tr_b16 v[132:133], v201 offset:8192
    v_mfma_f32_16x16x32_bf16 v[64:67], v[188:191], v[176:179], v[64:67]
    ds_read_b64_tr_b16 v[134:135], v201 offset:8704
    v_mfma_f32_16x16x32_bf16 v[60:63], v[152:155], v[176:179], v[60:63]
    ds_read_b64_tr_b16 v[156:157], v200 offset:16384
    v_mfma_f32_16x16x32_bf16 v[52:55], v[152:155], v[172:175], v[52:55]
    ds_read_b64_tr_b16 v[158:159], v200 offset:16896
    v_mfma_f32_16x16x32_bf16 v[44:47], v[152:155], v[168:171], v[44:47]
    ds_read_b64_tr_b16 v[136:137], v201 offset:16384
    v_mfma_f32_16x16x32_bf16 v[36:39], v[152:155], v[164:167], v[36:39]
    ds_read_b64_tr_b16 v[138:139], v201 offset:16896
    v_mfma_f32_16x16x32_bf16 v[68:71], v[164:167], v[160:163], v[68:71]
    s_sub_u32 s36, s36, 1
    v_mfma_f32_16x16x32_bf16 v[76:79], v[168:171], v[160:163], v[76:79]
    s_cmp_lg_u32 s36, 0
    v_mfma_f32_16x16x32_bf16 v[84:87], v[172:175], v[160:163], v[84:87]
    v_mfma_f32_16x16x32_bf16 v[92:95], v[176:179], v[160:163], v[92:95]
    v_mfma_f32_16x16x32_bf16 v[96:99], v[176:179], v[192:195], v[96:99]
    v_mfma_f32_16x16x32_bf16 v[88:91], v[172:175], v[192:195], v[88:91]
    v_mfma_f32_16x16x32_bf16 v[80:83], v[168:171], v[192:195], v[80:83]
    s_waitcnt lgkmcnt(0)
    v_mfma_f32_16x16x32_bf16 v[72:75], v[164:167], v[192:195], v[72:75]
    s_cbranch_scc1 L_g1_loop
    v_mfma_f32_16x16x32_bf16 v[4:7], v[124:127], v[108:111], v[4:7]
    ds_read_b128 v[164:167], v197 offset:0
    v_mfma_f32_16x16x32_bf16 v[12:15], v[124:127], v[112:115], v[12:15]
    ds_read_b64_tr_b16 v[180:181], v200 offset:4096
    v_mfma_f32_16x16x32_bf16 v[20:23], v[124:127], v[116:119], v[20:23]
    ds_read_b64_tr_b16 v[182:183], v200 offset:4608
    v_mfma_f32_16x16x32_bf16 v[28:31], v[124:127], v[120:123], v[28:31]
    ds_read_b128 v[168:171], v197 offset:2048
    v_mfma_f32_16x16x32_bf16 v[32:35], v[128:131], v[120:123], v[32:35]
    ds_read_b64_tr_b16 v[184:185], v201 offset:4096
    v_mfma_f32_16x16x32_bf16 v[24:27], v[128:131], v[116:119], v[24:27]
    ds_read_b64_tr_b16 v[186:187], v201 offset:4608
    v_mfma_f32_16x16x32_bf16 v[16:19], v[128:131], v[112:115], v[16:19]
    ds_read_b128 v[172:175], v197 offset:4096
    v_mfma_f32_16x16x32_bf16 v[8:11], v[128:131], v[108:111], v[8:11]
    ds_read_b64_tr_b16 v[152:153], v200 offset:12288
    v_mfma_f32_16x16x32_bf16 v[40:43], v[132:135], v[108:111], v[40:43]
    ds_read_b64_tr_b16 v[154:155], v200 offset:12800
    v_mfma_f32_16x16x32_bf16 v[48:51], v[132:135], v[112:115], v[48:51]
    ds_read_b128 v[176:179], v197 offset:6144
    v_mfma_f32_16x16x32_bf16 v[56:59], v[132:135], v[116:119], v[56:59]
    ds_read_b64_tr_b16 v[188:189], v201 offset:12288
    v_mfma_f32_16x16x32_bf16 v[64:67], v[132:135], v[120:123], v[64:67]
    ds_read_b64_tr_b16 v[190:191], v201 offset:12800
    v_mfma_f32_16x16x32_bf16 v[60:63], v[148:151], v[120:123], v[60:63]
    ds_read2_b32 v[140:141], v198 offset1:2
    v_mfma_f32_16x16x32_bf16 v[52:55], v[148:151], v[116:119], v[52:55]
    ds_read2_b32 v[142:143], v199 offset1:2
    v_mfma_f32_16x16x32_bf16 v[44:47], v[148:151], v[112:115], v[44:47]
    ds_read_b64_tr_b16 v[160:161], v200 offset:20480
    v_mfma_f32_16x16x32_bf16 v[36:39], v[148:151], v[108:111], v[36:39]
    ds_read_b64_tr_b16 v[162:163], v200 offset:20992
    v_mfma_f32_16x16x32_bf16 v[68:71], v[108:111], v[156:159], v[68:71]
    ds_read_b64_tr_b16 v[192:193], v201 offset:20480
    v_mfma_f32_16x16x32_bf16 v[76:79], v[112:115], v[156:159], v[76:79]
    ds_read_b64_tr_b16 v[194:195], v201 offset:20992
    v_mfma_f32_16x16x32_bf16 v[84:87], v[116:119], v[156:159], v[84:87]
    v_mfma_f32_16x16x32_bf16 v[92:95], v[120:123], v[156:159], v[92:95]
    v_mfma_f32_16x16x32_bf16 v[96:99], v[120:123], v[136:139], v[96:99]
    v_mfma_f32_16x16x32_bf16 v[88:91], v[116:119], v[136:139], v[88:91]
    v_mfma_f32_16x16x32_bf16 v[80:83], v[112:115], v[136:139], v[80:83]
    v_mfma_f32_16x16x32_bf16 v[72:75], v[108:111], v[136:139], v[72:75]
    s_waitcnt lgkmcnt(0)
    s_setprio 2
    v_mov_b32 v2, 1
    v_smfmac_f32_16x16x64_bf16 v[100:103], v[140:143], v[148:155], v202
    v_smfmac_f32_16x16x64_bf16 v[104:107], v[140:143], v[156:163], v202
    v_mfma_f32_16x16x32_bf16 v[60:63], v[152:155], v[176:179], v[60:63]
    v_mfma_f32_16x16x32_bf16 v[64:67], v[188:191], v[176:179], v[64:67]
    v_mfma_f32_16x16x32_bf16 v[92:95], v[176:179], v[160:163], v[92:95]
    v_mfma_f32_16x16x32_bf16 v[96:99], v[176:179], v[192:195], v[96:99]
    v_mfma_f32_16x16x32_bf16 v[28:31], v[180:183], v[176:179], v[28:31]
    v_mfma_f32_16x16x32_bf16 v[32:35], v[184:187], v[176:179], v[32:35]
    v_mfma_f32_16x16x32_bf16 v[52:55], v[152:155], v[172:175], v[52:55]
    v_mfma_f32_16x16x32_bf16 v[56:59], v[188:191], v[172:175], v[56:59]
    s_nop 3
    v_permlane32_swap_b32 v100, v104
    v_permlane32_swap_b32 v101, v105
    v_mfma_f32_16x16x32_bf16 v[20:23], v[180:183], v[172:175], v[20:23]
    v_permlane32_swap_b32 v102, v106
    v_permlane32_swap_b32 v103, v107
    v_mfma_f32_16x16x32_bf16 v[24:27], v[184:187], v[172:175], v[24:27]
    v_add_f32 v100, v100, v104
    v_add_f32 v101, v101, v105
    v_mfma_f32_16x16x32_bf16 v[44:47], v[152:155], v[168:171], v[44:47]
    v_add_f32 v102, v102, v106
    v_add_f32 v103, v103, v107
    v_mfma_f32_16x16x32_bf16 v[48:51], v[188:191], v[168:171], v[48:51]
    v_cvt_pk_bf16_f32 v144, v100, v101
    v_cvt_pk_bf16_f32 v145, v102, v103
    v_mfma_f32_16x16x32_bf16 v[12:15], v[180:183], v[168:171], v[12:15]
    ds_write_b64 v219, v[144:145] offset:1024
    ds_write_b16 v203, v144 offset:0
    v_mfma_f32_16x16x32_bf16 v[16:19], v[184:187], v[168:171], v[16:19]
    ds_write_b16_d16_hi v203, v144 offset:8
    ds_write_b16 v203, v145 offset:16
    v_mfma_f32_16x16x32_bf16 v[36:39], v[152:155], v[164:167], v[36:39]
    ds_write_b16_d16_hi v203, v145 offset:24
    v_cvt_pk_bf16_f32 v140, v60, v61
    v_mfma_f32_16x16x32_bf16 v[40:43], v[188:191], v[164:167], v[40:43]
    v_cvt_pk_bf16_f32 v141, v62, v63
    v_cvt_pk_bf16_f32 v142, v64, v65
    v_mfma_f32_16x16x32_bf16 v[4:7], v[180:183], v[164:167], v[4:7]
    v_cvt_pk_bf16_f32 v143, v66, v67
    v_cvt_pk_bf16_f32 v238, v92, v93
    v_mfma_f32_16x16x32_bf16 v[8:11], v[184:187], v[164:167], v[8:11]
    v_cvt_pk_bf16_f32 v239, v94, v95
    v_cvt_pk_bf16_f32 v248, v96, v97
    v_mfma_f32_16x16x32_bf16 v[84:87], v[172:175], v[160:163], v[84:87]
    v_cvt_pk_bf16_f32 v249, v98, v99
    s_cmp_eq_u32 s33, 0
    s_cbranch_scc0 L_at_nopub
    ds_write_b64 v220, v[140:141] offset:2048
    ds_write_b64 v220, v[238:239] offset:3072
    ds_write_b64 v220, v[142:143] offset:2560
    ds_write_b64 v220, v[248:249] offset:3584
L_at_nopub:
    s_mov_b64 exec, 1
    ds_add_u32 v228, v2 offset:20
    s_mov_b64 exec, -1
    v_mfma_f32_16x16x32_bf16 v[88:91], v[172:175], v[192:195], v[88:91]
    v_cvt_pk_bf16_f32 v120, v28, v29
    v_cvt_pk_bf16_f32 v121, v30, v31
    v_mfma_f32_16x16x32_bf16 v[76:79], v[168:171], v[160:163], v[76:79]
    v_cvt_pk_bf16_f32 v122, v32, v33
    v_cvt_pk_bf16_f32 v123, v34, v35
    v_mfma_f32_16x16x32_bf16 v[80:83], v[168:171], v[192:195], v[80:83]
    v_cvt_pk_bf16_f32 v136, v52, v53
    v_cvt_pk_bf16_f32 v137, v54, v55
    v_mfma_f32_16x16x32_bf16 v[68:71], v[164:167], v[160:163], v[68:71]
    v_cvt_pk_bf16_f32 v138, v56, v57
    v_cvt_pk_bf16_f32 v139, v58, v59
    v_mfma_f32_16x16x32_bf16 v[72:75], v[164:167], v[192:195], v[72:75]
    v_cvt_pk_bf16_f32 v116, v20, v21
    v_cvt_pk_bf16_f32 v117, v22, v23
    v_mfma_f32_16x16x32_bf16 v[28:31], v[140:143], v[120:123], v[204:207]
    v_cvt_pk_bf16_f32 v118, v24, v25
    v_cvt_pk_bf16_f32 v119, v26, v27
    v_mfma_f32_16x16x32_bf16 v[32:35], v[136:139], v[120:123], v[208:211]
    v_cvt_pk_bf16_f32 v132, v44, v45
    v_cvt_pk_bf16_f32 v133, v46, v47
    v_mfma_f32_16x16x32_bf16 v[20:23], v[136:139], v[116:119], v[204:207]
    v_cvt_pk_bf16_f32 v134, v48, v49
    v_cvt_pk_bf16_f32 v135, v50, v51
    s_nop 1
    v_mfma_f32_16x16x32_bf16 v[24:27], v[132:135], v[116:119], v[208:211]
    v_cvt_pk_bf16_f32 v112, v12, v13
    v_cvt_pk_bf16_f32 v113, v14, v15
    v_cvt_pk_bf16_f32 v114, v16, v17
    v_cvt_pk_bf16_f32 v115, v18, v19
    s_nop 1
    v_mfma_f32_16x16x32_bf16 v[12:15], v[132:135], v[112:115], v[204:207]
    v_cvt_pk_bf16_f32 v128, v36, v37
    v_cvt_pk_bf16_f32 v129, v38, v39
    v_cvt_pk_bf16_f32 v130, v40, v41
    v_cvt_pk_bf16_f32 v131, v42, v43
    s_nop 1
    v_mfma_f32_16x16x32_bf16 v[16:19], v[128:131], v[112:115], v[208:211]
    v_cvt_pk_bf16_f32 v108, v4, v5
    v_cvt_pk_bf16_f32 v109, v6, v7
    v_cvt_pk_bf16_f32 v110, v8, v9
    v_cvt_pk_bf16_f32 v111, v10, v11
    s_nop 1
    v_mfma_f32_16x16x32_bf16 v[4:7], v[128:131], v[108:111], v[204:207]
    v_cvt_pk_bf16_f32 v236, v84, v85
    v_cvt_pk_bf16_f32 v237, v86, v87
    v_cvt_pk_bf16_f32 v246, v88, v89
    v_cvt_pk_bf16_f32 v247, v90, v91
    v_cvt_pk_bf16_f32 v234, v76, v77
    v_cvt_pk_bf16_f32 v235, v78, v79
    ds_read_b32 v1, v228 offset:20
    v_cvt_pk_bf16_f32 v244, v80, v81
    v_cvt_pk_bf16_f32 v245, v82, v83
    v_cvt_pk_bf16_f32 v232, v68, v69
    v_cvt_pk_bf16_f32 v233, v70, v71
    v_cvt_pk_bf16_f32 v242, v72, v73
    v_cvt_pk_bf16_f32 v243, v74, v75
    s_waitcnt lgkmcnt(0)
    v_readfirstlane_b32 s37, v1
    s_nop 0
    s_cmp_ge_u32 s37, 4
    s_cbranch_scc1 L_sl_done_45
    s_mov_b32 s38, 1048576
L_sl_loop_46:
    ds_read_b32 v1, v228 offset:20
    s_waitcnt lgkmcnt(0)
    v_readfirstlane_b32 s37, v1
    s_nop 0
    s_cmp_ge_u32 s37, 4
    s_cbranch_scc1 L_sl_done_45
    s_sleep 1
    s_sub_u32 s38, s38, 1
    s_cbranch_scc0 L_sl_loop_46
L_sl_done_45:
    ds_read_b64 v[124:125], v221
    ds_read_b64 v[126:127], v222
    ds_read_b64 v[230:231], v221 offset:1024
    ds_read_b64 v[240:241], v222 offset:1024
    v_max_f32 v28, v28, v32
    v_max_f32 v29, v29, v33
    v_max_f32 v30, v30, v34
    v_max_f32 v31, v31, v35
    v_max3_f32 v39, v28, v29, v30
    v_max_f32 v39, v39, v31
    v_max_f32 v20, v20, v24
    v_max_f32 v21, v21, v25
    v_max_f32 v22, v22, v26
    v_max_f32 v23, v23, v27
    v_max3_f32 v38, v20, v21, v22
    v_max_f32 v38, v38, v23
    s_waitcnt lgkmcnt(2)
    v_mfma_f32_16x16x32_bf16 v[8:11], v[124:127], v[108:111], v[212:215]
    s_setprio 2
    s_mov_b32 s37, 0x3e8293ee
    v_max_f32 v12, v12, v16
    v_max_f32 v13, v13, v17
    v_max_f32 v14, v14, v18
    v_max_f32 v15, v15, v19
    v_max3_f32 v37, v12, v13, v14
    v_max_f32 v37, v37, v15
    v_max_f32 v4, v4, v8
    v_max_f32 v5, v5, v9
    v_max_f32 v6, v6, v10
    v_max_f32 v7, v7, v11
    v_max3_f32 v36, v4, v5, v6
    v_max_f32 v36, v36, v7
    v_permlane32_swap_b32 v38, v39
    s_nop 0
    v_permlane32_swap_b32 v36, v37
    v_max_f32 v38, v38, v39
    v_max_f32 v36, v36, v37
    s_nop 1
    v_permlane16_swap_b32 v36, v38
    v_max_f32 v36, v36, v38
    v_mul_f32 v38, s37, v36
    v_mul_f32 v36, s37, v36
    s_nop 1
    v_permlane16_swap_b32 v36, v38
    v_mov_b32 v37, v36
    s_add_u32 m0, s60, 0
    v_mov_b32 v39, v38
    v_permlane32_swap_b32 v36, v37
    s_xor_b32 s63, s62, 0
    v_permlane32_swap_b32 v38, v39
    v_fma_f32 v4, v4, s37, -v36
    buffer_load_dwordx4 v227, s[44:47], s63 offen offset:0 lds
    v_fma_f32 v5, v5, s37, -v36
    v_fma_f32 v6, v6, s37, -v36
    buffer_load_dwordx4 v223, s[44:47], s63 offen offset:1024 lds
    v_fma_f32 v7, v7, s37, -v36
    v_fma_f32 v12, v12, s37, -v37
    s_add_u32 m0, s60, 8192
    v_fma_f32 v13, v13, s37, -v37
    v_fma_f32 v14, v14, s37, -v37
    s_xor_b32 s63, s62, 131072
    v_fma_f32 v15, v15, s37, -v37
    v_fma_f32 v20, v20, s37, -v38
    buffer_load_dwordx4 v227, s[44:47], s63 offen offset:0 lds
    v_fma_f32 v21, v21, s37, -v38
    v_fma_f32 v22, v22, s37, -v38
    buffer_load_dwordx4 v223, s[44:47], s63 offen offset:1024 lds
    v_fma_f32 v23, v23, s37, -v38
    v_fma_f32 v28, v28, s37, -v39
    s_add_u32 m0, s60, 16384
    v_fma_f32 v29, v29, s37, -v39
    v_fma_f32 v30, v30, s37, -v39
    s_xor_b32 s63, s62, 262144
    v_fma_f32 v31, v31, s37, -v39
    v_exp_f32 v28, v28
    buffer_load_dwordx4 v227, s[44:47], s63 offen offset:0 lds
    v_exp_f32 v29, v29
    v_exp_f32 v30, v30
    buffer_load_dwordx4 v223, s[44:47], s63 offen offset:1024 lds
    v_exp_f32 v31, v31
    v_exp_f32 v20, v20
    s_add_u32 m0, s60, 24576
    v_exp_f32 v21, v21
    v_exp_f32 v22, v22
    s_xor_b32 s63, s62, 393216
    v_exp_f32 v23, v23
    v_exp_f32 v12, v12
    buffer_load_dwordx4 v227, s[44:47], s63 offen offset:0 lds
    v_exp_f32 v13, v13
    v_exp_f32 v14, v14
    buffer_load_dwordx4 v223, s[44:47], s63 offen offset:1024 lds
    v_exp_f32 v15, v15
    v_exp_f32 v4, v4
    s_add_u32 m0, s60, 32768
    v_exp_f32 v5, v5
    v_exp_f32 v6, v6
    s_xor_b32 s63, s62, 524288
    v_exp_f32 v7, v7
    v_add_f32 v39, v28, v29
    buffer_load_dwordx4 v227, s[44:47], s63 offen offset:0 lds
    v_add_f32 v32, v30, v31
    v_add_f32 v39, v39, v32
    buffer_load_dwordx4 v223, s[44:47], s63 offen offset:1024 lds
    v_add_f32 v38, v20, v21
    v_add_f32 v24, v22, v23
    s_add_u32 m0, s60, 83968
    v_add_f32 v38, v38, v24
    v_add_f32 v37, v12, v13
    s_xor_b32 s63, s62, 655360
    v_add_f32 v16, v14, v15
    v_add_f32 v37, v37, v16
    buffer_load_dwordx4 v227, s[44:47], s63 offen offset:0 lds
    v_add_f32 v36, v4, v5
    v_add_f32 v8, v6, v7
    buffer_load_dwordx4 v223, s[44:47], s63 offen offset:1024 lds
    v_add_f32 v36, v36, v8
    v_permlane32_swap_b32 v38, v39
    s_add_u32 m0, s60, 92160
    v_permlane32_swap_b32 v36, v37
    v_add_f32 v38, v38, v39
    s_xor_b32 s63, s62, 786432
    v_add_f32 v36, v36, v37
    s_nop 1
    v_permlane16_swap_b32 v36, v38
    buffer_load_dwordx4 v227, s[44:47], s63 offen offset:0 lds
    v_add_f32 v36, v36, v38
    v_rcp_f32 v38, v36
    buffer_load_dwordx4 v223, s[44:47], s63 offen offset:1024 lds
    v_rcp_f32 v36, v36
    s_nop 1
    v_permlane16_swap_b32 v36, v38
    s_add_u32 m0, s60, 100352
    v_mov_b32 v37, v36
    v_mov_b32 v39, v38
    s_xor_b32 s63, s62, 917504
    v_permlane32_swap_b32 v36, v37
    v_permlane32_swap_b32 v38, v39
    buffer_load_dwordx4 v227, s[44:47], s63 offen offset:0 lds
    s_waitcnt lgkmcnt(0)
    v_mul_f32 v4, v4, v36
    buffer_load_dwordx4 v223, s[44:47], s63 offen offset:1024 lds
    v_mul_f32 v5, v5, v36
    v_mul_f32 v6, v6, v36
    s_add_u32 m0, s60, 108544
    v_mul_f32 v7, v7, v36
    v_cvt_pk_bf16_f32 v10, v4, v5
    s_xor_b32 s63, s62, 1048576
    v_cvt_pk_bf16_f32 v11, v6, v7
    v_and_b32 v8, v216, v10
    buffer_load_dwordx4 v227, s[44:47], s63 offen offset:0 lds
    v_and_b32 v9, v217, v11
    v_xor_b32 v10, v8, v10
    buffer_load_dwordx4 v223, s[44:47], s63 offen offset:1024 lds
    v_xor_b32 v11, v9, v11
    s_setprio 2
    s_add_u32 m0, s60, 116736
    v_mfma_f32_16x16x32_bf16 v[68:71], v[230:233], v[8:11], 0
    v_mfma_f32_16x16x32_bf16 v[72:75], v[240:243], v[8:11], 0
    s_xor_b32 s63, s62, 1179648
    s_setprio 2
    v_mul_f32 v12, v12, v37
    buffer_load_dwordx4 v227, s[44:47], s63 offen offset:0 lds
    v_mul_f32 v13, v13, v37
    v_mul_f32 v14, v14, v37
    buffer_load_dwordx4 v223, s[44:47], s63 offen offset:1024 lds
    v_mul_f32 v15, v15, v37
    v_cvt_pk_bf16_f32 v18, v12, v13
    v_cvt_pk_bf16_f32 v19, v14, v15
    v_and_b32 v16, v216, v18
    v_and_b32 v17, v217, v19
    v_xor_b32 v18, v16, v18
    v_xor_b32 v19, v17, v19
    v_cvt_pk_bf16_f32 v108, v68, v69
    v_cvt_pk_bf16_f32 v109, v70, v71
    v_cvt_pk_bf16_f32 v110, v72, v73
    v_cvt_pk_bf16_f32 v111, v74, v75
    s_mov_b32 s37, 0
    buffer_store_dwordx4 v[108:111], v218, s[40:43], s37 offen sc1
    s_setprio 2
    v_mfma_f32_16x16x32_bf16 v[76:79], v[232:235], v[16:19], 0
    v_mfma_f32_16x16x32_bf16 v[80:83], v[242:245], v[16:19], 0
    s_setprio 2
    v_mul_f32 v20, v20, v38
    v_mul_f32 v21, v21, v38
    v_mul_f32 v22, v22, v38
    v_mul_f32 v23, v23, v38
    v_cvt_pk_bf16_f32 v26, v20, v21
    v_cvt_pk_bf16_f32 v27, v22, v23
    v_and_b32 v24, v216, v26
    v_and_b32 v25, v217, v27
    v_xor_b32 v26, v24, v26
    v_xor_b32 v27, v25, v27
    v_cvt_pk_bf16_f32 v112, v76, v77
    v_cvt_pk_bf16_f32 v113, v78, v79
    v_cvt_pk_bf16_f32 v114, v80, v81
    v_cvt_pk_bf16_f32 v115, v82, v83
    s_mov_b32 s37, 32768
    buffer_store_dwordx4 v[112:115], v218, s[40:43], s37 offen sc1
    s_setprio 2
    v_mfma_f32_16x16x32_bf16 v[84:87], v[234:237], v[24:27], 0
    v_mfma_f32_16x16x32_bf16 v[88:91], v[244:247], v[24:27], 0
    s_setprio 2
    v_mul_f32 v28, v28, v39
    v_mul_f32 v29, v29, v39
    v_mul_f32 v30, v30, v39
    v_mul_f32 v31, v31, v39
    v_cvt_pk_bf16_f32 v34, v28, v29
    v_cvt_pk_bf16_f32 v35, v30, v31
    v_and_b32 v32, v216, v34
    v_and_b32 v33, v217, v35
    v_xor_b32 v34, v32, v34
    v_xor_b32 v35, v33, v35
    v_cvt_pk_bf16_f32 v116, v84, v85
    v_cvt_pk_bf16_f32 v117, v86, v87
    v_cvt_pk_bf16_f32 v118, v88, v89
    v_cvt_pk_bf16_f32 v119, v90, v91
    s_mov_b32 s37, 65536
    buffer_store_dwordx4 v[116:119], v218, s[40:43], s37 offen sc1
    s_setprio 2
    v_mfma_f32_16x16x32_bf16 v[92:95], v[236:239], v[32:35], 0
    v_mfma_f32_16x16x32_bf16 v[96:99], v[246:249], v[32:35], 0
    s_setprio 2
    s_nop 5
    v_cvt_pk_bf16_f32 v120, v92, v93
    v_cvt_pk_bf16_f32 v121, v94, v95
    v_cvt_pk_bf16_f32 v122, v96, v97
    v_cvt_pk_bf16_f32 v123, v98, v99
    s_mov_b32 s37, 98304
    buffer_store_dwordx4 v[120:123], v218, s[40:43], s37 offen sc1
    s_setprio 0
    s_lshl_b32 s37, s32, 11
    v_add_u32 v229, s37, v229
    v_xor_b32 v84, 0, v229
    v_xor_b32 v85, 32, v229
    v_xor_b32 v86, 64, v229
    v_xor_b32 v87, 96, v229
    v_add_u32 v88, 83968, v84
    v_add_u32 v89, 83968, v85
    v_add_u32 v90, 83968, v86
    v_add_u32 v91, 83968, v87
    v_add_u32 v92, 125952, v84
    v_add_u32 v93, 125952, v85
    v_add_u32 v94, 125952, v86
    v_add_u32 v95, 125952, v87
    v_xor_b32 v232, 2048, v229
    v_xor_b32 v233, 2080, v229
    v_xor_b32 v234, 2112, v229
    v_xor_b32 v235, 2144, v229
    v_add_u32 v236, 83968, v232
    v_add_u32 v237, 83968, v233
    v_add_u32 v238, 83968, v234
    v_add_u32 v239, 83968, v235
    v_add_u32 v240, 125952, v232
    v_add_u32 v241, 125952, v233
    v_add_u32 v242, 125952, v234
    v_add_u32 v243, 125952, v235
    s_mul_i32 s37, s32, 80896
    s_lshl_b32 s38, s33, 11
    s_add_u32 s37, s37, s38
    s_add_u32 s37, s37, 78848
    v_lshrrev_b32 v1, 5, v0
    v_xor_b32 v1, v1, v0
    v_and_b32 v1, 7, v1
    v_lshl_add_u32 v1, v1, 4, s37
    v_bfe_u32 v2, v0, 4, 1
    v_lshl_add_u32 v1, v2, 3, v1
    v_and_b32 v2, 15, v0
    v_lshl_add_u32 v244, v2, 7, v1
    v_xor_b32 v245, 32, v244
    v_xor_b32 v246, 64, v244
    v_xor_b32 v247, 96, v244
    v_lshrrev_b32 v1, 3, v0
    v_xor_b32 v1, v1, v0
    v_and_b32 v1, 7, v1
    v_and_b32 v2, 56, v0
    v_add_u32 v1, v1, v2
    v_lshl_add_u32 v248, v1, 4, s37
    v_lshl_add_u32 v231, v0, 4, s60
    v_add_u32 v230, 125952, v231
    s_add_u32 s64, s61, 0
    s_and_b32 s64, s64, 7
    s_lshl_b32 s64, s64, 12
    s_add_u32 s65, s61, 1
    s_and_b32 s65, s65, 7
    s_lshl_b32 s65, s65, 12
    s_add_u32 s66, s61, 2
    s_and_b32 s66, s66, 7
    s_lshl_b32 s66, s66, 12
    s_add_u32 s67, s61, 3
    s_and_b32 s67, s67, 7
    s_lshl_b32 s67, s67, 12
    s_add_u32 s68, s61, 4
    s_and_b32 s68, s68, 7
    s_lshl_b32 s68, s68, 12
    s_add_u32 s69, s61, 5
    s_and_b32 s69, s69, 7
    s_lshl_b32 s69, s69, 12
    s_add_u32 s70, s61, 6
    s_and_b32 s70, s70, 7
    s_lshl_b32 s70, s70, 12
    s_add_u32 s71, s61, 7
    s_and_b32 s71, s71, 7
    s_lshl_b32 s71, s71, 12
    s_waitcnt vmcnt(0)
    s_setprio 2
    v_mov_b32 v2, 1
    s_mov_b64 exec, 1
    ds_add_rtn_u32 v1, v228, v2 offset:0
    s_waitcnt lgkmcnt(0)
    v_readfirstlane_b32 s39, v1
    s_nop 0
    s_cmp_eq_u32 s39, 3
    s_cbranch_scc0 L_jo_47a
    s_mov_b64 exec, 0xffff
    v_lshlrev_b32 v1, 8, v0
    buffer_atomic_add v2, v1, s[52:55], s56 offen sc1
L_jo_47a:
    s_mov_b64 exec, -1
    s_setprio 0
    s_xor_b32 s63, s62, 1310720
    buffer_load_dwordx4 v[172:175], v227, s[44:47], s63 offen offset:0
    buffer_load_dwordx4 v[176:179], v223, s[44:47], s63 offen offset:1024
    s_xor_b32 s63, s62, 1441792
    buffer_load_dwordx4 v[180:183], v227, s[44:47], s63 offen offset:0
    buffer_load_dwordx4 v[184:187], v223, s[44:47], s63 offen offset:1024
    s_cmp_eq_u32 s39, 3
    s_cbranch_scc0 L_ps_49
    s_load_dword s37, s[52:53], s57 glc
L_ps_49:
    s_xor_b32 s63, s62, 1572864
    buffer_load_dwordx4 v[188:191], v227, s[44:47], s63 offen offset:0
    buffer_load_dwordx4 v[192:195], v223, s[44:47], s63 offen offset:1024
    s_xor_b32 s63, s62, 1703936
    buffer_load_dwordx4 v[196:199], v227, s[44:47], s63 offen offset:0
    buffer_load_dwordx4 v[200:203], v223, s[44:47], s63 offen offset:1024
    s_xor_b32 s63, s62, 1835008
    buffer_load_dwordx4 v[204:207], v227, s[44:47], s63 offen offset:0
    buffer_load_dwordx4 v[208:211], v223, s[44:47], s63 offen offset:1024
    s_xor_b32 s63, s62, 1966080
    buffer_load_dwordx4 v[212:215], v227, s[44:47], s63 offen offset:0
    buffer_load_dwordx4 v[216:219], v223, s[44:47], s63 offen offset:1024
    s_setprio 0
    s_cmp_eq_u32 s39, 3
    s_cbranch_scc0 L_jo_47
    s_mov_b32 s38, 131072
    s_branch L_sg_chk_52
L_sg_loop_51:
    s_load_dword s37, s[52:53], s57 glc
L_sg_chk_52:
    s_waitcnt lgkmcnt(0)
    s_cmp_ge_u32 s37, 16
    s_cbranch_scc1 L_sg_done_50
    s_sub_u32 s38, s38, 1
    s_cbranch_scc0 L_sg_loop_51
L_sg_done_50:
    v_mov_b32 v1, 16
    s_mov_b64 exec, 1
    ds_add_u32 v228, v1 offset:4
    s_mov_b64 exec, -1
L_jo_47:
    s_waitcnt vmcnt(12)
    s_mov_b64 exec, 1
    ds_add_u32 v228, v2 offset:4
    s_mov_b64 exec, -1
    s_mov_b32 s38, 1048576
L_sl_loop_54:
    ds_read_b32 v1, v228 offset:4
    s_waitcnt lgkmcnt(0)
    v_readfirstlane_b32 s37, v1
    s_nop 0
    s_cmp_ge_u32 s37, 20
    s_cbranch_scc1 L_sl_done_53
    s_sleep 1
    s_sub_u32 s38, s38, 1
    s_cbranch_scc0 L_sl_loop_54
L_sl_done_53:
L_jd_48:
    buffer_load_dwordx4 v[96:99], v224, s[40:43], s64 offen offset:0 sc1
    buffer_load_dwordx4 v[100:103], v225, s[40:43], s64 offen offset:0 sc1
    ds_read_b64_tr_b16 v[36:37], v84 offset:0
    ds_read_b64_tr_b16 v[38:39], v232 offset:0
    buffer_load_dwordx4 v[104:107], v224, s[40:43], s64 offen offset:1024 sc1
    buffer_load_dwordx4 v[108:111], v225, s[40:43], s64 offen offset:1024 sc1
    ds_read_b64_tr_b16 v[40:41], v85 offset:0
    ds_read_b64_tr_b16 v[42:43], v233 offset:0
    buffer_load_dwordx4 v[112:115], v224, s[40:43], s64 offen offset:2048 sc1
    buffer_load_dwordx4 v[116:119], v225, s[40:43], s64 offen offset:2048 sc1
    ds_read_b64_tr_b16 v[44:45], v86 offset:0
    ds_read_b64_tr_b16 v[46:47], v234 offset:0
    buffer_load_dwordx4 v[120:123], v224, s[40:43], s64 offen offset:3072 sc1
    buffer_load_dwordx4 v[124:127], v225, s[40:43], s64 offen offset:3072 sc1
    ds_read_b64_tr_b16 v[48:49], v87 offset:0
    ds_read_b64_tr_b16 v[50:51], v235 offset:0
    buffer_load_dwordx4 v[128:131], v224, s[40:43], s65 offen offset:0 sc1
    buffer_load_dwordx4 v[132:135], v225, s[40:43], s65 offen offset:0 sc1
    ds_read_b64_tr_b16 v[52:53], v84 offset:4096
    ds_read_b64_tr_b16 v[54:55], v232 offset:4096
    buffer_load_dwordx4 v[136:139], v224, s[40:43], s65 offen offset:1024 sc1
    buffer_load_dwordx4 v[140:143], v225, s[40:43], s65 offen offset:1024 sc1
    ds_read_b64_tr_b16 v[56:57], v85 offset:4096
    ds_read_b64_tr_b16 v[58:59], v233 offset:4096
    ds_read_b64_tr_b16 v[60:61], v86 offset:4096
    ds_read_b64_tr_b16 v[62:63], v234 offset:4096
    s_waitcnt lgkmcnt(12)
    ds_read_b64_tr_b16 v[64:65], v87 offset:4096
    ds_read_b64_tr_b16 v[66:67], v235 offset:4096
    ds_read_b32 v1, v228 offset:36
    s_waitcnt vmcnt(10) lgkmcnt(9)
    v_mfma_f32_16x16x32_bf16 v[4:7], v[36:39], v[96:99], 0
    ds_read_b64_tr_b16 v[68:69], v84 offset:8192
    v_mfma_f32_16x16x32_bf16 v[20:23], v[36:39], v[100:103], 0
    ds_read_b64_tr_b16 v[70:71], v232 offset:8192
    v_mfma_f32_16x16x32_bf16 v[8:11], v[40:43], v[96:99], 0
    ds_read_b64_tr_b16 v[36:37], v85 offset:8192
    v_mfma_f32_16x16x32_bf16 v[24:27], v[40:43], v[100:103], 0
    ds_read_b64_tr_b16 v[38:39], v233 offset:8192
    buffer_load_dwordx4 v[144:147], v224, s[40:43], s65 offen offset:2048 sc1
    v_mfma_f32_16x16x32_bf16 v[12:15], v[44:47], v[96:99], 0
    ds_read_b64_tr_b16 v[40:41], v86 offset:8192
    v_mfma_f32_16x16x32_bf16 v[28:31], v[44:47], v[100:103], 0
    ds_read_b64_tr_b16 v[42:43], v234 offset:8192
    v_mfma_f32_16x16x32_bf16 v[16:19], v[48:51], v[96:99], 0
    ds_read_b64_tr_b16 v[44:45], v87 offset:8192
    v_mfma_f32_16x16x32_bf16 v[32:35], v[48:51], v[100:103], 0
    ds_read_b64_tr_b16 v[46:47], v235 offset:8192
    buffer_load_dwordx4 v[148:151], v225, s[40:43], s65 offen offset:2048 sc1
    s_waitcnt lgkmcnt(8)
    v_readfirstlane_b32 s37, v1
    s_nop 0
    s_cmp_ge_u32 s37, 4
    s_cbranch_scc1 L_sl_done_55
    s_mov_b32 s38, 1048576
L_sl_loop_56:
    ds_read_b32 v1, v228 offset:36
    s_waitcnt lgkmcnt(0)
    v_readfirstlane_b32 s37, v1
    s_nop 0
    s_cmp_ge_u32 s37, 4
    s_cbranch_scc1 L_sl_done_55
    s_sleep 1
    s_sub_u32 s38, s38, 1
    s_cbranch_scc0 L_sl_loop_56
L_sl_done_55:
    ds_write_b128 v230, v[172:175] offset:0
    s_waitcnt vmcnt(10)
    v_mfma_f32_16x16x32_bf16 v[4:7], v[52:55], v[104:107], v[4:7]
    ds_read_b64_tr_b16 v[48:49], v84 offset:12288
    v_mfma_f32_16x16x32_bf16 v[20:23], v[52:55], v[108:111], v[20:23]
    ds_read_b64_tr_b16 v[50:51], v232 offset:12288
    v_mfma_f32_16x16x32_bf16 v[8:11], v[56:59], v[104:107], v[8:11]
    ds_read_b64_tr_b16 v[52:53], v85 offset:12288
    v_mfma_f32_16x16x32_bf16 v[24:27], v[56:59], v[108:111], v[24:27]
    ds_read_b64_tr_b16 v[54:55], v233 offset:12288
    buffer_load_dwordx4 v[96:99], v224, s[40:43], s65 offen offset:3072 sc1
    ds_write_b128 v230, v[176:179] offset:1024
    v_mfma_f32_16x16x32_bf16 v[12:15], v[60:63], v[104:107], v[12:15]
    ds_read_b64_tr_b16 v[56:57], v86 offset:12288
    v_mfma_f32_16x16x32_bf16 v[28:31], v[60:63], v[108:111], v[28:31]
    ds_read_b64_tr_b16 v[58:59], v234 offset:12288
    v_mfma_f32_16x16x32_bf16 v[16:19], v[64:67], v[104:107], v[16:19]
    ds_read_b64_tr_b16 v[60:61], v87 offset:12288
    v_mfma_f32_16x16x32_bf16 v[32:35], v[64:67], v[108:111], v[32:35]
    ds_read_b64_tr_b16 v[62:63], v235 offset:12288
    buffer_load_dwordx4 v[100:103], v225, s[40:43], s65 offen offset:3072 sc1
    ds_write_b128 v230, v[180:183] offset:8448
    s_waitcnt vmcnt(10) lgkmcnt(11)
    v_mfma_f32_16x16x32_bf16 v[4:7], v[68:71], v[112:115], v[4:7]
    ds_read_b64_tr_b16 v[64:65], v84 offset:16384
    v_mfma_f32_16x16x32_bf16 v[20:23], v[68:71], v[116:119], v[20:23]
    ds_read_b64_tr_b16 v[66:67], v232 offset:16384
    v_mfma_f32_16x16x32_bf16 v[8:11], v[36:39], v[112:115], v[8:11]
    ds_read_b64_tr_b16 v[68:69], v85 offset:16384
    v_mfma_f32_16x16x32_bf16 v[24:27], v[36:39], v[116:119], v[24:27]
    ds_read_b64_tr_b16 v[70:71], v233 offset:16384
    buffer_load_dwordx4 v[104:107], v224, s[40:43], s66 offen offset:0 sc1
    ds_write_b128 v230, v[184:187] offset:9472
    v_mfma_f32_16x16x32_bf16 v[12:15], v[40:43], v[112:115], v[12:15]
    ds_read_b64_tr_b16 v[36:37], v86 offset:16384
    v_mfma_f32_16x16x32_bf16 v[28:31], v[40:43], v[116:119], v[28:31]
    ds_read_b64_tr_b16 v[38:39], v234 offset:16384
    v_mfma_f32_16x16x32_bf16 v[16:19], v[44:47], v[112:115], v[16:19]
    ds_read_b64_tr_b16 v[40:41], v87 offset:16384
    v_mfma_f32_16x16x32_bf16 v[32:35], v[44:47], v[116:119], v[32:35]
    ds_read_b64_tr_b16 v[42:43], v235 offset:16384
    buffer_load_dwordx4 v[108:111], v225, s[40:43], s66 offen offset:0 sc1
    ds_write_b128 v230, v[188:191] offset:16896
    s_waitcnt vmcnt(10) lgkmcnt(11)
    v_mfma_f32_16x16x32_bf16 v[4:7], v[48:51], v[120:123], v[4:7]
    ds_read_b64_tr_b16 v[44:45], v84 offset:20480
    v_mfma_f32_16x16x32_bf16 v[20:23], v[48:51], v[124:127], v[20:23]
    ds_read_b64_tr_b16 v[46:47], v232 offset:20480
    v_mfma_f32_16x16x32_bf16 v[8:11], v[52:55], v[120:123], v[8:11]
    ds_read_b64_tr_b16 v[48:49], v85 offset:20480
    v_mfma_f32_16x16x32_bf16 v[24:27], v[52:55], v[124:127], v[24:27]
    ds_read_b64_tr_b16 v[50:51], v233 offset:20480
    buffer_load_dwordx4 v[112:115], v224, s[40:43], s66 offen offset:1024 sc1
    ds_write_b128 v230, v[192:195] offset:17920
    v_mfma_f32_16x16x32_bf16 v[12:15], v[56:59], v[120:123], v[12:15]
    ds_read_b64_tr_b16 v[52:53], v86 offset:20480
    v_mfma_f32_16x16x32_bf16 v[28:31], v[56:59], v[124:127], v[28:31]
    ds_read_b64_tr_b16 v[54:55], v234 offset:20480
    v_mfma_f32_16x16x32_bf16 v[16:19], v[60:63], v[120:123], v[16:19]
    ds_read_b64_tr_b16 v[56:57], v87 offset:20480
    v_mfma_f32_16x16x32_bf16 v[32:35], v[60:63], v[124:127], v[32:35]
    ds_read_b64_tr_b16 v[58:59], v235 offset:20480
    buffer_load_dwordx4 v[116:119], v225, s[40:43], s66 offen offset:1024 sc1
    ds_write_b128 v230, v[196:199] offset:25344
    s_waitcnt vmcnt(10) lgkmcnt(11)
    v_mfma_f32_16x16x32_bf16 v[4:7], v[64:67], v[128:131], v[4:7]
    ds_read_b64_tr_b16 v[60:61], v84 offset:24576
    v_mfma_f32_16x16x32_bf16 v[20:23], v[64:67], v[132:135], v[20:23]
    ds_read_b64_tr_b16 v[62:63], v232 offset:24576
    v_mfma_f32_16x16x32_bf16 v[8:11], v[68:71], v[128:131], v[8:11]
    ds_read_b64_tr_b16 v[64:65], v85 offset:24576
    v_mfma_f32_16x16x32_bf16 v[24:27], v[68:71], v[132:135], v[24:27]
    ds_read_b64_tr_b16 v[66:67], v233 offset:24576
    buffer_load_dwordx4 v[120:123], v224, s[40:43], s66 offen offset:2048 sc1
    ds_write_b128 v230, v[200:203] offset:26368
    v_mfma_f32_16x16x32_bf16 v[12:15], v[36:39], v[128:131], v[12:15]
    ds_read_b64_tr_b16 v[68:69], v86 offset:24576
    v_mfma_f32_16x16x32_bf16 v[28:31], v[36:39], v[132:135], v[28:31]
    ds_read_b64_tr_b16 v[70:71], v234 offset:24576
    v_mfma_f32_16x16x32_bf16 v[16:19], v[40:43], v[128:131], v[16:19]
    ds_read_b64_tr_b16 v[36:37], v87 offset:24576
    v_mfma_f32_16x16x32_bf16 v[32:35], v[40:43], v[132:135], v[32:35]
    ds_read_b64_tr_b16 v[38:39], v235 offset:24576
    buffer_load_dwordx4 v[124:127], v225, s[40:43], s66 offen offset:2048 sc1
    ds_write_b128 v231, v[204:207] offset:41984
    s_waitcnt vmcnt(10) lgkmcnt(11)
    v_mfma_f32_16x16x32_bf16 v[4:7], v[44:47], v[136:139], v[4:7]
    ds_read_b64_tr_b16 v[40:41], v84 offset:28672
    v_mfma_f32_16x16x32_bf16 v[20:23], v[44:47], v[140:143], v[20:23]
    ds_read_b64_tr_b16 v[42:43], v232 offset:28672
    v_mfma_f32_16x16x32_bf16 v[8:11], v[48:51], v[136:139], v[8:11]
    ds_read_b64_tr_b16 v[44:45], v85 offset:28672
    v_mfma_f32_16x16x32_bf16 v[24:27], v[48:51], v[140:143], v[24:27]
    ds_read_b64_tr_b16 v[46:47], v233 offset:28672
    buffer_load_dwordx4 v[128:131], v224, s[40:43], s66 offen offset:3072 sc1
    ds_write_b128 v231, v[208:211] offset:43008
    v_mfma_f32_16x16x32_bf16 v[12:15], v[52:55], v[136:139], v[12:15]
    ds_read_b64_tr_b16 v[48:49], v86 offset:28672
    v_mfma_f32_16x16x32_bf16 v[28:31], v[52:55], v[140:143], v[28:31]
    ds_read_b64_tr_b16 v[50:51], v234 offset:28672
    v_mfma_f32_16x16x32_bf16 v[16:19], v[56:59], v[136:139], v[16:19]
    ds_read_b64_tr_b16 v[52:53], v87 offset:28672
    v_mfma_f32_16x16x32_bf16 v[32:35], v[56:59], v[140:143], v[32:35]
    ds_read_b64_tr_b16 v[54:55], v235 offset:28672
    buffer_load_dwordx4 v[132:135], v225, s[40:43], s66 offen offset:3072 sc1
    ds_write_b128 v231, v[212:215] offset:51200
    s_waitcnt vmcnt(10) lgkmcnt(11)
    v_mfma_f32_16x16x32_bf16 v[4:7], v[60:63], v[144:147], v[4:7]
    ds_read_b64_tr_b16 v[56:57], v84 offset:32768
    v_mfma_f32_16x16x32_bf16 v[20:23], v[60:63], v[148:151], v[20:23]
    ds_read_b64_tr_b16 v[58:59], v232 offset:32768
    v_mfma_f32_16x16x32_bf16 v[8:11], v[64:67], v[144:147], v[8:11]
    ds_read_b64_tr_b16 v[60:61], v85 offset:32768
    v_mfma_f32_16x16x32_bf16 v[24:27], v[64:67], v[148:151], v[24:27]
    ds_read_b64_tr_b16 v[62:63], v233 offset:32768
    buffer_load_dwordx4 v[136:139], v224, s[40:43], s67 offen offset:0 sc1
    ds_write_b128 v231, v[216:219] offset:52224
    s_mov_b64 exec, 1
    ds_add_u32 v228, v2 offset:12
    s_mov_b64 exec, -1
    v_mfma_f32_16x16x32_bf16 v[12:15], v[68:71], v[144:147], v[12:15]
    ds_read_b64_tr_b16 v[64:65], v86 offset:32768
    v_mfma_f32_16x16x32_bf16 v[28:31], v[68:71], v[148:151], v[28:31]
    ds_read_b64_tr_b16 v[66:67], v234 offset:32768
    v_mfma_f32_16x16x32_bf16 v[16:19], v[36:39], v[144:147], v[16:19]
    ds_read_b64_tr_b16 v[68:69], v87 offset:32768
    v_mfma_f32_16x16x32_bf16 v[32:35], v[36:39], v[148:151], v[32:35]
    ds_read_b64_tr_b16 v[70:71], v235 offset:32768
    buffer_load_dwordx4 v[140:143], v225, s[40:43], s67 offen offset:0 sc1
    s_waitcnt vmcnt(10) lgkmcnt(11)
    v_mfma_f32_16x16x32_bf16 v[4:7], v[40:43], v[96:99], v[4:7]
    ds_read_b64_tr_b16 v[36:37], v84 offset:36864
    v_mfma_f32_16x16x32_bf16 v[20:23], v[40:43], v[100:103], v[20:23]
    ds_read_b64_tr_b16 v[38:39], v232 offset:36864
    v_mfma_f32_16x16x32_bf16 v[8:11], v[44:47], v[96:99], v[8:11]
    ds_read_b64_tr_b16 v[40:41], v85 offset:36864
    v_mfma_f32_16x16x32_bf16 v[24:27], v[44:47], v[100:103], v[24:27]
    ds_read_b64_tr_b16 v[42:43], v233 offset:36864
    buffer_load_dwordx4 v[144:147], v224, s[40:43], s67 offen offset:1024 sc1
    v_mfma_f32_16x16x32_bf16 v[12:15], v[48:51], v[96:99], v[12:15]
    ds_read_b64_tr_b16 v[44:45], v86 offset:36864
    v_mfma_f32_16x16x32_bf16 v[28:31], v[48:51], v[100:103], v[28:31]
    ds_read_b64_tr_b16 v[46:47], v234 offset:36864
    v_mfma_f32_16x16x32_bf16 v[16:19], v[52:55], v[96:99], v[16:19]
    ds_read_b64_tr_b16 v[48:49], v87 offset:36864
    v_mfma_f32_16x16x32_bf16 v[32:35], v[52:55], v[100:103], v[32:35]
    ds_read_b64_tr_b16 v[50:51], v235 offset:36864
    buffer_load_dwordx4 v[148:151], v225, s[40:43], s67 offen offset:1024 sc1
    s_waitcnt vmcnt(10) lgkmcnt(8)
    v_mfma_f32_16x16x32_bf16 v[4:7], v[56:59], v[104:107], v[4:7]
    ds_read_b64_tr_b16 v[52:53], v88 offset:0
    v_mfma_f32_16x16x32_bf16 v[20:23], v[56:59], v[108:111], v[20:23]
    ds_read_b64_tr_b16 v[54:55], v236 offset:0
    v_mfma_f32_16x16x32_bf16 v[8:11], v[60:63], v[104:107], v[8:11]
    ds_read_b64_tr_b16 v[56:57], v89 offset:0
    v_mfma_f32_16x16x32_bf16 v[24:27], v[60:63], v[108:111], v[24:27]
    ds_read_b64_tr_b16 v[58:59], v237 offset:0
    buffer_load_dwordx4 v[96:99], v224, s[40:43], s67 offen offset:2048 sc1
    v_mfma_f32_16x16x32_bf16 v[12:15], v[64:67], v[104:107], v[12:15]
    ds_read_b64_tr_b16 v[60:61], v90 offset:0
    v_mfma_f32_16x16x32_bf16 v[28:31], v[64:67], v[108:111], v[28:31]
    ds_read_b64_tr_b16 v[62:63], v238 offset:0
    v_mfma_f32_16x16x32_bf16 v[16:19], v[68:71], v[104:107], v[16:19]
    ds_read_b64_tr_b16 v[64:65], v91 offset:0
    v_mfma_f32_16x16x32_bf16 v[32:35], v[68:71], v[108:111], v[32:35]
    ds_read_b64_tr_b16 v[66:67], v239 offset:0
    buffer_load_dwordx4 v[100:103], v225, s[40:43], s67 offen offset:2048 sc1
    s_waitcnt vmcnt(10) lgkmcnt(8)
    v_mfma_f32_16x16x32_bf16 v[4:7], v[36:39], v[112:115], v[4:7]
    ds_read_b64_tr_b16 v[68:69], v88 offset:4096
    v_mfma_f32_16x16x32_bf16 v[20:23], v[36:39], v[116:119], v[20:23]
    ds_read_b64_tr_b16 v[70:71], v236 offset:4096
    v_mfma_f32_16x16x32_bf16 v[8:11], v[40:43], v[112:115], v[8:11]
    ds_read_b64_tr_b16 v[36:37], v89 offset:4096
    v_mfma_f32_16x16x32_bf16 v[24:27], v[40:43], v[116:119], v[24:27]
    ds_read_b64_tr_b16 v[38:39], v237 offset:4096
    buffer_load_dwordx4 v[104:107], v224, s[40:43], s67 offen offset:3072 sc1
    v_mfma_f32_16x16x32_bf16 v[12:15], v[44:47], v[112:115], v[12:15]
    ds_read_b64_tr_b16 v[40:41], v90 offset:4096
    v_mfma_f32_16x16x32_bf16 v[28:31], v[44:47], v[116:119], v[28:31]
    ds_read_b64_tr_b16 v[42:43], v238 offset:4096
    v_mfma_f32_16x16x32_bf16 v[16:19], v[48:51], v[112:115], v[16:19]
    ds_read_b64_tr_b16 v[44:45], v91 offset:4096
    v_mfma_f32_16x16x32_bf16 v[32:35], v[48:51], v[116:119], v[32:35]
    ds_read_b64_tr_b16 v[46:47], v239 offset:4096
    buffer_load_dwordx4 v[108:111], v225, s[40:43], s67 offen offset:3072 sc1
    s_waitcnt vmcnt(10) lgkmcnt(8)
    v_mfma_f32_16x16x32_bf16 v[4:7], v[52:55], v[120:123], v[4:7]
    ds_read_b64_tr_b16 v[48:49], v88 offset:8192
    v_mfma_f32_16x16x32_bf16 v[20:23], v[52:55], v[124:127], v[20:23]
    ds_read_b64_tr_b16 v[50:51], v236 offset:8192
    v_mfma_f32_16x16x32_bf16 v[8:11], v[56:59], v[120:123], v[8:11]
    ds_read_b64_tr_b16 v[52:53], v89 offset:8192
    v_mfma_f32_16x16x32_bf16 v[24:27], v[56:59], v[124:127], v[24:27]
    ds_read_b64_tr_b16 v[54:55], v237 offset:8192
    buffer_load_dwordx4 v[112:115], v224, s[40:43], s68 offen offset:0 sc1
    v_mfma_f32_16x16x32_bf16 v[12:15], v[60:63], v[120:123], v[12:15]
    ds_read_b64_tr_b16 v[56:57], v90 offset:8192
    v_mfma_f32_16x16x32_bf16 v[28:31], v[60:63], v[124:127], v[28:31]
    ds_read_b64_tr_b16 v[58:59], v238 offset:8192
    v_mfma_f32_16x16x32_bf16 v[16:19], v[64:67], v[120:123], v[16:19]
    ds_read_b64_tr_b16 v[60:61], v91 offset:8192
    v_mfma_f32_16x16x32_bf16 v[32:35], v[64:67], v[124:127], v[32:35]
    ds_read_b64_tr_b16 v[62:63], v239 offset:8192
    buffer_load_dwordx4 v[116:119], v225, s[40:43], s68 offen offset:0 sc1
    s_waitcnt vmcnt(10) lgkmcnt(8)
    v_mfma_f32_16x16x32_bf16 v[4:7], v[68:71], v[128:131], v[4:7]
    ds_read_b64_tr_b16 v[64:65], v88 offset:12288
    v_mfma_f32_16x16x32_bf16 v[20:23], v[68:71], v[132:135], v[20:23]
    ds_read_b64_tr_b16 v[66:67], v236 offset:12288
    v_mfma_f32_16x16x32_bf16 v[8:11], v[36:39], v[128:131], v[8:11]
    ds_read_b64_tr_b16 v[68:69], v89 offset:12288
    v_mfma_f32_16x16x32_bf16 v[24:27], v[36:39], v[132:135], v[24:27]
    ds_read_b64_tr_b16 v[70:71], v237 offset:12288
    buffer_load_dwordx4 v[120:123], v224, s[40:43], s68 offen offset:1024 sc1
    v_mfma_f32_16x16x32_bf16 v[12:15], v[40:43], v[128:131], v[12:15]
    ds_read_b64_tr_b16 v[36:37], v90 offset:12288
    v_mfma_f32_16x16x32_bf16 v[28:31], v[40:43], v[132:135], v[28:31]
    ds_read_b64_tr_b16 v[38:39], v238 offset:12288
    v_mfma_f32_16x16x32_bf16 v[16:19], v[44:47], v[128:131], v[16:19]
    ds_read_b64_tr_b16 v[40:41], v91 offset:12288
    v_mfma_f32_16x16x32_bf16 v[32:35], v[44:47], v[132:135], v[32:35]
    ds_read_b64_tr_b16 v[42:43], v239 offset:12288
    buffer_load_dwordx4 v[124:127], v225, s[40:43], s68 offen offset:1024 sc1
    s_waitcnt vmcnt(10) lgkmcnt(8)
    v_mfma_f32_16x16x32_bf16 v[4:7], v[48:51], v[136:139], v[4:7]
    ds_read_b64_tr_b16 v[44:45], v88 offset:16384
    v_mfma_f32_16x16x32_bf16 v[20:23], v[48:51], v[140:143], v[20:23]
    ds_read_b64_tr_b16 v[46:47], v236 offset:16384
    v_mfma_f32_16x16x32_bf16 v[8:11], v[52:55], v[136:139], v[8:11]
    ds_read_b64_tr_b16 v[48:49], v89 offset:16384
    v_mfma_f32_16x16x32_bf16 v[24:27], v[52:55], v[140:143], v[24:27]
    ds_read_b64_tr_b16 v[50:51], v237 offset:16384
    buffer_load_dwordx4 v[128:131], v224, s[40:43], s68 offen offset:2048 sc1
    v_mfma_f32_16x16x32_bf16 v[12:15], v[56:59], v[136:139], v[12:15]
    ds_read_b64_tr_b16 v[52:53], v90 offset:16384
    v_mfma_f32_16x16x32_bf16 v[28:31], v[56:59], v[140:143], v[28:31]
    ds_read_b64_tr_b16 v[54:55], v238 offset:16384
    v_mfma_f32_16x16x32_bf16 v[16:19], v[60:63], v[136:139], v[16:19]
    ds_read_b64_tr_b16 v[56:57], v91 offset:16384
    v_mfma_f32_16x16x32_bf16 v[32:35], v[60:63], v[140:143], v[32:35]
    ds_read_b64_tr_b16 v[58:59], v239 offset:16384
    buffer_load_dwordx4 v[132:135], v225, s[40:43], s68 offen offset:2048 sc1
    s_waitcnt vmcnt(10) lgkmcnt(8)
    v_mfma_f32_16x16x32_bf16 v[4:7], v[64:67], v[144:147], v[4:7]
    ds_read_b64_tr_b16 v[60:61], v88 offset:20480
    v_mfma_f32_16x16x32_bf16 v[20:23], v[64:67], v[148:151], v[20:23]
    ds_read_b64_tr_b16 v[62:63], v236 offset:20480
    v_mfma_f32_16x16x32_bf16 v[8:11], v[68:71], v[144:147], v[8:11]
    ds_read_b64_tr_b16 v[64:65], v89 offset:20480
    v_mfma_f32_16x16x32_bf16 v[24:27], v[68:71], v[148:151], v[24:27]
    ds_read_b64_tr_b16 v[66:67], v237 offset:20480
    buffer_load_dwordx4 v[136:139], v224, s[40:43], s68 offen offset:3072 sc1
    v_mfma_f32_16x16x32_bf16 v[12:15], v[36:39], v[144:147], v[12:15]
    ds_read_b64_tr_b16 v[68:69], v90 offset:20480
    v_mfma_f32_16x16x32_bf16 v[28:31], v[36:39], v[148:151], v[28:31]
    ds_read_b64_tr_b16 v[70:71], v238 offset:20480
    v_mfma_f32_16x16x32_bf16 v[16:19], v[40:43], v[144:147], v[16:19]
    ds_read_b64_tr_b16 v[36:37], v91 offset:20480
    v_mfma_f32_16x16x32_bf16 v[32:35], v[40:43], v[148:151], v[32:35]
    ds_read_b64_tr_b16 v[38:39], v239 offset:20480
    buffer_load_dwordx4 v[140:143], v225, s[40:43], s68 offen offset:3072 sc1
    s_waitcnt vmcnt(10) lgkmcnt(8)
    v_mfma_f32_16x16x32_bf16 v[4:7], v[44:47], v[96:99], v[4:7]
    ds_read_b64_tr_b16 v[40:41], v88 offset:24576
    v_mfma_f32_16x16x32_bf16 v[20:23], v[44:47], v[100:103], v[20:23]
    ds_read_b64_tr_b16 v[42:43], v236 offset:24576
    v_mfma_f32_16x16x32_bf16 v[8:11], v[48:51], v[96:99], v[8:11]
    ds_read_b64_tr_b16 v[44:45], v89 offset:24576
    v_mfma_f32_16x16x32_bf16 v[24:27], v[48:51], v[100:103], v[24:27]
    ds_read_b64_tr_b16 v[46:47], v237 offset:24576
    buffer_load_dwordx4 v[144:147], v224, s[40:43], s69 offen offset:0 sc1
    v_mfma_f32_16x16x32_bf16 v[12:15], v[52:55], v[96:99], v[12:15]
    ds_read_b64_tr_b16 v[48:49], v90 offset:24576
    v_mfma_f32_16x16x32_bf16 v[28:31], v[52:55], v[100:103], v[28:31]
    ds_read_b64_tr_b16 v[50:51], v238 offset:24576
    v_mfma_f32_16x16x32_bf16 v[16:19], v[56:59], v[96:99], v[16:19]
    ds_read_b64_tr_b16 v[52:53], v91 offset:24576
    v_mfma_f32_16x16x32_bf16 v[32:35], v[56:59], v[100:103], v[32:35]
    ds_read_b64_tr_b16 v[54:55], v239 offset:24576
    buffer_load_dwordx4 v[148:151], v225, s[40:43], s69 offen offset:0 sc1
    s_waitcnt vmcnt(10) lgkmcnt(8)
    v_mfma_f32_16x16x32_bf16 v[4:7], v[60:63], v[104:107], v[4:7]
    ds_read_b64_tr_b16 v[56:57], v88 offset:28672
    v_mfma_f32_16x16x32_bf16 v[20:23], v[60:63], v[108:111], v[20:23]
    ds_read_b64_tr_b16 v[58:59], v236 offset:28672
    v_mfma_f32_16x16x32_bf16 v[8:11], v[64:67], v[104:107], v[8:11]
    ds_read_b64_tr_b16 v[60:61], v89 offset:28672
    v_mfma_f32_16x16x32_bf16 v[24:27], v[64:67], v[108:111], v[24:27]
    ds_read_b64_tr_b16 v[62:63], v237 offset:28672
    buffer_load_dwordx4 v[96:99], v224, s[40:43], s69 offen offset:1024 sc1
    v_mfma_f32_16x16x32_bf16 v[12:15], v[68:71], v[104:107], v[12:15]
    ds_read_b64_tr_b16 v[64:65], v90 offset:28672
    v_mfma_f32_16x16x32_bf16 v[28:31], v[68:71], v[108:111], v[28:31]
    ds_read_b64_tr_b16 v[66:67], v238 offset:28672
    v_mfma_f32_16x16x32_bf16 v[16:19], v[36:39], v[104:107], v[16:19]
    ds_read_b64_tr_b16 v[68:69], v91 offset:28672
    v_mfma_f32_16x16x32_bf16 v[32:35], v[36:39], v[108:111], v[32:35]
    ds_read_b64_tr_b16 v[70:71], v239 offset:28672
    buffer_load_dwordx4 v[100:103], v225, s[40:43], s69 offen offset:1024 sc1
    s_waitcnt vmcnt(10) lgkmcnt(8)
    v_mfma_f32_16x16x32_bf16 v[4:7], v[40:43], v[112:115], v[4:7]
    ds_read_b64_tr_b16 v[36:37], v88 offset:32768
    v_mfma_f32_16x16x32_bf16 v[20:23], v[40:43], v[116:119], v[20:23]
    ds_read_b64_tr_b16 v[38:39], v236 offset:32768
    v_mfma_f32_16x16x32_bf16 v[8:11], v[44:47], v[112:115], v[8:11]
    ds_read_b64_tr_b16 v[40:41], v89 offset:32768
    v_mfma_f32_16x16x32_bf16 v[24:27], v[44:47], v[116:119], v[24:27]
    ds_read_b64_tr_b16 v[42:43], v237 offset:32768
    buffer_load_dwordx4 v[104:107], v224, s[40:43], s69 offen offset:2048 sc1
    v_mfma_f32_16x16x32_bf16 v[12:15], v[48:51], v[112:115], v[12:15]
    ds_read_b64_tr_b16 v[44:45], v90 offset:32768
    v_mfma_f32_16x16x32_bf16 v[28:31], v[48:51], v[116:119], v[28:31]
    ds_read_b64_tr_b16 v[46:47], v238 offset:32768
    v_mfma_f32_16x16x32_bf16 v[16:19], v[52:55], v[112:115], v[16:19]
    ds_read_b64_tr_b16 v[48:49], v91 offset:32768
    v_mfma_f32_16x16x32_bf16 v[32:35], v[52:55], v[116:119], v[32:35]
    ds_read_b64_tr_b16 v[50:51], v239 offset:32768
    buffer_load_dwordx4 v[108:111], v225, s[40:43], s69 offen offset:2048 sc1
    ds_read_b32 v1, v228 offset:12
    s_waitcnt vmcnt(10) lgkmcnt(9)
    v_mfma_f32_16x16x32_bf16 v[4:7], v[56:59], v[120:123], v[4:7]
    ds_read_b64_tr_b16 v[52:53], v88 offset:36864
    v_mfma_f32_16x16x32_bf16 v[20:23], v[56:59], v[124:127], v[20:23]
    ds_read_b64_tr_b16 v[54:55], v236 offset:36864
    v_mfma_f32_16x16x32_bf16 v[8:11], v[60:63], v[120:123], v[8:11]
    ds_read_b64_tr_b16 v[56:57], v89 offset:36864
    v_mfma_f32_16x16x32_bf16 v[24:27], v[60:63], v[124:127], v[24:27]
    ds_read_b64_tr_b16 v[58:59], v237 offset:36864
    buffer_load_dwordx4 v[112:115], v224, s[40:43], s69 offen offset:3072 sc1
    v_mfma_f32_16x16x32_bf16 v[12:15], v[64:67], v[120:123], v[12:15]
    ds_read_b64_tr_b16 v[60:61], v90 offset:36864
    v_mfma_f32_16x16x32_bf16 v[28:31], v[64:67], v[124:127], v[28:31]
    ds_read_b64_tr_b16 v[62:63], v238 offset:36864
    v_mfma_f32_16x16x32_bf16 v[16:19], v[68:71], v[120:123], v[16:19]
    ds_read_b64_tr_b16 v[64:65], v91 offset:36864
    v_mfma_f32_16x16x32_bf16 v[32:35], v[68:71], v[124:127], v[32:35]
    ds_read_b64_tr_b16 v[66:67], v239 offset:36864
    buffer_load_dwordx4 v[116:119], v225, s[40:43], s69 offen offset:3072 sc1
    s_waitcnt lgkmcnt(8)
    v_readfirstlane_b32 s37, v1
    s_nop 0
    s_cmp_ge_u32 s37, 4
    s_cbranch_scc1 L_sl_done_57
    s_mov_b32 s38, 1048576
L_sl_loop_58:
    ds_read_b32 v1, v228 offset:12
    s_waitcnt lgkmcnt(0)
    v_readfirstlane_b32 s37, v1
    s_nop 0
    s_cmp_ge_u32 s37, 4
    s_cbranch_scc1 L_sl_done_57
    s_sleep 1
    s_sub_u32 s38, s38, 1
    s_cbranch_scc0 L_sl_loop_58
L_sl_done_57:
    s_waitcnt vmcnt(10)
    v_mfma_f32_16x16x32_bf16 v[4:7], v[36:39], v[128:131], v[4:7]
    ds_read_b64_tr_b16 v[68:69], v92 offset:0
    v_mfma_f32_16x16x32_bf16 v[20:23], v[36:39], v[132:135], v[20:23]
    ds_read_b64_tr_b16 v[70:71], v240 offset:0
    v_mfma_f32_16x16x32_bf16 v[8:11], v[40:43], v[128:131], v[8:11]
    ds_read_b64_tr_b16 v[36:37], v93 offset:0
    v_mfma_f32_16x16x32_bf16 v[24:27], v[40:43], v[132:135], v[24:27]
    ds_read_b64_tr_b16 v[38:39], v241 offset:0
    buffer_load_dwordx4 v[120:123], v224, s[40:43], s70 offen offset:0 sc1
    v_mfma_f32_16x16x32_bf16 v[12:15], v[44:47], v[128:131], v[12:15]
    ds_read_b64_tr_b16 v[40:41], v94 offset:0
    v_mfma_f32_16x16x32_bf16 v[28:31], v[44:47], v[132:135], v[28:31]
    ds_read_b64_tr_b16 v[42:43], v242 offset:0
    v_mfma_f32_16x16x32_bf16 v[16:19], v[48:51], v[128:131], v[16:19]
    ds_read_b64_tr_b16 v[44:45], v95 offset:0
    v_mfma_f32_16x16x32_bf16 v[32:35], v[48:51], v[132:135], v[32:35]
    ds_read_b64_tr_b16 v[46:47], v243 offset:0
    buffer_load_dwordx4 v[124:127], v225, s[40:43], s70 offen offset:0 sc1
    s_waitcnt vmcnt(10) lgkmcnt(8)
    v_mfma_f32_16x16x32_bf16 v[4:7], v[52:55], v[136:139], v[4:7]
    ds_read_b64_tr_b16 v[48:49], v92 offset:4096
    v_mfma_f32_16x16x32_bf16 v[20:23], v[52:55], v[140:143], v[20:23]
    ds_read_b64_tr_b16 v[50:51], v240 offset:4096
    v_mfma_f32_16x16x32_bf16 v[8:11], v[56:59], v[136:139], v[8:11]
    ds_read_b64_tr_b16 v[52:53], v93 offset:4096
    v_mfma_f32_16x16x32_bf16 v[24:27], v[56:59], v[140:143], v[24:27]
    ds_read_b64_tr_b16 v[54:55], v241 offset:4096
    buffer_load_dwordx4 v[128:131], v224, s[40:43], s70 offen offset:1024 sc1
    v_mfma_f32_16x16x32_bf16 v[12:15], v[60:63], v[136:139], v[12:15]
    ds_read_b64_tr_b16 v[56:57], v94 offset:4096
    v_mfma_f32_16x16x32_bf16 v[28:31], v[60:63], v[140:143], v[28:31]
    ds_read_b64_tr_b16 v[58:59], v242 offset:4096
    v_mfma_f32_16x16x32_bf16 v[16:19], v[64:67], v[136:139], v[16:19]
    ds_read_b64_tr_b16 v[60:61], v95 offset:4096
    v_mfma_f32_16x16x32_bf16 v[32:35], v[64:67], v[140:143], v[32:35]
    ds_read_b64_tr_b16 v[62:63], v243 offset:4096
    buffer_load_dwordx4 v[132:135], v225, s[40:43], s70 offen offset:1024 sc1
    s_waitcnt vmcnt(10) lgkmcnt(8)
    v_mfma_f32_16x16x32_bf16 v[4:7], v[68:71], v[144:147], v[4:7]
    ds_read_b64_tr_b16 v[64:65], v92 offset:8448
    v_mfma_f32_16x16x32_bf16 v[20:23], v[68:71], v[148:151], v[20:23]
    ds_read_b64_tr_b16 v[66:67], v240 offset:8448
    v_mfma_f32_16x16x32_bf16 v[8:11], v[36:39], v[144:147], v[8:11]
    ds_read_b64_tr_b16 v[68:69], v93 offset:8448
    v_mfma_f32_16x16x32_bf16 v[24:27], v[36:39], v[148:151], v[24:27]
    ds_read_b64_tr_b16 v[70:71], v241 offset:8448
    buffer_load_dwordx4 v[136:139], v224, s[40:43], s70 offen offset:2048 sc1
    v_mfma_f32_16x16x32_bf16 v[12:15], v[40:43], v[144:147], v[12:15]
    ds_read_b64_tr_b16 v[36:37], v94 offset:8448
    v_mfma_f32_16x16x32_bf16 v[28:31], v[40:43], v[148:151], v[28:31]
    ds_read_b64_tr_b16 v[38:39], v242 offset:8448
    v_mfma_f32_16x16x32_bf16 v[16:19], v[44:47], v[144:147], v[16:19]
    ds_read_b64_tr_b16 v[40:41], v95 offset:8448
    v_mfma_f32_16x16x32_bf16 v[32:35], v[44:47], v[148:151], v[32:35]
    ds_read_b64_tr_b16 v[42:43], v243 offset:8448
    buffer_load_dwordx4 v[140:143], v225, s[40:43], s70 offen offset:2048 sc1
    s_waitcnt vmcnt(10) lgkmcnt(8)
    v_mfma_f32_16x16x32_bf16 v[4:7], v[48:51], v[96:99], v[4:7]
    ds_read_b64_tr_b16 v[44:45], v92 offset:12544
    v_mfma_f32_16x16x32_bf16 v[20:23], v[48:51], v[100:103], v[20:23]
    ds_read_b64_tr_b16 v[46:47], v240 offset:12544
    v_mfma_f32_16x16x32_bf16 v[8:11], v[52:55], v[96:99], v[8:11]
    ds_read_b64_tr_b16 v[48:49], v93 offset:12544
    v_mfma_f32_16x16x32_bf16 v[24:27], v[52:55], v[100:103], v[24:27]
    ds_read_b64_tr_b16 v[50:51], v241 offset:12544
    buffer_load_dwordx4 v[144:147], v224, s[40:43], s70 offen offset:3072 sc1
    v_mfma_f32_16x16x32_bf16 v[12:15], v[56:59], v[96:99], v[12:15]
    ds_read_b64_tr_b16 v[52:53], v94 offset:12544
    v_mfma_f32_16x16x32_bf16 v[28:31], v[56:59], v[100:103], v[28:31]
    ds_read_b64_tr_b16 v[54:55], v242 offset:12544
    v_mfma_f32_16x16x32_bf16 v[16:19], v[60:63], v[96:99], v[16:19]
    ds_read_b64_tr_b16 v[56:57], v95 offset:12544
    v_mfma_f32_16x16x32_bf16 v[32:35], v[60:63], v[100:103], v[32:35]
    ds_read_b64_tr_b16 v[58:59], v243 offset:12544
    buffer_load_dwordx4 v[148:151], v225, s[40:43], s70 offen offset:3072 sc1
    s_waitcnt vmcnt(10) lgkmcnt(8)
    v_mfma_f32_16x16x32_bf16 v[4:7], v[64:67], v[104:107], v[4:7]
    ds_read_b64_tr_b16 v[60:61], v92 offset:16896
    v_mfma_f32_16x16x32_bf16 v[20:23], v[64:67], v[108:111], v[20:23]
    ds_read_b64_tr_b16 v[62:63], v240 offset:16896
    v_mfma_f32_16x16x32_bf16 v[8:11], v[68:71], v[104:107], v[8:11]
    ds_read_b64_tr_b16 v[64:65], v93 offset:16896
    v_mfma_f32_16x16x32_bf16 v[24:27], v[68:71], v[108:111], v[24:27]
    ds_read_b64_tr_b16 v[66:67], v241 offset:16896
    buffer_load_dwordx4 v[96:99], v224, s[40:43], s71 offen offset:0 sc1
    v_mfma_f32_16x16x32_bf16 v[12:15], v[36:39], v[104:107], v[12:15]
    ds_read_b64_tr_b16 v[68:69], v94 offset:16896
    v_mfma_f32_16x16x32_bf16 v[28:31], v[36:39], v[108:111], v[28:31]
    ds_read_b64_tr_b16 v[70:71], v242 offset:16896
    v_mfma_f32_16x16x32_bf16 v[16:19], v[40:43], v[104:107], v[16:19]
    ds_read_b64_tr_b16 v[36:37], v95 offset:16896
    v_mfma_f32_16x16x32_bf16 v[32:35], v[40:43], v[108:111], v[32:35]
    ds_read_b64_tr_b16 v[38:39], v243 offset:16896
    buffer_load_dwordx4 v[100:103], v225, s[40:43], s71 offen offset:0 sc1
    s_waitcnt vmcnt(10) lgkmcnt(8)
    v_mfma_f32_16x16x32_bf16 v[4:7], v[44:47], v[112:115], v[4:7]
    ds_read_b64_tr_b16 v[40:41], v92 offset:20992
    v_mfma_f32_16x16x32_bf16 v[20:23], v[44:47], v[116:119], v[20:23]
    ds_read_b64_tr_b16 v[42:43], v240 offset:20992
    v_mfma_f32_16x16x32_bf16 v[8:11], v[48:51], v[112:115], v[8:11]
    ds_read_b64_tr_b16 v[44:45], v93 offset:20992
    v_mfma_f32_16x16x32_bf16 v[24:27], v[48:51], v[116:119], v[24:27]
    ds_read_b64_tr_b16 v[46:47], v241 offset:20992
    buffer_load_dwordx4 v[104:107], v224, s[40:43], s71 offen offset:1024 sc1
    v_mfma_f32_16x16x32_bf16 v[12:15], v[52:55], v[112:115], v[12:15]
    ds_read_b64_tr_b16 v[48:49], v94 offset:20992
    v_mfma_f32_16x16x32_bf16 v[28:31], v[52:55], v[116:119], v[28:31]
    ds_read_b64_tr_b16 v[50:51], v242 offset:20992
    v_mfma_f32_16x16x32_bf16 v[16:19], v[56:59], v[112:115], v[16:19]
    ds_read_b64_tr_b16 v[52:53], v95 offset:20992
    v_mfma_f32_16x16x32_bf16 v[32:35], v[56:59], v[116:119], v[32:35]
    ds_read_b64_tr_b16 v[54:55], v243 offset:20992
    buffer_load_dwordx4 v[108:111], v225, s[40:43], s71 offen offset:1024 sc1
    s_waitcnt vmcnt(10) lgkmcnt(8)
    v_mfma_f32_16x16x32_bf16 v[4:7], v[60:63], v[120:123], v[4:7]
    ds_read_b64_tr_b16 v[56:57], v92 offset:25344
    v_mfma_f32_16x16x32_bf16 v[20:23], v[60:63], v[124:127], v[20:23]
    ds_read_b64_tr_b16 v[58:59], v240 offset:25344
    v_mfma_f32_16x16x32_bf16 v[8:11], v[64:67], v[120:123], v[8:11]
    ds_read_b64_tr_b16 v[60:61], v93 offset:25344
    v_mfma_f32_16x16x32_bf16 v[24:27], v[64:67], v[124:127], v[24:27]
    ds_read_b64_tr_b16 v[62:63], v241 offset:25344
    buffer_load_dwordx4 v[112:115], v224, s[40:43], s71 offen offset:2048 sc1
    v_mfma_f32_16x16x32_bf16 v[12:15], v[68:71], v[120:123], v[12:15]
    ds_read_b64_tr_b16 v[64:65], v94 offset:25344
    v_mfma_f32_16x16x32_bf16 v[28:31], v[68:71], v[124:127], v[28:31]
    ds_read_b64_tr_b16 v[66:67], v242 offset:25344
    v_mfma_f32_16x16x32_bf16 v[16:19], v[36:39], v[120:123], v[16:19]
    ds_read_b64_tr_b16 v[68:69], v95 offset:25344
    v_mfma_f32_16x16x32_bf16 v[32:35], v[36:39], v[124:127], v[32:35]
    ds_read_b64_tr_b16 v[70:71], v243 offset:25344
    buffer_load_dwordx4 v[116:119], v225, s[40:43], s71 offen offset:2048 sc1
    s_waitcnt vmcnt(10) lgkmcnt(8)
    v_mfma_f32_16x16x32_bf16 v[4:7], v[40:43], v[128:131], v[4:7]
    ds_read_b64_tr_b16 v[36:37], v92 offset:29440
    v_mfma_f32_16x16x32_bf16 v[20:23], v[40:43], v[132:135], v[20:23]
    ds_read_b64_tr_b16 v[38:39], v240 offset:29440
    v_mfma_f32_16x16x32_bf16 v[8:11], v[44:47], v[128:131], v[8:11]
    ds_read_b64_tr_b16 v[40:41], v93 offset:29440
    v_mfma_f32_16x16x32_bf16 v[24:27], v[44:47], v[132:135], v[24:27]
    ds_read_b64_tr_b16 v[42:43], v241 offset:29440
    buffer_load_dwordx4 v[120:123], v224, s[40:43], s71 offen offset:3072 sc1
    v_mfma_f32_16x16x32_bf16 v[12:15], v[48:51], v[128:131], v[12:15]
    ds_read_b64_tr_b16 v[44:45], v94 offset:29440
    v_mfma_f32_16x16x32_bf16 v[28:31], v[48:51], v[132:135], v[28:31]
    ds_read_b64_tr_b16 v[46:47], v242 offset:29440
    v_mfma_f32_16x16x32_bf16 v[16:19], v[52:55], v[128:131], v[16:19]
    ds_read_b64_tr_b16 v[48:49], v95 offset:29440
    v_mfma_f32_16x16x32_bf16 v[32:35], v[52:55], v[132:135], v[32:35]
    ds_read_b64_tr_b16 v[50:51], v243 offset:29440
    buffer_load_dwordx4 v[124:127], v225, s[40:43], s71 offen offset:3072 sc1
    s_waitcnt vmcnt(10) lgkmcnt(8)
    v_mfma_f32_16x16x32_bf16 v[4:7], v[56:59], v[136:139], v[4:7]
    ds_read_b64_tr_b16 v[52:53], v84 offset:41984
    v_mfma_f32_16x16x32_bf16 v[20:23], v[56:59], v[140:143], v[20:23]
    ds_read_b64_tr_b16 v[54:55], v232 offset:41984
    v_mfma_f32_16x16x32_bf16 v[8:11], v[60:63], v[136:139], v[8:11]
    ds_read_b64_tr_b16 v[56:57], v85 offset:41984
    v_mfma_f32_16x16x32_bf16 v[24:27], v[60:63], v[140:143], v[24:27]
    ds_read_b64_tr_b16 v[58:59], v233 offset:41984
    v_mfma_f32_16x16x32_bf16 v[12:15], v[64:67], v[136:139], v[12:15]
    ds_read_b64_tr_b16 v[60:61], v86 offset:41984
    v_mfma_f32_16x16x32_bf16 v[28:31], v[64:67], v[140:143], v[28:31]
    ds_read_b64_tr_b16 v[62:63], v234 offset:41984
    v_mfma_f32_16x16x32_bf16 v[16:19], v[68:71], v[136:139], v[16:19]
    ds_read_b64_tr_b16 v[64:65], v87 offset:41984
    v_mfma_f32_16x16x32_bf16 v[32:35], v[68:71], v[140:143], v[32:35]
    ds_read_b64_tr_b16 v[66:67], v235 offset:41984
    s_waitcnt vmcnt(8) lgkmcnt(8)
    v_mfma_f32_16x16x32_bf16 v[4:7], v[36:39], v[144:147], v[4:7]
    ds_read_b64_tr_b16 v[68:69], v84 offset:46080
    v_mfma_f32_16x16x32_bf16 v[20:23], v[36:39], v[148:151], v[20:23]
    ds_read_b64_tr_b16 v[70:71], v232 offset:46080
    v_mfma_f32_16x16x32_bf16 v[8:11], v[40:43], v[144:147], v[8:11]
    ds_read_b64_tr_b16 v[36:37], v85 offset:46080
    v_mfma_f32_16x16x32_bf16 v[24:27], v[40:43], v[148:151], v[24:27]
    ds_read_b64_tr_b16 v[38:39], v233 offset:46080
    v_mfma_f32_16x16x32_bf16 v[12:15], v[44:47], v[144:147], v[12:15]
    ds_read_b64_tr_b16 v[40:41], v86 offset:46080
    v_mfma_f32_16x16x32_bf16 v[28:31], v[44:47], v[148:151], v[28:31]
    ds_read_b64_tr_b16 v[42:43], v234 offset:46080
    v_mfma_f32_16x16x32_bf16 v[16:19], v[48:51], v[144:147], v[16:19]
    ds_read_b64_tr_b16 v[44:45], v87 offset:46080
    v_mfma_f32_16x16x32_bf16 v[32:35], v[48:51], v[148:151], v[32:35]
    ds_read_b64_tr_b16 v[46:47], v235 offset:46080
    s_waitcnt vmcnt(6) lgkmcnt(8)
    v_mfma_f32_16x16x32_bf16 v[4:7], v[52:55], v[96:99], v[4:7]
    ds_read_b64_tr_b16 v[48:49], v84 offset:51200
    v_mfma_f32_16x16x32_bf16 v[20:23], v[52:55], v[100:103], v[20:23]
    ds_read_b64_tr_b16 v[50:51], v232 offset:51200
    v_mfma_f32_16x16x32_bf16 v[8:11], v[56:59], v[96:99], v[8:11]
    ds_read_b64_tr_b16 v[52:53], v85 offset:51200
    v_mfma_f32_16x16x32_bf16 v[24:27], v[56:59], v[100:103], v[24:27]
    ds_read_b64_tr_b16 v[54:55], v233 offset:51200
    v_mfma_f32_16x16x32_bf16 v[12:15], v[60:63], v[96:99], v[12:15]
    ds_read_b64_tr_b16 v[56:57], v86 offset:51200
    v_mfma_f32_16x16x32_bf16 v[28:31], v[60:63], v[100:103], v[28:31]
    ds_read_b64_tr_b16 v[58:59], v234 offset:51200
    v_mfma_f32_16x16x32_bf16 v[16:19], v[64:67], v[96:99], v[16:19]
    ds_read_b64_tr_b16 v[60:61], v87 offset:51200
    v_mfma_f32_16x16x32_bf16 v[32:35], v[64:67], v[100:103], v[32:35]
    ds_read_b64_tr_b16 v[62:63], v235 offset:51200
    s_waitcnt vmcnt(4) lgkmcnt(8)
    v_mfma_f32_16x16x32_bf16 v[4:7], v[68:71], v[104:107], v[4:7]
    ds_read_b64_tr_b16 v[64:65], v84 offset:55296
    v_mfma_f32_16x16x32_bf16 v[20:23], v[68:71], v[108:111], v[20:23]
    ds_read_b64_tr_b16 v[66:67], v232 offset:55296
    v_mfma_f32_16x16x32_bf16 v[8:11], v[36:39], v[104:107], v[8:11]
    ds_read_b64_tr_b16 v[68:69], v85 offset:55296
    v_mfma_f32_16x16x32_bf16 v[24:27], v[36:39], v[108:111], v[24:27]
    ds_read_b64_tr_b16 v[70:71], v233 offset:55296
    v_mfma_f32_16x16x32_bf16 v[12:15], v[40:43], v[104:107], v[12:15]
    ds_read_b64_tr_b16 v[36:37], v86 offset:55296
    v_mfma_f32_16x16x32_bf16 v[28:31], v[40:43], v[108:111], v[28:31]
    ds_read_b64_tr_b16 v[38:39], v234 offset:55296
    v_mfma_f32_16x16x32_bf16 v[16:19], v[44:47], v[104:107], v[16:19]
    ds_read_b64_tr_b16 v[40:41], v87 offset:55296
    v_mfma_f32_16x16x32_bf16 v[32:35], v[44:47], v[108:111], v[32:35]
    ds_read_b64_tr_b16 v[42:43], v235 offset:55296
    s_waitcnt vmcnt(2) lgkmcnt(8)
    v_mfma_f32_16x16x32_bf16 v[4:7], v[48:51], v[112:115], v[4:7]
    v_mfma_f32_16x16x32_bf16 v[8:11], v[52:55], v[112:115], v[8:11]
    v_mfma_f32_16x16x32_bf16 v[12:15], v[56:59], v[112:115], v[12:15]
    v_mfma_f32_16x16x32_bf16 v[16:19], v[60:63], v[112:115], v[16:19]
    s_waitcnt vmcnt(0) lgkmcnt(0)
    v_mfma_f32_16x16x32_bf16 v[4:7], v[64:67], v[120:123], v[4:7]
    s_nop 0
    s_nop 0
    v_mfma_f32_16x16x32_bf16 v[8:11], v[68:71], v[120:123], v[8:11]
    s_nop 0
    s_nop 0
    v_mfma_f32_16x16x32_bf16 v[12:15], v[36:39], v[120:123], v[12:15]
    s_nop 0
    s_nop 0
    v_cvt_pk_bf16_f32 v172, v4, v5
    v_cvt_pk_bf16_f32 v173, v6, v7
    v_mfma_f32_16x16x32_bf16 v[16:19], v[40:43], v[120:123], v[16:19]
    ds_write_b64 v244, v[172:173]
    v_cvt_pk_bf16_f32 v174, v8, v9
    v_mfma_f32_16x16x32_bf16 v[20:23], v[48:51], v[116:119], v[20:23]
    v_cvt_pk_bf16_f32 v175, v10, v11
    ds_write_b64 v245, v[174:175]
    v_mfma_f32_16x16x32_bf16 v[20:23], v[64:67], v[124:127], v[20:23]
    v_cvt_pk_bf16_f32 v176, v12, v13
    v_cvt_pk_bf16_f32 v177, v14, v15
    v_mfma_f32_16x16x32_bf16 v[24:27], v[52:55], v[116:119], v[24:27]
    ds_write_b64 v246, v[176:177]
    v_cvt_pk_bf16_f32 v178, v16, v17
    v_mfma_f32_16x16x32_bf16 v[24:27], v[68:71], v[124:127], v[24:27]
    v_cvt_pk_bf16_f32 v179, v18, v19
    ds_write_b64 v247, v[178:179]
    v_mfma_f32_16x16x32_bf16 v[28:31], v[56:59], v[116:119], v[28:31]
    ds_read_b128 v[188:191], v248 offset:0
    ds_read_b128 v[192:195], v248 offset:1024
    v_mfma_f32_16x16x32_bf16 v[28:31], v[36:39], v[124:127], v[28:31]
    v_cvt_pk_bf16_f32 v180, v20, v21
    v_cvt_pk_bf16_f32 v181, v22, v23
    v_mfma_f32_16x16x32_bf16 v[32:35], v[60:63], v[116:119], v[32:35]
    ds_write_b64 v244, v[180:181]
    v_cvt_pk_bf16_f32 v182, v24, v25
    v_mfma_f32_16x16x32_bf16 v[32:35], v[40:43], v[124:127], v[32:35]
    v_cvt_pk_bf16_f32 v183, v26, v27
    ds_write_b64 v245, v[182:183]
    v_cvt_pk_bf16_f32 v184, v28, v29
    v_cvt_pk_bf16_f32 v185, v30, v31
    s_mov_b32 s37, 0
    s_waitcnt lgkmcnt(3)
    buffer_store_dwordx4 v[188:191], v226, s[48:51], s37 offen nt
    s_mov_b32 s37, 65536
    s_waitcnt lgkmcnt(2)
    buffer_store_dwordx4 v[192:195], v226, s[48:51], s37 offen nt
    ds_write_b64 v246, v[184:185]
    v_cvt_pk_bf16_f32 v186, v32, v33
    v_cvt_pk_bf16_f32 v187, v34, v35
    ds_write_b64 v247, v[186:187]
    ds_read_b128 v[196:199], v248 offset:0
    ds_read_b128 v[200:203], v248 offset:1024
    s_mov_b32 s37, 131072
    s_waitcnt lgkmcnt(1)
    buffer_store_dwordx4 v[196:199], v226, s[48:51], s37 offen nt
    s_mov_b32 s37, 196608
    s_waitcnt lgkmcnt(0)
    buffer_store_dwordx4 v[200:203], v226, s[48:51], s37 offen nt
    s_endpgm
L_g1_rare:
    s_waitcnt vmcnt(0)
    s_cmp_lg_u32 s36, 1
    s_cbranch_scc1 L_g1_bar
    v_readfirstlane_b32 s38, v1
    s_nop 0
    s_cmp_ge_u32 s38, 4
    s_cbranch_scc1 L_sl_done_59
    s_mov_b32 s39, 1048576
L_sl_loop_60:
    ds_read_b32 v1, v228 offset:24
    s_waitcnt lgkmcnt(0)
    v_readfirstlane_b32 s38, v1
    s_nop 0
    s_cmp_ge_u32 s38, 4
    s_cbranch_scc1 L_sl_done_59
    s_sleep 1
    s_sub_u32 s39, s39, 1
    s_cbranch_scc0 L_sl_loop_60
L_sl_done_59:
    s_branch L_g1_nobar
L_end:
    s_endpgm
.section .rodata,"a"
.p2align 6
.amdhsa_kernel concat_heads__ssm_conv_h3__sliding_local_dilated__prompt_kernel
  .amdhsa_next_free_vgpr 256
  .amdhsa_next_free_sgpr 102
  .amdhsa_accum_offset 256
  .amdhsa_group_segment_fixed_size 0
  .amdhsa_kernarg_size 96
  .amdhsa_user_sgpr_count 2
  .amdhsa_user_sgpr_kernarg_segment_ptr 1
  .amdhsa_system_sgpr_workgroup_id_x 1
  .amdhsa_float_denorm_mode_32 3
.end_amdhsa_kernel
```

```asm
; @launch grid=(256,1,1) block=(512,1,1) lds=163840
.amdgcn_target "amdgcn-amd-amdhsa--gfx950"
.text
.globl concat_heads__ssm_conv_h3__sliding_local_dilated__prompt_kernel
.p2align 8
.type concat_heads__ssm_conv_h3__sliding_local_dilated__prompt_kernel,@function
concat_heads__ssm_conv_h3__sliding_local_dilated__prompt_kernel:
L_entry:
    s_getpc_b64 s[32:33]
    s_cmp_ge_u32 s2, 256
    s_cbranch_scc1 L_end
    s_load_dwordx16 s[8:23], s[0:1], 0
    s_load_dwordx8 s[24:31], s[0:1], 64
    v_lshrrev_b32 v1, 6, v0
    s_and_b32 s4, s2, 1
    v_readfirstlane_b32 s3, v1
    v_and_b32 v0, 63, v0
    s_bfe_u32 s5, s2, 0x30003
    s_bfe_u32 s6, s2, 0x20001
    s_lshr_b32 s7, s2, 6
    s_lshl2_add_u32 s6, s6, s7
    s_cmp_ge_u32 s3, 4
    s_cbranch_scc1 L_crole
    s_bfe_u32 s34, s2, 0x20003
    s_lshl2_add_u32 s34, s34, s3
    s_lshl_b32 s34, s34, 7
    v_lshl_add_u32 v1, v0, 11, s34
    v_min_u32 v1, L_end-L_entry-8, v1
    s_mov_b64 exec, 0xffff
    global_load_dword v249, v1, s[32:33]
    s_mov_b64 exec, -1
    s_and_b32 s84, s2, 3
    s_lshl2_add_u32 s84, s84, s3
    s_lshr_b32 s85, s2, 2
    s_mul_i32 s86, s3, 8448
    s_add_u32 s86, s86, 125952
    s_lshl_b32 s87, s85, 9
    s_add_u32 s87, s87, s84
    s_lshl_b32 s87, s87, 7
    v_and_b32 v231, 7, v0
    v_lshl_add_u32 v231, v231, 4, s87
    v_lshrrev_b32 v230, 3, v0
    v_lshl_add_u32 v230, v230, 13, v231
    v_subrev_u32 v231, 6144, v230
    v_subrev_u32 v232, 4096, v230
    v_subrev_u32 v233, 2048, v230
    v_add_u32 v234, 4096, v230
    v_lshlrev_b32 v235, 4, v0
    s_lshl_b32 s87, s84, 9
    s_add_u32 m0, s86, 4224
    s_waitcnt lgkmcnt(0)
    s_mov_b32 s80, s14
    s_mov_b32 s81, s15
    s_mov_b32 s82, 0x2000
    s_mov_b32 s83, 0x20000
    s_mov_b32 s72, s10
    s_mov_b32 s73, s11
    s_mov_b32 s74, 0x400000
    s_mov_b32 s75, 0x20000
    s_mov_b32 exec_hi, 0
    buffer_load_dwordx4 v235, s[80:83], s87 offen lds
    s_mov_b64 exec, -1
    buffer_load_dwordx4 v[108:111], v231, s[72:75], 0 offen offset:0 nt
    buffer_load_dwordx4 v[112:115], v232, s[72:75], 0 offen offset:0 nt
    buffer_load_dwordx4 v[116:119], v233, s[72:75], 0 offen offset:0 nt
    buffer_load_dwordx4 v[120:123], v230, s[72:75], 0 offen offset:0 nt
    buffer_load_dwordx4 v[124:127], v230, s[72:75], 0 offen offset:2048 nt
    buffer_load_dwordx4 v[128:131], v234, s[72:75], 0 offen offset:0 nt
    buffer_load_dwordx4 v[132:135], v234, s[72:75], 0 offen offset:2048 nt
    s_mov_b32 s76, s12
    s_mov_b32 s77, s13
    s_mov_b32 s78, 0x400000
    s_mov_b32 s79, 0x20000
    buffer_load_dwordx4 v[136:139], v230, s[76:79], 0 offen offset:0 nt
    buffer_load_dwordx4 v[140:143], v230, s[76:79], 0 offen offset:2048 nt
    buffer_load_dwordx4 v[144:147], v234, s[76:79], 0 offen offset:0 nt
    buffer_load_dwordx4 v[148:151], v234, s[76:79], 0 offen offset:2048 nt
    s_branch L_grole
L_crole:
    s_sub_u32 s70, s3, 4
    s_lshl_b32 s43, s70, 12
    s_lshl_b32 s44, s70, 11
    s_add_u32 s44, s44, 17408
    s_lshl_b32 s49, s70, 4
    s_lshl_b64 s[46:47], 0xffff, s49
    v_lshrrev_b32 v13, 3, v0
    v_and_b32 v14, 7, v0
    v_lshrrev_b32 v15, 4, v0
    s_lshl2_add_u32 s50, s5, s70
    s_lshl_b32 s50, s50, 6
    s_add_u32 s50, s50, s4
    s_lshl_b32 s50, s50, 11
    v_lshl_add_u32 v16, v13, 12, s50
    v_xor_b32 v17, v14, v15
    v_lshl_add_u32 v2, v17, 4, v16
    v_xor_b32 v3, 64, v2
    v_add_u32 v3, 31744, v3
    v_add_u32 v4, 63488, v2
    v_add_u32 v5, 63488, v3
    s_lshl_b32 s49, s5, 7
    s_sub_u32 s49, s49, 8
    s_max_i32 s49, s49, 0
    s_lshl1_add_u32 s49, s49, s4
    s_lshl_b32 s49, s49, 11
    v_lshl_add_u32 v16, v13, 12, s49
    v_lshlrev_b32 v17, 1, v15
    v_xor_b32 v18, v14, v13
    v_lshl_add_u32 v6, v18, 4, v16
    s_mul_i32 s49, s70, 768
    s_add_u32 s49, s49, s6
    s_lshl_b32 s49, s49, 7
    v_mul_u32_u24 v16, 6144, v13
    v_and_b32 v17, 2, v17
    v_xor_b32 v17, v14, v17
    v_lshlrev_b32 v17, 4, v17
    v_add3_u32 v7, v17, v16, s49
    v_xor_b32 v8, 64, v7
    v_add_u32 v8, 48128, v8
    v_add_u32 v9, 2048, v7
    v_add_u32 v10, 2048, v8
    v_add_u32 v11, 4096, v7
    v_add_u32 v12, 4096, v8
    s_movk_i32 s40, 0
    s_mov_b32 s41, 0
    s_lshr_b32 s90, s2, 3
    s_and_b32 s91, s3, 3
    s_lshl2_add_u32 s90, s90, s91
    s_and_b32 s91, s2, 6
    s_lshl3_add_u32 s88, s90, s91
    s_lshl1_add_u32 s88, s88, s4
    s_lshl_b32 s88, s88, 11
    s_and_b32 s89, s2, 7
    s_and_b32 s91, s90, 1
    s_lshl1_add_u32 s89, s89, s91
    s_lshr_b32 s90, s90, 1
    s_mul_i32 s90, s90, 48
    s_add_u32 s89, s89, s90
    s_lshl_b32 s89, s89, 7
    v_and_b32 v251, 1, v0
    v_lshlrev_b32 v251, 12, v251
    v_lshrrev_b32 v252, 1, v0
    v_lshl_add_u32 v251, v252, 7, v251
    v_lshrrev_b32 v250, 2, v0
    v_mul_u32_u24 v250, 393216, v250
    v_and_b32 v252, 3, v0
    v_lshl_add_u32 v252, v252, 11, v250
    s_waitcnt lgkmcnt(0)
    s_mov_b32 s32, s20
    s_mov_b32 s33, s21
    s_mov_b32 s34, 0x400000
    s_mov_b32 s35, 0x20000
    s_mov_b32 s36, s22
    s_mov_b32 s37, s23
    s_mov_b32 s38, 0x600000
    s_mov_b32 s39, 0x20000
    s_setprio 0
    s_and_b32 s73, s2, 7
    s_xor_b32 s73, s73, 2
    s_lshr_b32 s74, s2, 7
    s_lshl1_add_u32 s68, s73, s74
    s_bfe_u32 s69, s2, 0x40003
    s_lshl4_add_u32 s71, s68, s69
    s_lshl2_add_u32 s71, s71, s70
    s_mul_i32 s80, s70, 8448
    s_add_u32 s80, s80, 125952
    s_mul_i32 s81, s70, 9216
    s_add_u32 s81, s81, 41984
    s_add_u32 s52, s30, 0xe00000
    s_addc_u32 s53, s31, 0
    s_mov_b32 s54, 0x20000
    s_mov_b32 s55, 0x20000
    s_add_u32 s64, s30, 0x900000
    s_addc_u32 s65, s31, 0
    s_mov_b32 s66, 0x420000
    s_mov_b32 s67, 0x20000
    s_lshl_b32 s84, s71, 12
    s_mul_i32 s85, s71, 4224
    s_add_u32 s85, s85, 4194304
    s_lshr_b32 s72, s71, 1
    s_lshl_b32 s72, s72, 2
    s_load_dword s72, s[18:19], s72
    v_lshlrev_b32 v224, 4, v0
    v_mov_b32 v228, 0
    v_mov_b32 v229, 0
    v_mov_b32 v230, 0
    v_mov_b32 v231, 0
    v_mov_b32 v227, 134352
    v_mov_b32 v244, 1
    s_bfe_u32 s87, s2, 0x20006
    s_mov_b64 exec, 1
    ds_write_b128 v227, v[228:231]
    ds_write_b128 v227, v[228:231] offset:16
    ds_write_b128 v227, v[228:231] offset:32
    s_mov_b64 exec, -1
    s_mov_b32 exec_lo, 0x7777
    s_mov_b32 exec_hi, 0x0
    s_bfe_u32 s7, s89, 0x30007
    s_cmp_lg_u32 s7, 1
    s_cbranch_scc1 L_wx3_1
    buffer_load_dword v250, v252, s[36:39], s89 offen offset:256
L_wx3_1:
    buffer_load_dword v250, v252, s[36:39], s89 offen
    s_mov_b32 exec_lo, 0xff
    s_mov_b32 exec_hi, 0
    buffer_load_dword v250, v251, s[32:35], s88 offen
    s_mov_b64 exec, -1
    s_add_u32 m0, s43, 0
    s_nop 0
    buffer_load_dwordx4 v2, s[32:35], s40 offen offset:0 lds
    s_add_u32 m0, s44, 0
    s_nop 0
    buffer_load_dwordx4 v7, s[36:39], s41 offen offset:0 lds
    buffer_load_dwordx4 v8, s[36:39], s41 offen offset:1024 lds
    s_add_u32 m0, s43, 0
    s_nop 0
    buffer_load_dwordx4 v3, s[32:35], s40 offen offset:1024 lds
    s_add_u32 m0, s44, 8192
    s_nop 0
    buffer_load_dwordx4 v9, s[36:39], s41 offen offset:0 lds
    buffer_load_dwordx4 v10, s[36:39], s41 offen offset:1024 lds
    s_add_u32 m0, s43, 0
    s_nop 0
    buffer_load_dwordx4 v4, s[32:35], s40 offen offset:2048 lds
    s_add_u32 m0, s44, 16384
    s_nop 0
    buffer_load_dwordx4 v11, s[36:39], s41 offen offset:0 lds
    buffer_load_dwordx4 v12, s[36:39], s41 offen offset:1024 lds
    s_add_u32 m0, s43, 0
    s_nop 0
    buffer_load_dwordx4 v5, s[32:35], s40 offen offset:3072 lds
    s_mov_b32 m0, 16384
    s_mov_b64 exec, s[46:47]
    buffer_load_dwordx4 v6, s[32:35], s40 offen lds
    s_mov_b64 exec, -1
    s_movk_i32 s40, 128
    s_mov_b32 s41, 393216
    s_add_u32 m0, s43, 41984
    s_nop 0
    buffer_load_dwordx4 v2, s[32:35], s40 offen offset:0 lds
    s_add_u32 m0, s44, 41984
    s_nop 0
    buffer_load_dwordx4 v7, s[36:39], s41 offen offset:0 lds
    buffer_load_dwordx4 v8, s[36:39], s41 offen offset:1024 lds
    s_add_u32 m0, s43, 41984
    s_nop 0
    buffer_load_dwordx4 v3, s[32:35], s40 offen offset:1024 lds
    s_add_u32 m0, s44, 50176
    s_nop 0
    buffer_load_dwordx4 v9, s[36:39], s41 offen offset:0 lds
    buffer_load_dwordx4 v10, s[36:39], s41 offen offset:1024 lds
    s_add_u32 m0, s43, 41984
    s_nop 0
    buffer_load_dwordx4 v4, s[32:35], s40 offen offset:2048 lds
    s_add_u32 m0, s44, 58368
    s_nop 0
    buffer_load_dwordx4 v11, s[36:39], s41 offen offset:0 lds
    buffer_load_dwordx4 v12, s[36:39], s41 offen offset:1024 lds
    s_add_u32 m0, s43, 41984
    s_nop 0
    buffer_load_dwordx4 v5, s[32:35], s40 offen offset:3072 lds
    s_mov_b32 m0, 58368
    s_mov_b64 exec, s[46:47]
    buffer_load_dwordx4 v6, s[32:35], s40 offen lds
    s_mov_b64 exec, -1
    s_movk_i32 s40, 256
    s_mov_b32 s41, 786432
    s_lshr_b32 s74, s69, 2
    s_and_b32 s75, s69, 3
    s_lshl3_add_u32 s74, s74, s75
    s_lshl3_add_u32 s74, s74, s70
    s_lshl_b32 s74, s74, 3
    v_bfe_u32 v234, v0, 3, 1
    v_lshl_add_u32 v225, v234, 8, s74
    v_bfe_u32 v234, v0, 4, 1
    v_lshl_add_u32 v225, v234, 1, v225
    v_lshrrev_b32 v234, 5, v0
    v_lshl_add_u32 v225, v234, 5, v225
    s_lshl_b32 s74, s68, 7
    v_and_b32 v234, 7, v0
    v_lshl_add_u32 v234, v234, 4, s74
    v_lshl_add_u32 v226, v225, 12, v234
    v_lshl_add_u32 v225, v225, 11, v234
    v_and_b32 v234, 1, v0
    v_xor_b32 v234, 1, v234
    v_mul_u32_u24 v232, 4224, v234
    v_mul_u32_u24 v233, 4576, v234
    v_bfe_u32 v234, v0, 1, 3
    v_lshl_add_u32 v232, v234, 3, v232
    v_xor_b32 v234, 7, v234
    v_lshl_add_u32 v233, v234, 6, v233
    v_lshrrev_b32 v234, 4, v0
    v_lshl_add_u32 v232, v234, 4, v232
    v_lshl_add_u32 v233, v234, 4, v233
    v_add3_u32 v232, v232, s80, 8
    v_add_u32 v233, s81, v233
    s_waitcnt lgkmcnt(0)
    s_bitcmp1_b32 s71, 0
    s_cselect_b32 s74, 0, 16
    s_lshl_b32 s72, s72, s74
    s_and_b32 s72, s72, 0xffff0000
    v_and_b32 v235, 1, v0
    v_lshlrev_b32 v235, 4, v235
    v_lshrrev_b32 v235, v235, s72
    v_bfe_u32 v236, v0, 1, 3
    v_lshl_add_u32 v236, v234, 1, v236
    v_cmp_eq_u32 vcc, 7, v236
    v_mov_b32 v241, 0
    v_mov_b32 v243, 0
    v_cndmask_b32 v240, 0, v235, vcc
    v_cmp_eq_u32 vcc, 6, v236
    s_nop 1
    v_cndmask_b32 v242, 0, v235, vcc
    s_lshr_b32 s7, s2, 6
    s_mul_i32 s90, s7, 1048576
    s_sub_u32 s88, s88, s90
    s_mul_i32 s90, s7, 98304
    s_sub_u32 s89, s89, s90
    v_lshrrev_b32 v20, 3, v0
    v_mul_u32_u24 v20, 1048064, v20
    v_add_u32 v251, v251, v20
    v_lshrrev_b32 v20, 4, v0
    v_mul_u32_u24 v20, 1474560, v20
    v_sub_u32 v252, v252, v20
    s_waitcnt vmcnt(11)
    s_barrier
    s_add_u32 m0, s43, 83968
    s_nop 0
    buffer_load_dwordx4 v2, s[32:35], s40 offen offset:0 lds
    s_add_u32 m0, s44, 83968
    s_nop 0
    buffer_load_dwordx4 v7, s[36:39], s41 offen offset:0 lds
    buffer_load_dwordx4 v8, s[36:39], s41 offen offset:1024 lds
    s_add_u32 m0, s43, 83968
    s_nop 0
    buffer_load_dwordx4 v3, s[32:35], s40 offen offset:1024 lds
    s_add_u32 m0, s44, 92160
    s_nop 0
    buffer_load_dwordx4 v9, s[36:39], s41 offen offset:0 lds
    buffer_load_dwordx4 v10, s[36:39], s41 offen offset:1024 lds
    s_add_u32 m0, s43, 83968
    s_nop 0
    buffer_load_dwordx4 v4, s[32:35], s40 offen offset:2048 lds
    s_add_u32 m0, s44, 100352
    s_nop 0
    buffer_load_dwordx4 v11, s[36:39], s41 offen offset:0 lds
    buffer_load_dwordx4 v12, s[36:39], s41 offen offset:1024 lds
    s_add_u32 m0, s43, 83968
    s_nop 0
    buffer_load_dwordx4 v5, s[32:35], s40 offen offset:3072 lds
    s_mov_b32 m0, 100352
    s_mov_b64 exec, s[46:47]
    buffer_load_dwordx4 v6, s[32:35], s40 offen lds
    s_mov_b64 exec, -1
    s_movk_i32 s40, 384
    s_mov_b32 s41, 1179648
    s_cmp_lg_u32 s87, 0
    s_cbranch_scc1 L_stg_3
    s_add_u32 s6, s89, 1572864
    s_mov_b32 exec_lo, 0x770077
    s_mov_b32 exec_hi, 0x770077
    s_bfe_u32 s7, s89, 0x30007
    s_cmp_lg_u32 s7, 1
    s_cbranch_scc1 L_wx3_4
    buffer_load_dword v250, v252, s[36:39], s6 offen offset:256
L_wx3_4:
    buffer_load_dword v250, v252, s[36:39], s6 offen
    s_mov_b32 exec_lo, 0xf0f0f0f
    s_mov_b32 exec_hi, 0
    buffer_load_dword v250, v251, s[32:35], s88 offen offset:512
    s_mov_b64 exec, -1
L_stg_3:
    s_waitcnt vmcnt(13)
    s_bitcmp1_b32 1, s87
    s_cbranch_scc1 L_mw_5
    s_waitcnt vmcnt(11)
L_mw_5:
    s_barrier
    s_add_u32 m0, s43, 0
    s_nop 0
    buffer_load_dwordx4 v2, s[32:35], s40 offen offset:0 lds
    s_add_u32 m0, s44, 0
    s_nop 0
    buffer_load_dwordx4 v7, s[36:39], s41 offen offset:0 lds
    buffer_load_dwordx4 v8, s[36:39], s41 offen offset:1024 lds
    s_add_u32 m0, s43, 0
    s_nop 0
    buffer_load_dwordx4 v3, s[32:35], s40 offen offset:1024 lds
    s_add_u32 m0, s44, 8192
    s_nop 0
    buffer_load_dwordx4 v9, s[36:39], s41 offen offset:0 lds
    buffer_load_dwordx4 v10, s[36:39], s41 offen offset:1024 lds
    s_add_u32 m0, s43, 0
    s_nop 0
    buffer_load_dwordx4 v4, s[32:35], s40 offen offset:2048 lds
    s_add_u32 m0, s44, 16384
    s_nop 0
    buffer_load_dwordx4 v11, s[36:39], s41 offen offset:0 lds
    buffer_load_dwordx4 v12, s[36:39], s41 offen offset:1024 lds
    s_add_u32 m0, s43, 0
    s_nop 0
    buffer_load_dwordx4 v5, s[32:35], s40 offen offset:3072 lds
    s_mov_b32 m0, 16384
    s_mov_b64 exec, s[46:47]
    buffer_load_dwordx4 v6, s[32:35], s40 offen lds
    s_mov_b64 exec, -1
    s_movk_i32 s40, 512
    s_mov_b32 s41, 1572864
    s_cmp_lg_u32 s87, 1
    s_cbranch_scc1 L_stg_6
    s_add_u32 s6, s89, 2359296
    s_mov_b32 exec_lo, 0x770077
    s_mov_b32 exec_hi, 0x770077
    s_bfe_u32 s7, s89, 0x30007
    s_cmp_lg_u32 s7, 1
    s_cbranch_scc1 L_wx3_7
    buffer_load_dword v250, v252, s[36:39], s6 offen offset:256
L_wx3_7:
    buffer_load_dword v250, v252, s[36:39], s6 offen
    s_mov_b32 exec_lo, 0xf0f0f0f
    s_mov_b32 exec_hi, 0
    buffer_load_dword v250, v251, s[32:35], s88 offen offset:768
    s_mov_b64 exec, -1
L_stg_6:
    s_load_dwordx2 s[90:91], s[16:17], s84 offset:60
    s_load_dwordx2 s[90:91], s[16:17], s84 offset:188
    s_load_dwordx2 s[90:91], s[16:17], s84 offset:316
    s_waitcnt vmcnt(13)
    s_bitcmp1_b32 3, s87
    s_cbranch_scc1 L_mw_8
    s_waitcnt vmcnt(11)
L_mw_8:
    s_barrier
    s_add_u32 m0, s43, 41984
    s_nop 0
    buffer_load_dwordx4 v2, s[32:35], s40 offen offset:0 lds
    s_add_u32 m0, s44, 41984
    s_nop 0
    buffer_load_dwordx4 v7, s[36:39], s41 offen offset:0 lds
    buffer_load_dwordx4 v8, s[36:39], s41 offen offset:1024 lds
    s_add_u32 m0, s43, 41984
    s_nop 0
    buffer_load_dwordx4 v3, s[32:35], s40 offen offset:1024 lds
    s_add_u32 m0, s44, 50176
    s_nop 0
    buffer_load_dwordx4 v9, s[36:39], s41 offen offset:0 lds
    buffer_load_dwordx4 v10, s[36:39], s41 offen offset:1024 lds
    s_add_u32 m0, s43, 41984
    s_nop 0
    buffer_load_dwordx4 v4, s[32:35], s40 offen offset:2048 lds
    s_add_u32 m0, s44, 58368
    s_nop 0
    buffer_load_dwordx4 v11, s[36:39], s41 offen offset:0 lds
    buffer_load_dwordx4 v12, s[36:39], s41 offen offset:1024 lds
    s_add_u32 m0, s43, 41984
    s_nop 0
    buffer_load_dwordx4 v5, s[32:35], s40 offen offset:3072 lds
    s_mov_b32 m0, 58368
    s_mov_b64 exec, s[46:47]
    buffer_load_dwordx4 v6, s[32:35], s40 offen lds
    s_mov_b64 exec, -1
    s_movk_i32 s40, 640
    s_mov_b32 s41, 1966080
    s_load_dwordx2 s[90:91], s[16:17], s84 offset:444
    s_load_dwordx2 s[90:91], s[16:17], s84 offset:572
    s_load_dwordx2 s[90:91], s[16:17], s84 offset:700
    s_waitcnt vmcnt(13)
    s_bitcmp1_b32 2, s87
    s_cbranch_scc1 L_mw_9
    s_waitcnt vmcnt(11)
L_mw_9:
    s_barrier
    s_add_u32 m0, s43, 83968
    s_nop 0
    buffer_load_dwordx4 v2, s[32:35], s40 offen offset:0 lds
    s_add_u32 m0, s44, 83968
    s_nop 0
    buffer_load_dwordx4 v7, s[36:39], s41 offen offset:0 lds
    buffer_load_dwordx4 v8, s[36:39], s41 offen offset:1024 lds
    s_add_u32 m0, s43, 83968
    s_nop 0
    buffer_load_dwordx4 v3, s[32:35], s40 offen offset:1024 lds
    s_add_u32 m0, s44, 92160
    s_nop 0
    buffer_load_dwordx4 v9, s[36:39], s41 offen offset:0 lds
    buffer_load_dwordx4 v10, s[36:39], s41 offen offset:1024 lds
    s_add_u32 m0, s43, 83968
    s_nop 0
    buffer_load_dwordx4 v4, s[32:35], s40 offen offset:2048 lds
    s_add_u32 m0, s44, 100352
    s_nop 0
    buffer_load_dwordx4 v11, s[36:39], s41 offen offset:0 lds
    buffer_load_dwordx4 v12, s[36:39], s41 offen offset:1024 lds
    s_add_u32 m0, s43, 83968
    s_nop 0
    buffer_load_dwordx4 v5, s[32:35], s40 offen offset:3072 lds
    s_mov_b32 m0, 100352
    s_mov_b64 exec, s[46:47]
    buffer_load_dwordx4 v6, s[32:35], s40 offen lds
    s_mov_b64 exec, -1
    s_movk_i32 s40, 768
    s_mov_b32 s41, 2359296
    s_cmp_lg_u32 s87, 2
    s_cbranch_scc1 L_stg_10
    s_add_u32 s6, s89, 3145728
    s_mov_b32 exec_lo, 0x770077
    s_mov_b32 exec_hi, 0x770077
    s_bfe_u32 s7, s89, 0x30007
    s_cmp_lg_u32 s7, 1
    s_cbranch_scc1 L_wx3_11
    buffer_load_dword v250, v252, s[36:39], s6 offen offset:256
L_wx3_11:
    buffer_load_dword v250, v252, s[36:39], s6 offen
    s_mov_b32 exec_lo, 0xf0f0f0f
    s_mov_b32 exec_hi, 0
    buffer_load_dword v250, v251, s[32:35], s88 offen offset:1024
    s_mov_b64 exec, -1
L_stg_10:
    s_load_dwordx2 s[90:91], s[16:17], s84 offset:828
    s_load_dwordx2 s[90:91], s[16:17], s84 offset:956
    s_load_dwordx2 s[90:91], s[16:17], s84 offset:1084
    s_waitcnt vmcnt(13)
    s_bitcmp1_b32 4, s87
    s_cbranch_scc1 L_mw_12
    s_waitcnt vmcnt(11)
L_mw_12:
    s_barrier
    s_add_u32 m0, s43, 0
    s_nop 0
    buffer_load_dwordx4 v2, s[32:35], s40 offen offset:0 lds
    s_add_u32 m0, s44, 0
    s_nop 0
    buffer_load_dwordx4 v7, s[36:39], s41 offen offset:0 lds
    buffer_load_dwordx4 v8, s[36:39], s41 offen offset:1024 lds
    s_add_u32 m0, s43, 0
    s_nop 0
    buffer_load_dwordx4 v3, s[32:35], s40 offen offset:1024 lds
    s_add_u32 m0, s44, 8192
    s_nop 0
    buffer_load_dwordx4 v9, s[36:39], s41 offen offset:0 lds
    buffer_load_dwordx4 v10, s[36:39], s41 offen offset:1024 lds
    s_add_u32 m0, s43, 0
    s_nop 0
    buffer_load_dwordx4 v4, s[32:35], s40 offen offset:2048 lds
    s_add_u32 m0, s44, 16384
    s_nop 0
    buffer_load_dwordx4 v11, s[36:39], s41 offen offset:0 lds
    buffer_load_dwordx4 v12, s[36:39], s41 offen offset:1024 lds
    s_add_u32 m0, s43, 0
    s_nop 0
    buffer_load_dwordx4 v5, s[32:35], s40 offen offset:3072 lds
    s_mov_b32 m0, 16384
    s_mov_b64 exec, s[46:47]
    buffer_load_dwordx4 v6, s[32:35], s40 offen lds
    s_mov_b64 exec, -1
    s_movk_i32 s40, 896
    s_mov_b32 s41, 2752512
    s_bfe_u32 s74, s2, 0x20003
    s_lshl2_add_u32 s74, s74, s70
    s_cmp_lg_u32 s74, 0
    s_cbranch_scc1 L_sig_13
    s_mov_b32 s60, s28
    s_mov_b32 s61, s29
    s_mov_b32 s62, 0x100
    s_mov_b32 s63, 0x20000
    s_and_b32 s74, s2, 3
    s_lshl_b32 s74, s74, 6
    s_mov_b64 exec, 1
    buffer_atomic_add v244, off, s[60:63], s74 sc1
    s_mov_b64 exec, -1
L_sig_13:
    s_load_dwordx2 s[90:91], s[16:17], s84 offset:1212
    s_load_dwordx2 s[90:91], s[16:17], s84 offset:1340
    s_load_dwordx2 s[90:91], s[16:17], s84 offset:1468
    s_waitcnt vmcnt(13)
    s_bitcmp1_b32 4, s87
    s_cbranch_scc1 L_mw_14
    s_waitcnt vmcnt(11)
L_mw_14:
    s_barrier
    s_add_u32 m0, s43, 41984
    s_nop 0
    buffer_load_dwordx4 v2, s[32:35], s40 offen offset:0 lds
    s_add_u32 m0, s44, 41984
    s_nop 0
    buffer_load_dwordx4 v7, s[36:39], s41 offen offset:0 lds
    buffer_load_dwordx4 v8, s[36:39], s41 offen offset:1024 lds
    s_add_u32 m0, s43, 41984
    s_nop 0
    buffer_load_dwordx4 v3, s[32:35], s40 offen offset:1024 lds
    s_add_u32 m0, s44, 50176
    s_nop 0
    buffer_load_dwordx4 v9, s[36:39], s41 offen offset:0 lds
    buffer_load_dwordx4 v10, s[36:39], s41 offen offset:1024 lds
    s_add_u32 m0, s43, 41984
    s_nop 0
    buffer_load_dwordx4 v4, s[32:35], s40 offen offset:2048 lds
    s_add_u32 m0, s44, 58368
    s_nop 0
    buffer_load_dwordx4 v11, s[36:39], s41 offen offset:0 lds
    buffer_load_dwordx4 v12, s[36:39], s41 offen offset:1024 lds
    s_add_u32 m0, s43, 41984
    s_nop 0
    buffer_load_dwordx4 v5, s[32:35], s40 offen offset:3072 lds
    s_mov_b32 m0, 58368
    s_mov_b64 exec, s[46:47]
    buffer_load_dwordx4 v6, s[32:35], s40 offen lds
    s_mov_b64 exec, -1
    s_movk_i32 s40, 1024
    s_mov_b32 s41, 3145728
    s_cmp_lg_u32 s87, 3
    s_cbranch_scc1 L_stg_15
    s_add_u32 s6, s89, 3932160
    s_mov_b32 exec_lo, 0x770077
    s_mov_b32 exec_hi, 0x770077
    s_bfe_u32 s7, s89, 0x30007
    s_cmp_lg_u32 s7, 1
    s_cbranch_scc1 L_wx3_16
    buffer_load_dword v250, v252, s[36:39], s6 offen offset:256
L_wx3_16:
    buffer_load_dword v250, v252, s[36:39], s6 offen
    s_mov_b32 exec_lo, 0xf0f0f0f
    s_mov_b32 exec_hi, 0
    buffer_load_dword v250, v251, s[32:35], s88 offen offset:1280
    s_mov_b64 exec, -1
L_stg_15:
    s_bfe_u32 s74, s2, 0x20003
    s_lshl2_add_u32 s74, s74, s70
    s_cmp_lg_u32 s74, 4
    s_cbranch_scc1 L_sig_17
    s_mov_b32 s60, s28
    s_mov_b32 s61, s29
    s_mov_b32 s62, 0x100
    s_mov_b32 s63, 0x20000
    s_and_b32 s74, s2, 3
    s_lshl_b32 s74, s74, 6
    s_mov_b64 exec, 1
    buffer_atomic_add v244, off, s[60:63], s74 sc1
    s_mov_b64 exec, -1
L_sig_17:
    s_load_dwordx2 s[90:91], s[16:17], s84 offset:1596
    s_load_dwordx2 s[90:91], s[16:17], s84 offset:1724
    s_load_dwordx2 s[90:91], s[16:17], s84 offset:1852
    s_waitcnt vmcnt(13)
    s_bitcmp1_b32 8, s87
    s_cbranch_scc1 L_mw_18
    s_waitcnt vmcnt(11)
L_mw_18:
    s_barrier
    s_add_u32 m0, s43, 83968
    s_nop 0
    buffer_load_dwordx4 v2, s[32:35], s40 offen offset:0 lds
    s_add_u32 m0, s44, 83968
    s_nop 0
    buffer_load_dwordx4 v7, s[36:39], s41 offen offset:0 lds
    buffer_load_dwordx4 v8, s[36:39], s41 offen offset:1024 lds
    s_add_u32 m0, s43, 83968
    s_nop 0
    buffer_load_dwordx4 v3, s[32:35], s40 offen offset:1024 lds
    s_add_u32 m0, s44, 92160
    s_nop 0
    buffer_load_dwordx4 v9, s[36:39], s41 offen offset:0 lds
    buffer_load_dwordx4 v10, s[36:39], s41 offen offset:1024 lds
    s_add_u32 m0, s43, 83968
    s_nop 0
    buffer_load_dwordx4 v4, s[32:35], s40 offen offset:2048 lds
    s_add_u32 m0, s44, 100352
    s_nop 0
    buffer_load_dwordx4 v11, s[36:39], s41 offen offset:0 lds
    buffer_load_dwordx4 v12, s[36:39], s41 offen offset:1024 lds
    s_add_u32 m0, s43, 83968
    s_nop 0
    buffer_load_dwordx4 v5, s[32:35], s40 offen offset:3072 lds
    s_mov_b32 m0, 100352
    s_mov_b64 exec, s[46:47]
    buffer_load_dwordx4 v6, s[32:35], s40 offen lds
    s_mov_b64 exec, -1
    s_movk_i32 s40, 1152
    s_mov_b32 s41, 3538944
    s_bfe_u32 s74, s2, 0x20003
    s_lshl2_add_u32 s74, s74, s70
    s_cmp_lg_u32 s74, 8
    s_cbranch_scc1 L_sig_19
    s_mov_b32 s60, s28
    s_mov_b32 s61, s29
    s_mov_b32 s62, 0x100
    s_mov_b32 s63, 0x20000
    s_and_b32 s74, s2, 3
    s_lshl_b32 s74, s74, 6
    s_mov_b64 exec, 1
    buffer_atomic_add v244, off, s[60:63], s74 sc1
    s_mov_b64 exec, -1
L_sig_19:
    s_load_dwordx2 s[90:91], s[16:17], s84 offset:1980
    s_load_dwordx2 s[90:91], s[16:17], s84 offset:2108
    s_load_dwordx2 s[90:91], s[16:17], s84 offset:2236
    s_waitcnt vmcnt(13)
    s_bitcmp1_b32 8, s87
    s_cbranch_scc1 L_mw_20
    s_waitcnt vmcnt(11)
L_mw_20:
    s_barrier
    s_add_u32 m0, s43, 0
    s_nop 0
    buffer_load_dwordx4 v2, s[32:35], s40 offen offset:0 lds
    s_add_u32 m0, s44, 0
    s_nop 0
    buffer_load_dwordx4 v7, s[36:39], s41 offen offset:0 lds
    buffer_load_dwordx4 v8, s[36:39], s41 offen offset:1024 lds
    s_add_u32 m0, s43, 0
    s_nop 0
    buffer_load_dwordx4 v3, s[32:35], s40 offen offset:1024 lds
    s_add_u32 m0, s44, 8192
    s_nop 0
    buffer_load_dwordx4 v9, s[36:39], s41 offen offset:0 lds
    buffer_load_dwordx4 v10, s[36:39], s41 offen offset:1024 lds
    s_add_u32 m0, s43, 0
    s_nop 0
    buffer_load_dwordx4 v4, s[32:35], s40 offen offset:2048 lds
    s_add_u32 m0, s44, 16384
    s_nop 0
    buffer_load_dwordx4 v11, s[36:39], s41 offen offset:0 lds
    buffer_load_dwordx4 v12, s[36:39], s41 offen offset:1024 lds
    s_add_u32 m0, s43, 0
    s_nop 0
    buffer_load_dwordx4 v5, s[32:35], s40 offen offset:3072 lds
    s_mov_b32 m0, 16384
    s_mov_b64 exec, s[46:47]
    buffer_load_dwordx4 v6, s[32:35], s40 offen lds
    s_mov_b64 exec, -1
    s_movk_i32 s40, 1280
    s_mov_b32 s41, 3932160
    s_cmp_lg_u32 s87, 0
    s_cbranch_scc1 L_stg_21
    s_add_u32 s6, s89, 4718592
    s_mov_b32 exec_lo, 0x770077
    s_mov_b32 exec_hi, 0x770077
    s_bfe_u32 s7, s89, 0x30007
    s_cmp_lg_u32 s7, 1
    s_cbranch_scc1 L_wx3_22
    buffer_load_dword v250, v252, s[36:39], s6 offen offset:256
L_wx3_22:
    buffer_load_dword v250, v252, s[36:39], s6 offen
    s_mov_b32 exec_lo, 0xf0f0f0f
    s_mov_b32 exec_hi, 0
    buffer_load_dword v250, v251, s[32:35], s88 offen offset:1536
    s_mov_b64 exec, -1
L_stg_21:
    s_bfe_u32 s74, s2, 0x20003
    s_lshl2_add_u32 s74, s74, s70
    s_cmp_lg_u32 s74, 12
    s_cbranch_scc1 L_sig_23
    s_mov_b32 s60, s28
    s_mov_b32 s61, s29
    s_mov_b32 s62, 0x100
    s_mov_b32 s63, 0x20000
    s_and_b32 s74, s2, 3
    s_lshl_b32 s74, s74, 6
    s_mov_b64 exec, 1
    buffer_atomic_add v244, off, s[60:63], s74 sc1
    s_mov_b64 exec, -1
L_sig_23:
    s_load_dwordx2 s[90:91], s[16:17], s84 offset:2364
    s_load_dwordx2 s[90:91], s[16:17], s84 offset:2492
    s_load_dwordx2 s[90:91], s[16:17], s84 offset:2620
    s_waitcnt vmcnt(13)
    s_bitcmp1_b32 1, s87
    s_cbranch_scc1 L_mw_24
    s_waitcnt vmcnt(11)
L_mw_24:
    s_barrier
    s_add_u32 m0, s43, 41984
    s_nop 0
    buffer_load_dwordx4 v2, s[32:35], s40 offen offset:0 lds
    s_add_u32 m0, s44, 41984
    s_nop 0
    buffer_load_dwordx4 v7, s[36:39], s41 offen offset:0 lds
    buffer_load_dwordx4 v8, s[36:39], s41 offen offset:1024 lds
    s_add_u32 m0, s43, 41984
    s_nop 0
    buffer_load_dwordx4 v3, s[32:35], s40 offen offset:1024 lds
    s_add_u32 m0, s44, 50176
    s_nop 0
    buffer_load_dwordx4 v9, s[36:39], s41 offen offset:0 lds
    buffer_load_dwordx4 v10, s[36:39], s41 offen offset:1024 lds
    s_add_u32 m0, s43, 41984
    s_nop 0
    buffer_load_dwordx4 v4, s[32:35], s40 offen offset:2048 lds
    s_add_u32 m0, s44, 58368
    s_nop 0
    buffer_load_dwordx4 v11, s[36:39], s41 offen offset:0 lds
    buffer_load_dwordx4 v12, s[36:39], s41 offen offset:1024 lds
    s_add_u32 m0, s43, 41984
    s_nop 0
    buffer_load_dwordx4 v5, s[32:35], s40 offen offset:3072 lds
    s_mov_b32 m0, 58368
    s_mov_b64 exec, s[46:47]
    buffer_load_dwordx4 v6, s[32:35], s40 offen lds
    s_mov_b64 exec, -1
    s_movk_i32 s40, 1408
    s_mov_b32 s41, 4325376
    s_load_dwordx2 s[90:91], s[16:17], s84 offset:2748
    s_load_dwordx2 s[90:91], s[16:17], s84 offset:2876
    s_load_dwordx2 s[90:91], s[16:17], s84 offset:3004
    s_waitcnt vmcnt(13)
    s_bitcmp1_b32 1, s87
    s_cbranch_scc1 L_mw_25
    s_waitcnt vmcnt(11)
L_mw_25:
    s_barrier
    s_add_u32 m0, s43, 83968
    s_nop 0
    buffer_load_dwordx4 v2, s[32:35], s40 offen offset:0 lds
    s_add_u32 m0, s44, 83968
    s_nop 0
    buffer_load_dwordx4 v7, s[36:39], s41 offen offset:0 lds
    buffer_load_dwordx4 v8, s[36:39], s41 offen offset:1024 lds
    s_add_u32 m0, s43, 83968
    s_nop 0
    buffer_load_dwordx4 v3, s[32:35], s40 offen offset:1024 lds
    s_add_u32 m0, s44, 92160
    s_nop 0
    buffer_load_dwordx4 v9, s[36:39], s41 offen offset:0 lds
    buffer_load_dwordx4 v10, s[36:39], s41 offen offset:1024 lds
    s_add_u32 m0, s43, 83968
    s_nop 0
    buffer_load_dwordx4 v4, s[32:35], s40 offen offset:2048 lds
    s_add_u32 m0, s44, 100352
    s_nop 0
    buffer_load_dwordx4 v11, s[36:39], s41 offen offset:0 lds
    buffer_load_dwordx4 v12, s[36:39], s41 offen offset:1024 lds
    s_add_u32 m0, s43, 83968
    s_nop 0
    buffer_load_dwordx4 v5, s[32:35], s40 offen offset:3072 lds
    s_mov_b32 m0, 100352
    s_mov_b64 exec, s[46:47]
    buffer_load_dwordx4 v6, s[32:35], s40 offen lds
    s_mov_b64 exec, -1
    s_movk_i32 s40, 1536
    s_mov_b32 s41, 4718592
    s_cmp_lg_u32 s87, 1
    s_cbranch_scc1 L_stg_26
    s_add_u32 s6, s89, 5505024
    s_mov_b32 exec_lo, 0x770077
    s_mov_b32 exec_hi, 0x770077
    s_bfe_u32 s7, s89, 0x30007
    s_cmp_lg_u32 s7, 1
    s_cbranch_scc1 L_wx3_27
    buffer_load_dword v250, v252, s[36:39], s6 offen offset:256
L_wx3_27:
    buffer_load_dword v250, v252, s[36:39], s6 offen
    s_mov_b32 exec_lo, 0xf0f0f0f
    s_mov_b32 exec_hi, 0
    buffer_load_dword v250, v251, s[32:35], s88 offen offset:1792
    s_mov_b64 exec, -1
L_stg_26:
    s_load_dwordx2 s[90:91], s[16:17], s84 offset:3132
    s_load_dwordx2 s[90:91], s[16:17], s84 offset:3260
    s_load_dwordx2 s[90:91], s[16:17], s84 offset:3388
    s_waitcnt vmcnt(13)
    s_bitcmp1_b32 2, s87
    s_cbranch_scc1 L_mw_28
    s_waitcnt vmcnt(11)
L_mw_28:
    s_barrier
    s_add_u32 m0, s43, 0
    s_nop 0
    buffer_load_dwordx4 v2, s[32:35], s40 offen offset:0 lds
    s_add_u32 m0, s44, 0
    s_nop 0
    buffer_load_dwordx4 v7, s[36:39], s41 offen offset:0 lds
    buffer_load_dwordx4 v8, s[36:39], s41 offen offset:1024 lds
    s_add_u32 m0, s43, 0
    s_nop 0
    buffer_load_dwordx4 v3, s[32:35], s40 offen offset:1024 lds
    s_add_u32 m0, s44, 8192
    s_nop 0
    buffer_load_dwordx4 v9, s[36:39], s41 offen offset:0 lds
    buffer_load_dwordx4 v10, s[36:39], s41 offen offset:1024 lds
    s_add_u32 m0, s43, 0
    s_nop 0
    buffer_load_dwordx4 v4, s[32:35], s40 offen offset:2048 lds
    s_add_u32 m0, s44, 16384
    s_nop 0
    buffer_load_dwordx4 v11, s[36:39], s41 offen offset:0 lds
    buffer_load_dwordx4 v12, s[36:39], s41 offen offset:1024 lds
    s_add_u32 m0, s43, 0
    s_nop 0
    buffer_load_dwordx4 v5, s[32:35], s40 offen offset:3072 lds
    s_mov_b32 m0, 16384
    s_mov_b64 exec, s[46:47]
    buffer_load_dwordx4 v6, s[32:35], s40 offen lds
    s_mov_b64 exec, -1
    s_movk_i32 s40, 1664
    s_mov_b32 s41, 5111808
    s_load_dwordx2 s[90:91], s[16:17], s84 offset:3516
    s_load_dwordx2 s[90:91], s[16:17], s84 offset:3644
    s_load_dwordx2 s[90:91], s[16:17], s84 offset:3772
    s_waitcnt vmcnt(13)
    s_bitcmp1_b32 2, s87
    s_cbranch_scc1 L_mw_29
    s_waitcnt vmcnt(11)
L_mw_29:
    s_barrier
    s_add_u32 m0, s43, 41984
    s_nop 0
    buffer_load_dwordx4 v2, s[32:35], s40 offen offset:0 lds
    s_add_u32 m0, s44, 41984
    s_nop 0
    buffer_load_dwordx4 v7, s[36:39], s41 offen offset:0 lds
    buffer_load_dwordx4 v8, s[36:39], s41 offen offset:1024 lds
    s_add_u32 m0, s43, 41984
    s_nop 0
    buffer_load_dwordx4 v3, s[32:35], s40 offen offset:1024 lds
    s_add_u32 m0, s44, 50176
    s_nop 0
    buffer_load_dwordx4 v9, s[36:39], s41 offen offset:0 lds
    buffer_load_dwordx4 v10, s[36:39], s41 offen offset:1024 lds
    s_add_u32 m0, s43, 41984
    s_nop 0
    buffer_load_dwordx4 v4, s[32:35], s40 offen offset:2048 lds
    s_add_u32 m0, s44, 58368
    s_nop 0
    buffer_load_dwordx4 v11, s[36:39], s41 offen offset:0 lds
    buffer_load_dwordx4 v12, s[36:39], s41 offen offset:1024 lds
    s_add_u32 m0, s43, 41984
    s_nop 0
    buffer_load_dwordx4 v5, s[32:35], s40 offen offset:3072 lds
    s_mov_b32 m0, 58368
    s_mov_b64 exec, s[46:47]
    buffer_load_dwordx4 v6, s[32:35], s40 offen lds
    s_mov_b64 exec, -1
    s_movk_i32 s40, 1792
    s_mov_b32 s41, 5505024
    s_load_dwordx2 s[90:91], s[16:17], s84 offset:3900
    s_load_dwordx2 s[90:91], s[16:17], s84 offset:4028
    s_waitcnt vmcnt(11)
    s_barrier
    s_add_u32 m0, s43, 83968
    s_nop 0
    buffer_load_dwordx4 v2, s[32:35], s40 offen offset:0 lds
    s_add_u32 m0, s44, 83968
    s_nop 0
    buffer_load_dwordx4 v7, s[36:39], s41 offen offset:0 lds
    buffer_load_dwordx4 v8, s[36:39], s41 offen offset:1024 lds
    s_add_u32 m0, s43, 83968
    s_nop 0
    buffer_load_dwordx4 v3, s[32:35], s40 offen offset:1024 lds
    s_add_u32 m0, s44, 92160
    s_nop 0
    buffer_load_dwordx4 v9, s[36:39], s41 offen offset:0 lds
    buffer_load_dwordx4 v10, s[36:39], s41 offen offset:1024 lds
    s_add_u32 m0, s43, 83968
    s_nop 0
    buffer_load_dwordx4 v4, s[32:35], s40 offen offset:2048 lds
    s_add_u32 m0, s44, 100352
    s_nop 0
    buffer_load_dwordx4 v11, s[36:39], s41 offen offset:0 lds
    buffer_load_dwordx4 v12, s[36:39], s41 offen offset:1024 lds
    s_add_u32 m0, s43, 83968
    s_nop 0
    buffer_load_dwordx4 v5, s[32:35], s40 offen offset:3072 lds
    s_mov_b32 m0, 100352
    s_mov_b64 exec, s[46:47]
    buffer_load_dwordx4 v6, s[32:35], s40 offen lds
    s_mov_b64 exec, -1
    s_movk_i32 s40, 1920
    s_mov_b32 s41, 5898240
    s_waitcnt vmcnt(11)
    s_barrier
    s_load_dword s4, s[28:29], 0
    s_load_dword s5, s[28:29], 64
    s_load_dword s6, s[28:29], 128
    s_load_dword s7, s[28:29], 192
    s_add_u32 m0, s43, 0
    s_nop 0
    buffer_load_dwordx4 v2, s[32:35], s40 offen offset:0 lds
    s_add_u32 m0, s44, 0
    s_nop 0
    buffer_load_dwordx4 v7, s[36:39], s41 offen offset:0 lds
    buffer_load_dwordx4 v8, s[36:39], s41 offen offset:1024 lds
    s_add_u32 m0, s43, 0
    s_nop 0
    buffer_load_dwordx4 v3, s[32:35], s40 offen offset:1024 lds
    s_add_u32 m0, s44, 8192
    s_nop 0
    buffer_load_dwordx4 v9, s[36:39], s41 offen offset:0 lds
    buffer_load_dwordx4 v10, s[36:39], s41 offen offset:1024 lds
    s_add_u32 m0, s43, 0
    s_nop 0
    buffer_load_dwordx4 v4, s[32:35], s40 offen offset:2048 lds
    s_add_u32 m0, s44, 16384
    s_nop 0
    buffer_load_dwordx4 v11, s[36:39], s41 offen offset:0 lds
    buffer_load_dwordx4 v12, s[36:39], s41 offen offset:1024 lds
    s_add_u32 m0, s43, 0
    s_nop 0
    buffer_load_dwordx4 v5, s[32:35], s40 offen offset:3072 lds
    s_mov_b32 m0, 16384
    s_mov_b64 exec, s[46:47]
    buffer_load_dwordx4 v6, s[32:35], s40 offen lds
    s_mov_b64 exec, -1
    s_movk_i32 s40, 2048
    s_mov_b32 s41, 6291456
    s_mov_b32 s60, s8
    s_mov_b32 s61, s9
    s_mov_b32 s62, 0x400000
    s_mov_b32 s63, 0x20000
    s_movk_i32 s75, 8192
    buffer_load_dwordx4 v[208:211], v225, s[60:63], 0 offen offset:0 nt
    buffer_load_dwordx4 v[212:215], v225, s[60:63], 0 offen offset:2048 nt
    buffer_load_dwordx4 v[216:219], v225, s[60:63], s75 offen offset:0 nt
    buffer_load_dwordx4 v[220:223], v225, s[60:63], s75 offen offset:2048 nt
    s_cmp_lg_u32 s70, 0
    s_cbranch_scc1 L_pc_done_32
    s_waitcnt lgkmcnt(0)
    s_min_u32 s4, s4, s5
    s_min_u32 s6, s6, s7
    s_min_u32 s4, s4, s6
    s_cmp_ge_u32 s4, 64
    s_cbranch_scc1 L_pc_done_32
    s_mov_b32 s60, s28
    s_mov_b32 s61, s29
    s_mov_b32 s62, 0x100
    s_mov_b32 s63, 0x20000
    v_lshlrev_b32 v20, 6, v0
    s_mov_b32 s74, 131072
    s_mov_b64 exec, 0xf
L_pc_loop_33:
    buffer_load_dword v21, v20, s[60:63], 0 offen sc1
    s_waitcnt vmcnt(0)
    v_cmp_gt_u32 vcc, 64, v21
    s_cbranch_vccz L_pc_done_32
    s_sleep 4
    s_sub_u32 s74, s74, 1
    s_cbranch_scc0 L_pc_loop_33
L_pc_done_32:
    s_mov_b64 exec, -1
    s_waitcnt vmcnt(15)
    s_barrier
    s_waitcnt vmcnt(4)
    s_mov_b64 exec, 1
    ds_add_u32 v227, v244 offset:24
    s_mov_b64 exec, -1
    s_add_u32 s56, s30, s85
    s_addc_u32 s57, s31, 0
    s_movk_i32 s58, 4096
    s_mov_b32 s59, 0x20000
    s_add_u32 m0, s81, 0
    s_nop 0
    buffer_load_dwordx4 v224, s[56:59], 0 offen offset:0 sc1 lds
    buffer_load_dwordx4 v224, s[56:59], 0 offen offset:1024 sc1 lds
    buffer_load_dwordx4 v224, s[56:59], 0 offen offset:2048 sc1 lds
    buffer_load_dwordx4 v224, s[56:59], 0 offen offset:3072 sc1 lds
    s_add_u32 m0, s81, 4572
    s_nop 0
    buffer_load_dwordx4 v224, s[56:59], 0 offen offset:0 sc1 lds
    buffer_load_dwordx4 v224, s[56:59], 0 offen offset:1024 sc1 lds
    buffer_load_dwordx4 v224, s[56:59], 0 offen offset:2048 sc1 lds
    buffer_load_dwordx4 v224, s[56:59], 0 offen offset:3072 sc1 lds
    s_add_u32 s56, s16, s84
    s_addc_u32 s57, s17, 0
    s_movk_i32 s58, 4096
    s_mov_b32 s59, 0x20000
    s_add_u32 m0, s80, 64
    v_mov_b32 v180, 0
    v_mov_b32 v181, 0
    v_mov_b32 v182, 0
    v_mov_b32 v183, 0
    buffer_load_dwordx4 v224, s[56:59], 0 offen offset:0 lds
    buffer_load_dwordx4 v224, s[56:59], 0 offen offset:1024 lds
    buffer_load_dwordx4 v224, s[56:59], 0 offen offset:2048 lds
    buffer_load_dwordx4 v224, s[56:59], 0 offen offset:3072 lds
    s_add_u32 m0, s80, 4304
    s_mov_b64 exec, 0x100
    buffer_load_dwordx4 v[180:183], off, s[56:59], 0
    s_mov_b64 exec, -1
    buffer_load_dwordx4 v224, s[56:59], 14 offen offset:0 lds
    buffer_load_dwordx4 v224, s[56:59], 14 offen offset:1024 lds
    buffer_load_dwordx4 v224, s[56:59], 14 offen offset:2048 lds
    buffer_load_dwordx4 v224, s[56:59], 14 offen offset:3072 lds
    v_lshrrev_b32 v234, 5, v0
    v_mul_u32_u24 v234, 4064, v234
    v_add3_u32 v234, v234, v224, s81
    s_mov_b32 exec_lo, 0xfffffff
    s_mov_b32 exec_hi, 0xfffffff
    ds_write_b128 v234, v[228:231] offset:4096
    s_mov_b64 exec, 1
    ds_write_b32 v234, v228 offset:8668
    s_mov_b64 exec, -1
    s_setprio 3
    s_waitcnt vmcnt(9)
    s_mov_b32 s60, s24
    s_mov_b32 s61, s25
    s_mov_b32 s62, 0x200000
    s_mov_b32 s63, 0x20000
    s_lshr_b32 s74, s2, 3
    s_lshl2_add_u32 s74, s74, s70
    s_bfe_u32 s75, s2, 0x10002
    s_lshl4_add_u32 s74, s74, s75
    s_lshl_b32 s74, s74, 10
    v_lshrrev_b32 v234, 3, v0
    v_and_b32 v235, 7, v0
    v_lshlrev_b32 v235, 7, v235
    v_lshl_add_u32 v234, v234, 11, v235
    buffer_load_dword v250, v234, s[60:63], s74 offen
    s_waitcnt vmcnt(1)
    v_cmp_lt_u32 vcc, 3, v0
    v_mov_b32 v188, 4160
    v_lshlrev_b32 v184, 16, v180
    v_cndmask_b32 v188, 0, v188, vcc
    v_alignbit_b32 v185, v181, v180, 16
    v_alignbit_b32 v186, v182, v181, 16
    v_alignbit_b32 v187, v183, v182, 16
    v_add3_u32 v188, v188, v224, s80
    s_mov_b64 exec, 0x1ff
    ds_write_b128 v188, v[184:187]
    s_mov_b64 exec, -1
    ds_read_b128 v[112:115], v233 offset:3584
    ds_read_b128 v[116:119], v233 offset:3072
    ds_read_b128 v[120:123], v233 offset:2560
    ds_read_b128 v[124:127], v233 offset:2048
    ds_read_b128 v[128:131], v233 offset:1536
    ds_read_b128 v[132:135], v233 offset:1024
    ds_read_b128 v[136:139], v233 offset:512
    ds_read_b128 v[140:143], v233 offset:0
    ds_read_b64 v[48:49], v232 offset:0
    ds_read_b64 v[50:51], v232 offset:8
    ds_read_b64 v[52:53], v232 offset:512
    ds_read_b64 v[54:55], v232 offset:520
    ds_read_b64 v[56:57], v232 offset:1024
    ds_read_b64 v[58:59], v232 offset:1032
    ds_read_b64 v[60:61], v232 offset:1536
    ds_read_b64 v[62:63], v232 offset:1544
    ds_read_b64 v[64:65], v232 offset:2048
    ds_read_b64 v[66:67], v232 offset:2056
    ds_read_b64 v[68:69], v232 offset:2560
    ds_read_b64 v[70:71], v232 offset:2568
    ds_read_b64 v[72:73], v232 offset:3072
    ds_read_b64 v[74:75], v232 offset:3080
    ds_read_b64 v[76:77], v232 offset:3584
    ds_read_b64 v[78:79], v232 offset:3592
    s_setprio 1
    s_mov_b32 s74, 3
    s_waitcnt lgkmcnt(15)
    v_mfma_f32_16x16x32_bf16 v[16:19], v[240:243], v[112:115], 0
    v_mfma_f32_16x16x32_bf16 v[20:23], v[240:243], v[116:119], 0
    v_mfma_f32_16x16x32_bf16 v[24:27], v[240:243], v[120:123], 0
    v_mfma_f32_16x16x32_bf16 v[28:31], v[240:243], v[124:127], 0
    v_mfma_f32_16x16x32_bf16 v[32:35], v[240:243], v[128:131], 0
    v_mfma_f32_16x16x32_bf16 v[36:39], v[240:243], v[132:135], 0
    v_mfma_f32_16x16x32_bf16 v[40:43], v[240:243], v[136:139], 0
    v_mfma_f32_16x16x32_bf16 v[44:47], v[240:243], v[140:143], 0
    s_waitcnt lgkmcnt(0)
L_conv:
    v_mfma_f32_16x16x32_bf16 v[16:19], v[48:51], v[112:115], v[16:19]
    ds_read_b128 v[144:147], v233 offset:3648
    v_mfma_f32_16x16x32_bf16 v[20:23], v[48:51], v[116:119], v[20:23]
    ds_read_b64 v[80:81], v232 offset:64
    v_mfma_f32_16x16x32_bf16 v[20:23], v[52:55], v[112:115], v[20:23]
    ds_read_b64 v[82:83], v232 offset:72
    v_mfma_f32_16x16x32_bf16 v[24:27], v[48:51], v[120:123], v[24:27]
    ds_read_b128 v[148:151], v233 offset:3136
    v_mfma_f32_16x16x32_bf16 v[24:27], v[52:55], v[116:119], v[24:27]
    ds_read_b64 v[84:85], v232 offset:576
    v_mfma_f32_16x16x32_bf16 v[24:27], v[56:59], v[112:115], v[24:27]
    ds_read_b64 v[86:87], v232 offset:584
    v_mfma_f32_16x16x32_bf16 v[28:31], v[48:51], v[124:127], v[28:31]
    ds_read_b128 v[152:155], v233 offset:2624
    v_mfma_f32_16x16x32_bf16 v[28:31], v[52:55], v[120:123], v[28:31]
    ds_read_b64 v[88:89], v232 offset:1088
    v_mfma_f32_16x16x32_bf16 v[28:31], v[56:59], v[116:119], v[28:31]
    ds_read_b64 v[90:91], v232 offset:1096
    v_mfma_f32_16x16x32_bf16 v[28:31], v[60:63], v[112:115], v[28:31]
    ds_read_b128 v[156:159], v233 offset:2112
    v_mfma_f32_16x16x32_bf16 v[32:35], v[48:51], v[128:131], v[32:35]
    ds_read_b64 v[92:93], v232 offset:1600
    v_mfma_f32_16x16x32_bf16 v[32:35], v[52:55], v[124:127], v[32:35]
    ds_read_b64 v[94:95], v232 offset:1608
    v_mfma_f32_16x16x32_bf16 v[32:35], v[56:59], v[120:123], v[32:35]
    ds_read_b128 v[160:163], v233 offset:1600
    v_mfma_f32_16x16x32_bf16 v[32:35], v[60:63], v[116:119], v[32:35]
    ds_read_b64 v[96:97], v232 offset:2112
    v_mfma_f32_16x16x32_bf16 v[32:35], v[64:67], v[112:115], v[32:35]
    ds_read_b64 v[98:99], v232 offset:2120
    v_mfma_f32_16x16x32_bf16 v[36:39], v[48:51], v[132:135], v[36:39]
    ds_read_b128 v[164:167], v233 offset:1088
    v_mfma_f32_16x16x32_bf16 v[36:39], v[52:55], v[128:131], v[36:39]
    ds_read_b64 v[100:101], v232 offset:2624
    v_mfma_f32_16x16x32_bf16 v[36:39], v[56:59], v[124:127], v[36:39]
    ds_read_b64 v[102:103], v232 offset:2632
    v_mfma_f32_16x16x32_bf16 v[36:39], v[60:63], v[120:123], v[36:39]
    ds_read_b128 v[168:171], v233 offset:576
    v_mfma_f32_16x16x32_bf16 v[36:39], v[64:67], v[116:119], v[36:39]
    ds_read_b64 v[104:105], v232 offset:3136
    v_mfma_f32_16x16x32_bf16 v[36:39], v[68:71], v[112:115], v[36:39]
    ds_read_b64 v[106:107], v232 offset:3144
    v_mfma_f32_16x16x32_bf16 v[40:43], v[48:51], v[136:139], v[40:43]
    ds_read_b128 v[172:175], v233 offset:64
    v_mfma_f32_16x16x32_bf16 v[40:43], v[52:55], v[132:135], v[40:43]
    ds_read_b64 v[108:109], v232 offset:3648
    v_mfma_f32_16x16x32_bf16 v[40:43], v[56:59], v[128:131], v[40:43]
    ds_read_b64 v[110:111], v232 offset:3656
    v_mfma_f32_16x16x32_bf16 v[40:43], v[60:63], v[124:127], v[40:43]
    v_mfma_f32_16x16x32_bf16 v[40:43], v[64:67], v[120:123], v[40:43]
    v_mfma_f32_16x16x32_bf16 v[40:43], v[68:71], v[116:119], v[40:43]
    v_mfma_f32_16x16x32_bf16 v[40:43], v[72:75], v[112:115], v[40:43]
    v_mfma_f32_16x16x32_bf16 v[44:47], v[48:51], v[140:143], v[44:47]
    v_mfma_f32_16x16x32_bf16 v[44:47], v[52:55], v[136:139], v[44:47]
    v_mfma_f32_16x16x32_bf16 v[44:47], v[56:59], v[132:135], v[44:47]
    v_mfma_f32_16x16x32_bf16 v[44:47], v[60:63], v[128:131], v[44:47]
    v_mfma_f32_16x16x32_bf16 v[44:47], v[64:67], v[124:127], v[44:47]
    v_mfma_f32_16x16x32_bf16 v[44:47], v[68:71], v[120:123], v[44:47]
    v_mfma_f32_16x16x32_bf16 v[44:47], v[72:75], v[116:119], v[44:47]
    v_mfma_f32_16x16x32_bf16 v[44:47], v[76:79], v[112:115], v[44:47]
    s_waitcnt lgkmcnt(0)
    v_mfma_f32_16x16x32_bf16 v[16:19], v[80:83], v[144:147], v[16:19]
    ds_read_b128 v[112:115], v233 offset:3712
    v_mfma_f32_16x16x32_bf16 v[20:23], v[80:83], v[148:151], v[20:23]
    ds_read_b64 v[48:49], v232 offset:128
    v_mfma_f32_16x16x32_bf16 v[20:23], v[84:87], v[144:147], v[20:23]
    ds_read_b64 v[50:51], v232 offset:136
    v_mfma_f32_16x16x32_bf16 v[24:27], v[80:83], v[152:155], v[24:27]
    ds_read_b128 v[116:119], v233 offset:3200
    v_mfma_f32_16x16x32_bf16 v[24:27], v[84:87], v[148:151], v[24:27]
    ds_read_b64 v[52:53], v232 offset:640
    v_mfma_f32_16x16x32_bf16 v[24:27], v[88:91], v[144:147], v[24:27]
    ds_read_b64 v[54:55], v232 offset:648
    v_mfma_f32_16x16x32_bf16 v[28:31], v[80:83], v[156:159], v[28:31]
    ds_read_b128 v[120:123], v233 offset:2688
    v_mfma_f32_16x16x32_bf16 v[28:31], v[84:87], v[152:155], v[28:31]
    ds_read_b64 v[56:57], v232 offset:1152
    v_mfma_f32_16x16x32_bf16 v[28:31], v[88:91], v[148:151], v[28:31]
    ds_read_b64 v[58:59], v232 offset:1160
    v_mfma_f32_16x16x32_bf16 v[28:31], v[92:95], v[144:147], v[28:31]
    ds_read_b128 v[124:127], v233 offset:2176
    v_mfma_f32_16x16x32_bf16 v[32:35], v[80:83], v[160:163], v[32:35]
    ds_read_b64 v[60:61], v232 offset:1664
    v_mfma_f32_16x16x32_bf16 v[32:35], v[84:87], v[156:159], v[32:35]
    ds_read_b64 v[62:63], v232 offset:1672
    v_mfma_f32_16x16x32_bf16 v[32:35], v[88:91], v[152:155], v[32:35]
    ds_read_b128 v[128:131], v233 offset:1664
    v_mfma_f32_16x16x32_bf16 v[32:35], v[92:95], v[148:151], v[32:35]
    ds_read_b64 v[64:65], v232 offset:2176
    v_mfma_f32_16x16x32_bf16 v[32:35], v[96:99], v[144:147], v[32:35]
    ds_read_b64 v[66:67], v232 offset:2184
    v_mfma_f32_16x16x32_bf16 v[36:39], v[80:83], v[164:167], v[36:39]
    ds_read_b128 v[132:135], v233 offset:1152
    v_mfma_f32_16x16x32_bf16 v[36:39], v[84:87], v[160:163], v[36:39]
    ds_read_b64 v[68:69], v232 offset:2688
    v_mfma_f32_16x16x32_bf16 v[36:39], v[88:91], v[156:159], v[36:39]
    ds_read_b64 v[70:71], v232 offset:2696
    v_mfma_f32_16x16x32_bf16 v[36:39], v[92:95], v[152:155], v[36:39]
    ds_read_b128 v[136:139], v233 offset:640
    v_mfma_f32_16x16x32_bf16 v[36:39], v[96:99], v[148:151], v[36:39]
    ds_read_b64 v[72:73], v232 offset:3200
    v_mfma_f32_16x16x32_bf16 v[36:39], v[100:103], v[144:147], v[36:39]
    ds_read_b64 v[74:75], v232 offset:3208
    v_mfma_f32_16x16x32_bf16 v[40:43], v[80:83], v[168:171], v[40:43]
    ds_read_b128 v[140:143], v233 offset:128
    v_mfma_f32_16x16x32_bf16 v[40:43], v[84:87], v[164:167], v[40:43]
    ds_read_b64 v[76:77], v232 offset:3712
    v_mfma_f32_16x16x32_bf16 v[40:43], v[88:91], v[160:163], v[40:43]
    ds_read_b64 v[78:79], v232 offset:3720
    v_mfma_f32_16x16x32_bf16 v[40:43], v[92:95], v[156:159], v[40:43]
    v_add_u32 v232, 128, v232
    v_mfma_f32_16x16x32_bf16 v[40:43], v[96:99], v[152:155], v[40:43]
    v_add_u32 v233, 128, v233
    v_mfma_f32_16x16x32_bf16 v[40:43], v[100:103], v[148:151], v[40:43]
    s_sub_u32 s74, s74, 1
    v_mfma_f32_16x16x32_bf16 v[40:43], v[104:107], v[144:147], v[40:43]
    s_cmp_lg_u32 s74, 0
    v_mfma_f32_16x16x32_bf16 v[44:47], v[80:83], v[172:175], v[44:47]
    v_mfma_f32_16x16x32_bf16 v[44:47], v[84:87], v[168:171], v[44:47]
    v_mfma_f32_16x16x32_bf16 v[44:47], v[88:91], v[164:167], v[44:47]
    v_mfma_f32_16x16x32_bf16 v[44:47], v[92:95], v[160:163], v[44:47]
    v_mfma_f32_16x16x32_bf16 v[44:47], v[96:99], v[156:159], v[44:47]
    v_mfma_f32_16x16x32_bf16 v[44:47], v[100:103], v[152:155], v[44:47]
    v_mfma_f32_16x16x32_bf16 v[44:47], v[104:107], v[148:151], v[44:47]
    v_mfma_f32_16x16x32_bf16 v[44:47], v[108:111], v[144:147], v[44:47]
    s_waitcnt lgkmcnt(0)
    s_cbranch_scc1 L_conv
    v_mfma_f32_16x16x32_bf16 v[16:19], v[48:51], v[112:115], v[16:19]
    ds_read_b128 v[144:147], v233 offset:3648
    ds_read_b64 v[80:81], v232 offset:64
    v_mfma_f32_16x16x32_bf16 v[20:23], v[48:51], v[116:119], v[20:23]
    ds_read_b64 v[82:83], v232 offset:72
    ds_read_b128 v[148:151], v233 offset:3136
    v_mfma_f32_16x16x32_bf16 v[20:23], v[52:55], v[112:115], v[20:23]
    ds_read_b64 v[84:85], v232 offset:576
    ds_read_b64 v[86:87], v232 offset:584
    v_mfma_f32_16x16x32_bf16 v[24:27], v[48:51], v[120:123], v[24:27]
    ds_read_b128 v[152:155], v233 offset:2624
    ds_read_b64 v[88:89], v232 offset:1088
    v_mfma_f32_16x16x32_bf16 v[24:27], v[52:55], v[116:119], v[24:27]
    ds_read_b64 v[90:91], v232 offset:1096
    ds_read_b128 v[156:159], v233 offset:2112
    v_mfma_f32_16x16x32_bf16 v[24:27], v[56:59], v[112:115], v[24:27]
    ds_read_b64 v[92:93], v232 offset:1600
    ds_read_b64 v[94:95], v232 offset:1608
    v_mfma_f32_16x16x32_bf16 v[28:31], v[48:51], v[124:127], v[28:31]
    ds_read_b128 v[160:163], v233 offset:1600
    ds_read_b64 v[96:97], v232 offset:2112
    v_mfma_f32_16x16x32_bf16 v[28:31], v[52:55], v[120:123], v[28:31]
    ds_read_b64 v[98:99], v232 offset:2120
    ds_read_b128 v[164:167], v233 offset:1088
    v_mfma_f32_16x16x32_bf16 v[28:31], v[56:59], v[116:119], v[28:31]
    ds_read_b64 v[100:101], v232 offset:2624
    ds_read_b64 v[102:103], v232 offset:2632
    v_mfma_f32_16x16x32_bf16 v[28:31], v[60:63], v[112:115], v[28:31]
    ds_read_b128 v[168:171], v233 offset:576
    ds_read_b64 v[104:105], v232 offset:3136
    v_mfma_f32_16x16x32_bf16 v[32:35], v[48:51], v[128:131], v[32:35]
    ds_read_b64 v[106:107], v232 offset:3144
    ds_read_b128 v[172:175], v233 offset:64
    v_mfma_f32_16x16x32_bf16 v[32:35], v[52:55], v[124:127], v[32:35]
    ds_read_b64 v[108:109], v232 offset:3648
    ds_read_b64 v[110:111], v232 offset:3656
    v_mfma_f32_16x16x32_bf16 v[32:35], v[56:59], v[120:123], v[32:35]
    s_mul_i32 s74, s68, 4224
    s_and_b32 s75, s71, 63
    v_mfma_f32_16x16x32_bf16 v[32:35], v[60:63], v[116:119], v[32:35]
    s_add_u32 s74, s74, s75
    s_lshl_b32 s74, s74, 6
    v_mfma_f32_16x16x32_bf16 v[32:35], v[64:67], v[112:115], v[32:35]
    v_and_b32 v234, 3, v0
    v_lshl_add_u32 v234, v234, 4, s74
    v_mfma_f32_16x16x32_bf16 v[36:39], v[48:51], v[132:135], v[36:39]
    v_and_b32 v235, 12, v0
    v_lshrrev_b32 v236, 4, v0
    v_mfma_f32_16x16x32_bf16 v[36:39], v[52:55], v[128:131], v[36:39]
    v_add_u32 v235, v235, v236
    v_mul_u32_u24 v235, 4224, v235
    v_mfma_f32_16x16x32_bf16 v[36:39], v[56:59], v[124:127], v[36:39]
    v_add_u32 v234, v234, v235
    v_mfma_f32_16x16x32_bf16 v[36:39], v[60:63], v[120:123], v[36:39]
    v_mfma_f32_16x16x32_bf16 v[36:39], v[64:67], v[116:119], v[36:39]
    v_mfma_f32_16x16x32_bf16 v[36:39], v[68:71], v[112:115], v[36:39]
    s_waitcnt lgkmcnt(0)
    s_mov_b64 exec, 1
    ds_add_u32 v227, v244 offset:36
    s_mov_b64 exec, -1
    v_mfma_f32_16x16x32_bf16 v[16:19], v[80:83], v[144:147], v[16:19]
    s_lshl4_add_u32 s73, s68, 256
    s_add_u32 s45, s73, s69
    v_mfma_f32_16x16x32_bf16 v[20:23], v[80:83], v[148:151], v[20:23]
    s_lshl_b32 s73, s73, 8
    s_lshl_b32 s45, s45, 8
    v_mfma_f32_16x16x32_bf16 v[20:23], v[84:87], v[144:147], v[20:23]
    v_mfma_f32_16x16x32_bf16 v[24:27], v[80:83], v[152:155], v[24:27]
    v_mfma_f32_16x16x32_bf16 v[24:27], v[84:87], v[148:151], v[24:27]
    v_mfma_f32_16x16x32_bf16 v[24:27], v[88:91], v[144:147], v[24:27]
    v_mfma_f32_16x16x32_bf16 v[28:31], v[80:83], v[156:159], v[28:31]
    v_cvt_pk_bf16_f32 v176, v16, v17
    v_cvt_pk_bf16_f32 v177, v18, v19
    v_mfma_f32_16x16x32_bf16 v[28:31], v[84:87], v[152:155], v[28:31]
    v_mfma_f32_16x16x32_bf16 v[28:31], v[88:91], v[148:151], v[28:31]
    v_cvt_pk_bf16_f32 v178, v20, v21
    v_cvt_pk_bf16_f32 v179, v22, v23
    v_mfma_f32_16x16x32_bf16 v[28:31], v[92:95], v[144:147], v[28:31]
    s_mov_b32 s76, 0
    buffer_store_dwordx4 v[176:179], v234, s[64:67], s76 offen sc1
    v_mfma_f32_16x16x32_bf16 v[32:35], v[80:83], v[160:163], v[32:35]
    v_cvt_pk_bf16_f32 v180, v24, v25
    v_cvt_pk_bf16_f32 v181, v26, v27
    v_mfma_f32_16x16x32_bf16 v[32:35], v[84:87], v[156:159], v[32:35]
    v_mfma_f32_16x16x32_bf16 v[32:35], v[88:91], v[152:155], v[32:35]
    v_mfma_f32_16x16x32_bf16 v[32:35], v[92:95], v[148:151], v[32:35]
    v_cvt_pk_bf16_f32 v182, v28, v29
    v_cvt_pk_bf16_f32 v183, v30, v31
    v_mfma_f32_16x16x32_bf16 v[32:35], v[96:99], v[144:147], v[32:35]
    s_mov_b32 s76, 67584
    buffer_store_dwordx4 v[180:183], v234, s[64:67], s76 offen sc1
    v_mfma_f32_16x16x32_bf16 v[36:39], v[80:83], v[164:167], v[36:39]
    v_mfma_f32_16x16x32_bf16 v[36:39], v[84:87], v[160:163], v[36:39]
    v_mfma_f32_16x16x32_bf16 v[36:39], v[88:91], v[156:159], v[36:39]
    v_mfma_f32_16x16x32_bf16 v[36:39], v[92:95], v[152:155], v[36:39]
    v_mfma_f32_16x16x32_bf16 v[36:39], v[96:99], v[148:151], v[36:39]
    v_mfma_f32_16x16x32_bf16 v[36:39], v[100:103], v[144:147], v[36:39]
    v_cvt_pk_bf16_f32 v184, v32, v33
    v_cvt_pk_bf16_f32 v185, v34, v35
    v_mfma_f32_16x16x32_bf16 v[40:43], v[48:51], v[136:139], v[40:43]
    v_mfma_f32_16x16x32_bf16 v[40:43], v[52:55], v[132:135], v[40:43]
    v_mfma_f32_16x16x32_bf16 v[40:43], v[56:59], v[128:131], v[40:43]
    v_mfma_f32_16x16x32_bf16 v[40:43], v[60:63], v[124:127], v[40:43]
    v_mfma_f32_16x16x32_bf16 v[40:43], v[64:67], v[120:123], v[40:43]
    v_mfma_f32_16x16x32_bf16 v[40:43], v[68:71], v[116:119], v[40:43]
    v_cvt_pk_bf16_f32 v186, v36, v37
    v_cvt_pk_bf16_f32 v187, v38, v39
    v_mfma_f32_16x16x32_bf16 v[40:43], v[72:75], v[112:115], v[40:43]
    s_mov_b32 s76, 135168
    buffer_store_dwordx4 v[184:187], v234, s[64:67], s76 offen sc1
    v_mfma_f32_16x16x32_bf16 v[44:47], v[48:51], v[140:143], v[44:47]
    v_mfma_f32_16x16x32_bf16 v[44:47], v[52:55], v[136:139], v[44:47]
    v_mfma_f32_16x16x32_bf16 v[44:47], v[56:59], v[132:135], v[44:47]
    v_mfma_f32_16x16x32_bf16 v[44:47], v[60:63], v[128:131], v[44:47]
    v_mfma_f32_16x16x32_bf16 v[44:47], v[64:67], v[124:127], v[44:47]
    v_mfma_f32_16x16x32_bf16 v[44:47], v[68:71], v[120:123], v[44:47]
    v_mfma_f32_16x16x32_bf16 v[44:47], v[72:75], v[116:119], v[44:47]
    v_mfma_f32_16x16x32_bf16 v[44:47], v[76:79], v[112:115], v[44:47]
    v_mfma_f32_16x16x32_bf16 v[40:43], v[80:83], v[168:171], v[40:43]
    v_mfma_f32_16x16x32_bf16 v[40:43], v[84:87], v[164:167], v[40:43]
    v_mfma_f32_16x16x32_bf16 v[40:43], v[88:91], v[160:163], v[40:43]
    v_mfma_f32_16x16x32_bf16 v[40:43], v[92:95], v[156:159], v[40:43]
    v_mfma_f32_16x16x32_bf16 v[40:43], v[96:99], v[152:155], v[40:43]
    v_mfma_f32_16x16x32_bf16 v[40:43], v[100:103], v[148:151], v[40:43]
    v_mfma_f32_16x16x32_bf16 v[40:43], v[104:107], v[144:147], v[40:43]
    v_mfma_f32_16x16x32_bf16 v[44:47], v[80:83], v[172:175], v[44:47]
    v_mfma_f32_16x16x32_bf16 v[44:47], v[84:87], v[168:171], v[44:47]
    v_mfma_f32_16x16x32_bf16 v[44:47], v[88:91], v[164:167], v[44:47]
    v_mfma_f32_16x16x32_bf16 v[44:47], v[92:95], v[160:163], v[44:47]
    v_mfma_f32_16x16x32_bf16 v[44:47], v[96:99], v[156:159], v[44:47]
    v_mfma_f32_16x16x32_bf16 v[44:47], v[100:103], v[152:155], v[44:47]
    v_mfma_f32_16x16x32_bf16 v[44:47], v[104:107], v[148:151], v[44:47]
    v_mfma_f32_16x16x32_bf16 v[44:47], v[108:111], v[144:147], v[44:47]
    v_cvt_pk_bf16_f32 v188, v40, v41
    v_cvt_pk_bf16_f32 v189, v42, v43
    s_nop 5
    v_cvt_pk_bf16_f32 v190, v44, v45
    v_cvt_pk_bf16_f32 v191, v46, v47
    s_mov_b32 s76, 202752
    buffer_store_dwordx4 v[188:191], v234, s[64:67], s76 offen sc1
    s_setprio 1
    s_waitcnt vmcnt(0)
    v_mov_b32 v238, 1
    s_mov_b64 exec, 1
    ds_add_rtn_u32 v237, v227, v238 offset:8
    s_waitcnt lgkmcnt(0)
    v_readfirstlane_b32 s76, v237
    s_nop 0
    s_cmp_eq_u32 s76, 3
    s_cbranch_scc0 L_jo_38a
    s_mov_b64 exec, 0xffff
    v_lshlrev_b32 v237, 8, v0
    buffer_atomic_add v238, v237, s[52:55], s73 offen sc1
L_jo_38a:
    s_mov_b64 exec, -1
    v_lshlrev_b32 v112, 16, v208
    v_and_b32 v113, 0xffff0000, v208
    v_lshlrev_b32 v114, 16, v209
    v_and_b32 v115, 0xffff0000, v209
    v_lshlrev_b32 v116, 16, v210
    v_and_b32 v117, 0xffff0000, v210
    v_lshlrev_b32 v118, 16, v211
    v_and_b32 v119, 0xffff0000, v211
    v_lshlrev_b32 v120, 16, v212
    v_and_b32 v121, 0xffff0000, v212
    v_lshlrev_b32 v122, 16, v213
    v_and_b32 v123, 0xffff0000, v213
    v_lshlrev_b32 v124, 16, v214
    v_and_b32 v125, 0xffff0000, v214
    v_lshlrev_b32 v126, 16, v215
    v_and_b32 v127, 0xffff0000, v215
    v_lshlrev_b32 v128, 16, v216
    v_and_b32 v129, 0xffff0000, v216
    v_lshlrev_b32 v130, 16, v217
    v_and_b32 v131, 0xffff0000, v217
    v_lshlrev_b32 v132, 16, v218
    v_and_b32 v133, 0xffff0000, v218
    v_lshlrev_b32 v134, 16, v219
    v_and_b32 v135, 0xffff0000, v219
    v_lshlrev_b32 v136, 16, v220
    v_and_b32 v137, 0xffff0000, v220
    v_lshlrev_b32 v138, 16, v221
    v_and_b32 v139, 0xffff0000, v221
    v_lshlrev_b32 v140, 16, v222
    v_and_b32 v141, 0xffff0000, v222
    v_lshlrev_b32 v142, 16, v223
    v_and_b32 v143, 0xffff0000, v223
    s_setprio 1
    s_setprio 1
    s_mul_i32 s77, s70, 4352
    s_add_u32 s77, s77, 60416
    v_lshrrev_b32 v234, 5, v0
    v_lshl_add_u32 v234, v234, 1, v0
    v_lshl_add_u32 v234, v234, 4, s77
    v_and_b32 v235, 7, v0
    v_mul_u32_u24 v235, 544, v235
    v_lshrrev_b32 v236, 3, v0
    v_lshl_add_u32 v235, v236, 3, v235
    v_add_u32 v235, s77, v235
    s_mul_i32 s77, s71, 4224
    s_mov_b32 s60, s26
    s_mov_b32 s61, s27
    s_mov_b32 s62, 0x800000
    s_mov_b32 s63, 0x20000
    s_cmp_eq_u32 s76, 3
    s_cbranch_scc0 L_jo_38
    s_mov_b32 s75, 131072
L_sg_loop_41:
    s_load_dword s74, s[52:53], s45 glc
L_sg_chk_42:
    s_waitcnt lgkmcnt(0)
    s_cmp_ge_u32 s74, 16
    s_cbranch_scc1 L_sg_done_40
    s_sub_u32 s75, s75, 1
    s_cbranch_scc0 L_sg_loop_41
L_sg_done_40:
    v_mov_b32 v237, 16
    s_mov_b64 exec, 1
    ds_add_u32 v227, v237 offset:16
    s_mov_b64 exec, -1
    s_branch L_jd_39
L_jo_38:
    s_mov_b32 s75, 1048576
L_sl_loop_44:
    ds_read_b32 v237, v227 offset:16
    s_waitcnt lgkmcnt(0)
    v_readfirstlane_b32 s74, v237
    s_nop 0
    s_cmp_ge_u32 s74, 16
    s_cbranch_scc1 L_sl_done_43
    s_sleep 1
    s_sub_u32 s75, s75, 1
    s_cbranch_scc0 L_sl_loop_44
L_sl_done_43:
L_jd_39:
    buffer_load_dwordx4 v[48:51], v224, s[64:67], s77 offen offset:0 sc1
    buffer_load_dwordx4 v[52:55], v224, s[64:67], s77 offen offset:1024 sc1
    buffer_load_dwordx4 v[56:59], v224, s[64:67], s77 offen offset:2048 sc1
    buffer_load_dwordx4 v[60:63], v224, s[64:67], s77 offen offset:3072 sc1
    s_waitcnt vmcnt(3)
    ds_write_b128 v234, v[48:51] offset:0
    s_waitcnt vmcnt(2)
    ds_write_b128 v234, v[52:55] offset:1088
    s_waitcnt vmcnt(1)
    ds_write_b128 v234, v[56:59] offset:2176
    s_waitcnt vmcnt(0)
    ds_write_b128 v234, v[60:63] offset:3264
    ds_read_b64 v[64:65], v235 offset:0
    ds_read_b64 v[66:67], v235 offset:64
    ds_read_b64 v[68:69], v235 offset:128
    ds_read_b64 v[70:71], v235 offset:192
    ds_read_b64 v[72:73], v235 offset:256
    ds_read_b64 v[74:75], v235 offset:320
    ds_read_b64 v[76:77], v235 offset:384
    ds_read_b64 v[78:79], v235 offset:448
    s_waitcnt lgkmcnt(7)
    v_lshlrev_b32 v16, 16, v64
    v_and_b32 v24, 0xffff0000, v64
    v_lshlrev_b32 v32, 16, v65
    v_and_b32 v40, 0xffff0000, v65
    s_waitcnt lgkmcnt(6)
    v_lshlrev_b32 v17, 16, v66
    v_and_b32 v25, 0xffff0000, v66
    v_lshlrev_b32 v33, 16, v67
    v_and_b32 v41, 0xffff0000, v67
    s_waitcnt lgkmcnt(5)
    v_lshlrev_b32 v18, 16, v68
    v_and_b32 v26, 0xffff0000, v68
    v_lshlrev_b32 v34, 16, v69
    v_and_b32 v42, 0xffff0000, v69
    s_waitcnt lgkmcnt(4)
    v_lshlrev_b32 v19, 16, v70
    v_and_b32 v27, 0xffff0000, v70
    v_lshlrev_b32 v35, 16, v71
    v_and_b32 v43, 0xffff0000, v71
    s_waitcnt lgkmcnt(3)
    v_lshlrev_b32 v20, 16, v72
    v_and_b32 v28, 0xffff0000, v72
    v_lshlrev_b32 v36, 16, v73
    v_and_b32 v44, 0xffff0000, v73
    s_waitcnt lgkmcnt(2)
    v_lshlrev_b32 v21, 16, v74
    v_and_b32 v29, 0xffff0000, v74
    v_lshlrev_b32 v37, 16, v75
    v_and_b32 v45, 0xffff0000, v75
    s_waitcnt lgkmcnt(1)
    v_lshlrev_b32 v22, 16, v76
    v_and_b32 v30, 0xffff0000, v76
    v_lshlrev_b32 v38, 16, v77
    v_and_b32 v46, 0xffff0000, v77
    s_waitcnt lgkmcnt(0)
    v_lshlrev_b32 v23, 16, v78
    v_and_b32 v31, 0xffff0000, v78
    v_lshlrev_b32 v39, 16, v79
    v_and_b32 v47, 0xffff0000, v79
    v_mul_f32 v16, v16, v112
    v_mul_f32 v17, v17, v113
    v_mul_f32 v18, v18, v114
    v_mul_f32 v19, v19, v115
    v_mul_f32 v20, v20, v116
    v_mul_f32 v21, v21, v117
    v_mul_f32 v22, v22, v118
    v_mul_f32 v23, v23, v119
    v_cvt_pk_bf16_f32 v48, v16, v17
    v_cvt_pk_bf16_f32 v49, v18, v19
    v_cvt_pk_bf16_f32 v50, v20, v21
    v_cvt_pk_bf16_f32 v51, v22, v23
    s_mov_b32 s74, 0
    buffer_store_dwordx4 v[48:51], v226, s[60:63], s74 offen nt
    v_mul_f32 v24, v24, v120
    v_mul_f32 v25, v25, v121
    v_mul_f32 v26, v26, v122
    v_mul_f32 v27, v27, v123
    v_mul_f32 v28, v28, v124
    v_mul_f32 v29, v29, v125
    v_mul_f32 v30, v30, v126
    v_mul_f32 v31, v31, v127
    v_cvt_pk_bf16_f32 v52, v24, v25
    v_cvt_pk_bf16_f32 v53, v26, v27
    v_cvt_pk_bf16_f32 v54, v28, v29
    v_cvt_pk_bf16_f32 v55, v30, v31
    s_mov_b32 s74, 4096
    buffer_store_dwordx4 v[52:55], v226, s[60:63], s74 offen nt
    v_mul_f32 v32, v32, v128
    v_mul_f32 v33, v33, v129
    v_mul_f32 v34, v34, v130
    v_mul_f32 v35, v35, v131
    v_mul_f32 v36, v36, v132
    v_mul_f32 v37, v37, v133
    v_mul_f32 v38, v38, v134
    v_mul_f32 v39, v39, v135
    v_cvt_pk_bf16_f32 v56, v32, v33
    v_cvt_pk_bf16_f32 v57, v34, v35
    v_cvt_pk_bf16_f32 v58, v36, v37
    v_cvt_pk_bf16_f32 v59, v38, v39
    s_mov_b32 s74, 16384
    buffer_store_dwordx4 v[56:59], v226, s[60:63], s74 offen nt
    v_mul_f32 v40, v40, v136
    v_mul_f32 v41, v41, v137
    v_mul_f32 v42, v42, v138
    v_mul_f32 v43, v43, v139
    v_mul_f32 v44, v44, v140
    v_mul_f32 v45, v45, v141
    v_mul_f32 v46, v46, v142
    v_mul_f32 v47, v47, v143
    v_cvt_pk_bf16_f32 v60, v40, v41
    v_cvt_pk_bf16_f32 v61, v42, v43
    v_cvt_pk_bf16_f32 v62, v44, v45
    v_cvt_pk_bf16_f32 v63, v46, v47
    s_mov_b32 s74, 20480
    buffer_store_dwordx4 v[60:63], v226, s[60:63], s74 offen nt
    s_endpgm
L_grole:
    s_setprio 2
    s_add_u32 s52, s30, 0xe00000
    s_addc_u32 s53, s31, 0
    s_mov_b32 s54, 0x20000
    s_mov_b32 s55, 0x20000
    s_lshr_b32 s32, s3, 1
    s_and_b32 s33, s3, 1
    v_and_b32 v1, 15, v0
    v_lshrrev_b32 v2, 4, v0
    v_lshrrev_b32 v3, 1, v1
    v_xor_b32 v3, v2, v3
    v_lshlrev_b32 v3, 4, v3
    v_lshl_add_u32 v3, v1, 7, v3
    s_lshl_b32 s37, s33, 13
    v_add_u32 v196, s37, v3
    v_xor_b32 v197, 64, v196
    v_and_b32 v198, 7, v1
    v_lshlrev_b32 v3, 1, v2
    v_xor_b32 v3, v3, v198
    v_lshlrev_b32 v3, 4, v3
    v_lshl_add_u32 v3, v198, 7, v3
    v_lshrrev_b32 v202, 3, v1
    v_lshl_add_u32 v3, v202, 2, v3
    v_add_u32 v198, 16384, v3
    v_xor_b32 v199, 16, v198
    v_mul_u32_u24 v202, 0xaaaa, v202
    v_add_u32 v202, 0x4444, v202
    v_bfe_u32 v3, v0, 2, 2
    v_lshl_add_u32 v200, v2, 3, v3
    v_lshlrev_b32 v200, 7, v200
    v_bfe_u32 v3, v0, 3, 2
    v_xor_b32 v3, s3, v3
    v_lshl_add_u32 v200, v3, 5, v200
    v_and_b32 v3, 3, v0
    v_lshl_add_u32 v200, v3, 3, v200
    v_add_u32 v200, 17408, v200
    v_xor_b32 v201, 32, v200
    v_mov_b64 v[52:53], 0
    v_mov_b64 v[54:55], 0
    v_mov_b64 v[56:57], 0
    v_mov_b64 v[58:59], 0
    v_mov_b64 v[60:61], 0
    v_mov_b64 v[62:63], 0
    v_mov_b64 v[64:65], 0
    v_mov_b64 v[66:67], 0
    v_mov_b64 v[68:69], 0
    v_mov_b64 v[70:71], 0
    v_mov_b64 v[72:73], 0
    v_mov_b64 v[74:75], 0
    v_mov_b64 v[76:77], 0
    v_mov_b64 v[78:79], 0
    v_mov_b64 v[80:81], 0
    v_mov_b64 v[82:83], 0
    v_mov_b64 v[84:85], 0
    v_mov_b64 v[86:87], 0
    v_mov_b64 v[88:89], 0
    v_mov_b64 v[90:91], 0
    v_mov_b64 v[92:93], 0
    v_mov_b64 v[94:95], 0
    v_mov_b64 v[96:97], 0
    v_mov_b64 v[98:99], 0
    v_mov_b64 v[100:101], 0
    v_mov_b64 v[102:103], 0
    v_mov_b64 v[104:105], 0
    v_mov_b64 v[106:107], 0
    s_mov_b32 s34, 0
    v_mov_b32 v228, 134352
    v_and_b32 v1, 15, v0
    v_lshrrev_b32 v2, 4, v0
    v_lshlrev_b32 v2, 2, v2
    v_sub_u32 v1, v1, v2
    s_mov_b32 s37, 0xf149f2ca
    v_mov_b32 v3, s37
    s_or_b32 s38, s5, s33
    s_cmp_eq_u32 s38, 0
    s_cselect_b32 s38, s37, 0
    v_subrev_u32 v2, 0, v1
    v_cmp_gt_u32 vcc, 8, v2
    v_cmp_gt_i32 s[64:65], -8, v2
    v_ashrrev_i32 v2, 31, v2
    v_cndmask_b32 v204, v3, 0, vcc
    v_cndmask_b32 v208, v3, 0, s[64:65]
    v_mov_b32 v216, v2
    v_min_f32 v212, s38, v208
    v_subrev_u32 v2, 1, v1
    v_cmp_gt_u32 vcc, 8, v2
    v_cmp_gt_i32 s[64:65], -8, v2
    v_ashrrev_i32 v2, 31, v2
    v_cndmask_b32 v205, v3, 0, vcc
    v_cndmask_b32 v209, v3, 0, s[64:65]
    v_alignbit_b32 v216, v2, v216, 16
    v_min_f32 v213, s38, v209
    v_subrev_u32 v2, 2, v1
    v_cmp_gt_u32 vcc, 8, v2
    v_cmp_gt_i32 s[64:65], -8, v2
    v_ashrrev_i32 v2, 31, v2
    v_cndmask_b32 v206, v3, 0, vcc
    v_cndmask_b32 v210, v3, 0, s[64:65]
    v_mov_b32 v217, v2
    v_min_f32 v214, s38, v210
    v_subrev_u32 v2, 3, v1
    v_cmp_gt_u32 vcc, 8, v2
    v_cmp_gt_i32 s[64:65], -8, v2
    v_ashrrev_i32 v2, 31, v2
    v_cndmask_b32 v207, v3, 0, vcc
    v_cndmask_b32 v211, v3, 0, s[64:65]
    v_alignbit_b32 v217, v2, v217, 16
    v_min_f32 v215, s38, v211
    s_mul_i32 s37, s32, 80896
    s_add_u32 s37, s37, 78848
    v_lshl_add_u32 v220, v0, 3, s37
    s_lshl_b32 s38, s33, 9
    v_add_u32 v219, s38, v220
    s_add_u32 s38, s38, s37
    v_and_b32 v1, 3, v0
    v_lshl_add_u32 v1, v1, 1, s38
    v_bfe_u32 v2, v0, 2, 2
    v_lshl_add_u32 v1, v2, 7, v1
    v_lshrrev_b32 v2, 4, v0
    v_xor_b32 v2, 2, v2
    v_lshl_add_u32 v203, v2, 5, v1
    s_mul_i32 s38, s33, 2560
    v_add_u32 v221, s38, v220
    v_xor_b32 v222, 512, v221
    s_lshl3_add_u32 s37, s4, s5
    s_lshl1_add_u32 s37, s37, s33
    s_lshl_b32 s37, s37, 7
    s_lshl1_add_u32 s38, s6, s32
    s_add_u32 s37, s37, s38
    s_lshl_b32 s37, s37, 10
    v_lshl_add_u32 v218, v0, 4, s37
    s_mov_b32 s40, s30
    s_mov_b32 s41, s31
    s_mov_b32 s42, 0x400000
    s_mov_b32 s43, 0x20000
    s_and_b32 s58, s2, 3
    s_bfe_u32 s37, s2, 0x20003
    s_lshl2_add_u32 s58, s58, s37
    s_bfe_u32 s59, s2, 0x10002
    s_lshr_b32 s37, s2, 5
    s_lshl3_add_u32 s59, s59, s37
    s_mov_b32 s44, s24
    s_mov_b32 s45, s25
    s_mov_b32 s46, 0x200000
    s_mov_b32 s47, 0x20000
    s_mov_b32 s48, s26
    s_mov_b32 s49, s27
    s_mov_b32 s50, 0x800000
    s_mov_b32 s51, 0x20000
    s_lshl3_add_u32 s56, s4, s5
    s_lshl4_add_u32 s56, s56, 0
    s_lshl_b32 s56, s56, 8
    s_lshl4_add_u32 s57, s58, 0
    s_add_u32 s57, s57, s59
    s_lshl_b32 s57, s57, 8
    s_lshl2_add_u32 s37, s58, s3
    s_lshl_b32 s38, s37, 16
    v_lshl_add_u32 v224, v0, 4, s38
    v_add_u32 v225, 0x8000, v224
    s_and_b32 s37, s37, 31
    s_lshl_b32 s37, s37, 6
    s_lshr_b32 s38, s58, 3
    s_add_u32 s37, s37, s38
    s_lshl_b32 s37, s37, 5
    s_add_u32 s37, s37, s59
    s_add_u32 s37, s37, 16
    s_lshl_b32 s37, s37, 7
    v_lshrrev_b32 v1, 3, v0
    v_lshl_add_u32 v1, v1, 13, s37
    v_and_b32 v2, 7, v0
    v_lshl_add_u32 v226, v2, 4, v1
    v_lshrrev_b32 v1, 4, v0
    v_lshlrev_b32 v1, 1, v1
    v_xor_b32 v1, v0, v1
    v_and_b32 v1, 7, v1
    s_lshl_b32 s37, s59, 7
    v_lshl_add_u32 v1, v1, 4, s37
    v_lshrrev_b32 v227, 3, v0
    v_lshl_add_u32 v227, v227, 11, v1
    v_add_u32 v223, 15360, v227
    s_lshl_b32 s60, s3, 11
    s_mul_i32 s61, s59, 0
    s_and_b32 s61, s61, 7
    s_lshl3_add_u32 s62, s61, s3
    s_lshl_b32 s62, s62, 15
    v_lshrrev_b32 v1, 2, v0
    v_lshlrev_b32 v1, 7, v1
    v_bfe_u32 v2, v0, 3, 2
    v_lshl_add_u32 v1, v2, 5, v1
    v_and_b32 v2, 3, v0
    v_lshl_add_u32 v229, v2, 3, v1
    v_and_b32 v231, 7, v0
    v_lshl_add_u32 v230, v231, 6, s86
    v_mul_u32_u24 v231, 528, v231
    v_lshrrev_b32 v232, 3, v0
    v_xor_b32 v232, 7, v232
    v_lshl_add_u32 v231, v232, 3, v231
    v_add_u32 v231, s86, v231
    v_lshrrev_b32 v232, 5, v0
    v_add_u32 v232, v0, v232
    v_lshl_add_u32 v232, v232, 4, s86
    s_mul_i32 s87, s84, 4224
    s_sub_u32 s87, s87, s85
    s_lshl_b32 s87, s87, 6
    s_add_u32 s87, s87, 4032
    v_and_b32 v233, 3, v0
    v_lshl_add_u32 v233, v233, 4, s87
    v_lshrrev_b32 v234, 2, v0
    v_mul_u32_u24 v234, 4224, v234
    v_add_u32 v233, v233, v234
    s_add_u32 s80, s30, 0x400000
    s_addc_u32 s81, s31, 0
    s_mov_b32 s82, 0x420000
    s_mov_b32 s83, 0x20000
    s_waitcnt vmcnt(11)
    ds_read_b128 v[36:39], v230 offset:4224
    ds_read_b128 v[40:43], v230 offset:4240
    ds_read_b128 v[44:47], v230 offset:4256
    ds_read_b128 v[48:51], v230 offset:4272
    s_waitcnt lgkmcnt(3)
    v_lshlrev_b32 v152, 16, v36
    v_and_b32 v154, 0xffff0000, v36
    v_lshlrev_b32 v156, 16, v37
    v_and_b32 v158, 0xffff0000, v37
    v_lshlrev_b32 v153, 16, v38
    v_and_b32 v155, 0xffff0000, v38
    v_lshlrev_b32 v157, 16, v39
    v_and_b32 v159, 0xffff0000, v39
    s_waitcnt lgkmcnt(2)
    v_lshlrev_b32 v160, 16, v40
    v_and_b32 v162, 0xffff0000, v40
    v_lshlrev_b32 v164, 16, v41
    v_and_b32 v166, 0xffff0000, v41
    v_lshlrev_b32 v161, 16, v42
    v_and_b32 v163, 0xffff0000, v42
    v_lshlrev_b32 v165, 16, v43
    v_and_b32 v167, 0xffff0000, v43
    s_waitcnt lgkmcnt(1)
    v_lshlrev_b32 v168, 16, v44
    v_and_b32 v170, 0xffff0000, v44
    v_lshlrev_b32 v172, 16, v45
    v_and_b32 v174, 0xffff0000, v45
    v_lshlrev_b32 v169, 16, v46
    v_and_b32 v171, 0xffff0000, v46
    v_lshlrev_b32 v173, 16, v47
    v_and_b32 v175, 0xffff0000, v47
    s_waitcnt lgkmcnt(0)
    v_lshlrev_b32 v176, 16, v48
    v_and_b32 v178, 0xffff0000, v48
    v_lshlrev_b32 v180, 16, v49
    v_and_b32 v182, 0xffff0000, v49
    v_lshlrev_b32 v177, 16, v50
    v_and_b32 v179, 0xffff0000, v50
    v_lshlrev_b32 v181, 16, v51
    v_and_b32 v183, 0xffff0000, v51
    v_mov_b64 v[36:37], 0
    v_mov_b64 v[38:39], 0
    v_mov_b64 v[40:41], 0
    v_mov_b64 v[42:43], 0
    v_mov_b64 v[44:45], 0
    v_mov_b64 v[46:47], 0
    v_mov_b64 v[48:49], 0
    v_mov_b64 v[50:51], 0
    s_waitcnt vmcnt(10)
    v_lshlrev_b32 v184, 16, v108
    v_and_b32 v185, 0xffff0000, v108
    v_lshlrev_b32 v186, 16, v109
    v_and_b32 v187, 0xffff0000, v109
    v_lshlrev_b32 v188, 16, v110
    v_and_b32 v189, 0xffff0000, v110
    v_lshlrev_b32 v190, 16, v111
    v_and_b32 v191, 0xffff0000, v111
    v_pk_mul_f32 v[4:5], v[184:185], v[158:159]
    v_pk_mul_f32 v[12:13], v[186:187], v[166:167]
    v_pk_mul_f32 v[20:21], v[188:189], v[174:175]
    v_pk_mul_f32 v[28:29], v[190:191], v[182:183]
    s_waitcnt vmcnt(9)
    v_lshlrev_b32 v184, 16, v112
    v_and_b32 v185, 0xffff0000, v112
    v_lshlrev_b32 v186, 16, v113
    v_and_b32 v187, 0xffff0000, v113
    v_lshlrev_b32 v188, 16, v114
    v_and_b32 v189, 0xffff0000, v114
    v_lshlrev_b32 v190, 16, v115
    v_and_b32 v191, 0xffff0000, v115
    v_pk_fma_f32 v[4:5], v[184:185], v[156:157], v[4:5]
    v_pk_fma_f32 v[12:13], v[186:187], v[164:165], v[12:13]
    v_pk_fma_f32 v[20:21], v[188:189], v[172:173], v[20:21]
    v_pk_fma_f32 v[28:29], v[190:191], v[180:181], v[28:29]
    v_pk_mul_f32 v[6:7], v[184:185], v[158:159]
    v_pk_mul_f32 v[14:15], v[186:187], v[166:167]
    v_pk_mul_f32 v[22:23], v[188:189], v[174:175]
    v_pk_mul_f32 v[30:31], v[190:191], v[182:183]
    s_waitcnt vmcnt(8)
    v_lshlrev_b32 v184, 16, v116
    v_and_b32 v185, 0xffff0000, v116
    v_lshlrev_b32 v186, 16, v117
    v_and_b32 v187, 0xffff0000, v117
    v_lshlrev_b32 v188, 16, v118
    v_and_b32 v189, 0xffff0000, v118
    v_lshlrev_b32 v190, 16, v119
    v_and_b32 v191, 0xffff0000, v119
    v_pk_fma_f32 v[4:5], v[184:185], v[154:155], v[4:5]
    v_pk_fma_f32 v[12:13], v[186:187], v[162:163], v[12:13]
    v_pk_fma_f32 v[20:21], v[188:189], v[170:171], v[20:21]
    v_pk_fma_f32 v[28:29], v[190:191], v[178:179], v[28:29]
    v_pk_fma_f32 v[6:7], v[184:185], v[156:157], v[6:7]
    v_pk_fma_f32 v[14:15], v[186:187], v[164:165], v[14:15]
    v_pk_fma_f32 v[22:23], v[188:189], v[172:173], v[22:23]
    v_pk_fma_f32 v[30:31], v[190:191], v[180:181], v[30:31]
    v_pk_mul_f32 v[8:9], v[184:185], v[158:159]
    v_pk_mul_f32 v[16:17], v[186:187], v[166:167]
    v_pk_mul_f32 v[24:25], v[188:189], v[174:175]
    v_pk_mul_f32 v[32:33], v[190:191], v[182:183]
    s_waitcnt vmcnt(7)
    v_lshlrev_b32 v184, 16, v120
    v_and_b32 v185, 0xffff0000, v120
    v_lshlrev_b32 v186, 16, v121
    v_and_b32 v187, 0xffff0000, v121
    v_lshlrev_b32 v188, 16, v122
    v_and_b32 v189, 0xffff0000, v122
    v_lshlrev_b32 v190, 16, v123
    v_and_b32 v191, 0xffff0000, v123
    v_pk_fma_f32 v[4:5], v[184:185], v[152:153], v[4:5]
    v_pk_fma_f32 v[12:13], v[186:187], v[160:161], v[12:13]
    v_pk_fma_f32 v[20:21], v[188:189], v[168:169], v[20:21]
    v_pk_fma_f32 v[28:29], v[190:191], v[176:177], v[28:29]
    v_pk_fma_f32 v[6:7], v[184:185], v[154:155], v[6:7]
    v_pk_fma_f32 v[14:15], v[186:187], v[162:163], v[14:15]
    v_pk_fma_f32 v[22:23], v[188:189], v[170:171], v[22:23]
    v_pk_fma_f32 v[30:31], v[190:191], v[178:179], v[30:31]
    v_pk_fma_f32 v[8:9], v[184:185], v[156:157], v[8:9]
    v_pk_fma_f32 v[16:17], v[186:187], v[164:165], v[16:17]
    v_pk_fma_f32 v[24:25], v[188:189], v[172:173], v[24:25]
    v_pk_fma_f32 v[32:33], v[190:191], v[180:181], v[32:33]
    v_pk_mul_f32 v[10:11], v[184:185], v[158:159]
    v_pk_mul_f32 v[18:19], v[186:187], v[166:167]
    v_pk_mul_f32 v[26:27], v[188:189], v[174:175]
    v_pk_mul_f32 v[34:35], v[190:191], v[182:183]
    s_waitcnt vmcnt(6)
    v_lshlrev_b32 v184, 16, v124
    v_and_b32 v185, 0xffff0000, v124
    v_lshlrev_b32 v186, 16, v125
    v_and_b32 v187, 0xffff0000, v125
    v_lshlrev_b32 v188, 16, v126
    v_and_b32 v189, 0xffff0000, v126
    v_lshlrev_b32 v190, 16, v127
    v_and_b32 v191, 0xffff0000, v127
    v_pk_fma_f32 v[6:7], v[184:185], v[152:153], v[6:7]
    v_pk_fma_f32 v[14:15], v[186:187], v[160:161], v[14:15]
    v_pk_fma_f32 v[22:23], v[188:189], v[168:169], v[22:23]
    v_pk_fma_f32 v[30:31], v[190:191], v[176:177], v[30:31]
    v_pk_fma_f32 v[8:9], v[184:185], v[154:155], v[8:9]
    v_pk_fma_f32 v[16:17], v[186:187], v[162:163], v[16:17]
    v_pk_fma_f32 v[24:25], v[188:189], v[170:171], v[24:25]
    v_pk_fma_f32 v[32:33], v[190:191], v[178:179], v[32:33]
    v_pk_fma_f32 v[10:11], v[184:185], v[156:157], v[10:11]
    v_pk_fma_f32 v[18:19], v[186:187], v[164:165], v[18:19]
    v_pk_fma_f32 v[26:27], v[188:189], v[172:173], v[26:27]
    v_pk_fma_f32 v[34:35], v[190:191], v[180:181], v[34:35]
    s_waitcnt vmcnt(5)
    v_lshlrev_b32 v184, 16, v128
    v_and_b32 v185, 0xffff0000, v128
    v_lshlrev_b32 v186, 16, v129
    v_and_b32 v187, 0xffff0000, v129
    v_lshlrev_b32 v188, 16, v130
    v_and_b32 v189, 0xffff0000, v130
    v_lshlrev_b32 v190, 16, v131
    v_and_b32 v191, 0xffff0000, v131
    v_pk_fma_f32 v[8:9], v[184:185], v[152:153], v[8:9]
    v_pk_fma_f32 v[16:17], v[186:187], v[160:161], v[16:17]
    v_pk_fma_f32 v[24:25], v[188:189], v[168:169], v[24:25]
    v_pk_fma_f32 v[32:33], v[190:191], v[176:177], v[32:33]
    v_pk_fma_f32 v[10:11], v[184:185], v[154:155], v[10:11]
    v_pk_fma_f32 v[18:19], v[186:187], v[162:163], v[18:19]
    v_pk_fma_f32 v[26:27], v[188:189], v[170:171], v[26:27]
    v_pk_fma_f32 v[34:35], v[190:191], v[178:179], v[34:35]
    s_waitcnt vmcnt(4)
    v_lshlrev_b32 v184, 16, v132
    v_and_b32 v185, 0xffff0000, v132
    v_lshlrev_b32 v186, 16, v133
    v_and_b32 v187, 0xffff0000, v133
    v_lshlrev_b32 v188, 16, v134
    v_and_b32 v189, 0xffff0000, v134
    v_lshlrev_b32 v190, 16, v135
    v_and_b32 v191, 0xffff0000, v135
    v_pk_fma_f32 v[10:11], v[184:185], v[152:153], v[10:11]
    v_pk_fma_f32 v[18:19], v[186:187], v[160:161], v[18:19]
    v_pk_fma_f32 v[26:27], v[188:189], v[168:169], v[26:27]
    v_pk_fma_f32 v[34:35], v[190:191], v[176:177], v[34:35]
    s_waitcnt vmcnt(3)
    v_lshlrev_b32 v184, 16, v136
    v_and_b32 v185, 0xffff0000, v136
    v_lshlrev_b32 v186, 16, v137
    v_and_b32 v187, 0xffff0000, v137
    v_lshlrev_b32 v188, 16, v138
    v_and_b32 v189, 0xffff0000, v138
    v_lshlrev_b32 v190, 16, v139
    v_and_b32 v191, 0xffff0000, v139
    v_pk_mul_f32 v[4:5], v[4:5], v[184:185]
    v_pk_mul_f32 v[12:13], v[12:13], v[186:187]
    v_pk_mul_f32 v[20:21], v[20:21], v[188:189]
    v_pk_mul_f32 v[28:29], v[28:29], v[190:191]
    s_waitcnt vmcnt(2)
    v_lshlrev_b32 v184, 16, v140
    v_and_b32 v185, 0xffff0000, v140
    v_lshlrev_b32 v186, 16, v141
    v_and_b32 v187, 0xffff0000, v141
    v_lshlrev_b32 v188, 16, v142
    v_and_b32 v189, 0xffff0000, v142
    v_lshlrev_b32 v190, 16, v143
    v_and_b32 v191, 0xffff0000, v143
    v_pk_mul_f32 v[6:7], v[6:7], v[184:185]
    v_pk_mul_f32 v[14:15], v[14:15], v[186:187]
    v_pk_mul_f32 v[22:23], v[22:23], v[188:189]
    v_pk_mul_f32 v[30:31], v[30:31], v[190:191]
    s_waitcnt vmcnt(1)
    v_lshlrev_b32 v184, 16, v144
    v_and_b32 v185, 0xffff0000, v144
    v_lshlrev_b32 v186, 16, v145
    v_and_b32 v187, 0xffff0000, v145
    v_lshlrev_b32 v188, 16, v146
    v_and_b32 v189, 0xffff0000, v146
    v_lshlrev_b32 v190, 16, v147
    v_and_b32 v191, 0xffff0000, v147
    v_pk_mul_f32 v[8:9], v[8:9], v[184:185]
    v_pk_mul_f32 v[16:17], v[16:17], v[186:187]
    v_pk_mul_f32 v[24:25], v[24:25], v[188:189]
    v_pk_mul_f32 v[32:33], v[32:33], v[190:191]
    s_waitcnt vmcnt(0)
    v_lshlrev_b32 v184, 16, v148
    v_and_b32 v185, 0xffff0000, v148
    v_lshlrev_b32 v186, 16, v149
    v_and_b32 v187, 0xffff0000, v149
    v_lshlrev_b32 v188, 16, v150
    v_and_b32 v189, 0xffff0000, v150
    v_lshlrev_b32 v190, 16, v151
    v_and_b32 v191, 0xffff0000, v151
    v_pk_mul_f32 v[10:11], v[10:11], v[184:185]
    v_pk_mul_f32 v[18:19], v[18:19], v[186:187]
    v_pk_mul_f32 v[26:27], v[26:27], v[188:189]
    v_pk_mul_f32 v[34:35], v[34:35], v[190:191]
    v_cvt_pk_bf16_f32 v108, v10, v8
    v_cvt_pk_bf16_f32 v109, v6, v4
    ds_write_b64 v231, v[108:109] offset:0
    v_cvt_pk_bf16_f32 v110, v11, v9
    v_cvt_pk_bf16_f32 v111, v7, v5
    ds_write_b64 v231, v[110:111] offset:64
    v_cvt_pk_bf16_f32 v112, v18, v16
    v_cvt_pk_bf16_f32 v113, v14, v12
    ds_write_b64 v231, v[112:113] offset:128
    v_cvt_pk_bf16_f32 v114, v19, v17
    v_cvt_pk_bf16_f32 v115, v15, v13
    ds_write_b64 v231, v[114:115] offset:192
    v_cvt_pk_bf16_f32 v116, v26, v24
    v_cvt_pk_bf16_f32 v117, v22, v20
    ds_write_b64 v231, v[116:117] offset:256
    v_cvt_pk_bf16_f32 v118, v27, v25
    v_cvt_pk_bf16_f32 v119, v23, v21
    ds_write_b64 v231, v[118:119] offset:320
    v_cvt_pk_bf16_f32 v120, v34, v32
    v_cvt_pk_bf16_f32 v121, v30, v28
    ds_write_b64 v231, v[120:121] offset:384
    v_cvt_pk_bf16_f32 v122, v35, v33
    v_cvt_pk_bf16_f32 v123, v31, v29
    ds_write_b64 v231, v[122:123] offset:448
    ds_read_b128 v[234:237], v232 offset:0
    ds_read_b128 v[238:241], v232 offset:1056
    ds_read_b128 v[242:245], v232 offset:2112
    ds_read_b128 v[246:249], v232 offset:3168
    v_mov_b64 v[4:5], 0
    v_mov_b64 v[6:7], 0
    v_mov_b64 v[8:9], 0
    v_mov_b64 v[10:11], 0
    v_mov_b64 v[12:13], 0
    v_mov_b64 v[14:15], 0
    v_mov_b64 v[16:17], 0
    v_mov_b64 v[18:19], 0
    v_mov_b64 v[20:21], 0
    v_mov_b64 v[22:23], 0
    v_mov_b64 v[24:25], 0
    v_mov_b64 v[26:27], 0
    v_mov_b64 v[28:29], 0
    v_mov_b64 v[30:31], 0
    v_mov_b64 v[32:33], 0
    v_mov_b64 v[34:35], 0
    s_waitcnt lgkmcnt(0)
    s_and_b32 s37, s2, 7
    s_xor_b32 s37, s37, 2
    s_lshl_b32 s37, s37, 5
    s_lshr_b32 s38, s2, 3
    s_add_u32 s37, s37, s38
    s_add_u32 s37, s37, 256
    s_lshl_b32 s37, s37, 8
    s_cmp_eq_u32 s33, 0
    s_cselect_b32 s37, s37, s57
    s_cmp_eq_u32 s32, 0
    s_cbranch_scc0 L_noclear
    s_mov_b64 exec, 1
    buffer_store_dword v4, off, s[52:55], s37 sc1
    s_mov_b64 exec, -1
L_noclear:
    s_mov_b32 s37, 41984
    s_mov_b32 s36, 15
    s_barrier
    ds_read_b128 v[108:111], v196 offset:0
    ds_read_b64_tr_b16 v[124:125], v200 offset:0
    ds_read_b64_tr_b16 v[126:127], v200 offset:512
    ds_read_b128 v[112:115], v196 offset:2048
    ds_read_b64_tr_b16 v[128:129], v201 offset:0
    ds_read_b64_tr_b16 v[130:131], v201 offset:512
    ds_read_b128 v[116:119], v196 offset:4096
    ds_read_b64_tr_b16 v[148:149], v200 offset:8192
    ds_read_b64_tr_b16 v[150:151], v200 offset:8704
    ds_read_b128 v[120:123], v196 offset:6144
    ds_read_b64_tr_b16 v[132:133], v201 offset:8192
    ds_read_b64_tr_b16 v[134:135], v201 offset:8704
    ds_read_b64_tr_b16 v[156:157], v200 offset:16384
    ds_read_b64_tr_b16 v[158:159], v200 offset:16896
    ds_read_b64_tr_b16 v[136:137], v201 offset:16384
    ds_read_b64_tr_b16 v[138:139], v201 offset:16896
    s_mov_b32 s87, 0
    buffer_store_dwordx4 v[234:237], v233, s[80:83], s87 offen sc1
    s_mov_b32 s87, 67584
    buffer_store_dwordx4 v[238:241], v233, s[80:83], s87 offen sc1
    s_mov_b32 s87, 135168
    buffer_store_dwordx4 v[242:245], v233, s[80:83], s87 offen sc1
    s_mov_b32 s87, 202752
    buffer_store_dwordx4 v[246:249], v233, s[80:83], s87 offen sc1
    s_branch L_g1_head
.p2align 6
L_g1_head:
    s_waitcnt lgkmcnt(0)
L_g1_loop:
    v_mfma_f32_16x16x32_bf16 v[4:7], v[124:127], v[108:111], v[4:7]
    ds_read_b128 v[164:167], v197 offset:0
    v_mfma_f32_16x16x32_bf16 v[12:15], v[124:127], v[112:115], v[12:15]
    ds_read_b64_tr_b16 v[180:181], v200 offset:4096
    v_mfma_f32_16x16x32_bf16 v[20:23], v[124:127], v[116:119], v[20:23]
    ds_read_b64_tr_b16 v[182:183], v200 offset:4608
    v_mfma_f32_16x16x32_bf16 v[28:31], v[124:127], v[120:123], v[28:31]
    ds_read_b128 v[168:171], v197 offset:2048
    v_mfma_f32_16x16x32_bf16 v[32:35], v[128:131], v[120:123], v[32:35]
    ds_read_b64_tr_b16 v[184:185], v201 offset:4096
    v_mfma_f32_16x16x32_bf16 v[24:27], v[128:131], v[116:119], v[24:27]
    ds_read_b64_tr_b16 v[186:187], v201 offset:4608
    v_mfma_f32_16x16x32_bf16 v[16:19], v[128:131], v[112:115], v[16:19]
    ds_read_b128 v[172:175], v197 offset:4096
    v_mfma_f32_16x16x32_bf16 v[8:11], v[128:131], v[108:111], v[8:11]
    ds_read_b64_tr_b16 v[152:153], v200 offset:12288
    v_mfma_f32_16x16x32_bf16 v[40:43], v[132:135], v[108:111], v[40:43]
    ds_read_b64_tr_b16 v[154:155], v200 offset:12800
    v_mfma_f32_16x16x32_bf16 v[48:51], v[132:135], v[112:115], v[48:51]
    ds_read_b128 v[176:179], v197 offset:6144
    v_mfma_f32_16x16x32_bf16 v[56:59], v[132:135], v[116:119], v[56:59]
    ds_read_b64_tr_b16 v[188:189], v201 offset:12288
    v_mfma_f32_16x16x32_bf16 v[64:67], v[132:135], v[120:123], v[64:67]
    ds_read_b64_tr_b16 v[190:191], v201 offset:12800
    v_mfma_f32_16x16x32_bf16 v[60:63], v[148:151], v[120:123], v[60:63]
    ds_read2_b32 v[140:141], v198 offset1:2
    v_mfma_f32_16x16x32_bf16 v[52:55], v[148:151], v[116:119], v[52:55]
    ds_read2_b32 v[142:143], v199 offset1:2
    v_mfma_f32_16x16x32_bf16 v[44:47], v[148:151], v[112:115], v[44:47]
    ds_read_b64_tr_b16 v[160:161], v200 offset:20480
    v_mfma_f32_16x16x32_bf16 v[36:39], v[148:151], v[108:111], v[36:39]
    ds_read_b64_tr_b16 v[162:163], v200 offset:20992
    v_mfma_f32_16x16x32_bf16 v[68:71], v[108:111], v[156:159], v[68:71]
    ds_read_b64_tr_b16 v[192:193], v201 offset:20480
    ds_read_b64_tr_b16 v[194:195], v201 offset:20992
    v_mfma_f32_16x16x32_bf16 v[76:79], v[112:115], v[156:159], v[76:79]
    ds_read_b32 v1, v228 offset:24
    s_add_u32 s34, s34, 41984
    v_mfma_f32_16x16x32_bf16 v[84:87], v[116:119], v[156:159], v[84:87]
    s_cmp_eq_u32 s34, 125952
    s_cselect_b32 s35, -83968, s37
    v_mfma_f32_16x16x32_bf16 v[92:95], v[120:123], v[156:159], v[92:95]
    s_cselect_b32 s34, 0, s34
    s_bitcmp1_b32 0x1002, s36
    v_mfma_f32_16x16x32_bf16 v[96:99], v[120:123], v[136:139], v[96:99]
    v_add_u32 v196, s35, v196
    v_add_u32 v197, s35, v197
    v_mfma_f32_16x16x32_bf16 v[88:91], v[116:119], v[136:139], v[88:91]
    v_add_u32 v198, s35, v198
    v_add_u32 v199, s35, v199
    v_mfma_f32_16x16x32_bf16 v[80:83], v[112:115], v[136:139], v[80:83]
    v_add_u32 v200, s35, v200
    v_add_u32 v201, s35, v201
    v_mfma_f32_16x16x32_bf16 v[72:75], v[108:111], v[136:139], v[72:75]
    s_waitcnt lgkmcnt(0)
    v_smfmac_f32_16x16x64_bf16 v[100:103], v[140:143], v[148:155], v202
    v_smfmac_f32_16x16x64_bf16 v[104:107], v[140:143], v[156:163], v202
    s_cbranch_scc1 L_g1_rare
L_g1_bar:
    s_barrier
L_g1_nobar:
    v_mfma_f32_16x16x32_bf16 v[4:7], v[180:183], v[164:167], v[4:7]
    ds_read_b128 v[108:111], v196 offset:0
    v_mfma_f32_16x16x32_bf16 v[12:15], v[180:183], v[168:171], v[12:15]
    ds_read_b64_tr_b16 v[124:125], v200 offset:0
    v_mfma_f32_16x16x32_bf16 v[20:23], v[180:183], v[172:175], v[20:23]
    ds_read_b64_tr_b16 v[126:127], v200 offset:512
    v_mfma_f32_16x16x32_bf16 v[28:31], v[180:183], v[176:179], v[28:31]
    ds_read_b128 v[112:115], v196 offset:2048
    v_mfma_f32_16x16x32_bf16 v[32:35], v[184:187], v[176:179], v[32:35]
    ds_read_b64_tr_b16 v[128:129], v201 offset:0
    v_mfma_f32_16x16x32_bf16 v[24:27], v[184:187], v[172:175], v[24:27]
    ds_read_b64_tr_b16 v[130:131], v201 offset:512
    v_mfma_f32_16x16x32_bf16 v[16:19], v[184:187], v[168:171], v[16:19]
    ds_read_b128 v[116:119], v196 offset:4096
    v_mfma_f32_16x16x32_bf16 v[8:11], v[184:187], v[164:167], v[8:11]
    ds_read_b64_tr_b16 v[148:149], v200 offset:8192
    v_mfma_f32_16x16x32_bf16 v[40:43], v[188:191], v[164:167], v[40:43]
    ds_read_b64_tr_b16 v[150:151], v200 offset:8704
    v_mfma_f32_16x16x32_bf16 v[48:51], v[188:191], v[168:171], v[48:51]
    ds_read_b128 v[120:123], v196 offset:6144
    v_mfma_f32_16x16x32_bf16 v[56:59], v[188:191], v[172:175], v[56:59]
    ds_read_b64_tr_b16 v[132:133], v201 offset:8192
    v_mfma_f32_16x16x32_bf16 v[64:67], v[188:191], v[176:179], v[64:67]
    ds_read_b64_tr_b16 v[134:135], v201 offset:8704
    v_mfma_f32_16x16x32_bf16 v[60:63], v[152:155], v[176:179], v[60:63]
    ds_read_b64_tr_b16 v[156:157], v200 offset:16384
    v_mfma_f32_16x16x32_bf16 v[52:55], v[152:155], v[172:175], v[52:55]
    ds_read_b64_tr_b16 v[158:159], v200 offset:16896
    v_mfma_f32_16x16x32_bf16 v[44:47], v[152:155], v[168:171], v[44:47]
    ds_read_b64_tr_b16 v[136:137], v201 offset:16384
    v_mfma_f32_16x16x32_bf16 v[36:39], v[152:155], v[164:167], v[36:39]
    ds_read_b64_tr_b16 v[138:139], v201 offset:16896
    v_mfma_f32_16x16x32_bf16 v[68:71], v[164:167], v[160:163], v[68:71]
    s_sub_u32 s36, s36, 1
    v_mfma_f32_16x16x32_bf16 v[76:79], v[168:171], v[160:163], v[76:79]
    s_cmp_lg_u32 s36, 0
    v_mfma_f32_16x16x32_bf16 v[84:87], v[172:175], v[160:163], v[84:87]
    v_mfma_f32_16x16x32_bf16 v[92:95], v[176:179], v[160:163], v[92:95]
    v_mfma_f32_16x16x32_bf16 v[96:99], v[176:179], v[192:195], v[96:99]
    v_mfma_f32_16x16x32_bf16 v[88:91], v[172:175], v[192:195], v[88:91]
    v_mfma_f32_16x16x32_bf16 v[80:83], v[168:171], v[192:195], v[80:83]
    s_waitcnt lgkmcnt(0)
    v_mfma_f32_16x16x32_bf16 v[72:75], v[164:167], v[192:195], v[72:75]
    s_cbranch_scc1 L_g1_loop
    v_mfma_f32_16x16x32_bf16 v[4:7], v[124:127], v[108:111], v[4:7]
    ds_read_b128 v[164:167], v197 offset:0
    v_mfma_f32_16x16x32_bf16 v[12:15], v[124:127], v[112:115], v[12:15]
    ds_read_b64_tr_b16 v[180:181], v200 offset:4096
    v_mfma_f32_16x16x32_bf16 v[20:23], v[124:127], v[116:119], v[20:23]
    ds_read_b64_tr_b16 v[182:183], v200 offset:4608
    v_mfma_f32_16x16x32_bf16 v[28:31], v[124:127], v[120:123], v[28:31]
    ds_read_b128 v[168:171], v197 offset:2048
    v_mfma_f32_16x16x32_bf16 v[32:35], v[128:131], v[120:123], v[32:35]
    ds_read_b64_tr_b16 v[184:185], v201 offset:4096
    v_mfma_f32_16x16x32_bf16 v[24:27], v[128:131], v[116:119], v[24:27]
    ds_read_b64_tr_b16 v[186:187], v201 offset:4608
    v_mfma_f32_16x16x32_bf16 v[16:19], v[128:131], v[112:115], v[16:19]
    ds_read_b128 v[172:175], v197 offset:4096
    v_mfma_f32_16x16x32_bf16 v[8:11], v[128:131], v[108:111], v[8:11]
    ds_read_b64_tr_b16 v[152:153], v200 offset:12288
    v_mfma_f32_16x16x32_bf16 v[40:43], v[132:135], v[108:111], v[40:43]
    ds_read_b64_tr_b16 v[154:155], v200 offset:12800
    v_mfma_f32_16x16x32_bf16 v[48:51], v[132:135], v[112:115], v[48:51]
    ds_read_b128 v[176:179], v197 offset:6144
    v_mfma_f32_16x16x32_bf16 v[56:59], v[132:135], v[116:119], v[56:59]
    ds_read_b64_tr_b16 v[188:189], v201 offset:12288
    v_mfma_f32_16x16x32_bf16 v[64:67], v[132:135], v[120:123], v[64:67]
    ds_read_b64_tr_b16 v[190:191], v201 offset:12800
    v_mfma_f32_16x16x32_bf16 v[60:63], v[148:151], v[120:123], v[60:63]
    ds_read2_b32 v[140:141], v198 offset1:2
    v_mfma_f32_16x16x32_bf16 v[52:55], v[148:151], v[116:119], v[52:55]
    ds_read2_b32 v[142:143], v199 offset1:2
    v_mfma_f32_16x16x32_bf16 v[44:47], v[148:151], v[112:115], v[44:47]
    ds_read_b64_tr_b16 v[160:161], v200 offset:20480
    v_mfma_f32_16x16x32_bf16 v[36:39], v[148:151], v[108:111], v[36:39]
    ds_read_b64_tr_b16 v[162:163], v200 offset:20992
    v_mfma_f32_16x16x32_bf16 v[68:71], v[108:111], v[156:159], v[68:71]
    ds_read_b64_tr_b16 v[192:193], v201 offset:20480
    v_mfma_f32_16x16x32_bf16 v[76:79], v[112:115], v[156:159], v[76:79]
    ds_read_b64_tr_b16 v[194:195], v201 offset:20992
    v_mfma_f32_16x16x32_bf16 v[84:87], v[116:119], v[156:159], v[84:87]
    v_mfma_f32_16x16x32_bf16 v[92:95], v[120:123], v[156:159], v[92:95]
    v_mfma_f32_16x16x32_bf16 v[96:99], v[120:123], v[136:139], v[96:99]
    v_mfma_f32_16x16x32_bf16 v[88:91], v[116:119], v[136:139], v[88:91]
    v_mfma_f32_16x16x32_bf16 v[80:83], v[112:115], v[136:139], v[80:83]
    v_mfma_f32_16x16x32_bf16 v[72:75], v[108:111], v[136:139], v[72:75]
    s_waitcnt lgkmcnt(0)
    s_setprio 2
    v_mov_b32 v2, 1
    v_smfmac_f32_16x16x64_bf16 v[100:103], v[140:143], v[148:155], v202
    v_smfmac_f32_16x16x64_bf16 v[104:107], v[140:143], v[156:163], v202
    v_mfma_f32_16x16x32_bf16 v[60:63], v[152:155], v[176:179], v[60:63]
    v_mfma_f32_16x16x32_bf16 v[64:67], v[188:191], v[176:179], v[64:67]
    v_mfma_f32_16x16x32_bf16 v[92:95], v[176:179], v[160:163], v[92:95]
    v_mfma_f32_16x16x32_bf16 v[96:99], v[176:179], v[192:195], v[96:99]
    v_mfma_f32_16x16x32_bf16 v[28:31], v[180:183], v[176:179], v[28:31]
    v_mfma_f32_16x16x32_bf16 v[32:35], v[184:187], v[176:179], v[32:35]
    v_mfma_f32_16x16x32_bf16 v[52:55], v[152:155], v[172:175], v[52:55]
    v_mfma_f32_16x16x32_bf16 v[56:59], v[188:191], v[172:175], v[56:59]
    s_nop 3
    v_permlane32_swap_b32 v100, v104
    v_permlane32_swap_b32 v101, v105
    v_mfma_f32_16x16x32_bf16 v[20:23], v[180:183], v[172:175], v[20:23]
    v_permlane32_swap_b32 v102, v106
    v_permlane32_swap_b32 v103, v107
    v_mfma_f32_16x16x32_bf16 v[24:27], v[184:187], v[172:175], v[24:27]
    v_add_f32 v100, v100, v104
    v_add_f32 v101, v101, v105
    v_mfma_f32_16x16x32_bf16 v[44:47], v[152:155], v[168:171], v[44:47]
    v_add_f32 v102, v102, v106
    v_add_f32 v103, v103, v107
    v_mfma_f32_16x16x32_bf16 v[48:51], v[188:191], v[168:171], v[48:51]
    v_cvt_pk_bf16_f32 v144, v100, v101
    v_cvt_pk_bf16_f32 v145, v102, v103
    v_mfma_f32_16x16x32_bf16 v[12:15], v[180:183], v[168:171], v[12:15]
    ds_write_b64 v219, v[144:145] offset:1024
    ds_write_b16 v203, v144 offset:0
    v_mfma_f32_16x16x32_bf16 v[16:19], v[184:187], v[168:171], v[16:19]
    ds_write_b16_d16_hi v203, v144 offset:8
    ds_write_b16 v203, v145 offset:16
    v_mfma_f32_16x16x32_bf16 v[36:39], v[152:155], v[164:167], v[36:39]
    ds_write_b16_d16_hi v203, v145 offset:24
    v_cvt_pk_bf16_f32 v140, v60, v61
    v_mfma_f32_16x16x32_bf16 v[40:43], v[188:191], v[164:167], v[40:43]
    v_cvt_pk_bf16_f32 v141, v62, v63
    v_cvt_pk_bf16_f32 v142, v64, v65
    v_mfma_f32_16x16x32_bf16 v[4:7], v[180:183], v[164:167], v[4:7]
    v_cvt_pk_bf16_f32 v143, v66, v67
    v_cvt_pk_bf16_f32 v238, v92, v93
    v_mfma_f32_16x16x32_bf16 v[8:11], v[184:187], v[164:167], v[8:11]
    v_cvt_pk_bf16_f32 v239, v94, v95
    v_cvt_pk_bf16_f32 v248, v96, v97
    v_mfma_f32_16x16x32_bf16 v[84:87], v[172:175], v[160:163], v[84:87]
    v_cvt_pk_bf16_f32 v249, v98, v99
    s_cmp_eq_u32 s33, 0
    s_cbranch_scc0 L_at_nopub
    ds_write_b64 v220, v[140:141] offset:2048
    ds_write_b64 v220, v[238:239] offset:3072
    ds_write_b64 v220, v[142:143] offset:2560
    ds_write_b64 v220, v[248:249] offset:3584
L_at_nopub:
    s_mov_b64 exec, 1
    ds_add_u32 v228, v2 offset:20
    s_mov_b64 exec, -1
    v_mfma_f32_16x16x32_bf16 v[88:91], v[172:175], v[192:195], v[88:91]
    v_cvt_pk_bf16_f32 v120, v28, v29
    v_cvt_pk_bf16_f32 v121, v30, v31
    v_mfma_f32_16x16x32_bf16 v[76:79], v[168:171], v[160:163], v[76:79]
    v_cvt_pk_bf16_f32 v122, v32, v33
    v_cvt_pk_bf16_f32 v123, v34, v35
    v_mfma_f32_16x16x32_bf16 v[80:83], v[168:171], v[192:195], v[80:83]
    v_cvt_pk_bf16_f32 v136, v52, v53
    v_cvt_pk_bf16_f32 v137, v54, v55
    v_mfma_f32_16x16x32_bf16 v[68:71], v[164:167], v[160:163], v[68:71]
    v_cvt_pk_bf16_f32 v138, v56, v57
    v_cvt_pk_bf16_f32 v139, v58, v59
    v_mfma_f32_16x16x32_bf16 v[72:75], v[164:167], v[192:195], v[72:75]
    v_cvt_pk_bf16_f32 v116, v20, v21
    v_cvt_pk_bf16_f32 v117, v22, v23
    v_mfma_f32_16x16x32_bf16 v[28:31], v[140:143], v[120:123], v[204:207]
    v_cvt_pk_bf16_f32 v118, v24, v25
    v_cvt_pk_bf16_f32 v119, v26, v27
    v_mfma_f32_16x16x32_bf16 v[32:35], v[136:139], v[120:123], v[208:211]
    v_cvt_pk_bf16_f32 v132, v44, v45
    v_cvt_pk_bf16_f32 v133, v46, v47
    v_mfma_f32_16x16x32_bf16 v[20:23], v[136:139], v[116:119], v[204:207]
    v_cvt_pk_bf16_f32 v134, v48, v49
    v_cvt_pk_bf16_f32 v135, v50, v51
    s_nop 1
    v_mfma_f32_16x16x32_bf16 v[24:27], v[132:135], v[116:119], v[208:211]
    v_cvt_pk_bf16_f32 v112, v12, v13
    v_cvt_pk_bf16_f32 v113, v14, v15
    v_cvt_pk_bf16_f32 v114, v16, v17
    v_cvt_pk_bf16_f32 v115, v18, v19
    s_nop 1
    v_mfma_f32_16x16x32_bf16 v[12:15], v[132:135], v[112:115], v[204:207]
    v_cvt_pk_bf16_f32 v128, v36, v37
    v_cvt_pk_bf16_f32 v129, v38, v39
    v_cvt_pk_bf16_f32 v130, v40, v41
    v_cvt_pk_bf16_f32 v131, v42, v43
    s_nop 1
    v_mfma_f32_16x16x32_bf16 v[16:19], v[128:131], v[112:115], v[208:211]
    v_cvt_pk_bf16_f32 v108, v4, v5
    v_cvt_pk_bf16_f32 v109, v6, v7
    v_cvt_pk_bf16_f32 v110, v8, v9
    v_cvt_pk_bf16_f32 v111, v10, v11
    s_nop 1
    v_mfma_f32_16x16x32_bf16 v[4:7], v[128:131], v[108:111], v[204:207]
    v_cvt_pk_bf16_f32 v236, v84, v85
    v_cvt_pk_bf16_f32 v237, v86, v87
    v_cvt_pk_bf16_f32 v246, v88, v89
    v_cvt_pk_bf16_f32 v247, v90, v91
    v_cvt_pk_bf16_f32 v234, v76, v77
    v_cvt_pk_bf16_f32 v235, v78, v79
    ds_read_b32 v1, v228 offset:20
    v_cvt_pk_bf16_f32 v244, v80, v81
    v_cvt_pk_bf16_f32 v245, v82, v83
    v_cvt_pk_bf16_f32 v232, v68, v69
    v_cvt_pk_bf16_f32 v233, v70, v71
    v_cvt_pk_bf16_f32 v242, v72, v73
    v_cvt_pk_bf16_f32 v243, v74, v75
    s_waitcnt lgkmcnt(0)
    v_readfirstlane_b32 s37, v1
    s_nop 0
    s_cmp_ge_u32 s37, 4
    s_cbranch_scc1 L_sl_done_45
    s_mov_b32 s38, 1048576
L_sl_loop_46:
    ds_read_b32 v1, v228 offset:20
    s_waitcnt lgkmcnt(0)
    v_readfirstlane_b32 s37, v1
    s_nop 0
    s_cmp_ge_u32 s37, 4
    s_cbranch_scc1 L_sl_done_45
    s_sleep 1
    s_sub_u32 s38, s38, 1
    s_cbranch_scc0 L_sl_loop_46
L_sl_done_45:
    ds_read_b64 v[124:125], v221
    ds_read_b64 v[126:127], v222
    ds_read_b64 v[230:231], v221 offset:1024
    ds_read_b64 v[240:241], v222 offset:1024
    v_max_f32 v28, v28, v32
    v_max_f32 v29, v29, v33
    v_max_f32 v30, v30, v34
    v_max_f32 v31, v31, v35
    v_max3_f32 v39, v28, v29, v30
    v_max_f32 v39, v39, v31
    v_max_f32 v20, v20, v24
    v_max_f32 v21, v21, v25
    v_max_f32 v22, v22, v26
    v_max_f32 v23, v23, v27
    v_max3_f32 v38, v20, v21, v22
    v_max_f32 v38, v38, v23
    s_waitcnt lgkmcnt(2)
    v_mfma_f32_16x16x32_bf16 v[8:11], v[124:127], v[108:111], v[212:215]
    s_setprio 2
    s_mov_b32 s37, 0x3e8293ee
    v_max_f32 v12, v12, v16
    v_max_f32 v13, v13, v17
    v_max_f32 v14, v14, v18
    v_max_f32 v15, v15, v19
    v_max3_f32 v37, v12, v13, v14
    v_max_f32 v37, v37, v15
    v_max_f32 v4, v4, v8
    v_max_f32 v5, v5, v9
    v_max_f32 v6, v6, v10
    v_max_f32 v7, v7, v11
    v_max3_f32 v36, v4, v5, v6
    v_max_f32 v36, v36, v7
    v_permlane32_swap_b32 v38, v39
    s_nop 0
    v_permlane32_swap_b32 v36, v37
    v_max_f32 v38, v38, v39
    v_max_f32 v36, v36, v37
    s_nop 1
    v_permlane16_swap_b32 v36, v38
    v_max_f32 v36, v36, v38
    v_mul_f32 v38, s37, v36
    v_mul_f32 v36, s37, v36
    s_nop 1
    v_permlane16_swap_b32 v36, v38
    v_mov_b32 v37, v36
    s_add_u32 m0, s60, 0
    v_mov_b32 v39, v38
    v_permlane32_swap_b32 v36, v37
    s_xor_b32 s63, s62, 0
    v_permlane32_swap_b32 v38, v39
    v_fma_f32 v4, v4, s37, -v36
    buffer_load_dwordx4 v227, s[44:47], s63 offen offset:0 lds
    v_fma_f32 v5, v5, s37, -v36
    v_fma_f32 v6, v6, s37, -v36
    buffer_load_dwordx4 v223, s[44:47], s63 offen offset:1024 lds
    v_fma_f32 v7, v7, s37, -v36
    v_fma_f32 v12, v12, s37, -v37
    s_add_u32 m0, s60, 8192
    v_fma_f32 v13, v13, s37, -v37
    v_fma_f32 v14, v14, s37, -v37
    s_xor_b32 s63, s62, 131072
    v_fma_f32 v15, v15, s37, -v37
    v_fma_f32 v20, v20, s37, -v38
    buffer_load_dwordx4 v227, s[44:47], s63 offen offset:0 lds
    v_fma_f32 v21, v21, s37, -v38
    v_fma_f32 v22, v22, s37, -v38
    buffer_load_dwordx4 v223, s[44:47], s63 offen offset:1024 lds
    v_fma_f32 v23, v23, s37, -v38
    v_fma_f32 v28, v28, s37, -v39
    s_add_u32 m0, s60, 16384
    v_fma_f32 v29, v29, s37, -v39
    v_fma_f32 v30, v30, s37, -v39
    s_xor_b32 s63, s62, 262144
    v_fma_f32 v31, v31, s37, -v39
    v_exp_f32 v28, v28
    buffer_load_dwordx4 v227, s[44:47], s63 offen offset:0 lds
    v_exp_f32 v29, v29
    v_exp_f32 v30, v30
    buffer_load_dwordx4 v223, s[44:47], s63 offen offset:1024 lds
    v_exp_f32 v31, v31
    v_exp_f32 v20, v20
    s_add_u32 m0, s60, 24576
    v_exp_f32 v21, v21
    v_exp_f32 v22, v22
    s_xor_b32 s63, s62, 393216
    v_exp_f32 v23, v23
    v_exp_f32 v12, v12
    buffer_load_dwordx4 v227, s[44:47], s63 offen offset:0 lds
    v_exp_f32 v13, v13
    v_exp_f32 v14, v14
    buffer_load_dwordx4 v223, s[44:47], s63 offen offset:1024 lds
    v_exp_f32 v15, v15
    v_exp_f32 v4, v4
    s_add_u32 m0, s60, 32768
    v_exp_f32 v5, v5
    v_exp_f32 v6, v6
    s_xor_b32 s63, s62, 524288
    v_exp_f32 v7, v7
    v_add_f32 v39, v28, v29
    buffer_load_dwordx4 v227, s[44:47], s63 offen offset:0 lds
    v_add_f32 v32, v30, v31
    v_add_f32 v39, v39, v32
    buffer_load_dwordx4 v223, s[44:47], s63 offen offset:1024 lds
    v_add_f32 v38, v20, v21
    v_add_f32 v24, v22, v23
    s_add_u32 m0, s60, 83968
    v_add_f32 v38, v38, v24
    v_add_f32 v37, v12, v13
    s_xor_b32 s63, s62, 655360
    v_add_f32 v16, v14, v15
    v_add_f32 v37, v37, v16
    buffer_load_dwordx4 v227, s[44:47], s63 offen offset:0 lds
    v_add_f32 v36, v4, v5
    v_add_f32 v8, v6, v7
    buffer_load_dwordx4 v223, s[44:47], s63 offen offset:1024 lds
    v_add_f32 v36, v36, v8
    v_permlane32_swap_b32 v38, v39
    s_add_u32 m0, s60, 92160
    v_permlane32_swap_b32 v36, v37
    v_add_f32 v38, v38, v39
    s_xor_b32 s63, s62, 786432
    v_add_f32 v36, v36, v37
    s_nop 1
    v_permlane16_swap_b32 v36, v38
    buffer_load_dwordx4 v227, s[44:47], s63 offen offset:0 lds
    v_add_f32 v36, v36, v38
    v_rcp_f32 v38, v36
    buffer_load_dwordx4 v223, s[44:47], s63 offen offset:1024 lds
    v_rcp_f32 v36, v36
    s_nop 1
    v_permlane16_swap_b32 v36, v38
    s_add_u32 m0, s60, 100352
    v_mov_b32 v37, v36
    v_mov_b32 v39, v38
    s_xor_b32 s63, s62, 917504
    v_permlane32_swap_b32 v36, v37
    v_permlane32_swap_b32 v38, v39
    buffer_load_dwordx4 v227, s[44:47], s63 offen offset:0 lds
    s_waitcnt lgkmcnt(0)
    v_mul_f32 v4, v4, v36
    buffer_load_dwordx4 v223, s[44:47], s63 offen offset:1024 lds
    v_mul_f32 v5, v5, v36
    v_mul_f32 v6, v6, v36
    s_add_u32 m0, s60, 108544
    v_mul_f32 v7, v7, v36
    v_cvt_pk_bf16_f32 v10, v4, v5
    s_xor_b32 s63, s62, 1048576
    v_cvt_pk_bf16_f32 v11, v6, v7
    v_and_b32 v8, v216, v10
    buffer_load_dwordx4 v227, s[44:47], s63 offen offset:0 lds
    v_and_b32 v9, v217, v11
    v_xor_b32 v10, v8, v10
    buffer_load_dwordx4 v223, s[44:47], s63 offen offset:1024 lds
    v_xor_b32 v11, v9, v11
    s_setprio 2
    s_add_u32 m0, s60, 116736
    v_mfma_f32_16x16x32_bf16 v[68:71], v[230:233], v[8:11], 0
    v_mfma_f32_16x16x32_bf16 v[72:75], v[240:243], v[8:11], 0
    s_xor_b32 s63, s62, 1179648
    s_setprio 2
    v_mul_f32 v12, v12, v37
    buffer_load_dwordx4 v227, s[44:47], s63 offen offset:0 lds
    v_mul_f32 v13, v13, v37
    v_mul_f32 v14, v14, v37
    buffer_load_dwordx4 v223, s[44:47], s63 offen offset:1024 lds
    v_mul_f32 v15, v15, v37
    v_cvt_pk_bf16_f32 v18, v12, v13
    v_cvt_pk_bf16_f32 v19, v14, v15
    v_and_b32 v16, v216, v18
    v_and_b32 v17, v217, v19
    v_xor_b32 v18, v16, v18
    v_xor_b32 v19, v17, v19
    v_cvt_pk_bf16_f32 v108, v68, v69
    v_cvt_pk_bf16_f32 v109, v70, v71
    v_cvt_pk_bf16_f32 v110, v72, v73
    v_cvt_pk_bf16_f32 v111, v74, v75
    s_mov_b32 s37, 0
    buffer_store_dwordx4 v[108:111], v218, s[40:43], s37 offen sc1
    s_setprio 2
    v_mfma_f32_16x16x32_bf16 v[76:79], v[232:235], v[16:19], 0
    v_mfma_f32_16x16x32_bf16 v[80:83], v[242:245], v[16:19], 0
    s_setprio 2
    v_mul_f32 v20, v20, v38
    v_mul_f32 v21, v21, v38
    v_mul_f32 v22, v22, v38
    v_mul_f32 v23, v23, v38
    v_cvt_pk_bf16_f32 v26, v20, v21
    v_cvt_pk_bf16_f32 v27, v22, v23
    v_and_b32 v24, v216, v26
    v_and_b32 v25, v217, v27
    v_xor_b32 v26, v24, v26
    v_xor_b32 v27, v25, v27
    v_cvt_pk_bf16_f32 v112, v76, v77
    v_cvt_pk_bf16_f32 v113, v78, v79
    v_cvt_pk_bf16_f32 v114, v80, v81
    v_cvt_pk_bf16_f32 v115, v82, v83
    s_mov_b32 s37, 32768
    buffer_store_dwordx4 v[112:115], v218, s[40:43], s37 offen sc1
    s_setprio 2
    v_mfma_f32_16x16x32_bf16 v[84:87], v[234:237], v[24:27], 0
    v_mfma_f32_16x16x32_bf16 v[88:91], v[244:247], v[24:27], 0
    s_setprio 2
    v_mul_f32 v28, v28, v39
    v_mul_f32 v29, v29, v39
    v_mul_f32 v30, v30, v39
    v_mul_f32 v31, v31, v39
    v_cvt_pk_bf16_f32 v34, v28, v29
    v_cvt_pk_bf16_f32 v35, v30, v31
    v_and_b32 v32, v216, v34
    v_and_b32 v33, v217, v35
    v_xor_b32 v34, v32, v34
    v_xor_b32 v35, v33, v35
    v_cvt_pk_bf16_f32 v116, v84, v85
    v_cvt_pk_bf16_f32 v117, v86, v87
    v_cvt_pk_bf16_f32 v118, v88, v89
    v_cvt_pk_bf16_f32 v119, v90, v91
    s_mov_b32 s37, 65536
    buffer_store_dwordx4 v[116:119], v218, s[40:43], s37 offen sc1
    s_setprio 2
    v_mfma_f32_16x16x32_bf16 v[92:95], v[236:239], v[32:35], 0
    v_mfma_f32_16x16x32_bf16 v[96:99], v[246:249], v[32:35], 0
    s_setprio 2
    s_nop 5
    v_cvt_pk_bf16_f32 v120, v92, v93
    v_cvt_pk_bf16_f32 v121, v94, v95
    v_cvt_pk_bf16_f32 v122, v96, v97
    v_cvt_pk_bf16_f32 v123, v98, v99
    s_mov_b32 s37, 98304
    buffer_store_dwordx4 v[120:123], v218, s[40:43], s37 offen sc1
    s_setprio 0
    s_lshl_b32 s37, s32, 11
    v_add_u32 v229, s37, v229
    v_xor_b32 v84, 0, v229
    v_xor_b32 v85, 32, v229
    v_xor_b32 v86, 64, v229
    v_xor_b32 v87, 96, v229
    v_add_u32 v88, 83968, v84
    v_add_u32 v89, 83968, v85
    v_add_u32 v90, 83968, v86
    v_add_u32 v91, 83968, v87
    v_add_u32 v92, 125952, v84
    v_add_u32 v93, 125952, v85
    v_add_u32 v94, 125952, v86
    v_add_u32 v95, 125952, v87
    v_xor_b32 v232, 2048, v229
    v_xor_b32 v233, 2080, v229
    v_xor_b32 v234, 2112, v229
    v_xor_b32 v235, 2144, v229
    v_add_u32 v236, 83968, v232
    v_add_u32 v237, 83968, v233
    v_add_u32 v238, 83968, v234
    v_add_u32 v239, 83968, v235
    v_add_u32 v240, 125952, v232
    v_add_u32 v241, 125952, v233
    v_add_u32 v242, 125952, v234
    v_add_u32 v243, 125952, v235
    s_mul_i32 s37, s32, 80896
    s_lshl_b32 s38, s33, 11
    s_add_u32 s37, s37, s38
    s_add_u32 s37, s37, 78848
    v_lshrrev_b32 v1, 5, v0
    v_xor_b32 v1, v1, v0
    v_and_b32 v1, 7, v1
    v_lshl_add_u32 v1, v1, 4, s37
    v_bfe_u32 v2, v0, 4, 1
    v_lshl_add_u32 v1, v2, 3, v1
    v_and_b32 v2, 15, v0
    v_lshl_add_u32 v244, v2, 7, v1
    v_xor_b32 v245, 32, v244
    v_xor_b32 v246, 64, v244
    v_xor_b32 v247, 96, v244
    v_lshrrev_b32 v1, 3, v0
    v_xor_b32 v1, v1, v0
    v_and_b32 v1, 7, v1
    v_and_b32 v2, 56, v0
    v_add_u32 v1, v1, v2
    v_lshl_add_u32 v248, v1, 4, s37
    v_lshl_add_u32 v231, v0, 4, s60
    v_add_u32 v230, 125952, v231
    s_add_u32 s64, s61, 0
    s_and_b32 s64, s64, 7
    s_lshl_b32 s64, s64, 12
    s_add_u32 s65, s61, 1
    s_and_b32 s65, s65, 7
    s_lshl_b32 s65, s65, 12
    s_add_u32 s66, s61, 2
    s_and_b32 s66, s66, 7
    s_lshl_b32 s66, s66, 12
    s_add_u32 s67, s61, 3
    s_and_b32 s67, s67, 7
    s_lshl_b32 s67, s67, 12
    s_add_u32 s68, s61, 4
    s_and_b32 s68, s68, 7
    s_lshl_b32 s68, s68, 12
    s_add_u32 s69, s61, 5
    s_and_b32 s69, s69, 7
    s_lshl_b32 s69, s69, 12
    s_add_u32 s70, s61, 6
    s_and_b32 s70, s70, 7
    s_lshl_b32 s70, s70, 12
    s_add_u32 s71, s61, 7
    s_and_b32 s71, s71, 7
    s_lshl_b32 s71, s71, 12
    s_waitcnt vmcnt(0)
    s_setprio 2
    v_mov_b32 v2, 1
    s_mov_b64 exec, 1
    ds_add_rtn_u32 v1, v228, v2 offset:0
    s_waitcnt lgkmcnt(0)
    v_readfirstlane_b32 s39, v1
    s_nop 0
    s_cmp_eq_u32 s39, 3
    s_cbranch_scc0 L_jo_47a
    s_mov_b64 exec, 0xffff
    v_lshlrev_b32 v1, 8, v0
    buffer_atomic_add v2, v1, s[52:55], s56 offen sc1
L_jo_47a:
    s_mov_b64 exec, -1
    s_setprio 0
    s_xor_b32 s63, s62, 1310720
    buffer_load_dwordx4 v[172:175], v227, s[44:47], s63 offen offset:0
    buffer_load_dwordx4 v[176:179], v223, s[44:47], s63 offen offset:1024
    s_xor_b32 s63, s62, 1441792
    buffer_load_dwordx4 v[180:183], v227, s[44:47], s63 offen offset:0
    buffer_load_dwordx4 v[184:187], v223, s[44:47], s63 offen offset:1024
    s_cmp_eq_u32 s39, 3
    s_cbranch_scc0 L_ps_49
    s_load_dword s37, s[52:53], s57 glc
L_ps_49:
    s_xor_b32 s63, s62, 1572864
    buffer_load_dwordx4 v[188:191], v227, s[44:47], s63 offen offset:0
    buffer_load_dwordx4 v[192:195], v223, s[44:47], s63 offen offset:1024
    s_xor_b32 s63, s62, 1703936
    buffer_load_dwordx4 v[196:199], v227, s[44:47], s63 offen offset:0
    buffer_load_dwordx4 v[200:203], v223, s[44:47], s63 offen offset:1024
    s_xor_b32 s63, s62, 1835008
    buffer_load_dwordx4 v[204:207], v227, s[44:47], s63 offen offset:0
    buffer_load_dwordx4 v[208:211], v223, s[44:47], s63 offen offset:1024
    s_xor_b32 s63, s62, 1966080
    buffer_load_dwordx4 v[212:215], v227, s[44:47], s63 offen offset:0
    buffer_load_dwordx4 v[216:219], v223, s[44:47], s63 offen offset:1024
    s_setprio 0
    s_cmp_eq_u32 s39, 3
    s_cbranch_scc0 L_jo_47
    s_mov_b32 s38, 131072
    s_branch L_sg_chk_52
L_sg_loop_51:
    s_load_dword s37, s[52:53], s57 glc
L_sg_chk_52:
    s_waitcnt lgkmcnt(0)
    s_cmp_ge_u32 s37, 16
    s_cbranch_scc1 L_sg_done_50
    s_sub_u32 s38, s38, 1
    s_cbranch_scc0 L_sg_loop_51
L_sg_done_50:
    v_mov_b32 v1, 16
    s_mov_b64 exec, 1
    ds_add_u32 v228, v1 offset:4
    s_mov_b64 exec, -1
L_jo_47:
    s_waitcnt vmcnt(12)
    s_mov_b64 exec, 1
    ds_add_u32 v228, v2 offset:4
    s_mov_b64 exec, -1
    s_mov_b32 s38, 1048576
L_sl_loop_54:
    ds_read_b32 v1, v228 offset:4
    s_waitcnt lgkmcnt(0)
    v_readfirstlane_b32 s37, v1
    s_nop 0
    s_cmp_ge_u32 s37, 20
    s_cbranch_scc1 L_sl_done_53
    s_sleep 1
    s_sub_u32 s38, s38, 1
    s_cbranch_scc0 L_sl_loop_54
L_sl_done_53:
L_jd_48:
    buffer_load_dwordx4 v[96:99], v224, s[40:43], s64 offen offset:0 sc1
    buffer_load_dwordx4 v[100:103], v225, s[40:43], s64 offen offset:0 sc1
    ds_read_b64_tr_b16 v[36:37], v84 offset:0
    ds_read_b64_tr_b16 v[38:39], v232 offset:0
    buffer_load_dwordx4 v[104:107], v224, s[40:43], s64 offen offset:1024 sc1
    buffer_load_dwordx4 v[108:111], v225, s[40:43], s64 offen offset:1024 sc1
    ds_read_b64_tr_b16 v[40:41], v85 offset:0
    ds_read_b64_tr_b16 v[42:43], v233 offset:0
    buffer_load_dwordx4 v[112:115], v224, s[40:43], s64 offen offset:2048 sc1
    buffer_load_dwordx4 v[116:119], v225, s[40:43], s64 offen offset:2048 sc1
    ds_read_b64_tr_b16 v[44:45], v86 offset:0
    ds_read_b64_tr_b16 v[46:47], v234 offset:0
    buffer_load_dwordx4 v[120:123], v224, s[40:43], s64 offen offset:3072 sc1
    buffer_load_dwordx4 v[124:127], v225, s[40:43], s64 offen offset:3072 sc1
    ds_read_b64_tr_b16 v[48:49], v87 offset:0
    ds_read_b64_tr_b16 v[50:51], v235 offset:0
    buffer_load_dwordx4 v[128:131], v224, s[40:43], s65 offen offset:0 sc1
    buffer_load_dwordx4 v[132:135], v225, s[40:43], s65 offen offset:0 sc1
    ds_read_b64_tr_b16 v[52:53], v84 offset:4096
    ds_read_b64_tr_b16 v[54:55], v232 offset:4096
    buffer_load_dwordx4 v[136:139], v224, s[40:43], s65 offen offset:1024 sc1
    buffer_load_dwordx4 v[140:143], v225, s[40:43], s65 offen offset:1024 sc1
    ds_read_b64_tr_b16 v[56:57], v85 offset:4096
    ds_read_b64_tr_b16 v[58:59], v233 offset:4096
    ds_read_b64_tr_b16 v[60:61], v86 offset:4096
    ds_read_b64_tr_b16 v[62:63], v234 offset:4096
    s_waitcnt lgkmcnt(12)
    ds_read_b64_tr_b16 v[64:65], v87 offset:4096
    ds_read_b64_tr_b16 v[66:67], v235 offset:4096
    ds_read_b32 v1, v228 offset:36
    s_waitcnt vmcnt(10) lgkmcnt(9)
    v_mfma_f32_16x16x32_bf16 v[4:7], v[36:39], v[96:99], 0
    ds_read_b64_tr_b16 v[68:69], v84 offset:8192
    v_mfma_f32_16x16x32_bf16 v[20:23], v[36:39], v[100:103], 0
    ds_read_b64_tr_b16 v[70:71], v232 offset:8192
    v_mfma_f32_16x16x32_bf16 v[8:11], v[40:43], v[96:99], 0
    ds_read_b64_tr_b16 v[36:37], v85 offset:8192
    v_mfma_f32_16x16x32_bf16 v[24:27], v[40:43], v[100:103], 0
    ds_read_b64_tr_b16 v[38:39], v233 offset:8192
    buffer_load_dwordx4 v[144:147], v224, s[40:43], s65 offen offset:2048 sc1
    v_mfma_f32_16x16x32_bf16 v[12:15], v[44:47], v[96:99], 0
    ds_read_b64_tr_b16 v[40:41], v86 offset:8192
    v_mfma_f32_16x16x32_bf16 v[28:31], v[44:47], v[100:103], 0
    ds_read_b64_tr_b16 v[42:43], v234 offset:8192
    v_mfma_f32_16x16x32_bf16 v[16:19], v[48:51], v[96:99], 0
    ds_read_b64_tr_b16 v[44:45], v87 offset:8192
    v_mfma_f32_16x16x32_bf16 v[32:35], v[48:51], v[100:103], 0
    ds_read_b64_tr_b16 v[46:47], v235 offset:8192
    buffer_load_dwordx4 v[148:151], v225, s[40:43], s65 offen offset:2048 sc1
    s_waitcnt lgkmcnt(8)
    v_readfirstlane_b32 s37, v1
    s_nop 0
    s_cmp_ge_u32 s37, 4
    s_cbranch_scc1 L_sl_done_55
    s_mov_b32 s38, 1048576
L_sl_loop_56:
    ds_read_b32 v1, v228 offset:36
    s_waitcnt lgkmcnt(0)
    v_readfirstlane_b32 s37, v1
    s_nop 0
    s_cmp_ge_u32 s37, 4
    s_cbranch_scc1 L_sl_done_55
    s_sleep 1
    s_sub_u32 s38, s38, 1
    s_cbranch_scc0 L_sl_loop_56
L_sl_done_55:
    ds_write_b128 v230, v[172:175] offset:0
    s_waitcnt vmcnt(10)
    v_mfma_f32_16x16x32_bf16 v[4:7], v[52:55], v[104:107], v[4:7]
    ds_read_b64_tr_b16 v[48:49], v84 offset:12288
    v_mfma_f32_16x16x32_bf16 v[20:23], v[52:55], v[108:111], v[20:23]
    ds_read_b64_tr_b16 v[50:51], v232 offset:12288
    v_mfma_f32_16x16x32_bf16 v[8:11], v[56:59], v[104:107], v[8:11]
    ds_read_b64_tr_b16 v[52:53], v85 offset:12288
    v_mfma_f32_16x16x32_bf16 v[24:27], v[56:59], v[108:111], v[24:27]
    ds_read_b64_tr_b16 v[54:55], v233 offset:12288
    buffer_load_dwordx4 v[96:99], v224, s[40:43], s65 offen offset:3072 sc1
    ds_write_b128 v230, v[176:179] offset:1024
    v_mfma_f32_16x16x32_bf16 v[12:15], v[60:63], v[104:107], v[12:15]
    ds_read_b64_tr_b16 v[56:57], v86 offset:12288
    v_mfma_f32_16x16x32_bf16 v[28:31], v[60:63], v[108:111], v[28:31]
    ds_read_b64_tr_b16 v[58:59], v234 offset:12288
    v_mfma_f32_16x16x32_bf16 v[16:19], v[64:67], v[104:107], v[16:19]
    ds_read_b64_tr_b16 v[60:61], v87 offset:12288
    v_mfma_f32_16x16x32_bf16 v[32:35], v[64:67], v[108:111], v[32:35]
    ds_read_b64_tr_b16 v[62:63], v235 offset:12288
    buffer_load_dwordx4 v[100:103], v225, s[40:43], s65 offen offset:3072 sc1
    ds_write_b128 v230, v[180:183] offset:8448
    s_waitcnt vmcnt(10) lgkmcnt(11)
    v_mfma_f32_16x16x32_bf16 v[4:7], v[68:71], v[112:115], v[4:7]
    ds_read_b64_tr_b16 v[64:65], v84 offset:16384
    v_mfma_f32_16x16x32_bf16 v[20:23], v[68:71], v[116:119], v[20:23]
    ds_read_b64_tr_b16 v[66:67], v232 offset:16384
    v_mfma_f32_16x16x32_bf16 v[8:11], v[36:39], v[112:115], v[8:11]
    ds_read_b64_tr_b16 v[68:69], v85 offset:16384
    v_mfma_f32_16x16x32_bf16 v[24:27], v[36:39], v[116:119], v[24:27]
    ds_read_b64_tr_b16 v[70:71], v233 offset:16384
    buffer_load_dwordx4 v[104:107], v224, s[40:43], s66 offen offset:0 sc1
    ds_write_b128 v230, v[184:187] offset:9472
    v_mfma_f32_16x16x32_bf16 v[12:15], v[40:43], v[112:115], v[12:15]
    ds_read_b64_tr_b16 v[36:37], v86 offset:16384
    v_mfma_f32_16x16x32_bf16 v[28:31], v[40:43], v[116:119], v[28:31]
    ds_read_b64_tr_b16 v[38:39], v234 offset:16384
    v_mfma_f32_16x16x32_bf16 v[16:19], v[44:47], v[112:115], v[16:19]
    ds_read_b64_tr_b16 v[40:41], v87 offset:16384
    v_mfma_f32_16x16x32_bf16 v[32:35], v[44:47], v[116:119], v[32:35]
    ds_read_b64_tr_b16 v[42:43], v235 offset:16384
    buffer_load_dwordx4 v[108:111], v225, s[40:43], s66 offen offset:0 sc1
    ds_write_b128 v230, v[188:191] offset:16896
    s_waitcnt vmcnt(10) lgkmcnt(11)
    v_mfma_f32_16x16x32_bf16 v[4:7], v[48:51], v[120:123], v[4:7]
    ds_read_b64_tr_b16 v[44:45], v84 offset:20480
    v_mfma_f32_16x16x32_bf16 v[20:23], v[48:51], v[124:127], v[20:23]
    ds_read_b64_tr_b16 v[46:47], v232 offset:20480
    v_mfma_f32_16x16x32_bf16 v[8:11], v[52:55], v[120:123], v[8:11]
    ds_read_b64_tr_b16 v[48:49], v85 offset:20480
    v_mfma_f32_16x16x32_bf16 v[24:27], v[52:55], v[124:127], v[24:27]
    ds_read_b64_tr_b16 v[50:51], v233 offset:20480
    buffer_load_dwordx4 v[112:115], v224, s[40:43], s66 offen offset:1024 sc1
    ds_write_b128 v230, v[192:195] offset:17920
    v_mfma_f32_16x16x32_bf16 v[12:15], v[56:59], v[120:123], v[12:15]
    ds_read_b64_tr_b16 v[52:53], v86 offset:20480
    v_mfma_f32_16x16x32_bf16 v[28:31], v[56:59], v[124:127], v[28:31]
    ds_read_b64_tr_b16 v[54:55], v234 offset:20480
    v_mfma_f32_16x16x32_bf16 v[16:19], v[60:63], v[120:123], v[16:19]
    ds_read_b64_tr_b16 v[56:57], v87 offset:20480
    v_mfma_f32_16x16x32_bf16 v[32:35], v[60:63], v[124:127], v[32:35]
    ds_read_b64_tr_b16 v[58:59], v235 offset:20480
    buffer_load_dwordx4 v[116:119], v225, s[40:43], s66 offen offset:1024 sc1
    ds_write_b128 v230, v[196:199] offset:25344
    s_waitcnt vmcnt(10) lgkmcnt(11)
    v_mfma_f32_16x16x32_bf16 v[4:7], v[64:67], v[128:131], v[4:7]
    ds_read_b64_tr_b16 v[60:61], v84 offset:24576
    v_mfma_f32_16x16x32_bf16 v[20:23], v[64:67], v[132:135], v[20:23]
    ds_read_b64_tr_b16 v[62:63], v232 offset:24576
    v_mfma_f32_16x16x32_bf16 v[8:11], v[68:71], v[128:131], v[8:11]
    ds_read_b64_tr_b16 v[64:65], v85 offset:24576
    v_mfma_f32_16x16x32_bf16 v[24:27], v[68:71], v[132:135], v[24:27]
    ds_read_b64_tr_b16 v[66:67], v233 offset:24576
    buffer_load_dwordx4 v[120:123], v224, s[40:43], s66 offen offset:2048 sc1
    ds_write_b128 v230, v[200:203] offset:26368
    v_mfma_f32_16x16x32_bf16 v[12:15], v[36:39], v[128:131], v[12:15]
    ds_read_b64_tr_b16 v[68:69], v86 offset:24576
    v_mfma_f32_16x16x32_bf16 v[28:31], v[36:39], v[132:135], v[28:31]
    ds_read_b64_tr_b16 v[70:71], v234 offset:24576
    v_mfma_f32_16x16x32_bf16 v[16:19], v[40:43], v[128:131], v[16:19]
    ds_read_b64_tr_b16 v[36:37], v87 offset:24576
    v_mfma_f32_16x16x32_bf16 v[32:35], v[40:43], v[132:135], v[32:35]
    ds_read_b64_tr_b16 v[38:39], v235 offset:24576
    buffer_load_dwordx4 v[124:127], v225, s[40:43], s66 offen offset:2048 sc1
    ds_write_b128 v231, v[204:207] offset:41984
    s_waitcnt vmcnt(10) lgkmcnt(11)
    v_mfma_f32_16x16x32_bf16 v[4:7], v[44:47], v[136:139], v[4:7]
    ds_read_b64_tr_b16 v[40:41], v84 offset:28672
    v_mfma_f32_16x16x32_bf16 v[20:23], v[44:47], v[140:143], v[20:23]
    ds_read_b64_tr_b16 v[42:43], v232 offset:28672
    v_mfma_f32_16x16x32_bf16 v[8:11], v[48:51], v[136:139], v[8:11]
    ds_read_b64_tr_b16 v[44:45], v85 offset:28672
    v_mfma_f32_16x16x32_bf16 v[24:27], v[48:51], v[140:143], v[24:27]
    ds_read_b64_tr_b16 v[46:47], v233 offset:28672
    buffer_load_dwordx4 v[128:131], v224, s[40:43], s66 offen offset:3072 sc1
    ds_write_b128 v231, v[208:211] offset:43008
    v_mfma_f32_16x16x32_bf16 v[12:15], v[52:55], v[136:139], v[12:15]
    ds_read_b64_tr_b16 v[48:49], v86 offset:28672
    v_mfma_f32_16x16x32_bf16 v[28:31], v[52:55], v[140:143], v[28:31]
    ds_read_b64_tr_b16 v[50:51], v234 offset:28672
    v_mfma_f32_16x16x32_bf16 v[16:19], v[56:59], v[136:139], v[16:19]
    ds_read_b64_tr_b16 v[52:53], v87 offset:28672
    v_mfma_f32_16x16x32_bf16 v[32:35], v[56:59], v[140:143], v[32:35]
    ds_read_b64_tr_b16 v[54:55], v235 offset:28672
    buffer_load_dwordx4 v[132:135], v225, s[40:43], s66 offen offset:3072 sc1
    ds_write_b128 v231, v[212:215] offset:51200
    s_waitcnt vmcnt(10) lgkmcnt(11)
    v_mfma_f32_16x16x32_bf16 v[4:7], v[60:63], v[144:147], v[4:7]
    ds_read_b64_tr_b16 v[56:57], v84 offset:32768
    v_mfma_f32_16x16x32_bf16 v[20:23], v[60:63], v[148:151], v[20:23]
    ds_read_b64_tr_b16 v[58:59], v232 offset:32768
    v_mfma_f32_16x16x32_bf16 v[8:11], v[64:67], v[144:147], v[8:11]
    ds_read_b64_tr_b16 v[60:61], v85 offset:32768
    v_mfma_f32_16x16x32_bf16 v[24:27], v[64:67], v[148:151], v[24:27]
    ds_read_b64_tr_b16 v[62:63], v233 offset:32768
    buffer_load_dwordx4 v[136:139], v224, s[40:43], s67 offen offset:0 sc1
    ds_write_b128 v231, v[216:219] offset:52224
    s_mov_b64 exec, 1
    ds_add_u32 v228, v2 offset:12
    s_mov_b64 exec, -1
    v_mfma_f32_16x16x32_bf16 v[12:15], v[68:71], v[144:147], v[12:15]
    ds_read_b64_tr_b16 v[64:65], v86 offset:32768
    v_mfma_f32_16x16x32_bf16 v[28:31], v[68:71], v[148:151], v[28:31]
    ds_read_b64_tr_b16 v[66:67], v234 offset:32768
    v_mfma_f32_16x16x32_bf16 v[16:19], v[36:39], v[144:147], v[16:19]
    ds_read_b64_tr_b16 v[68:69], v87 offset:32768
    v_mfma_f32_16x16x32_bf16 v[32:35], v[36:39], v[148:151], v[32:35]
    ds_read_b64_tr_b16 v[70:71], v235 offset:32768
    buffer_load_dwordx4 v[140:143], v225, s[40:43], s67 offen offset:0 sc1
    s_waitcnt vmcnt(10) lgkmcnt(11)
    v_mfma_f32_16x16x32_bf16 v[4:7], v[40:43], v[96:99], v[4:7]
    ds_read_b64_tr_b16 v[36:37], v84 offset:36864
    v_mfma_f32_16x16x32_bf16 v[20:23], v[40:43], v[100:103], v[20:23]
    ds_read_b64_tr_b16 v[38:39], v232 offset:36864
    v_mfma_f32_16x16x32_bf16 v[8:11], v[44:47], v[96:99], v[8:11]
    ds_read_b64_tr_b16 v[40:41], v85 offset:36864
    v_mfma_f32_16x16x32_bf16 v[24:27], v[44:47], v[100:103], v[24:27]
    ds_read_b64_tr_b16 v[42:43], v233 offset:36864
    buffer_load_dwordx4 v[144:147], v224, s[40:43], s67 offen offset:1024 sc1
    v_mfma_f32_16x16x32_bf16 v[12:15], v[48:51], v[96:99], v[12:15]
    ds_read_b64_tr_b16 v[44:45], v86 offset:36864
    v_mfma_f32_16x16x32_bf16 v[28:31], v[48:51], v[100:103], v[28:31]
    ds_read_b64_tr_b16 v[46:47], v234 offset:36864
    v_mfma_f32_16x16x32_bf16 v[16:19], v[52:55], v[96:99], v[16:19]
    ds_read_b64_tr_b16 v[48:49], v87 offset:36864
    v_mfma_f32_16x16x32_bf16 v[32:35], v[52:55], v[100:103], v[32:35]
    ds_read_b64_tr_b16 v[50:51], v235 offset:36864
    buffer_load_dwordx4 v[148:151], v225, s[40:43], s67 offen offset:1024 sc1
    s_waitcnt vmcnt(10) lgkmcnt(8)
    v_mfma_f32_16x16x32_bf16 v[4:7], v[56:59], v[104:107], v[4:7]
    ds_read_b64_tr_b16 v[52:53], v88 offset:0
    v_mfma_f32_16x16x32_bf16 v[20:23], v[56:59], v[108:111], v[20:23]
    ds_read_b64_tr_b16 v[54:55], v236 offset:0
    v_mfma_f32_16x16x32_bf16 v[8:11], v[60:63], v[104:107], v[8:11]
    ds_read_b64_tr_b16 v[56:57], v89 offset:0
    v_mfma_f32_16x16x32_bf16 v[24:27], v[60:63], v[108:111], v[24:27]
    ds_read_b64_tr_b16 v[58:59], v237 offset:0
    buffer_load_dwordx4 v[96:99], v224, s[40:43], s67 offen offset:2048 sc1
    v_mfma_f32_16x16x32_bf16 v[12:15], v[64:67], v[104:107], v[12:15]
    ds_read_b64_tr_b16 v[60:61], v90 offset:0
    v_mfma_f32_16x16x32_bf16 v[28:31], v[64:67], v[108:111], v[28:31]
    ds_read_b64_tr_b16 v[62:63], v238 offset:0
    v_mfma_f32_16x16x32_bf16 v[16:19], v[68:71], v[104:107], v[16:19]
    ds_read_b64_tr_b16 v[64:65], v91 offset:0
    v_mfma_f32_16x16x32_bf16 v[32:35], v[68:71], v[108:111], v[32:35]
    ds_read_b64_tr_b16 v[66:67], v239 offset:0
    buffer_load_dwordx4 v[100:103], v225, s[40:43], s67 offen offset:2048 sc1
    s_waitcnt vmcnt(10) lgkmcnt(8)
    v_mfma_f32_16x16x32_bf16 v[4:7], v[36:39], v[112:115], v[4:7]
    ds_read_b64_tr_b16 v[68:69], v88 offset:4096
    v_mfma_f32_16x16x32_bf16 v[20:23], v[36:39], v[116:119], v[20:23]
    ds_read_b64_tr_b16 v[70:71], v236 offset:4096
    v_mfma_f32_16x16x32_bf16 v[8:11], v[40:43], v[112:115], v[8:11]
    ds_read_b64_tr_b16 v[36:37], v89 offset:4096
    v_mfma_f32_16x16x32_bf16 v[24:27], v[40:43], v[116:119], v[24:27]
    ds_read_b64_tr_b16 v[38:39], v237 offset:4096
    buffer_load_dwordx4 v[104:107], v224, s[40:43], s67 offen offset:3072 sc1
    v_mfma_f32_16x16x32_bf16 v[12:15], v[44:47], v[112:115], v[12:15]
    ds_read_b64_tr_b16 v[40:41], v90 offset:4096
    v_mfma_f32_16x16x32_bf16 v[28:31], v[44:47], v[116:119], v[28:31]
    ds_read_b64_tr_b16 v[42:43], v238 offset:4096
    v_mfma_f32_16x16x32_bf16 v[16:19], v[48:51], v[112:115], v[16:19]
    ds_read_b64_tr_b16 v[44:45], v91 offset:4096
    v_mfma_f32_16x16x32_bf16 v[32:35], v[48:51], v[116:119], v[32:35]
    ds_read_b64_tr_b16 v[46:47], v239 offset:4096
    buffer_load_dwordx4 v[108:111], v225, s[40:43], s67 offen offset:3072 sc1
    s_waitcnt vmcnt(10) lgkmcnt(8)
    v_mfma_f32_16x16x32_bf16 v[4:7], v[52:55], v[120:123], v[4:7]
    ds_read_b64_tr_b16 v[48:49], v88 offset:8192
    v_mfma_f32_16x16x32_bf16 v[20:23], v[52:55], v[124:127], v[20:23]
    ds_read_b64_tr_b16 v[50:51], v236 offset:8192
    v_mfma_f32_16x16x32_bf16 v[8:11], v[56:59], v[120:123], v[8:11]
    ds_read_b64_tr_b16 v[52:53], v89 offset:8192
    v_mfma_f32_16x16x32_bf16 v[24:27], v[56:59], v[124:127], v[24:27]
    ds_read_b64_tr_b16 v[54:55], v237 offset:8192
    buffer_load_dwordx4 v[112:115], v224, s[40:43], s68 offen offset:0 sc1
    v_mfma_f32_16x16x32_bf16 v[12:15], v[60:63], v[120:123], v[12:15]
    ds_read_b64_tr_b16 v[56:57], v90 offset:8192
    v_mfma_f32_16x16x32_bf16 v[28:31], v[60:63], v[124:127], v[28:31]
    ds_read_b64_tr_b16 v[58:59], v238 offset:8192
    v_mfma_f32_16x16x32_bf16 v[16:19], v[64:67], v[120:123], v[16:19]
    ds_read_b64_tr_b16 v[60:61], v91 offset:8192
    v_mfma_f32_16x16x32_bf16 v[32:35], v[64:67], v[124:127], v[32:35]
    ds_read_b64_tr_b16 v[62:63], v239 offset:8192
    buffer_load_dwordx4 v[116:119], v225, s[40:43], s68 offen offset:0 sc1
    s_waitcnt vmcnt(10) lgkmcnt(8)
    v_mfma_f32_16x16x32_bf16 v[4:7], v[68:71], v[128:131], v[4:7]
    ds_read_b64_tr_b16 v[64:65], v88 offset:12288
    v_mfma_f32_16x16x32_bf16 v[20:23], v[68:71], v[132:135], v[20:23]
    ds_read_b64_tr_b16 v[66:67], v236 offset:12288
    v_mfma_f32_16x16x32_bf16 v[8:11], v[36:39], v[128:131], v[8:11]
    ds_read_b64_tr_b16 v[68:69], v89 offset:12288
    v_mfma_f32_16x16x32_bf16 v[24:27], v[36:39], v[132:135], v[24:27]
    ds_read_b64_tr_b16 v[70:71], v237 offset:12288
    buffer_load_dwordx4 v[120:123], v224, s[40:43], s68 offen offset:1024 sc1
    v_mfma_f32_16x16x32_bf16 v[12:15], v[40:43], v[128:131], v[12:15]
    ds_read_b64_tr_b16 v[36:37], v90 offset:12288
    v_mfma_f32_16x16x32_bf16 v[28:31], v[40:43], v[132:135], v[28:31]
    ds_read_b64_tr_b16 v[38:39], v238 offset:12288
    v_mfma_f32_16x16x32_bf16 v[16:19], v[44:47], v[128:131], v[16:19]
    ds_read_b64_tr_b16 v[40:41], v91 offset:12288
    v_mfma_f32_16x16x32_bf16 v[32:35], v[44:47], v[132:135], v[32:35]
    ds_read_b64_tr_b16 v[42:43], v239 offset:12288
    buffer_load_dwordx4 v[124:127], v225, s[40:43], s68 offen offset:1024 sc1
    s_waitcnt vmcnt(10) lgkmcnt(8)
    v_mfma_f32_16x16x32_bf16 v[4:7], v[48:51], v[136:139], v[4:7]
    ds_read_b64_tr_b16 v[44:45], v88 offset:16384
    v_mfma_f32_16x16x32_bf16 v[20:23], v[48:51], v[140:143], v[20:23]
    ds_read_b64_tr_b16 v[46:47], v236 offset:16384
    v_mfma_f32_16x16x32_bf16 v[8:11], v[52:55], v[136:139], v[8:11]
    ds_read_b64_tr_b16 v[48:49], v89 offset:16384
    v_mfma_f32_16x16x32_bf16 v[24:27], v[52:55], v[140:143], v[24:27]
    ds_read_b64_tr_b16 v[50:51], v237 offset:16384
    buffer_load_dwordx4 v[128:131], v224, s[40:43], s68 offen offset:2048 sc1
    v_mfma_f32_16x16x32_bf16 v[12:15], v[56:59], v[136:139], v[12:15]
    ds_read_b64_tr_b16 v[52:53], v90 offset:16384
    v_mfma_f32_16x16x32_bf16 v[28:31], v[56:59], v[140:143], v[28:31]
    ds_read_b64_tr_b16 v[54:55], v238 offset:16384
    v_mfma_f32_16x16x32_bf16 v[16:19], v[60:63], v[136:139], v[16:19]
    ds_read_b64_tr_b16 v[56:57], v91 offset:16384
    v_mfma_f32_16x16x32_bf16 v[32:35], v[60:63], v[140:143], v[32:35]
    ds_read_b64_tr_b16 v[58:59], v239 offset:16384
    buffer_load_dwordx4 v[132:135], v225, s[40:43], s68 offen offset:2048 sc1
    s_waitcnt vmcnt(10) lgkmcnt(8)
    v_mfma_f32_16x16x32_bf16 v[4:7], v[64:67], v[144:147], v[4:7]
    ds_read_b64_tr_b16 v[60:61], v88 offset:20480
    v_mfma_f32_16x16x32_bf16 v[20:23], v[64:67], v[148:151], v[20:23]
    ds_read_b64_tr_b16 v[62:63], v236 offset:20480
    v_mfma_f32_16x16x32_bf16 v[8:11], v[68:71], v[144:147], v[8:11]
    ds_read_b64_tr_b16 v[64:65], v89 offset:20480
    v_mfma_f32_16x16x32_bf16 v[24:27], v[68:71], v[148:151], v[24:27]
    ds_read_b64_tr_b16 v[66:67], v237 offset:20480
    buffer_load_dwordx4 v[136:139], v224, s[40:43], s68 offen offset:3072 sc1
    v_mfma_f32_16x16x32_bf16 v[12:15], v[36:39], v[144:147], v[12:15]
    ds_read_b64_tr_b16 v[68:69], v90 offset:20480
    v_mfma_f32_16x16x32_bf16 v[28:31], v[36:39], v[148:151], v[28:31]
    ds_read_b64_tr_b16 v[70:71], v238 offset:20480
    v_mfma_f32_16x16x32_bf16 v[16:19], v[40:43], v[144:147], v[16:19]
    ds_read_b64_tr_b16 v[36:37], v91 offset:20480
    v_mfma_f32_16x16x32_bf16 v[32:35], v[40:43], v[148:151], v[32:35]
    ds_read_b64_tr_b16 v[38:39], v239 offset:20480
    buffer_load_dwordx4 v[140:143], v225, s[40:43], s68 offen offset:3072 sc1
    s_waitcnt vmcnt(10) lgkmcnt(8)
    v_mfma_f32_16x16x32_bf16 v[4:7], v[44:47], v[96:99], v[4:7]
    ds_read_b64_tr_b16 v[40:41], v88 offset:24576
    v_mfma_f32_16x16x32_bf16 v[20:23], v[44:47], v[100:103], v[20:23]
    ds_read_b64_tr_b16 v[42:43], v236 offset:24576
    v_mfma_f32_16x16x32_bf16 v[8:11], v[48:51], v[96:99], v[8:11]
    ds_read_b64_tr_b16 v[44:45], v89 offset:24576
    v_mfma_f32_16x16x32_bf16 v[24:27], v[48:51], v[100:103], v[24:27]
    ds_read_b64_tr_b16 v[46:47], v237 offset:24576
    buffer_load_dwordx4 v[144:147], v224, s[40:43], s69 offen offset:0 sc1
    v_mfma_f32_16x16x32_bf16 v[12:15], v[52:55], v[96:99], v[12:15]
    ds_read_b64_tr_b16 v[48:49], v90 offset:24576
    v_mfma_f32_16x16x32_bf16 v[28:31], v[52:55], v[100:103], v[28:31]
    ds_read_b64_tr_b16 v[50:51], v238 offset:24576
    v_mfma_f32_16x16x32_bf16 v[16:19], v[56:59], v[96:99], v[16:19]
    ds_read_b64_tr_b16 v[52:53], v91 offset:24576
    v_mfma_f32_16x16x32_bf16 v[32:35], v[56:59], v[100:103], v[32:35]
    ds_read_b64_tr_b16 v[54:55], v239 offset:24576
    buffer_load_dwordx4 v[148:151], v225, s[40:43], s69 offen offset:0 sc1
    s_waitcnt vmcnt(10) lgkmcnt(8)
    v_mfma_f32_16x16x32_bf16 v[4:7], v[60:63], v[104:107], v[4:7]
    ds_read_b64_tr_b16 v[56:57], v88 offset:28672
    v_mfma_f32_16x16x32_bf16 v[20:23], v[60:63], v[108:111], v[20:23]
    ds_read_b64_tr_b16 v[58:59], v236 offset:28672
    v_mfma_f32_16x16x32_bf16 v[8:11], v[64:67], v[104:107], v[8:11]
    ds_read_b64_tr_b16 v[60:61], v89 offset:28672
    v_mfma_f32_16x16x32_bf16 v[24:27], v[64:67], v[108:111], v[24:27]
    ds_read_b64_tr_b16 v[62:63], v237 offset:28672
    buffer_load_dwordx4 v[96:99], v224, s[40:43], s69 offen offset:1024 sc1
    v_mfma_f32_16x16x32_bf16 v[12:15], v[68:71], v[104:107], v[12:15]
    ds_read_b64_tr_b16 v[64:65], v90 offset:28672
    v_mfma_f32_16x16x32_bf16 v[28:31], v[68:71], v[108:111], v[28:31]
    ds_read_b64_tr_b16 v[66:67], v238 offset:28672
    v_mfma_f32_16x16x32_bf16 v[16:19], v[36:39], v[104:107], v[16:19]
    ds_read_b64_tr_b16 v[68:69], v91 offset:28672
    v_mfma_f32_16x16x32_bf16 v[32:35], v[36:39], v[108:111], v[32:35]
    ds_read_b64_tr_b16 v[70:71], v239 offset:28672
    buffer_load_dwordx4 v[100:103], v225, s[40:43], s69 offen offset:1024 sc1
    s_waitcnt vmcnt(10) lgkmcnt(8)
    v_mfma_f32_16x16x32_bf16 v[4:7], v[40:43], v[112:115], v[4:7]
    ds_read_b64_tr_b16 v[36:37], v88 offset:32768
    v_mfma_f32_16x16x32_bf16 v[20:23], v[40:43], v[116:119], v[20:23]
    ds_read_b64_tr_b16 v[38:39], v236 offset:32768
    v_mfma_f32_16x16x32_bf16 v[8:11], v[44:47], v[112:115], v[8:11]
    ds_read_b64_tr_b16 v[40:41], v89 offset:32768
    v_mfma_f32_16x16x32_bf16 v[24:27], v[44:47], v[116:119], v[24:27]
    ds_read_b64_tr_b16 v[42:43], v237 offset:32768
    buffer_load_dwordx4 v[104:107], v224, s[40:43], s69 offen offset:2048 sc1
    v_mfma_f32_16x16x32_bf16 v[12:15], v[48:51], v[112:115], v[12:15]
    ds_read_b64_tr_b16 v[44:45], v90 offset:32768
    v_mfma_f32_16x16x32_bf16 v[28:31], v[48:51], v[116:119], v[28:31]
    ds_read_b64_tr_b16 v[46:47], v238 offset:32768
    v_mfma_f32_16x16x32_bf16 v[16:19], v[52:55], v[112:115], v[16:19]
    ds_read_b64_tr_b16 v[48:49], v91 offset:32768
    v_mfma_f32_16x16x32_bf16 v[32:35], v[52:55], v[116:119], v[32:35]
    ds_read_b64_tr_b16 v[50:51], v239 offset:32768
    buffer_load_dwordx4 v[108:111], v225, s[40:43], s69 offen offset:2048 sc1
    ds_read_b32 v1, v228 offset:12
    s_waitcnt vmcnt(10) lgkmcnt(9)
    v_mfma_f32_16x16x32_bf16 v[4:7], v[56:59], v[120:123], v[4:7]
    ds_read_b64_tr_b16 v[52:53], v88 offset:36864
    v_mfma_f32_16x16x32_bf16 v[20:23], v[56:59], v[124:127], v[20:23]
    ds_read_b64_tr_b16 v[54:55], v236 offset:36864
    v_mfma_f32_16x16x32_bf16 v[8:11], v[60:63], v[120:123], v[8:11]
    ds_read_b64_tr_b16 v[56:57], v89 offset:36864
    v_mfma_f32_16x16x32_bf16 v[24:27], v[60:63], v[124:127], v[24:27]
    ds_read_b64_tr_b16 v[58:59], v237 offset:36864
    buffer_load_dwordx4 v[112:115], v224, s[40:43], s69 offen offset:3072 sc1
    v_mfma_f32_16x16x32_bf16 v[12:15], v[64:67], v[120:123], v[12:15]
    ds_read_b64_tr_b16 v[60:61], v90 offset:36864
    v_mfma_f32_16x16x32_bf16 v[28:31], v[64:67], v[124:127], v[28:31]
    ds_read_b64_tr_b16 v[62:63], v238 offset:36864
    v_mfma_f32_16x16x32_bf16 v[16:19], v[68:71], v[120:123], v[16:19]
    ds_read_b64_tr_b16 v[64:65], v91 offset:36864
    v_mfma_f32_16x16x32_bf16 v[32:35], v[68:71], v[124:127], v[32:35]
    ds_read_b64_tr_b16 v[66:67], v239 offset:36864
    buffer_load_dwordx4 v[116:119], v225, s[40:43], s69 offen offset:3072 sc1
    s_waitcnt lgkmcnt(8)
    v_readfirstlane_b32 s37, v1
    s_nop 0
    s_cmp_ge_u32 s37, 4
    s_cbranch_scc1 L_sl_done_57
    s_mov_b32 s38, 1048576
L_sl_loop_58:
    ds_read_b32 v1, v228 offset:12
    s_waitcnt lgkmcnt(0)
    v_readfirstlane_b32 s37, v1
    s_nop 0
    s_cmp_ge_u32 s37, 4
    s_cbranch_scc1 L_sl_done_57
    s_sleep 1
    s_sub_u32 s38, s38, 1
    s_cbranch_scc0 L_sl_loop_58
L_sl_done_57:
    s_waitcnt vmcnt(10)
    v_mfma_f32_16x16x32_bf16 v[4:7], v[36:39], v[128:131], v[4:7]
    ds_read_b64_tr_b16 v[68:69], v92 offset:0
    v_mfma_f32_16x16x32_bf16 v[20:23], v[36:39], v[132:135], v[20:23]
    ds_read_b64_tr_b16 v[70:71], v240 offset:0
    v_mfma_f32_16x16x32_bf16 v[8:11], v[40:43], v[128:131], v[8:11]
    ds_read_b64_tr_b16 v[36:37], v93 offset:0
    v_mfma_f32_16x16x32_bf16 v[24:27], v[40:43], v[132:135], v[24:27]
    ds_read_b64_tr_b16 v[38:39], v241 offset:0
    buffer_load_dwordx4 v[120:123], v224, s[40:43], s70 offen offset:0 sc1
    v_mfma_f32_16x16x32_bf16 v[12:15], v[44:47], v[128:131], v[12:15]
    ds_read_b64_tr_b16 v[40:41], v94 offset:0
    v_mfma_f32_16x16x32_bf16 v[28:31], v[44:47], v[132:135], v[28:31]
    ds_read_b64_tr_b16 v[42:43], v242 offset:0
    v_mfma_f32_16x16x32_bf16 v[16:19], v[48:51], v[128:131], v[16:19]
    ds_read_b64_tr_b16 v[44:45], v95 offset:0
    v_mfma_f32_16x16x32_bf16 v[32:35], v[48:51], v[132:135], v[32:35]
    ds_read_b64_tr_b16 v[46:47], v243 offset:0
    buffer_load_dwordx4 v[124:127], v225, s[40:43], s70 offen offset:0 sc1
    s_waitcnt vmcnt(10) lgkmcnt(8)
    v_mfma_f32_16x16x32_bf16 v[4:7], v[52:55], v[136:139], v[4:7]
    ds_read_b64_tr_b16 v[48:49], v92 offset:4096
    v_mfma_f32_16x16x32_bf16 v[20:23], v[52:55], v[140:143], v[20:23]
    ds_read_b64_tr_b16 v[50:51], v240 offset:4096
    v_mfma_f32_16x16x32_bf16 v[8:11], v[56:59], v[136:139], v[8:11]
    ds_read_b64_tr_b16 v[52:53], v93 offset:4096
    v_mfma_f32_16x16x32_bf16 v[24:27], v[56:59], v[140:143], v[24:27]
    ds_read_b64_tr_b16 v[54:55], v241 offset:4096
    buffer_load_dwordx4 v[128:131], v224, s[40:43], s70 offen offset:1024 sc1
    v_mfma_f32_16x16x32_bf16 v[12:15], v[60:63], v[136:139], v[12:15]
    ds_read_b64_tr_b16 v[56:57], v94 offset:4096
    v_mfma_f32_16x16x32_bf16 v[28:31], v[60:63], v[140:143], v[28:31]
    ds_read_b64_tr_b16 v[58:59], v242 offset:4096
    v_mfma_f32_16x16x32_bf16 v[16:19], v[64:67], v[136:139], v[16:19]
    ds_read_b64_tr_b16 v[60:61], v95 offset:4096
    v_mfma_f32_16x16x32_bf16 v[32:35], v[64:67], v[140:143], v[32:35]
    ds_read_b64_tr_b16 v[62:63], v243 offset:4096
    buffer_load_dwordx4 v[132:135], v225, s[40:43], s70 offen offset:1024 sc1
    s_waitcnt vmcnt(10) lgkmcnt(8)
    v_mfma_f32_16x16x32_bf16 v[4:7], v[68:71], v[144:147], v[4:7]
    ds_read_b64_tr_b16 v[64:65], v92 offset:8448
    v_mfma_f32_16x16x32_bf16 v[20:23], v[68:71], v[148:151], v[20:23]
    ds_read_b64_tr_b16 v[66:67], v240 offset:8448
    v_mfma_f32_16x16x32_bf16 v[8:11], v[36:39], v[144:147], v[8:11]
    ds_read_b64_tr_b16 v[68:69], v93 offset:8448
    v_mfma_f32_16x16x32_bf16 v[24:27], v[36:39], v[148:151], v[24:27]
    ds_read_b64_tr_b16 v[70:71], v241 offset:8448
    buffer_load_dwordx4 v[136:139], v224, s[40:43], s70 offen offset:2048 sc1
    v_mfma_f32_16x16x32_bf16 v[12:15], v[40:43], v[144:147], v[12:15]
    ds_read_b64_tr_b16 v[36:37], v94 offset:8448
    v_mfma_f32_16x16x32_bf16 v[28:31], v[40:43], v[148:151], v[28:31]
    ds_read_b64_tr_b16 v[38:39], v242 offset:8448
    v_mfma_f32_16x16x32_bf16 v[16:19], v[44:47], v[144:147], v[16:19]
    ds_read_b64_tr_b16 v[40:41], v95 offset:8448
    v_mfma_f32_16x16x32_bf16 v[32:35], v[44:47], v[148:151], v[32:35]
    ds_read_b64_tr_b16 v[42:43], v243 offset:8448
    buffer_load_dwordx4 v[140:143], v225, s[40:43], s70 offen offset:2048 sc1
    s_waitcnt vmcnt(10) lgkmcnt(8)
    v_mfma_f32_16x16x32_bf16 v[4:7], v[48:51], v[96:99], v[4:7]
    ds_read_b64_tr_b16 v[44:45], v92 offset:12544
    v_mfma_f32_16x16x32_bf16 v[20:23], v[48:51], v[100:103], v[20:23]
    ds_read_b64_tr_b16 v[46:47], v240 offset:12544
    v_mfma_f32_16x16x32_bf16 v[8:11], v[52:55], v[96:99], v[8:11]
    ds_read_b64_tr_b16 v[48:49], v93 offset:12544
    v_mfma_f32_16x16x32_bf16 v[24:27], v[52:55], v[100:103], v[24:27]
    ds_read_b64_tr_b16 v[50:51], v241 offset:12544
    buffer_load_dwordx4 v[144:147], v224, s[40:43], s70 offen offset:3072 sc1
    v_mfma_f32_16x16x32_bf16 v[12:15], v[56:59], v[96:99], v[12:15]
    ds_read_b64_tr_b16 v[52:53], v94 offset:12544
    v_mfma_f32_16x16x32_bf16 v[28:31], v[56:59], v[100:103], v[28:31]
    ds_read_b64_tr_b16 v[54:55], v242 offset:12544
    v_mfma_f32_16x16x32_bf16 v[16:19], v[60:63], v[96:99], v[16:19]
    ds_read_b64_tr_b16 v[56:57], v95 offset:12544
    v_mfma_f32_16x16x32_bf16 v[32:35], v[60:63], v[100:103], v[32:35]
    ds_read_b64_tr_b16 v[58:59], v243 offset:12544
    buffer_load_dwordx4 v[148:151], v225, s[40:43], s70 offen offset:3072 sc1
    s_waitcnt vmcnt(10) lgkmcnt(8)
    v_mfma_f32_16x16x32_bf16 v[4:7], v[64:67], v[104:107], v[4:7]
    ds_read_b64_tr_b16 v[60:61], v92 offset:16896
    v_mfma_f32_16x16x32_bf16 v[20:23], v[64:67], v[108:111], v[20:23]
    ds_read_b64_tr_b16 v[62:63], v240 offset:16896
    v_mfma_f32_16x16x32_bf16 v[8:11], v[68:71], v[104:107], v[8:11]
    ds_read_b64_tr_b16 v[64:65], v93 offset:16896
    v_mfma_f32_16x16x32_bf16 v[24:27], v[68:71], v[108:111], v[24:27]
    ds_read_b64_tr_b16 v[66:67], v241 offset:16896
    buffer_load_dwordx4 v[96:99], v224, s[40:43], s71 offen offset:0 sc1
    v_mfma_f32_16x16x32_bf16 v[12:15], v[36:39], v[104:107], v[12:15]
    ds_read_b64_tr_b16 v[68:69], v94 offset:16896
    v_mfma_f32_16x16x32_bf16 v[28:31], v[36:39], v[108:111], v[28:31]
    ds_read_b64_tr_b16 v[70:71], v242 offset:16896
    v_mfma_f32_16x16x32_bf16 v[16:19], v[40:43], v[104:107], v[16:19]
    ds_read_b64_tr_b16 v[36:37], v95 offset:16896
    v_mfma_f32_16x16x32_bf16 v[32:35], v[40:43], v[108:111], v[32:35]
    ds_read_b64_tr_b16 v[38:39], v243 offset:16896
    buffer_load_dwordx4 v[100:103], v225, s[40:43], s71 offen offset:0 sc1
    s_waitcnt vmcnt(10) lgkmcnt(8)
    v_mfma_f32_16x16x32_bf16 v[4:7], v[44:47], v[112:115], v[4:7]
    ds_read_b64_tr_b16 v[40:41], v92 offset:20992
    v_mfma_f32_16x16x32_bf16 v[20:23], v[44:47], v[116:119], v[20:23]
    ds_read_b64_tr_b16 v[42:43], v240 offset:20992
    v_mfma_f32_16x16x32_bf16 v[8:11], v[48:51], v[112:115], v[8:11]
    ds_read_b64_tr_b16 v[44:45], v93 offset:20992
    v_mfma_f32_16x16x32_bf16 v[24:27], v[48:51], v[116:119], v[24:27]
    ds_read_b64_tr_b16 v[46:47], v241 offset:20992
    buffer_load_dwordx4 v[104:107], v224, s[40:43], s71 offen offset:1024 sc1
    v_mfma_f32_16x16x32_bf16 v[12:15], v[52:55], v[112:115], v[12:15]
    ds_read_b64_tr_b16 v[48:49], v94 offset:20992
    v_mfma_f32_16x16x32_bf16 v[28:31], v[52:55], v[116:119], v[28:31]
    ds_read_b64_tr_b16 v[50:51], v242 offset:20992
    v_mfma_f32_16x16x32_bf16 v[16:19], v[56:59], v[112:115], v[16:19]
    ds_read_b64_tr_b16 v[52:53], v95 offset:20992
    v_mfma_f32_16x16x32_bf16 v[32:35], v[56:59], v[116:119], v[32:35]
    ds_read_b64_tr_b16 v[54:55], v243 offset:20992
    buffer_load_dwordx4 v[108:111], v225, s[40:43], s71 offen offset:1024 sc1
    s_waitcnt vmcnt(10) lgkmcnt(8)
    v_mfma_f32_16x16x32_bf16 v[4:7], v[60:63], v[120:123], v[4:7]
    ds_read_b64_tr_b16 v[56:57], v92 offset:25344
    v_mfma_f32_16x16x32_bf16 v[20:23], v[60:63], v[124:127], v[20:23]
    ds_read_b64_tr_b16 v[58:59], v240 offset:25344
    v_mfma_f32_16x16x32_bf16 v[8:11], v[64:67], v[120:123], v[8:11]
    ds_read_b64_tr_b16 v[60:61], v93 offset:25344
    v_mfma_f32_16x16x32_bf16 v[24:27], v[64:67], v[124:127], v[24:27]
    ds_read_b64_tr_b16 v[62:63], v241 offset:25344
    buffer_load_dwordx4 v[112:115], v224, s[40:43], s71 offen offset:2048 sc1
    v_mfma_f32_16x16x32_bf16 v[12:15], v[68:71], v[120:123], v[12:15]
    ds_read_b64_tr_b16 v[64:65], v94 offset:25344
    v_mfma_f32_16x16x32_bf16 v[28:31], v[68:71], v[124:127], v[28:31]
    ds_read_b64_tr_b16 v[66:67], v242 offset:25344
    v_mfma_f32_16x16x32_bf16 v[16:19], v[36:39], v[120:123], v[16:19]
    ds_read_b64_tr_b16 v[68:69], v95 offset:25344
    v_mfma_f32_16x16x32_bf16 v[32:35], v[36:39], v[124:127], v[32:35]
    ds_read_b64_tr_b16 v[70:71], v243 offset:25344
    buffer_load_dwordx4 v[116:119], v225, s[40:43], s71 offen offset:2048 sc1
    s_waitcnt vmcnt(10) lgkmcnt(8)
    v_mfma_f32_16x16x32_bf16 v[4:7], v[40:43], v[128:131], v[4:7]
    ds_read_b64_tr_b16 v[36:37], v92 offset:29440
    v_mfma_f32_16x16x32_bf16 v[20:23], v[40:43], v[132:135], v[20:23]
    ds_read_b64_tr_b16 v[38:39], v240 offset:29440
    v_mfma_f32_16x16x32_bf16 v[8:11], v[44:47], v[128:131], v[8:11]
    ds_read_b64_tr_b16 v[40:41], v93 offset:29440
    v_mfma_f32_16x16x32_bf16 v[24:27], v[44:47], v[132:135], v[24:27]
    ds_read_b64_tr_b16 v[42:43], v241 offset:29440
    buffer_load_dwordx4 v[120:123], v224, s[40:43], s71 offen offset:3072 sc1
    v_mfma_f32_16x16x32_bf16 v[12:15], v[48:51], v[128:131], v[12:15]
    ds_read_b64_tr_b16 v[44:45], v94 offset:29440
    v_mfma_f32_16x16x32_bf16 v[28:31], v[48:51], v[132:135], v[28:31]
    ds_read_b64_tr_b16 v[46:47], v242 offset:29440
    v_mfma_f32_16x16x32_bf16 v[16:19], v[52:55], v[128:131], v[16:19]
    ds_read_b64_tr_b16 v[48:49], v95 offset:29440
    v_mfma_f32_16x16x32_bf16 v[32:35], v[52:55], v[132:135], v[32:35]
    ds_read_b64_tr_b16 v[50:51], v243 offset:29440
    buffer_load_dwordx4 v[124:127], v225, s[40:43], s71 offen offset:3072 sc1
    s_waitcnt vmcnt(10) lgkmcnt(8)
    v_mfma_f32_16x16x32_bf16 v[4:7], v[56:59], v[136:139], v[4:7]
    ds_read_b64_tr_b16 v[52:53], v84 offset:41984
    v_mfma_f32_16x16x32_bf16 v[20:23], v[56:59], v[140:143], v[20:23]
    ds_read_b64_tr_b16 v[54:55], v232 offset:41984
    v_mfma_f32_16x16x32_bf16 v[8:11], v[60:63], v[136:139], v[8:11]
    ds_read_b64_tr_b16 v[56:57], v85 offset:41984
    v_mfma_f32_16x16x32_bf16 v[24:27], v[60:63], v[140:143], v[24:27]
    ds_read_b64_tr_b16 v[58:59], v233 offset:41984
    v_mfma_f32_16x16x32_bf16 v[12:15], v[64:67], v[136:139], v[12:15]
    ds_read_b64_tr_b16 v[60:61], v86 offset:41984
    v_mfma_f32_16x16x32_bf16 v[28:31], v[64:67], v[140:143], v[28:31]
    ds_read_b64_tr_b16 v[62:63], v234 offset:41984
    v_mfma_f32_16x16x32_bf16 v[16:19], v[68:71], v[136:139], v[16:19]
    ds_read_b64_tr_b16 v[64:65], v87 offset:41984
    v_mfma_f32_16x16x32_bf16 v[32:35], v[68:71], v[140:143], v[32:35]
    ds_read_b64_tr_b16 v[66:67], v235 offset:41984
    s_waitcnt vmcnt(8) lgkmcnt(8)
    v_mfma_f32_16x16x32_bf16 v[4:7], v[36:39], v[144:147], v[4:7]
    ds_read_b64_tr_b16 v[68:69], v84 offset:46080
    v_mfma_f32_16x16x32_bf16 v[20:23], v[36:39], v[148:151], v[20:23]
    ds_read_b64_tr_b16 v[70:71], v232 offset:46080
    v_mfma_f32_16x16x32_bf16 v[8:11], v[40:43], v[144:147], v[8:11]
    ds_read_b64_tr_b16 v[36:37], v85 offset:46080
    v_mfma_f32_16x16x32_bf16 v[24:27], v[40:43], v[148:151], v[24:27]
    ds_read_b64_tr_b16 v[38:39], v233 offset:46080
    v_mfma_f32_16x16x32_bf16 v[12:15], v[44:47], v[144:147], v[12:15]
    ds_read_b64_tr_b16 v[40:41], v86 offset:46080
    v_mfma_f32_16x16x32_bf16 v[28:31], v[44:47], v[148:151], v[28:31]
    ds_read_b64_tr_b16 v[42:43], v234 offset:46080
    v_mfma_f32_16x16x32_bf16 v[16:19], v[48:51], v[144:147], v[16:19]
    ds_read_b64_tr_b16 v[44:45], v87 offset:46080
    v_mfma_f32_16x16x32_bf16 v[32:35], v[48:51], v[148:151], v[32:35]
    ds_read_b64_tr_b16 v[46:47], v235 offset:46080
    s_waitcnt vmcnt(6) lgkmcnt(8)
    v_mfma_f32_16x16x32_bf16 v[4:7], v[52:55], v[96:99], v[4:7]
    ds_read_b64_tr_b16 v[48:49], v84 offset:51200
    v_mfma_f32_16x16x32_bf16 v[20:23], v[52:55], v[100:103], v[20:23]
    ds_read_b64_tr_b16 v[50:51], v232 offset:51200
    v_mfma_f32_16x16x32_bf16 v[8:11], v[56:59], v[96:99], v[8:11]
    ds_read_b64_tr_b16 v[52:53], v85 offset:51200
    v_mfma_f32_16x16x32_bf16 v[24:27], v[56:59], v[100:103], v[24:27]
    ds_read_b64_tr_b16 v[54:55], v233 offset:51200
    v_mfma_f32_16x16x32_bf16 v[12:15], v[60:63], v[96:99], v[12:15]
    ds_read_b64_tr_b16 v[56:57], v86 offset:51200
    v_mfma_f32_16x16x32_bf16 v[28:31], v[60:63], v[100:103], v[28:31]
    ds_read_b64_tr_b16 v[58:59], v234 offset:51200
    v_mfma_f32_16x16x32_bf16 v[16:19], v[64:67], v[96:99], v[16:19]
    ds_read_b64_tr_b16 v[60:61], v87 offset:51200
    v_mfma_f32_16x16x32_bf16 v[32:35], v[64:67], v[100:103], v[32:35]
    ds_read_b64_tr_b16 v[62:63], v235 offset:51200
    s_waitcnt vmcnt(4) lgkmcnt(8)
    v_mfma_f32_16x16x32_bf16 v[4:7], v[68:71], v[104:107], v[4:7]
    ds_read_b64_tr_b16 v[64:65], v84 offset:55296
    v_mfma_f32_16x16x32_bf16 v[20:23], v[68:71], v[108:111], v[20:23]
    ds_read_b64_tr_b16 v[66:67], v232 offset:55296
    v_mfma_f32_16x16x32_bf16 v[8:11], v[36:39], v[104:107], v[8:11]
    ds_read_b64_tr_b16 v[68:69], v85 offset:55296
    v_mfma_f32_16x16x32_bf16 v[24:27], v[36:39], v[108:111], v[24:27]
    ds_read_b64_tr_b16 v[70:71], v233 offset:55296
    v_mfma_f32_16x16x32_bf16 v[12:15], v[40:43], v[104:107], v[12:15]
    ds_read_b64_tr_b16 v[36:37], v86 offset:55296
    v_mfma_f32_16x16x32_bf16 v[28:31], v[40:43], v[108:111], v[28:31]
    ds_read_b64_tr_b16 v[38:39], v234 offset:55296
    v_mfma_f32_16x16x32_bf16 v[16:19], v[44:47], v[104:107], v[16:19]
    ds_read_b64_tr_b16 v[40:41], v87 offset:55296
    v_mfma_f32_16x16x32_bf16 v[32:35], v[44:47], v[108:111], v[32:35]
    ds_read_b64_tr_b16 v[42:43], v235 offset:55296
    s_waitcnt vmcnt(2) lgkmcnt(8)
    v_mfma_f32_16x16x32_bf16 v[4:7], v[48:51], v[112:115], v[4:7]
    v_mfma_f32_16x16x32_bf16 v[8:11], v[52:55], v[112:115], v[8:11]
    v_mfma_f32_16x16x32_bf16 v[12:15], v[56:59], v[112:115], v[12:15]
    v_mfma_f32_16x16x32_bf16 v[16:19], v[60:63], v[112:115], v[16:19]
    s_waitcnt vmcnt(0) lgkmcnt(0)
    v_mfma_f32_16x16x32_bf16 v[4:7], v[64:67], v[120:123], v[4:7]
    s_nop 0
    s_nop 0
    v_mfma_f32_16x16x32_bf16 v[8:11], v[68:71], v[120:123], v[8:11]
    s_nop 0
    s_nop 0
    v_mfma_f32_16x16x32_bf16 v[12:15], v[36:39], v[120:123], v[12:15]
    s_nop 0
    s_nop 0
    v_cvt_pk_bf16_f32 v172, v4, v5
    v_cvt_pk_bf16_f32 v173, v6, v7
    v_mfma_f32_16x16x32_bf16 v[16:19], v[40:43], v[120:123], v[16:19]
    ds_write_b64 v244, v[172:173]
    v_cvt_pk_bf16_f32 v174, v8, v9
    v_mfma_f32_16x16x32_bf16 v[20:23], v[48:51], v[116:119], v[20:23]
    v_cvt_pk_bf16_f32 v175, v10, v11
    ds_write_b64 v245, v[174:175]
    v_mfma_f32_16x16x32_bf16 v[20:23], v[64:67], v[124:127], v[20:23]
    v_cvt_pk_bf16_f32 v176, v12, v13
    v_cvt_pk_bf16_f32 v177, v14, v15
    v_mfma_f32_16x16x32_bf16 v[24:27], v[52:55], v[116:119], v[24:27]
    ds_write_b64 v246, v[176:177]
    v_cvt_pk_bf16_f32 v178, v16, v17
    v_mfma_f32_16x16x32_bf16 v[24:27], v[68:71], v[124:127], v[24:27]
    v_cvt_pk_bf16_f32 v179, v18, v19
    ds_write_b64 v247, v[178:179]
    v_mfma_f32_16x16x32_bf16 v[28:31], v[56:59], v[116:119], v[28:31]
    ds_read_b128 v[188:191], v248 offset:0
    ds_read_b128 v[192:195], v248 offset:1024
    v_mfma_f32_16x16x32_bf16 v[28:31], v[36:39], v[124:127], v[28:31]
    v_cvt_pk_bf16_f32 v180, v20, v21
    v_cvt_pk_bf16_f32 v181, v22, v23
    v_mfma_f32_16x16x32_bf16 v[32:35], v[60:63], v[116:119], v[32:35]
    ds_write_b64 v244, v[180:181]
    v_cvt_pk_bf16_f32 v182, v24, v25
    v_mfma_f32_16x16x32_bf16 v[32:35], v[40:43], v[124:127], v[32:35]
    v_cvt_pk_bf16_f32 v183, v26, v27
    ds_write_b64 v245, v[182:183]
    v_cvt_pk_bf16_f32 v184, v28, v29
    v_cvt_pk_bf16_f32 v185, v30, v31
    s_mov_b32 s37, 0
    s_waitcnt lgkmcnt(3)
    buffer_store_dwordx4 v[188:191], v226, s[48:51], s37 offen nt
    s_mov_b32 s37, 65536
    s_waitcnt lgkmcnt(2)
    buffer_store_dwordx4 v[192:195], v226, s[48:51], s37 offen nt
    ds_write_b64 v246, v[184:185]
    v_cvt_pk_bf16_f32 v186, v32, v33
    v_cvt_pk_bf16_f32 v187, v34, v35
    ds_write_b64 v247, v[186:187]
    ds_read_b128 v[196:199], v248 offset:0
    ds_read_b128 v[200:203], v248 offset:1024
    s_mov_b32 s37, 131072
    s_waitcnt lgkmcnt(1)
    buffer_store_dwordx4 v[196:199], v226, s[48:51], s37 offen nt
    s_mov_b32 s37, 196608
    s_waitcnt lgkmcnt(0)
    buffer_store_dwordx4 v[200:203], v226, s[48:51], s37 offen nt
    s_endpgm
L_g1_rare:
    s_waitcnt vmcnt(0)
    s_cmp_lg_u32 s36, 1
    s_cbranch_scc1 L_g1_bar
    v_readfirstlane_b32 s38, v1
    s_nop 0
    s_cmp_ge_u32 s38, 4
    s_cbranch_scc1 L_sl_done_59
    s_mov_b32 s39, 1048576
L_sl_loop_60:
    ds_read_b32 v1, v228 offset:24
    s_waitcnt lgkmcnt(0)
    v_readfirstlane_b32 s38, v1
    s_nop 0
    s_cmp_ge_u32 s38, 4
    s_cbranch_scc1 L_sl_done_59
    s_sleep 1
    s_sub_u32 s39, s39, 1
    s_cbranch_scc0 L_sl_loop_60
L_sl_done_59:
    s_branch L_g1_nobar
L_end:
    s_endpgm
.section .rodata,"a"
.p2align 6
.amdhsa_kernel concat_heads__ssm_conv_h3__sliding_local_dilated__prompt_kernel
  .amdhsa_next_free_vgpr 256
  .amdhsa_next_free_sgpr 102
  .amdhsa_accum_offset 256
  .amdhsa_group_segment_fixed_size 0
  .amdhsa_kernarg_size 96
  .amdhsa_user_sgpr_count 2
  .amdhsa_user_sgpr_kernarg_segment_ptr 1
  .amdhsa_system_sgpr_workgroup_id_x 1
  .amdhsa_float_denorm_mode_32 3
.end_amdhsa_kernel
```

```asm
; @launch grid=(256,1,1) block=(512,1,1) lds=163840
.amdgcn_target "amdgcn-amd-amdhsa--gfx950"
.text
.globl concat_heads__ssm_conv_h3__sliding_local_dilated__prompt_kernel
.p2align 8
.type concat_heads__ssm_conv_h3__sliding_local_dilated__prompt_kernel,@function
concat_heads__ssm_conv_h3__sliding_local_dilated__prompt_kernel:
L_entry:
    s_getpc_b64 s[32:33]
    s_cmp_ge_u32 s2, 256
    s_cbranch_scc1 L_end
    s_load_dwordx16 s[8:23], s[0:1], 0
    s_load_dwordx8 s[24:31], s[0:1], 64
    v_lshrrev_b32 v1, 6, v0
    s_and_b32 s4, s2, 1
    v_readfirstlane_b32 s3, v1
    v_and_b32 v0, 63, v0
    s_bfe_u32 s5, s2, 0x30003
    s_bfe_u32 s6, s2, 0x20001
    s_lshr_b32 s7, s2, 6
    s_lshl2_add_u32 s6, s6, s7
    s_cmp_ge_u32 s3, 4
    s_cbranch_scc1 L_crole
    s_bfe_u32 s34, s2, 0x20003
    s_lshl2_add_u32 s34, s34, s3
    s_lshl_b32 s34, s34, 7
    v_lshl_add_u32 v1, v0, 11, s34
    v_min_u32 v1, L_end-L_entry-8, v1
    s_mov_b64 exec, 0xffff
    global_load_dword v249, v1, s[32:33]
    s_mov_b64 exec, -1
    s_and_b32 s84, s2, 3
    s_lshl2_add_u32 s84, s84, s3
    s_lshr_b32 s85, s2, 2
    s_mul_i32 s86, s3, 8448
    s_add_u32 s86, s86, 125952
    s_lshl_b32 s87, s85, 9
    s_add_u32 s87, s87, s84
    s_lshl_b32 s87, s87, 7
    v_and_b32 v231, 7, v0
    v_lshl_add_u32 v231, v231, 4, s87
    v_lshrrev_b32 v230, 3, v0
    v_lshl_add_u32 v230, v230, 13, v231
    v_subrev_u32 v231, 6144, v230
    v_subrev_u32 v232, 4096, v230
    v_subrev_u32 v233, 2048, v230
    v_add_u32 v234, 4096, v230
    v_lshlrev_b32 v235, 4, v0
    s_lshl_b32 s87, s84, 9
    s_add_u32 m0, s86, 4224
    s_waitcnt lgkmcnt(0)
    s_mov_b32 s80, s14
    s_mov_b32 s81, s15
    s_mov_b32 s82, 0x2000
    s_mov_b32 s83, 0x20000
    s_mov_b32 s72, s10
    s_mov_b32 s73, s11
    s_mov_b32 s74, 0x400000
    s_mov_b32 s75, 0x20000
    s_mov_b32 exec_hi, 0
    buffer_load_dwordx4 v235, s[80:83], s87 offen lds
    s_mov_b64 exec, -1
    buffer_load_dwordx4 v[108:111], v231, s[72:75], 0 offen offset:0 nt
    buffer_load_dwordx4 v[112:115], v232, s[72:75], 0 offen offset:0 nt
    buffer_load_dwordx4 v[116:119], v233, s[72:75], 0 offen offset:0 nt
    buffer_load_dwordx4 v[120:123], v230, s[72:75], 0 offen offset:0 nt
    buffer_load_dwordx4 v[124:127], v230, s[72:75], 0 offen offset:2048 nt
    buffer_load_dwordx4 v[128:131], v234, s[72:75], 0 offen offset:0 nt
    buffer_load_dwordx4 v[132:135], v234, s[72:75], 0 offen offset:2048 nt
    s_mov_b32 s76, s12
    s_mov_b32 s77, s13
    s_mov_b32 s78, 0x400000
    s_mov_b32 s79, 0x20000
    buffer_load_dwordx4 v[136:139], v230, s[76:79], 0 offen offset:0 nt
    buffer_load_dwordx4 v[140:143], v230, s[76:79], 0 offen offset:2048 nt
    buffer_load_dwordx4 v[144:147], v234, s[76:79], 0 offen offset:0 nt
    buffer_load_dwordx4 v[148:151], v234, s[76:79], 0 offen offset:2048 nt
    s_branch L_grole
L_crole:
    s_sub_u32 s70, s3, 4
    s_lshl_b32 s43, s70, 12
    s_lshl_b32 s44, s70, 11
    s_add_u32 s44, s44, 17408
    s_lshl_b32 s49, s70, 4
    s_lshl_b64 s[46:47], 0xffff, s49
    v_lshrrev_b32 v13, 3, v0
    v_and_b32 v14, 7, v0
    v_lshrrev_b32 v15, 4, v0
    s_lshl2_add_u32 s50, s5, s70
    s_lshl_b32 s50, s50, 6
    s_add_u32 s50, s50, s4
    s_lshl_b32 s50, s50, 11
    v_lshl_add_u32 v16, v13, 12, s50
    v_xor_b32 v17, v14, v15
    v_lshl_add_u32 v2, v17, 4, v16
    v_xor_b32 v3, 64, v2
    v_add_u32 v3, 31744, v3
    v_add_u32 v4, 63488, v2
    v_add_u32 v5, 63488, v3
    s_lshl_b32 s49, s5, 7
    s_sub_u32 s49, s49, 8
    s_max_i32 s49, s49, 0
    s_lshl1_add_u32 s49, s49, s4
    s_lshl_b32 s49, s49, 11
    v_lshl_add_u32 v16, v13, 12, s49
    v_lshlrev_b32 v17, 1, v15
    v_xor_b32 v18, v14, v13
    v_lshl_add_u32 v6, v18, 4, v16
    s_mul_i32 s49, s70, 768
    s_add_u32 s49, s49, s6
    s_lshl_b32 s49, s49, 7
    v_mul_u32_u24 v16, 6144, v13
    v_and_b32 v17, 2, v17
    v_xor_b32 v17, v14, v17
    v_lshlrev_b32 v17, 4, v17
    v_add3_u32 v7, v17, v16, s49
    v_xor_b32 v8, 64, v7
    v_add_u32 v8, 48128, v8
    v_add_u32 v9, 2048, v7
    v_add_u32 v10, 2048, v8
    v_add_u32 v11, 4096, v7
    v_add_u32 v12, 4096, v8
    s_movk_i32 s40, 0
    s_mov_b32 s41, 0
    s_lshr_b32 s90, s2, 3
    s_and_b32 s91, s3, 3
    s_lshl2_add_u32 s90, s90, s91
    s_and_b32 s91, s2, 6
    s_lshl3_add_u32 s88, s90, s91
    s_lshl1_add_u32 s88, s88, s4
    s_lshl_b32 s88, s88, 11
    s_and_b32 s89, s2, 7
    s_and_b32 s91, s90, 1
    s_lshl1_add_u32 s89, s89, s91
    s_lshr_b32 s90, s90, 1
    s_mul_i32 s90, s90, 48
    s_add_u32 s89, s89, s90
    s_lshl_b32 s89, s89, 7
    v_and_b32 v251, 1, v0
    v_lshlrev_b32 v251, 12, v251
    v_lshrrev_b32 v252, 1, v0
    v_lshl_add_u32 v251, v252, 7, v251
    v_lshrrev_b32 v250, 2, v0
    v_mul_u32_u24 v250, 393216, v250
    v_and_b32 v252, 3, v0
    v_lshl_add_u32 v252, v252, 11, v250
    s_waitcnt lgkmcnt(0)
    s_mov_b32 s32, s20
    s_mov_b32 s33, s21
    s_mov_b32 s34, 0x400000
    s_mov_b32 s35, 0x20000
    s_mov_b32 s36, s22
    s_mov_b32 s37, s23
    s_mov_b32 s38, 0x600000
    s_mov_b32 s39, 0x20000
    s_setprio 0
    s_and_b32 s73, s2, 7
    s_xor_b32 s73, s73, 2
    s_lshr_b32 s74, s2, 7
    s_lshl1_add_u32 s68, s73, s74
    s_bfe_u32 s69, s2, 0x40003
    s_lshl4_add_u32 s71, s68, s69
    s_lshl2_add_u32 s71, s71, s70
    s_mul_i32 s80, s70, 8448
    s_add_u32 s80, s80, 125952
    s_mul_i32 s81, s70, 9216
    s_add_u32 s81, s81, 41984
    s_add_u32 s52, s30, 0xe00000
    s_addc_u32 s53, s31, 0
    s_mov_b32 s54, 0x20000
    s_mov_b32 s55, 0x20000
    s_add_u32 s64, s30, 0x900000
    s_addc_u32 s65, s31, 0
    s_mov_b32 s66, 0x420000
    s_mov_b32 s67, 0x20000
    s_lshl_b32 s84, s71, 12
    s_mul_i32 s85, s71, 4224
    s_add_u32 s85, s85, 4194304
    s_lshr_b32 s72, s71, 1
    s_lshl_b32 s72, s72, 2
    s_load_dword s72, s[18:19], s72
    v_lshlrev_b32 v224, 4, v0
    v_mov_b32 v228, 0
    v_mov_b32 v229, 0
    v_mov_b32 v230, 0
    v_mov_b32 v231, 0
    v_mov_b32 v227, 134352
    v_mov_b32 v244, 1
    s_bfe_u32 s87, s2, 0x20006
    s_mov_b64 exec, 1
    ds_write_b128 v227, v[228:231]
    ds_write_b128 v227, v[228:231] offset:16
    ds_write_b128 v227, v[228:231] offset:32
    s_mov_b64 exec, -1
    s_mov_b32 exec_lo, 0x7777
    s_mov_b32 exec_hi, 0x0
    s_bfe_u32 s7, s89, 0x30007
    s_cmp_lg_u32 s7, 1
    s_cbranch_scc1 L_wx3_1
    buffer_load_dword v250, v252, s[36:39], s89 offen offset:256
L_wx3_1:
    buffer_load_dword v250, v252, s[36:39], s89 offen
    s_mov_b32 exec_lo, 0xff
    s_mov_b32 exec_hi, 0
    buffer_load_dword v250, v251, s[32:35], s88 offen
    s_mov_b64 exec, -1
    s_add_u32 m0, s43, 0
    s_nop 0
    buffer_load_dwordx4 v2, s[32:35], s40 offen offset:0 lds
    s_add_u32 m0, s44, 0
    s_nop 0
    buffer_load_dwordx4 v7, s[36:39], s41 offen offset:0 lds
    buffer_load_dwordx4 v8, s[36:39], s41 offen offset:1024 lds
    s_add_u32 m0, s43, 0
    s_nop 0
    buffer_load_dwordx4 v3, s[32:35], s40 offen offset:1024 lds
    s_add_u32 m0, s44, 8192
    s_nop 0
    buffer_load_dwordx4 v9, s[36:39], s41 offen offset:0 lds
    buffer_load_dwordx4 v10, s[36:39], s41 offen offset:1024 lds
    s_add_u32 m0, s43, 0
    s_nop 0
    buffer_load_dwordx4 v4, s[32:35], s40 offen offset:2048 lds
    s_add_u32 m0, s44, 16384
    s_nop 0
    buffer_load_dwordx4 v11, s[36:39], s41 offen offset:0 lds
    buffer_load_dwordx4 v12, s[36:39], s41 offen offset:1024 lds
    s_add_u32 m0, s43, 0
    s_nop 0
    buffer_load_dwordx4 v5, s[32:35], s40 offen offset:3072 lds
    s_mov_b32 m0, 16384
    s_mov_b64 exec, s[46:47]
    buffer_load_dwordx4 v6, s[32:35], s40 offen lds
    s_mov_b64 exec, -1
    s_movk_i32 s40, 128
    s_mov_b32 s41, 393216
    s_add_u32 m0, s43, 41984
    s_nop 0
    buffer_load_dwordx4 v2, s[32:35], s40 offen offset:0 lds
    s_add_u32 m0, s44, 41984
    s_nop 0
    buffer_load_dwordx4 v7, s[36:39], s41 offen offset:0 lds
    buffer_load_dwordx4 v8, s[36:39], s41 offen offset:1024 lds
    s_add_u32 m0, s43, 41984
    s_nop 0
    buffer_load_dwordx4 v3, s[32:35], s40 offen offset:1024 lds
    s_add_u32 m0, s44, 50176
    s_nop 0
    buffer_load_dwordx4 v9, s[36:39], s41 offen offset:0 lds
    buffer_load_dwordx4 v10, s[36:39], s41 offen offset:1024 lds
    s_add_u32 m0, s43, 41984
    s_nop 0
    buffer_load_dwordx4 v4, s[32:35], s40 offen offset:2048 lds
    s_add_u32 m0, s44, 58368
    s_nop 0
    buffer_load_dwordx4 v11, s[36:39], s41 offen offset:0 lds
    buffer_load_dwordx4 v12, s[36:39], s41 offen offset:1024 lds
    s_add_u32 m0, s43, 41984
    s_nop 0
    buffer_load_dwordx4 v5, s[32:35], s40 offen offset:3072 lds
    s_mov_b32 m0, 58368
    s_mov_b64 exec, s[46:47]
    buffer_load_dwordx4 v6, s[32:35], s40 offen lds
    s_mov_b64 exec, -1
    s_movk_i32 s40, 256
    s_mov_b32 s41, 786432
    s_lshr_b32 s74, s69, 2
    s_and_b32 s75, s69, 3
    s_lshl3_add_u32 s74, s74, s75
    s_lshl3_add_u32 s74, s74, s70
    s_lshl_b32 s74, s74, 3
    v_bfe_u32 v234, v0, 3, 1
    v_lshl_add_u32 v225, v234, 8, s74
    v_bfe_u32 v234, v0, 4, 1
    v_lshl_add_u32 v225, v234, 1, v225
    v_lshrrev_b32 v234, 5, v0
    v_lshl_add_u32 v225, v234, 5, v225
    s_lshl_b32 s74, s68, 7
    v_and_b32 v234, 7, v0
    v_lshl_add_u32 v234, v234, 4, s74
    v_lshl_add_u32 v226, v225, 12, v234
    v_lshl_add_u32 v225, v225, 11, v234
    v_and_b32 v234, 1, v0
    v_xor_b32 v234, 1, v234
    v_mul_u32_u24 v232, 4224, v234
    v_mul_u32_u24 v233, 4576, v234
    v_bfe_u32 v234, v0, 1, 3
    v_lshl_add_u32 v232, v234, 3, v232
    v_xor_b32 v234, 7, v234
    v_lshl_add_u32 v233, v234, 6, v233
    v_lshrrev_b32 v234, 4, v0
    v_lshl_add_u32 v232, v234, 4, v232
    v_lshl_add_u32 v233, v234, 4, v233
    v_add3_u32 v232, v232, s80, 8
    v_add_u32 v233, s81, v233
    s_waitcnt lgkmcnt(0)
    s_bitcmp1_b32 s71, 0
    s_cselect_b32 s74, 0, 16
    s_lshl_b32 s72, s72, s74
    s_and_b32 s72, s72, 0xffff0000
    v_and_b32 v235, 1, v0
    v_lshlrev_b32 v235, 4, v235
    v_lshrrev_b32 v235, v235, s72
    v_bfe_u32 v236, v0, 1, 3
    v_lshl_add_u32 v236, v234, 1, v236
    v_cmp_eq_u32 vcc, 7, v236
    v_mov_b32 v241, 0
    v_mov_b32 v243, 0
    v_cndmask_b32 v240, 0, v235, vcc
    v_cmp_eq_u32 vcc, 6, v236
    s_nop 1
    v_cndmask_b32 v242, 0, v235, vcc
    s_lshr_b32 s7, s2, 6
    s_mul_i32 s90, s7, 1048576
    s_sub_u32 s88, s88, s90
    s_mul_i32 s90, s7, 98304
    s_sub_u32 s89, s89, s90
    v_lshrrev_b32 v20, 3, v0
    v_mul_u32_u24 v20, 1048064, v20
    v_add_u32 v251, v251, v20
    v_lshrrev_b32 v20, 4, v0
    v_mul_u32_u24 v20, 1474560, v20
    v_sub_u32 v252, v252, v20
    s_waitcnt vmcnt(11)
    s_barrier
    s_add_u32 m0, s43, 83968
    s_nop 0
    buffer_load_dwordx4 v2, s[32:35], s40 offen offset:0 lds
    s_add_u32 m0, s44, 83968
    s_nop 0
    buffer_load_dwordx4 v7, s[36:39], s41 offen offset:0 lds
    buffer_load_dwordx4 v8, s[36:39], s41 offen offset:1024 lds
    s_add_u32 m0, s43, 83968
    s_nop 0
    buffer_load_dwordx4 v3, s[32:35], s40 offen offset:1024 lds
    s_add_u32 m0, s44, 92160
    s_nop 0
    buffer_load_dwordx4 v9, s[36:39], s41 offen offset:0 lds
    buffer_load_dwordx4 v10, s[36:39], s41 offen offset:1024 lds
    s_add_u32 m0, s43, 83968
    s_nop 0
    buffer_load_dwordx4 v4, s[32:35], s40 offen offset:2048 lds
    s_add_u32 m0, s44, 100352
    s_nop 0
    buffer_load_dwordx4 v11, s[36:39], s41 offen offset:0 lds
    buffer_load_dwordx4 v12, s[36:39], s41 offen offset:1024 lds
    s_add_u32 m0, s43, 83968
    s_nop 0
    buffer_load_dwordx4 v5, s[32:35], s40 offen offset:3072 lds
    s_mov_b32 m0, 100352
    s_mov_b64 exec, s[46:47]
    buffer_load_dwordx4 v6, s[32:35], s40 offen lds
    s_mov_b64 exec, -1
    s_movk_i32 s40, 384
    s_mov_b32 s41, 1179648
    s_cmp_lg_u32 s87, 0
    s_cbranch_scc1 L_stg_3
    s_add_u32 s6, s89, 1572864
    s_mov_b32 exec_lo, 0x770077
    s_mov_b32 exec_hi, 0x770077
    s_bfe_u32 s7, s89, 0x30007
    s_cmp_lg_u32 s7, 1
    s_cbranch_scc1 L_wx3_4
    buffer_load_dword v250, v252, s[36:39], s6 offen offset:256
L_wx3_4:
    buffer_load_dword v250, v252, s[36:39], s6 offen
    s_mov_b32 exec_lo, 0xf0f0f0f
    s_mov_b32 exec_hi, 0
    buffer_load_dword v250, v251, s[32:35], s88 offen offset:512
    s_mov_b64 exec, -1
L_stg_3:
    s_waitcnt vmcnt(13)
    s_bitcmp1_b32 1, s87
    s_cbranch_scc1 L_mw_5
    s_waitcnt vmcnt(11)
L_mw_5:
    s_barrier
    s_add_u32 m0, s43, 0
    s_nop 0
    buffer_load_dwordx4 v2, s[32:35], s40 offen offset:0 lds
    s_add_u32 m0, s44, 0
    s_nop 0
    buffer_load_dwordx4 v7, s[36:39], s41 offen offset:0 lds
    buffer_load_dwordx4 v8, s[36:39], s41 offen offset:1024 lds
    s_add_u32 m0, s43, 0
    s_nop 0
    buffer_load_dwordx4 v3, s[32:35], s40 offen offset:1024 lds
    s_add_u32 m0, s44, 8192
    s_nop 0
    buffer_load_dwordx4 v9, s[36:39], s41 offen offset:0 lds
    buffer_load_dwordx4 v10, s[36:39], s41 offen offset:1024 lds
    s_add_u32 m0, s43, 0
    s_nop 0
    buffer_load_dwordx4 v4, s[32:35], s40 offen offset:2048 lds
    s_add_u32 m0, s44, 16384
    s_nop 0
    buffer_load_dwordx4 v11, s[36:39], s41 offen offset:0 lds
    buffer_load_dwordx4 v12, s[36:39], s41 offen offset:1024 lds
    s_add_u32 m0, s43, 0
    s_nop 0
    buffer_load_dwordx4 v5, s[32:35], s40 offen offset:3072 lds
    s_mov_b32 m0, 16384
    s_mov_b64 exec, s[46:47]
    buffer_load_dwordx4 v6, s[32:35], s40 offen lds
    s_mov_b64 exec, -1
    s_movk_i32 s40, 512
    s_mov_b32 s41, 1572864
    s_cmp_lg_u32 s87, 1
    s_cbranch_scc1 L_stg_6
    s_add_u32 s6, s89, 2359296
    s_mov_b32 exec_lo, 0x770077
    s_mov_b32 exec_hi, 0x770077
    s_bfe_u32 s7, s89, 0x30007
    s_cmp_lg_u32 s7, 1
    s_cbranch_scc1 L_wx3_7
    buffer_load_dword v250, v252, s[36:39], s6 offen offset:256
L_wx3_7:
    buffer_load_dword v250, v252, s[36:39], s6 offen
    s_mov_b32 exec_lo, 0xf0f0f0f
    s_mov_b32 exec_hi, 0
    buffer_load_dword v250, v251, s[32:35], s88 offen offset:768
    s_mov_b64 exec, -1
L_stg_6:
    s_load_dwordx2 s[90:91], s[16:17], s84 offset:60
    s_load_dwordx2 s[90:91], s[16:17], s84 offset:188
    s_load_dwordx2 s[90:91], s[16:17], s84 offset:316
    s_waitcnt vmcnt(13)
    s_bitcmp1_b32 3, s87
    s_cbranch_scc1 L_mw_8
    s_waitcnt vmcnt(11)
L_mw_8:
    s_barrier
    s_add_u32 m0, s43, 41984
    s_nop 0
    buffer_load_dwordx4 v2, s[32:35], s40 offen offset:0 lds
    s_add_u32 m0, s44, 41984
    s_nop 0
    buffer_load_dwordx4 v7, s[36:39], s41 offen offset:0 lds
    buffer_load_dwordx4 v8, s[36:39], s41 offen offset:1024 lds
    s_add_u32 m0, s43, 41984
    s_nop 0
    buffer_load_dwordx4 v3, s[32:35], s40 offen offset:1024 lds
    s_add_u32 m0, s44, 50176
    s_nop 0
    buffer_load_dwordx4 v9, s[36:39], s41 offen offset:0 lds
    buffer_load_dwordx4 v10, s[36:39], s41 offen offset:1024 lds
    s_add_u32 m0, s43, 41984
    s_nop 0
    buffer_load_dwordx4 v4, s[32:35], s40 offen offset:2048 lds
    s_add_u32 m0, s44, 58368
    s_nop 0
    buffer_load_dwordx4 v11, s[36:39], s41 offen offset:0 lds
    buffer_load_dwordx4 v12, s[36:39], s41 offen offset:1024 lds
    s_add_u32 m0, s43, 41984
    s_nop 0
    buffer_load_dwordx4 v5, s[32:35], s40 offen offset:3072 lds
    s_mov_b32 m0, 58368
    s_mov_b64 exec, s[46:47]
    buffer_load_dwordx4 v6, s[32:35], s40 offen lds
    s_mov_b64 exec, -1
    s_movk_i32 s40, 640
    s_mov_b32 s41, 1966080
    s_load_dwordx2 s[90:91], s[16:17], s84 offset:444
    s_load_dwordx2 s[90:91], s[16:17], s84 offset:572
    s_load_dwordx2 s[90:91], s[16:17], s84 offset:700
    s_waitcnt vmcnt(13)
    s_bitcmp1_b32 2, s87
    s_cbranch_scc1 L_mw_9
    s_waitcnt vmcnt(11)
L_mw_9:
    s_barrier
    s_add_u32 m0, s43, 83968
    s_nop 0
    buffer_load_dwordx4 v2, s[32:35], s40 offen offset:0 lds
    s_add_u32 m0, s44, 83968
    s_nop 0
    buffer_load_dwordx4 v7, s[36:39], s41 offen offset:0 lds
    buffer_load_dwordx4 v8, s[36:39], s41 offen offset:1024 lds
    s_add_u32 m0, s43, 83968
    s_nop 0
    buffer_load_dwordx4 v3, s[32:35], s40 offen offset:1024 lds
    s_add_u32 m0, s44, 92160
    s_nop 0
    buffer_load_dwordx4 v9, s[36:39], s41 offen offset:0 lds
    buffer_load_dwordx4 v10, s[36:39], s41 offen offset:1024 lds
    s_add_u32 m0, s43, 83968
    s_nop 0
    buffer_load_dwordx4 v4, s[32:35], s40 offen offset:2048 lds
    s_add_u32 m0, s44, 100352
    s_nop 0
    buffer_load_dwordx4 v11, s[36:39], s41 offen offset:0 lds
    buffer_load_dwordx4 v12, s[36:39], s41 offen offset:1024 lds
    s_add_u32 m0, s43, 83968
    s_nop 0
    buffer_load_dwordx4 v5, s[32:35], s40 offen offset:3072 lds
    s_mov_b32 m0, 100352
    s_mov_b64 exec, s[46:47]
    buffer_load_dwordx4 v6, s[32:35], s40 offen lds
    s_mov_b64 exec, -1
    s_movk_i32 s40, 768
    s_mov_b32 s41, 2359296
    s_cmp_lg_u32 s87, 2
    s_cbranch_scc1 L_stg_10
    s_add_u32 s6, s89, 3145728
    s_mov_b32 exec_lo, 0x770077
    s_mov_b32 exec_hi, 0x770077
    s_bfe_u32 s7, s89, 0x30007
    s_cmp_lg_u32 s7, 1
    s_cbranch_scc1 L_wx3_11
    buffer_load_dword v250, v252, s[36:39], s6 offen offset:256
L_wx3_11:
    buffer_load_dword v250, v252, s[36:39], s6 offen
    s_mov_b32 exec_lo, 0xf0f0f0f
    s_mov_b32 exec_hi, 0
    buffer_load_dword v250, v251, s[32:35], s88 offen offset:1024
    s_mov_b64 exec, -1
L_stg_10:
    s_load_dwordx2 s[90:91], s[16:17], s84 offset:828
    s_load_dwordx2 s[90:91], s[16:17], s84 offset:956
    s_load_dwordx2 s[90:91], s[16:17], s84 offset:1084
    s_waitcnt vmcnt(13)
    s_bitcmp1_b32 4, s87
    s_cbranch_scc1 L_mw_12
    s_waitcnt vmcnt(11)
L_mw_12:
    s_barrier
    s_add_u32 m0, s43, 0
    s_nop 0
    buffer_load_dwordx4 v2, s[32:35], s40 offen offset:0 lds
    s_add_u32 m0, s44, 0
    s_nop 0
    buffer_load_dwordx4 v7, s[36:39], s41 offen offset:0 lds
    buffer_load_dwordx4 v8, s[36:39], s41 offen offset:1024 lds
    s_add_u32 m0, s43, 0
    s_nop 0
    buffer_load_dwordx4 v3, s[32:35], s40 offen offset:1024 lds
    s_add_u32 m0, s44, 8192
    s_nop 0
    buffer_load_dwordx4 v9, s[36:39], s41 offen offset:0 lds
    buffer_load_dwordx4 v10, s[36:39], s41 offen offset:1024 lds
    s_add_u32 m0, s43, 0
    s_nop 0
    buffer_load_dwordx4 v4, s[32:35], s40 offen offset:2048 lds
    s_add_u32 m0, s44, 16384
    s_nop 0
    buffer_load_dwordx4 v11, s[36:39], s41 offen offset:0 lds
    buffer_load_dwordx4 v12, s[36:39], s41 offen offset:1024 lds
    s_add_u32 m0, s43, 0
    s_nop 0
    buffer_load_dwordx4 v5, s[32:35], s40 offen offset:3072 lds
    s_mov_b32 m0, 16384
    s_mov_b64 exec, s[46:47]
    buffer_load_dwordx4 v6, s[32:35], s40 offen lds
    s_mov_b64 exec, -1
    s_movk_i32 s40, 896
    s_mov_b32 s41, 2752512
    s_bfe_u32 s74, s2, 0x20003
    s_lshl2_add_u32 s74, s74, s70
    s_cmp_lg_u32 s74, 0
    s_cbranch_scc1 L_sig_13
    s_mov_b32 s60, s28
    s_mov_b32 s61, s29
    s_mov_b32 s62, 0x100
    s_mov_b32 s63, 0x20000
    s_and_b32 s74, s2, 3
    s_lshl_b32 s74, s74, 6
    s_mov_b64 exec, 1
    buffer_atomic_add v244, off, s[60:63], s74 sc1
    s_mov_b64 exec, -1
L_sig_13:
    s_load_dwordx2 s[90:91], s[16:17], s84 offset:1212
    s_load_dwordx2 s[90:91], s[16:17], s84 offset:1340
    s_load_dwordx2 s[90:91], s[16:17], s84 offset:1468
    s_waitcnt vmcnt(13)
    s_bitcmp1_b32 4, s87
    s_cbranch_scc1 L_mw_14
    s_waitcnt vmcnt(11)
L_mw_14:
    s_barrier
    s_add_u32 m0, s43, 41984
    s_nop 0
    buffer_load_dwordx4 v2, s[32:35], s40 offen offset:0 lds
    s_add_u32 m0, s44, 41984
    s_nop 0
    buffer_load_dwordx4 v7, s[36:39], s41 offen offset:0 lds
    buffer_load_dwordx4 v8, s[36:39], s41 offen offset:1024 lds
    s_add_u32 m0, s43, 41984
    s_nop 0
    buffer_load_dwordx4 v3, s[32:35], s40 offen offset:1024 lds
    s_add_u32 m0, s44, 50176
    s_nop 0
    buffer_load_dwordx4 v9, s[36:39], s41 offen offset:0 lds
    buffer_load_dwordx4 v10, s[36:39], s41 offen offset:1024 lds
    s_add_u32 m0, s43, 41984
    s_nop 0
    buffer_load_dwordx4 v4, s[32:35], s40 offen offset:2048 lds
    s_add_u32 m0, s44, 58368
    s_nop 0
    buffer_load_dwordx4 v11, s[36:39], s41 offen offset:0 lds
    buffer_load_dwordx4 v12, s[36:39], s41 offen offset:1024 lds
    s_add_u32 m0, s43, 41984
    s_nop 0
    buffer_load_dwordx4 v5, s[32:35], s40 offen offset:3072 lds
    s_mov_b32 m0, 58368
    s_mov_b64 exec, s[46:47]
    buffer_load_dwordx4 v6, s[32:35], s40 offen lds
    s_mov_b64 exec, -1
    s_movk_i32 s40, 1024
    s_mov_b32 s41, 3145728
    s_cmp_lg_u32 s87, 3
    s_cbranch_scc1 L_stg_15
    s_add_u32 s6, s89, 3932160
    s_mov_b32 exec_lo, 0x770077
    s_mov_b32 exec_hi, 0x770077
    s_bfe_u32 s7, s89, 0x30007
    s_cmp_lg_u32 s7, 1
    s_cbranch_scc1 L_wx3_16
    buffer_load_dword v250, v252, s[36:39], s6 offen offset:256
L_wx3_16:
    buffer_load_dword v250, v252, s[36:39], s6 offen
    s_mov_b32 exec_lo, 0xf0f0f0f
    s_mov_b32 exec_hi, 0
    buffer_load_dword v250, v251, s[32:35], s88 offen offset:1280
    s_mov_b64 exec, -1
L_stg_15:
    s_bfe_u32 s74, s2, 0x20003
    s_lshl2_add_u32 s74, s74, s70
    s_cmp_lg_u32 s74, 4
    s_cbranch_scc1 L_sig_17
    s_mov_b32 s60, s28
    s_mov_b32 s61, s29
    s_mov_b32 s62, 0x100
    s_mov_b32 s63, 0x20000
    s_and_b32 s74, s2, 3
    s_lshl_b32 s74, s74, 6
    s_mov_b64 exec, 1
    buffer_atomic_add v244, off, s[60:63], s74 sc1
    s_mov_b64 exec, -1
L_sig_17:
    s_load_dwordx2 s[90:91], s[16:17], s84 offset:1596
    s_load_dwordx2 s[90:91], s[16:17], s84 offset:1724
    s_load_dwordx2 s[90:91], s[16:17], s84 offset:1852
    s_waitcnt vmcnt(13)
    s_bitcmp1_b32 8, s87
    s_cbranch_scc1 L_mw_18
    s_waitcnt vmcnt(11)
L_mw_18:
    s_barrier
    s_add_u32 m0, s43, 83968
    s_nop 0
    buffer_load_dwordx4 v2, s[32:35], s40 offen offset:0 lds
    s_add_u32 m0, s44, 83968
    s_nop 0
    buffer_load_dwordx4 v7, s[36:39], s41 offen offset:0 lds
    buffer_load_dwordx4 v8, s[36:39], s41 offen offset:1024 lds
    s_add_u32 m0, s43, 83968
    s_nop 0
    buffer_load_dwordx4 v3, s[32:35], s40 offen offset:1024 lds
    s_add_u32 m0, s44, 92160
    s_nop 0
    buffer_load_dwordx4 v9, s[36:39], s41 offen offset:0 lds
    buffer_load_dwordx4 v10, s[36:39], s41 offen offset:1024 lds
    s_add_u32 m0, s43, 83968
    s_nop 0
    buffer_load_dwordx4 v4, s[32:35], s40 offen offset:2048 lds
    s_add_u32 m0, s44, 100352
    s_nop 0
    buffer_load_dwordx4 v11, s[36:39], s41 offen offset:0 lds
    buffer_load_dwordx4 v12, s[36:39], s41 offen offset:1024 lds
    s_add_u32 m0, s43, 83968
    s_nop 0
    buffer_load_dwordx4 v5, s[32:35], s40 offen offset:3072 lds
    s_mov_b32 m0, 100352
    s_mov_b64 exec, s[46:47]
    buffer_load_dwordx4 v6, s[32:35], s40 offen lds
    s_mov_b64 exec, -1
    s_movk_i32 s40, 1152
    s_mov_b32 s41, 3538944
    s_bfe_u32 s74, s2, 0x20003
    s_lshl2_add_u32 s74, s74, s70
    s_cmp_lg_u32 s74, 8
    s_cbranch_scc1 L_sig_19
    s_mov_b32 s60, s28
    s_mov_b32 s61, s29
    s_mov_b32 s62, 0x100
    s_mov_b32 s63, 0x20000
    s_and_b32 s74, s2, 3
    s_lshl_b32 s74, s74, 6
    s_mov_b64 exec, 1
    buffer_atomic_add v244, off, s[60:63], s74 sc1
    s_mov_b64 exec, -1
L_sig_19:
    s_load_dwordx2 s[90:91], s[16:17], s84 offset:1980
    s_load_dwordx2 s[90:91], s[16:17], s84 offset:2108
    s_load_dwordx2 s[90:91], s[16:17], s84 offset:2236
    s_waitcnt vmcnt(13)
    s_bitcmp1_b32 8, s87
    s_cbranch_scc1 L_mw_20
    s_waitcnt vmcnt(11)
L_mw_20:
    s_barrier
    s_add_u32 m0, s43, 0
    s_nop 0
    buffer_load_dwordx4 v2, s[32:35], s40 offen offset:0 lds
    s_add_u32 m0, s44, 0
    s_nop 0
    buffer_load_dwordx4 v7, s[36:39], s41 offen offset:0 lds
    buffer_load_dwordx4 v8, s[36:39], s41 offen offset:1024 lds
    s_add_u32 m0, s43, 0
    s_nop 0
    buffer_load_dwordx4 v3, s[32:35], s40 offen offset:1024 lds
    s_add_u32 m0, s44, 8192
    s_nop 0
    buffer_load_dwordx4 v9, s[36:39], s41 offen offset:0 lds
    buffer_load_dwordx4 v10, s[36:39], s41 offen offset:1024 lds
    s_add_u32 m0, s43, 0
    s_nop 0
    buffer_load_dwordx4 v4, s[32:35], s40 offen offset:2048 lds
    s_add_u32 m0, s44, 16384
    s_nop 0
    buffer_load_dwordx4 v11, s[36:39], s41 offen offset:0 lds
    buffer_load_dwordx4 v12, s[36:39], s41 offen offset:1024 lds
    s_add_u32 m0, s43, 0
    s_nop 0
    buffer_load_dwordx4 v5, s[32:35], s40 offen offset:3072 lds
    s_mov_b32 m0, 16384
    s_mov_b64 exec, s[46:47]
    buffer_load_dwordx4 v6, s[32:35], s40 offen lds
    s_mov_b64 exec, -1
    s_movk_i32 s40, 1280
    s_mov_b32 s41, 3932160
    s_cmp_lg_u32 s87, 0
    s_cbranch_scc1 L_stg_21
    s_add_u32 s6, s89, 4718592
    s_mov_b32 exec_lo, 0x770077
    s_mov_b32 exec_hi, 0x770077
    s_bfe_u32 s7, s89, 0x30007
    s_cmp_lg_u32 s7, 1
    s_cbranch_scc1 L_wx3_22
    buffer_load_dword v250, v252, s[36:39], s6 offen offset:256
L_wx3_22:
    buffer_load_dword v250, v252, s[36:39], s6 offen
    s_mov_b32 exec_lo, 0xf0f0f0f
    s_mov_b32 exec_hi, 0
    buffer_load_dword v250, v251, s[32:35], s88 offen offset:1536
    s_mov_b64 exec, -1
L_stg_21:
    s_bfe_u32 s74, s2, 0x20003
    s_lshl2_add_u32 s74, s74, s70
    s_cmp_lg_u32 s74, 12
    s_cbranch_scc1 L_sig_23
    s_mov_b32 s60, s28
    s_mov_b32 s61, s29
    s_mov_b32 s62, 0x100
    s_mov_b32 s63, 0x20000
    s_and_b32 s74, s2, 3
    s_lshl_b32 s74, s74, 6
    s_mov_b64 exec, 1
    buffer_atomic_add v244, off, s[60:63], s74 sc1
    s_mov_b64 exec, -1
L_sig_23:
    s_load_dwordx2 s[90:91], s[16:17], s84 offset:2364
    s_load_dwordx2 s[90:91], s[16:17], s84 offset:2492
    s_load_dwordx2 s[90:91], s[16:17], s84 offset:2620
    s_waitcnt vmcnt(13)
    s_bitcmp1_b32 1, s87
    s_cbranch_scc1 L_mw_24
    s_waitcnt vmcnt(11)
L_mw_24:
    s_barrier
    s_add_u32 m0, s43, 41984
    s_nop 0
    buffer_load_dwordx4 v2, s[32:35], s40 offen offset:0 lds
    s_add_u32 m0, s44, 41984
    s_nop 0
    buffer_load_dwordx4 v7, s[36:39], s41 offen offset:0 lds
    buffer_load_dwordx4 v8, s[36:39], s41 offen offset:1024 lds
    s_add_u32 m0, s43, 41984
    s_nop 0
    buffer_load_dwordx4 v3, s[32:35], s40 offen offset:1024 lds
    s_add_u32 m0, s44, 50176
    s_nop 0
    buffer_load_dwordx4 v9, s[36:39], s41 offen offset:0 lds
    buffer_load_dwordx4 v10, s[36:39], s41 offen offset:1024 lds
    s_add_u32 m0, s43, 41984
    s_nop 0
    buffer_load_dwordx4 v4, s[32:35], s40 offen offset:2048 lds
    s_add_u32 m0, s44, 58368
    s_nop 0
    buffer_load_dwordx4 v11, s[36:39], s41 offen offset:0 lds
    buffer_load_dwordx4 v12, s[36:39], s41 offen offset:1024 lds
    s_add_u32 m0, s43, 41984
    s_nop 0
    buffer_load_dwordx4 v5, s[32:35], s40 offen offset:3072 lds
    s_mov_b32 m0, 58368
    s_mov_b64 exec, s[46:47]
    buffer_load_dwordx4 v6, s[32:35], s40 offen lds
    s_mov_b64 exec, -1
    s_movk_i32 s40, 1408
    s_mov_b32 s41, 4325376
    s_load_dwordx2 s[90:91], s[16:17], s84 offset:2748
    s_load_dwordx2 s[90:91], s[16:17], s84 offset:2876
    s_load_dwordx2 s[90:91], s[16:17], s84 offset:3004
    s_waitcnt vmcnt(13)
    s_bitcmp1_b32 1, s87
    s_cbranch_scc1 L_mw_25
    s_waitcnt vmcnt(11)
L_mw_25:
    s_barrier
    s_add_u32 m0, s43, 83968
    s_nop 0
    buffer_load_dwordx4 v2, s[32:35], s40 offen offset:0 lds
    s_add_u32 m0, s44, 83968
    s_nop 0
    buffer_load_dwordx4 v7, s[36:39], s41 offen offset:0 lds
    buffer_load_dwordx4 v8, s[36:39], s41 offen offset:1024 lds
    s_add_u32 m0, s43, 83968
    s_nop 0
    buffer_load_dwordx4 v3, s[32:35], s40 offen offset:1024 lds
    s_add_u32 m0, s44, 92160
    s_nop 0
    buffer_load_dwordx4 v9, s[36:39], s41 offen offset:0 lds
    buffer_load_dwordx4 v10, s[36:39], s41 offen offset:1024 lds
    s_add_u32 m0, s43, 83968
    s_nop 0
    buffer_load_dwordx4 v4, s[32:35], s40 offen offset:2048 lds
    s_add_u32 m0, s44, 100352
    s_nop 0
    buffer_load_dwordx4 v11, s[36:39], s41 offen offset:0 lds
    buffer_load_dwordx4 v12, s[36:39], s41 offen offset:1024 lds
    s_add_u32 m0, s43, 83968
    s_nop 0
    buffer_load_dwordx4 v5, s[32:35], s40 offen offset:3072 lds
    s_mov_b32 m0, 100352
    s_mov_b64 exec, s[46:47]
    buffer_load_dwordx4 v6, s[32:35], s40 offen lds
    s_mov_b64 exec, -1
    s_movk_i32 s40, 1536
    s_mov_b32 s41, 4718592
    s_cmp_lg_u32 s87, 1
    s_cbranch_scc1 L_stg_26
    s_add_u32 s6, s89, 5505024
    s_mov_b32 exec_lo, 0x770077
    s_mov_b32 exec_hi, 0x770077
    s_bfe_u32 s7, s89, 0x30007
    s_cmp_lg_u32 s7, 1
    s_cbranch_scc1 L_wx3_27
    buffer_load_dword v250, v252, s[36:39], s6 offen offset:256
L_wx3_27:
    buffer_load_dword v250, v252, s[36:39], s6 offen
    s_mov_b32 exec_lo, 0xf0f0f0f
    s_mov_b32 exec_hi, 0
    buffer_load_dword v250, v251, s[32:35], s88 offen offset:1792
    s_mov_b64 exec, -1
L_stg_26:
    s_load_dwordx2 s[90:91], s[16:17], s84 offset:3132
    s_load_dwordx2 s[90:91], s[16:17], s84 offset:3260
    s_load_dwordx2 s[90:91], s[16:17], s84 offset:3388
    s_waitcnt vmcnt(13)
    s_bitcmp1_b32 2, s87
    s_cbranch_scc1 L_mw_28
    s_waitcnt vmcnt(11)
L_mw_28:
    s_barrier
    s_add_u32 m0, s43, 0
    s_nop 0
    buffer_load_dwordx4 v2, s[32:35], s40 offen offset:0 lds
    s_add_u32 m0, s44, 0
    s_nop 0
    buffer_load_dwordx4 v7, s[36:39], s41 offen offset:0 lds
    buffer_load_dwordx4 v8, s[36:39], s41 offen offset:1024 lds
    s_add_u32 m0, s43, 0
    s_nop 0
    buffer_load_dwordx4 v3, s[32:35], s40 offen offset:1024 lds
    s_add_u32 m0, s44, 8192
    s_nop 0
    buffer_load_dwordx4 v9, s[36:39], s41 offen offset:0 lds
    buffer_load_dwordx4 v10, s[36:39], s41 offen offset:1024 lds
    s_add_u32 m0, s43, 0
    s_nop 0
    buffer_load_dwordx4 v4, s[32:35], s40 offen offset:2048 lds
    s_add_u32 m0, s44, 16384
    s_nop 0
    buffer_load_dwordx4 v11, s[36:39], s41 offen offset:0 lds
    buffer_load_dwordx4 v12, s[36:39], s41 offen offset:1024 lds
    s_add_u32 m0, s43, 0
    s_nop 0
    buffer_load_dwordx4 v5, s[32:35], s40 offen offset:3072 lds
    s_mov_b32 m0, 16384
    s_mov_b64 exec, s[46:47]
    buffer_load_dwordx4 v6, s[32:35], s40 offen lds
    s_mov_b64 exec, -1
    s_movk_i32 s40, 1664
    s_mov_b32 s41, 5111808
    s_load_dwordx2 s[90:91], s[16:17], s84 offset:3516
    s_load_dwordx2 s[90:91], s[16:17], s84 offset:3644
    s_load_dwordx2 s[90:91], s[16:17], s84 offset:3772
    s_waitcnt vmcnt(13)
    s_bitcmp1_b32 2, s87
    s_cbranch_scc1 L_mw_29
    s_waitcnt vmcnt(11)
L_mw_29:
    s_barrier
    s_add_u32 m0, s43, 41984
    s_nop 0
    buffer_load_dwordx4 v2, s[32:35], s40 offen offset:0 lds
    s_add_u32 m0, s44, 41984
    s_nop 0
    buffer_load_dwordx4 v7, s[36:39], s41 offen offset:0 lds
    buffer_load_dwordx4 v8, s[36:39], s41 offen offset:1024 lds
    s_add_u32 m0, s43, 41984
    s_nop 0
    buffer_load_dwordx4 v3, s[32:35], s40 offen offset:1024 lds
    s_add_u32 m0, s44, 50176
    s_nop 0
    buffer_load_dwordx4 v9, s[36:39], s41 offen offset:0 lds
    buffer_load_dwordx4 v10, s[36:39], s41 offen offset:1024 lds
    s_add_u32 m0, s43, 41984
    s_nop 0
    buffer_load_dwordx4 v4, s[32:35], s40 offen offset:2048 lds
    s_add_u32 m0, s44, 58368
    s_nop 0
    buffer_load_dwordx4 v11, s[36:39], s41 offen offset:0 lds
    buffer_load_dwordx4 v12, s[36:39], s41 offen offset:1024 lds
    s_add_u32 m0, s43, 41984
    s_nop 0
    buffer_load_dwordx4 v5, s[32:35], s40 offen offset:3072 lds
    s_mov_b32 m0, 58368
    s_mov_b64 exec, s[46:47]
    buffer_load_dwordx4 v6, s[32:35], s40 offen lds
    s_mov_b64 exec, -1
    s_movk_i32 s40, 1792
    s_mov_b32 s41, 5505024
    s_load_dwordx2 s[90:91], s[16:17], s84 offset:3900
    s_load_dwordx2 s[90:91], s[16:17], s84 offset:4028
    s_waitcnt vmcnt(11)
    s_barrier
    s_add_u32 m0, s43, 83968
    s_nop 0
    buffer_load_dwordx4 v2, s[32:35], s40 offen offset:0 lds
    s_add_u32 m0, s44, 83968
    s_nop 0
    buffer_load_dwordx4 v7, s[36:39], s41 offen offset:0 lds
    buffer_load_dwordx4 v8, s[36:39], s41 offen offset:1024 lds
    s_add_u32 m0, s43, 83968
    s_nop 0
    buffer_load_dwordx4 v3, s[32:35], s40 offen offset:1024 lds
    s_add_u32 m0, s44, 92160
    s_nop 0
    buffer_load_dwordx4 v9, s[36:39], s41 offen offset:0 lds
    buffer_load_dwordx4 v10, s[36:39], s41 offen offset:1024 lds
    s_add_u32 m0, s43, 83968
    s_nop 0
    buffer_load_dwordx4 v4, s[32:35], s40 offen offset:2048 lds
    s_add_u32 m0, s44, 100352
    s_nop 0
    buffer_load_dwordx4 v11, s[36:39], s41 offen offset:0 lds
    buffer_load_dwordx4 v12, s[36:39], s41 offen offset:1024 lds
    s_add_u32 m0, s43, 83968
    s_nop 0
    buffer_load_dwordx4 v5, s[32:35], s40 offen offset:3072 lds
    s_mov_b32 m0, 100352
    s_mov_b64 exec, s[46:47]
    buffer_load_dwordx4 v6, s[32:35], s40 offen lds
    s_mov_b64 exec, -1
    s_movk_i32 s40, 1920
    s_mov_b32 s41, 5898240
    s_waitcnt vmcnt(11)
    s_barrier
    s_load_dword s4, s[28:29], 0
    s_load_dword s5, s[28:29], 64
    s_load_dword s6, s[28:29], 128
    s_load_dword s7, s[28:29], 192
    s_add_u32 m0, s43, 0
    s_nop 0
    buffer_load_dwordx4 v2, s[32:35], s40 offen offset:0 lds
    s_add_u32 m0, s44, 0
    s_nop 0
    buffer_load_dwordx4 v7, s[36:39], s41 offen offset:0 lds
    buffer_load_dwordx4 v8, s[36:39], s41 offen offset:1024 lds
    s_add_u32 m0, s43, 0
    s_nop 0
    buffer_load_dwordx4 v3, s[32:35], s40 offen offset:1024 lds
    s_add_u32 m0, s44, 8192
    s_nop 0
    buffer_load_dwordx4 v9, s[36:39], s41 offen offset:0 lds
    buffer_load_dwordx4 v10, s[36:39], s41 offen offset:1024 lds
    s_add_u32 m0, s43, 0
    s_nop 0
    buffer_load_dwordx4 v4, s[32:35], s40 offen offset:2048 lds
    s_add_u32 m0, s44, 16384
    s_nop 0
    buffer_load_dwordx4 v11, s[36:39], s41 offen offset:0 lds
    buffer_load_dwordx4 v12, s[36:39], s41 offen offset:1024 lds
    s_add_u32 m0, s43, 0
    s_nop 0
    buffer_load_dwordx4 v5, s[32:35], s40 offen offset:3072 lds
    s_mov_b32 m0, 16384
    s_mov_b64 exec, s[46:47]
    buffer_load_dwordx4 v6, s[32:35], s40 offen lds
    s_mov_b64 exec, -1
    s_movk_i32 s40, 2048
    s_mov_b32 s41, 6291456
    s_mov_b32 s60, s8
    s_mov_b32 s61, s9
    s_mov_b32 s62, 0x400000
    s_mov_b32 s63, 0x20000
    s_movk_i32 s75, 8192
    buffer_load_dwordx4 v[208:211], v225, s[60:63], 0 offen offset:0 nt
    buffer_load_dwordx4 v[212:215], v225, s[60:63], 0 offen offset:2048 nt
    buffer_load_dwordx4 v[216:219], v225, s[60:63], s75 offen offset:0 nt
    buffer_load_dwordx4 v[220:223], v225, s[60:63], s75 offen offset:2048 nt
    s_cmp_lg_u32 s70, 0
    s_cbranch_scc1 L_pc_done_32
    s_waitcnt lgkmcnt(0)
    s_min_u32 s4, s4, s5
    s_min_u32 s6, s6, s7
    s_min_u32 s4, s4, s6
    s_cmp_ge_u32 s4, 64
    s_cbranch_scc1 L_pc_done_32
    s_mov_b32 s60, s28
    s_mov_b32 s61, s29
    s_mov_b32 s62, 0x100
    s_mov_b32 s63, 0x20000
    v_lshlrev_b32 v20, 6, v0
    s_mov_b32 s74, 131072
    s_mov_b64 exec, 0xf
L_pc_loop_33:
    buffer_load_dword v21, v20, s[60:63], 0 offen sc1
    s_waitcnt vmcnt(0)
    v_cmp_gt_u32 vcc, 64, v21
    s_cbranch_vccz L_pc_done_32
    s_sleep 4
    s_sub_u32 s74, s74, 1
    s_cbranch_scc0 L_pc_loop_33
L_pc_done_32:
    s_mov_b64 exec, -1
    s_waitcnt vmcnt(15)
    s_barrier
    s_waitcnt vmcnt(4)
    s_mov_b64 exec, 1
    ds_add_u32 v227, v244 offset:24
    s_mov_b64 exec, -1
    s_add_u32 s56, s30, s85
    s_addc_u32 s57, s31, 0
    s_movk_i32 s58, 4096
    s_mov_b32 s59, 0x20000
    s_add_u32 m0, s81, 0
    s_nop 0
    buffer_load_dwordx4 v224, s[56:59], 0 offen offset:0 sc1 lds
    buffer_load_dwordx4 v224, s[56:59], 0 offen offset:1024 sc1 lds
    buffer_load_dwordx4 v224, s[56:59], 0 offen offset:2048 sc1 lds
    buffer_load_dwordx4 v224, s[56:59], 0 offen offset:3072 sc1 lds
    s_add_u32 m0, s81, 4572
    s_nop 0
    buffer_load_dwordx4 v224, s[56:59], 0 offen offset:0 sc1 lds
    buffer_load_dwordx4 v224, s[56:59], 0 offen offset:1024 sc1 lds
    buffer_load_dwordx4 v224, s[56:59], 0 offen offset:2048 sc1 lds
    buffer_load_dwordx4 v224, s[56:59], 0 offen offset:3072 sc1 lds
    s_add_u32 s56, s16, s84
    s_addc_u32 s57, s17, 0
    s_movk_i32 s58, 4096
    s_mov_b32 s59, 0x20000
    s_add_u32 m0, s80, 64
    v_mov_b32 v180, 0
    v_mov_b32 v181, 0
    v_mov_b32 v182, 0
    v_mov_b32 v183, 0
    buffer_load_dwordx4 v224, s[56:59], 0 offen offset:0 lds
    buffer_load_dwordx4 v224, s[56:59], 0 offen offset:1024 lds
    buffer_load_dwordx4 v224, s[56:59], 0 offen offset:2048 lds
    buffer_load_dwordx4 v224, s[56:59], 0 offen offset:3072 lds
    s_add_u32 m0, s80, 4304
    s_mov_b64 exec, 0x100
    buffer_load_dwordx4 v[180:183], off, s[56:59], 0
    s_mov_b64 exec, -1
    buffer_load_dwordx4 v224, s[56:59], 14 offen offset:0 lds
    buffer_load_dwordx4 v224, s[56:59], 14 offen offset:1024 lds
    buffer_load_dwordx4 v224, s[56:59], 14 offen offset:2048 lds
    buffer_load_dwordx4 v224, s[56:59], 14 offen offset:3072 lds
    v_lshrrev_b32 v234, 5, v0
    v_mul_u32_u24 v234, 4064, v234
    v_add3_u32 v234, v234, v224, s81
    s_mov_b32 exec_lo, 0xfffffff
    s_mov_b32 exec_hi, 0xfffffff
    ds_write_b128 v234, v[228:231] offset:4096
    s_mov_b64 exec, 1
    ds_write_b32 v234, v228 offset:8668
    s_mov_b64 exec, -1
    s_setprio 3
    s_waitcnt vmcnt(9)
    s_mov_b32 s60, s24
    s_mov_b32 s61, s25
    s_mov_b32 s62, 0x200000
    s_mov_b32 s63, 0x20000
    s_lshr_b32 s74, s2, 3
    s_lshl2_add_u32 s74, s74, s70
    s_bfe_u32 s75, s2, 0x10002
    s_lshl4_add_u32 s74, s74, s75
    s_lshl_b32 s74, s74, 10
    v_lshrrev_b32 v234, 3, v0
    v_and_b32 v235, 7, v0
    v_lshlrev_b32 v235, 7, v235
    v_lshl_add_u32 v234, v234, 11, v235
    buffer_load_dword v250, v234, s[60:63], s74 offen
    s_waitcnt vmcnt(1)
    v_cmp_lt_u32 vcc, 3, v0
    v_mov_b32 v188, 4160
    v_lshlrev_b32 v184, 16, v180
    v_cndmask_b32 v188, 0, v188, vcc
    v_alignbit_b32 v185, v181, v180, 16
    v_alignbit_b32 v186, v182, v181, 16
    v_alignbit_b32 v187, v183, v182, 16
    v_add3_u32 v188, v188, v224, s80
    s_mov_b64 exec, 0x1ff
    ds_write_b128 v188, v[184:187]
    s_mov_b64 exec, -1
    ds_read_b128 v[112:115], v233 offset:3584
    ds_read_b128 v[116:119], v233 offset:3072
    ds_read_b128 v[120:123], v233 offset:2560
    ds_read_b128 v[124:127], v233 offset:2048
    ds_read_b128 v[128:131], v233 offset:1536
    ds_read_b128 v[132:135], v233 offset:1024
    ds_read_b128 v[136:139], v233 offset:512
    ds_read_b128 v[140:143], v233 offset:0
    ds_read_b64 v[48:49], v232 offset:0
    ds_read_b64 v[50:51], v232 offset:8
    ds_read_b64 v[52:53], v232 offset:512
    ds_read_b64 v[54:55], v232 offset:520
    ds_read_b64 v[56:57], v232 offset:1024
    ds_read_b64 v[58:59], v232 offset:1032
    ds_read_b64 v[60:61], v232 offset:1536
    ds_read_b64 v[62:63], v232 offset:1544
    ds_read_b64 v[64:65], v232 offset:2048
    ds_read_b64 v[66:67], v232 offset:2056
    ds_read_b64 v[68:69], v232 offset:2560
    ds_read_b64 v[70:71], v232 offset:2568
    ds_read_b64 v[72:73], v232 offset:3072
    ds_read_b64 v[74:75], v232 offset:3080
    ds_read_b64 v[76:77], v232 offset:3584
    ds_read_b64 v[78:79], v232 offset:3592
    s_setprio 1
    s_mov_b32 s74, 3
    s_waitcnt lgkmcnt(14)
    v_mfma_f32_16x16x32_bf16 v[16:19], v[240:243], v[112:115], 0
    v_mfma_f32_16x16x32_bf16 v[20:23], v[240:243], v[116:119], 0
    v_mfma_f32_16x16x32_bf16 v[24:27], v[240:243], v[120:123], 0
    v_mfma_f32_16x16x32_bf16 v[28:31], v[240:243], v[124:127], 0
    v_mfma_f32_16x16x32_bf16 v[32:35], v[240:243], v[128:131], 0
    v_mfma_f32_16x16x32_bf16 v[36:39], v[240:243], v[132:135], 0
    v_mfma_f32_16x16x32_bf16 v[40:43], v[240:243], v[136:139], 0
    v_mfma_f32_16x16x32_bf16 v[44:47], v[240:243], v[140:143], 0
    s_waitcnt lgkmcnt(0)
L_conv:
    v_mfma_f32_16x16x32_bf16 v[16:19], v[48:51], v[112:115], v[16:19]
    ds_read_b128 v[144:147], v233 offset:3648
    v_mfma_f32_16x16x32_bf16 v[20:23], v[48:51], v[116:119], v[20:23]
    ds_read_b64 v[80:81], v232 offset:64
    v_mfma_f32_16x16x32_bf16 v[20:23], v[52:55], v[112:115], v[20:23]
    ds_read_b64 v[82:83], v232 offset:72
    v_mfma_f32_16x16x32_bf16 v[24:27], v[48:51], v[120:123], v[24:27]
    ds_read_b128 v[148:151], v233 offset:3136
    v_mfma_f32_16x16x32_bf16 v[24:27], v[52:55], v[116:119], v[24:27]
    ds_read_b64 v[84:85], v232 offset:576
    v_mfma_f32_16x16x32_bf16 v[24:27], v[56:59], v[112:115], v[24:27]
    ds_read_b64 v[86:87], v232 offset:584
    v_mfma_f32_16x16x32_bf16 v[28:31], v[48:51], v[124:127], v[28:31]
    ds_read_b128 v[152:155], v233 offset:2624
    v_mfma_f32_16x16x32_bf16 v[28:31], v[52:55], v[120:123], v[28:31]
    ds_read_b64 v[88:89], v232 offset:1088
    v_mfma_f32_16x16x32_bf16 v[28:31], v[56:59], v[116:119], v[28:31]
    ds_read_b64 v[90:91], v232 offset:1096
    v_mfma_f32_16x16x32_bf16 v[28:31], v[60:63], v[112:115], v[28:31]
    ds_read_b128 v[156:159], v233 offset:2112
    v_mfma_f32_16x16x32_bf16 v[32:35], v[48:51], v[128:131], v[32:35]
    ds_read_b64 v[92:93], v232 offset:1600
    v_mfma_f32_16x16x32_bf16 v[32:35], v[52:55], v[124:127], v[32:35]
    ds_read_b64 v[94:95], v232 offset:1608
    v_mfma_f32_16x16x32_bf16 v[32:35], v[56:59], v[120:123], v[32:35]
    ds_read_b128 v[160:163], v233 offset:1600
    v_mfma_f32_16x16x32_bf16 v[32:35], v[60:63], v[116:119], v[32:35]
    ds_read_b64 v[96:97], v232 offset:2112
    v_mfma_f32_16x16x32_bf16 v[32:35], v[64:67], v[112:115], v[32:35]
    ds_read_b64 v[98:99], v232 offset:2120
    v_mfma_f32_16x16x32_bf16 v[36:39], v[48:51], v[132:135], v[36:39]
    ds_read_b128 v[164:167], v233 offset:1088
    v_mfma_f32_16x16x32_bf16 v[36:39], v[52:55], v[128:131], v[36:39]
    ds_read_b64 v[100:101], v232 offset:2624
    v_mfma_f32_16x16x32_bf16 v[36:39], v[56:59], v[124:127], v[36:39]
    ds_read_b64 v[102:103], v232 offset:2632
    v_mfma_f32_16x16x32_bf16 v[36:39], v[60:63], v[120:123], v[36:39]
    ds_read_b128 v[168:171], v233 offset:576
    v_mfma_f32_16x16x32_bf16 v[36:39], v[64:67], v[116:119], v[36:39]
    ds_read_b64 v[104:105], v232 offset:3136
    v_mfma_f32_16x16x32_bf16 v[36:39], v[68:71], v[112:115], v[36:39]
    ds_read_b64 v[106:107], v232 offset:3144
    v_mfma_f32_16x16x32_bf16 v[40:43], v[48:51], v[136:139], v[40:43]
    ds_read_b128 v[172:175], v233 offset:64
    v_mfma_f32_16x16x32_bf16 v[40:43], v[52:55], v[132:135], v[40:43]
    ds_read_b64 v[108:109], v232 offset:3648
    v_mfma_f32_16x16x32_bf16 v[40:43], v[56:59], v[128:131], v[40:43]
    ds_read_b64 v[110:111], v232 offset:3656
    v_mfma_f32_16x16x32_bf16 v[40:43], v[60:63], v[124:127], v[40:43]
    v_mfma_f32_16x16x32_bf16 v[40:43], v[64:67], v[120:123], v[40:43]
    v_mfma_f32_16x16x32_bf16 v[40:43], v[68:71], v[116:119], v[40:43]
    v_mfma_f32_16x16x32_bf16 v[40:43], v[72:75], v[112:115], v[40:43]
    v_mfma_f32_16x16x32_bf16 v[44:47], v[48:51], v[140:143], v[44:47]
    v_mfma_f32_16x16x32_bf16 v[44:47], v[52:55], v[136:139], v[44:47]
    v_mfma_f32_16x16x32_bf16 v[44:47], v[56:59], v[132:135], v[44:47]
    v_mfma_f32_16x16x32_bf16 v[44:47], v[60:63], v[128:131], v[44:47]
    v_mfma_f32_16x16x32_bf16 v[44:47], v[64:67], v[124:127], v[44:47]
    v_mfma_f32_16x16x32_bf16 v[44:47], v[68:71], v[120:123], v[44:47]
    v_mfma_f32_16x16x32_bf16 v[44:47], v[72:75], v[116:119], v[44:47]
    v_mfma_f32_16x16x32_bf16 v[44:47], v[76:79], v[112:115], v[44:47]
    s_waitcnt lgkmcnt(0)
    v_mfma_f32_16x16x32_bf16 v[16:19], v[80:83], v[144:147], v[16:19]
    ds_read_b128 v[112:115], v233 offset:3712
    v_mfma_f32_16x16x32_bf16 v[20:23], v[80:83], v[148:151], v[20:23]
    ds_read_b64 v[48:49], v232 offset:128
    v_mfma_f32_16x16x32_bf16 v[20:23], v[84:87], v[144:147], v[20:23]
    ds_read_b64 v[50:51], v232 offset:136
    v_mfma_f32_16x16x32_bf16 v[24:27], v[80:83], v[152:155], v[24:27]
    ds_read_b128 v[116:119], v233 offset:3200
    v_mfma_f32_16x16x32_bf16 v[24:27], v[84:87], v[148:151], v[24:27]
    ds_read_b64 v[52:53], v232 offset:640
    v_mfma_f32_16x16x32_bf16 v[24:27], v[88:91], v[144:147], v[24:27]
    ds_read_b64 v[54:55], v232 offset:648
    v_mfma_f32_16x16x32_bf16 v[28:31], v[80:83], v[156:159], v[28:31]
    ds_read_b128 v[120:123], v233 offset:2688
    v_mfma_f32_16x16x32_bf16 v[28:31], v[84:87], v[152:155], v[28:31]
    ds_read_b64 v[56:57], v232 offset:1152
    v_mfma_f32_16x16x32_bf16 v[28:31], v[88:91], v[148:151], v[28:31]
    ds_read_b64 v[58:59], v232 offset:1160
    v_mfma_f32_16x16x32_bf16 v[28:31], v[92:95], v[144:147], v[28:31]
    ds_read_b128 v[124:127], v233 offset:2176
    v_mfma_f32_16x16x32_bf16 v[32:35], v[80:83], v[160:163], v[32:35]
    ds_read_b64 v[60:61], v232 offset:1664
    v_mfma_f32_16x16x32_bf16 v[32:35], v[84:87], v[156:159], v[32:35]
    ds_read_b64 v[62:63], v232 offset:1672
    v_mfma_f32_16x16x32_bf16 v[32:35], v[88:91], v[152:155], v[32:35]
    ds_read_b128 v[128:131], v233 offset:1664
    v_mfma_f32_16x16x32_bf16 v[32:35], v[92:95], v[148:151], v[32:35]
    ds_read_b64 v[64:65], v232 offset:2176
    v_mfma_f32_16x16x32_bf16 v[32:35], v[96:99], v[144:147], v[32:35]
    ds_read_b64 v[66:67], v232 offset:2184
    v_mfma_f32_16x16x32_bf16 v[36:39], v[80:83], v[164:167], v[36:39]
    ds_read_b128 v[132:135], v233 offset:1152
    v_mfma_f32_16x16x32_bf16 v[36:39], v[84:87], v[160:163], v[36:39]
    ds_read_b64 v[68:69], v232 offset:2688
    v_mfma_f32_16x16x32_bf16 v[36:39], v[88:91], v[156:159], v[36:39]
    ds_read_b64 v[70:71], v232 offset:2696
    v_mfma_f32_16x16x32_bf16 v[36:39], v[92:95], v[152:155], v[36:39]
    ds_read_b128 v[136:139], v233 offset:640
    v_mfma_f32_16x16x32_bf16 v[36:39], v[96:99], v[148:151], v[36:39]
    ds_read_b64 v[72:73], v232 offset:3200
    v_mfma_f32_16x16x32_bf16 v[36:39], v[100:103], v[144:147], v[36:39]
    ds_read_b64 v[74:75], v232 offset:3208
    v_mfma_f32_16x16x32_bf16 v[40:43], v[80:83], v[168:171], v[40:43]
    ds_read_b128 v[140:143], v233 offset:128
    v_mfma_f32_16x16x32_bf16 v[40:43], v[84:87], v[164:167], v[40:43]
    ds_read_b64 v[76:77], v232 offset:3712
    v_mfma_f32_16x16x32_bf16 v[40:43], v[88:91], v[160:163], v[40:43]
    ds_read_b64 v[78:79], v232 offset:3720
    v_mfma_f32_16x16x32_bf16 v[40:43], v[92:95], v[156:159], v[40:43]
    v_add_u32 v232, 128, v232
    v_mfma_f32_16x16x32_bf16 v[40:43], v[96:99], v[152:155], v[40:43]
    v_add_u32 v233, 128, v233
    v_mfma_f32_16x16x32_bf16 v[40:43], v[100:103], v[148:151], v[40:43]
    s_sub_u32 s74, s74, 1
    v_mfma_f32_16x16x32_bf16 v[40:43], v[104:107], v[144:147], v[40:43]
    s_cmp_lg_u32 s74, 0
    v_mfma_f32_16x16x32_bf16 v[44:47], v[80:83], v[172:175], v[44:47]
    v_mfma_f32_16x16x32_bf16 v[44:47], v[84:87], v[168:171], v[44:47]
    v_mfma_f32_16x16x32_bf16 v[44:47], v[88:91], v[164:167], v[44:47]
    v_mfma_f32_16x16x32_bf16 v[44:47], v[92:95], v[160:163], v[44:47]
    v_mfma_f32_16x16x32_bf16 v[44:47], v[96:99], v[156:159], v[44:47]
    v_mfma_f32_16x16x32_bf16 v[44:47], v[100:103], v[152:155], v[44:47]
    v_mfma_f32_16x16x32_bf16 v[44:47], v[104:107], v[148:151], v[44:47]
    v_mfma_f32_16x16x32_bf16 v[44:47], v[108:111], v[144:147], v[44:47]
    s_waitcnt lgkmcnt(0)
    s_cbranch_scc1 L_conv
    v_mfma_f32_16x16x32_bf16 v[16:19], v[48:51], v[112:115], v[16:19]
    ds_read_b128 v[144:147], v233 offset:3648
    ds_read_b64 v[80:81], v232 offset:64
    v_mfma_f32_16x16x32_bf16 v[20:23], v[48:51], v[116:119], v[20:23]
    ds_read_b64 v[82:83], v232 offset:72
    ds_read_b128 v[148:151], v233 offset:3136
    v_mfma_f32_16x16x32_bf16 v[20:23], v[52:55], v[112:115], v[20:23]
    ds_read_b64 v[84:85], v232 offset:576
    ds_read_b64 v[86:87], v232 offset:584
    v_mfma_f32_16x16x32_bf16 v[24:27], v[48:51], v[120:123], v[24:27]
    ds_read_b128 v[152:155], v233 offset:2624
    ds_read_b64 v[88:89], v232 offset:1088
    v_mfma_f32_16x16x32_bf16 v[24:27], v[52:55], v[116:119], v[24:27]
    ds_read_b64 v[90:91], v232 offset:1096
    ds_read_b128 v[156:159], v233 offset:2112
    v_mfma_f32_16x16x32_bf16 v[24:27], v[56:59], v[112:115], v[24:27]
    ds_read_b64 v[92:93], v232 offset:1600
    ds_read_b64 v[94:95], v232 offset:1608
    v_mfma_f32_16x16x32_bf16 v[28:31], v[48:51], v[124:127], v[28:31]
    ds_read_b128 v[160:163], v233 offset:1600
    ds_read_b64 v[96:97], v232 offset:2112
    v_mfma_f32_16x16x32_bf16 v[28:31], v[52:55], v[120:123], v[28:31]
    ds_read_b64 v[98:99], v232 offset:2120
    ds_read_b128 v[164:167], v233 offset:1088
    v_mfma_f32_16x16x32_bf16 v[28:31], v[56:59], v[116:119], v[28:31]
    ds_read_b64 v[100:101], v232 offset:2624
    ds_read_b64 v[102:103], v232 offset:2632
    v_mfma_f32_16x16x32_bf16 v[28:31], v[60:63], v[112:115], v[28:31]
    ds_read_b128 v[168:171], v233 offset:576
    ds_read_b64 v[104:105], v232 offset:3136
    v_mfma_f32_16x16x32_bf16 v[32:35], v[48:51], v[128:131], v[32:35]
    ds_read_b64 v[106:107], v232 offset:3144
    ds_read_b128 v[172:175], v233 offset:64
    v_mfma_f32_16x16x32_bf16 v[32:35], v[52:55], v[124:127], v[32:35]
    ds_read_b64 v[108:109], v232 offset:3648
    ds_read_b64 v[110:111], v232 offset:3656
    v_mfma_f32_16x16x32_bf16 v[32:35], v[56:59], v[120:123], v[32:35]
    s_mul_i32 s74, s68, 4224
    s_and_b32 s75, s71, 63
    v_mfma_f32_16x16x32_bf16 v[32:35], v[60:63], v[116:119], v[32:35]
    s_add_u32 s74, s74, s75
    s_lshl_b32 s74, s74, 6
    v_mfma_f32_16x16x32_bf16 v[32:35], v[64:67], v[112:115], v[32:35]
    v_and_b32 v234, 3, v0
    v_lshl_add_u32 v234, v234, 4, s74
    v_mfma_f32_16x16x32_bf16 v[36:39], v[48:51], v[132:135], v[36:39]
    v_and_b32 v235, 12, v0
    v_lshrrev_b32 v236, 4, v0
    v_mfma_f32_16x16x32_bf16 v[36:39], v[52:55], v[128:131], v[36:39]
    v_add_u32 v235, v235, v236
    v_mul_u32_u24 v235, 4224, v235
    v_mfma_f32_16x16x32_bf16 v[36:39], v[56:59], v[124:127], v[36:39]
    v_add_u32 v234, v234, v235
    v_mfma_f32_16x16x32_bf16 v[36:39], v[60:63], v[120:123], v[36:39]
    v_mfma_f32_16x16x32_bf16 v[36:39], v[64:67], v[116:119], v[36:39]
    v_mfma_f32_16x16x32_bf16 v[36:39], v[68:71], v[112:115], v[36:39]
    s_waitcnt lgkmcnt(0)
    s_mov_b64 exec, 1
    ds_add_u32 v227, v244 offset:36
    s_mov_b64 exec, -1
    v_mfma_f32_16x16x32_bf16 v[16:19], v[80:83], v[144:147], v[16:19]
    s_lshl4_add_u32 s73, s68, 256
    s_add_u32 s45, s73, s69
    v_mfma_f32_16x16x32_bf16 v[20:23], v[80:83], v[148:151], v[20:23]
    s_lshl_b32 s73, s73, 8
    s_lshl_b32 s45, s45, 8
    v_mfma_f32_16x16x32_bf16 v[20:23], v[84:87], v[144:147], v[20:23]
    v_mfma_f32_16x16x32_bf16 v[24:27], v[80:83], v[152:155], v[24:27]
    v_mfma_f32_16x16x32_bf16 v[24:27], v[84:87], v[148:151], v[24:27]
    v_mfma_f32_16x16x32_bf16 v[24:27], v[88:91], v[144:147], v[24:27]
    v_mfma_f32_16x16x32_bf16 v[28:31], v[80:83], v[156:159], v[28:31]
    v_cvt_pk_bf16_f32 v176, v16, v17
    v_cvt_pk_bf16_f32 v177, v18, v19
    v_mfma_f32_16x16x32_bf16 v[28:31], v[84:87], v[152:155], v[28:31]
    v_mfma_f32_16x16x32_bf16 v[28:31], v[88:91], v[148:151], v[28:31]
    v_cvt_pk_bf16_f32 v178, v20, v21
    v_cvt_pk_bf16_f32 v179, v22, v23
    v_mfma_f32_16x16x32_bf16 v[28:31], v[92:95], v[144:147], v[28:31]
    s_mov_b32 s76, 0
    buffer_store_dwordx4 v[176:179], v234, s[64:67], s76 offen sc1
    v_mfma_f32_16x16x32_bf16 v[32:35], v[80:83], v[160:163], v[32:35]
    v_cvt_pk_bf16_f32 v180, v24, v25
    v_cvt_pk_bf16_f32 v181, v26, v27
    v_mfma_f32_16x16x32_bf16 v[32:35], v[84:87], v[156:159], v[32:35]
    v_mfma_f32_16x16x32_bf16 v[32:35], v[88:91], v[152:155], v[32:35]
    v_mfma_f32_16x16x32_bf16 v[32:35], v[92:95], v[148:151], v[32:35]
    v_cvt_pk_bf16_f32 v182, v28, v29
    v_cvt_pk_bf16_f32 v183, v30, v31
    v_mfma_f32_16x16x32_bf16 v[32:35], v[96:99], v[144:147], v[32:35]
    s_mov_b32 s76, 67584
    buffer_store_dwordx4 v[180:183], v234, s[64:67], s76 offen sc1
    v_mfma_f32_16x16x32_bf16 v[36:39], v[80:83], v[164:167], v[36:39]
    v_mfma_f32_16x16x32_bf16 v[36:39], v[84:87], v[160:163], v[36:39]
    v_mfma_f32_16x16x32_bf16 v[36:39], v[88:91], v[156:159], v[36:39]
    v_mfma_f32_16x16x32_bf16 v[36:39], v[92:95], v[152:155], v[36:39]
    v_mfma_f32_16x16x32_bf16 v[36:39], v[96:99], v[148:151], v[36:39]
    v_mfma_f32_16x16x32_bf16 v[36:39], v[100:103], v[144:147], v[36:39]
    v_cvt_pk_bf16_f32 v184, v32, v33
    v_cvt_pk_bf16_f32 v185, v34, v35
    v_mfma_f32_16x16x32_bf16 v[40:43], v[48:51], v[136:139], v[40:43]
    v_mfma_f32_16x16x32_bf16 v[40:43], v[52:55], v[132:135], v[40:43]
    v_mfma_f32_16x16x32_bf16 v[40:43], v[56:59], v[128:131], v[40:43]
    v_mfma_f32_16x16x32_bf16 v[40:43], v[60:63], v[124:127], v[40:43]
    v_mfma_f32_16x16x32_bf16 v[40:43], v[64:67], v[120:123], v[40:43]
    v_mfma_f32_16x16x32_bf16 v[40:43], v[68:71], v[116:119], v[40:43]
    v_cvt_pk_bf16_f32 v186, v36, v37
    v_cvt_pk_bf16_f32 v187, v38, v39
    v_mfma_f32_16x16x32_bf16 v[40:43], v[72:75], v[112:115], v[40:43]
    s_mov_b32 s76, 135168
    buffer_store_dwordx4 v[184:187], v234, s[64:67], s76 offen sc1
    v_mfma_f32_16x16x32_bf16 v[44:47], v[48:51], v[140:143], v[44:47]
    v_mfma_f32_16x16x32_bf16 v[44:47], v[52:55], v[136:139], v[44:47]
    v_mfma_f32_16x16x32_bf16 v[44:47], v[56:59], v[132:135], v[44:47]
    v_mfma_f32_16x16x32_bf16 v[44:47], v[60:63], v[128:131], v[44:47]
    v_mfma_f32_16x16x32_bf16 v[44:47], v[64:67], v[124:127], v[44:47]
    v_mfma_f32_16x16x32_bf16 v[44:47], v[68:71], v[120:123], v[44:47]
    v_mfma_f32_16x16x32_bf16 v[44:47], v[72:75], v[116:119], v[44:47]
    v_mfma_f32_16x16x32_bf16 v[44:47], v[76:79], v[112:115], v[44:47]
    v_mfma_f32_16x16x32_bf16 v[40:43], v[80:83], v[168:171], v[40:43]
    v_mfma_f32_16x16x32_bf16 v[40:43], v[84:87], v[164:167], v[40:43]
    v_mfma_f32_16x16x32_bf16 v[40:43], v[88:91], v[160:163], v[40:43]
    v_mfma_f32_16x16x32_bf16 v[40:43], v[92:95], v[156:159], v[40:43]
    v_mfma_f32_16x16x32_bf16 v[40:43], v[96:99], v[152:155], v[40:43]
    v_mfma_f32_16x16x32_bf16 v[40:43], v[100:103], v[148:151], v[40:43]
    v_mfma_f32_16x16x32_bf16 v[40:43], v[104:107], v[144:147], v[40:43]
    v_mfma_f32_16x16x32_bf16 v[44:47], v[80:83], v[172:175], v[44:47]
    v_mfma_f32_16x16x32_bf16 v[44:47], v[84:87], v[168:171], v[44:47]
    v_mfma_f32_16x16x32_bf16 v[44:47], v[88:91], v[164:167], v[44:47]
    v_mfma_f32_16x16x32_bf16 v[44:47], v[92:95], v[160:163], v[44:47]
    v_mfma_f32_16x16x32_bf16 v[44:47], v[96:99], v[156:159], v[44:47]
    v_mfma_f32_16x16x32_bf16 v[44:47], v[100:103], v[152:155], v[44:47]
    v_mfma_f32_16x16x32_bf16 v[44:47], v[104:107], v[148:151], v[44:47]
    v_mfma_f32_16x16x32_bf16 v[44:47], v[108:111], v[144:147], v[44:47]
    v_cvt_pk_bf16_f32 v188, v40, v41
    v_cvt_pk_bf16_f32 v189, v42, v43
    s_nop 5
    v_cvt_pk_bf16_f32 v190, v44, v45
    v_cvt_pk_bf16_f32 v191, v46, v47
    s_mov_b32 s76, 202752
    buffer_store_dwordx4 v[188:191], v234, s[64:67], s76 offen sc1
    s_setprio 1
    s_waitcnt vmcnt(0)
    v_mov_b32 v238, 1
    s_mov_b64 exec, 1
    ds_add_rtn_u32 v237, v227, v238 offset:8
    s_waitcnt lgkmcnt(0)
    v_readfirstlane_b32 s76, v237
    s_nop 0
    s_cmp_eq_u32 s76, 3
    s_cbranch_scc0 L_jo_38a
    s_mov_b64 exec, 0xffff
    v_lshlrev_b32 v237, 8, v0
    buffer_atomic_add v238, v237, s[52:55], s73 offen sc1
L_jo_38a:
    s_mov_b64 exec, -1
    v_lshlrev_b32 v112, 16, v208
    v_and_b32 v113, 0xffff0000, v208
    v_lshlrev_b32 v114, 16, v209
    v_and_b32 v115, 0xffff0000, v209
    v_lshlrev_b32 v116, 16, v210
    v_and_b32 v117, 0xffff0000, v210
    v_lshlrev_b32 v118, 16, v211
    v_and_b32 v119, 0xffff0000, v211
    v_lshlrev_b32 v120, 16, v212
    v_and_b32 v121, 0xffff0000, v212
    v_lshlrev_b32 v122, 16, v213
    v_and_b32 v123, 0xffff0000, v213
    v_lshlrev_b32 v124, 16, v214
    v_and_b32 v125, 0xffff0000, v214
    v_lshlrev_b32 v126, 16, v215
    v_and_b32 v127, 0xffff0000, v215
    v_lshlrev_b32 v128, 16, v216
    v_and_b32 v129, 0xffff0000, v216
    v_lshlrev_b32 v130, 16, v217
    v_and_b32 v131, 0xffff0000, v217
    v_lshlrev_b32 v132, 16, v218
    v_and_b32 v133, 0xffff0000, v218
    v_lshlrev_b32 v134, 16, v219
    v_and_b32 v135, 0xffff0000, v219
    v_lshlrev_b32 v136, 16, v220
    v_and_b32 v137, 0xffff0000, v220
    v_lshlrev_b32 v138, 16, v221
    v_and_b32 v139, 0xffff0000, v221
    v_lshlrev_b32 v140, 16, v222
    v_and_b32 v141, 0xffff0000, v222
    v_lshlrev_b32 v142, 16, v223
    v_and_b32 v143, 0xffff0000, v223
    s_setprio 1
    s_setprio 1
    s_mul_i32 s77, s70, 4352
    s_add_u32 s77, s77, 60416
    v_lshrrev_b32 v234, 5, v0
    v_lshl_add_u32 v234, v234, 1, v0
    v_lshl_add_u32 v234, v234, 4, s77
    v_and_b32 v235, 7, v0
    v_mul_u32_u24 v235, 544, v235
    v_lshrrev_b32 v236, 3, v0
    v_lshl_add_u32 v235, v236, 3, v235
    v_add_u32 v235, s77, v235
    s_mul_i32 s77, s71, 4224
    s_mov_b32 s60, s26
    s_mov_b32 s61, s27
    s_mov_b32 s62, 0x800000
    s_mov_b32 s63, 0x20000
    s_cmp_eq_u32 s76, 3
    s_cbranch_scc0 L_jo_38
    s_mov_b32 s75, 131072
L_sg_loop_41:
    s_load_dword s74, s[52:53], s45 glc
L_sg_chk_42:
    s_waitcnt lgkmcnt(0)
    s_cmp_ge_u32 s74, 16
    s_cbranch_scc1 L_sg_done_40
    s_sub_u32 s75, s75, 1
    s_cbranch_scc0 L_sg_loop_41
L_sg_done_40:
    v_mov_b32 v237, 16
    s_mov_b64 exec, 1
    ds_add_u32 v227, v237 offset:16
    s_mov_b64 exec, -1
    s_branch L_jd_39
L_jo_38:
    s_mov_b32 s75, 1048576
L_sl_loop_44:
    ds_read_b32 v237, v227 offset:16
    s_waitcnt lgkmcnt(0)
    v_readfirstlane_b32 s74, v237
    s_nop 0
    s_cmp_ge_u32 s74, 16
    s_cbranch_scc1 L_sl_done_43
    s_sleep 1
    s_sub_u32 s75, s75, 1
    s_cbranch_scc0 L_sl_loop_44
L_sl_done_43:
L_jd_39:
    buffer_load_dwordx4 v[48:51], v224, s[64:67], s77 offen offset:0 sc1
    buffer_load_dwordx4 v[52:55], v224, s[64:67], s77 offen offset:1024 sc1
    buffer_load_dwordx4 v[56:59], v224, s[64:67], s77 offen offset:2048 sc1
    buffer_load_dwordx4 v[60:63], v224, s[64:67], s77 offen offset:3072 sc1
    s_waitcnt vmcnt(3)
    ds_write_b128 v234, v[48:51] offset:0
    s_waitcnt vmcnt(2)
    ds_write_b128 v234, v[52:55] offset:1088
    s_waitcnt vmcnt(1)
    ds_write_b128 v234, v[56:59] offset:2176
    s_waitcnt vmcnt(0)
    ds_write_b128 v234, v[60:63] offset:3264
    ds_read_b64 v[64:65], v235 offset:0
    ds_read_b64 v[66:67], v235 offset:64
    ds_read_b64 v[68:69], v235 offset:128
    ds_read_b64 v[70:71], v235 offset:192
    ds_read_b64 v[72:73], v235 offset:256
    ds_read_b64 v[74:75], v235 offset:320
    ds_read_b64 v[76:77], v235 offset:384
    ds_read_b64 v[78:79], v235 offset:448
    s_waitcnt lgkmcnt(7)
    v_lshlrev_b32 v16, 16, v64
    v_and_b32 v24, 0xffff0000, v64
    v_lshlrev_b32 v32, 16, v65
    v_and_b32 v40, 0xffff0000, v65
    s_waitcnt lgkmcnt(6)
    v_lshlrev_b32 v17, 16, v66
    v_and_b32 v25, 0xffff0000, v66
    v_lshlrev_b32 v33, 16, v67
    v_and_b32 v41, 0xffff0000, v67
    s_waitcnt lgkmcnt(5)
    v_lshlrev_b32 v18, 16, v68
    v_and_b32 v26, 0xffff0000, v68
    v_lshlrev_b32 v34, 16, v69
    v_and_b32 v42, 0xffff0000, v69
    s_waitcnt lgkmcnt(4)
    v_lshlrev_b32 v19, 16, v70
    v_and_b32 v27, 0xffff0000, v70
    v_lshlrev_b32 v35, 16, v71
    v_and_b32 v43, 0xffff0000, v71
    s_waitcnt lgkmcnt(3)
    v_lshlrev_b32 v20, 16, v72
    v_and_b32 v28, 0xffff0000, v72
    v_lshlrev_b32 v36, 16, v73
    v_and_b32 v44, 0xffff0000, v73
    s_waitcnt lgkmcnt(2)
    v_lshlrev_b32 v21, 16, v74
    v_and_b32 v29, 0xffff0000, v74
    v_lshlrev_b32 v37, 16, v75
    v_and_b32 v45, 0xffff0000, v75
    s_waitcnt lgkmcnt(1)
    v_lshlrev_b32 v22, 16, v76
    v_and_b32 v30, 0xffff0000, v76
    v_lshlrev_b32 v38, 16, v77
    v_and_b32 v46, 0xffff0000, v77
    s_waitcnt lgkmcnt(0)
    v_lshlrev_b32 v23, 16, v78
    v_and_b32 v31, 0xffff0000, v78
    v_lshlrev_b32 v39, 16, v79
    v_and_b32 v47, 0xffff0000, v79
    v_mul_f32 v16, v16, v112
    v_mul_f32 v17, v17, v113
    v_mul_f32 v18, v18, v114
    v_mul_f32 v19, v19, v115
    v_mul_f32 v20, v20, v116
    v_mul_f32 v21, v21, v117
    v_mul_f32 v22, v22, v118
    v_mul_f32 v23, v23, v119
    v_cvt_pk_bf16_f32 v48, v16, v17
    v_cvt_pk_bf16_f32 v49, v18, v19
    v_cvt_pk_bf16_f32 v50, v20, v21
    v_cvt_pk_bf16_f32 v51, v22, v23
    s_mov_b32 s74, 0
    buffer_store_dwordx4 v[48:51], v226, s[60:63], s74 offen nt
    v_mul_f32 v24, v24, v120
    v_mul_f32 v25, v25, v121
    v_mul_f32 v26, v26, v122
    v_mul_f32 v27, v27, v123
    v_mul_f32 v28, v28, v124
    v_mul_f32 v29, v29, v125
    v_mul_f32 v30, v30, v126
    v_mul_f32 v31, v31, v127
    v_cvt_pk_bf16_f32 v52, v24, v25
    v_cvt_pk_bf16_f32 v53, v26, v27
    v_cvt_pk_bf16_f32 v54, v28, v29
    v_cvt_pk_bf16_f32 v55, v30, v31
    s_mov_b32 s74, 4096
    buffer_store_dwordx4 v[52:55], v226, s[60:63], s74 offen nt
    v_mul_f32 v32, v32, v128
    v_mul_f32 v33, v33, v129
    v_mul_f32 v34, v34, v130
    v_mul_f32 v35, v35, v131
    v_mul_f32 v36, v36, v132
    v_mul_f32 v37, v37, v133
    v_mul_f32 v38, v38, v134
    v_mul_f32 v39, v39, v135
    v_cvt_pk_bf16_f32 v56, v32, v33
    v_cvt_pk_bf16_f32 v57, v34, v35
    v_cvt_pk_bf16_f32 v58, v36, v37
    v_cvt_pk_bf16_f32 v59, v38, v39
    s_mov_b32 s74, 16384
    buffer_store_dwordx4 v[56:59], v226, s[60:63], s74 offen nt
    v_mul_f32 v40, v40, v136
    v_mul_f32 v41, v41, v137
    v_mul_f32 v42, v42, v138
    v_mul_f32 v43, v43, v139
    v_mul_f32 v44, v44, v140
    v_mul_f32 v45, v45, v141
    v_mul_f32 v46, v46, v142
    v_mul_f32 v47, v47, v143
    v_cvt_pk_bf16_f32 v60, v40, v41
    v_cvt_pk_bf16_f32 v61, v42, v43
    v_cvt_pk_bf16_f32 v62, v44, v45
    v_cvt_pk_bf16_f32 v63, v46, v47
    s_mov_b32 s74, 20480
    buffer_store_dwordx4 v[60:63], v226, s[60:63], s74 offen nt
    s_endpgm
L_grole:
    s_setprio 2
    s_add_u32 s52, s30, 0xe00000
    s_addc_u32 s53, s31, 0
    s_mov_b32 s54, 0x20000
    s_mov_b32 s55, 0x20000
    s_lshr_b32 s32, s3, 1
    s_and_b32 s33, s3, 1
    v_and_b32 v1, 15, v0
    v_lshrrev_b32 v2, 4, v0
    v_lshrrev_b32 v3, 1, v1
    v_xor_b32 v3, v2, v3
    v_lshlrev_b32 v3, 4, v3
    v_lshl_add_u32 v3, v1, 7, v3
    s_lshl_b32 s37, s33, 13
    v_add_u32 v196, s37, v3
    v_xor_b32 v197, 64, v196
    v_and_b32 v198, 7, v1
    v_lshlrev_b32 v3, 1, v2
    v_xor_b32 v3, v3, v198
    v_lshlrev_b32 v3, 4, v3
    v_lshl_add_u32 v3, v198, 7, v3
    v_lshrrev_b32 v202, 3, v1
    v_lshl_add_u32 v3, v202, 2, v3
    v_add_u32 v198, 16384, v3
    v_xor_b32 v199, 16, v198
    v_mul_u32_u24 v202, 0xaaaa, v202
    v_add_u32 v202, 0x4444, v202
    v_bfe_u32 v3, v0, 2, 2
    v_lshl_add_u32 v200, v2, 3, v3
    v_lshlrev_b32 v200, 7, v200
    v_bfe_u32 v3, v0, 3, 2
    v_xor_b32 v3, s3, v3
    v_lshl_add_u32 v200, v3, 5, v200
    v_and_b32 v3, 3, v0
    v_lshl_add_u32 v200, v3, 3, v200
    v_add_u32 v200, 17408, v200
    v_xor_b32 v201, 32, v200
    v_mov_b64 v[52:53], 0
    v_mov_b64 v[54:55], 0
    v_mov_b64 v[56:57], 0
    v_mov_b64 v[58:59], 0
    v_mov_b64 v[60:61], 0
    v_mov_b64 v[62:63], 0
    v_mov_b64 v[64:65], 0
    v_mov_b64 v[66:67], 0
    v_mov_b64 v[68:69], 0
    v_mov_b64 v[70:71], 0
    v_mov_b64 v[72:73], 0
    v_mov_b64 v[74:75], 0
    v_mov_b64 v[76:77], 0
    v_mov_b64 v[78:79], 0
    v_mov_b64 v[80:81], 0
    v_mov_b64 v[82:83], 0
    v_mov_b64 v[84:85], 0
    v_mov_b64 v[86:87], 0
    v_mov_b64 v[88:89], 0
    v_mov_b64 v[90:91], 0
    v_mov_b64 v[92:93], 0
    v_mov_b64 v[94:95], 0
    v_mov_b64 v[96:97], 0
    v_mov_b64 v[98:99], 0
    v_mov_b64 v[100:101], 0
    v_mov_b64 v[102:103], 0
    v_mov_b64 v[104:105], 0
    v_mov_b64 v[106:107], 0
    s_mov_b32 s34, 0
    v_mov_b32 v228, 134352
    v_and_b32 v1, 15, v0
    v_lshrrev_b32 v2, 4, v0
    v_lshlrev_b32 v2, 2, v2
    v_sub_u32 v1, v1, v2
    s_mov_b32 s37, 0xf149f2ca
    v_mov_b32 v3, s37
    s_or_b32 s38, s5, s33
    s_cmp_eq_u32 s38, 0
    s_cselect_b32 s38, s37, 0
    v_subrev_u32 v2, 0, v1
    v_cmp_gt_u32 vcc, 8, v2
    v_cmp_gt_i32 s[64:65], -8, v2
    v_ashrrev_i32 v2, 31, v2
    v_cndmask_b32 v204, v3, 0, vcc
    v_cndmask_b32 v208, v3, 0, s[64:65]
    v_mov_b32 v216, v2
    v_min_f32 v212, s38, v208
    v_subrev_u32 v2, 1, v1
    v_cmp_gt_u32 vcc, 8, v2
    v_cmp_gt_i32 s[64:65], -8, v2
    v_ashrrev_i32 v2, 31, v2
    v_cndmask_b32 v205, v3, 0, vcc
    v_cndmask_b32 v209, v3, 0, s[64:65]
    v_alignbit_b32 v216, v2, v216, 16
    v_min_f32 v213, s38, v209
    v_subrev_u32 v2, 2, v1
    v_cmp_gt_u32 vcc, 8, v2
    v_cmp_gt_i32 s[64:65], -8, v2
    v_ashrrev_i32 v2, 31, v2
    v_cndmask_b32 v206, v3, 0, vcc
    v_cndmask_b32 v210, v3, 0, s[64:65]
    v_mov_b32 v217, v2
    v_min_f32 v214, s38, v210
    v_subrev_u32 v2, 3, v1
    v_cmp_gt_u32 vcc, 8, v2
    v_cmp_gt_i32 s[64:65], -8, v2
    v_ashrrev_i32 v2, 31, v2
    v_cndmask_b32 v207, v3, 0, vcc
    v_cndmask_b32 v211, v3, 0, s[64:65]
    v_alignbit_b32 v217, v2, v217, 16
    v_min_f32 v215, s38, v211
    s_mul_i32 s37, s32, 80896
    s_add_u32 s37, s37, 78848
    v_lshl_add_u32 v220, v0, 3, s37
    s_lshl_b32 s38, s33, 9
    v_add_u32 v219, s38, v220
    s_add_u32 s38, s38, s37
    v_and_b32 v1, 3, v0
    v_lshl_add_u32 v1, v1, 1, s38
    v_bfe_u32 v2, v0, 2, 2
    v_lshl_add_u32 v1, v2, 7, v1
    v_lshrrev_b32 v2, 4, v0
    v_xor_b32 v2, 2, v2
    v_lshl_add_u32 v203, v2, 5, v1
    s_mul_i32 s38, s33, 2560
    v_add_u32 v221, s38, v220
    v_xor_b32 v222, 512, v221
    s_lshl3_add_u32 s37, s4, s5
    s_lshl1_add_u32 s37, s37, s33
    s_lshl_b32 s37, s37, 7
    s_lshl1_add_u32 s38, s6, s32
    s_add_u32 s37, s37, s38
    s_lshl_b32 s37, s37, 10
    v_lshl_add_u32 v218, v0, 4, s37
    s_mov_b32 s40, s30
    s_mov_b32 s41, s31
    s_mov_b32 s42, 0x400000
    s_mov_b32 s43, 0x20000
    s_and_b32 s58, s2, 3
    s_bfe_u32 s37, s2, 0x20003
    s_lshl2_add_u32 s58, s58, s37
    s_bfe_u32 s59, s2, 0x10002
    s_lshr_b32 s37, s2, 5
    s_lshl3_add_u32 s59, s59, s37
    s_mov_b32 s44, s24
    s_mov_b32 s45, s25
    s_mov_b32 s46, 0x200000
    s_mov_b32 s47, 0x20000
    s_mov_b32 s48, s26
    s_mov_b32 s49, s27
    s_mov_b32 s50, 0x800000
    s_mov_b32 s51, 0x20000
    s_lshl3_add_u32 s56, s4, s5
    s_lshl4_add_u32 s56, s56, 0
    s_lshl_b32 s56, s56, 8
    s_lshl4_add_u32 s57, s58, 0
    s_add_u32 s57, s57, s59
    s_lshl_b32 s57, s57, 8
    s_lshl2_add_u32 s37, s58, s3
    s_lshl_b32 s38, s37, 16
    v_lshl_add_u32 v224, v0, 4, s38
    v_add_u32 v225, 0x8000, v224
    s_and_b32 s37, s37, 31
    s_lshl_b32 s37, s37, 6
    s_lshr_b32 s38, s58, 3
    s_add_u32 s37, s37, s38
    s_lshl_b32 s37, s37, 5
    s_add_u32 s37, s37, s59
    s_add_u32 s37, s37, 16
    s_lshl_b32 s37, s37, 7
    v_lshrrev_b32 v1, 3, v0
    v_lshl_add_u32 v1, v1, 13, s37
    v_and_b32 v2, 7, v0
    v_lshl_add_u32 v226, v2, 4, v1
    v_lshrrev_b32 v1, 4, v0
    v_lshlrev_b32 v1, 1, v1
    v_xor_b32 v1, v0, v1
    v_and_b32 v1, 7, v1
    s_lshl_b32 s37, s59, 7
    v_lshl_add_u32 v1, v1, 4, s37
    v_lshrrev_b32 v227, 3, v0
    v_lshl_add_u32 v227, v227, 11, v1
    v_add_u32 v223, 15360, v227
    s_lshl_b32 s60, s3, 11
    s_mul_i32 s61, s59, 0
    s_and_b32 s61, s61, 7
    s_lshl3_add_u32 s62, s61, s3
    s_lshl_b32 s62, s62, 15
    v_lshrrev_b32 v1, 2, v0
    v_lshlrev_b32 v1, 7, v1
    v_bfe_u32 v2, v0, 3, 2
    v_lshl_add_u32 v1, v2, 5, v1
    v_and_b32 v2, 3, v0
    v_lshl_add_u32 v229, v2, 3, v1
    v_and_b32 v231, 7, v0
    v_lshl_add_u32 v230, v231, 6, s86
    v_mul_u32_u24 v231, 528, v231
    v_lshrrev_b32 v232, 3, v0
    v_xor_b32 v232, 7, v232
    v_lshl_add_u32 v231, v232, 3, v231
    v_add_u32 v231, s86, v231
    v_lshrrev_b32 v232, 5, v0
    v_add_u32 v232, v0, v232
    v_lshl_add_u32 v232, v232, 4, s86
    s_mul_i32 s87, s84, 4224
    s_sub_u32 s87, s87, s85
    s_lshl_b32 s87, s87, 6
    s_add_u32 s87, s87, 4032
    v_and_b32 v233, 3, v0
    v_lshl_add_u32 v233, v233, 4, s87
    v_lshrrev_b32 v234, 2, v0
    v_mul_u32_u24 v234, 4224, v234
    v_add_u32 v233, v233, v234
    s_add_u32 s80, s30, 0x400000
    s_addc_u32 s81, s31, 0
    s_mov_b32 s82, 0x420000
    s_mov_b32 s83, 0x20000
    s_waitcnt vmcnt(11)
    ds_read_b128 v[36:39], v230 offset:4224
    ds_read_b128 v[40:43], v230 offset:4240
    ds_read_b128 v[44:47], v230 offset:4256
    ds_read_b128 v[48:51], v230 offset:4272
    s_waitcnt lgkmcnt(3)
    v_lshlrev_b32 v152, 16, v36
    v_and_b32 v154, 0xffff0000, v36
    v_lshlrev_b32 v156, 16, v37
    v_and_b32 v158, 0xffff0000, v37
    v_lshlrev_b32 v153, 16, v38
    v_and_b32 v155, 0xffff0000, v38
    v_lshlrev_b32 v157, 16, v39
    v_and_b32 v159, 0xffff0000, v39
    s_waitcnt lgkmcnt(2)
    v_lshlrev_b32 v160, 16, v40
    v_and_b32 v162, 0xffff0000, v40
    v_lshlrev_b32 v164, 16, v41
    v_and_b32 v166, 0xffff0000, v41
    v_lshlrev_b32 v161, 16, v42
    v_and_b32 v163, 0xffff0000, v42
    v_lshlrev_b32 v165, 16, v43
    v_and_b32 v167, 0xffff0000, v43
    s_waitcnt lgkmcnt(1)
    v_lshlrev_b32 v168, 16, v44
    v_and_b32 v170, 0xffff0000, v44
    v_lshlrev_b32 v172, 16, v45
    v_and_b32 v174, 0xffff0000, v45
    v_lshlrev_b32 v169, 16, v46
    v_and_b32 v171, 0xffff0000, v46
    v_lshlrev_b32 v173, 16, v47
    v_and_b32 v175, 0xffff0000, v47
    s_waitcnt lgkmcnt(0)
    v_lshlrev_b32 v176, 16, v48
    v_and_b32 v178, 0xffff0000, v48
    v_lshlrev_b32 v180, 16, v49
    v_and_b32 v182, 0xffff0000, v49
    v_lshlrev_b32 v177, 16, v50
    v_and_b32 v179, 0xffff0000, v50
    v_lshlrev_b32 v181, 16, v51
    v_and_b32 v183, 0xffff0000, v51
    v_mov_b64 v[36:37], 0
    v_mov_b64 v[38:39], 0
    v_mov_b64 v[40:41], 0
    v_mov_b64 v[42:43], 0
    v_mov_b64 v[44:45], 0
    v_mov_b64 v[46:47], 0
    v_mov_b64 v[48:49], 0
    v_mov_b64 v[50:51], 0
    s_waitcnt vmcnt(10)
    v_lshlrev_b32 v184, 16, v108
    v_and_b32 v185, 0xffff0000, v108
    v_lshlrev_b32 v186, 16, v109
    v_and_b32 v187, 0xffff0000, v109
    v_lshlrev_b32 v188, 16, v110
    v_and_b32 v189, 0xffff0000, v110
    v_lshlrev_b32 v190, 16, v111
    v_and_b32 v191, 0xffff0000, v111
    v_pk_mul_f32 v[4:5], v[184:185], v[158:159]
    v_pk_mul_f32 v[12:13], v[186:187], v[166:167]
    v_pk_mul_f32 v[20:21], v[188:189], v[174:175]
    v_pk_mul_f32 v[28:29], v[190:191], v[182:183]
    s_waitcnt vmcnt(9)
    v_lshlrev_b32 v184, 16, v112
    v_and_b32 v185, 0xffff0000, v112
    v_lshlrev_b32 v186, 16, v113
    v_and_b32 v187, 0xffff0000, v113
    v_lshlrev_b32 v188, 16, v114
    v_and_b32 v189, 0xffff0000, v114
    v_lshlrev_b32 v190, 16, v115
    v_and_b32 v191, 0xffff0000, v115
    v_pk_fma_f32 v[4:5], v[184:185], v[156:157], v[4:5]
    v_pk_fma_f32 v[12:13], v[186:187], v[164:165], v[12:13]
    v_pk_fma_f32 v[20:21], v[188:189], v[172:173], v[20:21]
    v_pk_fma_f32 v[28:29], v[190:191], v[180:181], v[28:29]
    v_pk_mul_f32 v[6:7], v[184:185], v[158:159]
    v_pk_mul_f32 v[14:15], v[186:187], v[166:167]
    v_pk_mul_f32 v[22:23], v[188:189], v[174:175]
    v_pk_mul_f32 v[30:31], v[190:191], v[182:183]
    s_waitcnt vmcnt(8)
    v_lshlrev_b32 v184, 16, v116
    v_and_b32 v185, 0xffff0000, v116
    v_lshlrev_b32 v186, 16, v117
    v_and_b32 v187, 0xffff0000, v117
    v_lshlrev_b32 v188, 16, v118
    v_and_b32 v189, 0xffff0000, v118
    v_lshlrev_b32 v190, 16, v119
    v_and_b32 v191, 0xffff0000, v119
    v_pk_fma_f32 v[4:5], v[184:185], v[154:155], v[4:5]
    v_pk_fma_f32 v[12:13], v[186:187], v[162:163], v[12:13]
    v_pk_fma_f32 v[20:21], v[188:189], v[170:171], v[20:21]
    v_pk_fma_f32 v[28:29], v[190:191], v[178:179], v[28:29]
    v_pk_fma_f32 v[6:7], v[184:185], v[156:157], v[6:7]
    v_pk_fma_f32 v[14:15], v[186:187], v[164:165], v[14:15]
    v_pk_fma_f32 v[22:23], v[188:189], v[172:173], v[22:23]
    v_pk_fma_f32 v[30:31], v[190:191], v[180:181], v[30:31]
    v_pk_mul_f32 v[8:9], v[184:185], v[158:159]
    v_pk_mul_f32 v[16:17], v[186:187], v[166:167]
    v_pk_mul_f32 v[24:25], v[188:189], v[174:175]
    v_pk_mul_f32 v[32:33], v[190:191], v[182:183]
    s_waitcnt vmcnt(7)
    v_lshlrev_b32 v184, 16, v120
    v_and_b32 v185, 0xffff0000, v120
    v_lshlrev_b32 v186, 16, v121
    v_and_b32 v187, 0xffff0000, v121
    v_lshlrev_b32 v188, 16, v122
    v_and_b32 v189, 0xffff0000, v122
    v_lshlrev_b32 v190, 16, v123
    v_and_b32 v191, 0xffff0000, v123
    v_pk_fma_f32 v[4:5], v[184:185], v[152:153], v[4:5]
    v_pk_fma_f32 v[12:13], v[186:187], v[160:161], v[12:13]
    v_pk_fma_f32 v[20:21], v[188:189], v[168:169], v[20:21]
    v_pk_fma_f32 v[28:29], v[190:191], v[176:177], v[28:29]
    v_pk_fma_f32 v[6:7], v[184:185], v[154:155], v[6:7]
    v_pk_fma_f32 v[14:15], v[186:187], v[162:163], v[14:15]
    v_pk_fma_f32 v[22:23], v[188:189], v[170:171], v[22:23]
    v_pk_fma_f32 v[30:31], v[190:191], v[178:179], v[30:31]
    v_pk_fma_f32 v[8:9], v[184:185], v[156:157], v[8:9]
    v_pk_fma_f32 v[16:17], v[186:187], v[164:165], v[16:17]
    v_pk_fma_f32 v[24:25], v[188:189], v[172:173], v[24:25]
    v_pk_fma_f32 v[32:33], v[190:191], v[180:181], v[32:33]
    v_pk_mul_f32 v[10:11], v[184:185], v[158:159]
    v_pk_mul_f32 v[18:19], v[186:187], v[166:167]
    v_pk_mul_f32 v[26:27], v[188:189], v[174:175]
    v_pk_mul_f32 v[34:35], v[190:191], v[182:183]
    s_waitcnt vmcnt(6)
    v_lshlrev_b32 v184, 16, v124
    v_and_b32 v185, 0xffff0000, v124
    v_lshlrev_b32 v186, 16, v125
    v_and_b32 v187, 0xffff0000, v125
    v_lshlrev_b32 v188, 16, v126
    v_and_b32 v189, 0xffff0000, v126
    v_lshlrev_b32 v190, 16, v127
    v_and_b32 v191, 0xffff0000, v127
    v_pk_fma_f32 v[6:7], v[184:185], v[152:153], v[6:7]
    v_pk_fma_f32 v[14:15], v[186:187], v[160:161], v[14:15]
    v_pk_fma_f32 v[22:23], v[188:189], v[168:169], v[22:23]
    v_pk_fma_f32 v[30:31], v[190:191], v[176:177], v[30:31]
    v_pk_fma_f32 v[8:9], v[184:185], v[154:155], v[8:9]
    v_pk_fma_f32 v[16:17], v[186:187], v[162:163], v[16:17]
    v_pk_fma_f32 v[24:25], v[188:189], v[170:171], v[24:25]
    v_pk_fma_f32 v[32:33], v[190:191], v[178:179], v[32:33]
    v_pk_fma_f32 v[10:11], v[184:185], v[156:157], v[10:11]
    v_pk_fma_f32 v[18:19], v[186:187], v[164:165], v[18:19]
    v_pk_fma_f32 v[26:27], v[188:189], v[172:173], v[26:27]
    v_pk_fma_f32 v[34:35], v[190:191], v[180:181], v[34:35]
    s_waitcnt vmcnt(5)
    v_lshlrev_b32 v184, 16, v128
    v_and_b32 v185, 0xffff0000, v128
    v_lshlrev_b32 v186, 16, v129
    v_and_b32 v187, 0xffff0000, v129
    v_lshlrev_b32 v188, 16, v130
    v_and_b32 v189, 0xffff0000, v130
    v_lshlrev_b32 v190, 16, v131
    v_and_b32 v191, 0xffff0000, v131
    v_pk_fma_f32 v[8:9], v[184:185], v[152:153], v[8:9]
    v_pk_fma_f32 v[16:17], v[186:187], v[160:161], v[16:17]
    v_pk_fma_f32 v[24:25], v[188:189], v[168:169], v[24:25]
    v_pk_fma_f32 v[32:33], v[190:191], v[176:177], v[32:33]
    v_pk_fma_f32 v[10:11], v[184:185], v[154:155], v[10:11]
    v_pk_fma_f32 v[18:19], v[186:187], v[162:163], v[18:19]
    v_pk_fma_f32 v[26:27], v[188:189], v[170:171], v[26:27]
    v_pk_fma_f32 v[34:35], v[190:191], v[178:179], v[34:35]
    s_waitcnt vmcnt(4)
    v_lshlrev_b32 v184, 16, v132
    v_and_b32 v185, 0xffff0000, v132
    v_lshlrev_b32 v186, 16, v133
    v_and_b32 v187, 0xffff0000, v133
    v_lshlrev_b32 v188, 16, v134
    v_and_b32 v189, 0xffff0000, v134
    v_lshlrev_b32 v190, 16, v135
    v_and_b32 v191, 0xffff0000, v135
    v_pk_fma_f32 v[10:11], v[184:185], v[152:153], v[10:11]
    v_pk_fma_f32 v[18:19], v[186:187], v[160:161], v[18:19]
    v_pk_fma_f32 v[26:27], v[188:189], v[168:169], v[26:27]
    v_pk_fma_f32 v[34:35], v[190:191], v[176:177], v[34:35]
    s_waitcnt vmcnt(3)
    v_lshlrev_b32 v184, 16, v136
    v_and_b32 v185, 0xffff0000, v136
    v_lshlrev_b32 v186, 16, v137
    v_and_b32 v187, 0xffff0000, v137
    v_lshlrev_b32 v188, 16, v138
    v_and_b32 v189, 0xffff0000, v138
    v_lshlrev_b32 v190, 16, v139
    v_and_b32 v191, 0xffff0000, v139
    v_pk_mul_f32 v[4:5], v[4:5], v[184:185]
    v_pk_mul_f32 v[12:13], v[12:13], v[186:187]
    v_pk_mul_f32 v[20:21], v[20:21], v[188:189]
    v_pk_mul_f32 v[28:29], v[28:29], v[190:191]
    s_waitcnt vmcnt(2)
    v_lshlrev_b32 v184, 16, v140
    v_and_b32 v185, 0xffff0000, v140
    v_lshlrev_b32 v186, 16, v141
    v_and_b32 v187, 0xffff0000, v141
    v_lshlrev_b32 v188, 16, v142
    v_and_b32 v189, 0xffff0000, v142
    v_lshlrev_b32 v190, 16, v143
    v_and_b32 v191, 0xffff0000, v143
    v_pk_mul_f32 v[6:7], v[6:7], v[184:185]
    v_pk_mul_f32 v[14:15], v[14:15], v[186:187]
    v_pk_mul_f32 v[22:23], v[22:23], v[188:189]
    v_pk_mul_f32 v[30:31], v[30:31], v[190:191]
    s_waitcnt vmcnt(1)
    v_lshlrev_b32 v184, 16, v144
    v_and_b32 v185, 0xffff0000, v144
    v_lshlrev_b32 v186, 16, v145
    v_and_b32 v187, 0xffff0000, v145
    v_lshlrev_b32 v188, 16, v146
    v_and_b32 v189, 0xffff0000, v146
    v_lshlrev_b32 v190, 16, v147
    v_and_b32 v191, 0xffff0000, v147
    v_pk_mul_f32 v[8:9], v[8:9], v[184:185]
    v_pk_mul_f32 v[16:17], v[16:17], v[186:187]
    v_pk_mul_f32 v[24:25], v[24:25], v[188:189]
    v_pk_mul_f32 v[32:33], v[32:33], v[190:191]
    s_waitcnt vmcnt(0)
    v_lshlrev_b32 v184, 16, v148
    v_and_b32 v185, 0xffff0000, v148
    v_lshlrev_b32 v186, 16, v149
    v_and_b32 v187, 0xffff0000, v149
    v_lshlrev_b32 v188, 16, v150
    v_and_b32 v189, 0xffff0000, v150
    v_lshlrev_b32 v190, 16, v151
    v_and_b32 v191, 0xffff0000, v151
    v_pk_mul_f32 v[10:11], v[10:11], v[184:185]
    v_pk_mul_f32 v[18:19], v[18:19], v[186:187]
    v_pk_mul_f32 v[26:27], v[26:27], v[188:189]
    v_pk_mul_f32 v[34:35], v[34:35], v[190:191]
    v_cvt_pk_bf16_f32 v108, v10, v8
    v_cvt_pk_bf16_f32 v109, v6, v4
    ds_write_b64 v231, v[108:109] offset:0
    v_cvt_pk_bf16_f32 v110, v11, v9
    v_cvt_pk_bf16_f32 v111, v7, v5
    ds_write_b64 v231, v[110:111] offset:64
    v_cvt_pk_bf16_f32 v112, v18, v16
    v_cvt_pk_bf16_f32 v113, v14, v12
    ds_write_b64 v231, v[112:113] offset:128
    v_cvt_pk_bf16_f32 v114, v19, v17
    v_cvt_pk_bf16_f32 v115, v15, v13
    ds_write_b64 v231, v[114:115] offset:192
    v_cvt_pk_bf16_f32 v116, v26, v24
    v_cvt_pk_bf16_f32 v117, v22, v20
    ds_write_b64 v231, v[116:117] offset:256
    v_cvt_pk_bf16_f32 v118, v27, v25
    v_cvt_pk_bf16_f32 v119, v23, v21
    ds_write_b64 v231, v[118:119] offset:320
    v_cvt_pk_bf16_f32 v120, v34, v32
    v_cvt_pk_bf16_f32 v121, v30, v28
    ds_write_b64 v231, v[120:121] offset:384
    v_cvt_pk_bf16_f32 v122, v35, v33
    v_cvt_pk_bf16_f32 v123, v31, v29
    ds_write_b64 v231, v[122:123] offset:448
    ds_read_b128 v[234:237], v232 offset:0
    ds_read_b128 v[238:241], v232 offset:1056
    ds_read_b128 v[242:245], v232 offset:2112
    ds_read_b128 v[246:249], v232 offset:3168
    v_mov_b64 v[4:5], 0
    v_mov_b64 v[6:7], 0
    v_mov_b64 v[8:9], 0
    v_mov_b64 v[10:11], 0
    v_mov_b64 v[12:13], 0
    v_mov_b64 v[14:15], 0
    v_mov_b64 v[16:17], 0
    v_mov_b64 v[18:19], 0
    v_mov_b64 v[20:21], 0
    v_mov_b64 v[22:23], 0
    v_mov_b64 v[24:25], 0
    v_mov_b64 v[26:27], 0
    v_mov_b64 v[28:29], 0
    v_mov_b64 v[30:31], 0
    v_mov_b64 v[32:33], 0
    v_mov_b64 v[34:35], 0
    s_waitcnt lgkmcnt(0)
    s_and_b32 s37, s2, 7
    s_xor_b32 s37, s37, 2
    s_lshl_b32 s37, s37, 5
    s_lshr_b32 s38, s2, 3
    s_add_u32 s37, s37, s38
    s_add_u32 s37, s37, 256
    s_lshl_b32 s37, s37, 8
    s_cmp_eq_u32 s33, 0
    s_cselect_b32 s37, s37, s57
    s_cmp_eq_u32 s32, 0
    s_cbranch_scc0 L_noclear
    s_mov_b64 exec, 1
    buffer_store_dword v4, off, s[52:55], s37 sc1
    s_mov_b64 exec, -1
L_noclear:
    s_mov_b32 s37, 41984
    s_mov_b32 s36, 15
    s_barrier
    ds_read_b128 v[108:111], v196 offset:0
    ds_read_b64_tr_b16 v[124:125], v200 offset:0
    ds_read_b64_tr_b16 v[126:127], v200 offset:512
    ds_read_b128 v[112:115], v196 offset:2048
    ds_read_b64_tr_b16 v[128:129], v201 offset:0
    ds_read_b64_tr_b16 v[130:131], v201 offset:512
    ds_read_b128 v[116:119], v196 offset:4096
    ds_read_b64_tr_b16 v[148:149], v200 offset:8192
    ds_read_b64_tr_b16 v[150:151], v200 offset:8704
    ds_read_b128 v[120:123], v196 offset:6144
    ds_read_b64_tr_b16 v[132:133], v201 offset:8192
    ds_read_b64_tr_b16 v[134:135], v201 offset:8704
    ds_read_b64_tr_b16 v[156:157], v200 offset:16384
    ds_read_b64_tr_b16 v[158:159], v200 offset:16896
    ds_read_b64_tr_b16 v[136:137], v201 offset:16384
    ds_read_b64_tr_b16 v[138:139], v201 offset:16896
    s_mov_b32 s87, 0
    buffer_store_dwordx4 v[234:237], v233, s[80:83], s87 offen sc1
    s_mov_b32 s87, 67584
    buffer_store_dwordx4 v[238:241], v233, s[80:83], s87 offen sc1
    s_mov_b32 s87, 135168
    buffer_store_dwordx4 v[242:245], v233, s[80:83], s87 offen sc1
    s_mov_b32 s87, 202752
    buffer_store_dwordx4 v[246:249], v233, s[80:83], s87 offen sc1
    s_branch L_g1_head
L_g1_rare:
    v_readfirstlane_b32 s38, v1
    s_nop 0
    s_cmp_ge_u32 s38, 4
    s_cbranch_scc1 L_sl_done_45
    s_mov_b32 s39, 1048576
L_sl_loop_46:
    ds_read_b32 v1, v228 offset:24
    s_waitcnt lgkmcnt(0)
    v_readfirstlane_b32 s38, v1
    s_nop 0
    s_cmp_ge_u32 s38, 4
    s_cbranch_scc1 L_sl_done_45
    s_sleep 1
    s_sub_u32 s39, s39, 1
    s_cbranch_scc0 L_sl_loop_46
L_sl_done_45:
    s_branch L_g1_nobar
.p2align 6
L_g1_head:
    s_waitcnt lgkmcnt(0)
L_g1_loop:
    v_mfma_f32_16x16x32_bf16 v[4:7], v[124:127], v[108:111], v[4:7]
    ds_read_b128 v[164:167], v197 offset:0
    v_mfma_f32_16x16x32_bf16 v[12:15], v[124:127], v[112:115], v[12:15]
    ds_read_b64_tr_b16 v[180:181], v200 offset:4096
    v_mfma_f32_16x16x32_bf16 v[20:23], v[124:127], v[116:119], v[20:23]
    ds_read_b64_tr_b16 v[182:183], v200 offset:4608
    v_mfma_f32_16x16x32_bf16 v[28:31], v[124:127], v[120:123], v[28:31]
    ds_read_b128 v[168:171], v197 offset:2048
    v_mfma_f32_16x16x32_bf16 v[32:35], v[128:131], v[120:123], v[32:35]
    ds_read_b64_tr_b16 v[184:185], v201 offset:4096
    v_mfma_f32_16x16x32_bf16 v[24:27], v[128:131], v[116:119], v[24:27]
    ds_read_b64_tr_b16 v[186:187], v201 offset:4608
    v_mfma_f32_16x16x32_bf16 v[16:19], v[128:131], v[112:115], v[16:19]
    ds_read_b128 v[172:175], v197 offset:4096
    v_mfma_f32_16x16x32_bf16 v[8:11], v[128:131], v[108:111], v[8:11]
    ds_read_b64_tr_b16 v[152:153], v200 offset:12288
    v_mfma_f32_16x16x32_bf16 v[40:43], v[132:135], v[108:111], v[40:43]
    ds_read_b64_tr_b16 v[154:155], v200 offset:12800
    v_mfma_f32_16x16x32_bf16 v[48:51], v[132:135], v[112:115], v[48:51]
    ds_read_b128 v[176:179], v197 offset:6144
    v_mfma_f32_16x16x32_bf16 v[56:59], v[132:135], v[116:119], v[56:59]
    ds_read_b64_tr_b16 v[188:189], v201 offset:12288
    v_mfma_f32_16x16x32_bf16 v[64:67], v[132:135], v[120:123], v[64:67]
    ds_read_b64_tr_b16 v[190:191], v201 offset:12800
    v_mfma_f32_16x16x32_bf16 v[60:63], v[148:151], v[120:123], v[60:63]
    ds_read2_b32 v[140:141], v198 offset1:2
    v_mfma_f32_16x16x32_bf16 v[52:55], v[148:151], v[116:119], v[52:55]
    ds_read2_b32 v[142:143], v199 offset1:2
    v_mfma_f32_16x16x32_bf16 v[44:47], v[148:151], v[112:115], v[44:47]
    ds_read_b64_tr_b16 v[160:161], v200 offset:20480
    v_mfma_f32_16x16x32_bf16 v[36:39], v[148:151], v[108:111], v[36:39]
    ds_read_b64_tr_b16 v[162:163], v200 offset:20992
    v_mfma_f32_16x16x32_bf16 v[68:71], v[108:111], v[156:159], v[68:71]
    ds_read_b64_tr_b16 v[192:193], v201 offset:20480
    ds_read_b64_tr_b16 v[194:195], v201 offset:20992
    v_mfma_f32_16x16x32_bf16 v[76:79], v[112:115], v[156:159], v[76:79]
    ds_read_b32 v1, v228 offset:24
    s_add_u32 s34, s34, 41984
    v_mfma_f32_16x16x32_bf16 v[84:87], v[116:119], v[156:159], v[84:87]
    s_cmp_eq_u32 s34, 125952
    s_cselect_b32 s35, -83968, s37
    v_mfma_f32_16x16x32_bf16 v[92:95], v[120:123], v[156:159], v[92:95]
    s_cselect_b32 s34, 0, s34
    s_cmp_eq_u32 s36, 1
    v_mfma_f32_16x16x32_bf16 v[96:99], v[120:123], v[136:139], v[96:99]
    v_add_u32 v196, s35, v196
    v_add_u32 v197, s35, v197
    v_mfma_f32_16x16x32_bf16 v[88:91], v[116:119], v[136:139], v[88:91]
    v_add_u32 v198, s35, v198
    v_add_u32 v199, s35, v199
    v_mfma_f32_16x16x32_bf16 v[80:83], v[112:115], v[136:139], v[80:83]
    v_add_u32 v200, s35, v200
    v_add_u32 v201, s35, v201
    v_mfma_f32_16x16x32_bf16 v[72:75], v[108:111], v[136:139], v[72:75]
    s_waitcnt lgkmcnt(0)
    v_smfmac_f32_16x16x64_bf16 v[100:103], v[140:143], v[148:155], v202
    v_smfmac_f32_16x16x64_bf16 v[104:107], v[140:143], v[156:163], v202
    s_cbranch_scc1 L_g1_rare
L_g1_bar:
    s_barrier
L_g1_nobar:
    v_mfma_f32_16x16x32_bf16 v[4:7], v[180:183], v[164:167], v[4:7]
    ds_read_b128 v[108:111], v196 offset:0
    v_mfma_f32_16x16x32_bf16 v[12:15], v[180:183], v[168:171], v[12:15]
    ds_read_b64_tr_b16 v[124:125], v200 offset:0
    v_mfma_f32_16x16x32_bf16 v[20:23], v[180:183], v[172:175], v[20:23]
    ds_read_b64_tr_b16 v[126:127], v200 offset:512
    v_mfma_f32_16x16x32_bf16 v[28:31], v[180:183], v[176:179], v[28:31]
    ds_read_b128 v[112:115], v196 offset:2048
    v_mfma_f32_16x16x32_bf16 v[32:35], v[184:187], v[176:179], v[32:35]
    ds_read_b64_tr_b16 v[128:129], v201 offset:0
    v_mfma_f32_16x16x32_bf16 v[24:27], v[184:187], v[172:175], v[24:27]
    ds_read_b64_tr_b16 v[130:131], v201 offset:512
    v_mfma_f32_16x16x32_bf16 v[16:19], v[184:187], v[168:171], v[16:19]
    ds_read_b128 v[116:119], v196 offset:4096
    v_mfma_f32_16x16x32_bf16 v[8:11], v[184:187], v[164:167], v[8:11]
    ds_read_b64_tr_b16 v[148:149], v200 offset:8192
    v_mfma_f32_16x16x32_bf16 v[40:43], v[188:191], v[164:167], v[40:43]
    ds_read_b64_tr_b16 v[150:151], v200 offset:8704
    v_mfma_f32_16x16x32_bf16 v[48:51], v[188:191], v[168:171], v[48:51]
    ds_read_b128 v[120:123], v196 offset:6144
    v_mfma_f32_16x16x32_bf16 v[56:59], v[188:191], v[172:175], v[56:59]
    ds_read_b64_tr_b16 v[132:133], v201 offset:8192
    v_mfma_f32_16x16x32_bf16 v[64:67], v[188:191], v[176:179], v[64:67]
    ds_read_b64_tr_b16 v[134:135], v201 offset:8704
    v_mfma_f32_16x16x32_bf16 v[60:63], v[152:155], v[176:179], v[60:63]
    ds_read_b64_tr_b16 v[156:157], v200 offset:16384
    v_mfma_f32_16x16x32_bf16 v[52:55], v[152:155], v[172:175], v[52:55]
    ds_read_b64_tr_b16 v[158:159], v200 offset:16896
    v_mfma_f32_16x16x32_bf16 v[44:47], v[152:155], v[168:171], v[44:47]
    ds_read_b64_tr_b16 v[136:137], v201 offset:16384
    v_mfma_f32_16x16x32_bf16 v[36:39], v[152:155], v[164:167], v[36:39]
    ds_read_b64_tr_b16 v[138:139], v201 offset:16896
    v_mfma_f32_16x16x32_bf16 v[68:71], v[164:167], v[160:163], v[68:71]
    s_sub_u32 s36, s36, 1
    v_mfma_f32_16x16x32_bf16 v[76:79], v[168:171], v[160:163], v[76:79]
    s_cmp_lg_u32 s36, 0
    v_mfma_f32_16x16x32_bf16 v[84:87], v[172:175], v[160:163], v[84:87]
    v_mfma_f32_16x16x32_bf16 v[92:95], v[176:179], v[160:163], v[92:95]
    v_mfma_f32_16x16x32_bf16 v[96:99], v[176:179], v[192:195], v[96:99]
    v_mfma_f32_16x16x32_bf16 v[88:91], v[172:175], v[192:195], v[88:91]
    v_mfma_f32_16x16x32_bf16 v[80:83], v[168:171], v[192:195], v[80:83]
    s_waitcnt vmcnt(0) lgkmcnt(0)
    v_mfma_f32_16x16x32_bf16 v[72:75], v[164:167], v[192:195], v[72:75]
    s_cbranch_scc1 L_g1_loop
    v_mfma_f32_16x16x32_bf16 v[4:7], v[124:127], v[108:111], v[4:7]
    ds_read_b128 v[164:167], v197 offset:0
    v_mfma_f32_16x16x32_bf16 v[12:15], v[124:127], v[112:115], v[12:15]
    ds_read_b64_tr_b16 v[180:181], v200 offset:4096
    v_mfma_f32_16x16x32_bf16 v[20:23], v[124:127], v[116:119], v[20:23]
    ds_read_b64_tr_b16 v[182:183], v200 offset:4608
    v_mfma_f32_16x16x32_bf16 v[28:31], v[124:127], v[120:123], v[28:31]
    ds_read_b128 v[168:171], v197 offset:2048
    v_mfma_f32_16x16x32_bf16 v[32:35], v[128:131], v[120:123], v[32:35]
    ds_read_b64_tr_b16 v[184:185], v201 offset:4096
    v_mfma_f32_16x16x32_bf16 v[24:27], v[128:131], v[116:119], v[24:27]
    ds_read_b64_tr_b16 v[186:187], v201 offset:4608
    v_mfma_f32_16x16x32_bf16 v[16:19], v[128:131], v[112:115], v[16:19]
    ds_read_b128 v[172:175], v197 offset:4096
    v_mfma_f32_16x16x32_bf16 v[8:11], v[128:131], v[108:111], v[8:11]
    ds_read_b64_tr_b16 v[152:153], v200 offset:12288
    v_mfma_f32_16x16x32_bf16 v[40:43], v[132:135], v[108:111], v[40:43]
    ds_read_b64_tr_b16 v[154:155], v200 offset:12800
    v_mfma_f32_16x16x32_bf16 v[48:51], v[132:135], v[112:115], v[48:51]
    ds_read_b128 v[176:179], v197 offset:6144
    v_mfma_f32_16x16x32_bf16 v[56:59], v[132:135], v[116:119], v[56:59]
    ds_read_b64_tr_b16 v[188:189], v201 offset:12288
    v_mfma_f32_16x16x32_bf16 v[64:67], v[132:135], v[120:123], v[64:67]
    ds_read_b64_tr_b16 v[190:191], v201 offset:12800
    v_mfma_f32_16x16x32_bf16 v[60:63], v[148:151], v[120:123], v[60:63]
    ds_read2_b32 v[140:141], v198 offset1:2
    v_mfma_f32_16x16x32_bf16 v[52:55], v[148:151], v[116:119], v[52:55]
    ds_read2_b32 v[142:143], v199 offset1:2
    v_mfma_f32_16x16x32_bf16 v[44:47], v[148:151], v[112:115], v[44:47]
    ds_read_b64_tr_b16 v[160:161], v200 offset:20480
    v_mfma_f32_16x16x32_bf16 v[36:39], v[148:151], v[108:111], v[36:39]
    ds_read_b64_tr_b16 v[162:163], v200 offset:20992
    v_mfma_f32_16x16x32_bf16 v[68:71], v[108:111], v[156:159], v[68:71]
    ds_read_b64_tr_b16 v[192:193], v201 offset:20480
    v_mfma_f32_16x16x32_bf16 v[76:79], v[112:115], v[156:159], v[76:79]
    ds_read_b64_tr_b16 v[194:195], v201 offset:20992
    v_mfma_f32_16x16x32_bf16 v[84:87], v[116:119], v[156:159], v[84:87]
    v_mfma_f32_16x16x32_bf16 v[92:95], v[120:123], v[156:159], v[92:95]
    v_mfma_f32_16x16x32_bf16 v[96:99], v[120:123], v[136:139], v[96:99]
    v_mfma_f32_16x16x32_bf16 v[88:91], v[116:119], v[136:139], v[88:91]
    v_mfma_f32_16x16x32_bf16 v[80:83], v[112:115], v[136:139], v[80:83]
    v_mfma_f32_16x16x32_bf16 v[72:75], v[108:111], v[136:139], v[72:75]
    s_waitcnt lgkmcnt(0)
    s_setprio 2
    v_mov_b32 v2, 1
    v_smfmac_f32_16x16x64_bf16 v[100:103], v[140:143], v[148:155], v202
    v_smfmac_f32_16x16x64_bf16 v[104:107], v[140:143], v[156:163], v202
    v_mfma_f32_16x16x32_bf16 v[60:63], v[152:155], v[176:179], v[60:63]
    v_mfma_f32_16x16x32_bf16 v[64:67], v[188:191], v[176:179], v[64:67]
    v_mfma_f32_16x16x32_bf16 v[92:95], v[176:179], v[160:163], v[92:95]
    v_mfma_f32_16x16x32_bf16 v[96:99], v[176:179], v[192:195], v[96:99]
    v_mfma_f32_16x16x32_bf16 v[28:31], v[180:183], v[176:179], v[28:31]
    v_mfma_f32_16x16x32_bf16 v[32:35], v[184:187], v[176:179], v[32:35]
    v_mfma_f32_16x16x32_bf16 v[52:55], v[152:155], v[172:175], v[52:55]
    v_mfma_f32_16x16x32_bf16 v[56:59], v[188:191], v[172:175], v[56:59]
    s_nop 3
    v_permlane32_swap_b32 v100, v104
    v_permlane32_swap_b32 v101, v105
    v_mfma_f32_16x16x32_bf16 v[20:23], v[180:183], v[172:175], v[20:23]
    v_permlane32_swap_b32 v102, v106
    v_permlane32_swap_b32 v103, v107
    v_mfma_f32_16x16x32_bf16 v[24:27], v[184:187], v[172:175], v[24:27]
    v_add_f32 v100, v100, v104
    v_add_f32 v101, v101, v105
    v_mfma_f32_16x16x32_bf16 v[44:47], v[152:155], v[168:171], v[44:47]
    v_add_f32 v102, v102, v106
    v_add_f32 v103, v103, v107
    v_mfma_f32_16x16x32_bf16 v[48:51], v[188:191], v[168:171], v[48:51]
    v_cvt_pk_bf16_f32 v144, v100, v101
    v_cvt_pk_bf16_f32 v145, v102, v103
    v_mfma_f32_16x16x32_bf16 v[12:15], v[180:183], v[168:171], v[12:15]
    ds_write_b64 v219, v[144:145] offset:1024
    ds_write_b16 v203, v144 offset:0
    v_mfma_f32_16x16x32_bf16 v[16:19], v[184:187], v[168:171], v[16:19]
    ds_write_b16_d16_hi v203, v144 offset:8
    ds_write_b16 v203, v145 offset:16
    v_mfma_f32_16x16x32_bf16 v[36:39], v[152:155], v[164:167], v[36:39]
    ds_write_b16_d16_hi v203, v145 offset:24
    v_cvt_pk_bf16_f32 v140, v60, v61
    v_mfma_f32_16x16x32_bf16 v[40:43], v[188:191], v[164:167], v[40:43]
    v_cvt_pk_bf16_f32 v141, v62, v63
    v_cvt_pk_bf16_f32 v142, v64, v65
    v_mfma_f32_16x16x32_bf16 v[4:7], v[180:183], v[164:167], v[4:7]
    v_cvt_pk_bf16_f32 v143, v66, v67
    v_cvt_pk_bf16_f32 v238, v92, v93
    v_mfma_f32_16x16x32_bf16 v[8:11], v[184:187], v[164:167], v[8:11]
    v_cvt_pk_bf16_f32 v239, v94, v95
    v_cvt_pk_bf16_f32 v248, v96, v97
    v_mfma_f32_16x16x32_bf16 v[84:87], v[172:175], v[160:163], v[84:87]
    v_cvt_pk_bf16_f32 v249, v98, v99
    s_cmp_eq_u32 s33, 0
    s_cbranch_scc0 L_at_nopub
    ds_write_b64 v220, v[140:141] offset:2048
    ds_write_b64 v220, v[238:239] offset:3072
    ds_write_b64 v220, v[142:143] offset:2560
    ds_write_b64 v220, v[248:249] offset:3584
L_at_nopub:
    s_mov_b64 exec, 1
    ds_add_u32 v228, v2 offset:20
    s_mov_b64 exec, -1
    v_mfma_f32_16x16x32_bf16 v[88:91], v[172:175], v[192:195], v[88:91]
    v_cvt_pk_bf16_f32 v120, v28, v29
    v_cvt_pk_bf16_f32 v121, v30, v31
    v_mfma_f32_16x16x32_bf16 v[76:79], v[168:171], v[160:163], v[76:79]
    v_cvt_pk_bf16_f32 v122, v32, v33
    v_cvt_pk_bf16_f32 v123, v34, v35
    v_mfma_f32_16x16x32_bf16 v[80:83], v[168:171], v[192:195], v[80:83]
    v_cvt_pk_bf16_f32 v136, v52, v53
    v_cvt_pk_bf16_f32 v137, v54, v55
    v_mfma_f32_16x16x32_bf16 v[68:71], v[164:167], v[160:163], v[68:71]
    v_cvt_pk_bf16_f32 v138, v56, v57
    v_cvt_pk_bf16_f32 v139, v58, v59
    v_mfma_f32_16x16x32_bf16 v[72:75], v[164:167], v[192:195], v[72:75]
    v_cvt_pk_bf16_f32 v116, v20, v21
    v_cvt_pk_bf16_f32 v117, v22, v23
    v_mfma_f32_16x16x32_bf16 v[28:31], v[140:143], v[120:123], v[204:207]
    v_cvt_pk_bf16_f32 v118, v24, v25
    v_cvt_pk_bf16_f32 v119, v26, v27
    v_mfma_f32_16x16x32_bf16 v[32:35], v[136:139], v[120:123], v[208:211]
    v_cvt_pk_bf16_f32 v132, v44, v45
    v_cvt_pk_bf16_f32 v133, v46, v47
    v_mfma_f32_16x16x32_bf16 v[20:23], v[136:139], v[116:119], v[204:207]
    v_cvt_pk_bf16_f32 v134, v48, v49
    v_cvt_pk_bf16_f32 v135, v50, v51
    s_nop 1
    v_mfma_f32_16x16x32_bf16 v[24:27], v[132:135], v[116:119], v[208:211]
    v_cvt_pk_bf16_f32 v112, v12, v13
    v_cvt_pk_bf16_f32 v113, v14, v15
    v_cvt_pk_bf16_f32 v114, v16, v17
    v_cvt_pk_bf16_f32 v115, v18, v19
    s_nop 1
    v_mfma_f32_16x16x32_bf16 v[12:15], v[132:135], v[112:115], v[204:207]
    v_cvt_pk_bf16_f32 v128, v36, v37
    v_cvt_pk_bf16_f32 v129, v38, v39
    v_cvt_pk_bf16_f32 v130, v40, v41
    v_cvt_pk_bf16_f32 v131, v42, v43
    s_nop 1
    v_mfma_f32_16x16x32_bf16 v[16:19], v[128:131], v[112:115], v[208:211]
    v_cvt_pk_bf16_f32 v108, v4, v5
    v_cvt_pk_bf16_f32 v109, v6, v7
    v_cvt_pk_bf16_f32 v110, v8, v9
    v_cvt_pk_bf16_f32 v111, v10, v11
    s_nop 1
    v_mfma_f32_16x16x32_bf16 v[4:7], v[128:131], v[108:111], v[204:207]
    v_cvt_pk_bf16_f32 v236, v84, v85
    v_cvt_pk_bf16_f32 v237, v86, v87
    v_cvt_pk_bf16_f32 v246, v88, v89
    v_cvt_pk_bf16_f32 v247, v90, v91
    v_cvt_pk_bf16_f32 v234, v76, v77
    v_cvt_pk_bf16_f32 v235, v78, v79
    ds_read_b32 v1, v228 offset:20
    v_cvt_pk_bf16_f32 v244, v80, v81
    v_cvt_pk_bf16_f32 v245, v82, v83
    v_cvt_pk_bf16_f32 v232, v68, v69
    v_cvt_pk_bf16_f32 v233, v70, v71
    v_cvt_pk_bf16_f32 v242, v72, v73
    v_cvt_pk_bf16_f32 v243, v74, v75
    s_waitcnt lgkmcnt(0)
    v_readfirstlane_b32 s37, v1
    s_nop 0
    s_cmp_ge_u32 s37, 4
    s_cbranch_scc1 L_sl_done_47
    s_mov_b32 s38, 1048576
L_sl_loop_48:
    ds_read_b32 v1, v228 offset:20
    s_waitcnt lgkmcnt(0)
    v_readfirstlane_b32 s37, v1
    s_nop 0
    s_cmp_ge_u32 s37, 4
    s_cbranch_scc1 L_sl_done_47
    s_sleep 1
    s_sub_u32 s38, s38, 1
    s_cbranch_scc0 L_sl_loop_48
L_sl_done_47:
    ds_read_b64 v[124:125], v221
    ds_read_b64 v[126:127], v222
    ds_read_b64 v[230:231], v221 offset:1024
    ds_read_b64 v[240:241], v222 offset:1024
    v_max_f32 v28, v28, v32
    v_max_f32 v29, v29, v33
    v_max_f32 v30, v30, v34
    v_max_f32 v31, v31, v35
    v_max3_f32 v39, v28, v29, v30
    v_max_f32 v39, v39, v31
    v_max_f32 v20, v20, v24
    v_max_f32 v21, v21, v25
    v_max_f32 v22, v22, v26
    v_max_f32 v23, v23, v27
    v_max3_f32 v38, v20, v21, v22
    v_max_f32 v38, v38, v23
    s_waitcnt lgkmcnt(2)
    v_mfma_f32_16x16x32_bf16 v[8:11], v[124:127], v[108:111], v[212:215]
    s_setprio 2
    s_mov_b32 s37, 0x3e8293ee
    v_max_f32 v12, v12, v16
    v_max_f32 v13, v13, v17
    v_max_f32 v14, v14, v18
    v_max_f32 v15, v15, v19
    v_max3_f32 v37, v12, v13, v14
    v_max_f32 v37, v37, v15
    v_max_f32 v4, v4, v8
    v_max_f32 v5, v5, v9
    v_max_f32 v6, v6, v10
    v_max_f32 v7, v7, v11
    v_max3_f32 v36, v4, v5, v6
    v_max_f32 v36, v36, v7
    v_permlane32_swap_b32 v38, v39
    s_nop 0
    v_permlane32_swap_b32 v36, v37
    v_max_f32 v38, v38, v39
    v_max_f32 v36, v36, v37
    s_nop 1
    v_permlane16_swap_b32 v36, v38
    v_max_f32 v36, v36, v38
    v_mul_f32 v38, s37, v36
    v_mul_f32 v36, s37, v36
    s_nop 1
    v_permlane16_swap_b32 v36, v38
    v_mov_b32 v37, v36
    s_add_u32 m0, s60, 0
    v_mov_b32 v39, v38
    v_permlane32_swap_b32 v36, v37
    s_xor_b32 s63, s62, 0
    v_permlane32_swap_b32 v38, v39
    v_fma_f32 v4, v4, s37, -v36
    buffer_load_dwordx4 v227, s[44:47], s63 offen offset:0 lds
    v_fma_f32 v5, v5, s37, -v36
    v_fma_f32 v6, v6, s37, -v36
    buffer_load_dwordx4 v223, s[44:47], s63 offen offset:1024 lds
    v_fma_f32 v7, v7, s37, -v36
    v_fma_f32 v12, v12, s37, -v37
    s_add_u32 m0, s60, 8192
    v_fma_f32 v13, v13, s37, -v37
    v_fma_f32 v14, v14, s37, -v37
    s_xor_b32 s63, s62, 131072
    v_fma_f32 v15, v15, s37, -v37
    v_fma_f32 v20, v20, s37, -v38
    buffer_load_dwordx4 v227, s[44:47], s63 offen offset:0 lds
    v_fma_f32 v21, v21, s37, -v38
    v_fma_f32 v22, v22, s37, -v38
    buffer_load_dwordx4 v223, s[44:47], s63 offen offset:1024 lds
    v_fma_f32 v23, v23, s37, -v38
    v_fma_f32 v28, v28, s37, -v39
    s_add_u32 m0, s60, 16384
    v_fma_f32 v29, v29, s37, -v39
    v_fma_f32 v30, v30, s37, -v39
    s_xor_b32 s63, s62, 262144
    v_fma_f32 v31, v31, s37, -v39
    v_exp_f32 v28, v28
    buffer_load_dwordx4 v227, s[44:47], s63 offen offset:0 lds
    v_exp_f32 v29, v29
    v_exp_f32 v30, v30
    buffer_load_dwordx4 v223, s[44:47], s63 offen offset:1024 lds
    v_exp_f32 v31, v31
    v_exp_f32 v20, v20
    s_add_u32 m0, s60, 24576
    v_exp_f32 v21, v21
    v_exp_f32 v22, v22
    s_xor_b32 s63, s62, 393216
    v_exp_f32 v23, v23
    v_exp_f32 v12, v12
    buffer_load_dwordx4 v227, s[44:47], s63 offen offset:0 lds
    v_exp_f32 v13, v13
    v_exp_f32 v14, v14
    buffer_load_dwordx4 v223, s[44:47], s63 offen offset:1024 lds
    v_exp_f32 v15, v15
    v_exp_f32 v4, v4
    s_add_u32 m0, s60, 32768
    v_exp_f32 v5, v5
    v_exp_f32 v6, v6
    s_xor_b32 s63, s62, 524288
    v_exp_f32 v7, v7
    v_add_f32 v39, v28, v29
    buffer_load_dwordx4 v227, s[44:47], s63 offen offset:0 lds
    v_add_f32 v32, v30, v31
    v_add_f32 v39, v39, v32
    buffer_load_dwordx4 v223, s[44:47], s63 offen offset:1024 lds
    v_add_f32 v38, v20, v21
    v_add_f32 v24, v22, v23
    s_add_u32 m0, s60, 83968
    v_add_f32 v38, v38, v24
    v_add_f32 v37, v12, v13
    s_xor_b32 s63, s62, 655360
    v_add_f32 v16, v14, v15
    v_add_f32 v37, v37, v16
    buffer_load_dwordx4 v227, s[44:47], s63 offen offset:0 lds
    v_add_f32 v36, v4, v5
    v_add_f32 v8, v6, v7
    buffer_load_dwordx4 v223, s[44:47], s63 offen offset:1024 lds
    v_add_f32 v36, v36, v8
    v_permlane32_swap_b32 v38, v39
    s_add_u32 m0, s60, 92160
    v_permlane32_swap_b32 v36, v37
    v_add_f32 v38, v38, v39
    s_xor_b32 s63, s62, 786432
    v_add_f32 v36, v36, v37
    s_nop 1
    v_permlane16_swap_b32 v36, v38
    buffer_load_dwordx4 v227, s[44:47], s63 offen offset:0 lds
    v_add_f32 v36, v36, v38
    v_rcp_f32 v38, v36
    buffer_load_dwordx4 v223, s[44:47], s63 offen offset:1024 lds
    v_rcp_f32 v36, v36
    s_nop 1
    v_permlane16_swap_b32 v36, v38
    s_add_u32 m0, s60, 100352
    v_mov_b32 v37, v36
    v_mov_b32 v39, v38
    s_xor_b32 s63, s62, 917504
    v_permlane32_swap_b32 v36, v37
    v_permlane32_swap_b32 v38, v39
    buffer_load_dwordx4 v227, s[44:47], s63 offen offset:0 lds
    s_waitcnt lgkmcnt(0)
    v_mul_f32 v4, v4, v36
    buffer_load_dwordx4 v223, s[44:47], s63 offen offset:1024 lds
    v_mul_f32 v5, v5, v36
    v_mul_f32 v6, v6, v36
    s_add_u32 m0, s60, 108544
    v_mul_f32 v7, v7, v36
    v_cvt_pk_bf16_f32 v10, v4, v5
    s_xor_b32 s63, s62, 1048576
    v_cvt_pk_bf16_f32 v11, v6, v7
    v_and_b32 v8, v216, v10
    buffer_load_dwordx4 v227, s[44:47], s63 offen offset:0 lds
    v_and_b32 v9, v217, v11
    v_xor_b32 v10, v8, v10
    buffer_load_dwordx4 v223, s[44:47], s63 offen offset:1024 lds
    v_xor_b32 v11, v9, v11
    s_setprio 2
    s_add_u32 m0, s60, 116736
    v_mfma_f32_16x16x32_bf16 v[68:71], v[230:233], v[8:11], 0
    v_mfma_f32_16x16x32_bf16 v[72:75], v[240:243], v[8:11], 0
    s_xor_b32 s63, s62, 1179648
    s_setprio 2
    v_mul_f32 v12, v12, v37
    buffer_load_dwordx4 v227, s[44:47], s63 offen offset:0 lds
    v_mul_f32 v13, v13, v37
    v_mul_f32 v14, v14, v37
    buffer_load_dwordx4 v223, s[44:47], s63 offen offset:1024 lds
    v_mul_f32 v15, v15, v37
    v_cvt_pk_bf16_f32 v18, v12, v13
    v_cvt_pk_bf16_f32 v19, v14, v15
    v_and_b32 v16, v216, v18
    v_and_b32 v17, v217, v19
    v_xor_b32 v18, v16, v18
    v_xor_b32 v19, v17, v19
    v_cvt_pk_bf16_f32 v108, v68, v69
    v_cvt_pk_bf16_f32 v109, v70, v71
    v_cvt_pk_bf16_f32 v110, v72, v73
    v_cvt_pk_bf16_f32 v111, v74, v75
    s_mov_b32 s37, 0
    buffer_store_dwordx4 v[108:111], v218, s[40:43], s37 offen sc1
    s_setprio 2
    v_mfma_f32_16x16x32_bf16 v[76:79], v[232:235], v[16:19], 0
    v_mfma_f32_16x16x32_bf16 v[80:83], v[242:245], v[16:19], 0
    s_setprio 2
    v_mul_f32 v20, v20, v38
    v_mul_f32 v21, v21, v38
    v_mul_f32 v22, v22, v38
    v_mul_f32 v23, v23, v38
    v_cvt_pk_bf16_f32 v26, v20, v21
    v_cvt_pk_bf16_f32 v27, v22, v23
    v_and_b32 v24, v216, v26
    v_and_b32 v25, v217, v27
    v_xor_b32 v26, v24, v26
    v_xor_b32 v27, v25, v27
    v_cvt_pk_bf16_f32 v112, v76, v77
    v_cvt_pk_bf16_f32 v113, v78, v79
    v_cvt_pk_bf16_f32 v114, v80, v81
    v_cvt_pk_bf16_f32 v115, v82, v83
    s_mov_b32 s37, 32768
    buffer_store_dwordx4 v[112:115], v218, s[40:43], s37 offen sc1
    s_setprio 2
    v_mfma_f32_16x16x32_bf16 v[84:87], v[234:237], v[24:27], 0
    v_mfma_f32_16x16x32_bf16 v[88:91], v[244:247], v[24:27], 0
    s_setprio 2
    v_mul_f32 v28, v28, v39
    v_mul_f32 v29, v29, v39
    v_mul_f32 v30, v30, v39
    v_mul_f32 v31, v31, v39
    v_cvt_pk_bf16_f32 v34, v28, v29
    v_cvt_pk_bf16_f32 v35, v30, v31
    v_and_b32 v32, v216, v34
    v_and_b32 v33, v217, v35
    v_xor_b32 v34, v32, v34
    v_xor_b32 v35, v33, v35
    v_cvt_pk_bf16_f32 v116, v84, v85
    v_cvt_pk_bf16_f32 v117, v86, v87
    v_cvt_pk_bf16_f32 v118, v88, v89
    v_cvt_pk_bf16_f32 v119, v90, v91
    s_mov_b32 s37, 65536
    buffer_store_dwordx4 v[116:119], v218, s[40:43], s37 offen sc1
    s_setprio 2
    v_mfma_f32_16x16x32_bf16 v[92:95], v[236:239], v[32:35], 0
    v_mfma_f32_16x16x32_bf16 v[96:99], v[246:249], v[32:35], 0
    s_setprio 2
    s_nop 5
    v_cvt_pk_bf16_f32 v120, v92, v93
    v_cvt_pk_bf16_f32 v121, v94, v95
    v_cvt_pk_bf16_f32 v122, v96, v97
    v_cvt_pk_bf16_f32 v123, v98, v99
    s_mov_b32 s37, 98304
    buffer_store_dwordx4 v[120:123], v218, s[40:43], s37 offen sc1
    s_setprio 0
    s_lshl_b32 s37, s32, 11
    v_add_u32 v229, s37, v229
    v_xor_b32 v84, 0, v229
    v_xor_b32 v85, 32, v229
    v_xor_b32 v86, 64, v229
    v_xor_b32 v87, 96, v229
    v_add_u32 v88, 83968, v84
    v_add_u32 v89, 83968, v85
    v_add_u32 v90, 83968, v86
    v_add_u32 v91, 83968, v87
    v_add_u32 v92, 125952, v84
    v_add_u32 v93, 125952, v85
    v_add_u32 v94, 125952, v86
    v_add_u32 v95, 125952, v87
    v_xor_b32 v232, 2048, v229
    v_xor_b32 v233, 2080, v229
    v_xor_b32 v234, 2112, v229
    v_xor_b32 v235, 2144, v229
    v_add_u32 v236, 83968, v232
    v_add_u32 v237, 83968, v233
    v_add_u32 v238, 83968, v234
    v_add_u32 v239, 83968, v235
    v_add_u32 v240, 125952, v232
    v_add_u32 v241, 125952, v233
    v_add_u32 v242, 125952, v234
    v_add_u32 v243, 125952, v235
    s_mul_i32 s37, s32, 80896
    s_lshl_b32 s38, s33, 11
    s_add_u32 s37, s37, s38
    s_add_u32 s37, s37, 78848
    v_lshrrev_b32 v1, 5, v0
    v_xor_b32 v1, v1, v0
    v_and_b32 v1, 7, v1
    v_lshl_add_u32 v1, v1, 4, s37
    v_bfe_u32 v2, v0, 4, 1
    v_lshl_add_u32 v1, v2, 3, v1
    v_and_b32 v2, 15, v0
    v_lshl_add_u32 v244, v2, 7, v1
    v_xor_b32 v245, 32, v244
    v_xor_b32 v246, 64, v244
    v_xor_b32 v247, 96, v244
    v_lshrrev_b32 v1, 3, v0
    v_xor_b32 v1, v1, v0
    v_and_b32 v1, 7, v1
    v_and_b32 v2, 56, v0
    v_add_u32 v1, v1, v2
    v_lshl_add_u32 v248, v1, 4, s37
    v_lshl_add_u32 v231, v0, 4, s60
    v_add_u32 v230, 125952, v231
    s_add_u32 s64, s61, 0
    s_and_b32 s64, s64, 7
    s_lshl_b32 s64, s64, 12
    s_add_u32 s65, s61, 1
    s_and_b32 s65, s65, 7
    s_lshl_b32 s65, s65, 12
    s_add_u32 s66, s61, 2
    s_and_b32 s66, s66, 7
    s_lshl_b32 s66, s66, 12
    s_add_u32 s67, s61, 3
    s_and_b32 s67, s67, 7
    s_lshl_b32 s67, s67, 12
    s_add_u32 s68, s61, 4
    s_and_b32 s68, s68, 7
    s_lshl_b32 s68, s68, 12
    s_add_u32 s69, s61, 5
    s_and_b32 s69, s69, 7
    s_lshl_b32 s69, s69, 12
    s_add_u32 s70, s61, 6
    s_and_b32 s70, s70, 7
    s_lshl_b32 s70, s70, 12
    s_add_u32 s71, s61, 7
    s_and_b32 s71, s71, 7
    s_lshl_b32 s71, s71, 12
    s_waitcnt vmcnt(0)
    s_setprio 2
    v_mov_b32 v2, 1
    s_mov_b64 exec, 1
    ds_add_rtn_u32 v1, v228, v2 offset:0
    s_waitcnt lgkmcnt(0)
    v_readfirstlane_b32 s39, v1
    s_nop 0
    s_cmp_eq_u32 s39, 3
    s_cbranch_scc0 L_jo_49a
    s_mov_b64 exec, 0xffff
    v_lshlrev_b32 v1, 8, v0
    buffer_atomic_add v2, v1, s[52:55], s56 offen sc1
L_jo_49a:
    s_mov_b64 exec, -1
    s_setprio 0
    s_xor_b32 s63, s62, 1310720
    buffer_load_dwordx4 v[172:175], v227, s[44:47], s63 offen offset:0
    buffer_load_dwordx4 v[176:179], v223, s[44:47], s63 offen offset:1024
    s_xor_b32 s63, s62, 1441792
    buffer_load_dwordx4 v[180:183], v227, s[44:47], s63 offen offset:0
    buffer_load_dwordx4 v[184:187], v223, s[44:47], s63 offen offset:1024
    s_cmp_eq_u32 s39, 3
    s_cbranch_scc0 L_ps_51
    s_load_dword s37, s[52:53], s57 glc
L_ps_51:
    s_xor_b32 s63, s62, 1572864
    buffer_load_dwordx4 v[188:191], v227, s[44:47], s63 offen offset:0
    buffer_load_dwordx4 v[192:195], v223, s[44:47], s63 offen offset:1024
    s_xor_b32 s63, s62, 1703936
    buffer_load_dwordx4 v[196:199], v227, s[44:47], s63 offen offset:0
    buffer_load_dwordx4 v[200:203], v223, s[44:47], s63 offen offset:1024
    s_xor_b32 s63, s62, 1835008
    buffer_load_dwordx4 v[204:207], v227, s[44:47], s63 offen offset:0
    buffer_load_dwordx4 v[208:211], v223, s[44:47], s63 offen offset:1024
    s_xor_b32 s63, s62, 1966080
    buffer_load_dwordx4 v[212:215], v227, s[44:47], s63 offen offset:0
    buffer_load_dwordx4 v[216:219], v223, s[44:47], s63 offen offset:1024
    s_setprio 0
    s_cmp_eq_u32 s39, 3
    s_cbranch_scc0 L_jo_49
    s_mov_b32 s38, 131072
    s_branch L_sg_chk_54
L_sg_loop_53:
    s_load_dword s37, s[52:53], s57 glc
L_sg_chk_54:
    s_waitcnt lgkmcnt(0)
    s_cmp_ge_u32 s37, 16
    s_cbranch_scc1 L_sg_done_52
    s_sub_u32 s38, s38, 1
    s_cbranch_scc0 L_sg_loop_53
L_sg_done_52:
    v_mov_b32 v1, 16
    s_mov_b64 exec, 1
    ds_add_u32 v228, v1 offset:4
    s_mov_b64 exec, -1
L_jo_49:
    s_waitcnt vmcnt(12)
    s_mov_b64 exec, 1
    ds_add_u32 v228, v2 offset:4
    s_mov_b64 exec, -1
    s_mov_b32 s38, 1048576
L_sl_loop_56:
    ds_read_b32 v1, v228 offset:4
    s_waitcnt lgkmcnt(0)
    v_readfirstlane_b32 s37, v1
    s_nop 0
    s_cmp_ge_u32 s37, 20
    s_cbranch_scc1 L_sl_done_55
    s_sleep 1
    s_sub_u32 s38, s38, 1
    s_cbranch_scc0 L_sl_loop_56
L_sl_done_55:
L_jd_50:
    buffer_load_dwordx4 v[96:99], v224, s[40:43], s64 offen offset:0 sc1
    buffer_load_dwordx4 v[100:103], v225, s[40:43], s64 offen offset:0 sc1
    ds_read_b64_tr_b16 v[36:37], v84 offset:0
    ds_read_b64_tr_b16 v[38:39], v232 offset:0
    buffer_load_dwordx4 v[104:107], v224, s[40:43], s64 offen offset:1024 sc1
    buffer_load_dwordx4 v[108:111], v225, s[40:43], s64 offen offset:1024 sc1
    ds_read_b64_tr_b16 v[40:41], v85 offset:0
    ds_read_b64_tr_b16 v[42:43], v233 offset:0
    buffer_load_dwordx4 v[112:115], v224, s[40:43], s64 offen offset:2048 sc1
    buffer_load_dwordx4 v[116:119], v225, s[40:43], s64 offen offset:2048 sc1
    ds_read_b64_tr_b16 v[44:45], v86 offset:0
    ds_read_b64_tr_b16 v[46:47], v234 offset:0
    buffer_load_dwordx4 v[120:123], v224, s[40:43], s64 offen offset:3072 sc1
    buffer_load_dwordx4 v[124:127], v225, s[40:43], s64 offen offset:3072 sc1
    ds_read_b64_tr_b16 v[48:49], v87 offset:0
    ds_read_b64_tr_b16 v[50:51], v235 offset:0
    buffer_load_dwordx4 v[128:131], v224, s[40:43], s65 offen offset:0 sc1
    buffer_load_dwordx4 v[132:135], v225, s[40:43], s65 offen offset:0 sc1
    ds_read_b64_tr_b16 v[52:53], v84 offset:4096
    ds_read_b64_tr_b16 v[54:55], v232 offset:4096
    buffer_load_dwordx4 v[136:139], v224, s[40:43], s65 offen offset:1024 sc1
    buffer_load_dwordx4 v[140:143], v225, s[40:43], s65 offen offset:1024 sc1
    ds_read_b64_tr_b16 v[56:57], v85 offset:4096
    ds_read_b64_tr_b16 v[58:59], v233 offset:4096
    ds_read_b64_tr_b16 v[60:61], v86 offset:4096
    ds_read_b64_tr_b16 v[62:63], v234 offset:4096
    s_waitcnt lgkmcnt(12)
    ds_read_b64_tr_b16 v[64:65], v87 offset:4096
    ds_read_b64_tr_b16 v[66:67], v235 offset:4096
    ds_read_b32 v1, v228 offset:36
    s_waitcnt vmcnt(10) lgkmcnt(9)
    v_mfma_f32_16x16x32_bf16 v[4:7], v[36:39], v[96:99], 0
    ds_read_b64_tr_b16 v[68:69], v84 offset:8192
    v_mfma_f32_16x16x32_bf16 v[20:23], v[36:39], v[100:103], 0
    ds_read_b64_tr_b16 v[70:71], v232 offset:8192
    v_mfma_f32_16x16x32_bf16 v[8:11], v[40:43], v[96:99], 0
    ds_read_b64_tr_b16 v[36:37], v85 offset:8192
    v_mfma_f32_16x16x32_bf16 v[24:27], v[40:43], v[100:103], 0
    ds_read_b64_tr_b16 v[38:39], v233 offset:8192
    buffer_load_dwordx4 v[144:147], v224, s[40:43], s65 offen offset:2048 sc1
    v_mfma_f32_16x16x32_bf16 v[12:15], v[44:47], v[96:99], 0
    ds_read_b64_tr_b16 v[40:41], v86 offset:8192
    v_mfma_f32_16x16x32_bf16 v[28:31], v[44:47], v[100:103], 0
    ds_read_b64_tr_b16 v[42:43], v234 offset:8192
    v_mfma_f32_16x16x32_bf16 v[16:19], v[48:51], v[96:99], 0
    ds_read_b64_tr_b16 v[44:45], v87 offset:8192
    v_mfma_f32_16x16x32_bf16 v[32:35], v[48:51], v[100:103], 0
    ds_read_b64_tr_b16 v[46:47], v235 offset:8192
    buffer_load_dwordx4 v[148:151], v225, s[40:43], s65 offen offset:2048 sc1
    s_waitcnt lgkmcnt(8)
    v_readfirstlane_b32 s37, v1
    s_nop 0
    s_cmp_ge_u32 s37, 4
    s_cbranch_scc1 L_sl_done_57
    s_mov_b32 s38, 1048576
L_sl_loop_58:
    ds_read_b32 v1, v228 offset:36
    s_waitcnt lgkmcnt(0)
    v_readfirstlane_b32 s37, v1
    s_nop 0
    s_cmp_ge_u32 s37, 4
    s_cbranch_scc1 L_sl_done_57
    s_sleep 1
    s_sub_u32 s38, s38, 1
    s_cbranch_scc0 L_sl_loop_58
L_sl_done_57:
    ds_write_b128 v230, v[172:175] offset:0
    s_waitcnt vmcnt(10)
    v_mfma_f32_16x16x32_bf16 v[4:7], v[52:55], v[104:107], v[4:7]
    ds_read_b64_tr_b16 v[48:49], v84 offset:12288
    v_mfma_f32_16x16x32_bf16 v[20:23], v[52:55], v[108:111], v[20:23]
    ds_read_b64_tr_b16 v[50:51], v232 offset:12288
    v_mfma_f32_16x16x32_bf16 v[8:11], v[56:59], v[104:107], v[8:11]
    ds_read_b64_tr_b16 v[52:53], v85 offset:12288
    v_mfma_f32_16x16x32_bf16 v[24:27], v[56:59], v[108:111], v[24:27]
    ds_read_b64_tr_b16 v[54:55], v233 offset:12288
    buffer_load_dwordx4 v[96:99], v224, s[40:43], s65 offen offset:3072 sc1
    ds_write_b128 v230, v[176:179] offset:1024
    v_mfma_f32_16x16x32_bf16 v[12:15], v[60:63], v[104:107], v[12:15]
    ds_read_b64_tr_b16 v[56:57], v86 offset:12288
    v_mfma_f32_16x16x32_bf16 v[28:31], v[60:63], v[108:111], v[28:31]
    ds_read_b64_tr_b16 v[58:59], v234 offset:12288
    v_mfma_f32_16x16x32_bf16 v[16:19], v[64:67], v[104:107], v[16:19]
    ds_read_b64_tr_b16 v[60:61], v87 offset:12288
    v_mfma_f32_16x16x32_bf16 v[32:35], v[64:67], v[108:111], v[32:35]
    ds_read_b64_tr_b16 v[62:63], v235 offset:12288
    buffer_load_dwordx4 v[100:103], v225, s[40:43], s65 offen offset:3072 sc1
    ds_write_b128 v230, v[180:183] offset:8448
    s_waitcnt vmcnt(10) lgkmcnt(11)
    v_mfma_f32_16x16x32_bf16 v[4:7], v[68:71], v[112:115], v[4:7]
    ds_read_b64_tr_b16 v[64:65], v84 offset:16384
    v_mfma_f32_16x16x32_bf16 v[20:23], v[68:71], v[116:119], v[20:23]
    ds_read_b64_tr_b16 v[66:67], v232 offset:16384
    v_mfma_f32_16x16x32_bf16 v[8:11], v[36:39], v[112:115], v[8:11]
    ds_read_b64_tr_b16 v[68:69], v85 offset:16384
    v_mfma_f32_16x16x32_bf16 v[24:27], v[36:39], v[116:119], v[24:27]
    ds_read_b64_tr_b16 v[70:71], v233 offset:16384
    buffer_load_dwordx4 v[104:107], v224, s[40:43], s66 offen offset:0 sc1
    ds_write_b128 v230, v[184:187] offset:9472
    v_mfma_f32_16x16x32_bf16 v[12:15], v[40:43], v[112:115], v[12:15]
    ds_read_b64_tr_b16 v[36:37], v86 offset:16384
    v_mfma_f32_16x16x32_bf16 v[28:31], v[40:43], v[116:119], v[28:31]
    ds_read_b64_tr_b16 v[38:39], v234 offset:16384
    v_mfma_f32_16x16x32_bf16 v[16:19], v[44:47], v[112:115], v[16:19]
    ds_read_b64_tr_b16 v[40:41], v87 offset:16384
    v_mfma_f32_16x16x32_bf16 v[32:35], v[44:47], v[116:119], v[32:35]
    ds_read_b64_tr_b16 v[42:43], v235 offset:16384
    buffer_load_dwordx4 v[108:111], v225, s[40:43], s66 offen offset:0 sc1
    ds_write_b128 v230, v[188:191] offset:16896
    s_waitcnt vmcnt(10) lgkmcnt(11)
    v_mfma_f32_16x16x32_bf16 v[4:7], v[48:51], v[120:123], v[4:7]
    ds_read_b64_tr_b16 v[44:45], v84 offset:20480
    v_mfma_f32_16x16x32_bf16 v[20:23], v[48:51], v[124:127], v[20:23]
    ds_read_b64_tr_b16 v[46:47], v232 offset:20480
    v_mfma_f32_16x16x32_bf16 v[8:11], v[52:55], v[120:123], v[8:11]
    ds_read_b64_tr_b16 v[48:49], v85 offset:20480
    v_mfma_f32_16x16x32_bf16 v[24:27], v[52:55], v[124:127], v[24:27]
    ds_read_b64_tr_b16 v[50:51], v233 offset:20480
    buffer_load_dwordx4 v[112:115], v224, s[40:43], s66 offen offset:1024 sc1
    ds_write_b128 v230, v[192:195] offset:17920
    v_mfma_f32_16x16x32_bf16 v[12:15], v[56:59], v[120:123], v[12:15]
    ds_read_b64_tr_b16 v[52:53], v86 offset:20480
    v_mfma_f32_16x16x32_bf16 v[28:31], v[56:59], v[124:127], v[28:31]
    ds_read_b64_tr_b16 v[54:55], v234 offset:20480
    v_mfma_f32_16x16x32_bf16 v[16:19], v[60:63], v[120:123], v[16:19]
    ds_read_b64_tr_b16 v[56:57], v87 offset:20480
    v_mfma_f32_16x16x32_bf16 v[32:35], v[60:63], v[124:127], v[32:35]
    ds_read_b64_tr_b16 v[58:59], v235 offset:20480
    buffer_load_dwordx4 v[116:119], v225, s[40:43], s66 offen offset:1024 sc1
    ds_write_b128 v230, v[196:199] offset:25344
    s_waitcnt vmcnt(10) lgkmcnt(11)
    v_mfma_f32_16x16x32_bf16 v[4:7], v[64:67], v[128:131], v[4:7]
    ds_read_b64_tr_b16 v[60:61], v84 offset:24576
    v_mfma_f32_16x16x32_bf16 v[20:23], v[64:67], v[132:135], v[20:23]
    ds_read_b64_tr_b16 v[62:63], v232 offset:24576
    v_mfma_f32_16x16x32_bf16 v[8:11], v[68:71], v[128:131], v[8:11]
    ds_read_b64_tr_b16 v[64:65], v85 offset:24576
    v_mfma_f32_16x16x32_bf16 v[24:27], v[68:71], v[132:135], v[24:27]
    ds_read_b64_tr_b16 v[66:67], v233 offset:24576
    buffer_load_dwordx4 v[120:123], v224, s[40:43], s66 offen offset:2048 sc1
    ds_write_b128 v230, v[200:203] offset:26368
    v_mfma_f32_16x16x32_bf16 v[12:15], v[36:39], v[128:131], v[12:15]
    ds_read_b64_tr_b16 v[68:69], v86 offset:24576
    v_mfma_f32_16x16x32_bf16 v[28:31], v[36:39], v[132:135], v[28:31]
    ds_read_b64_tr_b16 v[70:71], v234 offset:24576
    v_mfma_f32_16x16x32_bf16 v[16:19], v[40:43], v[128:131], v[16:19]
    ds_read_b64_tr_b16 v[36:37], v87 offset:24576
    v_mfma_f32_16x16x32_bf16 v[32:35], v[40:43], v[132:135], v[32:35]
    ds_read_b64_tr_b16 v[38:39], v235 offset:24576
    buffer_load_dwordx4 v[124:127], v225, s[40:43], s66 offen offset:2048 sc1
    ds_write_b128 v231, v[204:207] offset:41984
    s_waitcnt vmcnt(10) lgkmcnt(11)
    v_mfma_f32_16x16x32_bf16 v[4:7], v[44:47], v[136:139], v[4:7]
    ds_read_b64_tr_b16 v[40:41], v84 offset:28672
    v_mfma_f32_16x16x32_bf16 v[20:23], v[44:47], v[140:143], v[20:23]
    ds_read_b64_tr_b16 v[42:43], v232 offset:28672
    v_mfma_f32_16x16x32_bf16 v[8:11], v[48:51], v[136:139], v[8:11]
    ds_read_b64_tr_b16 v[44:45], v85 offset:28672
    v_mfma_f32_16x16x32_bf16 v[24:27], v[48:51], v[140:143], v[24:27]
    ds_read_b64_tr_b16 v[46:47], v233 offset:28672
    buffer_load_dwordx4 v[128:131], v224, s[40:43], s66 offen offset:3072 sc1
    ds_write_b128 v231, v[208:211] offset:43008
    v_mfma_f32_16x16x32_bf16 v[12:15], v[52:55], v[136:139], v[12:15]
    ds_read_b64_tr_b16 v[48:49], v86 offset:28672
    v_mfma_f32_16x16x32_bf16 v[28:31], v[52:55], v[140:143], v[28:31]
    ds_read_b64_tr_b16 v[50:51], v234 offset:28672
    v_mfma_f32_16x16x32_bf16 v[16:19], v[56:59], v[136:139], v[16:19]
    ds_read_b64_tr_b16 v[52:53], v87 offset:28672
    v_mfma_f32_16x16x32_bf16 v[32:35], v[56:59], v[140:143], v[32:35]
    ds_read_b64_tr_b16 v[54:55], v235 offset:28672
    buffer_load_dwordx4 v[132:135], v225, s[40:43], s66 offen offset:3072 sc1
    ds_write_b128 v231, v[212:215] offset:51200
    s_waitcnt vmcnt(10) lgkmcnt(11)
    v_mfma_f32_16x16x32_bf16 v[4:7], v[60:63], v[144:147], v[4:7]
    ds_read_b64_tr_b16 v[56:57], v84 offset:32768
    v_mfma_f32_16x16x32_bf16 v[20:23], v[60:63], v[148:151], v[20:23]
    ds_read_b64_tr_b16 v[58:59], v232 offset:32768
    v_mfma_f32_16x16x32_bf16 v[8:11], v[64:67], v[144:147], v[8:11]
    ds_read_b64_tr_b16 v[60:61], v85 offset:32768
    v_mfma_f32_16x16x32_bf16 v[24:27], v[64:67], v[148:151], v[24:27]
    ds_read_b64_tr_b16 v[62:63], v233 offset:32768
    buffer_load_dwordx4 v[136:139], v224, s[40:43], s67 offen offset:0 sc1
    ds_write_b128 v231, v[216:219] offset:52224
    s_mov_b64 exec, 1
    ds_add_u32 v228, v2 offset:12
    s_mov_b64 exec, -1
    v_mfma_f32_16x16x32_bf16 v[12:15], v[68:71], v[144:147], v[12:15]
    ds_read_b64_tr_b16 v[64:65], v86 offset:32768
    v_mfma_f32_16x16x32_bf16 v[28:31], v[68:71], v[148:151], v[28:31]
    ds_read_b64_tr_b16 v[66:67], v234 offset:32768
    v_mfma_f32_16x16x32_bf16 v[16:19], v[36:39], v[144:147], v[16:19]
    ds_read_b64_tr_b16 v[68:69], v87 offset:32768
    v_mfma_f32_16x16x32_bf16 v[32:35], v[36:39], v[148:151], v[32:35]
    ds_read_b64_tr_b16 v[70:71], v235 offset:32768
    buffer_load_dwordx4 v[140:143], v225, s[40:43], s67 offen offset:0 sc1
    s_waitcnt vmcnt(10) lgkmcnt(11)
    v_mfma_f32_16x16x32_bf16 v[4:7], v[40:43], v[96:99], v[4:7]
    ds_read_b64_tr_b16 v[36:37], v84 offset:36864
    v_mfma_f32_16x16x32_bf16 v[20:23], v[40:43], v[100:103], v[20:23]
    ds_read_b64_tr_b16 v[38:39], v232 offset:36864
    v_mfma_f32_16x16x32_bf16 v[8:11], v[44:47], v[96:99], v[8:11]
    ds_read_b64_tr_b16 v[40:41], v85 offset:36864
    v_mfma_f32_16x16x32_bf16 v[24:27], v[44:47], v[100:103], v[24:27]
    ds_read_b64_tr_b16 v[42:43], v233 offset:36864
    buffer_load_dwordx4 v[144:147], v224, s[40:43], s67 offen offset:1024 sc1
    v_mfma_f32_16x16x32_bf16 v[12:15], v[48:51], v[96:99], v[12:15]
    ds_read_b64_tr_b16 v[44:45], v86 offset:36864
    v_mfma_f32_16x16x32_bf16 v[28:31], v[48:51], v[100:103], v[28:31]
    ds_read_b64_tr_b16 v[46:47], v234 offset:36864
    v_mfma_f32_16x16x32_bf16 v[16:19], v[52:55], v[96:99], v[16:19]
    ds_read_b64_tr_b16 v[48:49], v87 offset:36864
    v_mfma_f32_16x16x32_bf16 v[32:35], v[52:55], v[100:103], v[32:35]
    ds_read_b64_tr_b16 v[50:51], v235 offset:36864
    buffer_load_dwordx4 v[148:151], v225, s[40:43], s67 offen offset:1024 sc1
    s_waitcnt vmcnt(10) lgkmcnt(8)
    v_mfma_f32_16x16x32_bf16 v[4:7], v[56:59], v[104:107], v[4:7]
    ds_read_b64_tr_b16 v[52:53], v88 offset:0
    v_mfma_f32_16x16x32_bf16 v[20:23], v[56:59], v[108:111], v[20:23]
    ds_read_b64_tr_b16 v[54:55], v236 offset:0
    v_mfma_f32_16x16x32_bf16 v[8:11], v[60:63], v[104:107], v[8:11]
    ds_read_b64_tr_b16 v[56:57], v89 offset:0
    v_mfma_f32_16x16x32_bf16 v[24:27], v[60:63], v[108:111], v[24:27]
    ds_read_b64_tr_b16 v[58:59], v237 offset:0
    buffer_load_dwordx4 v[96:99], v224, s[40:43], s67 offen offset:2048 sc1
    v_mfma_f32_16x16x32_bf16 v[12:15], v[64:67], v[104:107], v[12:15]
    ds_read_b64_tr_b16 v[60:61], v90 offset:0
    v_mfma_f32_16x16x32_bf16 v[28:31], v[64:67], v[108:111], v[28:31]
    ds_read_b64_tr_b16 v[62:63], v238 offset:0
    v_mfma_f32_16x16x32_bf16 v[16:19], v[68:71], v[104:107], v[16:19]
    ds_read_b64_tr_b16 v[64:65], v91 offset:0
    v_mfma_f32_16x16x32_bf16 v[32:35], v[68:71], v[108:111], v[32:35]
    ds_read_b64_tr_b16 v[66:67], v239 offset:0
    buffer_load_dwordx4 v[100:103], v225, s[40:43], s67 offen offset:2048 sc1
    s_waitcnt vmcnt(10) lgkmcnt(8)
    v_mfma_f32_16x16x32_bf16 v[4:7], v[36:39], v[112:115], v[4:7]
    ds_read_b64_tr_b16 v[68:69], v88 offset:4096
    v_mfma_f32_16x16x32_bf16 v[20:23], v[36:39], v[116:119], v[20:23]
    ds_read_b64_tr_b16 v[70:71], v236 offset:4096
    v_mfma_f32_16x16x32_bf16 v[8:11], v[40:43], v[112:115], v[8:11]
    ds_read_b64_tr_b16 v[36:37], v89 offset:4096
    v_mfma_f32_16x16x32_bf16 v[24:27], v[40:43], v[116:119], v[24:27]
    ds_read_b64_tr_b16 v[38:39], v237 offset:4096
    buffer_load_dwordx4 v[104:107], v224, s[40:43], s67 offen offset:3072 sc1
    v_mfma_f32_16x16x32_bf16 v[12:15], v[44:47], v[112:115], v[12:15]
    ds_read_b64_tr_b16 v[40:41], v90 offset:4096
    v_mfma_f32_16x16x32_bf16 v[28:31], v[44:47], v[116:119], v[28:31]
    ds_read_b64_tr_b16 v[42:43], v238 offset:4096
    v_mfma_f32_16x16x32_bf16 v[16:19], v[48:51], v[112:115], v[16:19]
    ds_read_b64_tr_b16 v[44:45], v91 offset:4096
    v_mfma_f32_16x16x32_bf16 v[32:35], v[48:51], v[116:119], v[32:35]
    ds_read_b64_tr_b16 v[46:47], v239 offset:4096
    buffer_load_dwordx4 v[108:111], v225, s[40:43], s67 offen offset:3072 sc1
    s_waitcnt vmcnt(10) lgkmcnt(8)
    v_mfma_f32_16x16x32_bf16 v[4:7], v[52:55], v[120:123], v[4:7]
    ds_read_b64_tr_b16 v[48:49], v88 offset:8192
    v_mfma_f32_16x16x32_bf16 v[20:23], v[52:55], v[124:127], v[20:23]
    ds_read_b64_tr_b16 v[50:51], v236 offset:8192
    v_mfma_f32_16x16x32_bf16 v[8:11], v[56:59], v[120:123], v[8:11]
    ds_read_b64_tr_b16 v[52:53], v89 offset:8192
    v_mfma_f32_16x16x32_bf16 v[24:27], v[56:59], v[124:127], v[24:27]
    ds_read_b64_tr_b16 v[54:55], v237 offset:8192
    buffer_load_dwordx4 v[112:115], v224, s[40:43], s68 offen offset:0 sc1
    v_mfma_f32_16x16x32_bf16 v[12:15], v[60:63], v[120:123], v[12:15]
    ds_read_b64_tr_b16 v[56:57], v90 offset:8192
    v_mfma_f32_16x16x32_bf16 v[28:31], v[60:63], v[124:127], v[28:31]
    ds_read_b64_tr_b16 v[58:59], v238 offset:8192
    v_mfma_f32_16x16x32_bf16 v[16:19], v[64:67], v[120:123], v[16:19]
    ds_read_b64_tr_b16 v[60:61], v91 offset:8192
    v_mfma_f32_16x16x32_bf16 v[32:35], v[64:67], v[124:127], v[32:35]
    ds_read_b64_tr_b16 v[62:63], v239 offset:8192
    buffer_load_dwordx4 v[116:119], v225, s[40:43], s68 offen offset:0 sc1
    s_waitcnt vmcnt(10) lgkmcnt(8)
    v_mfma_f32_16x16x32_bf16 v[4:7], v[68:71], v[128:131], v[4:7]
    ds_read_b64_tr_b16 v[64:65], v88 offset:12288
    v_mfma_f32_16x16x32_bf16 v[20:23], v[68:71], v[132:135], v[20:23]
    ds_read_b64_tr_b16 v[66:67], v236 offset:12288
    v_mfma_f32_16x16x32_bf16 v[8:11], v[36:39], v[128:131], v[8:11]
    ds_read_b64_tr_b16 v[68:69], v89 offset:12288
    v_mfma_f32_16x16x32_bf16 v[24:27], v[36:39], v[132:135], v[24:27]
    ds_read_b64_tr_b16 v[70:71], v237 offset:12288
    buffer_load_dwordx4 v[120:123], v224, s[40:43], s68 offen offset:1024 sc1
    v_mfma_f32_16x16x32_bf16 v[12:15], v[40:43], v[128:131], v[12:15]
    ds_read_b64_tr_b16 v[36:37], v90 offset:12288
    v_mfma_f32_16x16x32_bf16 v[28:31], v[40:43], v[132:135], v[28:31]
    ds_read_b64_tr_b16 v[38:39], v238 offset:12288
    v_mfma_f32_16x16x32_bf16 v[16:19], v[44:47], v[128:131], v[16:19]
    ds_read_b64_tr_b16 v[40:41], v91 offset:12288
    v_mfma_f32_16x16x32_bf16 v[32:35], v[44:47], v[132:135], v[32:35]
    ds_read_b64_tr_b16 v[42:43], v239 offset:12288
    buffer_load_dwordx4 v[124:127], v225, s[40:43], s68 offen offset:1024 sc1
    s_waitcnt vmcnt(10) lgkmcnt(8)
    v_mfma_f32_16x16x32_bf16 v[4:7], v[48:51], v[136:139], v[4:7]
    ds_read_b64_tr_b16 v[44:45], v88 offset:16384
    v_mfma_f32_16x16x32_bf16 v[20:23], v[48:51], v[140:143], v[20:23]
    ds_read_b64_tr_b16 v[46:47], v236 offset:16384
    v_mfma_f32_16x16x32_bf16 v[8:11], v[52:55], v[136:139], v[8:11]
    ds_read_b64_tr_b16 v[48:49], v89 offset:16384
    v_mfma_f32_16x16x32_bf16 v[24:27], v[52:55], v[140:143], v[24:27]
    ds_read_b64_tr_b16 v[50:51], v237 offset:16384
    buffer_load_dwordx4 v[128:131], v224, s[40:43], s68 offen offset:2048 sc1
    v_mfma_f32_16x16x32_bf16 v[12:15], v[56:59], v[136:139], v[12:15]
    ds_read_b64_tr_b16 v[52:53], v90 offset:16384
    v_mfma_f32_16x16x32_bf16 v[28:31], v[56:59], v[140:143], v[28:31]
    ds_read_b64_tr_b16 v[54:55], v238 offset:16384
    v_mfma_f32_16x16x32_bf16 v[16:19], v[60:63], v[136:139], v[16:19]
    ds_read_b64_tr_b16 v[56:57], v91 offset:16384
    v_mfma_f32_16x16x32_bf16 v[32:35], v[60:63], v[140:143], v[32:35]
    ds_read_b64_tr_b16 v[58:59], v239 offset:16384
    buffer_load_dwordx4 v[132:135], v225, s[40:43], s68 offen offset:2048 sc1
    s_waitcnt vmcnt(10) lgkmcnt(8)
    v_mfma_f32_16x16x32_bf16 v[4:7], v[64:67], v[144:147], v[4:7]
    ds_read_b64_tr_b16 v[60:61], v88 offset:20480
    v_mfma_f32_16x16x32_bf16 v[20:23], v[64:67], v[148:151], v[20:23]
    ds_read_b64_tr_b16 v[62:63], v236 offset:20480
    v_mfma_f32_16x16x32_bf16 v[8:11], v[68:71], v[144:147], v[8:11]
    ds_read_b64_tr_b16 v[64:65], v89 offset:20480
    v_mfma_f32_16x16x32_bf16 v[24:27], v[68:71], v[148:151], v[24:27]
    ds_read_b64_tr_b16 v[66:67], v237 offset:20480
    buffer_load_dwordx4 v[136:139], v224, s[40:43], s68 offen offset:3072 sc1
    v_mfma_f32_16x16x32_bf16 v[12:15], v[36:39], v[144:147], v[12:15]
    ds_read_b64_tr_b16 v[68:69], v90 offset:20480
    v_mfma_f32_16x16x32_bf16 v[28:31], v[36:39], v[148:151], v[28:31]
    ds_read_b64_tr_b16 v[70:71], v238 offset:20480
    v_mfma_f32_16x16x32_bf16 v[16:19], v[40:43], v[144:147], v[16:19]
    ds_read_b64_tr_b16 v[36:37], v91 offset:20480
    v_mfma_f32_16x16x32_bf16 v[32:35], v[40:43], v[148:151], v[32:35]
    ds_read_b64_tr_b16 v[38:39], v239 offset:20480
    buffer_load_dwordx4 v[140:143], v225, s[40:43], s68 offen offset:3072 sc1
    s_waitcnt vmcnt(10) lgkmcnt(8)
    v_mfma_f32_16x16x32_bf16 v[4:7], v[44:47], v[96:99], v[4:7]
    ds_read_b64_tr_b16 v[40:41], v88 offset:24576
    v_mfma_f32_16x16x32_bf16 v[20:23], v[44:47], v[100:103], v[20:23]
    ds_read_b64_tr_b16 v[42:43], v236 offset:24576
    v_mfma_f32_16x16x32_bf16 v[8:11], v[48:51], v[96:99], v[8:11]
    ds_read_b64_tr_b16 v[44:45], v89 offset:24576
    v_mfma_f32_16x16x32_bf16 v[24:27], v[48:51], v[100:103], v[24:27]
    ds_read_b64_tr_b16 v[46:47], v237 offset:24576
    buffer_load_dwordx4 v[144:147], v224, s[40:43], s69 offen offset:0 sc1
    v_mfma_f32_16x16x32_bf16 v[12:15], v[52:55], v[96:99], v[12:15]
    ds_read_b64_tr_b16 v[48:49], v90 offset:24576
    v_mfma_f32_16x16x32_bf16 v[28:31], v[52:55], v[100:103], v[28:31]
    ds_read_b64_tr_b16 v[50:51], v238 offset:24576
    v_mfma_f32_16x16x32_bf16 v[16:19], v[56:59], v[96:99], v[16:19]
    ds_read_b64_tr_b16 v[52:53], v91 offset:24576
    v_mfma_f32_16x16x32_bf16 v[32:35], v[56:59], v[100:103], v[32:35]
    ds_read_b64_tr_b16 v[54:55], v239 offset:24576
    buffer_load_dwordx4 v[148:151], v225, s[40:43], s69 offen offset:0 sc1
    s_waitcnt vmcnt(10) lgkmcnt(8)
    v_mfma_f32_16x16x32_bf16 v[4:7], v[60:63], v[104:107], v[4:7]
    ds_read_b64_tr_b16 v[56:57], v88 offset:28672
    v_mfma_f32_16x16x32_bf16 v[20:23], v[60:63], v[108:111], v[20:23]
    ds_read_b64_tr_b16 v[58:59], v236 offset:28672
    v_mfma_f32_16x16x32_bf16 v[8:11], v[64:67], v[104:107], v[8:11]
    ds_read_b64_tr_b16 v[60:61], v89 offset:28672
    v_mfma_f32_16x16x32_bf16 v[24:27], v[64:67], v[108:111], v[24:27]
    ds_read_b64_tr_b16 v[62:63], v237 offset:28672
    buffer_load_dwordx4 v[96:99], v224, s[40:43], s69 offen offset:1024 sc1
    v_mfma_f32_16x16x32_bf16 v[12:15], v[68:71], v[104:107], v[12:15]
    ds_read_b64_tr_b16 v[64:65], v90 offset:28672
    v_mfma_f32_16x16x32_bf16 v[28:31], v[68:71], v[108:111], v[28:31]
    ds_read_b64_tr_b16 v[66:67], v238 offset:28672
    v_mfma_f32_16x16x32_bf16 v[16:19], v[36:39], v[104:107], v[16:19]
    ds_read_b64_tr_b16 v[68:69], v91 offset:28672
    v_mfma_f32_16x16x32_bf16 v[32:35], v[36:39], v[108:111], v[32:35]
    ds_read_b64_tr_b16 v[70:71], v239 offset:28672
    buffer_load_dwordx4 v[100:103], v225, s[40:43], s69 offen offset:1024 sc1
    s_waitcnt vmcnt(10) lgkmcnt(8)
    v_mfma_f32_16x16x32_bf16 v[4:7], v[40:43], v[112:115], v[4:7]
    ds_read_b64_tr_b16 v[36:37], v88 offset:32768
    v_mfma_f32_16x16x32_bf16 v[20:23], v[40:43], v[116:119], v[20:23]
    ds_read_b64_tr_b16 v[38:39], v236 offset:32768
    v_mfma_f32_16x16x32_bf16 v[8:11], v[44:47], v[112:115], v[8:11]
    ds_read_b64_tr_b16 v[40:41], v89 offset:32768
    v_mfma_f32_16x16x32_bf16 v[24:27], v[44:47], v[116:119], v[24:27]
    ds_read_b64_tr_b16 v[42:43], v237 offset:32768
    buffer_load_dwordx4 v[104:107], v224, s[40:43], s69 offen offset:2048 sc1
    v_mfma_f32_16x16x32_bf16 v[12:15], v[48:51], v[112:115], v[12:15]
    ds_read_b64_tr_b16 v[44:45], v90 offset:32768
    v_mfma_f32_16x16x32_bf16 v[28:31], v[48:51], v[116:119], v[28:31]
    ds_read_b64_tr_b16 v[46:47], v238 offset:32768
    v_mfma_f32_16x16x32_bf16 v[16:19], v[52:55], v[112:115], v[16:19]
    ds_read_b64_tr_b16 v[48:49], v91 offset:32768
    v_mfma_f32_16x16x32_bf16 v[32:35], v[52:55], v[116:119], v[32:35]
    ds_read_b64_tr_b16 v[50:51], v239 offset:32768
    buffer_load_dwordx4 v[108:111], v225, s[40:43], s69 offen offset:2048 sc1
    ds_read_b32 v1, v228 offset:12
    s_waitcnt vmcnt(10) lgkmcnt(9)
    v_mfma_f32_16x16x32_bf16 v[4:7], v[56:59], v[120:123], v[4:7]
    ds_read_b64_tr_b16 v[52:53], v88 offset:36864
    v_mfma_f32_16x16x32_bf16 v[20:23], v[56:59], v[124:127], v[20:23]
    ds_read_b64_tr_b16 v[54:55], v236 offset:36864
    v_mfma_f32_16x16x32_bf16 v[8:11], v[60:63], v[120:123], v[8:11]
    ds_read_b64_tr_b16 v[56:57], v89 offset:36864
    v_mfma_f32_16x16x32_bf16 v[24:27], v[60:63], v[124:127], v[24:27]
    ds_read_b64_tr_b16 v[58:59], v237 offset:36864
    buffer_load_dwordx4 v[112:115], v224, s[40:43], s69 offen offset:3072 sc1
    v_mfma_f32_16x16x32_bf16 v[12:15], v[64:67], v[120:123], v[12:15]
    ds_read_b64_tr_b16 v[60:61], v90 offset:36864
    v_mfma_f32_16x16x32_bf16 v[28:31], v[64:67], v[124:127], v[28:31]
    ds_read_b64_tr_b16 v[62:63], v238 offset:36864
    v_mfma_f32_16x16x32_bf16 v[16:19], v[68:71], v[120:123], v[16:19]
    ds_read_b64_tr_b16 v[64:65], v91 offset:36864
    v_mfma_f32_16x16x32_bf16 v[32:35], v[68:71], v[124:127], v[32:35]
    ds_read_b64_tr_b16 v[66:67], v239 offset:36864
    buffer_load_dwordx4 v[116:119], v225, s[40:43], s69 offen offset:3072 sc1
    s_waitcnt lgkmcnt(8)
    v_readfirstlane_b32 s37, v1
    s_nop 0
    s_cmp_ge_u32 s37, 4
    s_cbranch_scc1 L_sl_done_59
    s_mov_b32 s38, 1048576
L_sl_loop_60:
    ds_read_b32 v1, v228 offset:12
    s_waitcnt lgkmcnt(0)
    v_readfirstlane_b32 s37, v1
    s_nop 0
    s_cmp_ge_u32 s37, 4
    s_cbranch_scc1 L_sl_done_59
    s_sleep 1
    s_sub_u32 s38, s38, 1
    s_cbranch_scc0 L_sl_loop_60
L_sl_done_59:
    s_waitcnt vmcnt(10)
    v_mfma_f32_16x16x32_bf16 v[4:7], v[36:39], v[128:131], v[4:7]
    ds_read_b64_tr_b16 v[68:69], v92 offset:0
    v_mfma_f32_16x16x32_bf16 v[20:23], v[36:39], v[132:135], v[20:23]
    ds_read_b64_tr_b16 v[70:71], v240 offset:0
    v_mfma_f32_16x16x32_bf16 v[8:11], v[40:43], v[128:131], v[8:11]
    ds_read_b64_tr_b16 v[36:37], v93 offset:0
    v_mfma_f32_16x16x32_bf16 v[24:27], v[40:43], v[132:135], v[24:27]
    ds_read_b64_tr_b16 v[38:39], v241 offset:0
    buffer_load_dwordx4 v[120:123], v224, s[40:43], s70 offen offset:0 sc1
    v_mfma_f32_16x16x32_bf16 v[12:15], v[44:47], v[128:131], v[12:15]
    ds_read_b64_tr_b16 v[40:41], v94 offset:0
    v_mfma_f32_16x16x32_bf16 v[28:31], v[44:47], v[132:135], v[28:31]
    ds_read_b64_tr_b16 v[42:43], v242 offset:0
    v_mfma_f32_16x16x32_bf16 v[16:19], v[48:51], v[128:131], v[16:19]
    ds_read_b64_tr_b16 v[44:45], v95 offset:0
    v_mfma_f32_16x16x32_bf16 v[32:35], v[48:51], v[132:135], v[32:35]
    ds_read_b64_tr_b16 v[46:47], v243 offset:0
    buffer_load_dwordx4 v[124:127], v225, s[40:43], s70 offen offset:0 sc1
    s_waitcnt vmcnt(10) lgkmcnt(8)
    v_mfma_f32_16x16x32_bf16 v[4:7], v[52:55], v[136:139], v[4:7]
    ds_read_b64_tr_b16 v[48:49], v92 offset:4096
    v_mfma_f32_16x16x32_bf16 v[20:23], v[52:55], v[140:143], v[20:23]
    ds_read_b64_tr_b16 v[50:51], v240 offset:4096
    v_mfma_f32_16x16x32_bf16 v[8:11], v[56:59], v[136:139], v[8:11]
    ds_read_b64_tr_b16 v[52:53], v93 offset:4096
    v_mfma_f32_16x16x32_bf16 v[24:27], v[56:59], v[140:143], v[24:27]
    ds_read_b64_tr_b16 v[54:55], v241 offset:4096
    buffer_load_dwordx4 v[128:131], v224, s[40:43], s70 offen offset:1024 sc1
    v_mfma_f32_16x16x32_bf16 v[12:15], v[60:63], v[136:139], v[12:15]
    ds_read_b64_tr_b16 v[56:57], v94 offset:4096
    v_mfma_f32_16x16x32_bf16 v[28:31], v[60:63], v[140:143], v[28:31]
    ds_read_b64_tr_b16 v[58:59], v242 offset:4096
    v_mfma_f32_16x16x32_bf16 v[16:19], v[64:67], v[136:139], v[16:19]
    ds_read_b64_tr_b16 v[60:61], v95 offset:4096
    v_mfma_f32_16x16x32_bf16 v[32:35], v[64:67], v[140:143], v[32:35]
    ds_read_b64_tr_b16 v[62:63], v243 offset:4096
    buffer_load_dwordx4 v[132:135], v225, s[40:43], s70 offen offset:1024 sc1
    s_waitcnt vmcnt(10) lgkmcnt(8)
    v_mfma_f32_16x16x32_bf16 v[4:7], v[68:71], v[144:147], v[4:7]
    ds_read_b64_tr_b16 v[64:65], v92 offset:8448
    v_mfma_f32_16x16x32_bf16 v[20:23], v[68:71], v[148:151], v[20:23]
    ds_read_b64_tr_b16 v[66:67], v240 offset:8448
    v_mfma_f32_16x16x32_bf16 v[8:11], v[36:39], v[144:147], v[8:11]
    ds_read_b64_tr_b16 v[68:69], v93 offset:8448
    v_mfma_f32_16x16x32_bf16 v[24:27], v[36:39], v[148:151], v[24:27]
    ds_read_b64_tr_b16 v[70:71], v241 offset:8448
    buffer_load_dwordx4 v[136:139], v224, s[40:43], s70 offen offset:2048 sc1
    v_mfma_f32_16x16x32_bf16 v[12:15], v[40:43], v[144:147], v[12:15]
    ds_read_b64_tr_b16 v[36:37], v94 offset:8448
    v_mfma_f32_16x16x32_bf16 v[28:31], v[40:43], v[148:151], v[28:31]
    ds_read_b64_tr_b16 v[38:39], v242 offset:8448
    v_mfma_f32_16x16x32_bf16 v[16:19], v[44:47], v[144:147], v[16:19]
    ds_read_b64_tr_b16 v[40:41], v95 offset:8448
    v_mfma_f32_16x16x32_bf16 v[32:35], v[44:47], v[148:151], v[32:35]
    ds_read_b64_tr_b16 v[42:43], v243 offset:8448
    buffer_load_dwordx4 v[140:143], v225, s[40:43], s70 offen offset:2048 sc1
    s_waitcnt vmcnt(10) lgkmcnt(8)
    v_mfma_f32_16x16x32_bf16 v[4:7], v[48:51], v[96:99], v[4:7]
    ds_read_b64_tr_b16 v[44:45], v92 offset:12544
    v_mfma_f32_16x16x32_bf16 v[20:23], v[48:51], v[100:103], v[20:23]
    ds_read_b64_tr_b16 v[46:47], v240 offset:12544
    v_mfma_f32_16x16x32_bf16 v[8:11], v[52:55], v[96:99], v[8:11]
    ds_read_b64_tr_b16 v[48:49], v93 offset:12544
    v_mfma_f32_16x16x32_bf16 v[24:27], v[52:55], v[100:103], v[24:27]
    ds_read_b64_tr_b16 v[50:51], v241 offset:12544
    buffer_load_dwordx4 v[144:147], v224, s[40:43], s70 offen offset:3072 sc1
    v_mfma_f32_16x16x32_bf16 v[12:15], v[56:59], v[96:99], v[12:15]
    ds_read_b64_tr_b16 v[52:53], v94 offset:12544
    v_mfma_f32_16x16x32_bf16 v[28:31], v[56:59], v[100:103], v[28:31]
    ds_read_b64_tr_b16 v[54:55], v242 offset:12544
    v_mfma_f32_16x16x32_bf16 v[16:19], v[60:63], v[96:99], v[16:19]
    ds_read_b64_tr_b16 v[56:57], v95 offset:12544
    v_mfma_f32_16x16x32_bf16 v[32:35], v[60:63], v[100:103], v[32:35]
    ds_read_b64_tr_b16 v[58:59], v243 offset:12544
    buffer_load_dwordx4 v[148:151], v225, s[40:43], s70 offen offset:3072 sc1
    s_waitcnt vmcnt(10) lgkmcnt(8)
    v_mfma_f32_16x16x32_bf16 v[4:7], v[64:67], v[104:107], v[4:7]
    ds_read_b64_tr_b16 v[60:61], v92 offset:16896
    v_mfma_f32_16x16x32_bf16 v[20:23], v[64:67], v[108:111], v[20:23]
    ds_read_b64_tr_b16 v[62:63], v240 offset:16896
    v_mfma_f32_16x16x32_bf16 v[8:11], v[68:71], v[104:107], v[8:11]
    ds_read_b64_tr_b16 v[64:65], v93 offset:16896
    v_mfma_f32_16x16x32_bf16 v[24:27], v[68:71], v[108:111], v[24:27]
    ds_read_b64_tr_b16 v[66:67], v241 offset:16896
    buffer_load_dwordx4 v[96:99], v224, s[40:43], s71 offen offset:0 sc1
    v_mfma_f32_16x16x32_bf16 v[12:15], v[36:39], v[104:107], v[12:15]
    ds_read_b64_tr_b16 v[68:69], v94 offset:16896
    v_mfma_f32_16x16x32_bf16 v[28:31], v[36:39], v[108:111], v[28:31]
    ds_read_b64_tr_b16 v[70:71], v242 offset:16896
    v_mfma_f32_16x16x32_bf16 v[16:19], v[40:43], v[104:107], v[16:19]
    ds_read_b64_tr_b16 v[36:37], v95 offset:16896
    v_mfma_f32_16x16x32_bf16 v[32:35], v[40:43], v[108:111], v[32:35]
    ds_read_b64_tr_b16 v[38:39], v243 offset:16896
    buffer_load_dwordx4 v[100:103], v225, s[40:43], s71 offen offset:0 sc1
    s_waitcnt vmcnt(10) lgkmcnt(8)
    v_mfma_f32_16x16x32_bf16 v[4:7], v[44:47], v[112:115], v[4:7]
    ds_read_b64_tr_b16 v[40:41], v92 offset:20992
    v_mfma_f32_16x16x32_bf16 v[20:23], v[44:47], v[116:119], v[20:23]
    ds_read_b64_tr_b16 v[42:43], v240 offset:20992
    v_mfma_f32_16x16x32_bf16 v[8:11], v[48:51], v[112:115], v[8:11]
    ds_read_b64_tr_b16 v[44:45], v93 offset:20992
    v_mfma_f32_16x16x32_bf16 v[24:27], v[48:51], v[116:119], v[24:27]
    ds_read_b64_tr_b16 v[46:47], v241 offset:20992
    buffer_load_dwordx4 v[104:107], v224, s[40:43], s71 offen offset:1024 sc1
    v_mfma_f32_16x16x32_bf16 v[12:15], v[52:55], v[112:115], v[12:15]
    ds_read_b64_tr_b16 v[48:49], v94 offset:20992
    v_mfma_f32_16x16x32_bf16 v[28:31], v[52:55], v[116:119], v[28:31]
    ds_read_b64_tr_b16 v[50:51], v242 offset:20992
    v_mfma_f32_16x16x32_bf16 v[16:19], v[56:59], v[112:115], v[16:19]
    ds_read_b64_tr_b16 v[52:53], v95 offset:20992
    v_mfma_f32_16x16x32_bf16 v[32:35], v[56:59], v[116:119], v[32:35]
    ds_read_b64_tr_b16 v[54:55], v243 offset:20992
    buffer_load_dwordx4 v[108:111], v225, s[40:43], s71 offen offset:1024 sc1
    s_waitcnt vmcnt(10) lgkmcnt(8)
    v_mfma_f32_16x16x32_bf16 v[4:7], v[60:63], v[120:123], v[4:7]
    ds_read_b64_tr_b16 v[56:57], v92 offset:25344
    v_mfma_f32_16x16x32_bf16 v[20:23], v[60:63], v[124:127], v[20:23]
    ds_read_b64_tr_b16 v[58:59], v240 offset:25344
    v_mfma_f32_16x16x32_bf16 v[8:11], v[64:67], v[120:123], v[8:11]
    ds_read_b64_tr_b16 v[60:61], v93 offset:25344
    v_mfma_f32_16x16x32_bf16 v[24:27], v[64:67], v[124:127], v[24:27]
    ds_read_b64_tr_b16 v[62:63], v241 offset:25344
    buffer_load_dwordx4 v[112:115], v224, s[40:43], s71 offen offset:2048 sc1
    v_mfma_f32_16x16x32_bf16 v[12:15], v[68:71], v[120:123], v[12:15]
    ds_read_b64_tr_b16 v[64:65], v94 offset:25344
    v_mfma_f32_16x16x32_bf16 v[28:31], v[68:71], v[124:127], v[28:31]
    ds_read_b64_tr_b16 v[66:67], v242 offset:25344
    v_mfma_f32_16x16x32_bf16 v[16:19], v[36:39], v[120:123], v[16:19]
    ds_read_b64_tr_b16 v[68:69], v95 offset:25344
    v_mfma_f32_16x16x32_bf16 v[32:35], v[36:39], v[124:127], v[32:35]
    ds_read_b64_tr_b16 v[70:71], v243 offset:25344
    buffer_load_dwordx4 v[116:119], v225, s[40:43], s71 offen offset:2048 sc1
    s_waitcnt vmcnt(10) lgkmcnt(8)
    v_mfma_f32_16x16x32_bf16 v[4:7], v[40:43], v[128:131], v[4:7]
    ds_read_b64_tr_b16 v[36:37], v92 offset:29440
    v_mfma_f32_16x16x32_bf16 v[20:23], v[40:43], v[132:135], v[20:23]
    ds_read_b64_tr_b16 v[38:39], v240 offset:29440
    v_mfma_f32_16x16x32_bf16 v[8:11], v[44:47], v[128:131], v[8:11]
    ds_read_b64_tr_b16 v[40:41], v93 offset:29440
    v_mfma_f32_16x16x32_bf16 v[24:27], v[44:47], v[132:135], v[24:27]
    ds_read_b64_tr_b16 v[42:43], v241 offset:29440
    buffer_load_dwordx4 v[120:123], v224, s[40:43], s71 offen offset:3072 sc1
    v_mfma_f32_16x16x32_bf16 v[12:15], v[48:51], v[128:131], v[12:15]
    ds_read_b64_tr_b16 v[44:45], v94 offset:29440
    v_mfma_f32_16x16x32_bf16 v[28:31], v[48:51], v[132:135], v[28:31]
    ds_read_b64_tr_b16 v[46:47], v242 offset:29440
    v_mfma_f32_16x16x32_bf16 v[16:19], v[52:55], v[128:131], v[16:19]
    ds_read_b64_tr_b16 v[48:49], v95 offset:29440
    v_mfma_f32_16x16x32_bf16 v[32:35], v[52:55], v[132:135], v[32:35]
    ds_read_b64_tr_b16 v[50:51], v243 offset:29440
    buffer_load_dwordx4 v[124:127], v225, s[40:43], s71 offen offset:3072 sc1
    s_waitcnt vmcnt(10) lgkmcnt(8)
    v_mfma_f32_16x16x32_bf16 v[4:7], v[56:59], v[136:139], v[4:7]
    ds_read_b64_tr_b16 v[52:53], v84 offset:41984
    v_mfma_f32_16x16x32_bf16 v[20:23], v[56:59], v[140:143], v[20:23]
    ds_read_b64_tr_b16 v[54:55], v232 offset:41984
    v_mfma_f32_16x16x32_bf16 v[8:11], v[60:63], v[136:139], v[8:11]
    ds_read_b64_tr_b16 v[56:57], v85 offset:41984
    v_mfma_f32_16x16x32_bf16 v[24:27], v[60:63], v[140:143], v[24:27]
    ds_read_b64_tr_b16 v[58:59], v233 offset:41984
    v_mfma_f32_16x16x32_bf16 v[12:15], v[64:67], v[136:139], v[12:15]
    ds_read_b64_tr_b16 v[60:61], v86 offset:41984
    v_mfma_f32_16x16x32_bf16 v[28:31], v[64:67], v[140:143], v[28:31]
    ds_read_b64_tr_b16 v[62:63], v234 offset:41984
    v_mfma_f32_16x16x32_bf16 v[16:19], v[68:71], v[136:139], v[16:19]
    ds_read_b64_tr_b16 v[64:65], v87 offset:41984
    v_mfma_f32_16x16x32_bf16 v[32:35], v[68:71], v[140:143], v[32:35]
    ds_read_b64_tr_b16 v[66:67], v235 offset:41984
    s_waitcnt vmcnt(8) lgkmcnt(8)
    v_mfma_f32_16x16x32_bf16 v[4:7], v[36:39], v[144:147], v[4:7]
    ds_read_b64_tr_b16 v[68:69], v84 offset:46080
    v_mfma_f32_16x16x32_bf16 v[20:23], v[36:39], v[148:151], v[20:23]
    ds_read_b64_tr_b16 v[70:71], v232 offset:46080
    v_mfma_f32_16x16x32_bf16 v[8:11], v[40:43], v[144:147], v[8:11]
    ds_read_b64_tr_b16 v[36:37], v85 offset:46080
    v_mfma_f32_16x16x32_bf16 v[24:27], v[40:43], v[148:151], v[24:27]
    ds_read_b64_tr_b16 v[38:39], v233 offset:46080
    v_mfma_f32_16x16x32_bf16 v[12:15], v[44:47], v[144:147], v[12:15]
    ds_read_b64_tr_b16 v[40:41], v86 offset:46080
    v_mfma_f32_16x16x32_bf16 v[28:31], v[44:47], v[148:151], v[28:31]
    ds_read_b64_tr_b16 v[42:43], v234 offset:46080
    v_mfma_f32_16x16x32_bf16 v[16:19], v[48:51], v[144:147], v[16:19]
    ds_read_b64_tr_b16 v[44:45], v87 offset:46080
    v_mfma_f32_16x16x32_bf16 v[32:35], v[48:51], v[148:151], v[32:35]
    ds_read_b64_tr_b16 v[46:47], v235 offset:46080
    s_waitcnt vmcnt(6) lgkmcnt(8)
    v_mfma_f32_16x16x32_bf16 v[4:7], v[52:55], v[96:99], v[4:7]
    ds_read_b64_tr_b16 v[48:49], v84 offset:51200
    v_mfma_f32_16x16x32_bf16 v[20:23], v[52:55], v[100:103], v[20:23]
    ds_read_b64_tr_b16 v[50:51], v232 offset:51200
    v_mfma_f32_16x16x32_bf16 v[8:11], v[56:59], v[96:99], v[8:11]
    ds_read_b64_tr_b16 v[52:53], v85 offset:51200
    v_mfma_f32_16x16x32_bf16 v[24:27], v[56:59], v[100:103], v[24:27]
    ds_read_b64_tr_b16 v[54:55], v233 offset:51200
    v_mfma_f32_16x16x32_bf16 v[12:15], v[60:63], v[96:99], v[12:15]
    ds_read_b64_tr_b16 v[56:57], v86 offset:51200
    v_mfma_f32_16x16x32_bf16 v[28:31], v[60:63], v[100:103], v[28:31]
    ds_read_b64_tr_b16 v[58:59], v234 offset:51200
    v_mfma_f32_16x16x32_bf16 v[16:19], v[64:67], v[96:99], v[16:19]
    ds_read_b64_tr_b16 v[60:61], v87 offset:51200
    v_mfma_f32_16x16x32_bf16 v[32:35], v[64:67], v[100:103], v[32:35]
    ds_read_b64_tr_b16 v[62:63], v235 offset:51200
    s_waitcnt vmcnt(4) lgkmcnt(8)
    v_mfma_f32_16x16x32_bf16 v[4:7], v[68:71], v[104:107], v[4:7]
    ds_read_b64_tr_b16 v[64:65], v84 offset:55296
    v_mfma_f32_16x16x32_bf16 v[20:23], v[68:71], v[108:111], v[20:23]
    ds_read_b64_tr_b16 v[66:67], v232 offset:55296
    v_mfma_f32_16x16x32_bf16 v[8:11], v[36:39], v[104:107], v[8:11]
    ds_read_b64_tr_b16 v[68:69], v85 offset:55296
    v_mfma_f32_16x16x32_bf16 v[24:27], v[36:39], v[108:111], v[24:27]
    ds_read_b64_tr_b16 v[70:71], v233 offset:55296
    v_mfma_f32_16x16x32_bf16 v[12:15], v[40:43], v[104:107], v[12:15]
    ds_read_b64_tr_b16 v[36:37], v86 offset:55296
    v_mfma_f32_16x16x32_bf16 v[28:31], v[40:43], v[108:111], v[28:31]
    ds_read_b64_tr_b16 v[38:39], v234 offset:55296
    v_mfma_f32_16x16x32_bf16 v[16:19], v[44:47], v[104:107], v[16:19]
    ds_read_b64_tr_b16 v[40:41], v87 offset:55296
    v_mfma_f32_16x16x32_bf16 v[32:35], v[44:47], v[108:111], v[32:35]
    ds_read_b64_tr_b16 v[42:43], v235 offset:55296
    s_waitcnt vmcnt(2) lgkmcnt(8)
    v_mfma_f32_16x16x32_bf16 v[4:7], v[48:51], v[112:115], v[4:7]
    v_mfma_f32_16x16x32_bf16 v[8:11], v[52:55], v[112:115], v[8:11]
    v_mfma_f32_16x16x32_bf16 v[12:15], v[56:59], v[112:115], v[12:15]
    v_mfma_f32_16x16x32_bf16 v[16:19], v[60:63], v[112:115], v[16:19]
    s_waitcnt vmcnt(0) lgkmcnt(0)
    v_mfma_f32_16x16x32_bf16 v[4:7], v[64:67], v[120:123], v[4:7]
    s_nop 0
    s_nop 0
    v_mfma_f32_16x16x32_bf16 v[8:11], v[68:71], v[120:123], v[8:11]
    s_nop 0
    s_nop 0
    v_mfma_f32_16x16x32_bf16 v[12:15], v[36:39], v[120:123], v[12:15]
    s_nop 0
    s_nop 0
    v_cvt_pk_bf16_f32 v172, v4, v5
    v_cvt_pk_bf16_f32 v173, v6, v7
    v_mfma_f32_16x16x32_bf16 v[16:19], v[40:43], v[120:123], v[16:19]
    ds_write_b64 v244, v[172:173]
    v_cvt_pk_bf16_f32 v174, v8, v9
    v_mfma_f32_16x16x32_bf16 v[20:23], v[48:51], v[116:119], v[20:23]
    v_cvt_pk_bf16_f32 v175, v10, v11
    ds_write_b64 v245, v[174:175]
    v_mfma_f32_16x16x32_bf16 v[20:23], v[64:67], v[124:127], v[20:23]
    v_cvt_pk_bf16_f32 v176, v12, v13
    v_cvt_pk_bf16_f32 v177, v14, v15
    v_mfma_f32_16x16x32_bf16 v[24:27], v[52:55], v[116:119], v[24:27]
    ds_write_b64 v246, v[176:177]
    v_cvt_pk_bf16_f32 v178, v16, v17
    v_mfma_f32_16x16x32_bf16 v[24:27], v[68:71], v[124:127], v[24:27]
    v_cvt_pk_bf16_f32 v179, v18, v19
    ds_write_b64 v247, v[178:179]
    v_mfma_f32_16x16x32_bf16 v[28:31], v[56:59], v[116:119], v[28:31]
    ds_read_b128 v[188:191], v248 offset:0
    ds_read_b128 v[192:195], v248 offset:1024
    v_mfma_f32_16x16x32_bf16 v[28:31], v[36:39], v[124:127], v[28:31]
    v_cvt_pk_bf16_f32 v180, v20, v21
    v_cvt_pk_bf16_f32 v181, v22, v23
    v_mfma_f32_16x16x32_bf16 v[32:35], v[60:63], v[116:119], v[32:35]
    ds_write_b64 v244, v[180:181]
    v_cvt_pk_bf16_f32 v182, v24, v25
    v_mfma_f32_16x16x32_bf16 v[32:35], v[40:43], v[124:127], v[32:35]
    v_cvt_pk_bf16_f32 v183, v26, v27
    ds_write_b64 v245, v[182:183]
    v_cvt_pk_bf16_f32 v184, v28, v29
    v_cvt_pk_bf16_f32 v185, v30, v31
    s_mov_b32 s37, 0
    s_waitcnt lgkmcnt(3)
    buffer_store_dwordx4 v[188:191], v226, s[48:51], s37 offen nt
    s_mov_b32 s37, 65536
    s_waitcnt lgkmcnt(2)
    buffer_store_dwordx4 v[192:195], v226, s[48:51], s37 offen nt
    ds_write_b64 v246, v[184:185]
    v_cvt_pk_bf16_f32 v186, v32, v33
    v_cvt_pk_bf16_f32 v187, v34, v35
    ds_write_b64 v247, v[186:187]
    ds_read_b128 v[196:199], v248 offset:0
    ds_read_b128 v[200:203], v248 offset:1024
    s_mov_b32 s37, 131072
    s_waitcnt lgkmcnt(1)
    buffer_store_dwordx4 v[196:199], v226, s[48:51], s37 offen nt
    s_mov_b32 s37, 196608
    s_waitcnt lgkmcnt(0)
    buffer_store_dwordx4 v[200:203], v226, s[48:51], s37 offen nt
    s_endpgm
L_end:
    s_endpgm
.section .rodata,"a"
.p2align 6
.amdhsa_kernel concat_heads__ssm_conv_h3__sliding_local_dilated__prompt_kernel
  .amdhsa_next_free_vgpr 256
  .amdhsa_next_free_sgpr 102
  .amdhsa_accum_offset 256
  .amdhsa_group_segment_fixed_size 0
  .amdhsa_kernarg_size 96
  .amdhsa_user_sgpr_count 2
  .amdhsa_user_sgpr_kernarg_segment_ptr 1
  .amdhsa_system_sgpr_workgroup_id_x 1
  .amdhsa_float_denorm_mode_32 3
.end_amdhsa_kernel
```

```asm
; @launch grid=(256,1,1) block=(512,1,1) lds=163840
.amdgcn_target "amdgcn-amd-amdhsa--gfx950"
.text
.globl concat_heads__ssm_conv_h3__sliding_local_dilated__prompt_kernel
.p2align 8
.type concat_heads__ssm_conv_h3__sliding_local_dilated__prompt_kernel,@function
concat_heads__ssm_conv_h3__sliding_local_dilated__prompt_kernel:
L_entry:
    s_getpc_b64 s[32:33]
    s_cmp_ge_u32 s2, 256
    s_cbranch_scc1 L_end
    s_load_dwordx16 s[8:23], s[0:1], 0
    s_load_dwordx8 s[24:31], s[0:1], 64
    v_lshrrev_b32 v1, 6, v0
    s_and_b32 s4, s2, 1
    v_readfirstlane_b32 s3, v1
    v_and_b32 v0, 63, v0
    s_bfe_u32 s5, s2, 0x30003
    s_bfe_u32 s6, s2, 0x20001
    s_lshr_b32 s7, s2, 6
    s_lshl2_add_u32 s6, s6, s7
    s_cmp_ge_u32 s3, 4
    s_cbranch_scc1 L_crole
    s_bfe_u32 s34, s2, 0x20003
    s_lshl2_add_u32 s34, s34, s3
    s_lshl_b32 s34, s34, 7
    v_lshl_add_u32 v1, v0, 11, s34
    v_min_u32 v1, L_end-L_entry-8, v1
    s_mov_b64 exec, 0xffff
    global_load_dword v249, v1, s[32:33]
    s_mov_b64 exec, -1
    s_and_b32 s84, s2, 3
    s_lshl2_add_u32 s84, s84, s3
    s_lshr_b32 s85, s2, 2
    s_mul_i32 s86, s3, 8448
    s_add_u32 s86, s86, 125952
    s_lshl_b32 s87, s85, 9
    s_add_u32 s87, s87, s84
    s_lshl_b32 s87, s87, 7
    v_and_b32 v231, 7, v0
    v_lshl_add_u32 v231, v231, 4, s87
    v_lshrrev_b32 v230, 3, v0
    v_lshl_add_u32 v230, v230, 13, v231
    v_subrev_u32 v231, 6144, v230
    v_subrev_u32 v232, 4096, v230
    v_subrev_u32 v233, 2048, v230
    v_add_u32 v234, 4096, v230
    v_lshlrev_b32 v235, 4, v0
    s_lshl_b32 s87, s84, 9
    s_add_u32 m0, s86, 4224
    s_waitcnt lgkmcnt(0)
    s_mov_b32 s80, s14
    s_mov_b32 s81, s15
    s_mov_b32 s82, 0x2000
    s_mov_b32 s83, 0x20000
    s_mov_b32 s72, s10
    s_mov_b32 s73, s11
    s_mov_b32 s74, 0x400000
    s_mov_b32 s75, 0x20000
    s_mov_b32 exec_hi, 0
    buffer_load_dwordx4 v235, s[80:83], s87 offen lds
    s_mov_b64 exec, -1
    buffer_load_dwordx4 v[108:111], v231, s[72:75], 0 offen offset:0 nt
    buffer_load_dwordx4 v[112:115], v232, s[72:75], 0 offen offset:0 nt
    buffer_load_dwordx4 v[116:119], v233, s[72:75], 0 offen offset:0 nt
    buffer_load_dwordx4 v[120:123], v230, s[72:75], 0 offen offset:0 nt
    buffer_load_dwordx4 v[124:127], v230, s[72:75], 0 offen offset:2048 nt
    buffer_load_dwordx4 v[128:131], v234, s[72:75], 0 offen offset:0 nt
    buffer_load_dwordx4 v[132:135], v234, s[72:75], 0 offen offset:2048 nt
    s_mov_b32 s76, s12
    s_mov_b32 s77, s13
    s_mov_b32 s78, 0x400000
    s_mov_b32 s79, 0x20000
    buffer_load_dwordx4 v[136:139], v230, s[76:79], 0 offen offset:0 nt
    buffer_load_dwordx4 v[140:143], v230, s[76:79], 0 offen offset:2048 nt
    buffer_load_dwordx4 v[144:147], v234, s[76:79], 0 offen offset:0 nt
    buffer_load_dwordx4 v[148:151], v234, s[76:79], 0 offen offset:2048 nt
    s_branch L_grole
L_crole:
    s_sub_u32 s70, s3, 4
    s_lshl_b32 s43, s70, 12
    s_lshl_b32 s44, s70, 11
    s_add_u32 s44, s44, 17408
    s_lshl_b32 s49, s70, 4
    s_lshl_b64 s[46:47], 0xffff, s49
    v_lshrrev_b32 v13, 3, v0
    v_and_b32 v14, 7, v0
    v_lshrrev_b32 v15, 4, v0
    s_lshl2_add_u32 s50, s5, s70
    s_lshl_b32 s50, s50, 6
    s_add_u32 s50, s50, s4
    s_lshl_b32 s50, s50, 11
    v_lshl_add_u32 v16, v13, 12, s50
    v_xor_b32 v17, v14, v15
    v_lshl_add_u32 v2, v17, 4, v16
    v_xor_b32 v3, 64, v2
    v_add_u32 v3, 31744, v3
    v_add_u32 v4, 63488, v2
    v_add_u32 v5, 63488, v3
    s_lshl_b32 s49, s5, 7
    s_sub_u32 s49, s49, 8
    s_max_i32 s49, s49, 0
    s_lshl1_add_u32 s49, s49, s4
    s_lshl_b32 s49, s49, 11
    v_lshl_add_u32 v16, v13, 12, s49
    v_lshlrev_b32 v17, 1, v15
    v_xor_b32 v18, v14, v13
    v_lshl_add_u32 v6, v18, 4, v16
    s_mul_i32 s49, s70, 768
    s_add_u32 s49, s49, s6
    s_lshl_b32 s49, s49, 7
    v_mul_u32_u24 v16, 6144, v13
    v_and_b32 v17, 2, v17
    v_xor_b32 v17, v14, v17
    v_lshlrev_b32 v17, 4, v17
    v_add3_u32 v7, v17, v16, s49
    v_xor_b32 v8, 64, v7
    v_add_u32 v8, 48128, v8
    v_add_u32 v9, 2048, v7
    v_add_u32 v10, 2048, v8
    v_add_u32 v11, 4096, v7
    v_add_u32 v12, 4096, v8
    s_movk_i32 s40, 0
    s_mov_b32 s41, 0
    s_lshr_b32 s90, s2, 3
    s_and_b32 s91, s3, 3
    s_lshl2_add_u32 s90, s90, s91
    s_and_b32 s91, s2, 6
    s_lshl3_add_u32 s88, s90, s91
    s_lshl1_add_u32 s88, s88, s4
    s_lshl_b32 s88, s88, 11
    s_and_b32 s89, s2, 7
    s_and_b32 s91, s90, 1
    s_lshl1_add_u32 s89, s89, s91
    s_lshr_b32 s90, s90, 1
    s_mul_i32 s90, s90, 48
    s_add_u32 s89, s89, s90
    s_lshl_b32 s89, s89, 7
    v_and_b32 v251, 1, v0
    v_lshlrev_b32 v251, 12, v251
    v_lshrrev_b32 v252, 1, v0
    v_lshl_add_u32 v251, v252, 7, v251
    v_lshrrev_b32 v250, 2, v0
    v_mul_u32_u24 v250, 393216, v250
    v_and_b32 v252, 3, v0
    v_lshl_add_u32 v252, v252, 11, v250
    s_waitcnt lgkmcnt(0)
    s_mov_b32 s32, s20
    s_mov_b32 s33, s21
    s_mov_b32 s34, 0x400000
    s_mov_b32 s35, 0x20000
    s_mov_b32 s36, s22
    s_mov_b32 s37, s23
    s_mov_b32 s38, 0x600000
    s_mov_b32 s39, 0x20000
    s_setprio 0
    s_and_b32 s73, s2, 7
    s_xor_b32 s73, s73, 2
    s_lshr_b32 s74, s2, 7
    s_lshl1_add_u32 s68, s73, s74
    s_bfe_u32 s69, s2, 0x40003
    s_lshl4_add_u32 s71, s68, s69
    s_lshl2_add_u32 s71, s71, s70
    s_mul_i32 s80, s70, 8448
    s_add_u32 s80, s80, 125952
    s_mul_i32 s81, s70, 9216
    s_add_u32 s81, s81, 41984
    s_add_u32 s52, s30, 0xe00000
    s_addc_u32 s53, s31, 0
    s_mov_b32 s54, 0x20000
    s_mov_b32 s55, 0x20000
    s_add_u32 s64, s30, 0x900000
    s_addc_u32 s65, s31, 0
    s_mov_b32 s66, 0x420000
    s_mov_b32 s67, 0x20000
    s_lshl_b32 s84, s71, 12
    s_mul_i32 s85, s71, 4224
    s_add_u32 s85, s85, 4194304
    s_lshr_b32 s72, s71, 1
    s_lshl_b32 s72, s72, 2
    s_load_dword s72, s[18:19], s72
    v_lshlrev_b32 v224, 4, v0
    v_mov_b32 v228, 0
    v_mov_b32 v229, 0
    v_mov_b32 v230, 0
    v_mov_b32 v231, 0
    v_mov_b32 v227, 134352
    v_mov_b32 v244, 1
    s_bfe_u32 s87, s2, 0x20006
    s_mov_b64 exec, 1
    ds_write_b128 v227, v[228:231]
    ds_write_b128 v227, v[228:231] offset:16
    ds_write_b128 v227, v[228:231] offset:32
    s_mov_b64 exec, -1
    s_mov_b32 exec_lo, 0x7777
    s_mov_b32 exec_hi, 0x0
    s_bfe_u32 s7, s89, 0x30007
    s_cmp_lg_u32 s7, 1
    s_cbranch_scc1 L_wx3_1
    buffer_load_dword v250, v252, s[36:39], s89 offen offset:256
L_wx3_1:
    buffer_load_dword v250, v252, s[36:39], s89 offen
    s_mov_b32 exec_lo, 0xff
    s_mov_b32 exec_hi, 0
    buffer_load_dword v250, v251, s[32:35], s88 offen
    s_mov_b64 exec, -1
    s_add_u32 m0, s43, 0
    s_nop 0
    buffer_load_dwordx4 v2, s[32:35], s40 offen offset:0 lds
    s_add_u32 m0, s44, 0
    s_nop 0
    buffer_load_dwordx4 v7, s[36:39], s41 offen offset:0 lds
    buffer_load_dwordx4 v8, s[36:39], s41 offen offset:1024 lds
    s_add_u32 m0, s43, 0
    s_nop 0
    buffer_load_dwordx4 v3, s[32:35], s40 offen offset:1024 lds
    s_add_u32 m0, s44, 8192
    s_nop 0
    buffer_load_dwordx4 v9, s[36:39], s41 offen offset:0 lds
    buffer_load_dwordx4 v10, s[36:39], s41 offen offset:1024 lds
    s_add_u32 m0, s43, 0
    s_nop 0
    buffer_load_dwordx4 v4, s[32:35], s40 offen offset:2048 lds
    s_add_u32 m0, s44, 16384
    s_nop 0
    buffer_load_dwordx4 v11, s[36:39], s41 offen offset:0 lds
    buffer_load_dwordx4 v12, s[36:39], s41 offen offset:1024 lds
    s_add_u32 m0, s43, 0
    s_nop 0
    buffer_load_dwordx4 v5, s[32:35], s40 offen offset:3072 lds
    s_mov_b32 m0, 16384
    s_mov_b64 exec, s[46:47]
    buffer_load_dwordx4 v6, s[32:35], s40 offen lds
    s_mov_b64 exec, -1
    s_movk_i32 s40, 128
    s_mov_b32 s41, 393216
    s_add_u32 m0, s43, 41984
    s_nop 0
    buffer_load_dwordx4 v2, s[32:35], s40 offen offset:0 lds
    s_add_u32 m0, s44, 41984
    s_nop 0
    buffer_load_dwordx4 v7, s[36:39], s41 offen offset:0 lds
    buffer_load_dwordx4 v8, s[36:39], s41 offen offset:1024 lds
    s_add_u32 m0, s43, 41984
    s_nop 0
    buffer_load_dwordx4 v3, s[32:35], s40 offen offset:1024 lds
    s_add_u32 m0, s44, 50176
    s_nop 0
    buffer_load_dwordx4 v9, s[36:39], s41 offen offset:0 lds
    buffer_load_dwordx4 v10, s[36:39], s41 offen offset:1024 lds
    s_add_u32 m0, s43, 41984
    s_nop 0
    buffer_load_dwordx4 v4, s[32:35], s40 offen offset:2048 lds
    s_add_u32 m0, s44, 58368
    s_nop 0
    buffer_load_dwordx4 v11, s[36:39], s41 offen offset:0 lds
    buffer_load_dwordx4 v12, s[36:39], s41 offen offset:1024 lds
    s_add_u32 m0, s43, 41984
    s_nop 0
    buffer_load_dwordx4 v5, s[32:35], s40 offen offset:3072 lds
    s_mov_b32 m0, 58368
    s_mov_b64 exec, s[46:47]
    buffer_load_dwordx4 v6, s[32:35], s40 offen lds
    s_mov_b64 exec, -1
    s_movk_i32 s40, 256
    s_mov_b32 s41, 786432
    s_lshr_b32 s74, s69, 2
    s_and_b32 s75, s69, 3
    s_lshl3_add_u32 s74, s74, s75
    s_lshl3_add_u32 s74, s74, s70
    s_lshl_b32 s74, s74, 3
    v_bfe_u32 v234, v0, 3, 1
    v_lshl_add_u32 v225, v234, 8, s74
    v_bfe_u32 v234, v0, 4, 1
    v_lshl_add_u32 v225, v234, 1, v225
    v_lshrrev_b32 v234, 5, v0
    v_lshl_add_u32 v225, v234, 5, v225
    s_lshl_b32 s74, s68, 7
    v_and_b32 v234, 7, v0
    v_lshl_add_u32 v234, v234, 4, s74
    v_lshl_add_u32 v226, v225, 12, v234
    v_lshl_add_u32 v225, v225, 11, v234
    v_and_b32 v234, 1, v0
    v_xor_b32 v234, 1, v234
    v_mul_u32_u24 v232, 4224, v234
    v_mul_u32_u24 v233, 4576, v234
    v_bfe_u32 v234, v0, 1, 3
    v_lshl_add_u32 v232, v234, 3, v232
    v_xor_b32 v234, 7, v234
    v_lshl_add_u32 v233, v234, 6, v233
    v_lshrrev_b32 v234, 4, v0
    v_lshl_add_u32 v232, v234, 4, v232
    v_lshl_add_u32 v233, v234, 4, v233
    v_add3_u32 v232, v232, s80, 8
    v_add_u32 v233, s81, v233
    s_waitcnt lgkmcnt(0)
    s_bitcmp1_b32 s71, 0
    s_cselect_b32 s74, 0, 16
    s_lshl_b32 s72, s72, s74
    s_and_b32 s72, s72, 0xffff0000
    v_and_b32 v235, 1, v0
    v_lshlrev_b32 v235, 4, v235
    v_lshrrev_b32 v235, v235, s72
    v_bfe_u32 v236, v0, 1, 3
    v_lshl_add_u32 v236, v234, 1, v236
    v_cmp_eq_u32 vcc, 7, v236
    v_mov_b32 v241, 0
    v_mov_b32 v243, 0
    v_cndmask_b32 v240, 0, v235, vcc
    v_cmp_eq_u32 vcc, 6, v236
    s_nop 1
    v_cndmask_b32 v242, 0, v235, vcc
    s_lshr_b32 s7, s2, 6
    s_mul_i32 s90, s7, 1048576
    s_sub_u32 s88, s88, s90
    s_mul_i32 s90, s7, 98304
    s_sub_u32 s89, s89, s90
    v_lshrrev_b32 v20, 3, v0
    v_mul_u32_u24 v20, 1048064, v20
    v_add_u32 v251, v251, v20
    v_lshrrev_b32 v20, 4, v0
    v_mul_u32_u24 v20, 1474560, v20
    v_sub_u32 v252, v252, v20
    s_waitcnt vmcnt(11)
    s_barrier
    s_add_u32 m0, s43, 83968
    s_nop 0
    buffer_load_dwordx4 v2, s[32:35], s40 offen offset:0 lds
    s_add_u32 m0, s44, 83968
    s_nop 0
    buffer_load_dwordx4 v7, s[36:39], s41 offen offset:0 lds
    buffer_load_dwordx4 v8, s[36:39], s41 offen offset:1024 lds
    s_add_u32 m0, s43, 83968
    s_nop 0
    buffer_load_dwordx4 v3, s[32:35], s40 offen offset:1024 lds
    s_add_u32 m0, s44, 92160
    s_nop 0
    buffer_load_dwordx4 v9, s[36:39], s41 offen offset:0 lds
    buffer_load_dwordx4 v10, s[36:39], s41 offen offset:1024 lds
    s_add_u32 m0, s43, 83968
    s_nop 0
    buffer_load_dwordx4 v4, s[32:35], s40 offen offset:2048 lds
    s_add_u32 m0, s44, 100352
    s_nop 0
    buffer_load_dwordx4 v11, s[36:39], s41 offen offset:0 lds
    buffer_load_dwordx4 v12, s[36:39], s41 offen offset:1024 lds
    s_add_u32 m0, s43, 83968
    s_nop 0
    buffer_load_dwordx4 v5, s[32:35], s40 offen offset:3072 lds
    s_mov_b32 m0, 100352
    s_mov_b64 exec, s[46:47]
    buffer_load_dwordx4 v6, s[32:35], s40 offen lds
    s_mov_b64 exec, -1
    s_movk_i32 s40, 384
    s_mov_b32 s41, 1179648
    s_bitcmp0_b32 1, s87
    s_cbranch_scc1 L_stg_3
    s_add_u32 s6, s89, 1572864
    s_mov_b32 exec_lo, 0x770077
    s_mov_b32 exec_hi, 0x770077
    s_bfe_u32 s7, s89, 0x30007
    s_cmp_lg_u32 s7, 1
    s_cbranch_scc1 L_wx3_4
    buffer_load_dword v250, v252, s[36:39], s6 offen offset:256
L_wx3_4:
    buffer_load_dword v250, v252, s[36:39], s6 offen
    s_mov_b32 exec_lo, 0xf0f0f0f
    s_mov_b32 exec_hi, 0
    buffer_load_dword v250, v251, s[32:35], s88 offen offset:512
    s_mov_b64 exec, -1
L_stg_3:
    s_waitcnt vmcnt(13)
    s_bitcmp1_b32 1, s87
    s_cbranch_scc1 L_mw_5
    s_waitcnt vmcnt(11)
L_mw_5:
    s_barrier
    s_add_u32 m0, s43, 0
    s_nop 0
    buffer_load_dwordx4 v2, s[32:35], s40 offen offset:0 lds
    s_add_u32 m0, s44, 0
    s_nop 0
    buffer_load_dwordx4 v7, s[36:39], s41 offen offset:0 lds
    buffer_load_dwordx4 v8, s[36:39], s41 offen offset:1024 lds
    s_add_u32 m0, s43, 0
    s_nop 0
    buffer_load_dwordx4 v3, s[32:35], s40 offen offset:1024 lds
    s_add_u32 m0, s44, 8192
    s_nop 0
    buffer_load_dwordx4 v9, s[36:39], s41 offen offset:0 lds
    buffer_load_dwordx4 v10, s[36:39], s41 offen offset:1024 lds
    s_add_u32 m0, s43, 0
    s_nop 0
    buffer_load_dwordx4 v4, s[32:35], s40 offen offset:2048 lds
    s_add_u32 m0, s44, 16384
    s_nop 0
    buffer_load_dwordx4 v11, s[36:39], s41 offen offset:0 lds
    buffer_load_dwordx4 v12, s[36:39], s41 offen offset:1024 lds
    s_add_u32 m0, s43, 0
    s_nop 0
    buffer_load_dwordx4 v5, s[32:35], s40 offen offset:3072 lds
    s_mov_b32 m0, 16384
    s_mov_b64 exec, s[46:47]
    buffer_load_dwordx4 v6, s[32:35], s40 offen lds
    s_mov_b64 exec, -1
    s_movk_i32 s40, 512
    s_mov_b32 s41, 1572864
    s_bitcmp0_b32 2, s87
    s_cbranch_scc1 L_stg_6
    s_add_u32 s6, s89, 2359296
    s_mov_b32 exec_lo, 0x770077
    s_mov_b32 exec_hi, 0x770077
    s_bfe_u32 s7, s89, 0x30007
    s_cmp_lg_u32 s7, 1
    s_cbranch_scc1 L_wx3_7
    buffer_load_dword v250, v252, s[36:39], s6 offen offset:256
L_wx3_7:
    buffer_load_dword v250, v252, s[36:39], s6 offen
    s_mov_b32 exec_lo, 0xf0f0f0f
    s_mov_b32 exec_hi, 0
    buffer_load_dword v250, v251, s[32:35], s88 offen offset:768
    s_mov_b64 exec, -1
L_stg_6:
    s_load_dwordx2 s[90:91], s[16:17], s84 offset:60
    s_load_dwordx2 s[90:91], s[16:17], s84 offset:188
    s_load_dwordx2 s[90:91], s[16:17], s84 offset:316
    s_waitcnt vmcnt(13)
    s_bitcmp1_b32 3, s87
    s_cbranch_scc1 L_mw_8
    s_waitcnt vmcnt(11)
L_mw_8:
    s_barrier
    s_add_u32 m0, s43, 41984
    s_nop 0
    buffer_load_dwordx4 v2, s[32:35], s40 offen offset:0 lds
    s_add_u32 m0, s44, 41984
    s_nop 0
    buffer_load_dwordx4 v7, s[36:39], s41 offen offset:0 lds
    buffer_load_dwordx4 v8, s[36:39], s41 offen offset:1024 lds
    s_add_u32 m0, s43, 41984
    s_nop 0
    buffer_load_dwordx4 v3, s[32:35], s40 offen offset:1024 lds
    s_add_u32 m0, s44, 50176
    s_nop 0
    buffer_load_dwordx4 v9, s[36:39], s41 offen offset:0 lds
    buffer_load_dwordx4 v10, s[36:39], s41 offen offset:1024 lds
    s_add_u32 m0, s43, 41984
    s_nop 0
    buffer_load_dwordx4 v4, s[32:35], s40 offen offset:2048 lds
    s_add_u32 m0, s44, 58368
    s_nop 0
    buffer_load_dwordx4 v11, s[36:39], s41 offen offset:0 lds
    buffer_load_dwordx4 v12, s[36:39], s41 offen offset:1024 lds
    s_add_u32 m0, s43, 41984
    s_nop 0
    buffer_load_dwordx4 v5, s[32:35], s40 offen offset:3072 lds
    s_mov_b32 m0, 58368
    s_mov_b64 exec, s[46:47]
    buffer_load_dwordx4 v6, s[32:35], s40 offen lds
    s_mov_b64 exec, -1
    s_movk_i32 s40, 640
    s_mov_b32 s41, 1966080
    s_load_dwordx2 s[90:91], s[16:17], s84 offset:444
    s_load_dwordx2 s[90:91], s[16:17], s84 offset:572
    s_load_dwordx2 s[90:91], s[16:17], s84 offset:700
    s_waitcnt vmcnt(13)
    s_bitcmp1_b32 2, s87
    s_cbranch_scc1 L_mw_9
    s_waitcnt vmcnt(11)
L_mw_9:
    s_barrier
    s_add_u32 m0, s43, 83968
    s_nop 0
    buffer_load_dwordx4 v2, s[32:35], s40 offen offset:0 lds
    s_add_u32 m0, s44, 83968
    s_nop 0
    buffer_load_dwordx4 v7, s[36:39], s41 offen offset:0 lds
    buffer_load_dwordx4 v8, s[36:39], s41 offen offset:1024 lds
    s_add_u32 m0, s43, 83968
    s_nop 0
    buffer_load_dwordx4 v3, s[32:35], s40 offen offset:1024 lds
    s_add_u32 m0, s44, 92160
    s_nop 0
    buffer_load_dwordx4 v9, s[36:39], s41 offen offset:0 lds
    buffer_load_dwordx4 v10, s[36:39], s41 offen offset:1024 lds
    s_add_u32 m0, s43, 83968
    s_nop 0
    buffer_load_dwordx4 v4, s[32:35], s40 offen offset:2048 lds
    s_add_u32 m0, s44, 100352
    s_nop 0
    buffer_load_dwordx4 v11, s[36:39], s41 offen offset:0 lds
    buffer_load_dwordx4 v12, s[36:39], s41 offen offset:1024 lds
    s_add_u32 m0, s43, 83968
    s_nop 0
    buffer_load_dwordx4 v5, s[32:35], s40 offen offset:3072 lds
    s_mov_b32 m0, 100352
    s_mov_b64 exec, s[46:47]
    buffer_load_dwordx4 v6, s[32:35], s40 offen lds
    s_mov_b64 exec, -1
    s_movk_i32 s40, 768
    s_mov_b32 s41, 2359296
    s_bitcmp0_b32 4, s87
    s_cbranch_scc1 L_stg_10
    s_add_u32 s6, s89, 3145728
    s_mov_b32 exec_lo, 0x770077
    s_mov_b32 exec_hi, 0x770077
    s_bfe_u32 s7, s89, 0x30007
    s_cmp_lg_u32 s7, 1
    s_cbranch_scc1 L_wx3_11
    buffer_load_dword v250, v252, s[36:39], s6 offen offset:256
L_wx3_11:
    buffer_load_dword v250, v252, s[36:39], s6 offen
    s_mov_b32 exec_lo, 0xf0f0f0f
    s_mov_b32 exec_hi, 0
    buffer_load_dword v250, v251, s[32:35], s88 offen offset:1024
    s_mov_b64 exec, -1
L_stg_10:
    s_load_dwordx2 s[90:91], s[16:17], s84 offset:828
    s_load_dwordx2 s[90:91], s[16:17], s84 offset:956
    s_load_dwordx2 s[90:91], s[16:17], s84 offset:1084
    s_waitcnt vmcnt(13)
    s_bitcmp1_b32 4, s87
    s_cbranch_scc1 L_mw_12
    s_waitcnt vmcnt(11)
L_mw_12:
    s_barrier
    s_add_u32 m0, s43, 0
    s_nop 0
    buffer_load_dwordx4 v2, s[32:35], s40 offen offset:0 lds
    s_add_u32 m0, s44, 0
    s_nop 0
    buffer_load_dwordx4 v7, s[36:39], s41 offen offset:0 lds
    buffer_load_dwordx4 v8, s[36:39], s41 offen offset:1024 lds
    s_add_u32 m0, s43, 0
    s_nop 0
    buffer_load_dwordx4 v3, s[32:35], s40 offen offset:1024 lds
    s_add_u32 m0, s44, 8192
    s_nop 0
    buffer_load_dwordx4 v9, s[36:39], s41 offen offset:0 lds
    buffer_load_dwordx4 v10, s[36:39], s41 offen offset:1024 lds
    s_add_u32 m0, s43, 0
    s_nop 0
    buffer_load_dwordx4 v4, s[32:35], s40 offen offset:2048 lds
    s_add_u32 m0, s44, 16384
    s_nop 0
    buffer_load_dwordx4 v11, s[36:39], s41 offen offset:0 lds
    buffer_load_dwordx4 v12, s[36:39], s41 offen offset:1024 lds
    s_add_u32 m0, s43, 0
    s_nop 0
    buffer_load_dwordx4 v5, s[32:35], s40 offen offset:3072 lds
    s_mov_b32 m0, 16384
    s_mov_b64 exec, s[46:47]
    buffer_load_dwordx4 v6, s[32:35], s40 offen lds
    s_mov_b64 exec, -1
    s_movk_i32 s40, 896
    s_mov_b32 s41, 2752512
    s_bfe_u32 s74, s2, 0x20003
    s_lshl2_add_u32 s74, s74, s70
    s_cmp_lg_u32 s74, 0
    s_cbranch_scc1 L_sig_13
    s_mov_b32 s60, s28
    s_mov_b32 s61, s29
    s_mov_b32 s62, 0x100
    s_mov_b32 s63, 0x20000
    s_and_b32 s74, s2, 3
    s_lshl_b32 s74, s74, 6
    s_mov_b64 exec, 1
    buffer_atomic_add v244, off, s[60:63], s74 sc1
    s_mov_b64 exec, -1
L_sig_13:
    s_load_dwordx2 s[90:91], s[16:17], s84 offset:1212
    s_load_dwordx2 s[90:91], s[16:17], s84 offset:1340
    s_load_dwordx2 s[90:91], s[16:17], s84 offset:1468
    s_waitcnt vmcnt(13)
    s_bitcmp1_b32 4, s87
    s_cbranch_scc1 L_mw_14
    s_waitcnt vmcnt(11)
L_mw_14:
    s_barrier
    s_add_u32 m0, s43, 41984
    s_nop 0
    buffer_load_dwordx4 v2, s[32:35], s40 offen offset:0 lds
    s_add_u32 m0, s44, 41984
    s_nop 0
    buffer_load_dwordx4 v7, s[36:39], s41 offen offset:0 lds
    buffer_load_dwordx4 v8, s[36:39], s41 offen offset:1024 lds
    s_add_u32 m0, s43, 41984
    s_nop 0
    buffer_load_dwordx4 v3, s[32:35], s40 offen offset:1024 lds
    s_add_u32 m0, s44, 50176
    s_nop 0
    buffer_load_dwordx4 v9, s[36:39], s41 offen offset:0 lds
    buffer_load_dwordx4 v10, s[36:39], s41 offen offset:1024 lds
    s_add_u32 m0, s43, 41984
    s_nop 0
    buffer_load_dwordx4 v4, s[32:35], s40 offen offset:2048 lds
    s_add_u32 m0, s44, 58368
    s_nop 0
    buffer_load_dwordx4 v11, s[36:39], s41 offen offset:0 lds
    buffer_load_dwordx4 v12, s[36:39], s41 offen offset:1024 lds
    s_add_u32 m0, s43, 41984
    s_nop 0
    buffer_load_dwordx4 v5, s[32:35], s40 offen offset:3072 lds
    s_mov_b32 m0, 58368
    s_mov_b64 exec, s[46:47]
    buffer_load_dwordx4 v6, s[32:35], s40 offen lds
    s_mov_b64 exec, -1
    s_movk_i32 s40, 1024
    s_mov_b32 s41, 3145728
    s_bitcmp0_b32 8, s87
    s_cbranch_scc1 L_stg_15
    s_add_u32 s6, s89, 3932160
    s_mov_b32 exec_lo, 0x770077
    s_mov_b32 exec_hi, 0x770077
    s_bfe_u32 s7, s89, 0x30007
    s_cmp_lg_u32 s7, 1
    s_cbranch_scc1 L_wx3_16
    buffer_load_dword v250, v252, s[36:39], s6 offen offset:256
L_wx3_16:
    buffer_load_dword v250, v252, s[36:39], s6 offen
    s_mov_b32 exec_lo, 0xf0f0f0f
    s_mov_b32 exec_hi, 0
    buffer_load_dword v250, v251, s[32:35], s88 offen offset:1280
    s_mov_b64 exec, -1
L_stg_15:
    s_bfe_u32 s74, s2, 0x20003
    s_lshl2_add_u32 s74, s74, s70
    s_cmp_lg_u32 s74, 4
    s_cbranch_scc1 L_sig_17
    s_mov_b32 s60, s28
    s_mov_b32 s61, s29
    s_mov_b32 s62, 0x100
    s_mov_b32 s63, 0x20000
    s_and_b32 s74, s2, 3
    s_lshl_b32 s74, s74, 6
    s_mov_b64 exec, 1
    buffer_atomic_add v244, off, s[60:63], s74 sc1
    s_mov_b64 exec, -1
L_sig_17:
    s_load_dwordx2 s[90:91], s[16:17], s84 offset:1596
    s_load_dwordx2 s[90:91], s[16:17], s84 offset:1724
    s_load_dwordx2 s[90:91], s[16:17], s84 offset:1852
    s_waitcnt vmcnt(13)
    s_bitcmp1_b32 8, s87
    s_cbranch_scc1 L_mw_18
    s_waitcnt vmcnt(11)
L_mw_18:
    s_barrier
    s_add_u32 m0, s43, 83968
    s_nop 0
    buffer_load_dwordx4 v2, s[32:35], s40 offen offset:0 lds
    s_add_u32 m0, s44, 83968
    s_nop 0
    buffer_load_dwordx4 v7, s[36:39], s41 offen offset:0 lds
    buffer_load_dwordx4 v8, s[36:39], s41 offen offset:1024 lds
    s_add_u32 m0, s43, 83968
    s_nop 0
    buffer_load_dwordx4 v3, s[32:35], s40 offen offset:1024 lds
    s_add_u32 m0, s44, 92160
    s_nop 0
    buffer_load_dwordx4 v9, s[36:39], s41 offen offset:0 lds
    buffer_load_dwordx4 v10, s[36:39], s41 offen offset:1024 lds
    s_add_u32 m0, s43, 83968
    s_nop 0
    buffer_load_dwordx4 v4, s[32:35], s40 offen offset:2048 lds
    s_add_u32 m0, s44, 100352
    s_nop 0
    buffer_load_dwordx4 v11, s[36:39], s41 offen offset:0 lds
    buffer_load_dwordx4 v12, s[36:39], s41 offen offset:1024 lds
    s_add_u32 m0, s43, 83968
    s_nop 0
    buffer_load_dwordx4 v5, s[32:35], s40 offen offset:3072 lds
    s_mov_b32 m0, 100352
    s_mov_b64 exec, s[46:47]
    buffer_load_dwordx4 v6, s[32:35], s40 offen lds
    s_mov_b64 exec, -1
    s_movk_i32 s40, 1152
    s_mov_b32 s41, 3538944
    s_bfe_u32 s74, s2, 0x20003
    s_lshl2_add_u32 s74, s74, s70
    s_cmp_lg_u32 s74, 8
    s_cbranch_scc1 L_sig_19
    s_mov_b32 s60, s28
    s_mov_b32 s61, s29
    s_mov_b32 s62, 0x100
    s_mov_b32 s63, 0x20000
    s_and_b32 s74, s2, 3
    s_lshl_b32 s74, s74, 6
    s_mov_b64 exec, 1
    buffer_atomic_add v244, off, s[60:63], s74 sc1
    s_mov_b64 exec, -1
L_sig_19:
    s_load_dwordx2 s[90:91], s[16:17], s84 offset:1980
    s_load_dwordx2 s[90:91], s[16:17], s84 offset:2108
    s_load_dwordx2 s[90:91], s[16:17], s84 offset:2236
    s_waitcnt vmcnt(13)
    s_bitcmp1_b32 8, s87
    s_cbranch_scc1 L_mw_20
    s_waitcnt vmcnt(11)
L_mw_20:
    s_barrier
    s_add_u32 m0, s43, 0
    s_nop 0
    buffer_load_dwordx4 v2, s[32:35], s40 offen offset:0 lds
    s_add_u32 m0, s44, 0
    s_nop 0
    buffer_load_dwordx4 v7, s[36:39], s41 offen offset:0 lds
    buffer_load_dwordx4 v8, s[36:39], s41 offen offset:1024 lds
    s_add_u32 m0, s43, 0
    s_nop 0
    buffer_load_dwordx4 v3, s[32:35], s40 offen offset:1024 lds
    s_add_u32 m0, s44, 8192
    s_nop 0
    buffer_load_dwordx4 v9, s[36:39], s41 offen offset:0 lds
    buffer_load_dwordx4 v10, s[36:39], s41 offen offset:1024 lds
    s_add_u32 m0, s43, 0
    s_nop 0
    buffer_load_dwordx4 v4, s[32:35], s40 offen offset:2048 lds
    s_add_u32 m0, s44, 16384
    s_nop 0
    buffer_load_dwordx4 v11, s[36:39], s41 offen offset:0 lds
    buffer_load_dwordx4 v12, s[36:39], s41 offen offset:1024 lds
    s_add_u32 m0, s43, 0
    s_nop 0
    buffer_load_dwordx4 v5, s[32:35], s40 offen offset:3072 lds
    s_mov_b32 m0, 16384
    s_mov_b64 exec, s[46:47]
    buffer_load_dwordx4 v6, s[32:35], s40 offen lds
    s_mov_b64 exec, -1
    s_movk_i32 s40, 1280
    s_mov_b32 s41, 3932160
    s_bitcmp0_b32 1, s87
    s_cbranch_scc1 L_stg_21
    s_add_u32 s6, s89, 4718592
    s_mov_b32 exec_lo, 0x770077
    s_mov_b32 exec_hi, 0x770077
    s_bfe_u32 s7, s89, 0x30007
    s_cmp_lg_u32 s7, 1
    s_cbranch_scc1 L_wx3_22
    buffer_load_dword v250, v252, s[36:39], s6 offen offset:256
L_wx3_22:
    buffer_load_dword v250, v252, s[36:39], s6 offen
    s_mov_b32 exec_lo, 0xf0f0f0f
    s_mov_b32 exec_hi, 0
    buffer_load_dword v250, v251, s[32:35], s88 offen offset:1536
    s_mov_b64 exec, -1
L_stg_21:
    s_bfe_u32 s74, s2, 0x20003
    s_lshl2_add_u32 s74, s74, s70
    s_cmp_lg_u32 s74, 12
    s_cbranch_scc1 L_sig_23
    s_mov_b32 s60, s28
    s_mov_b32 s61, s29
    s_mov_b32 s62, 0x100
    s_mov_b32 s63, 0x20000
    s_and_b32 s74, s2, 3
    s_lshl_b32 s74, s74, 6
    s_mov_b64 exec, 1
    buffer_atomic_add v244, off, s[60:63], s74 sc1
    s_mov_b64 exec, -1
L_sig_23:
    s_load_dwordx2 s[90:91], s[16:17], s84 offset:2364
    s_load_dwordx2 s[90:91], s[16:17], s84 offset:2492
    s_load_dwordx2 s[90:91], s[16:17], s84 offset:2620
    s_waitcnt vmcnt(13)
    s_bitcmp1_b32 1, s87
    s_cbranch_scc1 L_mw_24
    s_waitcnt vmcnt(11)
L_mw_24:
    s_barrier
    s_add_u32 m0, s43, 41984
    s_nop 0
    buffer_load_dwordx4 v2, s[32:35], s40 offen offset:0 lds
    s_add_u32 m0, s44, 41984
    s_nop 0
    buffer_load_dwordx4 v7, s[36:39], s41 offen offset:0 lds
    buffer_load_dwordx4 v8, s[36:39], s41 offen offset:1024 lds
    s_add_u32 m0, s43, 41984
    s_nop 0
    buffer_load_dwordx4 v3, s[32:35], s40 offen offset:1024 lds
    s_add_u32 m0, s44, 50176
    s_nop 0
    buffer_load_dwordx4 v9, s[36:39], s41 offen offset:0 lds
    buffer_load_dwordx4 v10, s[36:39], s41 offen offset:1024 lds
    s_add_u32 m0, s43, 41984
    s_nop 0
    buffer_load_dwordx4 v4, s[32:35], s40 offen offset:2048 lds
    s_add_u32 m0, s44, 58368
    s_nop 0
    buffer_load_dwordx4 v11, s[36:39], s41 offen offset:0 lds
    buffer_load_dwordx4 v12, s[36:39], s41 offen offset:1024 lds
    s_add_u32 m0, s43, 41984
    s_nop 0
    buffer_load_dwordx4 v5, s[32:35], s40 offen offset:3072 lds
    s_mov_b32 m0, 58368
    s_mov_b64 exec, s[46:47]
    buffer_load_dwordx4 v6, s[32:35], s40 offen lds
    s_mov_b64 exec, -1
    s_movk_i32 s40, 1408
    s_mov_b32 s41, 4325376
    s_load_dwordx2 s[90:91], s[16:17], s84 offset:2748
    s_load_dwordx2 s[90:91], s[16:17], s84 offset:2876
    s_load_dwordx2 s[90:91], s[16:17], s84 offset:3004
    s_waitcnt vmcnt(13)
    s_bitcmp1_b32 1, s87
    s_cbranch_scc1 L_mw_25
    s_waitcnt vmcnt(11)
L_mw_25:
    s_barrier
    s_add_u32 m0, s43, 83968
    s_nop 0
    buffer_load_dwordx4 v2, s[32:35], s40 offen offset:0 lds
    s_add_u32 m0, s44, 83968
    s_nop 0
    buffer_load_dwordx4 v7, s[36:39], s41 offen offset:0 lds
    buffer_load_dwordx4 v8, s[36:39], s41 offen offset:1024 lds
    s_add_u32 m0, s43, 83968
    s_nop 0
    buffer_load_dwordx4 v3, s[32:35], s40 offen offset:1024 lds
    s_add_u32 m0, s44, 92160
    s_nop 0
    buffer_load_dwordx4 v9, s[36:39], s41 offen offset:0 lds
    buffer_load_dwordx4 v10, s[36:39], s41 offen offset:1024 lds
    s_add_u32 m0, s43, 83968
    s_nop 0
    buffer_load_dwordx4 v4, s[32:35], s40 offen offset:2048 lds
    s_add_u32 m0, s44, 100352
    s_nop 0
    buffer_load_dwordx4 v11, s[36:39], s41 offen offset:0 lds
    buffer_load_dwordx4 v12, s[36:39], s41 offen offset:1024 lds
    s_add_u32 m0, s43, 83968
    s_nop 0
    buffer_load_dwordx4 v5, s[32:35], s40 offen offset:3072 lds
    s_mov_b32 m0, 100352
    s_mov_b64 exec, s[46:47]
    buffer_load_dwordx4 v6, s[32:35], s40 offen lds
    s_mov_b64 exec, -1
    s_movk_i32 s40, 1536
    s_mov_b32 s41, 4718592
    s_bitcmp0_b32 2, s87
    s_cbranch_scc1 L_stg_26
    s_add_u32 s6, s89, 5505024
    s_mov_b32 exec_lo, 0x770077
    s_mov_b32 exec_hi, 0x770077
    s_bfe_u32 s7, s89, 0x30007
    s_cmp_lg_u32 s7, 1
    s_cbranch_scc1 L_wx3_27
    buffer_load_dword v250, v252, s[36:39], s6 offen offset:256
L_wx3_27:
    buffer_load_dword v250, v252, s[36:39], s6 offen
    s_mov_b32 exec_lo, 0xf0f0f0f
    s_mov_b32 exec_hi, 0
    buffer_load_dword v250, v251, s[32:35], s88 offen offset:1792
    s_mov_b64 exec, -1
L_stg_26:
    s_load_dwordx2 s[90:91], s[16:17], s84 offset:3132
    s_load_dwordx2 s[90:91], s[16:17], s84 offset:3260
    s_load_dwordx2 s[90:91], s[16:17], s84 offset:3388
    s_waitcnt vmcnt(13)
    s_bitcmp1_b32 2, s87
    s_cbranch_scc1 L_mw_28
    s_waitcnt vmcnt(11)
L_mw_28:
    s_barrier
    s_add_u32 m0, s43, 0
    s_nop 0
    buffer_load_dwordx4 v2, s[32:35], s40 offen offset:0 lds
    s_add_u32 m0, s44, 0
    s_nop 0
    buffer_load_dwordx4 v7, s[36:39], s41 offen offset:0 lds
    buffer_load_dwordx4 v8, s[36:39], s41 offen offset:1024 lds
    s_add_u32 m0, s43, 0
    s_nop 0
    buffer_load_dwordx4 v3, s[32:35], s40 offen offset:1024 lds
    s_add_u32 m0, s44, 8192
    s_nop 0
    buffer_load_dwordx4 v9, s[36:39], s41 offen offset:0 lds
    buffer_load_dwordx4 v10, s[36:39], s41 offen offset:1024 lds
    s_add_u32 m0, s43, 0
    s_nop 0
    buffer_load_dwordx4 v4, s[32:35], s40 offen offset:2048 lds
    s_add_u32 m0, s44, 16384
    s_nop 0
    buffer_load_dwordx4 v11, s[36:39], s41 offen offset:0 lds
    buffer_load_dwordx4 v12, s[36:39], s41 offen offset:1024 lds
    s_add_u32 m0, s43, 0
    s_nop 0
    buffer_load_dwordx4 v5, s[32:35], s40 offen offset:3072 lds
    s_mov_b32 m0, 16384
    s_mov_b64 exec, s[46:47]
    buffer_load_dwordx4 v6, s[32:35], s40 offen lds
    s_mov_b64 exec, -1
    s_movk_i32 s40, 1664
    s_mov_b32 s41, 5111808
    s_load_dwordx2 s[90:91], s[16:17], s84 offset:3516
    s_load_dwordx2 s[90:91], s[16:17], s84 offset:3644
    s_load_dwordx2 s[90:91], s[16:17], s84 offset:3772
    s_waitcnt vmcnt(13)
    s_bitcmp1_b32 2, s87
    s_cbranch_scc1 L_mw_29
    s_waitcnt vmcnt(11)
L_mw_29:
    s_barrier
    s_add_u32 m0, s43, 41984
    s_nop 0
    buffer_load_dwordx4 v2, s[32:35], s40 offen offset:0 lds
    s_add_u32 m0, s44, 41984
    s_nop 0
    buffer_load_dwordx4 v7, s[36:39], s41 offen offset:0 lds
    buffer_load_dwordx4 v8, s[36:39], s41 offen offset:1024 lds
    s_add_u32 m0, s43, 41984
    s_nop 0
    buffer_load_dwordx4 v3, s[32:35], s40 offen offset:1024 lds
    s_add_u32 m0, s44, 50176
    s_nop 0
    buffer_load_dwordx4 v9, s[36:39], s41 offen offset:0 lds
    buffer_load_dwordx4 v10, s[36:39], s41 offen offset:1024 lds
    s_add_u32 m0, s43, 41984
    s_nop 0
    buffer_load_dwordx4 v4, s[32:35], s40 offen offset:2048 lds
    s_add_u32 m0, s44, 58368
    s_nop 0
    buffer_load_dwordx4 v11, s[36:39], s41 offen offset:0 lds
    buffer_load_dwordx4 v12, s[36:39], s41 offen offset:1024 lds
    s_add_u32 m0, s43, 41984
    s_nop 0
    buffer_load_dwordx4 v5, s[32:35], s40 offen offset:3072 lds
    s_mov_b32 m0, 58368
    s_mov_b64 exec, s[46:47]
    buffer_load_dwordx4 v6, s[32:35], s40 offen lds
    s_mov_b64 exec, -1
    s_movk_i32 s40, 1792
    s_mov_b32 s41, 5505024
    s_load_dwordx2 s[90:91], s[16:17], s84 offset:3900
    s_load_dwordx2 s[90:91], s[16:17], s84 offset:4028
    s_waitcnt vmcnt(11)
    s_barrier
    s_add_u32 m0, s43, 83968
    s_nop 0
    buffer_load_dwordx4 v2, s[32:35], s40 offen offset:0 lds
    s_add_u32 m0, s44, 83968
    s_nop 0
    buffer_load_dwordx4 v7, s[36:39], s41 offen offset:0 lds
    buffer_load_dwordx4 v8, s[36:39], s41 offen offset:1024 lds
    s_add_u32 m0, s43, 83968
    s_nop 0
    buffer_load_dwordx4 v3, s[32:35], s40 offen offset:1024 lds
    s_add_u32 m0, s44, 92160
    s_nop 0
    buffer_load_dwordx4 v9, s[36:39], s41 offen offset:0 lds
    buffer_load_dwordx4 v10, s[36:39], s41 offen offset:1024 lds
    s_add_u32 m0, s43, 83968
    s_nop 0
    buffer_load_dwordx4 v4, s[32:35], s40 offen offset:2048 lds
    s_add_u32 m0, s44, 100352
    s_nop 0
    buffer_load_dwordx4 v11, s[36:39], s41 offen offset:0 lds
    buffer_load_dwordx4 v12, s[36:39], s41 offen offset:1024 lds
    s_add_u32 m0, s43, 83968
    s_nop 0
    buffer_load_dwordx4 v5, s[32:35], s40 offen offset:3072 lds
    s_mov_b32 m0, 100352
    s_mov_b64 exec, s[46:47]
    buffer_load_dwordx4 v6, s[32:35], s40 offen lds
    s_mov_b64 exec, -1
    s_movk_i32 s40, 1920
    s_mov_b32 s41, 5898240
    s_waitcnt vmcnt(11)
    s_barrier
    s_load_dword s4, s[28:29], 0
    s_load_dword s5, s[28:29], 64
    s_load_dword s6, s[28:29], 128
    s_load_dword s7, s[28:29], 192
    s_add_u32 m0, s43, 0
    s_nop 0
    buffer_load_dwordx4 v2, s[32:35], s40 offen offset:0 lds
    s_add_u32 m0, s44, 0
    s_nop 0
    buffer_load_dwordx4 v7, s[36:39], s41 offen offset:0 lds
    buffer_load_dwordx4 v8, s[36:39], s41 offen offset:1024 lds
    s_add_u32 m0, s43, 0
    s_nop 0
    buffer_load_dwordx4 v3, s[32:35], s40 offen offset:1024 lds
    s_add_u32 m0, s44, 8192
    s_nop 0
    buffer_load_dwordx4 v9, s[36:39], s41 offen offset:0 lds
    buffer_load_dwordx4 v10, s[36:39], s41 offen offset:1024 lds
    s_add_u32 m0, s43, 0
    s_nop 0
    buffer_load_dwordx4 v4, s[32:35], s40 offen offset:2048 lds
    s_add_u32 m0, s44, 16384
    s_nop 0
    buffer_load_dwordx4 v11, s[36:39], s41 offen offset:0 lds
    buffer_load_dwordx4 v12, s[36:39], s41 offen offset:1024 lds
    s_add_u32 m0, s43, 0
    s_nop 0
    buffer_load_dwordx4 v5, s[32:35], s40 offen offset:3072 lds
    s_mov_b32 m0, 16384
    s_mov_b64 exec, s[46:47]
    buffer_load_dwordx4 v6, s[32:35], s40 offen lds
    s_mov_b64 exec, -1
    s_movk_i32 s40, 2048
    s_mov_b32 s41, 6291456
    s_mov_b32 s60, s8
    s_mov_b32 s61, s9
    s_mov_b32 s62, 0x400000
    s_mov_b32 s63, 0x20000
    s_movk_i32 s75, 8192
    buffer_load_dwordx4 v[208:211], v225, s[60:63], 0 offen offset:0 nt
    buffer_load_dwordx4 v[212:215], v225, s[60:63], 0 offen offset:2048 nt
    buffer_load_dwordx4 v[216:219], v225, s[60:63], s75 offen offset:0 nt
    buffer_load_dwordx4 v[220:223], v225, s[60:63], s75 offen offset:2048 nt
    s_cmp_lg_u32 s70, 0
    s_cbranch_scc1 L_pc_done_32
    s_waitcnt lgkmcnt(0)
    s_min_u32 s4, s4, s5
    s_min_u32 s6, s6, s7
    s_min_u32 s4, s4, s6
    s_cmp_ge_u32 s4, 64
    s_cbranch_scc1 L_pc_done_32
    s_mov_b32 s60, s28
    s_mov_b32 s61, s29
    s_mov_b32 s62, 0x100
    s_mov_b32 s63, 0x20000
    v_lshlrev_b32 v20, 6, v0
    s_mov_b32 s74, 131072
    s_mov_b64 exec, 0xf
L_pc_loop_33:
    buffer_load_dword v21, v20, s[60:63], 0 offen sc1
    s_waitcnt vmcnt(0)
    v_cmp_gt_u32 vcc, 64, v21
    s_cbranch_vccz L_pc_done_32
    s_sleep 4
    s_sub_u32 s74, s74, 1
    s_cbranch_scc0 L_pc_loop_33
L_pc_done_32:
    s_mov_b64 exec, -1
    s_waitcnt vmcnt(15)
    s_barrier
    s_waitcnt vmcnt(4)
    s_mov_b64 exec, 1
    ds_add_u32 v227, v244 offset:24
    s_mov_b64 exec, -1
    s_add_u32 s56, s30, s85
    s_addc_u32 s57, s31, 0
    s_movk_i32 s58, 4096
    s_mov_b32 s59, 0x20000
    s_add_u32 m0, s81, 0
    s_nop 0
    buffer_load_dwordx4 v224, s[56:59], 0 offen offset:0 sc1 lds
    buffer_load_dwordx4 v224, s[56:59], 0 offen offset:1024 sc1 lds
    buffer_load_dwordx4 v224, s[56:59], 0 offen offset:2048 sc1 lds
    buffer_load_dwordx4 v224, s[56:59], 0 offen offset:3072 sc1 lds
    s_add_u32 m0, s81, 4572
    s_nop 0
    buffer_load_dwordx4 v224, s[56:59], 0 offen offset:0 sc1 lds
    buffer_load_dwordx4 v224, s[56:59], 0 offen offset:1024 sc1 lds
    buffer_load_dwordx4 v224, s[56:59], 0 offen offset:2048 sc1 lds
    buffer_load_dwordx4 v224, s[56:59], 0 offen offset:3072 sc1 lds
    s_add_u32 s56, s16, s84
    s_addc_u32 s57, s17, 0
    s_movk_i32 s58, 4096
    s_mov_b32 s59, 0x20000
    s_add_u32 m0, s80, 64
    v_mov_b32 v180, 0
    v_mov_b32 v181, 0
    v_mov_b32 v182, 0
    v_mov_b32 v183, 0
    buffer_load_dwordx4 v224, s[56:59], 0 offen offset:0 lds
    buffer_load_dwordx4 v224, s[56:59], 0 offen offset:1024 lds
    buffer_load_dwordx4 v224, s[56:59], 0 offen offset:2048 lds
    buffer_load_dwordx4 v224, s[56:59], 0 offen offset:3072 lds
    s_add_u32 m0, s80, 4304
    s_mov_b64 exec, 0x100
    buffer_load_dwordx4 v[180:183], off, s[56:59], 0
    s_mov_b64 exec, -1
    buffer_load_dwordx4 v224, s[56:59], 14 offen offset:0 lds
    buffer_load_dwordx4 v224, s[56:59], 14 offen offset:1024 lds
    buffer_load_dwordx4 v224, s[56:59], 14 offen offset:2048 lds
    buffer_load_dwordx4 v224, s[56:59], 14 offen offset:3072 lds
    v_lshrrev_b32 v234, 5, v0
    v_mul_u32_u24 v234, 4064, v234
    v_add3_u32 v234, v234, v224, s81
    s_mov_b32 exec_lo, 0xfffffff
    s_mov_b32 exec_hi, 0xfffffff
    ds_write_b128 v234, v[228:231] offset:4096
    s_mov_b64 exec, 1
    ds_write_b32 v234, v228 offset:8668
    s_mov_b64 exec, -1
    s_setprio 3
    s_waitcnt vmcnt(9)
    s_mov_b32 s60, s24
    s_mov_b32 s61, s25
    s_mov_b32 s62, 0x200000
    s_mov_b32 s63, 0x20000
    s_lshr_b32 s74, s2, 3
    s_lshl2_add_u32 s74, s74, s70
    s_bfe_u32 s75, s2, 0x10002
    s_lshl4_add_u32 s74, s74, s75
    s_lshl_b32 s74, s74, 10
    v_lshrrev_b32 v234, 3, v0
    v_and_b32 v235, 7, v0
    v_lshlrev_b32 v235, 7, v235
    v_lshl_add_u32 v234, v234, 11, v235
    buffer_load_dword v250, v234, s[60:63], s74 offen
    s_waitcnt vmcnt(1)
    v_cmp_lt_u32 vcc, 3, v0
    v_mov_b32 v188, 4160
    v_lshlrev_b32 v184, 16, v180
    v_cndmask_b32 v188, 0, v188, vcc
    v_alignbit_b32 v185, v181, v180, 16
    v_alignbit_b32 v186, v182, v181, 16
    v_alignbit_b32 v187, v183, v182, 16
    v_add3_u32 v188, v188, v224, s80
    s_mov_b64 exec, 0x1ff
    ds_write_b128 v188, v[184:187]
    s_mov_b64 exec, -1
    ds_read_b128 v[112:115], v233 offset:3584
    ds_read_b128 v[116:119], v233 offset:3072
    ds_read_b128 v[120:123], v233 offset:2560
    ds_read_b128 v[124:127], v233 offset:2048
    ds_read_b128 v[128:131], v233 offset:1536
    ds_read_b128 v[132:135], v233 offset:1024
    ds_read_b128 v[136:139], v233 offset:512
    ds_read_b128 v[140:143], v233 offset:0
    ds_read_b64 v[48:49], v232 offset:0
    ds_read_b64 v[50:51], v232 offset:8
    ds_read_b64 v[52:53], v232 offset:512
    ds_read_b64 v[54:55], v232 offset:520
    ds_read_b64 v[56:57], v232 offset:1024
    ds_read_b64 v[58:59], v232 offset:1032
    ds_read_b64 v[60:61], v232 offset:1536
    ds_read_b64 v[62:63], v232 offset:1544
    ds_read_b64 v[64:65], v232 offset:2048
    ds_read_b64 v[66:67], v232 offset:2056
    ds_read_b64 v[68:69], v232 offset:2560
    ds_read_b64 v[70:71], v232 offset:2568
    ds_read_b64 v[72:73], v232 offset:3072
    ds_read_b64 v[74:75], v232 offset:3080
    ds_read_b64 v[76:77], v232 offset:3584
    ds_read_b64 v[78:79], v232 offset:3592
    s_setprio 1
    s_mov_b32 s74, 3
    s_waitcnt lgkmcnt(14)
    v_mfma_f32_16x16x32_bf16 v[16:19], v[240:243], v[112:115], 0
    v_mfma_f32_16x16x32_bf16 v[20:23], v[240:243], v[116:119], 0
    v_mfma_f32_16x16x32_bf16 v[24:27], v[240:243], v[120:123], 0
    v_mfma_f32_16x16x32_bf16 v[28:31], v[240:243], v[124:127], 0
    v_mfma_f32_16x16x32_bf16 v[32:35], v[240:243], v[128:131], 0
    v_mfma_f32_16x16x32_bf16 v[36:39], v[240:243], v[132:135], 0
    v_mfma_f32_16x16x32_bf16 v[40:43], v[240:243], v[136:139], 0
    v_mfma_f32_16x16x32_bf16 v[44:47], v[240:243], v[140:143], 0
    s_waitcnt lgkmcnt(0)
L_conv:
    v_mfma_f32_16x16x32_bf16 v[16:19], v[48:51], v[112:115], v[16:19]
    ds_read_b128 v[144:147], v233 offset:3648
    v_mfma_f32_16x16x32_bf16 v[20:23], v[48:51], v[116:119], v[20:23]
    ds_read_b64 v[80:81], v232 offset:64
    v_mfma_f32_16x16x32_bf16 v[20:23], v[52:55], v[112:115], v[20:23]
    ds_read_b64 v[82:83], v232 offset:72
    v_mfma_f32_16x16x32_bf16 v[24:27], v[48:51], v[120:123], v[24:27]
    ds_read_b128 v[148:151], v233 offset:3136
    v_mfma_f32_16x16x32_bf16 v[24:27], v[52:55], v[116:119], v[24:27]
    ds_read_b64 v[84:85], v232 offset:576
    v_mfma_f32_16x16x32_bf16 v[24:27], v[56:59], v[112:115], v[24:27]
    ds_read_b64 v[86:87], v232 offset:584
    v_mfma_f32_16x16x32_bf16 v[28:31], v[48:51], v[124:127], v[28:31]
    ds_read_b128 v[152:155], v233 offset:2624
    v_mfma_f32_16x16x32_bf16 v[28:31], v[52:55], v[120:123], v[28:31]
    ds_read_b64 v[88:89], v232 offset:1088
    v_mfma_f32_16x16x32_bf16 v[28:31], v[56:59], v[116:119], v[28:31]
    ds_read_b64 v[90:91], v232 offset:1096
    v_mfma_f32_16x16x32_bf16 v[28:31], v[60:63], v[112:115], v[28:31]
    ds_read_b128 v[156:159], v233 offset:2112
    v_mfma_f32_16x16x32_bf16 v[32:35], v[48:51], v[128:131], v[32:35]
    ds_read_b64 v[92:93], v232 offset:1600
    v_mfma_f32_16x16x32_bf16 v[32:35], v[52:55], v[124:127], v[32:35]
    ds_read_b64 v[94:95], v232 offset:1608
    v_mfma_f32_16x16x32_bf16 v[32:35], v[56:59], v[120:123], v[32:35]
    ds_read_b128 v[160:163], v233 offset:1600
    v_mfma_f32_16x16x32_bf16 v[32:35], v[60:63], v[116:119], v[32:35]
    ds_read_b64 v[96:97], v232 offset:2112
    v_mfma_f32_16x16x32_bf16 v[32:35], v[64:67], v[112:115], v[32:35]
    ds_read_b64 v[98:99], v232 offset:2120
    v_mfma_f32_16x16x32_bf16 v[36:39], v[48:51], v[132:135], v[36:39]
    ds_read_b128 v[164:167], v233 offset:1088
    v_mfma_f32_16x16x32_bf16 v[36:39], v[52:55], v[128:131], v[36:39]
    ds_read_b64 v[100:101], v232 offset:2624
    v_mfma_f32_16x16x32_bf16 v[36:39], v[56:59], v[124:127], v[36:39]
    ds_read_b64 v[102:103], v232 offset:2632
    v_mfma_f32_16x16x32_bf16 v[36:39], v[60:63], v[120:123], v[36:39]
    ds_read_b128 v[168:171], v233 offset:576
    v_mfma_f32_16x16x32_bf16 v[36:39], v[64:67], v[116:119], v[36:39]
    ds_read_b64 v[104:105], v232 offset:3136
    v_mfma_f32_16x16x32_bf16 v[36:39], v[68:71], v[112:115], v[36:39]
    ds_read_b64 v[106:107], v232 offset:3144
    v_mfma_f32_16x16x32_bf16 v[40:43], v[48:51], v[136:139], v[40:43]
    ds_read_b128 v[172:175], v233 offset:64
    v_mfma_f32_16x16x32_bf16 v[40:43], v[52:55], v[132:135], v[40:43]
    ds_read_b64 v[108:109], v232 offset:3648
    v_mfma_f32_16x16x32_bf16 v[40:43], v[56:59], v[128:131], v[40:43]
    ds_read_b64 v[110:111], v232 offset:3656
    v_mfma_f32_16x16x32_bf16 v[40:43], v[60:63], v[124:127], v[40:43]
    v_mfma_f32_16x16x32_bf16 v[40:43], v[64:67], v[120:123], v[40:43]
    v_mfma_f32_16x16x32_bf16 v[40:43], v[68:71], v[116:119], v[40:43]
    v_mfma_f32_16x16x32_bf16 v[40:43], v[72:75], v[112:115], v[40:43]
    v_mfma_f32_16x16x32_bf16 v[44:47], v[48:51], v[140:143], v[44:47]
    v_mfma_f32_16x16x32_bf16 v[44:47], v[52:55], v[136:139], v[44:47]
    v_mfma_f32_16x16x32_bf16 v[44:47], v[56:59], v[132:135], v[44:47]
    v_mfma_f32_16x16x32_bf16 v[44:47], v[60:63], v[128:131], v[44:47]
    v_mfma_f32_16x16x32_bf16 v[44:47], v[64:67], v[124:127], v[44:47]
    v_mfma_f32_16x16x32_bf16 v[44:47], v[68:71], v[120:123], v[44:47]
    v_mfma_f32_16x16x32_bf16 v[44:47], v[72:75], v[116:119], v[44:47]
    v_mfma_f32_16x16x32_bf16 v[44:47], v[76:79], v[112:115], v[44:47]
    s_waitcnt lgkmcnt(0)
    v_mfma_f32_16x16x32_bf16 v[16:19], v[80:83], v[144:147], v[16:19]
    ds_read_b128 v[112:115], v233 offset:3712
    v_mfma_f32_16x16x32_bf16 v[20:23], v[80:83], v[148:151], v[20:23]
    ds_read_b64 v[48:49], v232 offset:128
    v_mfma_f32_16x16x32_bf16 v[20:23], v[84:87], v[144:147], v[20:23]
    ds_read_b64 v[50:51], v232 offset:136
    v_mfma_f32_16x16x32_bf16 v[24:27], v[80:83], v[152:155], v[24:27]
    ds_read_b128 v[116:119], v233 offset:3200
    v_mfma_f32_16x16x32_bf16 v[24:27], v[84:87], v[148:151], v[24:27]
    ds_read_b64 v[52:53], v232 offset:640
    v_mfma_f32_16x16x32_bf16 v[24:27], v[88:91], v[144:147], v[24:27]
    ds_read_b64 v[54:55], v232 offset:648
    v_mfma_f32_16x16x32_bf16 v[28:31], v[80:83], v[156:159], v[28:31]
    ds_read_b128 v[120:123], v233 offset:2688
    v_mfma_f32_16x16x32_bf16 v[28:31], v[84:87], v[152:155], v[28:31]
    ds_read_b64 v[56:57], v232 offset:1152
    v_mfma_f32_16x16x32_bf16 v[28:31], v[88:91], v[148:151], v[28:31]
    ds_read_b64 v[58:59], v232 offset:1160
    v_mfma_f32_16x16x32_bf16 v[28:31], v[92:95], v[144:147], v[28:31]
    ds_read_b128 v[124:127], v233 offset:2176
    v_mfma_f32_16x16x32_bf16 v[32:35], v[80:83], v[160:163], v[32:35]
    ds_read_b64 v[60:61], v232 offset:1664
    v_mfma_f32_16x16x32_bf16 v[32:35], v[84:87], v[156:159], v[32:35]
    ds_read_b64 v[62:63], v232 offset:1672
    v_mfma_f32_16x16x32_bf16 v[32:35], v[88:91], v[152:155], v[32:35]
    ds_read_b128 v[128:131], v233 offset:1664
    v_mfma_f32_16x16x32_bf16 v[32:35], v[92:95], v[148:151], v[32:35]
    ds_read_b64 v[64:65], v232 offset:2176
    v_mfma_f32_16x16x32_bf16 v[32:35], v[96:99], v[144:147], v[32:35]
    ds_read_b64 v[66:67], v232 offset:2184
    v_mfma_f32_16x16x32_bf16 v[36:39], v[80:83], v[164:167], v[36:39]
    ds_read_b128 v[132:135], v233 offset:1152
    v_mfma_f32_16x16x32_bf16 v[36:39], v[84:87], v[160:163], v[36:39]
    ds_read_b64 v[68:69], v232 offset:2688
    v_mfma_f32_16x16x32_bf16 v[36:39], v[88:91], v[156:159], v[36:39]
    ds_read_b64 v[70:71], v232 offset:2696
    v_mfma_f32_16x16x32_bf16 v[36:39], v[92:95], v[152:155], v[36:39]
    ds_read_b128 v[136:139], v233 offset:640
    v_mfma_f32_16x16x32_bf16 v[36:39], v[96:99], v[148:151], v[36:39]
    ds_read_b64 v[72:73], v232 offset:3200
    v_mfma_f32_16x16x32_bf16 v[36:39], v[100:103], v[144:147], v[36:39]
    ds_read_b64 v[74:75], v232 offset:3208
    v_mfma_f32_16x16x32_bf16 v[40:43], v[80:83], v[168:171], v[40:43]
    ds_read_b128 v[140:143], v233 offset:128
    v_mfma_f32_16x16x32_bf16 v[40:43], v[84:87], v[164:167], v[40:43]
    ds_read_b64 v[76:77], v232 offset:3712
    v_mfma_f32_16x16x32_bf16 v[40:43], v[88:91], v[160:163], v[40:43]
    ds_read_b64 v[78:79], v232 offset:3720
    v_mfma_f32_16x16x32_bf16 v[40:43], v[92:95], v[156:159], v[40:43]
    v_add_u32 v232, 128, v232
    v_mfma_f32_16x16x32_bf16 v[40:43], v[96:99], v[152:155], v[40:43]
    v_add_u32 v233, 128, v233
    v_mfma_f32_16x16x32_bf16 v[40:43], v[100:103], v[148:151], v[40:43]
    s_sub_u32 s74, s74, 1
    v_mfma_f32_16x16x32_bf16 v[40:43], v[104:107], v[144:147], v[40:43]
    s_cmp_lg_u32 s74, 0
    v_mfma_f32_16x16x32_bf16 v[44:47], v[80:83], v[172:175], v[44:47]
    v_mfma_f32_16x16x32_bf16 v[44:47], v[84:87], v[168:171], v[44:47]
    v_mfma_f32_16x16x32_bf16 v[44:47], v[88:91], v[164:167], v[44:47]
    v_mfma_f32_16x16x32_bf16 v[44:47], v[92:95], v[160:163], v[44:47]
    v_mfma_f32_16x16x32_bf16 v[44:47], v[96:99], v[156:159], v[44:47]
    v_mfma_f32_16x16x32_bf16 v[44:47], v[100:103], v[152:155], v[44:47]
    v_mfma_f32_16x16x32_bf16 v[44:47], v[104:107], v[148:151], v[44:47]
    v_mfma_f32_16x16x32_bf16 v[44:47], v[108:111], v[144:147], v[44:47]
    s_waitcnt lgkmcnt(0)
    s_cbranch_scc1 L_conv
    v_mfma_f32_16x16x32_bf16 v[16:19], v[48:51], v[112:115], v[16:19]
    ds_read_b128 v[144:147], v233 offset:3648
    ds_read_b64 v[80:81], v232 offset:64
    v_mfma_f32_16x16x32_bf16 v[20:23], v[48:51], v[116:119], v[20:23]
    ds_read_b64 v[82:83], v232 offset:72
    ds_read_b128 v[148:151], v233 offset:3136
    v_mfma_f32_16x16x32_bf16 v[20:23], v[52:55], v[112:115], v[20:23]
    ds_read_b64 v[84:85], v232 offset:576
    ds_read_b64 v[86:87], v232 offset:584
    v_mfma_f32_16x16x32_bf16 v[24:27], v[48:51], v[120:123], v[24:27]
    ds_read_b128 v[152:155], v233 offset:2624
    ds_read_b64 v[88:89], v232 offset:1088
    v_mfma_f32_16x16x32_bf16 v[24:27], v[52:55], v[116:119], v[24:27]
    ds_read_b64 v[90:91], v232 offset:1096
    ds_read_b128 v[156:159], v233 offset:2112
    v_mfma_f32_16x16x32_bf16 v[24:27], v[56:59], v[112:115], v[24:27]
    ds_read_b64 v[92:93], v232 offset:1600
    ds_read_b64 v[94:95], v232 offset:1608
    v_mfma_f32_16x16x32_bf16 v[28:31], v[48:51], v[124:127], v[28:31]
    ds_read_b128 v[160:163], v233 offset:1600
    ds_read_b64 v[96:97], v232 offset:2112
    v_mfma_f32_16x16x32_bf16 v[28:31], v[52:55], v[120:123], v[28:31]
    ds_read_b64 v[98:99], v232 offset:2120
    ds_read_b128 v[164:167], v233 offset:1088
    v_mfma_f32_16x16x32_bf16 v[28:31], v[56:59], v[116:119], v[28:31]
    ds_read_b64 v[100:101], v232 offset:2624
    ds_read_b64 v[102:103], v232 offset:2632
    v_mfma_f32_16x16x32_bf16 v[28:31], v[60:63], v[112:115], v[28:31]
    ds_read_b128 v[168:171], v233 offset:576
    ds_read_b64 v[104:105], v232 offset:3136
    v_mfma_f32_16x16x32_bf16 v[32:35], v[48:51], v[128:131], v[32:35]
    ds_read_b64 v[106:107], v232 offset:3144
    ds_read_b128 v[172:175], v233 offset:64
    v_mfma_f32_16x16x32_bf16 v[32:35], v[52:55], v[124:127], v[32:35]
    ds_read_b64 v[108:109], v232 offset:3648
    ds_read_b64 v[110:111], v232 offset:3656
    v_mfma_f32_16x16x32_bf16 v[32:35], v[56:59], v[120:123], v[32:35]
    s_mul_i32 s74, s68, 4224
    s_and_b32 s75, s71, 63
    v_mfma_f32_16x16x32_bf16 v[32:35], v[60:63], v[116:119], v[32:35]
    s_add_u32 s74, s74, s75
    s_lshl_b32 s74, s74, 6
    v_mfma_f32_16x16x32_bf16 v[32:35], v[64:67], v[112:115], v[32:35]
    v_and_b32 v234, 3, v0
    v_lshl_add_u32 v234, v234, 4, s74
    v_mfma_f32_16x16x32_bf16 v[36:39], v[48:51], v[132:135], v[36:39]
    v_and_b32 v235, 12, v0
    v_lshrrev_b32 v236, 4, v0
    v_mfma_f32_16x16x32_bf16 v[36:39], v[52:55], v[128:131], v[36:39]
    v_add_u32 v235, v235, v236
    v_mul_u32_u24 v235, 4224, v235
    v_mfma_f32_16x16x32_bf16 v[36:39], v[56:59], v[124:127], v[36:39]
    v_add_u32 v234, v234, v235
    v_mfma_f32_16x16x32_bf16 v[36:39], v[60:63], v[120:123], v[36:39]
    v_mfma_f32_16x16x32_bf16 v[36:39], v[64:67], v[116:119], v[36:39]
    v_mfma_f32_16x16x32_bf16 v[36:39], v[68:71], v[112:115], v[36:39]
    s_waitcnt lgkmcnt(0)
    s_mov_b64 exec, 1
    ds_add_u32 v227, v244 offset:36
    s_mov_b64 exec, -1
    v_mfma_f32_16x16x32_bf16 v[16:19], v[80:83], v[144:147], v[16:19]
    s_lshl4_add_u32 s73, s68, 256
    s_add_u32 s45, s73, s69
    v_mfma_f32_16x16x32_bf16 v[20:23], v[80:83], v[148:151], v[20:23]
    s_lshl_b32 s73, s73, 8
    s_lshl_b32 s45, s45, 8
    v_mfma_f32_16x16x32_bf16 v[20:23], v[84:87], v[144:147], v[20:23]
    v_mfma_f32_16x16x32_bf16 v[24:27], v[80:83], v[152:155], v[24:27]
    v_mfma_f32_16x16x32_bf16 v[24:27], v[84:87], v[148:151], v[24:27]
    v_mfma_f32_16x16x32_bf16 v[24:27], v[88:91], v[144:147], v[24:27]
    v_mfma_f32_16x16x32_bf16 v[28:31], v[80:83], v[156:159], v[28:31]
    v_cvt_pk_bf16_f32 v176, v16, v17
    v_cvt_pk_bf16_f32 v177, v18, v19
    v_mfma_f32_16x16x32_bf16 v[28:31], v[84:87], v[152:155], v[28:31]
    v_mfma_f32_16x16x32_bf16 v[28:31], v[88:91], v[148:151], v[28:31]
    v_cvt_pk_bf16_f32 v178, v20, v21
    v_cvt_pk_bf16_f32 v179, v22, v23
    v_mfma_f32_16x16x32_bf16 v[28:31], v[92:95], v[144:147], v[28:31]
    s_mov_b32 s76, 0
    buffer_store_dwordx4 v[176:179], v234, s[64:67], s76 offen sc1
    v_mfma_f32_16x16x32_bf16 v[32:35], v[80:83], v[160:163], v[32:35]
    v_cvt_pk_bf16_f32 v180, v24, v25
    v_cvt_pk_bf16_f32 v181, v26, v27
    v_mfma_f32_16x16x32_bf16 v[32:35], v[84:87], v[156:159], v[32:35]
    v_mfma_f32_16x16x32_bf16 v[32:35], v[88:91], v[152:155], v[32:35]
    v_mfma_f32_16x16x32_bf16 v[32:35], v[92:95], v[148:151], v[32:35]
    v_cvt_pk_bf16_f32 v182, v28, v29
    v_cvt_pk_bf16_f32 v183, v30, v31
    v_mfma_f32_16x16x32_bf16 v[32:35], v[96:99], v[144:147], v[32:35]
    s_mov_b32 s76, 67584
    buffer_store_dwordx4 v[180:183], v234, s[64:67], s76 offen sc1
    v_mfma_f32_16x16x32_bf16 v[36:39], v[80:83], v[164:167], v[36:39]
    v_mfma_f32_16x16x32_bf16 v[36:39], v[84:87], v[160:163], v[36:39]
    v_mfma_f32_16x16x32_bf16 v[36:39], v[88:91], v[156:159], v[36:39]
    v_mfma_f32_16x16x32_bf16 v[36:39], v[92:95], v[152:155], v[36:39]
    v_mfma_f32_16x16x32_bf16 v[36:39], v[96:99], v[148:151], v[36:39]
    v_mfma_f32_16x16x32_bf16 v[36:39], v[100:103], v[144:147], v[36:39]
    v_cvt_pk_bf16_f32 v184, v32, v33
    v_cvt_pk_bf16_f32 v185, v34, v35
    v_mfma_f32_16x16x32_bf16 v[40:43], v[48:51], v[136:139], v[40:43]
    v_mfma_f32_16x16x32_bf16 v[40:43], v[52:55], v[132:135], v[40:43]
    v_mfma_f32_16x16x32_bf16 v[40:43], v[56:59], v[128:131], v[40:43]
    v_mfma_f32_16x16x32_bf16 v[40:43], v[60:63], v[124:127], v[40:43]
    v_mfma_f32_16x16x32_bf16 v[40:43], v[64:67], v[120:123], v[40:43]
    v_mfma_f32_16x16x32_bf16 v[40:43], v[68:71], v[116:119], v[40:43]
    v_cvt_pk_bf16_f32 v186, v36, v37
    v_cvt_pk_bf16_f32 v187, v38, v39
    v_mfma_f32_16x16x32_bf16 v[40:43], v[72:75], v[112:115], v[40:43]
    s_mov_b32 s76, 135168
    buffer_store_dwordx4 v[184:187], v234, s[64:67], s76 offen sc1
    v_mfma_f32_16x16x32_bf16 v[44:47], v[48:51], v[140:143], v[44:47]
    v_mfma_f32_16x16x32_bf16 v[44:47], v[52:55], v[136:139], v[44:47]
    v_mfma_f32_16x16x32_bf16 v[44:47], v[56:59], v[132:135], v[44:47]
    v_mfma_f32_16x16x32_bf16 v[44:47], v[60:63], v[128:131], v[44:47]
    v_mfma_f32_16x16x32_bf16 v[44:47], v[64:67], v[124:127], v[44:47]
    v_mfma_f32_16x16x32_bf16 v[44:47], v[68:71], v[120:123], v[44:47]
    v_mfma_f32_16x16x32_bf16 v[44:47], v[72:75], v[116:119], v[44:47]
    v_mfma_f32_16x16x32_bf16 v[44:47], v[76:79], v[112:115], v[44:47]
    v_mfma_f32_16x16x32_bf16 v[40:43], v[80:83], v[168:171], v[40:43]
    v_mfma_f32_16x16x32_bf16 v[40:43], v[84:87], v[164:167], v[40:43]
    v_mfma_f32_16x16x32_bf16 v[40:43], v[88:91], v[160:163], v[40:43]
    v_mfma_f32_16x16x32_bf16 v[40:43], v[92:95], v[156:159], v[40:43]
    v_mfma_f32_16x16x32_bf16 v[40:43], v[96:99], v[152:155], v[40:43]
    v_mfma_f32_16x16x32_bf16 v[40:43], v[100:103], v[148:151], v[40:43]
    v_mfma_f32_16x16x32_bf16 v[40:43], v[104:107], v[144:147], v[40:43]
    v_mfma_f32_16x16x32_bf16 v[44:47], v[80:83], v[172:175], v[44:47]
    v_mfma_f32_16x16x32_bf16 v[44:47], v[84:87], v[168:171], v[44:47]
    v_mfma_f32_16x16x32_bf16 v[44:47], v[88:91], v[164:167], v[44:47]
    v_mfma_f32_16x16x32_bf16 v[44:47], v[92:95], v[160:163], v[44:47]
    v_mfma_f32_16x16x32_bf16 v[44:47], v[96:99], v[156:159], v[44:47]
    v_mfma_f32_16x16x32_bf16 v[44:47], v[100:103], v[152:155], v[44:47]
    v_mfma_f32_16x16x32_bf16 v[44:47], v[104:107], v[148:151], v[44:47]
    v_mfma_f32_16x16x32_bf16 v[44:47], v[108:111], v[144:147], v[44:47]
    v_cvt_pk_bf16_f32 v188, v40, v41
    v_cvt_pk_bf16_f32 v189, v42, v43
    s_nop 5
    v_cvt_pk_bf16_f32 v190, v44, v45
    v_cvt_pk_bf16_f32 v191, v46, v47
    s_mov_b32 s76, 202752
    buffer_store_dwordx4 v[188:191], v234, s[64:67], s76 offen sc1
    s_setprio 1
    s_waitcnt vmcnt(0)
    v_mov_b32 v238, 1
    s_mov_b64 exec, 1
    ds_add_rtn_u32 v237, v227, v238 offset:8
    s_waitcnt lgkmcnt(0)
    v_readfirstlane_b32 s76, v237
    s_nop 0
    s_cmp_eq_u32 s76, 3
    s_cbranch_scc0 L_jo_38a
    s_mov_b64 exec, 0xffff
    v_lshlrev_b32 v237, 8, v0
    buffer_atomic_add v238, v237, s[52:55], s73 offen sc1
L_jo_38a:
    s_mov_b64 exec, -1
    v_lshlrev_b32 v112, 16, v208
    v_and_b32 v113, 0xffff0000, v208
    v_lshlrev_b32 v114, 16, v209
    v_and_b32 v115, 0xffff0000, v209
    v_lshlrev_b32 v116, 16, v210
    v_and_b32 v117, 0xffff0000, v210
    v_lshlrev_b32 v118, 16, v211
    v_and_b32 v119, 0xffff0000, v211
    v_lshlrev_b32 v120, 16, v212
    v_and_b32 v121, 0xffff0000, v212
    v_lshlrev_b32 v122, 16, v213
    v_and_b32 v123, 0xffff0000, v213
    v_lshlrev_b32 v124, 16, v214
    v_and_b32 v125, 0xffff0000, v214
    v_lshlrev_b32 v126, 16, v215
    v_and_b32 v127, 0xffff0000, v215
    v_lshlrev_b32 v128, 16, v216
    v_and_b32 v129, 0xffff0000, v216
    v_lshlrev_b32 v130, 16, v217
    v_and_b32 v131, 0xffff0000, v217
    v_lshlrev_b32 v132, 16, v218
    v_and_b32 v133, 0xffff0000, v218
    v_lshlrev_b32 v134, 16, v219
    v_and_b32 v135, 0xffff0000, v219
    v_lshlrev_b32 v136, 16, v220
    v_and_b32 v137, 0xffff0000, v220
    v_lshlrev_b32 v138, 16, v221
    v_and_b32 v139, 0xffff0000, v221
    v_lshlrev_b32 v140, 16, v222
    v_and_b32 v141, 0xffff0000, v222
    v_lshlrev_b32 v142, 16, v223
    v_and_b32 v143, 0xffff0000, v223
    s_setprio 1
    s_setprio 1
    s_mul_i32 s77, s70, 4352
    s_add_u32 s77, s77, 60416
    v_lshrrev_b32 v234, 5, v0
    v_lshl_add_u32 v234, v234, 1, v0
    v_lshl_add_u32 v234, v234, 4, s77
    v_and_b32 v235, 7, v0
    v_mul_u32_u24 v235, 544, v235
    v_lshrrev_b32 v236, 3, v0
    v_lshl_add_u32 v235, v236, 3, v235
    v_add_u32 v235, s77, v235
    s_mul_i32 s77, s71, 4224
    s_mov_b32 s60, s26
    s_mov_b32 s61, s27
    s_mov_b32 s62, 0x800000
    s_mov_b32 s63, 0x20000
    s_cmp_eq_u32 s76, 3
    s_cbranch_scc0 L_jo_38
    s_mov_b32 s75, 131072
L_sg_loop_41:
    s_load_dword s74, s[52:53], s45 glc
L_sg_chk_42:
    s_waitcnt lgkmcnt(0)
    s_cmp_ge_u32 s74, 16
    s_cbranch_scc1 L_sg_done_40
    s_sub_u32 s75, s75, 1
    s_cbranch_scc0 L_sg_loop_41
L_sg_done_40:
    v_mov_b32 v237, 16
    s_mov_b64 exec, 1
    ds_add_u32 v227, v237 offset:16
    s_mov_b64 exec, -1
    s_branch L_jd_39
L_jo_38:
    s_mov_b32 s75, 1048576
L_sl_loop_44:
    ds_read_b32 v237, v227 offset:16
    s_waitcnt lgkmcnt(0)
    v_readfirstlane_b32 s74, v237
    s_nop 0
    s_cmp_ge_u32 s74, 16
    s_cbranch_scc1 L_sl_done_43
    s_sleep 1
    s_sub_u32 s75, s75, 1
    s_cbranch_scc0 L_sl_loop_44
L_sl_done_43:
L_jd_39:
    buffer_load_dwordx4 v[48:51], v224, s[64:67], s77 offen offset:0 sc1
    buffer_load_dwordx4 v[52:55], v224, s[64:67], s77 offen offset:1024 sc1
    buffer_load_dwordx4 v[56:59], v224, s[64:67], s77 offen offset:2048 sc1
    buffer_load_dwordx4 v[60:63], v224, s[64:67], s77 offen offset:3072 sc1
    s_waitcnt vmcnt(3)
    ds_write_b128 v234, v[48:51] offset:0
    s_waitcnt vmcnt(2)
    ds_write_b128 v234, v[52:55] offset:1088
    s_waitcnt vmcnt(1)
    ds_write_b128 v234, v[56:59] offset:2176
    s_waitcnt vmcnt(0)
    ds_write_b128 v234, v[60:63] offset:3264
    ds_read_b64 v[64:65], v235 offset:0
    ds_read_b64 v[66:67], v235 offset:64
    ds_read_b64 v[68:69], v235 offset:128
    ds_read_b64 v[70:71], v235 offset:192
    ds_read_b64 v[72:73], v235 offset:256
    ds_read_b64 v[74:75], v235 offset:320
    ds_read_b64 v[76:77], v235 offset:384
    ds_read_b64 v[78:79], v235 offset:448
    s_waitcnt lgkmcnt(7)
    v_lshlrev_b32 v16, 16, v64
    v_and_b32 v24, 0xffff0000, v64
    v_lshlrev_b32 v32, 16, v65
    v_and_b32 v40, 0xffff0000, v65
    s_waitcnt lgkmcnt(6)
    v_lshlrev_b32 v17, 16, v66
    v_and_b32 v25, 0xffff0000, v66
    v_lshlrev_b32 v33, 16, v67
    v_and_b32 v41, 0xffff0000, v67
    s_waitcnt lgkmcnt(5)
    v_lshlrev_b32 v18, 16, v68
    v_and_b32 v26, 0xffff0000, v68
    v_lshlrev_b32 v34, 16, v69
    v_and_b32 v42, 0xffff0000, v69
    s_waitcnt lgkmcnt(4)
    v_lshlrev_b32 v19, 16, v70
    v_and_b32 v27, 0xffff0000, v70
    v_lshlrev_b32 v35, 16, v71
    v_and_b32 v43, 0xffff0000, v71
    s_waitcnt lgkmcnt(3)
    v_lshlrev_b32 v20, 16, v72
    v_and_b32 v28, 0xffff0000, v72
    v_lshlrev_b32 v36, 16, v73
    v_and_b32 v44, 0xffff0000, v73
    s_waitcnt lgkmcnt(2)
    v_lshlrev_b32 v21, 16, v74
    v_and_b32 v29, 0xffff0000, v74
    v_lshlrev_b32 v37, 16, v75
    v_and_b32 v45, 0xffff0000, v75
    s_waitcnt lgkmcnt(1)
    v_lshlrev_b32 v22, 16, v76
    v_and_b32 v30, 0xffff0000, v76
    v_lshlrev_b32 v38, 16, v77
    v_and_b32 v46, 0xffff0000, v77
    s_waitcnt lgkmcnt(0)
    v_lshlrev_b32 v23, 16, v78
    v_and_b32 v31, 0xffff0000, v78
    v_lshlrev_b32 v39, 16, v79
    v_and_b32 v47, 0xffff0000, v79
    v_mul_f32 v16, v16, v112
    v_mul_f32 v17, v17, v113
    v_mul_f32 v18, v18, v114
    v_mul_f32 v19, v19, v115
    v_mul_f32 v20, v20, v116
    v_mul_f32 v21, v21, v117
    v_mul_f32 v22, v22, v118
    v_mul_f32 v23, v23, v119
    v_cvt_pk_bf16_f32 v48, v16, v17
    v_cvt_pk_bf16_f32 v49, v18, v19
    v_cvt_pk_bf16_f32 v50, v20, v21
    v_cvt_pk_bf16_f32 v51, v22, v23
    s_mov_b32 s74, 0
    buffer_store_dwordx4 v[48:51], v226, s[60:63], s74 offen nt
    v_mul_f32 v24, v24, v120
    v_mul_f32 v25, v25, v121
    v_mul_f32 v26, v26, v122
    v_mul_f32 v27, v27, v123
    v_mul_f32 v28, v28, v124
    v_mul_f32 v29, v29, v125
    v_mul_f32 v30, v30, v126
    v_mul_f32 v31, v31, v127
    v_cvt_pk_bf16_f32 v52, v24, v25
    v_cvt_pk_bf16_f32 v53, v26, v27
    v_cvt_pk_bf16_f32 v54, v28, v29
    v_cvt_pk_bf16_f32 v55, v30, v31
    s_mov_b32 s74, 4096
    buffer_store_dwordx4 v[52:55], v226, s[60:63], s74 offen nt
    v_mul_f32 v32, v32, v128
    v_mul_f32 v33, v33, v129
    v_mul_f32 v34, v34, v130
    v_mul_f32 v35, v35, v131
    v_mul_f32 v36, v36, v132
    v_mul_f32 v37, v37, v133
    v_mul_f32 v38, v38, v134
    v_mul_f32 v39, v39, v135
    v_cvt_pk_bf16_f32 v56, v32, v33
    v_cvt_pk_bf16_f32 v57, v34, v35
    v_cvt_pk_bf16_f32 v58, v36, v37
    v_cvt_pk_bf16_f32 v59, v38, v39
    s_mov_b32 s74, 16384
    buffer_store_dwordx4 v[56:59], v226, s[60:63], s74 offen nt
    v_mul_f32 v40, v40, v136
    v_mul_f32 v41, v41, v137
    v_mul_f32 v42, v42, v138
    v_mul_f32 v43, v43, v139
    v_mul_f32 v44, v44, v140
    v_mul_f32 v45, v45, v141
    v_mul_f32 v46, v46, v142
    v_mul_f32 v47, v47, v143
    v_cvt_pk_bf16_f32 v60, v40, v41
    v_cvt_pk_bf16_f32 v61, v42, v43
    v_cvt_pk_bf16_f32 v62, v44, v45
    v_cvt_pk_bf16_f32 v63, v46, v47
    s_mov_b32 s74, 20480
    buffer_store_dwordx4 v[60:63], v226, s[60:63], s74 offen nt
    s_endpgm
L_grole:
    s_setprio 2
    s_add_u32 s52, s30, 0xe00000
    s_addc_u32 s53, s31, 0
    s_mov_b32 s54, 0x20000
    s_mov_b32 s55, 0x20000
    s_lshr_b32 s32, s3, 1
    s_and_b32 s33, s3, 1
    v_and_b32 v1, 15, v0
    v_lshrrev_b32 v2, 4, v0
    v_lshrrev_b32 v3, 1, v1
    v_xor_b32 v3, v2, v3
    v_lshlrev_b32 v3, 4, v3
    v_lshl_add_u32 v3, v1, 7, v3
    s_lshl_b32 s37, s33, 13
    v_add_u32 v196, s37, v3
    v_xor_b32 v197, 64, v196
    v_and_b32 v198, 7, v1
    v_lshlrev_b32 v3, 1, v2
    v_xor_b32 v3, v3, v198
    v_lshlrev_b32 v3, 4, v3
    v_lshl_add_u32 v3, v198, 7, v3
    v_lshrrev_b32 v202, 3, v1
    v_lshl_add_u32 v3, v202, 2, v3
    v_add_u32 v198, 16384, v3
    v_xor_b32 v199, 16, v198
    v_mul_u32_u24 v202, 0xaaaa, v202
    v_add_u32 v202, 0x4444, v202
    v_bfe_u32 v3, v0, 2, 2
    v_lshl_add_u32 v200, v2, 3, v3
    v_lshlrev_b32 v200, 7, v200
    v_bfe_u32 v3, v0, 3, 2
    v_xor_b32 v3, s3, v3
    v_lshl_add_u32 v200, v3, 5, v200
    v_and_b32 v3, 3, v0
    v_lshl_add_u32 v200, v3, 3, v200
    v_add_u32 v200, 17408, v200
    v_xor_b32 v201, 32, v200
    v_mov_b64 v[52:53], 0
    v_mov_b64 v[54:55], 0
    v_mov_b64 v[56:57], 0
    v_mov_b64 v[58:59], 0
    v_mov_b64 v[60:61], 0
    v_mov_b64 v[62:63], 0
    v_mov_b64 v[64:65], 0
    v_mov_b64 v[66:67], 0
    v_mov_b64 v[68:69], 0
    v_mov_b64 v[70:71], 0
    v_mov_b64 v[72:73], 0
    v_mov_b64 v[74:75], 0
    v_mov_b64 v[76:77], 0
    v_mov_b64 v[78:79], 0
    v_mov_b64 v[80:81], 0
    v_mov_b64 v[82:83], 0
    v_mov_b64 v[84:85], 0
    v_mov_b64 v[86:87], 0
    v_mov_b64 v[88:89], 0
    v_mov_b64 v[90:91], 0
    v_mov_b64 v[92:93], 0
    v_mov_b64 v[94:95], 0
    v_mov_b64 v[96:97], 0
    v_mov_b64 v[98:99], 0
    v_mov_b64 v[100:101], 0
    v_mov_b64 v[102:103], 0
    v_mov_b64 v[104:105], 0
    v_mov_b64 v[106:107], 0
    s_mov_b32 s34, 0
    v_mov_b32 v228, 134352
    v_and_b32 v1, 15, v0
    v_lshrrev_b32 v2, 4, v0
    v_lshlrev_b32 v2, 2, v2
    v_sub_u32 v1, v1, v2
    s_mov_b32 s37, 0xf149f2ca
    v_mov_b32 v3, s37
    s_or_b32 s38, s5, s33
    s_cmp_eq_u32 s38, 0
    s_cselect_b32 s38, s37, 0
    v_subrev_u32 v2, 0, v1
    v_cmp_gt_u32 vcc, 8, v2
    v_cmp_gt_i32 s[64:65], -8, v2
    v_ashrrev_i32 v2, 31, v2
    v_cndmask_b32 v204, v3, 0, vcc
    v_cndmask_b32 v208, v3, 0, s[64:65]
    v_mov_b32 v216, v2
    v_min_f32 v212, s38, v208
    v_subrev_u32 v2, 1, v1
    v_cmp_gt_u32 vcc, 8, v2
    v_cmp_gt_i32 s[64:65], -8, v2
    v_ashrrev_i32 v2, 31, v2
    v_cndmask_b32 v205, v3, 0, vcc
    v_cndmask_b32 v209, v3, 0, s[64:65]
    v_alignbit_b32 v216, v2, v216, 16
    v_min_f32 v213, s38, v209
    v_subrev_u32 v2, 2, v1
    v_cmp_gt_u32 vcc, 8, v2
    v_cmp_gt_i32 s[64:65], -8, v2
    v_ashrrev_i32 v2, 31, v2
    v_cndmask_b32 v206, v3, 0, vcc
    v_cndmask_b32 v210, v3, 0, s[64:65]
    v_mov_b32 v217, v2
    v_min_f32 v214, s38, v210
    v_subrev_u32 v2, 3, v1
    v_cmp_gt_u32 vcc, 8, v2
    v_cmp_gt_i32 s[64:65], -8, v2
    v_ashrrev_i32 v2, 31, v2
    v_cndmask_b32 v207, v3, 0, vcc
    v_cndmask_b32 v211, v3, 0, s[64:65]
    v_alignbit_b32 v217, v2, v217, 16
    v_min_f32 v215, s38, v211
    s_mul_i32 s37, s32, 80896
    s_add_u32 s37, s37, 78848
    v_lshl_add_u32 v220, v0, 3, s37
    s_lshl_b32 s38, s33, 9
    v_add_u32 v219, s38, v220
    s_add_u32 s38, s38, s37
    v_and_b32 v1, 3, v0
    v_lshl_add_u32 v1, v1, 1, s38
    v_bfe_u32 v2, v0, 2, 2
    v_lshl_add_u32 v1, v2, 7, v1
    v_lshrrev_b32 v2, 4, v0
    v_xor_b32 v2, 2, v2
    v_lshl_add_u32 v203, v2, 5, v1
    s_mul_i32 s38, s33, 2560
    v_add_u32 v221, s38, v220
    v_xor_b32 v222, 512, v221
    s_lshl3_add_u32 s37, s4, s5
    s_lshl1_add_u32 s37, s37, s33
    s_lshl_b32 s37, s37, 7
    s_lshl1_add_u32 s38, s6, s32
    s_add_u32 s37, s37, s38
    s_lshl_b32 s37, s37, 10
    v_lshl_add_u32 v218, v0, 4, s37
    s_mov_b32 s40, s30
    s_mov_b32 s41, s31
    s_mov_b32 s42, 0x400000
    s_mov_b32 s43, 0x20000
    s_and_b32 s58, s2, 3
    s_bfe_u32 s37, s2, 0x20003
    s_lshl2_add_u32 s58, s58, s37
    s_bfe_u32 s59, s2, 0x10002
    s_lshr_b32 s37, s2, 5
    s_lshl3_add_u32 s59, s59, s37
    s_mov_b32 s44, s24
    s_mov_b32 s45, s25
    s_mov_b32 s46, 0x200000
    s_mov_b32 s47, 0x20000
    s_mov_b32 s48, s26
    s_mov_b32 s49, s27
    s_mov_b32 s50, 0x800000
    s_mov_b32 s51, 0x20000
    s_lshl3_add_u32 s56, s4, s5
    s_lshl4_add_u32 s56, s56, 0
    s_lshl_b32 s56, s56, 8
    s_lshl4_add_u32 s57, s58, 0
    s_add_u32 s57, s57, s59
    s_lshl_b32 s57, s57, 8
    s_lshl2_add_u32 s37, s58, s3
    s_lshl_b32 s38, s37, 16
    v_lshl_add_u32 v224, v0, 4, s38
    v_add_u32 v225, 0x8000, v224
    s_and_b32 s37, s37, 31
    s_lshl_b32 s37, s37, 6
    s_lshr_b32 s38, s58, 3
    s_add_u32 s37, s37, s38
    s_lshl_b32 s37, s37, 5
    s_add_u32 s37, s37, s59
    s_add_u32 s37, s37, 16
    s_lshl_b32 s37, s37, 7
    v_lshrrev_b32 v1, 3, v0
    v_lshl_add_u32 v1, v1, 13, s37
    v_and_b32 v2, 7, v0
    v_lshl_add_u32 v226, v2, 4, v1
    v_lshrrev_b32 v1, 4, v0
    v_lshlrev_b32 v1, 1, v1
    v_xor_b32 v1, v0, v1
    v_and_b32 v1, 7, v1
    s_lshl_b32 s37, s59, 7
    v_lshl_add_u32 v1, v1, 4, s37
    v_lshrrev_b32 v227, 3, v0
    v_lshl_add_u32 v227, v227, 11, v1
    v_add_u32 v223, 15360, v227
    s_lshl_b32 s60, s3, 11
    s_mul_i32 s61, s59, 0
    s_and_b32 s61, s61, 7
    s_lshl3_add_u32 s62, s61, s3
    s_lshl_b32 s62, s62, 15
    v_lshrrev_b32 v1, 2, v0
    v_lshlrev_b32 v1, 7, v1
    v_bfe_u32 v2, v0, 3, 2
    v_lshl_add_u32 v1, v2, 5, v1
    v_and_b32 v2, 3, v0
    v_lshl_add_u32 v229, v2, 3, v1
    v_and_b32 v231, 7, v0
    v_lshl_add_u32 v230, v231, 6, s86
    v_mul_u32_u24 v231, 528, v231
    v_lshrrev_b32 v232, 3, v0
    v_xor_b32 v232, 7, v232
    v_lshl_add_u32 v231, v232, 3, v231
    v_add_u32 v231, s86, v231
    v_lshrrev_b32 v232, 5, v0
    v_add_u32 v232, v0, v232
    v_lshl_add_u32 v232, v232, 4, s86
    s_mul_i32 s87, s84, 4224
    s_sub_u32 s87, s87, s85
    s_lshl_b32 s87, s87, 6
    s_add_u32 s87, s87, 4032
    v_and_b32 v233, 3, v0
    v_lshl_add_u32 v233, v233, 4, s87
    v_lshrrev_b32 v234, 2, v0
    v_mul_u32_u24 v234, 4224, v234
    v_add_u32 v233, v233, v234
    s_add_u32 s80, s30, 0x400000
    s_addc_u32 s81, s31, 0
    s_mov_b32 s82, 0x420000
    s_mov_b32 s83, 0x20000
    s_waitcnt vmcnt(11)
    ds_read_b128 v[36:39], v230 offset:4224
    ds_read_b128 v[40:43], v230 offset:4240
    ds_read_b128 v[44:47], v230 offset:4256
    ds_read_b128 v[48:51], v230 offset:4272
    s_waitcnt lgkmcnt(3)
    v_lshlrev_b32 v152, 16, v36
    v_and_b32 v154, 0xffff0000, v36
    v_lshlrev_b32 v156, 16, v37
    v_and_b32 v158, 0xffff0000, v37
    v_lshlrev_b32 v153, 16, v38
    v_and_b32 v155, 0xffff0000, v38
    v_lshlrev_b32 v157, 16, v39
    v_and_b32 v159, 0xffff0000, v39
    s_waitcnt lgkmcnt(2)
    v_lshlrev_b32 v160, 16, v40
    v_and_b32 v162, 0xffff0000, v40
    v_lshlrev_b32 v164, 16, v41
    v_and_b32 v166, 0xffff0000, v41
    v_lshlrev_b32 v161, 16, v42
    v_and_b32 v163, 0xffff0000, v42
    v_lshlrev_b32 v165, 16, v43
    v_and_b32 v167, 0xffff0000, v43
    s_waitcnt lgkmcnt(1)
    v_lshlrev_b32 v168, 16, v44
    v_and_b32 v170, 0xffff0000, v44
    v_lshlrev_b32 v172, 16, v45
    v_and_b32 v174, 0xffff0000, v45
    v_lshlrev_b32 v169, 16, v46
    v_and_b32 v171, 0xffff0000, v46
    v_lshlrev_b32 v173, 16, v47
    v_and_b32 v175, 0xffff0000, v47
    s_waitcnt lgkmcnt(0)
    v_lshlrev_b32 v176, 16, v48
    v_and_b32 v178, 0xffff0000, v48
    v_lshlrev_b32 v180, 16, v49
    v_and_b32 v182, 0xffff0000, v49
    v_lshlrev_b32 v177, 16, v50
    v_and_b32 v179, 0xffff0000, v50
    v_lshlrev_b32 v181, 16, v51
    v_and_b32 v183, 0xffff0000, v51
    v_mov_b64 v[36:37], 0
    v_mov_b64 v[38:39], 0
    v_mov_b64 v[40:41], 0
    v_mov_b64 v[42:43], 0
    v_mov_b64 v[44:45], 0
    v_mov_b64 v[46:47], 0
    v_mov_b64 v[48:49], 0
    v_mov_b64 v[50:51], 0
    s_waitcnt vmcnt(10)
    v_lshlrev_b32 v184, 16, v108
    v_and_b32 v185, 0xffff0000, v108
    v_lshlrev_b32 v186, 16, v109
    v_and_b32 v187, 0xffff0000, v109
    v_lshlrev_b32 v188, 16, v110
    v_and_b32 v189, 0xffff0000, v110
    v_lshlrev_b32 v190, 16, v111
    v_and_b32 v191, 0xffff0000, v111
    v_pk_mul_f32 v[4:5], v[184:185], v[158:159]
    v_pk_mul_f32 v[12:13], v[186:187], v[166:167]
    v_pk_mul_f32 v[20:21], v[188:189], v[174:175]
    v_pk_mul_f32 v[28:29], v[190:191], v[182:183]
    s_waitcnt vmcnt(9)
    v_lshlrev_b32 v184, 16, v112
    v_and_b32 v185, 0xffff0000, v112
    v_lshlrev_b32 v186, 16, v113
    v_and_b32 v187, 0xffff0000, v113
    v_lshlrev_b32 v188, 16, v114
    v_and_b32 v189, 0xffff0000, v114
    v_lshlrev_b32 v190, 16, v115
    v_and_b32 v191, 0xffff0000, v115
    v_pk_fma_f32 v[4:5], v[184:185], v[156:157], v[4:5]
    v_pk_fma_f32 v[12:13], v[186:187], v[164:165], v[12:13]
    v_pk_fma_f32 v[20:21], v[188:189], v[172:173], v[20:21]
    v_pk_fma_f32 v[28:29], v[190:191], v[180:181], v[28:29]
    v_pk_mul_f32 v[6:7], v[184:185], v[158:159]
    v_pk_mul_f32 v[14:15], v[186:187], v[166:167]
    v_pk_mul_f32 v[22:23], v[188:189], v[174:175]
    v_pk_mul_f32 v[30:31], v[190:191], v[182:183]
    s_waitcnt vmcnt(8)
    v_lshlrev_b32 v184, 16, v116
    v_and_b32 v185, 0xffff0000, v116
    v_lshlrev_b32 v186, 16, v117
    v_and_b32 v187, 0xffff0000, v117
    v_lshlrev_b32 v188, 16, v118
    v_and_b32 v189, 0xffff0000, v118
    v_lshlrev_b32 v190, 16, v119
    v_and_b32 v191, 0xffff0000, v119
    v_pk_fma_f32 v[4:5], v[184:185], v[154:155], v[4:5]
    v_pk_fma_f32 v[12:13], v[186:187], v[162:163], v[12:13]
    v_pk_fma_f32 v[20:21], v[188:189], v[170:171], v[20:21]
    v_pk_fma_f32 v[28:29], v[190:191], v[178:179], v[28:29]
    v_pk_fma_f32 v[6:7], v[184:185], v[156:157], v[6:7]
    v_pk_fma_f32 v[14:15], v[186:187], v[164:165], v[14:15]
    v_pk_fma_f32 v[22:23], v[188:189], v[172:173], v[22:23]
    v_pk_fma_f32 v[30:31], v[190:191], v[180:181], v[30:31]
    v_pk_mul_f32 v[8:9], v[184:185], v[158:159]
    v_pk_mul_f32 v[16:17], v[186:187], v[166:167]
    v_pk_mul_f32 v[24:25], v[188:189], v[174:175]
    v_pk_mul_f32 v[32:33], v[190:191], v[182:183]
    s_waitcnt vmcnt(7)
    v_lshlrev_b32 v184, 16, v120
    v_and_b32 v185, 0xffff0000, v120
    v_lshlrev_b32 v186, 16, v121
    v_and_b32 v187, 0xffff0000, v121
    v_lshlrev_b32 v188, 16, v122
    v_and_b32 v189, 0xffff0000, v122
    v_lshlrev_b32 v190, 16, v123
    v_and_b32 v191, 0xffff0000, v123
    v_pk_fma_f32 v[4:5], v[184:185], v[152:153], v[4:5]
    v_pk_fma_f32 v[12:13], v[186:187], v[160:161], v[12:13]
    v_pk_fma_f32 v[20:21], v[188:189], v[168:169], v[20:21]
    v_pk_fma_f32 v[28:29], v[190:191], v[176:177], v[28:29]
    v_pk_fma_f32 v[6:7], v[184:185], v[154:155], v[6:7]
    v_pk_fma_f32 v[14:15], v[186:187], v[162:163], v[14:15]
    v_pk_fma_f32 v[22:23], v[188:189], v[170:171], v[22:23]
    v_pk_fma_f32 v[30:31], v[190:191], v[178:179], v[30:31]
    v_pk_fma_f32 v[8:9], v[184:185], v[156:157], v[8:9]
    v_pk_fma_f32 v[16:17], v[186:187], v[164:165], v[16:17]
    v_pk_fma_f32 v[24:25], v[188:189], v[172:173], v[24:25]
    v_pk_fma_f32 v[32:33], v[190:191], v[180:181], v[32:33]
    v_pk_mul_f32 v[10:11], v[184:185], v[158:159]
    v_pk_mul_f32 v[18:19], v[186:187], v[166:167]
    v_pk_mul_f32 v[26:27], v[188:189], v[174:175]
    v_pk_mul_f32 v[34:35], v[190:191], v[182:183]
    s_waitcnt vmcnt(6)
    v_lshlrev_b32 v184, 16, v124
    v_and_b32 v185, 0xffff0000, v124
    v_lshlrev_b32 v186, 16, v125
    v_and_b32 v187, 0xffff0000, v125
    v_lshlrev_b32 v188, 16, v126
    v_and_b32 v189, 0xffff0000, v126
    v_lshlrev_b32 v190, 16, v127
    v_and_b32 v191, 0xffff0000, v127
    v_pk_fma_f32 v[6:7], v[184:185], v[152:153], v[6:7]
    v_pk_fma_f32 v[14:15], v[186:187], v[160:161], v[14:15]
    v_pk_fma_f32 v[22:23], v[188:189], v[168:169], v[22:23]
    v_pk_fma_f32 v[30:31], v[190:191], v[176:177], v[30:31]
    v_pk_fma_f32 v[8:9], v[184:185], v[154:155], v[8:9]
    v_pk_fma_f32 v[16:17], v[186:187], v[162:163], v[16:17]
    v_pk_fma_f32 v[24:25], v[188:189], v[170:171], v[24:25]
    v_pk_fma_f32 v[32:33], v[190:191], v[178:179], v[32:33]
    v_pk_fma_f32 v[10:11], v[184:185], v[156:157], v[10:11]
    v_pk_fma_f32 v[18:19], v[186:187], v[164:165], v[18:19]
    v_pk_fma_f32 v[26:27], v[188:189], v[172:173], v[26:27]
    v_pk_fma_f32 v[34:35], v[190:191], v[180:181], v[34:35]
    s_waitcnt vmcnt(5)
    v_lshlrev_b32 v184, 16, v128
    v_and_b32 v185, 0xffff0000, v128
    v_lshlrev_b32 v186, 16, v129
    v_and_b32 v187, 0xffff0000, v129
    v_lshlrev_b32 v188, 16, v130
    v_and_b32 v189, 0xffff0000, v130
    v_lshlrev_b32 v190, 16, v131
    v_and_b32 v191, 0xffff0000, v131
    v_pk_fma_f32 v[8:9], v[184:185], v[152:153], v[8:9]
    v_pk_fma_f32 v[16:17], v[186:187], v[160:161], v[16:17]
    v_pk_fma_f32 v[24:25], v[188:189], v[168:169], v[24:25]
    v_pk_fma_f32 v[32:33], v[190:191], v[176:177], v[32:33]
    v_pk_fma_f32 v[10:11], v[184:185], v[154:155], v[10:11]
    v_pk_fma_f32 v[18:19], v[186:187], v[162:163], v[18:19]
    v_pk_fma_f32 v[26:27], v[188:189], v[170:171], v[26:27]
    v_pk_fma_f32 v[34:35], v[190:191], v[178:179], v[34:35]
    s_waitcnt vmcnt(4)
    v_lshlrev_b32 v184, 16, v132
    v_and_b32 v185, 0xffff0000, v132
    v_lshlrev_b32 v186, 16, v133
    v_and_b32 v187, 0xffff0000, v133
    v_lshlrev_b32 v188, 16, v134
    v_and_b32 v189, 0xffff0000, v134
    v_lshlrev_b32 v190, 16, v135
    v_and_b32 v191, 0xffff0000, v135
    v_pk_fma_f32 v[10:11], v[184:185], v[152:153], v[10:11]
    v_pk_fma_f32 v[18:19], v[186:187], v[160:161], v[18:19]
    v_pk_fma_f32 v[26:27], v[188:189], v[168:169], v[26:27]
    v_pk_fma_f32 v[34:35], v[190:191], v[176:177], v[34:35]
    s_waitcnt vmcnt(3)
    v_lshlrev_b32 v184, 16, v136
    v_and_b32 v185, 0xffff0000, v136
    v_lshlrev_b32 v186, 16, v137
    v_and_b32 v187, 0xffff0000, v137
    v_lshlrev_b32 v188, 16, v138
    v_and_b32 v189, 0xffff0000, v138
    v_lshlrev_b32 v190, 16, v139
    v_and_b32 v191, 0xffff0000, v139
    v_pk_mul_f32 v[4:5], v[4:5], v[184:185]
    v_pk_mul_f32 v[12:13], v[12:13], v[186:187]
    v_pk_mul_f32 v[20:21], v[20:21], v[188:189]
    v_pk_mul_f32 v[28:29], v[28:29], v[190:191]
    s_waitcnt vmcnt(2)
    v_lshlrev_b32 v184, 16, v140
    v_and_b32 v185, 0xffff0000, v140
    v_lshlrev_b32 v186, 16, v141
    v_and_b32 v187, 0xffff0000, v141
    v_lshlrev_b32 v188, 16, v142
    v_and_b32 v189, 0xffff0000, v142
    v_lshlrev_b32 v190, 16, v143
    v_and_b32 v191, 0xffff0000, v143
    v_pk_mul_f32 v[6:7], v[6:7], v[184:185]
    v_pk_mul_f32 v[14:15], v[14:15], v[186:187]
    v_pk_mul_f32 v[22:23], v[22:23], v[188:189]
    v_pk_mul_f32 v[30:31], v[30:31], v[190:191]
    s_waitcnt vmcnt(1)
    v_lshlrev_b32 v184, 16, v144
    v_and_b32 v185, 0xffff0000, v144
    v_lshlrev_b32 v186, 16, v145
    v_and_b32 v187, 0xffff0000, v145
    v_lshlrev_b32 v188, 16, v146
    v_and_b32 v189, 0xffff0000, v146
    v_lshlrev_b32 v190, 16, v147
    v_and_b32 v191, 0xffff0000, v147
    v_pk_mul_f32 v[8:9], v[8:9], v[184:185]
    v_pk_mul_f32 v[16:17], v[16:17], v[186:187]
    v_pk_mul_f32 v[24:25], v[24:25], v[188:189]
    v_pk_mul_f32 v[32:33], v[32:33], v[190:191]
    s_waitcnt vmcnt(0)
    v_lshlrev_b32 v184, 16, v148
    v_and_b32 v185, 0xffff0000, v148
    v_lshlrev_b32 v186, 16, v149
    v_and_b32 v187, 0xffff0000, v149
    v_lshlrev_b32 v188, 16, v150
    v_and_b32 v189, 0xffff0000, v150
    v_lshlrev_b32 v190, 16, v151
    v_and_b32 v191, 0xffff0000, v151
    v_pk_mul_f32 v[10:11], v[10:11], v[184:185]
    v_pk_mul_f32 v[18:19], v[18:19], v[186:187]
    v_pk_mul_f32 v[26:27], v[26:27], v[188:189]
    v_pk_mul_f32 v[34:35], v[34:35], v[190:191]
    v_cvt_pk_bf16_f32 v108, v10, v8
    v_cvt_pk_bf16_f32 v109, v6, v4
    ds_write_b64 v231, v[108:109] offset:0
    v_cvt_pk_bf16_f32 v110, v11, v9
    v_cvt_pk_bf16_f32 v111, v7, v5
    ds_write_b64 v231, v[110:111] offset:64
    v_cvt_pk_bf16_f32 v112, v18, v16
    v_cvt_pk_bf16_f32 v113, v14, v12
    ds_write_b64 v231, v[112:113] offset:128
    v_cvt_pk_bf16_f32 v114, v19, v17
    v_cvt_pk_bf16_f32 v115, v15, v13
    ds_write_b64 v231, v[114:115] offset:192
    v_cvt_pk_bf16_f32 v116, v26, v24
    v_cvt_pk_bf16_f32 v117, v22, v20
    ds_write_b64 v231, v[116:117] offset:256
    v_cvt_pk_bf16_f32 v118, v27, v25
    v_cvt_pk_bf16_f32 v119, v23, v21
    ds_write_b64 v231, v[118:119] offset:320
    v_cvt_pk_bf16_f32 v120, v34, v32
    v_cvt_pk_bf16_f32 v121, v30, v28
    ds_write_b64 v231, v[120:121] offset:384
    v_cvt_pk_bf16_f32 v122, v35, v33
    v_cvt_pk_bf16_f32 v123, v31, v29
    ds_write_b64 v231, v[122:123] offset:448
    ds_read_b128 v[234:237], v232 offset:0
    ds_read_b128 v[238:241], v232 offset:1056
    ds_read_b128 v[242:245], v232 offset:2112
    ds_read_b128 v[246:249], v232 offset:3168
    v_mov_b64 v[4:5], 0
    v_mov_b64 v[6:7], 0
    v_mov_b64 v[8:9], 0
    v_mov_b64 v[10:11], 0
    v_mov_b64 v[12:13], 0
    v_mov_b64 v[14:15], 0
    v_mov_b64 v[16:17], 0
    v_mov_b64 v[18:19], 0
    v_mov_b64 v[20:21], 0
    v_mov_b64 v[22:23], 0
    v_mov_b64 v[24:25], 0
    v_mov_b64 v[26:27], 0
    v_mov_b64 v[28:29], 0
    v_mov_b64 v[30:31], 0
    v_mov_b64 v[32:33], 0
    v_mov_b64 v[34:35], 0
    s_waitcnt lgkmcnt(0)
    s_and_b32 s37, s2, 7
    s_xor_b32 s37, s37, 2
    s_lshl_b32 s37, s37, 5
    s_lshr_b32 s38, s2, 3
    s_add_u32 s37, s37, s38
    s_add_u32 s37, s37, 256
    s_lshl_b32 s37, s37, 8
    s_cmp_eq_u32 s33, 0
    s_cselect_b32 s37, s37, s57
    s_cmp_eq_u32 s32, 0
    s_cbranch_scc0 L_noclear
    s_mov_b64 exec, 1
    buffer_store_dword v4, off, s[52:55], s37 sc1
    s_mov_b64 exec, -1
L_noclear:
    s_mov_b32 s37, 41984
    s_mov_b32 s36, 15
    s_barrier
    ds_read_b128 v[108:111], v196 offset:0
    ds_read_b64_tr_b16 v[124:125], v200 offset:0
    ds_read_b64_tr_b16 v[126:127], v200 offset:512
    ds_read_b128 v[112:115], v196 offset:2048
    ds_read_b64_tr_b16 v[128:129], v201 offset:0
    ds_read_b64_tr_b16 v[130:131], v201 offset:512
    ds_read_b128 v[116:119], v196 offset:4096
    ds_read_b64_tr_b16 v[148:149], v200 offset:8192
    ds_read_b64_tr_b16 v[150:151], v200 offset:8704
    ds_read_b128 v[120:123], v196 offset:6144
    ds_read_b64_tr_b16 v[132:133], v201 offset:8192
    ds_read_b64_tr_b16 v[134:135], v201 offset:8704
    ds_read_b64_tr_b16 v[156:157], v200 offset:16384
    ds_read_b64_tr_b16 v[158:159], v200 offset:16896
    ds_read_b64_tr_b16 v[136:137], v201 offset:16384
    ds_read_b64_tr_b16 v[138:139], v201 offset:16896
    s_mov_b32 s87, 0
    buffer_store_dwordx4 v[234:237], v233, s[80:83], s87 offen sc1
    s_mov_b32 s87, 67584
    buffer_store_dwordx4 v[238:241], v233, s[80:83], s87 offen sc1
    s_mov_b32 s87, 135168
    buffer_store_dwordx4 v[242:245], v233, s[80:83], s87 offen sc1
    s_mov_b32 s87, 202752
    buffer_store_dwordx4 v[246:249], v233, s[80:83], s87 offen sc1
    s_branch L_g1_head
L_g1_rare:
    v_readfirstlane_b32 s38, v1
    s_nop 0
    s_cmp_ge_u32 s38, 4
    s_cbranch_scc1 L_sl_done_45
    s_mov_b32 s39, 1048576
L_sl_loop_46:
    ds_read_b32 v1, v228 offset:24
    s_waitcnt lgkmcnt(0)
    v_readfirstlane_b32 s38, v1
    s_nop 0
    s_cmp_ge_u32 s38, 4
    s_cbranch_scc1 L_sl_done_45
    s_sleep 1
    s_sub_u32 s39, s39, 1
    s_cbranch_scc0 L_sl_loop_46
L_sl_done_45:
    s_branch L_g1_nobar
.p2align 6
L_g1_head:
    s_waitcnt lgkmcnt(0)
L_g1_loop:
    v_mfma_f32_16x16x32_bf16 v[4:7], v[124:127], v[108:111], v[4:7]
    ds_read_b128 v[164:167], v197 offset:0
    v_mfma_f32_16x16x32_bf16 v[12:15], v[124:127], v[112:115], v[12:15]
    ds_read_b64_tr_b16 v[180:181], v200 offset:4096
    v_mfma_f32_16x16x32_bf16 v[20:23], v[124:127], v[116:119], v[20:23]
    ds_read_b64_tr_b16 v[182:183], v200 offset:4608
    v_mfma_f32_16x16x32_bf16 v[28:31], v[124:127], v[120:123], v[28:31]
    ds_read_b128 v[168:171], v197 offset:2048
    v_mfma_f32_16x16x32_bf16 v[32:35], v[128:131], v[120:123], v[32:35]
    ds_read_b64_tr_b16 v[184:185], v201 offset:4096
    v_mfma_f32_16x16x32_bf16 v[24:27], v[128:131], v[116:119], v[24:27]
    ds_read_b64_tr_b16 v[186:187], v201 offset:4608
    v_mfma_f32_16x16x32_bf16 v[16:19], v[128:131], v[112:115], v[16:19]
    ds_read_b128 v[172:175], v197 offset:4096
    v_mfma_f32_16x16x32_bf16 v[8:11], v[128:131], v[108:111], v[8:11]
    ds_read_b64_tr_b16 v[152:153], v200 offset:12288
    v_mfma_f32_16x16x32_bf16 v[40:43], v[132:135], v[108:111], v[40:43]
    ds_read_b64_tr_b16 v[154:155], v200 offset:12800
    v_mfma_f32_16x16x32_bf16 v[48:51], v[132:135], v[112:115], v[48:51]
    ds_read_b128 v[176:179], v197 offset:6144
    v_mfma_f32_16x16x32_bf16 v[56:59], v[132:135], v[116:119], v[56:59]
    ds_read_b64_tr_b16 v[188:189], v201 offset:12288
    v_mfma_f32_16x16x32_bf16 v[64:67], v[132:135], v[120:123], v[64:67]
    ds_read_b64_tr_b16 v[190:191], v201 offset:12800
    v_mfma_f32_16x16x32_bf16 v[60:63], v[148:151], v[120:123], v[60:63]
    ds_read2_b32 v[140:141], v198 offset1:2
    v_mfma_f32_16x16x32_bf16 v[52:55], v[148:151], v[116:119], v[52:55]
    ds_read2_b32 v[142:143], v199 offset1:2
    v_mfma_f32_16x16x32_bf16 v[44:47], v[148:151], v[112:115], v[44:47]
    ds_read_b64_tr_b16 v[160:161], v200 offset:20480
    v_mfma_f32_16x16x32_bf16 v[36:39], v[148:151], v[108:111], v[36:39]
    ds_read_b64_tr_b16 v[162:163], v200 offset:20992
    v_mfma_f32_16x16x32_bf16 v[68:71], v[108:111], v[156:159], v[68:71]
    ds_read_b64_tr_b16 v[192:193], v201 offset:20480
    ds_read_b64_tr_b16 v[194:195], v201 offset:20992
    v_mfma_f32_16x16x32_bf16 v[76:79], v[112:115], v[156:159], v[76:79]
    ds_read_b32 v1, v228 offset:24
    s_add_u32 s34, s34, 41984
    v_mfma_f32_16x16x32_bf16 v[84:87], v[116:119], v[156:159], v[84:87]
    s_cmp_eq_u32 s34, 125952
    s_cselect_b32 s35, -83968, s37
    v_mfma_f32_16x16x32_bf16 v[92:95], v[120:123], v[156:159], v[92:95]
    s_cselect_b32 s34, 0, s34
    s_cmp_eq_u32 s36, 1
    v_mfma_f32_16x16x32_bf16 v[96:99], v[120:123], v[136:139], v[96:99]
    v_add_u32 v196, s35, v196
    v_add_u32 v197, s35, v197
    v_mfma_f32_16x16x32_bf16 v[88:91], v[116:119], v[136:139], v[88:91]
    v_add_u32 v198, s35, v198
    v_add_u32 v199, s35, v199
    v_mfma_f32_16x16x32_bf16 v[80:83], v[112:115], v[136:139], v[80:83]
    v_add_u32 v200, s35, v200
    v_add_u32 v201, s35, v201
    v_mfma_f32_16x16x32_bf16 v[72:75], v[108:111], v[136:139], v[72:75]
    s_waitcnt lgkmcnt(0)
    v_smfmac_f32_16x16x64_bf16 v[100:103], v[140:143], v[148:155], v202
    v_smfmac_f32_16x16x64_bf16 v[104:107], v[140:143], v[156:163], v202
    s_cbranch_scc1 L_g1_rare
L_g1_bar:
    s_barrier
L_g1_nobar:
    v_mfma_f32_16x16x32_bf16 v[4:7], v[180:183], v[164:167], v[4:7]
    ds_read_b128 v[108:111], v196 offset:0
    v_mfma_f32_16x16x32_bf16 v[12:15], v[180:183], v[168:171], v[12:15]
    ds_read_b64_tr_b16 v[124:125], v200 offset:0
    v_mfma_f32_16x16x32_bf16 v[20:23], v[180:183], v[172:175], v[20:23]
    ds_read_b64_tr_b16 v[126:127], v200 offset:512
    v_mfma_f32_16x16x32_bf16 v[28:31], v[180:183], v[176:179], v[28:31]
    ds_read_b128 v[112:115], v196 offset:2048
    v_mfma_f32_16x16x32_bf16 v[32:35], v[184:187], v[176:179], v[32:35]
    ds_read_b64_tr_b16 v[128:129], v201 offset:0
    v_mfma_f32_16x16x32_bf16 v[24:27], v[184:187], v[172:175], v[24:27]
    ds_read_b64_tr_b16 v[130:131], v201 offset:512
    v_mfma_f32_16x16x32_bf16 v[16:19], v[184:187], v[168:171], v[16:19]
    ds_read_b128 v[116:119], v196 offset:4096
    v_mfma_f32_16x16x32_bf16 v[8:11], v[184:187], v[164:167], v[8:11]
    ds_read_b64_tr_b16 v[148:149], v200 offset:8192
    v_mfma_f32_16x16x32_bf16 v[40:43], v[188:191], v[164:167], v[40:43]
    ds_read_b64_tr_b16 v[150:151], v200 offset:8704
    v_mfma_f32_16x16x32_bf16 v[48:51], v[188:191], v[168:171], v[48:51]
    ds_read_b128 v[120:123], v196 offset:6144
    v_mfma_f32_16x16x32_bf16 v[56:59], v[188:191], v[172:175], v[56:59]
    ds_read_b64_tr_b16 v[132:133], v201 offset:8192
    v_mfma_f32_16x16x32_bf16 v[64:67], v[188:191], v[176:179], v[64:67]
    ds_read_b64_tr_b16 v[134:135], v201 offset:8704
    v_mfma_f32_16x16x32_bf16 v[60:63], v[152:155], v[176:179], v[60:63]
    ds_read_b64_tr_b16 v[156:157], v200 offset:16384
    v_mfma_f32_16x16x32_bf16 v[52:55], v[152:155], v[172:175], v[52:55]
    ds_read_b64_tr_b16 v[158:159], v200 offset:16896
    v_mfma_f32_16x16x32_bf16 v[44:47], v[152:155], v[168:171], v[44:47]
    ds_read_b64_tr_b16 v[136:137], v201 offset:16384
    v_mfma_f32_16x16x32_bf16 v[36:39], v[152:155], v[164:167], v[36:39]
    ds_read_b64_tr_b16 v[138:139], v201 offset:16896
    v_mfma_f32_16x16x32_bf16 v[68:71], v[164:167], v[160:163], v[68:71]
    s_sub_u32 s36, s36, 1
    v_mfma_f32_16x16x32_bf16 v[76:79], v[168:171], v[160:163], v[76:79]
    s_cmp_lg_u32 s36, 0
    v_mfma_f32_16x16x32_bf16 v[84:87], v[172:175], v[160:163], v[84:87]
    v_mfma_f32_16x16x32_bf16 v[92:95], v[176:179], v[160:163], v[92:95]
    v_mfma_f32_16x16x32_bf16 v[96:99], v[176:179], v[192:195], v[96:99]
    v_mfma_f32_16x16x32_bf16 v[88:91], v[172:175], v[192:195], v[88:91]
    v_mfma_f32_16x16x32_bf16 v[80:83], v[168:171], v[192:195], v[80:83]
    s_waitcnt vmcnt(0) lgkmcnt(0)
    v_mfma_f32_16x16x32_bf16 v[72:75], v[164:167], v[192:195], v[72:75]
    s_cbranch_scc1 L_g1_loop
    v_mfma_f32_16x16x32_bf16 v[4:7], v[124:127], v[108:111], v[4:7]
    ds_read_b128 v[164:167], v197 offset:0
    v_mfma_f32_16x16x32_bf16 v[12:15], v[124:127], v[112:115], v[12:15]
    ds_read_b64_tr_b16 v[180:181], v200 offset:4096
    v_mfma_f32_16x16x32_bf16 v[20:23], v[124:127], v[116:119], v[20:23]
    ds_read_b64_tr_b16 v[182:183], v200 offset:4608
    v_mfma_f32_16x16x32_bf16 v[28:31], v[124:127], v[120:123], v[28:31]
    ds_read_b128 v[168:171], v197 offset:2048
    v_mfma_f32_16x16x32_bf16 v[32:35], v[128:131], v[120:123], v[32:35]
    ds_read_b64_tr_b16 v[184:185], v201 offset:4096
    v_mfma_f32_16x16x32_bf16 v[24:27], v[128:131], v[116:119], v[24:27]
    ds_read_b64_tr_b16 v[186:187], v201 offset:4608
    v_mfma_f32_16x16x32_bf16 v[16:19], v[128:131], v[112:115], v[16:19]
    ds_read_b128 v[172:175], v197 offset:4096
    v_mfma_f32_16x16x32_bf16 v[8:11], v[128:131], v[108:111], v[8:11]
    ds_read_b64_tr_b16 v[152:153], v200 offset:12288
    v_mfma_f32_16x16x32_bf16 v[40:43], v[132:135], v[108:111], v[40:43]
    ds_read_b64_tr_b16 v[154:155], v200 offset:12800
    v_mfma_f32_16x16x32_bf16 v[48:51], v[132:135], v[112:115], v[48:51]
    ds_read_b128 v[176:179], v197 offset:6144
    v_mfma_f32_16x16x32_bf16 v[56:59], v[132:135], v[116:119], v[56:59]
    ds_read_b64_tr_b16 v[188:189], v201 offset:12288
    v_mfma_f32_16x16x32_bf16 v[64:67], v[132:135], v[120:123], v[64:67]
    ds_read_b64_tr_b16 v[190:191], v201 offset:12800
    v_mfma_f32_16x16x32_bf16 v[60:63], v[148:151], v[120:123], v[60:63]
    ds_read2_b32 v[140:141], v198 offset1:2
    v_mfma_f32_16x16x32_bf16 v[52:55], v[148:151], v[116:119], v[52:55]
    ds_read2_b32 v[142:143], v199 offset1:2
    v_mfma_f32_16x16x32_bf16 v[44:47], v[148:151], v[112:115], v[44:47]
    ds_read_b64_tr_b16 v[160:161], v200 offset:20480
    v_mfma_f32_16x16x32_bf16 v[36:39], v[148:151], v[108:111], v[36:39]
    ds_read_b64_tr_b16 v[162:163], v200 offset:20992
    v_mfma_f32_16x16x32_bf16 v[68:71], v[108:111], v[156:159], v[68:71]
    ds_read_b64_tr_b16 v[192:193], v201 offset:20480
    v_mfma_f32_16x16x32_bf16 v[76:79], v[112:115], v[156:159], v[76:79]
    ds_read_b64_tr_b16 v[194:195], v201 offset:20992
    v_mfma_f32_16x16x32_bf16 v[84:87], v[116:119], v[156:159], v[84:87]
    v_mfma_f32_16x16x32_bf16 v[92:95], v[120:123], v[156:159], v[92:95]
    v_mfma_f32_16x16x32_bf16 v[96:99], v[120:123], v[136:139], v[96:99]
    v_mfma_f32_16x16x32_bf16 v[88:91], v[116:119], v[136:139], v[88:91]
    v_mfma_f32_16x16x32_bf16 v[80:83], v[112:115], v[136:139], v[80:83]
    v_mfma_f32_16x16x32_bf16 v[72:75], v[108:111], v[136:139], v[72:75]
    s_waitcnt lgkmcnt(0)
    s_setprio 2
    v_mov_b32 v2, 1
    v_smfmac_f32_16x16x64_bf16 v[100:103], v[140:143], v[148:155], v202
    v_smfmac_f32_16x16x64_bf16 v[104:107], v[140:143], v[156:163], v202
    v_mfma_f32_16x16x32_bf16 v[60:63], v[152:155], v[176:179], v[60:63]
    v_mfma_f32_16x16x32_bf16 v[64:67], v[188:191], v[176:179], v[64:67]
    v_mfma_f32_16x16x32_bf16 v[92:95], v[176:179], v[160:163], v[92:95]
    v_mfma_f32_16x16x32_bf16 v[96:99], v[176:179], v[192:195], v[96:99]
    v_mfma_f32_16x16x32_bf16 v[28:31], v[180:183], v[176:179], v[28:31]
    v_mfma_f32_16x16x32_bf16 v[32:35], v[184:187], v[176:179], v[32:35]
    v_mfma_f32_16x16x32_bf16 v[52:55], v[152:155], v[172:175], v[52:55]
    v_mfma_f32_16x16x32_bf16 v[56:59], v[188:191], v[172:175], v[56:59]
    s_nop 3
    v_permlane32_swap_b32 v100, v104
    v_permlane32_swap_b32 v101, v105
    v_mfma_f32_16x16x32_bf16 v[20:23], v[180:183], v[172:175], v[20:23]
    v_permlane32_swap_b32 v102, v106
    v_permlane32_swap_b32 v103, v107
    v_mfma_f32_16x16x32_bf16 v[24:27], v[184:187], v[172:175], v[24:27]
    v_add_f32 v100, v100, v104
    v_add_f32 v101, v101, v105
    v_mfma_f32_16x16x32_bf16 v[44:47], v[152:155], v[168:171], v[44:47]
    v_add_f32 v102, v102, v106
    v_add_f32 v103, v103, v107
    v_mfma_f32_16x16x32_bf16 v[48:51], v[188:191], v[168:171], v[48:51]
    v_cvt_pk_bf16_f32 v144, v100, v101
    v_cvt_pk_bf16_f32 v145, v102, v103
    v_mfma_f32_16x16x32_bf16 v[12:15], v[180:183], v[168:171], v[12:15]
    ds_write_b64 v219, v[144:145] offset:1024
    ds_write_b16 v203, v144 offset:0
    v_mfma_f32_16x16x32_bf16 v[16:19], v[184:187], v[168:171], v[16:19]
    ds_write_b16_d16_hi v203, v144 offset:8
    ds_write_b16 v203, v145 offset:16
    v_mfma_f32_16x16x32_bf16 v[36:39], v[152:155], v[164:167], v[36:39]
    ds_write_b16_d16_hi v203, v145 offset:24
    v_cvt_pk_bf16_f32 v140, v60, v61
    v_mfma_f32_16x16x32_bf16 v[40:43], v[188:191], v[164:167], v[40:43]
    v_cvt_pk_bf16_f32 v141, v62, v63
    v_cvt_pk_bf16_f32 v142, v64, v65
    v_mfma_f32_16x16x32_bf16 v[4:7], v[180:183], v[164:167], v[4:7]
    v_cvt_pk_bf16_f32 v143, v66, v67
    v_cvt_pk_bf16_f32 v238, v92, v93
    v_mfma_f32_16x16x32_bf16 v[8:11], v[184:187], v[164:167], v[8:11]
    v_cvt_pk_bf16_f32 v239, v94, v95
    v_cvt_pk_bf16_f32 v248, v96, v97
    v_mfma_f32_16x16x32_bf16 v[84:87], v[172:175], v[160:163], v[84:87]
    v_cvt_pk_bf16_f32 v249, v98, v99
    s_cmp_eq_u32 s33, 0
    s_cbranch_scc0 L_at_nopub
    ds_write_b64 v220, v[140:141] offset:2048
    ds_write_b64 v220, v[238:239] offset:3072
    ds_write_b64 v220, v[142:143] offset:2560
    ds_write_b64 v220, v[248:249] offset:3584
L_at_nopub:
    s_mov_b64 exec, 1
    ds_add_u32 v228, v2 offset:20
    s_mov_b64 exec, -1
    v_mfma_f32_16x16x32_bf16 v[88:91], v[172:175], v[192:195], v[88:91]
    v_cvt_pk_bf16_f32 v120, v28, v29
    v_cvt_pk_bf16_f32 v121, v30, v31
    v_mfma_f32_16x16x32_bf16 v[76:79], v[168:171], v[160:163], v[76:79]
    v_cvt_pk_bf16_f32 v122, v32, v33
    v_cvt_pk_bf16_f32 v123, v34, v35
    v_mfma_f32_16x16x32_bf16 v[80:83], v[168:171], v[192:195], v[80:83]
    v_cvt_pk_bf16_f32 v136, v52, v53
    v_cvt_pk_bf16_f32 v137, v54, v55
    v_mfma_f32_16x16x32_bf16 v[68:71], v[164:167], v[160:163], v[68:71]
    v_cvt_pk_bf16_f32 v138, v56, v57
    v_cvt_pk_bf16_f32 v139, v58, v59
    v_mfma_f32_16x16x32_bf16 v[72:75], v[164:167], v[192:195], v[72:75]
    v_cvt_pk_bf16_f32 v116, v20, v21
    v_cvt_pk_bf16_f32 v117, v22, v23
    v_mfma_f32_16x16x32_bf16 v[28:31], v[140:143], v[120:123], v[204:207]
    v_cvt_pk_bf16_f32 v118, v24, v25
    v_cvt_pk_bf16_f32 v119, v26, v27
    v_mfma_f32_16x16x32_bf16 v[32:35], v[136:139], v[120:123], v[208:211]
    v_cvt_pk_bf16_f32 v132, v44, v45
    v_cvt_pk_bf16_f32 v133, v46, v47
    v_mfma_f32_16x16x32_bf16 v[20:23], v[136:139], v[116:119], v[204:207]
    v_cvt_pk_bf16_f32 v134, v48, v49
    v_cvt_pk_bf16_f32 v135, v50, v51
    s_nop 1
    v_mfma_f32_16x16x32_bf16 v[24:27], v[132:135], v[116:119], v[208:211]
    v_cvt_pk_bf16_f32 v112, v12, v13
    v_cvt_pk_bf16_f32 v113, v14, v15
    v_cvt_pk_bf16_f32 v114, v16, v17
    v_cvt_pk_bf16_f32 v115, v18, v19
    s_nop 1
    v_mfma_f32_16x16x32_bf16 v[12:15], v[132:135], v[112:115], v[204:207]
    v_cvt_pk_bf16_f32 v128, v36, v37
    v_cvt_pk_bf16_f32 v129, v38, v39
    v_cvt_pk_bf16_f32 v130, v40, v41
    v_cvt_pk_bf16_f32 v131, v42, v43
    s_nop 1
    v_mfma_f32_16x16x32_bf16 v[16:19], v[128:131], v[112:115], v[208:211]
    v_cvt_pk_bf16_f32 v108, v4, v5
    v_cvt_pk_bf16_f32 v109, v6, v7
    v_cvt_pk_bf16_f32 v110, v8, v9
    v_cvt_pk_bf16_f32 v111, v10, v11
    s_nop 1
    v_mfma_f32_16x16x32_bf16 v[4:7], v[128:131], v[108:111], v[204:207]
    v_cvt_pk_bf16_f32 v236, v84, v85
    v_cvt_pk_bf16_f32 v237, v86, v87
    v_cvt_pk_bf16_f32 v246, v88, v89
    v_cvt_pk_bf16_f32 v247, v90, v91
    v_cvt_pk_bf16_f32 v234, v76, v77
    v_cvt_pk_bf16_f32 v235, v78, v79
    ds_read_b32 v1, v228 offset:20
    v_cvt_pk_bf16_f32 v244, v80, v81
    v_cvt_pk_bf16_f32 v245, v82, v83
    v_cvt_pk_bf16_f32 v232, v68, v69
    v_cvt_pk_bf16_f32 v233, v70, v71
    v_cvt_pk_bf16_f32 v242, v72, v73
    v_cvt_pk_bf16_f32 v243, v74, v75
    s_waitcnt lgkmcnt(0)
    v_readfirstlane_b32 s37, v1
    s_nop 0
    s_cmp_ge_u32 s37, 4
    s_cbranch_scc1 L_sl_done_47
    s_mov_b32 s38, 1048576
L_sl_loop_48:
    ds_read_b32 v1, v228 offset:20
    s_waitcnt lgkmcnt(0)
    v_readfirstlane_b32 s37, v1
    s_nop 0
    s_cmp_ge_u32 s37, 4
    s_cbranch_scc1 L_sl_done_47
    s_sleep 1
    s_sub_u32 s38, s38, 1
    s_cbranch_scc0 L_sl_loop_48
L_sl_done_47:
    ds_read_b64 v[124:125], v221
    ds_read_b64 v[126:127], v222
    ds_read_b64 v[230:231], v221 offset:1024
    ds_read_b64 v[240:241], v222 offset:1024
    v_max_f32 v28, v28, v32
    v_max_f32 v29, v29, v33
    v_max_f32 v30, v30, v34
    v_max_f32 v31, v31, v35
    v_max3_f32 v39, v28, v29, v30
    v_max_f32 v39, v39, v31
    v_max_f32 v20, v20, v24
    v_max_f32 v21, v21, v25
    v_max_f32 v22, v22, v26
    v_max_f32 v23, v23, v27
    v_max3_f32 v38, v20, v21, v22
    v_max_f32 v38, v38, v23
    s_waitcnt lgkmcnt(2)
    v_mfma_f32_16x16x32_bf16 v[8:11], v[124:127], v[108:111], v[212:215]
    s_setprio 2
    s_mov_b32 s37, 0x3e8293ee
    v_max_f32 v12, v12, v16
    v_max_f32 v13, v13, v17
    v_max_f32 v14, v14, v18
    v_max_f32 v15, v15, v19
    v_max3_f32 v37, v12, v13, v14
    v_max_f32 v37, v37, v15
    v_max_f32 v4, v4, v8
    v_max_f32 v5, v5, v9
    v_max_f32 v6, v6, v10
    v_max_f32 v7, v7, v11
    v_max3_f32 v36, v4, v5, v6
    v_max_f32 v36, v36, v7
    v_permlane32_swap_b32 v38, v39
    s_nop 0
    v_permlane32_swap_b32 v36, v37
    v_max_f32 v38, v38, v39
    v_max_f32 v36, v36, v37
    s_nop 1
    v_permlane16_swap_b32 v36, v38
    v_max_f32 v36, v36, v38
    v_mul_f32 v38, s37, v36
    v_mul_f32 v36, s37, v36
    s_nop 1
    v_permlane16_swap_b32 v36, v38
    v_mov_b32 v37, v36
    s_add_u32 m0, s60, 0
    v_mov_b32 v39, v38
    v_permlane32_swap_b32 v36, v37
    s_xor_b32 s63, s62, 0
    v_permlane32_swap_b32 v38, v39
    v_fma_f32 v4, v4, s37, -v36
    buffer_load_dwordx4 v227, s[44:47], s63 offen offset:0 lds
    v_fma_f32 v5, v5, s37, -v36
    v_fma_f32 v6, v6, s37, -v36
    buffer_load_dwordx4 v223, s[44:47], s63 offen offset:1024 lds
    v_fma_f32 v7, v7, s37, -v36
    v_fma_f32 v12, v12, s37, -v37
    s_add_u32 m0, s60, 8192
    v_fma_f32 v13, v13, s37, -v37
    v_fma_f32 v14, v14, s37, -v37
    s_xor_b32 s63, s62, 131072
    v_fma_f32 v15, v15, s37, -v37
    v_fma_f32 v20, v20, s37, -v38
    buffer_load_dwordx4 v227, s[44:47], s63 offen offset:0 lds
    v_fma_f32 v21, v21, s37, -v38
    v_fma_f32 v22, v22, s37, -v38
    buffer_load_dwordx4 v223, s[44:47], s63 offen offset:1024 lds
    v_fma_f32 v23, v23, s37, -v38
    v_fma_f32 v28, v28, s37, -v39
    s_add_u32 m0, s60, 16384
    v_fma_f32 v29, v29, s37, -v39
    v_fma_f32 v30, v30, s37, -v39
    s_xor_b32 s63, s62, 262144
    v_fma_f32 v31, v31, s37, -v39
    v_exp_f32 v28, v28
    buffer_load_dwordx4 v227, s[44:47], s63 offen offset:0 lds
    v_exp_f32 v29, v29
    v_exp_f32 v30, v30
    buffer_load_dwordx4 v223, s[44:47], s63 offen offset:1024 lds
    v_exp_f32 v31, v31
    v_exp_f32 v20, v20
    s_add_u32 m0, s60, 24576
    v_exp_f32 v21, v21
    v_exp_f32 v22, v22
    s_xor_b32 s63, s62, 393216
    v_exp_f32 v23, v23
    v_exp_f32 v12, v12
    buffer_load_dwordx4 v227, s[44:47], s63 offen offset:0 lds
    v_exp_f32 v13, v13
    v_exp_f32 v14, v14
    buffer_load_dwordx4 v223, s[44:47], s63 offen offset:1024 lds
    v_exp_f32 v15, v15
    v_exp_f32 v4, v4
    s_add_u32 m0, s60, 32768
    v_exp_f32 v5, v5
    v_exp_f32 v6, v6
    s_xor_b32 s63, s62, 524288
    v_exp_f32 v7, v7
    v_add_f32 v39, v28, v29
    buffer_load_dwordx4 v227, s[44:47], s63 offen offset:0 lds
    v_add_f32 v32, v30, v31
    v_add_f32 v39, v39, v32
    buffer_load_dwordx4 v223, s[44:47], s63 offen offset:1024 lds
    v_add_f32 v38, v20, v21
    v_add_f32 v24, v22, v23
    s_add_u32 m0, s60, 83968
    v_add_f32 v38, v38, v24
    v_add_f32 v37, v12, v13
    s_xor_b32 s63, s62, 655360
    v_add_f32 v16, v14, v15
    v_add_f32 v37, v37, v16
    buffer_load_dwordx4 v227, s[44:47], s63 offen offset:0 lds
    v_add_f32 v36, v4, v5
    v_add_f32 v8, v6, v7
    buffer_load_dwordx4 v223, s[44:47], s63 offen offset:1024 lds
    v_add_f32 v36, v36, v8
    v_permlane32_swap_b32 v38, v39
    s_add_u32 m0, s60, 92160
    v_permlane32_swap_b32 v36, v37
    v_add_f32 v38, v38, v39
    s_xor_b32 s63, s62, 786432
    v_add_f32 v36, v36, v37
    s_nop 1
    v_permlane16_swap_b32 v36, v38
    buffer_load_dwordx4 v227, s[44:47], s63 offen offset:0 lds
    v_add_f32 v36, v36, v38
    v_rcp_f32 v38, v36
    buffer_load_dwordx4 v223, s[44:47], s63 offen offset:1024 lds
    v_rcp_f32 v36, v36
    s_nop 1
    v_permlane16_swap_b32 v36, v38
    s_add_u32 m0, s60, 100352
    v_mov_b32 v37, v36
    v_mov_b32 v39, v38
    s_xor_b32 s63, s62, 917504
    v_permlane32_swap_b32 v36, v37
    v_permlane32_swap_b32 v38, v39
    buffer_load_dwordx4 v227, s[44:47], s63 offen offset:0 lds
    s_waitcnt lgkmcnt(0)
    v_mul_f32 v4, v4, v36
    buffer_load_dwordx4 v223, s[44:47], s63 offen offset:1024 lds
    v_mul_f32 v5, v5, v36
    v_mul_f32 v6, v6, v36
    s_add_u32 m0, s60, 108544
    v_mul_f32 v7, v7, v36
    v_cvt_pk_bf16_f32 v10, v4, v5
    s_xor_b32 s63, s62, 1048576
    v_cvt_pk_bf16_f32 v11, v6, v7
    v_and_b32 v8, v216, v10
    buffer_load_dwordx4 v227, s[44:47], s63 offen offset:0 lds
    v_and_b32 v9, v217, v11
    v_xor_b32 v10, v8, v10
    buffer_load_dwordx4 v223, s[44:47], s63 offen offset:1024 lds
    v_xor_b32 v11, v9, v11
    s_setprio 2
    s_add_u32 m0, s60, 116736
    v_mfma_f32_16x16x32_bf16 v[68:71], v[230:233], v[8:11], 0
    v_mfma_f32_16x16x32_bf16 v[72:75], v[240:243], v[8:11], 0
    s_xor_b32 s63, s62, 1179648
    s_setprio 2
    v_mul_f32 v12, v12, v37
    buffer_load_dwordx4 v227, s[44:47], s63 offen offset:0 lds
    v_mul_f32 v13, v13, v37
    v_mul_f32 v14, v14, v37
    buffer_load_dwordx4 v223, s[44:47], s63 offen offset:1024 lds
    v_mul_f32 v15, v15, v37
    v_cvt_pk_bf16_f32 v18, v12, v13
    v_cvt_pk_bf16_f32 v19, v14, v15
    v_and_b32 v16, v216, v18
    v_and_b32 v17, v217, v19
    v_xor_b32 v18, v16, v18
    v_xor_b32 v19, v17, v19
    v_cvt_pk_bf16_f32 v108, v68, v69
    v_cvt_pk_bf16_f32 v109, v70, v71
    v_cvt_pk_bf16_f32 v110, v72, v73
    v_cvt_pk_bf16_f32 v111, v74, v75
    s_mov_b32 s37, 0
    buffer_store_dwordx4 v[108:111], v218, s[40:43], s37 offen sc1
    s_setprio 2
    v_mfma_f32_16x16x32_bf16 v[76:79], v[232:235], v[16:19], 0
    v_mfma_f32_16x16x32_bf16 v[80:83], v[242:245], v[16:19], 0
    s_setprio 2
    v_mul_f32 v20, v20, v38
    v_mul_f32 v21, v21, v38
    v_mul_f32 v22, v22, v38
    v_mul_f32 v23, v23, v38
    v_cvt_pk_bf16_f32 v26, v20, v21
    v_cvt_pk_bf16_f32 v27, v22, v23
    v_and_b32 v24, v216, v26
    v_and_b32 v25, v217, v27
    v_xor_b32 v26, v24, v26
    v_xor_b32 v27, v25, v27
    v_cvt_pk_bf16_f32 v112, v76, v77
    v_cvt_pk_bf16_f32 v113, v78, v79
    v_cvt_pk_bf16_f32 v114, v80, v81
    v_cvt_pk_bf16_f32 v115, v82, v83
    s_mov_b32 s37, 32768
    buffer_store_dwordx4 v[112:115], v218, s[40:43], s37 offen sc1
    s_setprio 2
    v_mfma_f32_16x16x32_bf16 v[84:87], v[234:237], v[24:27], 0
    v_mfma_f32_16x16x32_bf16 v[88:91], v[244:247], v[24:27], 0
    s_setprio 2
    v_mul_f32 v28, v28, v39
    v_mul_f32 v29, v29, v39
    v_mul_f32 v30, v30, v39
    v_mul_f32 v31, v31, v39
    v_cvt_pk_bf16_f32 v34, v28, v29
    v_cvt_pk_bf16_f32 v35, v30, v31
    v_and_b32 v32, v216, v34
    v_and_b32 v33, v217, v35
    v_xor_b32 v34, v32, v34
    v_xor_b32 v35, v33, v35
    v_cvt_pk_bf16_f32 v116, v84, v85
    v_cvt_pk_bf16_f32 v117, v86, v87
    v_cvt_pk_bf16_f32 v118, v88, v89
    v_cvt_pk_bf16_f32 v119, v90, v91
    s_mov_b32 s37, 65536
    buffer_store_dwordx4 v[116:119], v218, s[40:43], s37 offen sc1
    s_setprio 2
    v_mfma_f32_16x16x32_bf16 v[92:95], v[236:239], v[32:35], 0
    v_mfma_f32_16x16x32_bf16 v[96:99], v[246:249], v[32:35], 0
    s_setprio 2
    s_nop 5
    v_cvt_pk_bf16_f32 v120, v92, v93
    v_cvt_pk_bf16_f32 v121, v94, v95
    v_cvt_pk_bf16_f32 v122, v96, v97
    v_cvt_pk_bf16_f32 v123, v98, v99
    s_mov_b32 s37, 98304
    buffer_store_dwordx4 v[120:123], v218, s[40:43], s37 offen sc1
    s_setprio 0
    s_lshl_b32 s37, s32, 11
    v_add_u32 v229, s37, v229
    v_xor_b32 v84, 0, v229
    v_xor_b32 v85, 32, v229
    v_xor_b32 v86, 64, v229
    v_xor_b32 v87, 96, v229
    v_add_u32 v88, 83968, v84
    v_add_u32 v89, 83968, v85
    v_add_u32 v90, 83968, v86
    v_add_u32 v91, 83968, v87
    v_add_u32 v92, 125952, v84
    v_add_u32 v93, 125952, v85
    v_add_u32 v94, 125952, v86
    v_add_u32 v95, 125952, v87
    v_xor_b32 v232, 2048, v229
    v_xor_b32 v233, 2080, v229
    v_xor_b32 v234, 2112, v229
    v_xor_b32 v235, 2144, v229
    v_add_u32 v236, 83968, v232
    v_add_u32 v237, 83968, v233
    v_add_u32 v238, 83968, v234
    v_add_u32 v239, 83968, v235
    v_add_u32 v240, 125952, v232
    v_add_u32 v241, 125952, v233
    v_add_u32 v242, 125952, v234
    v_add_u32 v243, 125952, v235
    s_mul_i32 s37, s32, 80896
    s_lshl_b32 s38, s33, 11
    s_add_u32 s37, s37, s38
    s_add_u32 s37, s37, 78848
    v_lshrrev_b32 v1, 5, v0
    v_xor_b32 v1, v1, v0
    v_and_b32 v1, 7, v1
    v_lshl_add_u32 v1, v1, 4, s37
    v_bfe_u32 v2, v0, 4, 1
    v_lshl_add_u32 v1, v2, 3, v1
    v_and_b32 v2, 15, v0
    v_lshl_add_u32 v244, v2, 7, v1
    v_xor_b32 v245, 32, v244
    v_xor_b32 v246, 64, v244
    v_xor_b32 v247, 96, v244
    v_lshrrev_b32 v1, 3, v0
    v_xor_b32 v1, v1, v0
    v_and_b32 v1, 7, v1
    v_and_b32 v2, 56, v0
    v_add_u32 v1, v1, v2
    v_lshl_add_u32 v248, v1, 4, s37
    v_lshl_add_u32 v231, v0, 4, s60
    v_add_u32 v230, 125952, v231
    s_add_u32 s64, s61, 0
    s_and_b32 s64, s64, 7
    s_lshl_b32 s64, s64, 12
    s_add_u32 s65, s61, 1
    s_and_b32 s65, s65, 7
    s_lshl_b32 s65, s65, 12
    s_add_u32 s66, s61, 2
    s_and_b32 s66, s66, 7
    s_lshl_b32 s66, s66, 12
    s_add_u32 s67, s61, 3
    s_and_b32 s67, s67, 7
    s_lshl_b32 s67, s67, 12
    s_add_u32 s68, s61, 4
    s_and_b32 s68, s68, 7
    s_lshl_b32 s68, s68, 12
    s_add_u32 s69, s61, 5
    s_and_b32 s69, s69, 7
    s_lshl_b32 s69, s69, 12
    s_add_u32 s70, s61, 6
    s_and_b32 s70, s70, 7
    s_lshl_b32 s70, s70, 12
    s_add_u32 s71, s61, 7
    s_and_b32 s71, s71, 7
    s_lshl_b32 s71, s71, 12
    s_waitcnt vmcnt(0)
    s_setprio 2
    v_mov_b32 v2, 1
    s_mov_b64 exec, 1
    ds_add_rtn_u32 v1, v228, v2 offset:0
    s_waitcnt lgkmcnt(0)
    v_readfirstlane_b32 s39, v1
    s_nop 0
    s_cmp_eq_u32 s39, 3
    s_cbranch_scc0 L_jo_49a
    s_mov_b64 exec, 0xffff
    v_lshlrev_b32 v1, 8, v0
    buffer_atomic_add v2, v1, s[52:55], s56 offen sc1
L_jo_49a:
    s_mov_b64 exec, -1
    s_setprio 0
    s_xor_b32 s63, s62, 1310720
    buffer_load_dwordx4 v[172:175], v227, s[44:47], s63 offen offset:0
    buffer_load_dwordx4 v[176:179], v223, s[44:47], s63 offen offset:1024
    s_xor_b32 s63, s62, 1441792
    buffer_load_dwordx4 v[180:183], v227, s[44:47], s63 offen offset:0
    buffer_load_dwordx4 v[184:187], v223, s[44:47], s63 offen offset:1024
    s_cmp_eq_u32 s39, 3
    s_cbranch_scc0 L_ps_51
    s_load_dword s37, s[52:53], s57 glc
L_ps_51:
    s_xor_b32 s63, s62, 1572864
    buffer_load_dwordx4 v[188:191], v227, s[44:47], s63 offen offset:0
    buffer_load_dwordx4 v[192:195], v223, s[44:47], s63 offen offset:1024
    s_xor_b32 s63, s62, 1703936
    buffer_load_dwordx4 v[196:199], v227, s[44:47], s63 offen offset:0
    buffer_load_dwordx4 v[200:203], v223, s[44:47], s63 offen offset:1024
    s_xor_b32 s63, s62, 1835008
    buffer_load_dwordx4 v[204:207], v227, s[44:47], s63 offen offset:0
    buffer_load_dwordx4 v[208:211], v223, s[44:47], s63 offen offset:1024
    s_xor_b32 s63, s62, 1966080
    buffer_load_dwordx4 v[212:215], v227, s[44:47], s63 offen offset:0
    buffer_load_dwordx4 v[216:219], v223, s[44:47], s63 offen offset:1024
    s_setprio 0
    s_cmp_eq_u32 s39, 3
    s_cbranch_scc0 L_jo_49
    s_mov_b32 s38, 131072
    s_branch L_sg_chk_54
L_sg_loop_53:
    s_load_dword s37, s[52:53], s57 glc
L_sg_chk_54:
    s_waitcnt lgkmcnt(0)
    s_cmp_ge_u32 s37, 16
    s_cbranch_scc1 L_sg_done_52
    s_sub_u32 s38, s38, 1
    s_cbranch_scc0 L_sg_loop_53
L_sg_done_52:
    v_mov_b32 v1, 16
    s_mov_b64 exec, 1
    ds_add_u32 v228, v1 offset:4
    s_mov_b64 exec, -1
L_jo_49:
    s_waitcnt vmcnt(12)
    s_mov_b64 exec, 1
    ds_add_u32 v228, v2 offset:4
    s_mov_b64 exec, -1
    s_mov_b32 s38, 1048576
L_sl_loop_56:
    ds_read_b32 v1, v228 offset:4
    s_waitcnt lgkmcnt(0)
    v_readfirstlane_b32 s37, v1
    s_nop 0
    s_cmp_ge_u32 s37, 20
    s_cbranch_scc1 L_sl_done_55
    s_sleep 1
    s_sub_u32 s38, s38, 1
    s_cbranch_scc0 L_sl_loop_56
L_sl_done_55:
L_jd_50:
    buffer_load_dwordx4 v[96:99], v224, s[40:43], s64 offen offset:0 sc1
    buffer_load_dwordx4 v[100:103], v225, s[40:43], s64 offen offset:0 sc1
    ds_read_b64_tr_b16 v[36:37], v84 offset:0
    ds_read_b64_tr_b16 v[38:39], v232 offset:0
    buffer_load_dwordx4 v[104:107], v224, s[40:43], s64 offen offset:1024 sc1
    buffer_load_dwordx4 v[108:111], v225, s[40:43], s64 offen offset:1024 sc1
    ds_read_b64_tr_b16 v[40:41], v85 offset:0
    ds_read_b64_tr_b16 v[42:43], v233 offset:0
    buffer_load_dwordx4 v[112:115], v224, s[40:43], s64 offen offset:2048 sc1
    buffer_load_dwordx4 v[116:119], v225, s[40:43], s64 offen offset:2048 sc1
    ds_read_b64_tr_b16 v[44:45], v86 offset:0
    ds_read_b64_tr_b16 v[46:47], v234 offset:0
    buffer_load_dwordx4 v[120:123], v224, s[40:43], s64 offen offset:3072 sc1
    buffer_load_dwordx4 v[124:127], v225, s[40:43], s64 offen offset:3072 sc1
    ds_read_b64_tr_b16 v[48:49], v87 offset:0
    ds_read_b64_tr_b16 v[50:51], v235 offset:0
    buffer_load_dwordx4 v[128:131], v224, s[40:43], s65 offen offset:0 sc1
    buffer_load_dwordx4 v[132:135], v225, s[40:43], s65 offen offset:0 sc1
    ds_read_b64_tr_b16 v[52:53], v84 offset:4096
    ds_read_b64_tr_b16 v[54:55], v232 offset:4096
    buffer_load_dwordx4 v[136:139], v224, s[40:43], s65 offen offset:1024 sc1
    buffer_load_dwordx4 v[140:143], v225, s[40:43], s65 offen offset:1024 sc1
    ds_read_b64_tr_b16 v[56:57], v85 offset:4096
    ds_read_b64_tr_b16 v[58:59], v233 offset:4096
    ds_read_b64_tr_b16 v[60:61], v86 offset:4096
    ds_read_b64_tr_b16 v[62:63], v234 offset:4096
    s_waitcnt lgkmcnt(12)
    ds_read_b64_tr_b16 v[64:65], v87 offset:4096
    ds_read_b64_tr_b16 v[66:67], v235 offset:4096
    ds_read_b32 v1, v228 offset:36
    s_waitcnt vmcnt(10) lgkmcnt(9)
    v_mfma_f32_16x16x32_bf16 v[4:7], v[36:39], v[96:99], 0
    ds_read_b64_tr_b16 v[68:69], v84 offset:8192
    v_mfma_f32_16x16x32_bf16 v[20:23], v[36:39], v[100:103], 0
    ds_read_b64_tr_b16 v[70:71], v232 offset:8192
    v_mfma_f32_16x16x32_bf16 v[8:11], v[40:43], v[96:99], 0
    ds_read_b64_tr_b16 v[36:37], v85 offset:8192
    v_mfma_f32_16x16x32_bf16 v[24:27], v[40:43], v[100:103], 0
    ds_read_b64_tr_b16 v[38:39], v233 offset:8192
    buffer_load_dwordx4 v[144:147], v224, s[40:43], s65 offen offset:2048 sc1
    v_mfma_f32_16x16x32_bf16 v[12:15], v[44:47], v[96:99], 0
    ds_read_b64_tr_b16 v[40:41], v86 offset:8192
    v_mfma_f32_16x16x32_bf16 v[28:31], v[44:47], v[100:103], 0
    ds_read_b64_tr_b16 v[42:43], v234 offset:8192
    v_mfma_f32_16x16x32_bf16 v[16:19], v[48:51], v[96:99], 0
    ds_read_b64_tr_b16 v[44:45], v87 offset:8192
    v_mfma_f32_16x16x32_bf16 v[32:35], v[48:51], v[100:103], 0
    ds_read_b64_tr_b16 v[46:47], v235 offset:8192
    buffer_load_dwordx4 v[148:151], v225, s[40:43], s65 offen offset:2048 sc1
    s_waitcnt lgkmcnt(8)
    v_readfirstlane_b32 s37, v1
    s_nop 0
    s_cmp_ge_u32 s37, 4
    s_cbranch_scc1 L_sl_done_57
    s_mov_b32 s38, 1048576
L_sl_loop_58:
    ds_read_b32 v1, v228 offset:36
    s_waitcnt lgkmcnt(0)
    v_readfirstlane_b32 s37, v1
    s_nop 0
    s_cmp_ge_u32 s37, 4
    s_cbranch_scc1 L_sl_done_57
    s_sleep 1
    s_sub_u32 s38, s38, 1
    s_cbranch_scc0 L_sl_loop_58
L_sl_done_57:
    ds_write_b128 v230, v[172:175] offset:0
    s_waitcnt vmcnt(10)
    v_mfma_f32_16x16x32_bf16 v[4:7], v[52:55], v[104:107], v[4:7]
    ds_read_b64_tr_b16 v[48:49], v84 offset:12288
    v_mfma_f32_16x16x32_bf16 v[20:23], v[52:55], v[108:111], v[20:23]
    ds_read_b64_tr_b16 v[50:51], v232 offset:12288
    v_mfma_f32_16x16x32_bf16 v[8:11], v[56:59], v[104:107], v[8:11]
    ds_read_b64_tr_b16 v[52:53], v85 offset:12288
    v_mfma_f32_16x16x32_bf16 v[24:27], v[56:59], v[108:111], v[24:27]
    ds_read_b64_tr_b16 v[54:55], v233 offset:12288
    buffer_load_dwordx4 v[96:99], v224, s[40:43], s65 offen offset:3072 sc1
    ds_write_b128 v230, v[176:179] offset:1024
    v_mfma_f32_16x16x32_bf16 v[12:15], v[60:63], v[104:107], v[12:15]
    ds_read_b64_tr_b16 v[56:57], v86 offset:12288
    v_mfma_f32_16x16x32_bf16 v[28:31], v[60:63], v[108:111], v[28:31]
    ds_read_b64_tr_b16 v[58:59], v234 offset:12288
    v_mfma_f32_16x16x32_bf16 v[16:19], v[64:67], v[104:107], v[16:19]
    ds_read_b64_tr_b16 v[60:61], v87 offset:12288
    v_mfma_f32_16x16x32_bf16 v[32:35], v[64:67], v[108:111], v[32:35]
    ds_read_b64_tr_b16 v[62:63], v235 offset:12288
    buffer_load_dwordx4 v[100:103], v225, s[40:43], s65 offen offset:3072 sc1
    ds_write_b128 v230, v[180:183] offset:8448
    s_waitcnt vmcnt(10) lgkmcnt(11)
    v_mfma_f32_16x16x32_bf16 v[4:7], v[68:71], v[112:115], v[4:7]
    ds_read_b64_tr_b16 v[64:65], v84 offset:16384
    v_mfma_f32_16x16x32_bf16 v[20:23], v[68:71], v[116:119], v[20:23]
    ds_read_b64_tr_b16 v[66:67], v232 offset:16384
    v_mfma_f32_16x16x32_bf16 v[8:11], v[36:39], v[112:115], v[8:11]
    ds_read_b64_tr_b16 v[68:69], v85 offset:16384
    v_mfma_f32_16x16x32_bf16 v[24:27], v[36:39], v[116:119], v[24:27]
    ds_read_b64_tr_b16 v[70:71], v233 offset:16384
    buffer_load_dwordx4 v[104:107], v224, s[40:43], s66 offen offset:0 sc1
    ds_write_b128 v230, v[184:187] offset:9472
    v_mfma_f32_16x16x32_bf16 v[12:15], v[40:43], v[112:115], v[12:15]
    ds_read_b64_tr_b16 v[36:37], v86 offset:16384
    v_mfma_f32_16x16x32_bf16 v[28:31], v[40:43], v[116:119], v[28:31]
    ds_read_b64_tr_b16 v[38:39], v234 offset:16384
    v_mfma_f32_16x16x32_bf16 v[16:19], v[44:47], v[112:115], v[16:19]
    ds_read_b64_tr_b16 v[40:41], v87 offset:16384
    v_mfma_f32_16x16x32_bf16 v[32:35], v[44:47], v[116:119], v[32:35]
    ds_read_b64_tr_b16 v[42:43], v235 offset:16384
    buffer_load_dwordx4 v[108:111], v225, s[40:43], s66 offen offset:0 sc1
    ds_write_b128 v230, v[188:191] offset:16896
    s_waitcnt vmcnt(10) lgkmcnt(11)
    v_mfma_f32_16x16x32_bf16 v[4:7], v[48:51], v[120:123], v[4:7]
    ds_read_b64_tr_b16 v[44:45], v84 offset:20480
    v_mfma_f32_16x16x32_bf16 v[20:23], v[48:51], v[124:127], v[20:23]
    ds_read_b64_tr_b16 v[46:47], v232 offset:20480
    v_mfma_f32_16x16x32_bf16 v[8:11], v[52:55], v[120:123], v[8:11]
    ds_read_b64_tr_b16 v[48:49], v85 offset:20480
    v_mfma_f32_16x16x32_bf16 v[24:27], v[52:55], v[124:127], v[24:27]
    ds_read_b64_tr_b16 v[50:51], v233 offset:20480
    buffer_load_dwordx4 v[112:115], v224, s[40:43], s66 offen offset:1024 sc1
    ds_write_b128 v230, v[192:195] offset:17920
    v_mfma_f32_16x16x32_bf16 v[12:15], v[56:59], v[120:123], v[12:15]
    ds_read_b64_tr_b16 v[52:53], v86 offset:20480
    v_mfma_f32_16x16x32_bf16 v[28:31], v[56:59], v[124:127], v[28:31]
    ds_read_b64_tr_b16 v[54:55], v234 offset:20480
    v_mfma_f32_16x16x32_bf16 v[16:19], v[60:63], v[120:123], v[16:19]
    ds_read_b64_tr_b16 v[56:57], v87 offset:20480
    v_mfma_f32_16x16x32_bf16 v[32:35], v[60:63], v[124:127], v[32:35]
    ds_read_b64_tr_b16 v[58:59], v235 offset:20480
    buffer_load_dwordx4 v[116:119], v225, s[40:43], s66 offen offset:1024 sc1
    ds_write_b128 v230, v[196:199] offset:25344
    s_waitcnt vmcnt(10) lgkmcnt(11)
    v_mfma_f32_16x16x32_bf16 v[4:7], v[64:67], v[128:131], v[4:7]
    ds_read_b64_tr_b16 v[60:61], v84 offset:24576
    v_mfma_f32_16x16x32_bf16 v[20:23], v[64:67], v[132:135], v[20:23]
    ds_read_b64_tr_b16 v[62:63], v232 offset:24576
    v_mfma_f32_16x16x32_bf16 v[8:11], v[68:71], v[128:131], v[8:11]
    ds_read_b64_tr_b16 v[64:65], v85 offset:24576
    v_mfma_f32_16x16x32_bf16 v[24:27], v[68:71], v[132:135], v[24:27]
    ds_read_b64_tr_b16 v[66:67], v233 offset:24576
    buffer_load_dwordx4 v[120:123], v224, s[40:43], s66 offen offset:2048 sc1
    ds_write_b128 v230, v[200:203] offset:26368
    v_mfma_f32_16x16x32_bf16 v[12:15], v[36:39], v[128:131], v[12:15]
    ds_read_b64_tr_b16 v[68:69], v86 offset:24576
    v_mfma_f32_16x16x32_bf16 v[28:31], v[36:39], v[132:135], v[28:31]
    ds_read_b64_tr_b16 v[70:71], v234 offset:24576
    v_mfma_f32_16x16x32_bf16 v[16:19], v[40:43], v[128:131], v[16:19]
    ds_read_b64_tr_b16 v[36:37], v87 offset:24576
    v_mfma_f32_16x16x32_bf16 v[32:35], v[40:43], v[132:135], v[32:35]
    ds_read_b64_tr_b16 v[38:39], v235 offset:24576
    buffer_load_dwordx4 v[124:127], v225, s[40:43], s66 offen offset:2048 sc1
    ds_write_b128 v231, v[204:207] offset:41984
    s_waitcnt vmcnt(10) lgkmcnt(11)
    v_mfma_f32_16x16x32_bf16 v[4:7], v[44:47], v[136:139], v[4:7]
    ds_read_b64_tr_b16 v[40:41], v84 offset:28672
    v_mfma_f32_16x16x32_bf16 v[20:23], v[44:47], v[140:143], v[20:23]
    ds_read_b64_tr_b16 v[42:43], v232 offset:28672
    v_mfma_f32_16x16x32_bf16 v[8:11], v[48:51], v[136:139], v[8:11]
    ds_read_b64_tr_b16 v[44:45], v85 offset:28672
    v_mfma_f32_16x16x32_bf16 v[24:27], v[48:51], v[140:143], v[24:27]
    ds_read_b64_tr_b16 v[46:47], v233 offset:28672
    buffer_load_dwordx4 v[128:131], v224, s[40:43], s66 offen offset:3072 sc1
    ds_write_b128 v231, v[208:211] offset:43008
    v_mfma_f32_16x16x32_bf16 v[12:15], v[52:55], v[136:139], v[12:15]
    ds_read_b64_tr_b16 v[48:49], v86 offset:28672
    v_mfma_f32_16x16x32_bf16 v[28:31], v[52:55], v[140:143], v[28:31]
    ds_read_b64_tr_b16 v[50:51], v234 offset:28672
    v_mfma_f32_16x16x32_bf16 v[16:19], v[56:59], v[136:139], v[16:19]
    ds_read_b64_tr_b16 v[52:53], v87 offset:28672
    v_mfma_f32_16x16x32_bf16 v[32:35], v[56:59], v[140:143], v[32:35]
    ds_read_b64_tr_b16 v[54:55], v235 offset:28672
    buffer_load_dwordx4 v[132:135], v225, s[40:43], s66 offen offset:3072 sc1
    ds_write_b128 v231, v[212:215] offset:51200
    s_waitcnt vmcnt(10) lgkmcnt(11)
    v_mfma_f32_16x16x32_bf16 v[4:7], v[60:63], v[144:147], v[4:7]
    ds_read_b64_tr_b16 v[56:57], v84 offset:32768
    v_mfma_f32_16x16x32_bf16 v[20:23], v[60:63], v[148:151], v[20:23]
    ds_read_b64_tr_b16 v[58:59], v232 offset:32768
    v_mfma_f32_16x16x32_bf16 v[8:11], v[64:67], v[144:147], v[8:11]
    ds_read_b64_tr_b16 v[60:61], v85 offset:32768
    v_mfma_f32_16x16x32_bf16 v[24:27], v[64:67], v[148:151], v[24:27]
    ds_read_b64_tr_b16 v[62:63], v233 offset:32768
    buffer_load_dwordx4 v[136:139], v224, s[40:43], s67 offen offset:0 sc1
    ds_write_b128 v231, v[216:219] offset:52224
    s_mov_b64 exec, 1
    ds_add_u32 v228, v2 offset:12
    s_mov_b64 exec, -1
    v_mfma_f32_16x16x32_bf16 v[12:15], v[68:71], v[144:147], v[12:15]
    ds_read_b64_tr_b16 v[64:65], v86 offset:32768
    v_mfma_f32_16x16x32_bf16 v[28:31], v[68:71], v[148:151], v[28:31]
    ds_read_b64_tr_b16 v[66:67], v234 offset:32768
    v_mfma_f32_16x16x32_bf16 v[16:19], v[36:39], v[144:147], v[16:19]
    ds_read_b64_tr_b16 v[68:69], v87 offset:32768
    v_mfma_f32_16x16x32_bf16 v[32:35], v[36:39], v[148:151], v[32:35]
    ds_read_b64_tr_b16 v[70:71], v235 offset:32768
    buffer_load_dwordx4 v[140:143], v225, s[40:43], s67 offen offset:0 sc1
    s_waitcnt vmcnt(10) lgkmcnt(11)
    v_mfma_f32_16x16x32_bf16 v[4:7], v[40:43], v[96:99], v[4:7]
    ds_read_b64_tr_b16 v[36:37], v84 offset:36864
    v_mfma_f32_16x16x32_bf16 v[20:23], v[40:43], v[100:103], v[20:23]
    ds_read_b64_tr_b16 v[38:39], v232 offset:36864
    v_mfma_f32_16x16x32_bf16 v[8:11], v[44:47], v[96:99], v[8:11]
    ds_read_b64_tr_b16 v[40:41], v85 offset:36864
    v_mfma_f32_16x16x32_bf16 v[24:27], v[44:47], v[100:103], v[24:27]
    ds_read_b64_tr_b16 v[42:43], v233 offset:36864
    buffer_load_dwordx4 v[144:147], v224, s[40:43], s67 offen offset:1024 sc1
    v_mfma_f32_16x16x32_bf16 v[12:15], v[48:51], v[96:99], v[12:15]
    ds_read_b64_tr_b16 v[44:45], v86 offset:36864
    v_mfma_f32_16x16x32_bf16 v[28:31], v[48:51], v[100:103], v[28:31]
    ds_read_b64_tr_b16 v[46:47], v234 offset:36864
    v_mfma_f32_16x16x32_bf16 v[16:19], v[52:55], v[96:99], v[16:19]
    ds_read_b64_tr_b16 v[48:49], v87 offset:36864
    v_mfma_f32_16x16x32_bf16 v[32:35], v[52:55], v[100:103], v[32:35]
    ds_read_b64_tr_b16 v[50:51], v235 offset:36864
    buffer_load_dwordx4 v[148:151], v225, s[40:43], s67 offen offset:1024 sc1
    s_waitcnt vmcnt(10) lgkmcnt(8)
    v_mfma_f32_16x16x32_bf16 v[4:7], v[56:59], v[104:107], v[4:7]
    ds_read_b64_tr_b16 v[52:53], v88 offset:0
    v_mfma_f32_16x16x32_bf16 v[20:23], v[56:59], v[108:111], v[20:23]
    ds_read_b64_tr_b16 v[54:55], v236 offset:0
    v_mfma_f32_16x16x32_bf16 v[8:11], v[60:63], v[104:107], v[8:11]
    ds_read_b64_tr_b16 v[56:57], v89 offset:0
    v_mfma_f32_16x16x32_bf16 v[24:27], v[60:63], v[108:111], v[24:27]
    ds_read_b64_tr_b16 v[58:59], v237 offset:0
    buffer_load_dwordx4 v[96:99], v224, s[40:43], s67 offen offset:2048 sc1
    v_mfma_f32_16x16x32_bf16 v[12:15], v[64:67], v[104:107], v[12:15]
    ds_read_b64_tr_b16 v[60:61], v90 offset:0
    v_mfma_f32_16x16x32_bf16 v[28:31], v[64:67], v[108:111], v[28:31]
    ds_read_b64_tr_b16 v[62:63], v238 offset:0
    v_mfma_f32_16x16x32_bf16 v[16:19], v[68:71], v[104:107], v[16:19]
    ds_read_b64_tr_b16 v[64:65], v91 offset:0
    v_mfma_f32_16x16x32_bf16 v[32:35], v[68:71], v[108:111], v[32:35]
    ds_read_b64_tr_b16 v[66:67], v239 offset:0
    buffer_load_dwordx4 v[100:103], v225, s[40:43], s67 offen offset:2048 sc1
    s_waitcnt vmcnt(10) lgkmcnt(8)
    v_mfma_f32_16x16x32_bf16 v[4:7], v[36:39], v[112:115], v[4:7]
    ds_read_b64_tr_b16 v[68:69], v88 offset:4096
    v_mfma_f32_16x16x32_bf16 v[20:23], v[36:39], v[116:119], v[20:23]
    ds_read_b64_tr_b16 v[70:71], v236 offset:4096
    v_mfma_f32_16x16x32_bf16 v[8:11], v[40:43], v[112:115], v[8:11]
    ds_read_b64_tr_b16 v[36:37], v89 offset:4096
    v_mfma_f32_16x16x32_bf16 v[24:27], v[40:43], v[116:119], v[24:27]
    ds_read_b64_tr_b16 v[38:39], v237 offset:4096
    buffer_load_dwordx4 v[104:107], v224, s[40:43], s67 offen offset:3072 sc1
    v_mfma_f32_16x16x32_bf16 v[12:15], v[44:47], v[112:115], v[12:15]
    ds_read_b64_tr_b16 v[40:41], v90 offset:4096
    v_mfma_f32_16x16x32_bf16 v[28:31], v[44:47], v[116:119], v[28:31]
    ds_read_b64_tr_b16 v[42:43], v238 offset:4096
    v_mfma_f32_16x16x32_bf16 v[16:19], v[48:51], v[112:115], v[16:19]
    ds_read_b64_tr_b16 v[44:45], v91 offset:4096
    v_mfma_f32_16x16x32_bf16 v[32:35], v[48:51], v[116:119], v[32:35]
    ds_read_b64_tr_b16 v[46:47], v239 offset:4096
    buffer_load_dwordx4 v[108:111], v225, s[40:43], s67 offen offset:3072 sc1
    s_waitcnt vmcnt(10) lgkmcnt(8)
    v_mfma_f32_16x16x32_bf16 v[4:7], v[52:55], v[120:123], v[4:7]
    ds_read_b64_tr_b16 v[48:49], v88 offset:8192
    v_mfma_f32_16x16x32_bf16 v[20:23], v[52:55], v[124:127], v[20:23]
    ds_read_b64_tr_b16 v[50:51], v236 offset:8192
    v_mfma_f32_16x16x32_bf16 v[8:11], v[56:59], v[120:123], v[8:11]
    ds_read_b64_tr_b16 v[52:53], v89 offset:8192
    v_mfma_f32_16x16x32_bf16 v[24:27], v[56:59], v[124:127], v[24:27]
    ds_read_b64_tr_b16 v[54:55], v237 offset:8192
    buffer_load_dwordx4 v[112:115], v224, s[40:43], s68 offen offset:0 sc1
    v_mfma_f32_16x16x32_bf16 v[12:15], v[60:63], v[120:123], v[12:15]
    ds_read_b64_tr_b16 v[56:57], v90 offset:8192
    v_mfma_f32_16x16x32_bf16 v[28:31], v[60:63], v[124:127], v[28:31]
    ds_read_b64_tr_b16 v[58:59], v238 offset:8192
    v_mfma_f32_16x16x32_bf16 v[16:19], v[64:67], v[120:123], v[16:19]
    ds_read_b64_tr_b16 v[60:61], v91 offset:8192
    v_mfma_f32_16x16x32_bf16 v[32:35], v[64:67], v[124:127], v[32:35]
    ds_read_b64_tr_b16 v[62:63], v239 offset:8192
    buffer_load_dwordx4 v[116:119], v225, s[40:43], s68 offen offset:0 sc1
    s_waitcnt vmcnt(10) lgkmcnt(8)
    v_mfma_f32_16x16x32_bf16 v[4:7], v[68:71], v[128:131], v[4:7]
    ds_read_b64_tr_b16 v[64:65], v88 offset:12288
    v_mfma_f32_16x16x32_bf16 v[20:23], v[68:71], v[132:135], v[20:23]
    ds_read_b64_tr_b16 v[66:67], v236 offset:12288
    v_mfma_f32_16x16x32_bf16 v[8:11], v[36:39], v[128:131], v[8:11]
    ds_read_b64_tr_b16 v[68:69], v89 offset:12288
    v_mfma_f32_16x16x32_bf16 v[24:27], v[36:39], v[132:135], v[24:27]
    ds_read_b64_tr_b16 v[70:71], v237 offset:12288
    buffer_load_dwordx4 v[120:123], v224, s[40:43], s68 offen offset:1024 sc1
    v_mfma_f32_16x16x32_bf16 v[12:15], v[40:43], v[128:131], v[12:15]
    ds_read_b64_tr_b16 v[36:37], v90 offset:12288
    v_mfma_f32_16x16x32_bf16 v[28:31], v[40:43], v[132:135], v[28:31]
    ds_read_b64_tr_b16 v[38:39], v238 offset:12288
    v_mfma_f32_16x16x32_bf16 v[16:19], v[44:47], v[128:131], v[16:19]
    ds_read_b64_tr_b16 v[40:41], v91 offset:12288
    v_mfma_f32_16x16x32_bf16 v[32:35], v[44:47], v[132:135], v[32:35]
    ds_read_b64_tr_b16 v[42:43], v239 offset:12288
    buffer_load_dwordx4 v[124:127], v225, s[40:43], s68 offen offset:1024 sc1
    s_waitcnt vmcnt(10) lgkmcnt(8)
    v_mfma_f32_16x16x32_bf16 v[4:7], v[48:51], v[136:139], v[4:7]
    ds_read_b64_tr_b16 v[44:45], v88 offset:16384
    v_mfma_f32_16x16x32_bf16 v[20:23], v[48:51], v[140:143], v[20:23]
    ds_read_b64_tr_b16 v[46:47], v236 offset:16384
    v_mfma_f32_16x16x32_bf16 v[8:11], v[52:55], v[136:139], v[8:11]
    ds_read_b64_tr_b16 v[48:49], v89 offset:16384
    v_mfma_f32_16x16x32_bf16 v[24:27], v[52:55], v[140:143], v[24:27]
    ds_read_b64_tr_b16 v[50:51], v237 offset:16384
    buffer_load_dwordx4 v[128:131], v224, s[40:43], s68 offen offset:2048 sc1
    v_mfma_f32_16x16x32_bf16 v[12:15], v[56:59], v[136:139], v[12:15]
    ds_read_b64_tr_b16 v[52:53], v90 offset:16384
    v_mfma_f32_16x16x32_bf16 v[28:31], v[56:59], v[140:143], v[28:31]
    ds_read_b64_tr_b16 v[54:55], v238 offset:16384
    v_mfma_f32_16x16x32_bf16 v[16:19], v[60:63], v[136:139], v[16:19]
    ds_read_b64_tr_b16 v[56:57], v91 offset:16384
    v_mfma_f32_16x16x32_bf16 v[32:35], v[60:63], v[140:143], v[32:35]
    ds_read_b64_tr_b16 v[58:59], v239 offset:16384
    buffer_load_dwordx4 v[132:135], v225, s[40:43], s68 offen offset:2048 sc1
    s_waitcnt vmcnt(10) lgkmcnt(8)
    v_mfma_f32_16x16x32_bf16 v[4:7], v[64:67], v[144:147], v[4:7]
    ds_read_b64_tr_b16 v[60:61], v88 offset:20480
    v_mfma_f32_16x16x32_bf16 v[20:23], v[64:67], v[148:151], v[20:23]
    ds_read_b64_tr_b16 v[62:63], v236 offset:20480
    v_mfma_f32_16x16x32_bf16 v[8:11], v[68:71], v[144:147], v[8:11]
    ds_read_b64_tr_b16 v[64:65], v89 offset:20480
    v_mfma_f32_16x16x32_bf16 v[24:27], v[68:71], v[148:151], v[24:27]
    ds_read_b64_tr_b16 v[66:67], v237 offset:20480
    buffer_load_dwordx4 v[136:139], v224, s[40:43], s68 offen offset:3072 sc1
    v_mfma_f32_16x16x32_bf16 v[12:15], v[36:39], v[144:147], v[12:15]
    ds_read_b64_tr_b16 v[68:69], v90 offset:20480
    v_mfma_f32_16x16x32_bf16 v[28:31], v[36:39], v[148:151], v[28:31]
    ds_read_b64_tr_b16 v[70:71], v238 offset:20480
    v_mfma_f32_16x16x32_bf16 v[16:19], v[40:43], v[144:147], v[16:19]
    ds_read_b64_tr_b16 v[36:37], v91 offset:20480
    v_mfma_f32_16x16x32_bf16 v[32:35], v[40:43], v[148:151], v[32:35]
    ds_read_b64_tr_b16 v[38:39], v239 offset:20480
    buffer_load_dwordx4 v[140:143], v225, s[40:43], s68 offen offset:3072 sc1
    s_waitcnt vmcnt(10) lgkmcnt(8)
    v_mfma_f32_16x16x32_bf16 v[4:7], v[44:47], v[96:99], v[4:7]
    ds_read_b64_tr_b16 v[40:41], v88 offset:24576
    v_mfma_f32_16x16x32_bf16 v[20:23], v[44:47], v[100:103], v[20:23]
    ds_read_b64_tr_b16 v[42:43], v236 offset:24576
    v_mfma_f32_16x16x32_bf16 v[8:11], v[48:51], v[96:99], v[8:11]
    ds_read_b64_tr_b16 v[44:45], v89 offset:24576
    v_mfma_f32_16x16x32_bf16 v[24:27], v[48:51], v[100:103], v[24:27]
    ds_read_b64_tr_b16 v[46:47], v237 offset:24576
    buffer_load_dwordx4 v[144:147], v224, s[40:43], s69 offen offset:0 sc1
    v_mfma_f32_16x16x32_bf16 v[12:15], v[52:55], v[96:99], v[12:15]
    ds_read_b64_tr_b16 v[48:49], v90 offset:24576
    v_mfma_f32_16x16x32_bf16 v[28:31], v[52:55], v[100:103], v[28:31]
    ds_read_b64_tr_b16 v[50:51], v238 offset:24576
    v_mfma_f32_16x16x32_bf16 v[16:19], v[56:59], v[96:99], v[16:19]
    ds_read_b64_tr_b16 v[52:53], v91 offset:24576
    v_mfma_f32_16x16x32_bf16 v[32:35], v[56:59], v[100:103], v[32:35]
    ds_read_b64_tr_b16 v[54:55], v239 offset:24576
    buffer_load_dwordx4 v[148:151], v225, s[40:43], s69 offen offset:0 sc1
    s_waitcnt vmcnt(10) lgkmcnt(8)
    v_mfma_f32_16x16x32_bf16 v[4:7], v[60:63], v[104:107], v[4:7]
    ds_read_b64_tr_b16 v[56:57], v88 offset:28672
    v_mfma_f32_16x16x32_bf16 v[20:23], v[60:63], v[108:111], v[20:23]
    ds_read_b64_tr_b16 v[58:59], v236 offset:28672
    v_mfma_f32_16x16x32_bf16 v[8:11], v[64:67], v[104:107], v[8:11]
    ds_read_b64_tr_b16 v[60:61], v89 offset:28672
    v_mfma_f32_16x16x32_bf16 v[24:27], v[64:67], v[108:111], v[24:27]
    ds_read_b64_tr_b16 v[62:63], v237 offset:28672
    buffer_load_dwordx4 v[96:99], v224, s[40:43], s69 offen offset:1024 sc1
    v_mfma_f32_16x16x32_bf16 v[12:15], v[68:71], v[104:107], v[12:15]
    ds_read_b64_tr_b16 v[64:65], v90 offset:28672
    v_mfma_f32_16x16x32_bf16 v[28:31], v[68:71], v[108:111], v[28:31]
    ds_read_b64_tr_b16 v[66:67], v238 offset:28672
    v_mfma_f32_16x16x32_bf16 v[16:19], v[36:39], v[104:107], v[16:19]
    ds_read_b64_tr_b16 v[68:69], v91 offset:28672
    v_mfma_f32_16x16x32_bf16 v[32:35], v[36:39], v[108:111], v[32:35]
    ds_read_b64_tr_b16 v[70:71], v239 offset:28672
    buffer_load_dwordx4 v[100:103], v225, s[40:43], s69 offen offset:1024 sc1
    s_waitcnt vmcnt(10) lgkmcnt(8)
    v_mfma_f32_16x16x32_bf16 v[4:7], v[40:43], v[112:115], v[4:7]
    ds_read_b64_tr_b16 v[36:37], v88 offset:32768
    v_mfma_f32_16x16x32_bf16 v[20:23], v[40:43], v[116:119], v[20:23]
    ds_read_b64_tr_b16 v[38:39], v236 offset:32768
    v_mfma_f32_16x16x32_bf16 v[8:11], v[44:47], v[112:115], v[8:11]
    ds_read_b64_tr_b16 v[40:41], v89 offset:32768
    v_mfma_f32_16x16x32_bf16 v[24:27], v[44:47], v[116:119], v[24:27]
    ds_read_b64_tr_b16 v[42:43], v237 offset:32768
    buffer_load_dwordx4 v[104:107], v224, s[40:43], s69 offen offset:2048 sc1
    v_mfma_f32_16x16x32_bf16 v[12:15], v[48:51], v[112:115], v[12:15]
    ds_read_b64_tr_b16 v[44:45], v90 offset:32768
    v_mfma_f32_16x16x32_bf16 v[28:31], v[48:51], v[116:119], v[28:31]
    ds_read_b64_tr_b16 v[46:47], v238 offset:32768
    v_mfma_f32_16x16x32_bf16 v[16:19], v[52:55], v[112:115], v[16:19]
    ds_read_b64_tr_b16 v[48:49], v91 offset:32768
    v_mfma_f32_16x16x32_bf16 v[32:35], v[52:55], v[116:119], v[32:35]
    ds_read_b64_tr_b16 v[50:51], v239 offset:32768
    buffer_load_dwordx4 v[108:111], v225, s[40:43], s69 offen offset:2048 sc1
    ds_read_b32 v1, v228 offset:12
    s_waitcnt vmcnt(10) lgkmcnt(9)
    v_mfma_f32_16x16x32_bf16 v[4:7], v[56:59], v[120:123], v[4:7]
    ds_read_b64_tr_b16 v[52:53], v88 offset:36864
    v_mfma_f32_16x16x32_bf16 v[20:23], v[56:59], v[124:127], v[20:23]
    ds_read_b64_tr_b16 v[54:55], v236 offset:36864
    v_mfma_f32_16x16x32_bf16 v[8:11], v[60:63], v[120:123], v[8:11]
    ds_read_b64_tr_b16 v[56:57], v89 offset:36864
    v_mfma_f32_16x16x32_bf16 v[24:27], v[60:63], v[124:127], v[24:27]
    ds_read_b64_tr_b16 v[58:59], v237 offset:36864
    buffer_load_dwordx4 v[112:115], v224, s[40:43], s69 offen offset:3072 sc1
    v_mfma_f32_16x16x32_bf16 v[12:15], v[64:67], v[120:123], v[12:15]
    ds_read_b64_tr_b16 v[60:61], v90 offset:36864
    v_mfma_f32_16x16x32_bf16 v[28:31], v[64:67], v[124:127], v[28:31]
    ds_read_b64_tr_b16 v[62:63], v238 offset:36864
    v_mfma_f32_16x16x32_bf16 v[16:19], v[68:71], v[120:123], v[16:19]
    ds_read_b64_tr_b16 v[64:65], v91 offset:36864
    v_mfma_f32_16x16x32_bf16 v[32:35], v[68:71], v[124:127], v[32:35]
    ds_read_b64_tr_b16 v[66:67], v239 offset:36864
    buffer_load_dwordx4 v[116:119], v225, s[40:43], s69 offen offset:3072 sc1
    s_waitcnt lgkmcnt(8)
    v_readfirstlane_b32 s37, v1
    s_nop 0
    s_cmp_ge_u32 s37, 4
    s_cbranch_scc1 L_sl_done_59
    s_mov_b32 s38, 1048576
L_sl_loop_60:
    ds_read_b32 v1, v228 offset:12
    s_waitcnt lgkmcnt(0)
    v_readfirstlane_b32 s37, v1
    s_nop 0
    s_cmp_ge_u32 s37, 4
    s_cbranch_scc1 L_sl_done_59
    s_sleep 1
    s_sub_u32 s38, s38, 1
    s_cbranch_scc0 L_sl_loop_60
L_sl_done_59:
    s_waitcnt vmcnt(10)
    v_mfma_f32_16x16x32_bf16 v[4:7], v[36:39], v[128:131], v[4:7]
    ds_read_b64_tr_b16 v[68:69], v92 offset:0
    v_mfma_f32_16x16x32_bf16 v[20:23], v[36:39], v[132:135], v[20:23]
    ds_read_b64_tr_b16 v[70:71], v240 offset:0
    v_mfma_f32_16x16x32_bf16 v[8:11], v[40:43], v[128:131], v[8:11]
    ds_read_b64_tr_b16 v[36:37], v93 offset:0
    v_mfma_f32_16x16x32_bf16 v[24:27], v[40:43], v[132:135], v[24:27]
    ds_read_b64_tr_b16 v[38:39], v241 offset:0
    buffer_load_dwordx4 v[120:123], v224, s[40:43], s70 offen offset:0 sc1
    v_mfma_f32_16x16x32_bf16 v[12:15], v[44:47], v[128:131], v[12:15]
    ds_read_b64_tr_b16 v[40:41], v94 offset:0
    v_mfma_f32_16x16x32_bf16 v[28:31], v[44:47], v[132:135], v[28:31]
    ds_read_b64_tr_b16 v[42:43], v242 offset:0
    v_mfma_f32_16x16x32_bf16 v[16:19], v[48:51], v[128:131], v[16:19]
    ds_read_b64_tr_b16 v[44:45], v95 offset:0
    v_mfma_f32_16x16x32_bf16 v[32:35], v[48:51], v[132:135], v[32:35]
    ds_read_b64_tr_b16 v[46:47], v243 offset:0
    buffer_load_dwordx4 v[124:127], v225, s[40:43], s70 offen offset:0 sc1
    s_waitcnt vmcnt(10) lgkmcnt(8)
    v_mfma_f32_16x16x32_bf16 v[4:7], v[52:55], v[136:139], v[4:7]
    ds_read_b64_tr_b16 v[48:49], v92 offset:4096
    v_mfma_f32_16x16x32_bf16 v[20:23], v[52:55], v[140:143], v[20:23]
    ds_read_b64_tr_b16 v[50:51], v240 offset:4096
    v_mfma_f32_16x16x32_bf16 v[8:11], v[56:59], v[136:139], v[8:11]
    ds_read_b64_tr_b16 v[52:53], v93 offset:4096
    v_mfma_f32_16x16x32_bf16 v[24:27], v[56:59], v[140:143], v[24:27]
    ds_read_b64_tr_b16 v[54:55], v241 offset:4096
    buffer_load_dwordx4 v[128:131], v224, s[40:43], s70 offen offset:1024 sc1
    v_mfma_f32_16x16x32_bf16 v[12:15], v[60:63], v[136:139], v[12:15]
    ds_read_b64_tr_b16 v[56:57], v94 offset:4096
    v_mfma_f32_16x16x32_bf16 v[28:31], v[60:63], v[140:143], v[28:31]
    ds_read_b64_tr_b16 v[58:59], v242 offset:4096
    v_mfma_f32_16x16x32_bf16 v[16:19], v[64:67], v[136:139], v[16:19]
    ds_read_b64_tr_b16 v[60:61], v95 offset:4096
    v_mfma_f32_16x16x32_bf16 v[32:35], v[64:67], v[140:143], v[32:35]
    ds_read_b64_tr_b16 v[62:63], v243 offset:4096
    buffer_load_dwordx4 v[132:135], v225, s[40:43], s70 offen offset:1024 sc1
    s_waitcnt vmcnt(10) lgkmcnt(8)
    v_mfma_f32_16x16x32_bf16 v[4:7], v[68:71], v[144:147], v[4:7]
    ds_read_b64_tr_b16 v[64:65], v92 offset:8448
    v_mfma_f32_16x16x32_bf16 v[20:23], v[68:71], v[148:151], v[20:23]
    ds_read_b64_tr_b16 v[66:67], v240 offset:8448
    v_mfma_f32_16x16x32_bf16 v[8:11], v[36:39], v[144:147], v[8:11]
    ds_read_b64_tr_b16 v[68:69], v93 offset:8448
    v_mfma_f32_16x16x32_bf16 v[24:27], v[36:39], v[148:151], v[24:27]
    ds_read_b64_tr_b16 v[70:71], v241 offset:8448
    buffer_load_dwordx4 v[136:139], v224, s[40:43], s70 offen offset:2048 sc1
    v_mfma_f32_16x16x32_bf16 v[12:15], v[40:43], v[144:147], v[12:15]
    ds_read_b64_tr_b16 v[36:37], v94 offset:8448
    v_mfma_f32_16x16x32_bf16 v[28:31], v[40:43], v[148:151], v[28:31]
    ds_read_b64_tr_b16 v[38:39], v242 offset:8448
    v_mfma_f32_16x16x32_bf16 v[16:19], v[44:47], v[144:147], v[16:19]
    ds_read_b64_tr_b16 v[40:41], v95 offset:8448
    v_mfma_f32_16x16x32_bf16 v[32:35], v[44:47], v[148:151], v[32:35]
    ds_read_b64_tr_b16 v[42:43], v243 offset:8448
    buffer_load_dwordx4 v[140:143], v225, s[40:43], s70 offen offset:2048 sc1
    s_waitcnt vmcnt(10) lgkmcnt(8)
    v_mfma_f32_16x16x32_bf16 v[4:7], v[48:51], v[96:99], v[4:7]
    ds_read_b64_tr_b16 v[44:45], v92 offset:12544
    v_mfma_f32_16x16x32_bf16 v[20:23], v[48:51], v[100:103], v[20:23]
    ds_read_b64_tr_b16 v[46:47], v240 offset:12544
    v_mfma_f32_16x16x32_bf16 v[8:11], v[52:55], v[96:99], v[8:11]
    ds_read_b64_tr_b16 v[48:49], v93 offset:12544
    v_mfma_f32_16x16x32_bf16 v[24:27], v[52:55], v[100:103], v[24:27]
    ds_read_b64_tr_b16 v[50:51], v241 offset:12544
    buffer_load_dwordx4 v[144:147], v224, s[40:43], s70 offen offset:3072 sc1
    v_mfma_f32_16x16x32_bf16 v[12:15], v[56:59], v[96:99], v[12:15]
    ds_read_b64_tr_b16 v[52:53], v94 offset:12544
    v_mfma_f32_16x16x32_bf16 v[28:31], v[56:59], v[100:103], v[28:31]
    ds_read_b64_tr_b16 v[54:55], v242 offset:12544
    v_mfma_f32_16x16x32_bf16 v[16:19], v[60:63], v[96:99], v[16:19]
    ds_read_b64_tr_b16 v[56:57], v95 offset:12544
    v_mfma_f32_16x16x32_bf16 v[32:35], v[60:63], v[100:103], v[32:35]
    ds_read_b64_tr_b16 v[58:59], v243 offset:12544
    buffer_load_dwordx4 v[148:151], v225, s[40:43], s70 offen offset:3072 sc1
    s_waitcnt vmcnt(10) lgkmcnt(8)
    v_mfma_f32_16x16x32_bf16 v[4:7], v[64:67], v[104:107], v[4:7]
    ds_read_b64_tr_b16 v[60:61], v92 offset:16896
    v_mfma_f32_16x16x32_bf16 v[20:23], v[64:67], v[108:111], v[20:23]
    ds_read_b64_tr_b16 v[62:63], v240 offset:16896
    v_mfma_f32_16x16x32_bf16 v[8:11], v[68:71], v[104:107], v[8:11]
    ds_read_b64_tr_b16 v[64:65], v93 offset:16896
    v_mfma_f32_16x16x32_bf16 v[24:27], v[68:71], v[108:111], v[24:27]
    ds_read_b64_tr_b16 v[66:67], v241 offset:16896
    buffer_load_dwordx4 v[96:99], v224, s[40:43], s71 offen offset:0 sc1
    v_mfma_f32_16x16x32_bf16 v[12:15], v[36:39], v[104:107], v[12:15]
    ds_read_b64_tr_b16 v[68:69], v94 offset:16896
    v_mfma_f32_16x16x32_bf16 v[28:31], v[36:39], v[108:111], v[28:31]
    ds_read_b64_tr_b16 v[70:71], v242 offset:16896
    v_mfma_f32_16x16x32_bf16 v[16:19], v[40:43], v[104:107], v[16:19]
    ds_read_b64_tr_b16 v[36:37], v95 offset:16896
    v_mfma_f32_16x16x32_bf16 v[32:35], v[40:43], v[108:111], v[32:35]
    ds_read_b64_tr_b16 v[38:39], v243 offset:16896
    buffer_load_dwordx4 v[100:103], v225, s[40:43], s71 offen offset:0 sc1
    s_waitcnt vmcnt(10) lgkmcnt(8)
    v_mfma_f32_16x16x32_bf16 v[4:7], v[44:47], v[112:115], v[4:7]
    ds_read_b64_tr_b16 v[40:41], v92 offset:20992
    v_mfma_f32_16x16x32_bf16 v[20:23], v[44:47], v[116:119], v[20:23]
    ds_read_b64_tr_b16 v[42:43], v240 offset:20992
    v_mfma_f32_16x16x32_bf16 v[8:11], v[48:51], v[112:115], v[8:11]
    ds_read_b64_tr_b16 v[44:45], v93 offset:20992
    v_mfma_f32_16x16x32_bf16 v[24:27], v[48:51], v[116:119], v[24:27]
    ds_read_b64_tr_b16 v[46:47], v241 offset:20992
    buffer_load_dwordx4 v[104:107], v224, s[40:43], s71 offen offset:1024 sc1
    v_mfma_f32_16x16x32_bf16 v[12:15], v[52:55], v[112:115], v[12:15]
    ds_read_b64_tr_b16 v[48:49], v94 offset:20992
    v_mfma_f32_16x16x32_bf16 v[28:31], v[52:55], v[116:119], v[28:31]
    ds_read_b64_tr_b16 v[50:51], v242 offset:20992
    v_mfma_f32_16x16x32_bf16 v[16:19], v[56:59], v[112:115], v[16:19]
    ds_read_b64_tr_b16 v[52:53], v95 offset:20992
    v_mfma_f32_16x16x32_bf16 v[32:35], v[56:59], v[116:119], v[32:35]
    ds_read_b64_tr_b16 v[54:55], v243 offset:20992
    buffer_load_dwordx4 v[108:111], v225, s[40:43], s71 offen offset:1024 sc1
    s_waitcnt vmcnt(10) lgkmcnt(8)
    v_mfma_f32_16x16x32_bf16 v[4:7], v[60:63], v[120:123], v[4:7]
    ds_read_b64_tr_b16 v[56:57], v92 offset:25344
    v_mfma_f32_16x16x32_bf16 v[20:23], v[60:63], v[124:127], v[20:23]
    ds_read_b64_tr_b16 v[58:59], v240 offset:25344
    v_mfma_f32_16x16x32_bf16 v[8:11], v[64:67], v[120:123], v[8:11]
    ds_read_b64_tr_b16 v[60:61], v93 offset:25344
    v_mfma_f32_16x16x32_bf16 v[24:27], v[64:67], v[124:127], v[24:27]
    ds_read_b64_tr_b16 v[62:63], v241 offset:25344
    buffer_load_dwordx4 v[112:115], v224, s[40:43], s71 offen offset:2048 sc1
    v_mfma_f32_16x16x32_bf16 v[12:15], v[68:71], v[120:123], v[12:15]
    ds_read_b64_tr_b16 v[64:65], v94 offset:25344
    v_mfma_f32_16x16x32_bf16 v[28:31], v[68:71], v[124:127], v[28:31]
    ds_read_b64_tr_b16 v[66:67], v242 offset:25344
    v_mfma_f32_16x16x32_bf16 v[16:19], v[36:39], v[120:123], v[16:19]
    ds_read_b64_tr_b16 v[68:69], v95 offset:25344
    v_mfma_f32_16x16x32_bf16 v[32:35], v[36:39], v[124:127], v[32:35]
    ds_read_b64_tr_b16 v[70:71], v243 offset:25344
    buffer_load_dwordx4 v[116:119], v225, s[40:43], s71 offen offset:2048 sc1
    s_waitcnt vmcnt(10) lgkmcnt(8)
    v_mfma_f32_16x16x32_bf16 v[4:7], v[40:43], v[128:131], v[4:7]
    ds_read_b64_tr_b16 v[36:37], v92 offset:29440
    v_mfma_f32_16x16x32_bf16 v[20:23], v[40:43], v[132:135], v[20:23]
    ds_read_b64_tr_b16 v[38:39], v240 offset:29440
    v_mfma_f32_16x16x32_bf16 v[8:11], v[44:47], v[128:131], v[8:11]
    ds_read_b64_tr_b16 v[40:41], v93 offset:29440
    v_mfma_f32_16x16x32_bf16 v[24:27], v[44:47], v[132:135], v[24:27]
    ds_read_b64_tr_b16 v[42:43], v241 offset:29440
    buffer_load_dwordx4 v[120:123], v224, s[40:43], s71 offen offset:3072 sc1
    v_mfma_f32_16x16x32_bf16 v[12:15], v[48:51], v[128:131], v[12:15]
    ds_read_b64_tr_b16 v[44:45], v94 offset:29440
    v_mfma_f32_16x16x32_bf16 v[28:31], v[48:51], v[132:135], v[28:31]
    ds_read_b64_tr_b16 v[46:47], v242 offset:29440
    v_mfma_f32_16x16x32_bf16 v[16:19], v[52:55], v[128:131], v[16:19]
    ds_read_b64_tr_b16 v[48:49], v95 offset:29440
    v_mfma_f32_16x16x32_bf16 v[32:35], v[52:55], v[132:135], v[32:35]
    ds_read_b64_tr_b16 v[50:51], v243 offset:29440
    buffer_load_dwordx4 v[124:127], v225, s[40:43], s71 offen offset:3072 sc1
    s_waitcnt vmcnt(10) lgkmcnt(8)
    v_mfma_f32_16x16x32_bf16 v[4:7], v[56:59], v[136:139], v[4:7]
    ds_read_b64_tr_b16 v[52:53], v84 offset:41984
    v_mfma_f32_16x16x32_bf16 v[20:23], v[56:59], v[140:143], v[20:23]
    ds_read_b64_tr_b16 v[54:55], v232 offset:41984
    v_mfma_f32_16x16x32_bf16 v[8:11], v[60:63], v[136:139], v[8:11]
    ds_read_b64_tr_b16 v[56:57], v85 offset:41984
    v_mfma_f32_16x16x32_bf16 v[24:27], v[60:63], v[140:143], v[24:27]
    ds_read_b64_tr_b16 v[58:59], v233 offset:41984
    v_mfma_f32_16x16x32_bf16 v[12:15], v[64:67], v[136:139], v[12:15]
    ds_read_b64_tr_b16 v[60:61], v86 offset:41984
    v_mfma_f32_16x16x32_bf16 v[28:31], v[64:67], v[140:143], v[28:31]
    ds_read_b64_tr_b16 v[62:63], v234 offset:41984
    v_mfma_f32_16x16x32_bf16 v[16:19], v[68:71], v[136:139], v[16:19]
    ds_read_b64_tr_b16 v[64:65], v87 offset:41984
    v_mfma_f32_16x16x32_bf16 v[32:35], v[68:71], v[140:143], v[32:35]
    ds_read_b64_tr_b16 v[66:67], v235 offset:41984
    s_waitcnt vmcnt(8) lgkmcnt(8)
    v_mfma_f32_16x16x32_bf16 v[4:7], v[36:39], v[144:147], v[4:7]
    ds_read_b64_tr_b16 v[68:69], v84 offset:46080
    v_mfma_f32_16x16x32_bf16 v[20:23], v[36:39], v[148:151], v[20:23]
    ds_read_b64_tr_b16 v[70:71], v232 offset:46080
    v_mfma_f32_16x16x32_bf16 v[8:11], v[40:43], v[144:147], v[8:11]
    ds_read_b64_tr_b16 v[36:37], v85 offset:46080
    v_mfma_f32_16x16x32_bf16 v[24:27], v[40:43], v[148:151], v[24:27]
    ds_read_b64_tr_b16 v[38:39], v233 offset:46080
    v_mfma_f32_16x16x32_bf16 v[12:15], v[44:47], v[144:147], v[12:15]
    ds_read_b64_tr_b16 v[40:41], v86 offset:46080
    v_mfma_f32_16x16x32_bf16 v[28:31], v[44:47], v[148:151], v[28:31]
    ds_read_b64_tr_b16 v[42:43], v234 offset:46080
    v_mfma_f32_16x16x32_bf16 v[16:19], v[48:51], v[144:147], v[16:19]
    ds_read_b64_tr_b16 v[44:45], v87 offset:46080
    v_mfma_f32_16x16x32_bf16 v[32:35], v[48:51], v[148:151], v[32:35]
    ds_read_b64_tr_b16 v[46:47], v235 offset:46080
    s_waitcnt vmcnt(6) lgkmcnt(8)
    v_mfma_f32_16x16x32_bf16 v[4:7], v[52:55], v[96:99], v[4:7]
    ds_read_b64_tr_b16 v[48:49], v84 offset:51200
    v_mfma_f32_16x16x32_bf16 v[20:23], v[52:55], v[100:103], v[20:23]
    ds_read_b64_tr_b16 v[50:51], v232 offset:51200
    v_mfma_f32_16x16x32_bf16 v[8:11], v[56:59], v[96:99], v[8:11]
    ds_read_b64_tr_b16 v[52:53], v85 offset:51200
    v_mfma_f32_16x16x32_bf16 v[24:27], v[56:59], v[100:103], v[24:27]
    ds_read_b64_tr_b16 v[54:55], v233 offset:51200
    v_mfma_f32_16x16x32_bf16 v[12:15], v[60:63], v[96:99], v[12:15]
    ds_read_b64_tr_b16 v[56:57], v86 offset:51200
    v_mfma_f32_16x16x32_bf16 v[28:31], v[60:63], v[100:103], v[28:31]
    ds_read_b64_tr_b16 v[58:59], v234 offset:51200
    v_mfma_f32_16x16x32_bf16 v[16:19], v[64:67], v[96:99], v[16:19]
    ds_read_b64_tr_b16 v[60:61], v87 offset:51200
    v_mfma_f32_16x16x32_bf16 v[32:35], v[64:67], v[100:103], v[32:35]
    ds_read_b64_tr_b16 v[62:63], v235 offset:51200
    s_waitcnt vmcnt(4) lgkmcnt(8)
    v_mfma_f32_16x16x32_bf16 v[4:7], v[68:71], v[104:107], v[4:7]
    ds_read_b64_tr_b16 v[64:65], v84 offset:55296
    v_mfma_f32_16x16x32_bf16 v[20:23], v[68:71], v[108:111], v[20:23]
    ds_read_b64_tr_b16 v[66:67], v232 offset:55296
    v_mfma_f32_16x16x32_bf16 v[8:11], v[36:39], v[104:107], v[8:11]
    ds_read_b64_tr_b16 v[68:69], v85 offset:55296
    v_mfma_f32_16x16x32_bf16 v[24:27], v[36:39], v[108:111], v[24:27]
    ds_read_b64_tr_b16 v[70:71], v233 offset:55296
    v_mfma_f32_16x16x32_bf16 v[12:15], v[40:43], v[104:107], v[12:15]
    ds_read_b64_tr_b16 v[36:37], v86 offset:55296
    v_mfma_f32_16x16x32_bf16 v[28:31], v[40:43], v[108:111], v[28:31]
    ds_read_b64_tr_b16 v[38:39], v234 offset:55296
    v_mfma_f32_16x16x32_bf16 v[16:19], v[44:47], v[104:107], v[16:19]
    ds_read_b64_tr_b16 v[40:41], v87 offset:55296
    v_mfma_f32_16x16x32_bf16 v[32:35], v[44:47], v[108:111], v[32:35]
    ds_read_b64_tr_b16 v[42:43], v235 offset:55296
    s_waitcnt vmcnt(2) lgkmcnt(8)
    v_mfma_f32_16x16x32_bf16 v[4:7], v[48:51], v[112:115], v[4:7]
    v_mfma_f32_16x16x32_bf16 v[8:11], v[52:55], v[112:115], v[8:11]
    v_mfma_f32_16x16x32_bf16 v[12:15], v[56:59], v[112:115], v[12:15]
    v_mfma_f32_16x16x32_bf16 v[16:19], v[60:63], v[112:115], v[16:19]
    s_waitcnt vmcnt(0) lgkmcnt(0)
    v_mfma_f32_16x16x32_bf16 v[4:7], v[64:67], v[120:123], v[4:7]
    s_nop 0
    s_nop 0
    v_mfma_f32_16x16x32_bf16 v[8:11], v[68:71], v[120:123], v[8:11]
    s_nop 0
    s_nop 0
    v_mfma_f32_16x16x32_bf16 v[12:15], v[36:39], v[120:123], v[12:15]
    s_nop 0
    s_nop 0
    v_cvt_pk_bf16_f32 v172, v4, v5
    v_cvt_pk_bf16_f32 v173, v6, v7
    v_mfma_f32_16x16x32_bf16 v[16:19], v[40:43], v[120:123], v[16:19]
    ds_write_b64 v244, v[172:173]
    v_cvt_pk_bf16_f32 v174, v8, v9
    v_mfma_f32_16x16x32_bf16 v[20:23], v[48:51], v[116:119], v[20:23]
    v_cvt_pk_bf16_f32 v175, v10, v11
    ds_write_b64 v245, v[174:175]
    v_mfma_f32_16x16x32_bf16 v[20:23], v[64:67], v[124:127], v[20:23]
    v_cvt_pk_bf16_f32 v176, v12, v13
    v_cvt_pk_bf16_f32 v177, v14, v15
    v_mfma_f32_16x16x32_bf16 v[24:27], v[52:55], v[116:119], v[24:27]
    ds_write_b64 v246, v[176:177]
    v_cvt_pk_bf16_f32 v178, v16, v17
    v_mfma_f32_16x16x32_bf16 v[24:27], v[68:71], v[124:127], v[24:27]
    v_cvt_pk_bf16_f32 v179, v18, v19
    ds_write_b64 v247, v[178:179]
    v_mfma_f32_16x16x32_bf16 v[28:31], v[56:59], v[116:119], v[28:31]
    ds_read_b128 v[188:191], v248 offset:0
    ds_read_b128 v[192:195], v248 offset:1024
    v_mfma_f32_16x16x32_bf16 v[28:31], v[36:39], v[124:127], v[28:31]
    v_cvt_pk_bf16_f32 v180, v20, v21
    v_cvt_pk_bf16_f32 v181, v22, v23
    v_mfma_f32_16x16x32_bf16 v[32:35], v[60:63], v[116:119], v[32:35]
    ds_write_b64 v244, v[180:181]
    v_cvt_pk_bf16_f32 v182, v24, v25
    v_mfma_f32_16x16x32_bf16 v[32:35], v[40:43], v[124:127], v[32:35]
    v_cvt_pk_bf16_f32 v183, v26, v27
    ds_write_b64 v245, v[182:183]
    v_cvt_pk_bf16_f32 v184, v28, v29
    v_cvt_pk_bf16_f32 v185, v30, v31
    s_mov_b32 s37, 0
    s_waitcnt lgkmcnt(3)
    buffer_store_dwordx4 v[188:191], v226, s[48:51], s37 offen nt
    s_mov_b32 s37, 65536
    s_waitcnt lgkmcnt(2)
    buffer_store_dwordx4 v[192:195], v226, s[48:51], s37 offen nt
    ds_write_b64 v246, v[184:185]
    v_cvt_pk_bf16_f32 v186, v32, v33
    v_cvt_pk_bf16_f32 v187, v34, v35
    ds_write_b64 v247, v[186:187]
    ds_read_b128 v[196:199], v248 offset:0
    ds_read_b128 v[200:203], v248 offset:1024
    s_mov_b32 s37, 131072
    s_waitcnt lgkmcnt(1)
    buffer_store_dwordx4 v[196:199], v226, s[48:51], s37 offen nt
    s_mov_b32 s37, 196608
    s_waitcnt lgkmcnt(0)
    buffer_store_dwordx4 v[200:203], v226, s[48:51], s37 offen nt
    s_endpgm
L_end:
    s_endpgm
.section .rodata,"a"
.p2align 6
.amdhsa_kernel concat_heads__ssm_conv_h3__sliding_local_dilated__prompt_kernel
  .amdhsa_next_free_vgpr 256
  .amdhsa_next_free_sgpr 102
  .amdhsa_accum_offset 256
  .amdhsa_group_segment_fixed_size 0
  .amdhsa_kernarg_size 96
  .amdhsa_user_sgpr_count 2
  .amdhsa_user_sgpr_kernarg_segment_ptr 1
  .amdhsa_system_sgpr_workgroup_id_x 1
  .amdhsa_float_denorm_mode_32 3
.end_amdhsa_kernel
```

```asm
; @launch grid=(256,1,1) block=(512,1,1) lds=163840
.amdgcn_target "amdgcn-amd-amdhsa--gfx950"
.text
.globl concat_heads__ssm_conv_h3__sliding_local_dilated__prompt_kernel
.p2align 8
.type concat_heads__ssm_conv_h3__sliding_local_dilated__prompt_kernel,@function
concat_heads__ssm_conv_h3__sliding_local_dilated__prompt_kernel:
L_entry:
    s_getpc_b64 s[32:33]
    s_cmp_ge_u32 s2, 256
    s_cbranch_scc1 L_end
    s_load_dwordx16 s[8:23], s[0:1], 0
    s_load_dwordx8 s[24:31], s[0:1], 64
    v_lshrrev_b32 v1, 6, v0
    s_and_b32 s4, s2, 1
    v_readfirstlane_b32 s3, v1
    v_and_b32 v0, 63, v0
    s_bfe_u32 s5, s2, 0x30003
    s_bfe_u32 s6, s2, 0x20001
    s_lshr_b32 s7, s2, 6
    s_lshl2_add_u32 s6, s6, s7
    s_cmp_ge_u32 s3, 4
    s_cbranch_scc1 L_crole
    s_bfe_u32 s34, s2, 0x20003
    s_lshl2_add_u32 s34, s34, s3
    s_lshl_b32 s34, s34, 7
    v_lshl_add_u32 v1, v0, 11, s34
    v_min_u32 v1, L_end-L_entry-8, v1
    s_mov_b64 exec, 0xffff
    global_load_dword v252, v1, s[32:33]
    s_mov_b64 exec, -1
    s_and_b32 s84, s2, 3
    s_lshl2_add_u32 s84, s84, s3
    s_bfe_u32 s85, s2, 0x50002
    s_lshl_b32 s87, s85, 10
    s_add_u32 s87, s87, s84
    s_lshl_b32 s87, s87, 7
    v_and_b32 v185, 7, v0
    v_lshl_add_u32 v185, v185, 4, s87
    v_lshrrev_b32 v184, 3, v0
    v_lshl_add_u32 v184, v184, 14, v185
    v_subrev_u32 v185, 6144, v184
    v_add_u32 v188, 4096, v184
    v_subrev_u32 v186, 4096, v184
    v_add_u32 v189, 8192, v184
    v_subrev_u32 v187, 2048, v184
    v_add_u32 v190, 12288, v184
    v_lshlrev_b32 v191, 4, v0
    s_lshl_b32 s86, s3, 9
    s_add_u32 m0, s86, 159744
    s_lshl_b32 s87, s84, 9
    s_waitcnt lgkmcnt(0)
    s_bitcmp0_b32 s2, 7
    s_cbranch_scc1 L_nokv
    s_mov_b32 s80, s14
    s_mov_b32 s81, s15
    s_mov_b32 s82, 0x2000
    s_mov_b32 s83, 0x20000
    s_mov_b32 s72, s10
    s_mov_b32 s73, s11
    s_mov_b32 s74, 0x400000
    s_mov_b32 s75, 0x20000
    s_mov_b32 exec_hi, 0
    buffer_load_dwordx4 v191, s[80:83], s87 offen lds
    s_mov_b64 exec, -1
    buffer_load_dwordx4 v[108:111], v185, s[72:75], 0 offen offset:0 nt
    buffer_load_dwordx4 v[112:115], v186, s[72:75], 0 offen offset:0 nt
    buffer_load_dwordx4 v[116:119], v187, s[72:75], 0 offen offset:0 nt
    buffer_load_dwordx4 v[120:123], v184, s[72:75], 0 offen offset:0 nt
    buffer_load_dwordx4 v[124:127], v184, s[72:75], 0 offen offset:2048 nt
    buffer_load_dwordx4 v[128:131], v188, s[72:75], 0 offen offset:0 nt
    buffer_load_dwordx4 v[132:135], v188, s[72:75], 0 offen offset:2048 nt
    buffer_load_dwordx4 v[136:139], v189, s[72:75], 0 offen offset:0 nt
    buffer_load_dwordx4 v[140:143], v189, s[72:75], 0 offen offset:2048 nt
    buffer_load_dwordx4 v[144:147], v190, s[72:75], 0 offen offset:0 nt
    buffer_load_dwordx4 v[148:151], v190, s[72:75], 0 offen offset:2048 nt
    s_mov_b32 s76, s12
    s_mov_b32 s77, s13
    s_mov_b32 s78, 0x400000
    s_mov_b32 s79, 0x20000
    buffer_load_dwordx4 v[152:155], v184, s[76:79], 0 offen offset:0 nt
    buffer_load_dwordx4 v[156:159], v184, s[76:79], 0 offen offset:2048 nt
    buffer_load_dwordx4 v[160:163], v188, s[76:79], 0 offen offset:0 nt
    buffer_load_dwordx4 v[164:167], v188, s[76:79], 0 offen offset:2048 nt
    buffer_load_dwordx4 v[168:171], v189, s[76:79], 0 offen offset:0 nt
    buffer_load_dwordx4 v[172:175], v189, s[76:79], 0 offen offset:2048 nt
    buffer_load_dwordx4 v[176:179], v190, s[76:79], 0 offen offset:0 nt
    buffer_load_dwordx4 v[180:183], v190, s[76:79], 0 offen offset:2048 nt
L_nokv:
    s_branch L_grole
L_crole:
    s_sub_u32 s70, s3, 4
    s_lshl_b32 s43, s70, 12
    s_lshl_b32 s44, s70, 11
    s_add_u32 s44, s44, 17408
    s_lshl_b32 s49, s70, 4
    s_lshl_b64 s[46:47], 0xffff, s49
    v_lshrrev_b32 v13, 3, v0
    v_and_b32 v14, 7, v0
    v_lshrrev_b32 v15, 4, v0
    s_lshl2_add_u32 s50, s5, s70
    s_lshl_b32 s50, s50, 6
    s_add_u32 s50, s50, s4
    s_lshl_b32 s50, s50, 11
    v_lshl_add_u32 v16, v13, 12, s50
    v_xor_b32 v17, v14, v15
    v_lshl_add_u32 v2, v17, 4, v16
    v_xor_b32 v3, 64, v2
    v_add_u32 v3, 31744, v3
    v_add_u32 v4, 63488, v2
    v_add_u32 v5, 63488, v3
    s_lshl_b32 s49, s5, 7
    s_sub_u32 s49, s49, 8
    s_max_i32 s49, s49, 0
    s_lshl1_add_u32 s49, s49, s4
    s_lshl_b32 s49, s49, 11
    v_lshl_add_u32 v16, v13, 12, s49
    v_lshlrev_b32 v17, 1, v15
    v_xor_b32 v18, v14, v13
    v_lshl_add_u32 v6, v18, 4, v16
    s_mul_i32 s49, s70, 768
    s_add_u32 s49, s49, s6
    s_lshl_b32 s49, s49, 7
    v_mul_u32_u24 v16, 6144, v13
    v_and_b32 v17, 2, v17
    v_xor_b32 v17, v14, v17
    v_lshlrev_b32 v17, 4, v17
    v_add3_u32 v7, v17, v16, s49
    v_xor_b32 v8, 64, v7
    v_add_u32 v8, 48128, v8
    v_add_u32 v9, 2048, v7
    v_add_u32 v10, 2048, v8
    v_add_u32 v11, 4096, v7
    v_add_u32 v12, 4096, v8
    s_movk_i32 s40, 0
    s_mov_b32 s41, 0
    s_lshr_b32 s90, s2, 3
    s_and_b32 s91, s3, 3
    s_lshl2_add_u32 s90, s90, s91
    s_and_b32 s91, s2, 6
    s_lshl3_add_u32 s88, s90, s91
    s_lshl1_add_u32 s88, s88, s4
    s_lshl_b32 s88, s88, 11
    s_and_b32 s89, s2, 7
    s_and_b32 s91, s90, 1
    s_lshl1_add_u32 s89, s89, s91
    s_lshr_b32 s90, s90, 1
    s_mul_i32 s90, s90, 48
    s_add_u32 s89, s89, s90
    s_lshl_b32 s89, s89, 7
    v_and_b32 v251, 1, v0
    v_lshlrev_b32 v251, 12, v251
    v_lshrrev_b32 v252, 1, v0
    v_lshl_add_u32 v251, v252, 7, v251
    v_lshrrev_b32 v250, 2, v0
    v_mul_u32_u24 v250, 393216, v250
    v_and_b32 v252, 3, v0
    v_lshl_add_u32 v252, v252, 11, v250
    s_waitcnt lgkmcnt(0)
    s_mov_b32 s32, s20
    s_mov_b32 s33, s21
    s_mov_b32 s34, 0x400000
    s_mov_b32 s35, 0x20000
    s_mov_b32 s36, s22
    s_mov_b32 s37, s23
    s_mov_b32 s38, 0x600000
    s_mov_b32 s39, 0x20000
    s_setprio 0
    s_and_b32 s73, s2, 7
    s_xor_b32 s73, s73, 2
    s_lshr_b32 s74, s2, 7
    s_lshl1_add_u32 s68, s73, s74
    s_bfe_u32 s69, s2, 0x40003
    s_lshl4_add_u32 s71, s68, s69
    s_lshl2_add_u32 s71, s71, s70
    s_mul_i32 s80, s70, 8448
    s_add_u32 s80, s80, 125952
    s_mul_i32 s81, s70, 9216
    s_add_u32 s81, s81, 41984
    s_add_u32 s52, s30, 0xe00000
    s_addc_u32 s53, s31, 0
    s_mov_b32 s54, 0x20000
    s_mov_b32 s55, 0x20000
    s_add_u32 s64, s30, 0x900000
    s_addc_u32 s65, s31, 0
    s_mov_b32 s66, 0x420000
    s_mov_b32 s67, 0x20000
    s_lshl_b32 s84, s71, 12
    s_mul_i32 s85, s71, 4224
    s_add_u32 s85, s85, 4194304
    s_lshr_b32 s72, s71, 1
    s_lshl_b32 s72, s72, 2
    s_load_dword s72, s[18:19], s72
    v_lshlrev_b32 v224, 4, v0
    v_mov_b32 v228, 0
    v_mov_b32 v229, 0
    v_mov_b32 v230, 0
    v_mov_b32 v231, 0
    v_mov_b32 v227, 134352
    v_mov_b32 v244, 1
    s_bfe_u32 s87, s2, 0x20006
    s_mov_b64 exec, 1
    ds_write_b128 v227, v[228:231]
    ds_write_b128 v227, v[228:231] offset:16
    ds_write_b128 v227, v[228:231] offset:32
    s_mov_b64 exec, -1
    s_lshr_b32 s7, s2, 6
    s_mul_i32 s90, s7, 1048576
    s_sub_u32 s88, s88, s90
    s_mul_i32 s90, s7, 98304
    s_sub_u32 s89, s89, s90
    v_lshrrev_b32 v20, 3, v0
    v_mul_u32_u24 v20, 1048064, v20
    v_add_u32 v251, v251, v20
    v_lshrrev_b32 v20, 4, v0
    v_mul_u32_u24 v20, 1474560, v20
    v_sub_u32 v252, v252, v20
    s_bitcmp0_b32 1, s87
    s_cbranch_scc1 L_stg_1
    s_add_u32 s6, s89, 0
    s_mov_b32 exec_lo, 0x70007
    s_mov_b32 exec_hi, 0x70007
    s_bfe_u32 s7, s89, 0x30007
    s_cmp_lg_u32 s7, 1
    s_cbranch_scc1 L_wx3_2
    buffer_load_dword v250, v252, s[36:39], s6 offen offset:256
L_wx3_2:
    buffer_load_dword v250, v252, s[36:39], s6 offen
    s_mov_b32 exec_lo, 0x3030303
    s_mov_b32 exec_hi, 0
    buffer_load_dword v250, v251, s[32:35], s88 offen offset:0
    s_mov_b64 exec, -1
L_stg_1:
    s_bitcmp0_b32 2, s87
    s_cbranch_scc1 L_stg_3
    s_add_u32 s6, s89, 393216
    s_mov_b32 exec_lo, 0x70007
    s_mov_b32 exec_hi, 0x70007
    s_bfe_u32 s7, s89, 0x30007
    s_cmp_lg_u32 s7, 1
    s_cbranch_scc1 L_wx3_4
    buffer_load_dword v250, v252, s[36:39], s6 offen offset:256
L_wx3_4:
    buffer_load_dword v250, v252, s[36:39], s6 offen
    s_mov_b32 exec_lo, 0x3030303
    s_mov_b32 exec_hi, 0
    buffer_load_dword v250, v251, s[32:35], s88 offen offset:128
    s_mov_b64 exec, -1
L_stg_3:
    s_add_u32 m0, s43, 0
    s_nop 0
    buffer_load_dwordx4 v2, s[32:35], s40 offen offset:0 lds
    s_add_u32 m0, s44, 0
    s_nop 0
    buffer_load_dwordx4 v7, s[36:39], s41 offen offset:0 lds
    buffer_load_dwordx4 v8, s[36:39], s41 offen offset:1024 lds
    s_add_u32 m0, s43, 0
    s_nop 0
    buffer_load_dwordx4 v3, s[32:35], s40 offen offset:1024 lds
    s_add_u32 m0, s44, 8192
    s_nop 0
    buffer_load_dwordx4 v9, s[36:39], s41 offen offset:0 lds
    buffer_load_dwordx4 v10, s[36:39], s41 offen offset:1024 lds
    s_add_u32 m0, s43, 0
    s_nop 0
    buffer_load_dwordx4 v4, s[32:35], s40 offen offset:2048 lds
    s_add_u32 m0, s44, 16384
    s_nop 0
    buffer_load_dwordx4 v11, s[36:39], s41 offen offset:0 lds
    buffer_load_dwordx4 v12, s[36:39], s41 offen offset:1024 lds
    s_add_u32 m0, s43, 0
    s_nop 0
    buffer_load_dwordx4 v5, s[32:35], s40 offen offset:3072 lds
    s_mov_b32 m0, 16384
    s_mov_b64 exec, s[46:47]
    buffer_load_dwordx4 v6, s[32:35], s40 offen lds
    s_mov_b64 exec, -1
    s_movk_i32 s40, 128
    s_mov_b32 s41, 393216
    s_add_u32 m0, s43, 41984
    s_nop 0
    buffer_load_dwordx4 v2, s[32:35], s40 offen offset:0 lds
    s_add_u32 m0, s44, 41984
    s_nop 0
    buffer_load_dwordx4 v7, s[36:39], s41 offen offset:0 lds
    buffer_load_dwordx4 v8, s[36:39], s41 offen offset:1024 lds
    s_add_u32 m0, s43, 41984
    s_nop 0
    buffer_load_dwordx4 v3, s[32:35], s40 offen offset:1024 lds
    s_add_u32 m0, s44, 50176
    s_nop 0
    buffer_load_dwordx4 v9, s[36:39], s41 offen offset:0 lds
    buffer_load_dwordx4 v10, s[36:39], s41 offen offset:1024 lds
    s_add_u32 m0, s43, 41984
    s_nop 0
    buffer_load_dwordx4 v4, s[32:35], s40 offen offset:2048 lds
    s_add_u32 m0, s44, 58368
    s_nop 0
    buffer_load_dwordx4 v11, s[36:39], s41 offen offset:0 lds
    buffer_load_dwordx4 v12, s[36:39], s41 offen offset:1024 lds
    s_add_u32 m0, s43, 41984
    s_nop 0
    buffer_load_dwordx4 v5, s[32:35], s40 offen offset:3072 lds
    s_mov_b32 m0, 58368
    s_mov_b64 exec, s[46:47]
    buffer_load_dwordx4 v6, s[32:35], s40 offen lds
    s_mov_b64 exec, -1
    s_movk_i32 s40, 256
    s_mov_b32 s41, 786432
    s_bitcmp0_b32 1, s87
    s_cbranch_scc1 L_stg_5
    s_add_u32 s6, s89, 786432
    s_mov_b32 exec_lo, 0x70007
    s_mov_b32 exec_hi, 0x70007
    s_bfe_u32 s7, s89, 0x30007
    s_cmp_lg_u32 s7, 1
    s_cbranch_scc1 L_wx3_6
    buffer_load_dword v250, v252, s[36:39], s6 offen offset:256
L_wx3_6:
    buffer_load_dword v250, v252, s[36:39], s6 offen
    s_mov_b32 exec_lo, 0x3030303
    s_mov_b32 exec_hi, 0
    buffer_load_dword v250, v251, s[32:35], s88 offen offset:256
    s_mov_b64 exec, -1
L_stg_5:
    s_bitcmp0_b32 2, s87
    s_cbranch_scc1 L_stg_7
    s_add_u32 s6, s89, 1179648
    s_mov_b32 exec_lo, 0x70007
    s_mov_b32 exec_hi, 0x70007
    s_bfe_u32 s7, s89, 0x30007
    s_cmp_lg_u32 s7, 1
    s_cbranch_scc1 L_wx3_8
    buffer_load_dword v250, v252, s[36:39], s6 offen offset:256
L_wx3_8:
    buffer_load_dword v250, v252, s[36:39], s6 offen
    s_mov_b32 exec_lo, 0x3030303
    s_mov_b32 exec_hi, 0
    buffer_load_dword v250, v251, s[32:35], s88 offen offset:384
    s_mov_b64 exec, -1
L_stg_7:
    s_lshr_b32 s74, s69, 2
    s_and_b32 s75, s69, 3
    s_lshl3_add_u32 s74, s74, s75
    s_lshl3_add_u32 s74, s74, s70
    s_lshl_b32 s74, s74, 3
    v_bfe_u32 v234, v0, 3, 1
    v_lshl_add_u32 v225, v234, 8, s74
    v_bfe_u32 v234, v0, 4, 1
    v_lshl_add_u32 v225, v234, 1, v225
    v_lshrrev_b32 v234, 5, v0
    v_lshl_add_u32 v225, v234, 5, v225
    s_lshl_b32 s74, s68, 7
    v_and_b32 v234, 7, v0
    v_lshl_add_u32 v234, v234, 4, s74
    v_lshl_add_u32 v226, v225, 12, v234
    v_lshl_add_u32 v225, v225, 11, v234
    v_and_b32 v234, 1, v0
    v_xor_b32 v234, 1, v234
    v_mul_u32_u24 v232, 4224, v234
    v_mul_u32_u24 v233, 4576, v234
    v_bfe_u32 v234, v0, 1, 3
    v_lshl_add_u32 v232, v234, 3, v232
    v_xor_b32 v234, 7, v234
    v_lshl_add_u32 v233, v234, 6, v233
    v_lshrrev_b32 v234, 4, v0
    v_lshl_add_u32 v232, v234, 4, v232
    v_lshl_add_u32 v233, v234, 4, v233
    v_add3_u32 v232, v232, s80, 8
    v_add_u32 v233, s81, v233
    s_waitcnt lgkmcnt(0)
    s_bitcmp1_b32 s71, 0
    s_cselect_b32 s74, 0, 16
    s_lshl_b32 s72, s72, s74
    s_and_b32 s72, s72, 0xffff0000
    v_and_b32 v235, 1, v0
    v_lshlrev_b32 v235, 4, v235
    v_lshrrev_b32 v235, v235, s72
    v_bfe_u32 v236, v0, 1, 3
    v_lshl_add_u32 v236, v234, 1, v236
    v_cmp_eq_u32 vcc, 7, v236
    v_mov_b32 v241, 0
    v_mov_b32 v243, 0
    v_cndmask_b32 v240, 0, v235, vcc
    v_cmp_eq_u32 vcc, 6, v236
    s_nop 1
    v_cndmask_b32 v242, 0, v235, vcc
    s_waitcnt vmcnt(13)
    s_bitcmp1_b32 3, s87
    s_cbranch_scc1 L_mw_9
    s_waitcnt vmcnt(11)
L_mw_9:
    s_barrier
    s_add_u32 m0, s43, 83968
    s_nop 0
    buffer_load_dwordx4 v2, s[32:35], s40 offen offset:0 lds
    s_add_u32 m0, s44, 83968
    s_nop 0
    buffer_load_dwordx4 v7, s[36:39], s41 offen offset:0 lds
    buffer_load_dwordx4 v8, s[36:39], s41 offen offset:1024 lds
    s_add_u32 m0, s43, 83968
    s_nop 0
    buffer_load_dwordx4 v3, s[32:35], s40 offen offset:1024 lds
    s_add_u32 m0, s44, 92160
    s_nop 0
    buffer_load_dwordx4 v9, s[36:39], s41 offen offset:0 lds
    buffer_load_dwordx4 v10, s[36:39], s41 offen offset:1024 lds
    s_add_u32 m0, s43, 83968
    s_nop 0
    buffer_load_dwordx4 v4, s[32:35], s40 offen offset:2048 lds
    s_add_u32 m0, s44, 100352
    s_nop 0
    buffer_load_dwordx4 v11, s[36:39], s41 offen offset:0 lds
    buffer_load_dwordx4 v12, s[36:39], s41 offen offset:1024 lds
    s_add_u32 m0, s43, 83968
    s_nop 0
    buffer_load_dwordx4 v5, s[32:35], s40 offen offset:3072 lds
    s_mov_b32 m0, 100352
    s_mov_b64 exec, s[46:47]
    buffer_load_dwordx4 v6, s[32:35], s40 offen lds
    s_mov_b64 exec, -1
    s_movk_i32 s40, 384
    s_mov_b32 s41, 1179648
    s_bitcmp0_b32 1, s87
    s_cbranch_scc1 L_stg_10
    s_add_u32 s6, s89, 1572864
    s_mov_b32 exec_lo, 0x770077
    s_mov_b32 exec_hi, 0x770077
    s_bfe_u32 s7, s89, 0x30007
    s_cmp_lg_u32 s7, 1
    s_cbranch_scc1 L_wx3_11
    buffer_load_dword v250, v252, s[36:39], s6 offen offset:256
L_wx3_11:
    buffer_load_dword v250, v252, s[36:39], s6 offen
    s_mov_b32 exec_lo, 0xf0f0f0f
    s_mov_b32 exec_hi, 0
    buffer_load_dword v250, v251, s[32:35], s88 offen offset:512
    s_mov_b64 exec, -1
L_stg_10:
    s_waitcnt vmcnt(15)
    s_bitcmp1_b32 1, s87
    s_cbranch_scc1 L_mw_12
    s_waitcnt vmcnt(13)
    s_bitcmp1_b32 3, s87
    s_cbranch_scc1 L_mw_12
    s_waitcnt vmcnt(11)
L_mw_12:
    s_barrier
    s_add_u32 m0, s43, 0
    s_nop 0
    buffer_load_dwordx4 v2, s[32:35], s40 offen offset:0 lds
    s_add_u32 m0, s44, 0
    s_nop 0
    buffer_load_dwordx4 v7, s[36:39], s41 offen offset:0 lds
    buffer_load_dwordx4 v8, s[36:39], s41 offen offset:1024 lds
    s_add_u32 m0, s43, 0
    s_nop 0
    buffer_load_dwordx4 v3, s[32:35], s40 offen offset:1024 lds
    s_add_u32 m0, s44, 8192
    s_nop 0
    buffer_load_dwordx4 v9, s[36:39], s41 offen offset:0 lds
    buffer_load_dwordx4 v10, s[36:39], s41 offen offset:1024 lds
    s_add_u32 m0, s43, 0
    s_nop 0
    buffer_load_dwordx4 v4, s[32:35], s40 offen offset:2048 lds
    s_add_u32 m0, s44, 16384
    s_nop 0
    buffer_load_dwordx4 v11, s[36:39], s41 offen offset:0 lds
    buffer_load_dwordx4 v12, s[36:39], s41 offen offset:1024 lds
    s_add_u32 m0, s43, 0
    s_nop 0
    buffer_load_dwordx4 v5, s[32:35], s40 offen offset:3072 lds
    s_mov_b32 m0, 16384
    s_mov_b64 exec, s[46:47]
    buffer_load_dwordx4 v6, s[32:35], s40 offen lds
    s_mov_b64 exec, -1
    s_movk_i32 s40, 512
    s_mov_b32 s41, 1572864
    s_bitcmp0_b32 2, s87
    s_cbranch_scc1 L_stg_13
    s_add_u32 s6, s89, 2359296
    s_mov_b32 exec_lo, 0x770077
    s_mov_b32 exec_hi, 0x770077
    s_bfe_u32 s7, s89, 0x30007
    s_cmp_lg_u32 s7, 1
    s_cbranch_scc1 L_wx3_14
    buffer_load_dword v250, v252, s[36:39], s6 offen offset:256
L_wx3_14:
    buffer_load_dword v250, v252, s[36:39], s6 offen
    s_mov_b32 exec_lo, 0xf0f0f0f
    s_mov_b32 exec_hi, 0
    buffer_load_dword v250, v251, s[32:35], s88 offen offset:768
    s_mov_b64 exec, -1
L_stg_13:
    s_load_dwordx2 s[90:91], s[16:17], s84 offset:60
    s_load_dwordx2 s[90:91], s[16:17], s84 offset:188
    s_load_dwordx2 s[90:91], s[16:17], s84 offset:316
    s_waitcnt vmcnt(13)
    s_bitcmp1_b32 3, s87
    s_cbranch_scc1 L_mw_15
    s_waitcnt vmcnt(11)
L_mw_15:
    s_barrier
    s_add_u32 m0, s43, 41984
    s_nop 0
    buffer_load_dwordx4 v2, s[32:35], s40 offen offset:0 lds
    s_add_u32 m0, s44, 41984
    s_nop 0
    buffer_load_dwordx4 v7, s[36:39], s41 offen offset:0 lds
    buffer_load_dwordx4 v8, s[36:39], s41 offen offset:1024 lds
    s_add_u32 m0, s43, 41984
    s_nop 0
    buffer_load_dwordx4 v3, s[32:35], s40 offen offset:1024 lds
    s_add_u32 m0, s44, 50176
    s_nop 0
    buffer_load_dwordx4 v9, s[36:39], s41 offen offset:0 lds
    buffer_load_dwordx4 v10, s[36:39], s41 offen offset:1024 lds
    s_add_u32 m0, s43, 41984
    s_nop 0
    buffer_load_dwordx4 v4, s[32:35], s40 offen offset:2048 lds
    s_add_u32 m0, s44, 58368
    s_nop 0
    buffer_load_dwordx4 v11, s[36:39], s41 offen offset:0 lds
    buffer_load_dwordx4 v12, s[36:39], s41 offen offset:1024 lds
    s_add_u32 m0, s43, 41984
    s_nop 0
    buffer_load_dwordx4 v5, s[32:35], s40 offen offset:3072 lds
    s_mov_b32 m0, 58368
    s_mov_b64 exec, s[46:47]
    buffer_load_dwordx4 v6, s[32:35], s40 offen lds
    s_mov_b64 exec, -1
    s_movk_i32 s40, 640
    s_mov_b32 s41, 1966080
    s_load_dwordx2 s[90:91], s[16:17], s84 offset:444
    s_load_dwordx2 s[90:91], s[16:17], s84 offset:572
    s_load_dwordx2 s[90:91], s[16:17], s84 offset:700
    s_waitcnt vmcnt(13)
    s_bitcmp1_b32 2, s87
    s_cbranch_scc1 L_mw_16
    s_waitcnt vmcnt(11)
L_mw_16:
    s_barrier
    s_add_u32 m0, s43, 83968
    s_nop 0
    buffer_load_dwordx4 v2, s[32:35], s40 offen offset:0 lds
    s_add_u32 m0, s44, 83968
    s_nop 0
    buffer_load_dwordx4 v7, s[36:39], s41 offen offset:0 lds
    buffer_load_dwordx4 v8, s[36:39], s41 offen offset:1024 lds
    s_add_u32 m0, s43, 83968
    s_nop 0
    buffer_load_dwordx4 v3, s[32:35], s40 offen offset:1024 lds
    s_add_u32 m0, s44, 92160
    s_nop 0
    buffer_load_dwordx4 v9, s[36:39], s41 offen offset:0 lds
    buffer_load_dwordx4 v10, s[36:39], s41 offen offset:1024 lds
    s_add_u32 m0, s43, 83968
    s_nop 0
    buffer_load_dwordx4 v4, s[32:35], s40 offen offset:2048 lds
    s_add_u32 m0, s44, 100352
    s_nop 0
    buffer_load_dwordx4 v11, s[36:39], s41 offen offset:0 lds
    buffer_load_dwordx4 v12, s[36:39], s41 offen offset:1024 lds
    s_add_u32 m0, s43, 83968
    s_nop 0
    buffer_load_dwordx4 v5, s[32:35], s40 offen offset:3072 lds
    s_mov_b32 m0, 100352
    s_mov_b64 exec, s[46:47]
    buffer_load_dwordx4 v6, s[32:35], s40 offen lds
    s_mov_b64 exec, -1
    s_movk_i32 s40, 768
    s_mov_b32 s41, 2359296
    s_bitcmp0_b32 1, s87
    s_cbranch_scc1 L_stg_17
    s_add_u32 s6, s89, 3145728
    s_mov_b32 exec_lo, 0x770077
    s_mov_b32 exec_hi, 0x770077
    s_bfe_u32 s7, s89, 0x30007
    s_cmp_lg_u32 s7, 1
    s_cbranch_scc1 L_wx3_18
    buffer_load_dword v250, v252, s[36:39], s6 offen offset:256
L_wx3_18:
    buffer_load_dword v250, v252, s[36:39], s6 offen
    s_mov_b32 exec_lo, 0xf0f0f0f
    s_mov_b32 exec_hi, 0
    buffer_load_dword v250, v251, s[32:35], s88 offen offset:1024
    s_mov_b64 exec, -1
L_stg_17:
    s_load_dwordx2 s[90:91], s[16:17], s84 offset:828
    s_load_dwordx2 s[90:91], s[16:17], s84 offset:956
    s_load_dwordx2 s[90:91], s[16:17], s84 offset:1084
    s_waitcnt vmcnt(13)
    s_bitcmp1_b32 1, s87
    s_cbranch_scc1 L_mw_19
    s_waitcnt vmcnt(11)
L_mw_19:
    s_barrier
    s_add_u32 m0, s43, 0
    s_nop 0
    buffer_load_dwordx4 v2, s[32:35], s40 offen offset:0 lds
    s_add_u32 m0, s44, 0
    s_nop 0
    buffer_load_dwordx4 v7, s[36:39], s41 offen offset:0 lds
    buffer_load_dwordx4 v8, s[36:39], s41 offen offset:1024 lds
    s_add_u32 m0, s43, 0
    s_nop 0
    buffer_load_dwordx4 v3, s[32:35], s40 offen offset:1024 lds
    s_add_u32 m0, s44, 8192
    s_nop 0
    buffer_load_dwordx4 v9, s[36:39], s41 offen offset:0 lds
    buffer_load_dwordx4 v10, s[36:39], s41 offen offset:1024 lds
    s_add_u32 m0, s43, 0
    s_nop 0
    buffer_load_dwordx4 v4, s[32:35], s40 offen offset:2048 lds
    s_add_u32 m0, s44, 16384
    s_nop 0
    buffer_load_dwordx4 v11, s[36:39], s41 offen offset:0 lds
    buffer_load_dwordx4 v12, s[36:39], s41 offen offset:1024 lds
    s_add_u32 m0, s43, 0
    s_nop 0
    buffer_load_dwordx4 v5, s[32:35], s40 offen offset:3072 lds
    s_mov_b32 m0, 16384
    s_mov_b64 exec, s[46:47]
    buffer_load_dwordx4 v6, s[32:35], s40 offen lds
    s_mov_b64 exec, -1
    s_movk_i32 s40, 896
    s_mov_b32 s41, 2752512
    s_bfe_u32 s74, s2, 0x20003
    s_lshl2_add_u32 s74, s74, s70
    s_cmp_lg_u32 s74, 0
    s_cbranch_scc1 L_sig_20
    s_mov_b32 s60, s28
    s_mov_b32 s61, s29
    s_mov_b32 s62, 0x100
    s_mov_b32 s63, 0x20000
    s_and_b32 s74, s2, 3
    s_lshl_b32 s74, s74, 6
    s_mov_b64 exec, 1
    buffer_atomic_add v244, off, s[60:63], s74 sc1
    s_mov_b64 exec, -1
L_sig_20:
    s_load_dwordx2 s[90:91], s[16:17], s84 offset:1212
    s_load_dwordx2 s[90:91], s[16:17], s84 offset:1340
    s_load_dwordx2 s[90:91], s[16:17], s84 offset:1468
    s_waitcnt vmcnt(13)
    s_bitcmp1_b32 1, s87
    s_cbranch_scc1 L_mw_21
    s_waitcnt vmcnt(11)
L_mw_21:
    s_barrier
    s_add_u32 m0, s43, 41984
    s_nop 0
    buffer_load_dwordx4 v2, s[32:35], s40 offen offset:0 lds
    s_add_u32 m0, s44, 41984
    s_nop 0
    buffer_load_dwordx4 v7, s[36:39], s41 offen offset:0 lds
    buffer_load_dwordx4 v8, s[36:39], s41 offen offset:1024 lds
    s_add_u32 m0, s43, 41984
    s_nop 0
    buffer_load_dwordx4 v3, s[32:35], s40 offen offset:1024 lds
    s_add_u32 m0, s44, 50176
    s_nop 0
    buffer_load_dwordx4 v9, s[36:39], s41 offen offset:0 lds
    buffer_load_dwordx4 v10, s[36:39], s41 offen offset:1024 lds
    s_add_u32 m0, s43, 41984
    s_nop 0
    buffer_load_dwordx4 v4, s[32:35], s40 offen offset:2048 lds
    s_add_u32 m0, s44, 58368
    s_nop 0
    buffer_load_dwordx4 v11, s[36:39], s41 offen offset:0 lds
    buffer_load_dwordx4 v12, s[36:39], s41 offen offset:1024 lds
    s_add_u32 m0, s43, 41984
    s_nop 0
    buffer_load_dwordx4 v5, s[32:35], s40 offen offset:3072 lds
    s_mov_b32 m0, 58368
    s_mov_b64 exec, s[46:47]
    buffer_load_dwordx4 v6, s[32:35], s40 offen lds
    s_mov_b64 exec, -1
    s_movk_i32 s40, 1024
    s_mov_b32 s41, 3145728
    s_bitcmp0_b32 2, s87
    s_cbranch_scc1 L_stg_22
    s_add_u32 s6, s89, 3932160
    s_mov_b32 exec_lo, 0x770077
    s_mov_b32 exec_hi, 0x770077
    s_bfe_u32 s7, s89, 0x30007
    s_cmp_lg_u32 s7, 1
    s_cbranch_scc1 L_wx3_23
    buffer_load_dword v250, v252, s[36:39], s6 offen offset:256
L_wx3_23:
    buffer_load_dword v250, v252, s[36:39], s6 offen
    s_mov_b32 exec_lo, 0xf0f0f0f
    s_mov_b32 exec_hi, 0
    buffer_load_dword v250, v251, s[32:35], s88 offen offset:1280
    s_mov_b64 exec, -1
L_stg_22:
    s_bfe_u32 s74, s2, 0x20003
    s_lshl2_add_u32 s74, s74, s70
    s_cmp_lg_u32 s74, 4
    s_cbranch_scc1 L_sig_24
    s_mov_b32 s60, s28
    s_mov_b32 s61, s29
    s_mov_b32 s62, 0x100
    s_mov_b32 s63, 0x20000
    s_and_b32 s74, s2, 3
    s_lshl_b32 s74, s74, 6
    s_mov_b64 exec, 1
    buffer_atomic_add v244, off, s[60:63], s74 sc1
    s_mov_b64 exec, -1
L_sig_24:
    s_load_dwordx2 s[90:91], s[16:17], s84 offset:1596
    s_load_dwordx2 s[90:91], s[16:17], s84 offset:1724
    s_load_dwordx2 s[90:91], s[16:17], s84 offset:1852
    s_waitcnt vmcnt(13)
    s_bitcmp1_b32 2, s87
    s_cbranch_scc1 L_mw_25
    s_waitcnt vmcnt(11)
L_mw_25:
    s_barrier
    s_add_u32 m0, s43, 83968
    s_nop 0
    buffer_load_dwordx4 v2, s[32:35], s40 offen offset:0 lds
    s_add_u32 m0, s44, 83968
    s_nop 0
    buffer_load_dwordx4 v7, s[36:39], s41 offen offset:0 lds
    buffer_load_dwordx4 v8, s[36:39], s41 offen offset:1024 lds
    s_add_u32 m0, s43, 83968
    s_nop 0
    buffer_load_dwordx4 v3, s[32:35], s40 offen offset:1024 lds
    s_add_u32 m0, s44, 92160
    s_nop 0
    buffer_load_dwordx4 v9, s[36:39], s41 offen offset:0 lds
    buffer_load_dwordx4 v10, s[36:39], s41 offen offset:1024 lds
    s_add_u32 m0, s43, 83968
    s_nop 0
    buffer_load_dwordx4 v4, s[32:35], s40 offen offset:2048 lds
    s_add_u32 m0, s44, 100352
    s_nop 0
    buffer_load_dwordx4 v11, s[36:39], s41 offen offset:0 lds
    buffer_load_dwordx4 v12, s[36:39], s41 offen offset:1024 lds
    s_add_u32 m0, s43, 83968
    s_nop 0
    buffer_load_dwordx4 v5, s[32:35], s40 offen offset:3072 lds
    s_mov_b32 m0, 100352
    s_mov_b64 exec, s[46:47]
    buffer_load_dwordx4 v6, s[32:35], s40 offen lds
    s_mov_b64 exec, -1
    s_movk_i32 s40, 1152
    s_mov_b32 s41, 3538944
    s_bfe_u32 s74, s2, 0x20003
    s_lshl2_add_u32 s74, s74, s70
    s_cmp_lg_u32 s74, 8
    s_cbranch_scc1 L_sig_26
    s_mov_b32 s60, s28
    s_mov_b32 s61, s29
    s_mov_b32 s62, 0x100
    s_mov_b32 s63, 0x20000
    s_and_b32 s74, s2, 3
    s_lshl_b32 s74, s74, 6
    s_mov_b64 exec, 1
    buffer_atomic_add v244, off, s[60:63], s74 sc1
    s_mov_b64 exec, -1
L_sig_26:
    s_load_dwordx2 s[90:91], s[16:17], s84 offset:1980
    s_load_dwordx2 s[90:91], s[16:17], s84 offset:2108
    s_load_dwordx2 s[90:91], s[16:17], s84 offset:2236
    s_waitcnt vmcnt(13)
    s_bitcmp1_b32 2, s87
    s_cbranch_scc1 L_mw_27
    s_waitcnt vmcnt(11)
L_mw_27:
    s_barrier
    s_add_u32 m0, s43, 0
    s_nop 0
    buffer_load_dwordx4 v2, s[32:35], s40 offen offset:0 lds
    s_add_u32 m0, s44, 0
    s_nop 0
    buffer_load_dwordx4 v7, s[36:39], s41 offen offset:0 lds
    buffer_load_dwordx4 v8, s[36:39], s41 offen offset:1024 lds
    s_add_u32 m0, s43, 0
    s_nop 0
    buffer_load_dwordx4 v3, s[32:35], s40 offen offset:1024 lds
    s_add_u32 m0, s44, 8192
    s_nop 0
    buffer_load_dwordx4 v9, s[36:39], s41 offen offset:0 lds
    buffer_load_dwordx4 v10, s[36:39], s41 offen offset:1024 lds
    s_add_u32 m0, s43, 0
    s_nop 0
    buffer_load_dwordx4 v4, s[32:35], s40 offen offset:2048 lds
    s_add_u32 m0, s44, 16384
    s_nop 0
    buffer_load_dwordx4 v11, s[36:39], s41 offen offset:0 lds
    buffer_load_dwordx4 v12, s[36:39], s41 offen offset:1024 lds
    s_add_u32 m0, s43, 0
    s_nop 0
    buffer_load_dwordx4 v5, s[32:35], s40 offen offset:3072 lds
    s_mov_b32 m0, 16384
    s_mov_b64 exec, s[46:47]
    buffer_load_dwordx4 v6, s[32:35], s40 offen lds
    s_mov_b64 exec, -1
    s_movk_i32 s40, 1280
    s_mov_b32 s41, 3932160
    s_bitcmp0_b32 1, s87
    s_cbranch_scc1 L_stg_28
    s_add_u32 s6, s89, 4718592
    s_mov_b32 exec_lo, 0x770077
    s_mov_b32 exec_hi, 0x770077
    s_bfe_u32 s7, s89, 0x30007
    s_cmp_lg_u32 s7, 1
    s_cbranch_scc1 L_wx3_29
    buffer_load_dword v250, v252, s[36:39], s6 offen offset:256
L_wx3_29:
    buffer_load_dword v250, v252, s[36:39], s6 offen
    s_mov_b32 exec_lo, 0xf0f0f0f
    s_mov_b32 exec_hi, 0
    buffer_load_dword v250, v251, s[32:35], s88 offen offset:1536
    s_mov_b64 exec, -1
L_stg_28:
    s_bfe_u32 s74, s2, 0x20003
    s_lshl2_add_u32 s74, s74, s70
    s_cmp_lg_u32 s74, 12
    s_cbranch_scc1 L_sig_30
    s_mov_b32 s60, s28
    s_mov_b32 s61, s29
    s_mov_b32 s62, 0x100
    s_mov_b32 s63, 0x20000
    s_and_b32 s74, s2, 3
    s_lshl_b32 s74, s74, 6
    s_mov_b64 exec, 1
    buffer_atomic_add v244, off, s[60:63], s74 sc1
    s_mov_b64 exec, -1
L_sig_30:
    s_load_dwordx2 s[90:91], s[16:17], s84 offset:2364
    s_load_dwordx2 s[90:91], s[16:17], s84 offset:2492
    s_load_dwordx2 s[90:91], s[16:17], s84 offset:2620
    s_waitcnt vmcnt(13)
    s_bitcmp1_b32 1, s87
    s_cbranch_scc1 L_mw_31
    s_waitcnt vmcnt(11)
L_mw_31:
    s_barrier
    s_add_u32 m0, s43, 41984
    s_nop 0
    buffer_load_dwordx4 v2, s[32:35], s40 offen offset:0 lds
    s_add_u32 m0, s44, 41984
    s_nop 0
    buffer_load_dwordx4 v7, s[36:39], s41 offen offset:0 lds
    buffer_load_dwordx4 v8, s[36:39], s41 offen offset:1024 lds
    s_add_u32 m0, s43, 41984
    s_nop 0
    buffer_load_dwordx4 v3, s[32:35], s40 offen offset:1024 lds
    s_add_u32 m0, s44, 50176
    s_nop 0
    buffer_load_dwordx4 v9, s[36:39], s41 offen offset:0 lds
    buffer_load_dwordx4 v10, s[36:39], s41 offen offset:1024 lds
    s_add_u32 m0, s43, 41984
    s_nop 0
    buffer_load_dwordx4 v4, s[32:35], s40 offen offset:2048 lds
    s_add_u32 m0, s44, 58368
    s_nop 0
    buffer_load_dwordx4 v11, s[36:39], s41 offen offset:0 lds
    buffer_load_dwordx4 v12, s[36:39], s41 offen offset:1024 lds
    s_add_u32 m0, s43, 41984
    s_nop 0
    buffer_load_dwordx4 v5, s[32:35], s40 offen offset:3072 lds
    s_mov_b32 m0, 58368
    s_mov_b64 exec, s[46:47]
    buffer_load_dwordx4 v6, s[32:35], s40 offen lds
    s_mov_b64 exec, -1
    s_movk_i32 s40, 1408
    s_mov_b32 s41, 4325376
    s_load_dwordx2 s[90:91], s[16:17], s84 offset:2748
    s_load_dwordx2 s[90:91], s[16:17], s84 offset:2876
    s_load_dwordx2 s[90:91], s[16:17], s84 offset:3004
    s_waitcnt vmcnt(13)
    s_bitcmp1_b32 1, s87
    s_cbranch_scc1 L_mw_32
    s_waitcnt vmcnt(11)
L_mw_32:
    s_barrier
    s_add_u32 m0, s43, 83968
    s_nop 0
    buffer_load_dwordx4 v2, s[32:35], s40 offen offset:0 lds
    s_add_u32 m0, s44, 83968
    s_nop 0
    buffer_load_dwordx4 v7, s[36:39], s41 offen offset:0 lds
    buffer_load_dwordx4 v8, s[36:39], s41 offen offset:1024 lds
    s_add_u32 m0, s43, 83968
    s_nop 0
    buffer_load_dwordx4 v3, s[32:35], s40 offen offset:1024 lds
    s_add_u32 m0, s44, 92160
    s_nop 0
    buffer_load_dwordx4 v9, s[36:39], s41 offen offset:0 lds
    buffer_load_dwordx4 v10, s[36:39], s41 offen offset:1024 lds
    s_add_u32 m0, s43, 83968
    s_nop 0
    buffer_load_dwordx4 v4, s[32:35], s40 offen offset:2048 lds
    s_add_u32 m0, s44, 100352
    s_nop 0
    buffer_load_dwordx4 v11, s[36:39], s41 offen offset:0 lds
    buffer_load_dwordx4 v12, s[36:39], s41 offen offset:1024 lds
    s_add_u32 m0, s43, 83968
    s_nop 0
    buffer_load_dwordx4 v5, s[32:35], s40 offen offset:3072 lds
    s_mov_b32 m0, 100352
    s_mov_b64 exec, s[46:47]
    buffer_load_dwordx4 v6, s[32:35], s40 offen lds
    s_mov_b64 exec, -1
    s_movk_i32 s40, 1536
    s_mov_b32 s41, 4718592
    s_bitcmp0_b32 2, s87
    s_cbranch_scc1 L_stg_33
    s_add_u32 s6, s89, 5505024
    s_mov_b32 exec_lo, 0x770077
    s_mov_b32 exec_hi, 0x770077
    s_bfe_u32 s7, s89, 0x30007
    s_cmp_lg_u32 s7, 1
    s_cbranch_scc1 L_wx3_34
    buffer_load_dword v250, v252, s[36:39], s6 offen offset:256
L_wx3_34:
    buffer_load_dword v250, v252, s[36:39], s6 offen
    s_mov_b32 exec_lo, 0xf0f0f0f
    s_mov_b32 exec_hi, 0
    buffer_load_dword v250, v251, s[32:35], s88 offen offset:1792
    s_mov_b64 exec, -1
L_stg_33:
    s_load_dwordx2 s[90:91], s[16:17], s84 offset:3132
    s_load_dwordx2 s[90:91], s[16:17], s84 offset:3260
    s_load_dwordx2 s[90:91], s[16:17], s84 offset:3388
    s_waitcnt vmcnt(13)
    s_bitcmp1_b32 2, s87
    s_cbranch_scc1 L_mw_35
    s_waitcnt vmcnt(11)
L_mw_35:
    s_barrier
    s_add_u32 m0, s43, 0
    s_nop 0
    buffer_load_dwordx4 v2, s[32:35], s40 offen offset:0 lds
    s_add_u32 m0, s44, 0
    s_nop 0
    buffer_load_dwordx4 v7, s[36:39], s41 offen offset:0 lds
    buffer_load_dwordx4 v8, s[36:39], s41 offen offset:1024 lds
    s_add_u32 m0, s43, 0
    s_nop 0
    buffer_load_dwordx4 v3, s[32:35], s40 offen offset:1024 lds
    s_add_u32 m0, s44, 8192
    s_nop 0
    buffer_load_dwordx4 v9, s[36:39], s41 offen offset:0 lds
    buffer_load_dwordx4 v10, s[36:39], s41 offen offset:1024 lds
    s_add_u32 m0, s43, 0
    s_nop 0
    buffer_load_dwordx4 v4, s[32:35], s40 offen offset:2048 lds
    s_add_u32 m0, s44, 16384
    s_nop 0
    buffer_load_dwordx4 v11, s[36:39], s41 offen offset:0 lds
    buffer_load_dwordx4 v12, s[36:39], s41 offen offset:1024 lds
    s_add_u32 m0, s43, 0
    s_nop 0
    buffer_load_dwordx4 v5, s[32:35], s40 offen offset:3072 lds
    s_mov_b32 m0, 16384
    s_mov_b64 exec, s[46:47]
    buffer_load_dwordx4 v6, s[32:35], s40 offen lds
    s_mov_b64 exec, -1
    s_movk_i32 s40, 1664
    s_mov_b32 s41, 5111808
    s_load_dwordx2 s[90:91], s[16:17], s84 offset:3516
    s_load_dwordx2 s[90:91], s[16:17], s84 offset:3644
    s_load_dwordx2 s[90:91], s[16:17], s84 offset:3772
    s_waitcnt vmcnt(13)
    s_bitcmp1_b32 2, s87
    s_cbranch_scc1 L_mw_36
    s_waitcnt vmcnt(11)
L_mw_36:
    s_barrier
    s_add_u32 m0, s43, 41984
    s_nop 0
    buffer_load_dwordx4 v2, s[32:35], s40 offen offset:0 lds
    s_add_u32 m0, s44, 41984
    s_nop 0
    buffer_load_dwordx4 v7, s[36:39], s41 offen offset:0 lds
    buffer_load_dwordx4 v8, s[36:39], s41 offen offset:1024 lds
    s_add_u32 m0, s43, 41984
    s_nop 0
    buffer_load_dwordx4 v3, s[32:35], s40 offen offset:1024 lds
    s_add_u32 m0, s44, 50176
    s_nop 0
    buffer_load_dwordx4 v9, s[36:39], s41 offen offset:0 lds
    buffer_load_dwordx4 v10, s[36:39], s41 offen offset:1024 lds
    s_add_u32 m0, s43, 41984
    s_nop 0
    buffer_load_dwordx4 v4, s[32:35], s40 offen offset:2048 lds
    s_add_u32 m0, s44, 58368
    s_nop 0
    buffer_load_dwordx4 v11, s[36:39], s41 offen offset:0 lds
    buffer_load_dwordx4 v12, s[36:39], s41 offen offset:1024 lds
    s_add_u32 m0, s43, 41984
    s_nop 0
    buffer_load_dwordx4 v5, s[32:35], s40 offen offset:3072 lds
    s_mov_b32 m0, 58368
    s_mov_b64 exec, s[46:47]
    buffer_load_dwordx4 v6, s[32:35], s40 offen lds
    s_mov_b64 exec, -1
    s_movk_i32 s40, 1792
    s_mov_b32 s41, 5505024
    s_load_dwordx2 s[90:91], s[16:17], s84 offset:3900
    s_load_dwordx2 s[90:91], s[16:17], s84 offset:4028
    s_waitcnt vmcnt(11)
    s_barrier
    s_add_u32 m0, s43, 83968
    s_nop 0
    buffer_load_dwordx4 v2, s[32:35], s40 offen offset:0 lds
    s_add_u32 m0, s44, 83968
    s_nop 0
    buffer_load_dwordx4 v7, s[36:39], s41 offen offset:0 lds
    buffer_load_dwordx4 v8, s[36:39], s41 offen offset:1024 lds
    s_add_u32 m0, s43, 83968
    s_nop 0
    buffer_load_dwordx4 v3, s[32:35], s40 offen offset:1024 lds
    s_add_u32 m0, s44, 92160
    s_nop 0
    buffer_load_dwordx4 v9, s[36:39], s41 offen offset:0 lds
    buffer_load_dwordx4 v10, s[36:39], s41 offen offset:1024 lds
    s_add_u32 m0, s43, 83968
    s_nop 0
    buffer_load_dwordx4 v4, s[32:35], s40 offen offset:2048 lds
    s_add_u32 m0, s44, 100352
    s_nop 0
    buffer_load_dwordx4 v11, s[36:39], s41 offen offset:0 lds
    buffer_load_dwordx4 v12, s[36:39], s41 offen offset:1024 lds
    s_add_u32 m0, s43, 83968
    s_nop 0
    buffer_load_dwordx4 v5, s[32:35], s40 offen offset:3072 lds
    s_mov_b32 m0, 100352
    s_mov_b64 exec, s[46:47]
    buffer_load_dwordx4 v6, s[32:35], s40 offen lds
    s_mov_b64 exec, -1
    s_movk_i32 s40, 1920
    s_mov_b32 s41, 5898240
    s_waitcnt vmcnt(11)
    s_barrier
    s_load_dword s4, s[28:29], 0
    s_load_dword s5, s[28:29], 64
    s_load_dword s6, s[28:29], 128
    s_load_dword s7, s[28:29], 192
    s_add_u32 m0, s43, 0
    s_nop 0
    buffer_load_dwordx4 v2, s[32:35], s40 offen offset:0 lds
    s_add_u32 m0, s44, 0
    s_nop 0
    buffer_load_dwordx4 v7, s[36:39], s41 offen offset:0 lds
    buffer_load_dwordx4 v8, s[36:39], s41 offen offset:1024 lds
    s_add_u32 m0, s43, 0
    s_nop 0
    buffer_load_dwordx4 v3, s[32:35], s40 offen offset:1024 lds
    s_add_u32 m0, s44, 8192
    s_nop 0
    buffer_load_dwordx4 v9, s[36:39], s41 offen offset:0 lds
    buffer_load_dwordx4 v10, s[36:39], s41 offen offset:1024 lds
    s_add_u32 m0, s43, 0
    s_nop 0
    buffer_load_dwordx4 v4, s[32:35], s40 offen offset:2048 lds
    s_add_u32 m0, s44, 16384
    s_nop 0
    buffer_load_dwordx4 v11, s[36:39], s41 offen offset:0 lds
    buffer_load_dwordx4 v12, s[36:39], s41 offen offset:1024 lds
    s_add_u32 m0, s43, 0
    s_nop 0
    buffer_load_dwordx4 v5, s[32:35], s40 offen offset:3072 lds
    s_mov_b32 m0, 16384
    s_mov_b64 exec, s[46:47]
    buffer_load_dwordx4 v6, s[32:35], s40 offen lds
    s_mov_b64 exec, -1
    s_movk_i32 s40, 2048
    s_mov_b32 s41, 6291456
    s_mov_b32 s60, s8
    s_mov_b32 s61, s9
    s_mov_b32 s62, 0x400000
    s_mov_b32 s63, 0x20000
    s_movk_i32 s75, 8192
    buffer_load_dwordx4 v[208:211], v225, s[60:63], 0 offen offset:0 nt
    buffer_load_dwordx4 v[212:215], v225, s[60:63], 0 offen offset:2048 nt
    buffer_load_dwordx4 v[216:219], v225, s[60:63], s75 offen offset:0 nt
    buffer_load_dwordx4 v[220:223], v225, s[60:63], s75 offen offset:2048 nt
    s_cmp_lg_u32 s70, 0
    s_cbranch_scc1 L_pc_done_39
    s_waitcnt lgkmcnt(0)
    s_min_u32 s4, s4, s5
    s_min_u32 s6, s6, s7
    s_min_u32 s4, s4, s6
    s_cmp_ge_u32 s4, 64
    s_cbranch_scc1 L_pc_done_39
    s_mov_b32 s60, s28
    s_mov_b32 s61, s29
    s_mov_b32 s62, 0x100
    s_mov_b32 s63, 0x20000
    v_lshlrev_b32 v20, 6, v0
    s_mov_b32 s74, 131072
    s_mov_b64 exec, 0xf
L_pc_loop_40:
    buffer_load_dword v21, v20, s[60:63], 0 offen sc1
    s_waitcnt vmcnt(0)
    v_cmp_gt_u32 vcc, 64, v21
    s_cbranch_vccz L_pc_done_39
    s_sleep 4
    s_sub_u32 s74, s74, 1
    s_cbranch_scc0 L_pc_loop_40
L_pc_done_39:
    s_mov_b64 exec, -1
    s_waitcnt vmcnt(15)
    s_barrier
    s_waitcnt vmcnt(4)
    s_mov_b64 exec, 1
    ds_add_u32 v227, v244 offset:24
    s_mov_b64 exec, -1
    s_add_u32 s56, s30, s85
    s_addc_u32 s57, s31, 0
    s_movk_i32 s58, 4096
    s_mov_b32 s59, 0x20000
    s_add_u32 m0, s81, 0
    s_nop 0
    buffer_load_dwordx4 v224, s[56:59], 0 offen offset:0 sc1 lds
    buffer_load_dwordx4 v224, s[56:59], 0 offen offset:1024 sc1 lds
    buffer_load_dwordx4 v224, s[56:59], 0 offen offset:2048 sc1 lds
    buffer_load_dwordx4 v224, s[56:59], 0 offen offset:3072 sc1 lds
    s_add_u32 m0, s81, 4572
    s_nop 0
    buffer_load_dwordx4 v224, s[56:59], 0 offen offset:0 sc1 lds
    buffer_load_dwordx4 v224, s[56:59], 0 offen offset:1024 sc1 lds
    buffer_load_dwordx4 v224, s[56:59], 0 offen offset:2048 sc1 lds
    buffer_load_dwordx4 v224, s[56:59], 0 offen offset:3072 sc1 lds
    s_add_u32 s56, s16, s84
    s_addc_u32 s57, s17, 0
    s_movk_i32 s58, 4096
    s_mov_b32 s59, 0x20000
    s_add_u32 m0, s80, 64
    v_mov_b32 v180, 0
    v_mov_b32 v181, 0
    v_mov_b32 v182, 0
    v_mov_b32 v183, 0
    buffer_load_dwordx4 v224, s[56:59], 0 offen offset:0 lds
    buffer_load_dwordx4 v224, s[56:59], 0 offen offset:1024 lds
    buffer_load_dwordx4 v224, s[56:59], 0 offen offset:2048 lds
    buffer_load_dwordx4 v224, s[56:59], 0 offen offset:3072 lds
    s_add_u32 m0, s80, 4304
    s_mov_b64 exec, 0x100
    buffer_load_dwordx4 v[180:183], off, s[56:59], 0
    s_mov_b64 exec, -1
    buffer_load_dwordx4 v224, s[56:59], 14 offen offset:0 lds
    buffer_load_dwordx4 v224, s[56:59], 14 offen offset:1024 lds
    buffer_load_dwordx4 v224, s[56:59], 14 offen offset:2048 lds
    buffer_load_dwordx4 v224, s[56:59], 14 offen offset:3072 lds
    v_lshrrev_b32 v234, 5, v0
    v_mul_u32_u24 v234, 4064, v234
    v_add3_u32 v234, v234, v224, s81
    s_mov_b32 exec_lo, 0xfffffff
    s_mov_b32 exec_hi, 0xfffffff
    ds_write_b128 v234, v[228:231] offset:4096
    s_mov_b64 exec, 1
    ds_write_b32 v234, v228 offset:8668
    s_mov_b64 exec, -1
    s_setprio 3
    s_waitcnt vmcnt(9)
    s_mov_b32 s60, s24
    s_mov_b32 s61, s25
    s_mov_b32 s62, 0x200000
    s_mov_b32 s63, 0x20000
    s_lshr_b32 s74, s2, 3
    s_lshl2_add_u32 s74, s74, s70
    s_bfe_u32 s75, s2, 0x10002
    s_lshl4_add_u32 s74, s74, s75
    s_lshl_b32 s74, s74, 10
    v_lshrrev_b32 v234, 3, v0
    v_and_b32 v235, 7, v0
    v_lshlrev_b32 v235, 7, v235
    v_lshl_add_u32 v234, v234, 11, v235
    buffer_load_dword v250, v234, s[60:63], s74 offen
    s_waitcnt vmcnt(1)
    v_cmp_lt_u32 vcc, 3, v0
    v_mov_b32 v188, 4160
    v_lshlrev_b32 v184, 16, v180
    v_cndmask_b32 v188, 0, v188, vcc
    v_alignbit_b32 v185, v181, v180, 16
    v_alignbit_b32 v186, v182, v181, 16
    v_alignbit_b32 v187, v183, v182, 16
    v_add3_u32 v188, v188, v224, s80
    s_mov_b64 exec, 0x1ff
    ds_write_b128 v188, v[184:187]
    s_mov_b64 exec, -1
    ds_read_b128 v[112:115], v233 offset:3584
    ds_read_b128 v[116:119], v233 offset:3072
    ds_read_b128 v[120:123], v233 offset:2560
    ds_read_b128 v[124:127], v233 offset:2048
    ds_read_b128 v[128:131], v233 offset:1536
    ds_read_b128 v[132:135], v233 offset:1024
    ds_read_b128 v[136:139], v233 offset:512
    ds_read_b128 v[140:143], v233 offset:0
    ds_read_b64 v[48:49], v232 offset:0
    ds_read_b64 v[50:51], v232 offset:8
    ds_read_b64 v[52:53], v232 offset:512
    ds_read_b64 v[54:55], v232 offset:520
    ds_read_b64 v[56:57], v232 offset:1024
    ds_read_b64 v[58:59], v232 offset:1032
    ds_read_b64 v[60:61], v232 offset:1536
    ds_read_b64 v[62:63], v232 offset:1544
    ds_read_b64 v[64:65], v232 offset:2048
    ds_read_b64 v[66:67], v232 offset:2056
    ds_read_b64 v[68:69], v232 offset:2560
    ds_read_b64 v[70:71], v232 offset:2568
    ds_read_b64 v[72:73], v232 offset:3072
    ds_read_b64 v[74:75], v232 offset:3080
    ds_read_b64 v[76:77], v232 offset:3584
    ds_read_b64 v[78:79], v232 offset:3592
    s_setprio 1
    s_mov_b32 s74, 3
    s_waitcnt lgkmcnt(14)
    v_mfma_f32_16x16x32_bf16 v[16:19], v[240:243], v[112:115], 0
    v_mfma_f32_16x16x32_bf16 v[20:23], v[240:243], v[116:119], 0
    v_mfma_f32_16x16x32_bf16 v[24:27], v[240:243], v[120:123], 0
    v_mfma_f32_16x16x32_bf16 v[28:31], v[240:243], v[124:127], 0
    v_mfma_f32_16x16x32_bf16 v[32:35], v[240:243], v[128:131], 0
    v_mfma_f32_16x16x32_bf16 v[36:39], v[240:243], v[132:135], 0
    v_mfma_f32_16x16x32_bf16 v[40:43], v[240:243], v[136:139], 0
    v_mfma_f32_16x16x32_bf16 v[44:47], v[240:243], v[140:143], 0
    s_waitcnt lgkmcnt(0)
L_conv:
    v_mfma_f32_16x16x32_bf16 v[16:19], v[48:51], v[112:115], v[16:19]
    ds_read_b128 v[144:147], v233 offset:3648
    v_mfma_f32_16x16x32_bf16 v[20:23], v[48:51], v[116:119], v[20:23]
    ds_read_b64 v[80:81], v232 offset:64
    v_mfma_f32_16x16x32_bf16 v[20:23], v[52:55], v[112:115], v[20:23]
    ds_read_b64 v[82:83], v232 offset:72
    v_mfma_f32_16x16x32_bf16 v[24:27], v[48:51], v[120:123], v[24:27]
    ds_read_b128 v[148:151], v233 offset:3136
    v_mfma_f32_16x16x32_bf16 v[24:27], v[52:55], v[116:119], v[24:27]
    ds_read_b64 v[84:85], v232 offset:576
    v_mfma_f32_16x16x32_bf16 v[24:27], v[56:59], v[112:115], v[24:27]
    ds_read_b64 v[86:87], v232 offset:584
    v_mfma_f32_16x16x32_bf16 v[28:31], v[48:51], v[124:127], v[28:31]
    ds_read_b128 v[152:155], v233 offset:2624
    v_mfma_f32_16x16x32_bf16 v[28:31], v[52:55], v[120:123], v[28:31]
    ds_read_b64 v[88:89], v232 offset:1088
    v_mfma_f32_16x16x32_bf16 v[28:31], v[56:59], v[116:119], v[28:31]
    ds_read_b64 v[90:91], v232 offset:1096
    v_mfma_f32_16x16x32_bf16 v[28:31], v[60:63], v[112:115], v[28:31]
    ds_read_b128 v[156:159], v233 offset:2112
    v_mfma_f32_16x16x32_bf16 v[32:35], v[48:51], v[128:131], v[32:35]
    ds_read_b64 v[92:93], v232 offset:1600
    v_mfma_f32_16x16x32_bf16 v[32:35], v[52:55], v[124:127], v[32:35]
    ds_read_b64 v[94:95], v232 offset:1608
    v_mfma_f32_16x16x32_bf16 v[32:35], v[56:59], v[120:123], v[32:35]
    ds_read_b128 v[160:163], v233 offset:1600
    v_mfma_f32_16x16x32_bf16 v[32:35], v[60:63], v[116:119], v[32:35]
    ds_read_b64 v[96:97], v232 offset:2112
    v_mfma_f32_16x16x32_bf16 v[32:35], v[64:67], v[112:115], v[32:35]
    ds_read_b64 v[98:99], v232 offset:2120
    v_mfma_f32_16x16x32_bf16 v[36:39], v[48:51], v[132:135], v[36:39]
    ds_read_b128 v[164:167], v233 offset:1088
    v_mfma_f32_16x16x32_bf16 v[36:39], v[52:55], v[128:131], v[36:39]
    ds_read_b64 v[100:101], v232 offset:2624
    v_mfma_f32_16x16x32_bf16 v[36:39], v[56:59], v[124:127], v[36:39]
    ds_read_b64 v[102:103], v232 offset:2632
    v_mfma_f32_16x16x32_bf16 v[36:39], v[60:63], v[120:123], v[36:39]
    ds_read_b128 v[168:171], v233 offset:576
    v_mfma_f32_16x16x32_bf16 v[36:39], v[64:67], v[116:119], v[36:39]
    ds_read_b64 v[104:105], v232 offset:3136
    v_mfma_f32_16x16x32_bf16 v[36:39], v[68:71], v[112:115], v[36:39]
    ds_read_b64 v[106:107], v232 offset:3144
    v_mfma_f32_16x16x32_bf16 v[40:43], v[48:51], v[136:139], v[40:43]
    ds_read_b128 v[172:175], v233 offset:64
    v_mfma_f32_16x16x32_bf16 v[40:43], v[52:55], v[132:135], v[40:43]
    ds_read_b64 v[108:109], v232 offset:3648
    v_mfma_f32_16x16x32_bf16 v[40:43], v[56:59], v[128:131], v[40:43]
    ds_read_b64 v[110:111], v232 offset:3656
    v_mfma_f32_16x16x32_bf16 v[40:43], v[60:63], v[124:127], v[40:43]
    v_mfma_f32_16x16x32_bf16 v[40:43], v[64:67], v[120:123], v[40:43]
    v_mfma_f32_16x16x32_bf16 v[40:43], v[68:71], v[116:119], v[40:43]
    v_mfma_f32_16x16x32_bf16 v[40:43], v[72:75], v[112:115], v[40:43]
    v_mfma_f32_16x16x32_bf16 v[44:47], v[48:51], v[140:143], v[44:47]
    v_mfma_f32_16x16x32_bf16 v[44:47], v[52:55], v[136:139], v[44:47]
    v_mfma_f32_16x16x32_bf16 v[44:47], v[56:59], v[132:135], v[44:47]
    v_mfma_f32_16x16x32_bf16 v[44:47], v[60:63], v[128:131], v[44:47]
    v_mfma_f32_16x16x32_bf16 v[44:47], v[64:67], v[124:127], v[44:47]
    v_mfma_f32_16x16x32_bf16 v[44:47], v[68:71], v[120:123], v[44:47]
    v_mfma_f32_16x16x32_bf16 v[44:47], v[72:75], v[116:119], v[44:47]
    v_mfma_f32_16x16x32_bf16 v[44:47], v[76:79], v[112:115], v[44:47]
    s_waitcnt lgkmcnt(0)
    v_mfma_f32_16x16x32_bf16 v[16:19], v[80:83], v[144:147], v[16:19]
    ds_read_b128 v[112:115], v233 offset:3712
    v_mfma_f32_16x16x32_bf16 v[20:23], v[80:83], v[148:151], v[20:23]
    ds_read_b64 v[48:49], v232 offset:128
    v_mfma_f32_16x16x32_bf16 v[20:23], v[84:87], v[144:147], v[20:23]
    ds_read_b64 v[50:51], v232 offset:136
    v_mfma_f32_16x16x32_bf16 v[24:27], v[80:83], v[152:155], v[24:27]
    ds_read_b128 v[116:119], v233 offset:3200
    v_mfma_f32_16x16x32_bf16 v[24:27], v[84:87], v[148:151], v[24:27]
    ds_read_b64 v[52:53], v232 offset:640
    v_mfma_f32_16x16x32_bf16 v[24:27], v[88:91], v[144:147], v[24:27]
    ds_read_b64 v[54:55], v232 offset:648
    v_mfma_f32_16x16x32_bf16 v[28:31], v[80:83], v[156:159], v[28:31]
    ds_read_b128 v[120:123], v233 offset:2688
    v_mfma_f32_16x16x32_bf16 v[28:31], v[84:87], v[152:155], v[28:31]
    ds_read_b64 v[56:57], v232 offset:1152
    v_mfma_f32_16x16x32_bf16 v[28:31], v[88:91], v[148:151], v[28:31]
    ds_read_b64 v[58:59], v232 offset:1160
    v_mfma_f32_16x16x32_bf16 v[28:31], v[92:95], v[144:147], v[28:31]
    ds_read_b128 v[124:127], v233 offset:2176
    v_mfma_f32_16x16x32_bf16 v[32:35], v[80:83], v[160:163], v[32:35]
    ds_read_b64 v[60:61], v232 offset:1664
    v_mfma_f32_16x16x32_bf16 v[32:35], v[84:87], v[156:159], v[32:35]
    ds_read_b64 v[62:63], v232 offset:1672
    v_mfma_f32_16x16x32_bf16 v[32:35], v[88:91], v[152:155], v[32:35]
    ds_read_b128 v[128:131], v233 offset:1664
    v_mfma_f32_16x16x32_bf16 v[32:35], v[92:95], v[148:151], v[32:35]
    ds_read_b64 v[64:65], v232 offset:2176
    v_mfma_f32_16x16x32_bf16 v[32:35], v[96:99], v[144:147], v[32:35]
    ds_read_b64 v[66:67], v232 offset:2184
    v_mfma_f32_16x16x32_bf16 v[36:39], v[80:83], v[164:167], v[36:39]
    ds_read_b128 v[132:135], v233 offset:1152
    v_mfma_f32_16x16x32_bf16 v[36:39], v[84:87], v[160:163], v[36:39]
    ds_read_b64 v[68:69], v232 offset:2688
    v_mfma_f32_16x16x32_bf16 v[36:39], v[88:91], v[156:159], v[36:39]
    ds_read_b64 v[70:71], v232 offset:2696
    v_mfma_f32_16x16x32_bf16 v[36:39], v[92:95], v[152:155], v[36:39]
    ds_read_b128 v[136:139], v233 offset:640
    v_mfma_f32_16x16x32_bf16 v[36:39], v[96:99], v[148:151], v[36:39]
    ds_read_b64 v[72:73], v232 offset:3200
    v_mfma_f32_16x16x32_bf16 v[36:39], v[100:103], v[144:147], v[36:39]
    ds_read_b64 v[74:75], v232 offset:3208
    v_mfma_f32_16x16x32_bf16 v[40:43], v[80:83], v[168:171], v[40:43]
    ds_read_b128 v[140:143], v233 offset:128
    v_mfma_f32_16x16x32_bf16 v[40:43], v[84:87], v[164:167], v[40:43]
    ds_read_b64 v[76:77], v232 offset:3712
    v_mfma_f32_16x16x32_bf16 v[40:43], v[88:91], v[160:163], v[40:43]
    ds_read_b64 v[78:79], v232 offset:3720
    v_mfma_f32_16x16x32_bf16 v[40:43], v[92:95], v[156:159], v[40:43]
    v_add_u32 v232, 128, v232
    v_mfma_f32_16x16x32_bf16 v[40:43], v[96:99], v[152:155], v[40:43]
    v_add_u32 v233, 128, v233
    v_mfma_f32_16x16x32_bf16 v[40:43], v[100:103], v[148:151], v[40:43]
    s_sub_u32 s74, s74, 1
    v_mfma_f32_16x16x32_bf16 v[40:43], v[104:107], v[144:147], v[40:43]
    s_cmp_lg_u32 s74, 0
    v_mfma_f32_16x16x32_bf16 v[44:47], v[80:83], v[172:175], v[44:47]
    v_mfma_f32_16x16x32_bf16 v[44:47], v[84:87], v[168:171], v[44:47]
    v_mfma_f32_16x16x32_bf16 v[44:47], v[88:91], v[164:167], v[44:47]
    v_mfma_f32_16x16x32_bf16 v[44:47], v[92:95], v[160:163], v[44:47]
    v_mfma_f32_16x16x32_bf16 v[44:47], v[96:99], v[156:159], v[44:47]
    v_mfma_f32_16x16x32_bf16 v[44:47], v[100:103], v[152:155], v[44:47]
    v_mfma_f32_16x16x32_bf16 v[44:47], v[104:107], v[148:151], v[44:47]
    v_mfma_f32_16x16x32_bf16 v[44:47], v[108:111], v[144:147], v[44:47]
    s_waitcnt lgkmcnt(0)
    s_cbranch_scc1 L_conv
    v_mfma_f32_16x16x32_bf16 v[16:19], v[48:51], v[112:115], v[16:19]
    ds_read_b128 v[144:147], v233 offset:3648
    ds_read_b64 v[80:81], v232 offset:64
    v_mfma_f32_16x16x32_bf16 v[20:23], v[48:51], v[116:119], v[20:23]
    ds_read_b64 v[82:83], v232 offset:72
    ds_read_b128 v[148:151], v233 offset:3136
    v_mfma_f32_16x16x32_bf16 v[20:23], v[52:55], v[112:115], v[20:23]
    ds_read_b64 v[84:85], v232 offset:576
    ds_read_b64 v[86:87], v232 offset:584
    v_mfma_f32_16x16x32_bf16 v[24:27], v[48:51], v[120:123], v[24:27]
    ds_read_b128 v[152:155], v233 offset:2624
    ds_read_b64 v[88:89], v232 offset:1088
    v_mfma_f32_16x16x32_bf16 v[24:27], v[52:55], v[116:119], v[24:27]
    ds_read_b64 v[90:91], v232 offset:1096
    ds_read_b128 v[156:159], v233 offset:2112
    v_mfma_f32_16x16x32_bf16 v[24:27], v[56:59], v[112:115], v[24:27]
    ds_read_b64 v[92:93], v232 offset:1600
    ds_read_b64 v[94:95], v232 offset:1608
    v_mfma_f32_16x16x32_bf16 v[28:31], v[48:51], v[124:127], v[28:31]
    ds_read_b128 v[160:163], v233 offset:1600
    ds_read_b64 v[96:97], v232 offset:2112
    v_mfma_f32_16x16x32_bf16 v[28:31], v[52:55], v[120:123], v[28:31]
    ds_read_b64 v[98:99], v232 offset:2120
    ds_read_b128 v[164:167], v233 offset:1088
    v_mfma_f32_16x16x32_bf16 v[28:31], v[56:59], v[116:119], v[28:31]
    ds_read_b64 v[100:101], v232 offset:2624
    ds_read_b64 v[102:103], v232 offset:2632
    v_mfma_f32_16x16x32_bf16 v[28:31], v[60:63], v[112:115], v[28:31]
    ds_read_b128 v[168:171], v233 offset:576
    ds_read_b64 v[104:105], v232 offset:3136
    v_mfma_f32_16x16x32_bf16 v[32:35], v[48:51], v[128:131], v[32:35]
    ds_read_b64 v[106:107], v232 offset:3144
    ds_read_b128 v[172:175], v233 offset:64
    v_mfma_f32_16x16x32_bf16 v[32:35], v[52:55], v[124:127], v[32:35]
    ds_read_b64 v[108:109], v232 offset:3648
    ds_read_b64 v[110:111], v232 offset:3656
    v_mfma_f32_16x16x32_bf16 v[32:35], v[56:59], v[120:123], v[32:35]
    s_mul_i32 s74, s68, 4224
    s_and_b32 s75, s71, 63
    v_mfma_f32_16x16x32_bf16 v[32:35], v[60:63], v[116:119], v[32:35]
    s_add_u32 s74, s74, s75
    s_lshl_b32 s74, s74, 6
    v_mfma_f32_16x16x32_bf16 v[32:35], v[64:67], v[112:115], v[32:35]
    v_and_b32 v234, 3, v0
    v_lshl_add_u32 v234, v234, 4, s74
    v_mfma_f32_16x16x32_bf16 v[36:39], v[48:51], v[132:135], v[36:39]
    v_and_b32 v235, 12, v0
    v_lshrrev_b32 v236, 4, v0
    v_mfma_f32_16x16x32_bf16 v[36:39], v[52:55], v[128:131], v[36:39]
    v_add_u32 v235, v235, v236
    v_mul_u32_u24 v235, 4224, v235
    v_mfma_f32_16x16x32_bf16 v[36:39], v[56:59], v[124:127], v[36:39]
    v_add_u32 v234, v234, v235
    v_mfma_f32_16x16x32_bf16 v[36:39], v[60:63], v[120:123], v[36:39]
    v_mfma_f32_16x16x32_bf16 v[36:39], v[64:67], v[116:119], v[36:39]
    v_mfma_f32_16x16x32_bf16 v[36:39], v[68:71], v[112:115], v[36:39]
    s_waitcnt lgkmcnt(0)
    s_mov_b64 exec, 1
    ds_add_u32 v227, v244 offset:36
    s_mov_b64 exec, -1
    v_mfma_f32_16x16x32_bf16 v[16:19], v[80:83], v[144:147], v[16:19]
    s_lshl4_add_u32 s73, s68, 256
    s_add_u32 s45, s73, s69
    v_mfma_f32_16x16x32_bf16 v[20:23], v[80:83], v[148:151], v[20:23]
    s_lshl_b32 s73, s73, 8
    s_lshl_b32 s45, s45, 8
    v_mfma_f32_16x16x32_bf16 v[20:23], v[84:87], v[144:147], v[20:23]
    v_mfma_f32_16x16x32_bf16 v[24:27], v[80:83], v[152:155], v[24:27]
    v_mfma_f32_16x16x32_bf16 v[24:27], v[84:87], v[148:151], v[24:27]
    v_mfma_f32_16x16x32_bf16 v[24:27], v[88:91], v[144:147], v[24:27]
    v_mfma_f32_16x16x32_bf16 v[28:31], v[80:83], v[156:159], v[28:31]
    v_cvt_pk_bf16_f32 v176, v16, v17
    v_cvt_pk_bf16_f32 v177, v18, v19
    v_mfma_f32_16x16x32_bf16 v[28:31], v[84:87], v[152:155], v[28:31]
    v_mfma_f32_16x16x32_bf16 v[28:31], v[88:91], v[148:151], v[28:31]
    v_cvt_pk_bf16_f32 v178, v20, v21
    v_cvt_pk_bf16_f32 v179, v22, v23
    v_mfma_f32_16x16x32_bf16 v[28:31], v[92:95], v[144:147], v[28:31]
    s_mov_b32 s76, 0
    buffer_store_dwordx4 v[176:179], v234, s[64:67], s76 offen sc1
    v_mfma_f32_16x16x32_bf16 v[32:35], v[80:83], v[160:163], v[32:35]
    v_cvt_pk_bf16_f32 v180, v24, v25
    v_cvt_pk_bf16_f32 v181, v26, v27
    v_mfma_f32_16x16x32_bf16 v[32:35], v[84:87], v[156:159], v[32:35]
    v_mfma_f32_16x16x32_bf16 v[32:35], v[88:91], v[152:155], v[32:35]
    v_mfma_f32_16x16x32_bf16 v[32:35], v[92:95], v[148:151], v[32:35]
    v_cvt_pk_bf16_f32 v182, v28, v29
    v_cvt_pk_bf16_f32 v183, v30, v31
    v_mfma_f32_16x16x32_bf16 v[32:35], v[96:99], v[144:147], v[32:35]
    s_mov_b32 s76, 67584
    buffer_store_dwordx4 v[180:183], v234, s[64:67], s76 offen sc1
    v_mfma_f32_16x16x32_bf16 v[36:39], v[80:83], v[164:167], v[36:39]
    v_mfma_f32_16x16x32_bf16 v[36:39], v[84:87], v[160:163], v[36:39]
    v_mfma_f32_16x16x32_bf16 v[36:39], v[88:91], v[156:159], v[36:39]
    v_mfma_f32_16x16x32_bf16 v[36:39], v[92:95], v[152:155], v[36:39]
    v_mfma_f32_16x16x32_bf16 v[36:39], v[96:99], v[148:151], v[36:39]
    v_mfma_f32_16x16x32_bf16 v[36:39], v[100:103], v[144:147], v[36:39]
    v_cvt_pk_bf16_f32 v184, v32, v33
    v_cvt_pk_bf16_f32 v185, v34, v35
    v_mfma_f32_16x16x32_bf16 v[40:43], v[48:51], v[136:139], v[40:43]
    v_mfma_f32_16x16x32_bf16 v[40:43], v[52:55], v[132:135], v[40:43]
    v_mfma_f32_16x16x32_bf16 v[40:43], v[56:59], v[128:131], v[40:43]
    v_mfma_f32_16x16x32_bf16 v[40:43], v[60:63], v[124:127], v[40:43]
    v_mfma_f32_16x16x32_bf16 v[40:43], v[64:67], v[120:123], v[40:43]
    v_mfma_f32_16x16x32_bf16 v[40:43], v[68:71], v[116:119], v[40:43]
    v_cvt_pk_bf16_f32 v186, v36, v37
    v_cvt_pk_bf16_f32 v187, v38, v39
    v_mfma_f32_16x16x32_bf16 v[40:43], v[72:75], v[112:115], v[40:43]
    s_mov_b32 s76, 135168
    buffer_store_dwordx4 v[184:187], v234, s[64:67], s76 offen sc1
    v_mfma_f32_16x16x32_bf16 v[44:47], v[48:51], v[140:143], v[44:47]
    v_mfma_f32_16x16x32_bf16 v[44:47], v[52:55], v[136:139], v[44:47]
    v_mfma_f32_16x16x32_bf16 v[44:47], v[56:59], v[132:135], v[44:47]
    v_mfma_f32_16x16x32_bf16 v[44:47], v[60:63], v[128:131], v[44:47]
    v_mfma_f32_16x16x32_bf16 v[44:47], v[64:67], v[124:127], v[44:47]
    v_mfma_f32_16x16x32_bf16 v[44:47], v[68:71], v[120:123], v[44:47]
    v_mfma_f32_16x16x32_bf16 v[44:47], v[72:75], v[116:119], v[44:47]
    v_mfma_f32_16x16x32_bf16 v[44:47], v[76:79], v[112:115], v[44:47]
    v_mfma_f32_16x16x32_bf16 v[40:43], v[80:83], v[168:171], v[40:43]
    v_mfma_f32_16x16x32_bf16 v[40:43], v[84:87], v[164:167], v[40:43]
    v_mfma_f32_16x16x32_bf16 v[40:43], v[88:91], v[160:163], v[40:43]
    v_mfma_f32_16x16x32_bf16 v[40:43], v[92:95], v[156:159], v[40:43]
    v_mfma_f32_16x16x32_bf16 v[40:43], v[96:99], v[152:155], v[40:43]
    v_mfma_f32_16x16x32_bf16 v[40:43], v[100:103], v[148:151], v[40:43]
    v_mfma_f32_16x16x32_bf16 v[40:43], v[104:107], v[144:147], v[40:43]
    v_mfma_f32_16x16x32_bf16 v[44:47], v[80:83], v[172:175], v[44:47]
    v_mfma_f32_16x16x32_bf16 v[44:47], v[84:87], v[168:171], v[44:47]
    v_mfma_f32_16x16x32_bf16 v[44:47], v[88:91], v[164:167], v[44:47]
    v_mfma_f32_16x16x32_bf16 v[44:47], v[92:95], v[160:163], v[44:47]
    v_mfma_f32_16x16x32_bf16 v[44:47], v[96:99], v[156:159], v[44:47]
    v_mfma_f32_16x16x32_bf16 v[44:47], v[100:103], v[152:155], v[44:47]
    v_mfma_f32_16x16x32_bf16 v[44:47], v[104:107], v[148:151], v[44:47]
    v_mfma_f32_16x16x32_bf16 v[44:47], v[108:111], v[144:147], v[44:47]
    v_cvt_pk_bf16_f32 v188, v40, v41
    v_cvt_pk_bf16_f32 v189, v42, v43
    s_nop 5
    v_cvt_pk_bf16_f32 v190, v44, v45
    v_cvt_pk_bf16_f32 v191, v46, v47
    s_mov_b32 s76, 202752
    buffer_store_dwordx4 v[188:191], v234, s[64:67], s76 offen sc1
    s_setprio 1
    s_waitcnt vmcnt(0)
    v_mov_b32 v238, 1
    s_mov_b64 exec, 1
    ds_add_rtn_u32 v237, v227, v238 offset:8
    s_waitcnt lgkmcnt(0)
    v_readfirstlane_b32 s76, v237
    s_nop 0
    s_cmp_eq_u32 s76, 3
    s_cbranch_scc0 L_jo_45a
    s_mov_b64 exec, 0xffff
    v_lshlrev_b32 v237, 8, v0
    buffer_atomic_add v238, v237, s[52:55], s73 offen sc1
L_jo_45a:
    s_mov_b64 exec, -1
    v_lshlrev_b32 v112, 16, v208
    v_and_b32 v113, 0xffff0000, v208
    v_lshlrev_b32 v114, 16, v209
    v_and_b32 v115, 0xffff0000, v209
    v_lshlrev_b32 v116, 16, v210
    v_and_b32 v117, 0xffff0000, v210
    v_lshlrev_b32 v118, 16, v211
    v_and_b32 v119, 0xffff0000, v211
    v_lshlrev_b32 v120, 16, v212
    v_and_b32 v121, 0xffff0000, v212
    v_lshlrev_b32 v122, 16, v213
    v_and_b32 v123, 0xffff0000, v213
    v_lshlrev_b32 v124, 16, v214
    v_and_b32 v125, 0xffff0000, v214
    v_lshlrev_b32 v126, 16, v215
    v_and_b32 v127, 0xffff0000, v215
    v_lshlrev_b32 v128, 16, v216
    v_and_b32 v129, 0xffff0000, v216
    v_lshlrev_b32 v130, 16, v217
    v_and_b32 v131, 0xffff0000, v217
    v_lshlrev_b32 v132, 16, v218
    v_and_b32 v133, 0xffff0000, v218
    v_lshlrev_b32 v134, 16, v219
    v_and_b32 v135, 0xffff0000, v219
    v_lshlrev_b32 v136, 16, v220
    v_and_b32 v137, 0xffff0000, v220
    v_lshlrev_b32 v138, 16, v221
    v_and_b32 v139, 0xffff0000, v221
    v_lshlrev_b32 v140, 16, v222
    v_and_b32 v141, 0xffff0000, v222
    v_lshlrev_b32 v142, 16, v223
    v_and_b32 v143, 0xffff0000, v223
    s_setprio 1
    s_setprio 1
    s_mul_i32 s77, s70, 4352
    s_add_u32 s77, s77, 60416
    v_lshrrev_b32 v234, 5, v0
    v_lshl_add_u32 v234, v234, 1, v0
    v_lshl_add_u32 v234, v234, 4, s77
    v_and_b32 v235, 7, v0
    v_mul_u32_u24 v235, 544, v235
    v_lshrrev_b32 v236, 3, v0
    v_lshl_add_u32 v235, v236, 3, v235
    v_add_u32 v235, s77, v235
    s_mul_i32 s77, s71, 4224
    s_mov_b32 s60, s26
    s_mov_b32 s61, s27
    s_mov_b32 s62, 0x800000
    s_mov_b32 s63, 0x20000
    s_cmp_eq_u32 s76, 3
    s_cbranch_scc0 L_jo_45
    s_mov_b32 s75, 131072
L_sg_loop_48:
    s_load_dword s74, s[52:53], s45 glc
L_sg_chk_49:
    s_waitcnt lgkmcnt(0)
    s_cmp_ge_u32 s74, 16
    s_cbranch_scc1 L_sg_done_47
    s_sub_u32 s75, s75, 1
    s_cbranch_scc0 L_sg_loop_48
L_sg_done_47:
    v_mov_b32 v237, 16
    s_mov_b64 exec, 1
    ds_add_u32 v227, v237 offset:16
    s_mov_b64 exec, -1
    s_branch L_jd_46
L_jo_45:
    s_mov_b32 s75, 1048576
L_sl_loop_51:
    ds_read_b32 v237, v227 offset:16
    s_waitcnt lgkmcnt(0)
    v_readfirstlane_b32 s74, v237
    s_nop 0
    s_cmp_ge_u32 s74, 16
    s_cbranch_scc1 L_sl_done_50
    s_sleep 1
    s_sub_u32 s75, s75, 1
    s_cbranch_scc0 L_sl_loop_51
L_sl_done_50:
L_jd_46:
    buffer_load_dwordx4 v[48:51], v224, s[64:67], s77 offen offset:0 sc1
    buffer_load_dwordx4 v[52:55], v224, s[64:67], s77 offen offset:1024 sc1
    buffer_load_dwordx4 v[56:59], v224, s[64:67], s77 offen offset:2048 sc1
    buffer_load_dwordx4 v[60:63], v224, s[64:67], s77 offen offset:3072 sc1
    s_waitcnt vmcnt(3)
    ds_write_b128 v234, v[48:51] offset:0
    s_waitcnt vmcnt(2)
    ds_write_b128 v234, v[52:55] offset:1088
    s_waitcnt vmcnt(1)
    ds_write_b128 v234, v[56:59] offset:2176
    s_waitcnt vmcnt(0)
    ds_write_b128 v234, v[60:63] offset:3264
    ds_read_b64 v[64:65], v235 offset:0
    ds_read_b64 v[66:67], v235 offset:64
    ds_read_b64 v[68:69], v235 offset:128
    ds_read_b64 v[70:71], v235 offset:192
    ds_read_b64 v[72:73], v235 offset:256
    ds_read_b64 v[74:75], v235 offset:320
    ds_read_b64 v[76:77], v235 offset:384
    ds_read_b64 v[78:79], v235 offset:448
    s_waitcnt lgkmcnt(7)
    v_lshlrev_b32 v16, 16, v64
    v_and_b32 v24, 0xffff0000, v64
    v_lshlrev_b32 v32, 16, v65
    v_and_b32 v40, 0xffff0000, v65
    s_waitcnt lgkmcnt(6)
    v_lshlrev_b32 v17, 16, v66
    v_and_b32 v25, 0xffff0000, v66
    v_lshlrev_b32 v33, 16, v67
    v_and_b32 v41, 0xffff0000, v67
    s_waitcnt lgkmcnt(5)
    v_lshlrev_b32 v18, 16, v68
    v_and_b32 v26, 0xffff0000, v68
    v_lshlrev_b32 v34, 16, v69
    v_and_b32 v42, 0xffff0000, v69
    s_waitcnt lgkmcnt(4)
    v_lshlrev_b32 v19, 16, v70
    v_and_b32 v27, 0xffff0000, v70
    v_lshlrev_b32 v35, 16, v71
    v_and_b32 v43, 0xffff0000, v71
    s_waitcnt lgkmcnt(3)
    v_lshlrev_b32 v20, 16, v72
    v_and_b32 v28, 0xffff0000, v72
    v_lshlrev_b32 v36, 16, v73
    v_and_b32 v44, 0xffff0000, v73
    s_waitcnt lgkmcnt(2)
    v_lshlrev_b32 v21, 16, v74
    v_and_b32 v29, 0xffff0000, v74
    v_lshlrev_b32 v37, 16, v75
    v_and_b32 v45, 0xffff0000, v75
    s_waitcnt lgkmcnt(1)
    v_lshlrev_b32 v22, 16, v76
    v_and_b32 v30, 0xffff0000, v76
    v_lshlrev_b32 v38, 16, v77
    v_and_b32 v46, 0xffff0000, v77
    s_waitcnt lgkmcnt(0)
    v_lshlrev_b32 v23, 16, v78
    v_and_b32 v31, 0xffff0000, v78
    v_lshlrev_b32 v39, 16, v79
    v_and_b32 v47, 0xffff0000, v79
    v_mul_f32 v16, v16, v112
    v_mul_f32 v17, v17, v113
    v_mul_f32 v18, v18, v114
    v_mul_f32 v19, v19, v115
    v_mul_f32 v20, v20, v116
    v_mul_f32 v21, v21, v117
    v_mul_f32 v22, v22, v118
    v_mul_f32 v23, v23, v119
    v_cvt_pk_bf16_f32 v48, v16, v17
    v_cvt_pk_bf16_f32 v49, v18, v19
    v_cvt_pk_bf16_f32 v50, v20, v21
    v_cvt_pk_bf16_f32 v51, v22, v23
    s_mov_b32 s74, 0
    buffer_store_dwordx4 v[48:51], v226, s[60:63], s74 offen nt
    v_mul_f32 v24, v24, v120
    v_mul_f32 v25, v25, v121
    v_mul_f32 v26, v26, v122
    v_mul_f32 v27, v27, v123
    v_mul_f32 v28, v28, v124
    v_mul_f32 v29, v29, v125
    v_mul_f32 v30, v30, v126
    v_mul_f32 v31, v31, v127
    v_cvt_pk_bf16_f32 v52, v24, v25
    v_cvt_pk_bf16_f32 v53, v26, v27
    v_cvt_pk_bf16_f32 v54, v28, v29
    v_cvt_pk_bf16_f32 v55, v30, v31
    s_mov_b32 s74, 4096
    buffer_store_dwordx4 v[52:55], v226, s[60:63], s74 offen nt
    v_mul_f32 v32, v32, v128
    v_mul_f32 v33, v33, v129
    v_mul_f32 v34, v34, v130
    v_mul_f32 v35, v35, v131
    v_mul_f32 v36, v36, v132
    v_mul_f32 v37, v37, v133
    v_mul_f32 v38, v38, v134
    v_mul_f32 v39, v39, v135
    v_cvt_pk_bf16_f32 v56, v32, v33
    v_cvt_pk_bf16_f32 v57, v34, v35
    v_cvt_pk_bf16_f32 v58, v36, v37
    v_cvt_pk_bf16_f32 v59, v38, v39
    s_mov_b32 s74, 16384
    buffer_store_dwordx4 v[56:59], v226, s[60:63], s74 offen nt
    v_mul_f32 v40, v40, v136
    v_mul_f32 v41, v41, v137
    v_mul_f32 v42, v42, v138
    v_mul_f32 v43, v43, v139
    v_mul_f32 v44, v44, v140
    v_mul_f32 v45, v45, v141
    v_mul_f32 v46, v46, v142
    v_mul_f32 v47, v47, v143
    v_cvt_pk_bf16_f32 v60, v40, v41
    v_cvt_pk_bf16_f32 v61, v42, v43
    v_cvt_pk_bf16_f32 v62, v44, v45
    v_cvt_pk_bf16_f32 v63, v46, v47
    s_mov_b32 s74, 20480
    buffer_store_dwordx4 v[60:63], v226, s[60:63], s74 offen nt
    s_endpgm
L_grole:
    s_setprio 2
    s_add_u32 s52, s30, 0xe00000
    s_addc_u32 s53, s31, 0
    s_mov_b32 s54, 0x20000
    s_mov_b32 s55, 0x20000
    s_lshr_b32 s32, s3, 1
    s_and_b32 s33, s3, 1
    v_and_b32 v1, 15, v0
    v_lshrrev_b32 v2, 4, v0
    v_lshrrev_b32 v3, 1, v1
    v_xor_b32 v3, v2, v3
    v_lshlrev_b32 v3, 4, v3
    v_lshl_add_u32 v3, v1, 7, v3
    s_lshl_b32 s37, s33, 13
    v_add_u32 v196, s37, v3
    v_xor_b32 v197, 64, v196
    v_and_b32 v198, 7, v1
    v_lshlrev_b32 v3, 1, v2
    v_xor_b32 v3, v3, v198
    v_lshlrev_b32 v3, 4, v3
    v_lshl_add_u32 v3, v198, 7, v3
    v_lshrrev_b32 v202, 3, v1
    v_lshl_add_u32 v3, v202, 2, v3
    v_add_u32 v198, 16384, v3
    v_xor_b32 v199, 16, v198
    v_mul_u32_u24 v202, 0xaaaa, v202
    v_add_u32 v202, 0x4444, v202
    v_bfe_u32 v3, v0, 2, 2
    v_lshl_add_u32 v200, v2, 3, v3
    v_lshlrev_b32 v200, 7, v200
    v_bfe_u32 v3, v0, 3, 2
    v_xor_b32 v3, s3, v3
    v_lshl_add_u32 v200, v3, 5, v200
    v_and_b32 v3, 3, v0
    v_lshl_add_u32 v200, v3, 3, v200
    v_add_u32 v200, 17408, v200
    v_xor_b32 v201, 32, v200
    s_mov_b32 s34, 0
    v_mov_b32 v228, 134352
    v_and_b32 v1, 15, v0
    v_lshrrev_b32 v2, 4, v0
    v_lshlrev_b32 v2, 2, v2
    v_sub_u32 v1, v1, v2
    s_mov_b32 s37, 0xf149f2ca
    v_mov_b32 v3, s37
    s_or_b32 s38, s5, s33
    s_cmp_eq_u32 s38, 0
    s_cselect_b32 s38, s37, 0
    v_subrev_u32 v2, 0, v1
    v_cmp_gt_u32 vcc, 8, v2
    v_cmp_gt_i32 s[64:65], -8, v2
    v_ashrrev_i32 v2, 31, v2
    v_cndmask_b32 v204, v3, 0, vcc
    v_cndmask_b32 v208, v3, 0, s[64:65]
    v_mov_b32 v216, v2
    v_min_f32 v212, s38, v208
    v_subrev_u32 v2, 1, v1
    v_cmp_gt_u32 vcc, 8, v2
    v_cmp_gt_i32 s[64:65], -8, v2
    v_ashrrev_i32 v2, 31, v2
    v_cndmask_b32 v205, v3, 0, vcc
    v_cndmask_b32 v209, v3, 0, s[64:65]
    v_alignbit_b32 v216, v2, v216, 16
    v_min_f32 v213, s38, v209
    v_subrev_u32 v2, 2, v1
    v_cmp_gt_u32 vcc, 8, v2
    v_cmp_gt_i32 s[64:65], -8, v2
    v_ashrrev_i32 v2, 31, v2
    v_cndmask_b32 v206, v3, 0, vcc
    v_cndmask_b32 v210, v3, 0, s[64:65]
    v_mov_b32 v217, v2
    v_min_f32 v214, s38, v210
    v_subrev_u32 v2, 3, v1
    v_cmp_gt_u32 vcc, 8, v2
    v_cmp_gt_i32 s[64:65], -8, v2
    v_ashrrev_i32 v2, 31, v2
    v_cndmask_b32 v207, v3, 0, vcc
    v_cndmask_b32 v211, v3, 0, s[64:65]
    v_alignbit_b32 v217, v2, v217, 16
    v_min_f32 v215, s38, v211
    s_mul_i32 s37, s32, 80896
    s_add_u32 s37, s37, 78848
    v_lshl_add_u32 v220, v0, 3, s37
    s_lshl_b32 s38, s33, 9
    v_add_u32 v219, s38, v220
    s_add_u32 s38, s38, s37
    v_and_b32 v1, 3, v0
    v_lshl_add_u32 v1, v1, 1, s38
    v_bfe_u32 v2, v0, 2, 2
    v_lshl_add_u32 v1, v2, 7, v1
    v_lshrrev_b32 v2, 4, v0
    v_xor_b32 v2, 2, v2
    v_lshl_add_u32 v203, v2, 5, v1
    s_mul_i32 s38, s33, 2560
    v_add_u32 v221, s38, v220
    v_xor_b32 v222, 512, v221
    s_lshl3_add_u32 s37, s4, s5
    s_lshl1_add_u32 s37, s37, s33
    s_lshl_b32 s37, s37, 7
    s_lshl1_add_u32 s38, s6, s32
    s_add_u32 s37, s37, s38
    s_lshl_b32 s37, s37, 10
    v_lshl_add_u32 v218, v0, 4, s37
    s_mov_b32 s40, s30
    s_mov_b32 s41, s31
    s_mov_b32 s42, 0x400000
    s_mov_b32 s43, 0x20000
    s_and_b32 s58, s2, 3
    s_bfe_u32 s37, s2, 0x20003
    s_lshl2_add_u32 s58, s58, s37
    s_bfe_u32 s59, s2, 0x10002
    s_lshr_b32 s37, s2, 5
    s_lshl3_add_u32 s59, s59, s37
    s_mov_b32 s44, s24
    s_mov_b32 s45, s25
    s_mov_b32 s46, 0x200000
    s_mov_b32 s47, 0x20000
    s_mov_b32 s48, s26
    s_mov_b32 s49, s27
    s_mov_b32 s50, 0x800000
    s_mov_b32 s51, 0x20000
    s_lshl3_add_u32 s56, s4, s5
    s_lshl4_add_u32 s56, s56, 0
    s_lshl_b32 s56, s56, 8
    s_lshl4_add_u32 s57, s58, 0
    s_add_u32 s57, s57, s59
    s_lshl_b32 s57, s57, 8
    s_lshl2_add_u32 s37, s58, s3
    s_lshl_b32 s38, s37, 16
    v_lshl_add_u32 v224, v0, 4, s38
    v_add_u32 v225, 0x8000, v224
    s_and_b32 s37, s37, 31
    s_lshl_b32 s37, s37, 6
    s_lshr_b32 s38, s58, 3
    s_add_u32 s37, s37, s38
    s_lshl_b32 s37, s37, 5
    s_add_u32 s37, s37, s59
    s_add_u32 s37, s37, 16
    s_lshl_b32 s37, s37, 7
    v_lshrrev_b32 v1, 3, v0
    v_lshl_add_u32 v1, v1, 13, s37
    v_and_b32 v2, 7, v0
    v_lshl_add_u32 v226, v2, 4, v1
    v_lshrrev_b32 v1, 4, v0
    v_lshlrev_b32 v1, 1, v1
    v_xor_b32 v1, v0, v1
    v_and_b32 v1, 7, v1
    s_lshl_b32 s37, s59, 7
    v_lshl_add_u32 v1, v1, 4, s37
    v_lshrrev_b32 v227, 3, v0
    v_lshl_add_u32 v227, v227, 11, v1
    v_add_u32 v223, 15360, v227
    s_lshl_b32 s60, s3, 11
    s_mul_i32 s61, s59, 0
    s_and_b32 s61, s61, 7
    s_lshl3_add_u32 s62, s61, s3
    s_lshl_b32 s62, s62, 15
    v_lshrrev_b32 v1, 2, v0
    v_lshlrev_b32 v1, 7, v1
    v_bfe_u32 v2, v0, 3, 2
    v_lshl_add_u32 v1, v2, 5, v1
    v_and_b32 v2, 3, v0
    v_lshl_add_u32 v229, v2, 3, v1
    s_bitcmp0_b32 s2, 7
    s_cbranch_scc1 L_nopre
    s_add_u32 s87, s86, 159744
    v_and_b32 v247, 7, v0
    v_lshl_add_u32 v246, v247, 6, s87
    s_mul_i32 s86, s3, 8448
    s_add_u32 s86, s86, 125952
    s_mul_i32 s87, s84, 2112
    s_sub_u32 s87, s87, s85
    s_lshl_b32 s87, s87, 7
    s_add_u32 s87, s87, 3968
    v_lshl_add_u32 v249, v247, 4, s87
    v_lshrrev_b32 v248, 3, v0
    v_mul_u32_u24 v250, 4224, v248
    v_add_u32 v249, v249, v250
    v_mul_u32_u24 v247, 1040, v247
    v_xor_b32 v248, 7, v248
    v_lshl_add_u32 v247, v248, 4, v247
    v_add_u32 v247, s86, v247
    v_add_u32 v248, s86, v191
    s_add_u32 s80, s30, 0x400000
    s_addc_u32 s81, s31, 0
    s_mov_b32 s82, 0x420000
    s_mov_b32 s83, 0x20000
    s_waitcnt vmcnt(19)
    ds_read_b128 v[230:233], v246 offset:0
    ds_read_b128 v[234:237], v246 offset:16
    ds_read_b128 v[238:241], v246 offset:32
    ds_read_b128 v[242:245], v246 offset:48
    s_waitcnt lgkmcnt(3)
    v_lshlrev_b32 v68, 16, v230
    v_and_b32 v70, 0xffff0000, v230
    v_lshlrev_b32 v72, 16, v231
    v_and_b32 v74, 0xffff0000, v231
    v_lshlrev_b32 v69, 16, v232
    v_and_b32 v71, 0xffff0000, v232
    v_lshlrev_b32 v73, 16, v233
    v_and_b32 v75, 0xffff0000, v233
    s_waitcnt lgkmcnt(2)
    v_lshlrev_b32 v76, 16, v234
    v_and_b32 v78, 0xffff0000, v234
    v_lshlrev_b32 v80, 16, v235
    v_and_b32 v82, 0xffff0000, v235
    v_lshlrev_b32 v77, 16, v236
    v_and_b32 v79, 0xffff0000, v236
    v_lshlrev_b32 v81, 16, v237
    v_and_b32 v83, 0xffff0000, v237
    s_waitcnt lgkmcnt(1)
    v_lshlrev_b32 v84, 16, v238
    v_and_b32 v86, 0xffff0000, v238
    v_lshlrev_b32 v88, 16, v239
    v_and_b32 v90, 0xffff0000, v239
    v_lshlrev_b32 v85, 16, v240
    v_and_b32 v87, 0xffff0000, v240
    v_lshlrev_b32 v89, 16, v241
    v_and_b32 v91, 0xffff0000, v241
    s_waitcnt lgkmcnt(0)
    v_lshlrev_b32 v92, 16, v242
    v_and_b32 v94, 0xffff0000, v242
    v_lshlrev_b32 v96, 16, v243
    v_and_b32 v98, 0xffff0000, v243
    v_lshlrev_b32 v93, 16, v244
    v_and_b32 v95, 0xffff0000, v244
    v_lshlrev_b32 v97, 16, v245
    v_and_b32 v99, 0xffff0000, v245
    s_waitcnt vmcnt(18)
    v_lshlrev_b32 v100, 16, v108
    v_and_b32 v101, 0xffff0000, v108
    v_lshlrev_b32 v102, 16, v109
    v_and_b32 v103, 0xffff0000, v109
    v_lshlrev_b32 v104, 16, v110
    v_and_b32 v105, 0xffff0000, v110
    v_lshlrev_b32 v106, 16, v111
    v_and_b32 v107, 0xffff0000, v111
    v_pk_mul_f32 v[4:5], v[100:101], v[74:75]
    v_pk_mul_f32 v[20:21], v[102:103], v[82:83]
    v_pk_mul_f32 v[36:37], v[104:105], v[90:91]
    v_pk_mul_f32 v[52:53], v[106:107], v[98:99]
    s_waitcnt vmcnt(17)
    v_lshlrev_b32 v100, 16, v112
    v_and_b32 v101, 0xffff0000, v112
    v_lshlrev_b32 v102, 16, v113
    v_and_b32 v103, 0xffff0000, v113
    v_lshlrev_b32 v104, 16, v114
    v_and_b32 v105, 0xffff0000, v114
    v_lshlrev_b32 v106, 16, v115
    v_and_b32 v107, 0xffff0000, v115
    v_pk_fma_f32 v[4:5], v[100:101], v[72:73], v[4:5]
    v_pk_fma_f32 v[20:21], v[102:103], v[80:81], v[20:21]
    v_pk_fma_f32 v[36:37], v[104:105], v[88:89], v[36:37]
    v_pk_fma_f32 v[52:53], v[106:107], v[96:97], v[52:53]
    v_pk_mul_f32 v[6:7], v[100:101], v[74:75]
    v_pk_mul_f32 v[22:23], v[102:103], v[82:83]
    v_pk_mul_f32 v[38:39], v[104:105], v[90:91]
    v_pk_mul_f32 v[54:55], v[106:107], v[98:99]
    s_waitcnt vmcnt(16)
    v_lshlrev_b32 v100, 16, v116
    v_and_b32 v101, 0xffff0000, v116
    v_lshlrev_b32 v102, 16, v117
    v_and_b32 v103, 0xffff0000, v117
    v_lshlrev_b32 v104, 16, v118
    v_and_b32 v105, 0xffff0000, v118
    v_lshlrev_b32 v106, 16, v119
    v_and_b32 v107, 0xffff0000, v119
    v_pk_fma_f32 v[4:5], v[100:101], v[70:71], v[4:5]
    v_pk_fma_f32 v[20:21], v[102:103], v[78:79], v[20:21]
    v_pk_fma_f32 v[36:37], v[104:105], v[86:87], v[36:37]
    v_pk_fma_f32 v[52:53], v[106:107], v[94:95], v[52:53]
    v_pk_fma_f32 v[6:7], v[100:101], v[72:73], v[6:7]
    v_pk_fma_f32 v[22:23], v[102:103], v[80:81], v[22:23]
    v_pk_fma_f32 v[38:39], v[104:105], v[88:89], v[38:39]
    v_pk_fma_f32 v[54:55], v[106:107], v[96:97], v[54:55]
    v_pk_mul_f32 v[8:9], v[100:101], v[74:75]
    v_pk_mul_f32 v[24:25], v[102:103], v[82:83]
    v_pk_mul_f32 v[40:41], v[104:105], v[90:91]
    v_pk_mul_f32 v[56:57], v[106:107], v[98:99]
    s_waitcnt vmcnt(15)
    v_lshlrev_b32 v100, 16, v120
    v_and_b32 v101, 0xffff0000, v120
    v_lshlrev_b32 v102, 16, v121
    v_and_b32 v103, 0xffff0000, v121
    v_lshlrev_b32 v104, 16, v122
    v_and_b32 v105, 0xffff0000, v122
    v_lshlrev_b32 v106, 16, v123
    v_and_b32 v107, 0xffff0000, v123
    v_pk_fma_f32 v[4:5], v[100:101], v[68:69], v[4:5]
    v_pk_fma_f32 v[20:21], v[102:103], v[76:77], v[20:21]
    v_pk_fma_f32 v[36:37], v[104:105], v[84:85], v[36:37]
    v_pk_fma_f32 v[52:53], v[106:107], v[92:93], v[52:53]
    v_pk_fma_f32 v[6:7], v[100:101], v[70:71], v[6:7]
    v_pk_fma_f32 v[22:23], v[102:103], v[78:79], v[22:23]
    v_pk_fma_f32 v[38:39], v[104:105], v[86:87], v[38:39]
    v_pk_fma_f32 v[54:55], v[106:107], v[94:95], v[54:55]
    v_pk_fma_f32 v[8:9], v[100:101], v[72:73], v[8:9]
    v_pk_fma_f32 v[24:25], v[102:103], v[80:81], v[24:25]
    v_pk_fma_f32 v[40:41], v[104:105], v[88:89], v[40:41]
    v_pk_fma_f32 v[56:57], v[106:107], v[96:97], v[56:57]
    v_pk_mul_f32 v[10:11], v[100:101], v[74:75]
    v_pk_mul_f32 v[26:27], v[102:103], v[82:83]
    v_pk_mul_f32 v[42:43], v[104:105], v[90:91]
    v_pk_mul_f32 v[58:59], v[106:107], v[98:99]
    s_waitcnt vmcnt(14)
    v_lshlrev_b32 v100, 16, v124
    v_and_b32 v101, 0xffff0000, v124
    v_lshlrev_b32 v102, 16, v125
    v_and_b32 v103, 0xffff0000, v125
    v_lshlrev_b32 v104, 16, v126
    v_and_b32 v105, 0xffff0000, v126
    v_lshlrev_b32 v106, 16, v127
    v_and_b32 v107, 0xffff0000, v127
    v_pk_fma_f32 v[6:7], v[100:101], v[68:69], v[6:7]
    v_pk_fma_f32 v[22:23], v[102:103], v[76:77], v[22:23]
    v_pk_fma_f32 v[38:39], v[104:105], v[84:85], v[38:39]
    v_pk_fma_f32 v[54:55], v[106:107], v[92:93], v[54:55]
    v_pk_fma_f32 v[8:9], v[100:101], v[70:71], v[8:9]
    v_pk_fma_f32 v[24:25], v[102:103], v[78:79], v[24:25]
    v_pk_fma_f32 v[40:41], v[104:105], v[86:87], v[40:41]
    v_pk_fma_f32 v[56:57], v[106:107], v[94:95], v[56:57]
    v_pk_fma_f32 v[10:11], v[100:101], v[72:73], v[10:11]
    v_pk_fma_f32 v[26:27], v[102:103], v[80:81], v[26:27]
    v_pk_fma_f32 v[42:43], v[104:105], v[88:89], v[42:43]
    v_pk_fma_f32 v[58:59], v[106:107], v[96:97], v[58:59]
    v_pk_mul_f32 v[12:13], v[100:101], v[74:75]
    v_pk_mul_f32 v[28:29], v[102:103], v[82:83]
    v_pk_mul_f32 v[44:45], v[104:105], v[90:91]
    v_pk_mul_f32 v[60:61], v[106:107], v[98:99]
    s_waitcnt vmcnt(13)
    v_lshlrev_b32 v100, 16, v128
    v_and_b32 v101, 0xffff0000, v128
    v_lshlrev_b32 v102, 16, v129
    v_and_b32 v103, 0xffff0000, v129
    v_lshlrev_b32 v104, 16, v130
    v_and_b32 v105, 0xffff0000, v130
    v_lshlrev_b32 v106, 16, v131
    v_and_b32 v107, 0xffff0000, v131
    v_pk_fma_f32 v[8:9], v[100:101], v[68:69], v[8:9]
    v_pk_fma_f32 v[24:25], v[102:103], v[76:77], v[24:25]
    v_pk_fma_f32 v[40:41], v[104:105], v[84:85], v[40:41]
    v_pk_fma_f32 v[56:57], v[106:107], v[92:93], v[56:57]
    v_pk_fma_f32 v[10:11], v[100:101], v[70:71], v[10:11]
    v_pk_fma_f32 v[26:27], v[102:103], v[78:79], v[26:27]
    v_pk_fma_f32 v[42:43], v[104:105], v[86:87], v[42:43]
    v_pk_fma_f32 v[58:59], v[106:107], v[94:95], v[58:59]
    v_pk_fma_f32 v[12:13], v[100:101], v[72:73], v[12:13]
    v_pk_fma_f32 v[28:29], v[102:103], v[80:81], v[28:29]
    v_pk_fma_f32 v[44:45], v[104:105], v[88:89], v[44:45]
    v_pk_fma_f32 v[60:61], v[106:107], v[96:97], v[60:61]
    v_pk_mul_f32 v[14:15], v[100:101], v[74:75]
    v_pk_mul_f32 v[30:31], v[102:103], v[82:83]
    v_pk_mul_f32 v[46:47], v[104:105], v[90:91]
    v_pk_mul_f32 v[62:63], v[106:107], v[98:99]
    s_waitcnt vmcnt(12)
    v_lshlrev_b32 v100, 16, v132
    v_and_b32 v101, 0xffff0000, v132
    v_lshlrev_b32 v102, 16, v133
    v_and_b32 v103, 0xffff0000, v133
    v_lshlrev_b32 v104, 16, v134
    v_and_b32 v105, 0xffff0000, v134
    v_lshlrev_b32 v106, 16, v135
    v_and_b32 v107, 0xffff0000, v135
    v_pk_fma_f32 v[10:11], v[100:101], v[68:69], v[10:11]
    v_pk_fma_f32 v[26:27], v[102:103], v[76:77], v[26:27]
    v_pk_fma_f32 v[42:43], v[104:105], v[84:85], v[42:43]
    v_pk_fma_f32 v[58:59], v[106:107], v[92:93], v[58:59]
    v_pk_fma_f32 v[12:13], v[100:101], v[70:71], v[12:13]
    v_pk_fma_f32 v[28:29], v[102:103], v[78:79], v[28:29]
    v_pk_fma_f32 v[44:45], v[104:105], v[86:87], v[44:45]
    v_pk_fma_f32 v[60:61], v[106:107], v[94:95], v[60:61]
    v_pk_fma_f32 v[14:15], v[100:101], v[72:73], v[14:15]
    v_pk_fma_f32 v[30:31], v[102:103], v[80:81], v[30:31]
    v_pk_fma_f32 v[46:47], v[104:105], v[88:89], v[46:47]
    v_pk_fma_f32 v[62:63], v[106:107], v[96:97], v[62:63]
    v_pk_mul_f32 v[16:17], v[100:101], v[74:75]
    v_pk_mul_f32 v[32:33], v[102:103], v[82:83]
    v_pk_mul_f32 v[48:49], v[104:105], v[90:91]
    v_pk_mul_f32 v[64:65], v[106:107], v[98:99]
    s_waitcnt vmcnt(11)
    v_lshlrev_b32 v100, 16, v136
    v_and_b32 v101, 0xffff0000, v136
    v_lshlrev_b32 v102, 16, v137
    v_and_b32 v103, 0xffff0000, v137
    v_lshlrev_b32 v104, 16, v138
    v_and_b32 v105, 0xffff0000, v138
    v_lshlrev_b32 v106, 16, v139
    v_and_b32 v107, 0xffff0000, v139
    v_pk_fma_f32 v[12:13], v[100:101], v[68:69], v[12:13]
    v_pk_fma_f32 v[28:29], v[102:103], v[76:77], v[28:29]
    v_pk_fma_f32 v[44:45], v[104:105], v[84:85], v[44:45]
    v_pk_fma_f32 v[60:61], v[106:107], v[92:93], v[60:61]
    v_pk_fma_f32 v[14:15], v[100:101], v[70:71], v[14:15]
    v_pk_fma_f32 v[30:31], v[102:103], v[78:79], v[30:31]
    v_pk_fma_f32 v[46:47], v[104:105], v[86:87], v[46:47]
    v_pk_fma_f32 v[62:63], v[106:107], v[94:95], v[62:63]
    v_pk_fma_f32 v[16:17], v[100:101], v[72:73], v[16:17]
    v_pk_fma_f32 v[32:33], v[102:103], v[80:81], v[32:33]
    v_pk_fma_f32 v[48:49], v[104:105], v[88:89], v[48:49]
    v_pk_fma_f32 v[64:65], v[106:107], v[96:97], v[64:65]
    v_pk_mul_f32 v[18:19], v[100:101], v[74:75]
    v_pk_mul_f32 v[34:35], v[102:103], v[82:83]
    v_pk_mul_f32 v[50:51], v[104:105], v[90:91]
    v_pk_mul_f32 v[66:67], v[106:107], v[98:99]
    s_waitcnt vmcnt(10)
    v_lshlrev_b32 v100, 16, v140
    v_and_b32 v101, 0xffff0000, v140
    v_lshlrev_b32 v102, 16, v141
    v_and_b32 v103, 0xffff0000, v141
    v_lshlrev_b32 v104, 16, v142
    v_and_b32 v105, 0xffff0000, v142
    v_lshlrev_b32 v106, 16, v143
    v_and_b32 v107, 0xffff0000, v143
    v_pk_fma_f32 v[14:15], v[100:101], v[68:69], v[14:15]
    v_pk_fma_f32 v[30:31], v[102:103], v[76:77], v[30:31]
    v_pk_fma_f32 v[46:47], v[104:105], v[84:85], v[46:47]
    v_pk_fma_f32 v[62:63], v[106:107], v[92:93], v[62:63]
    v_pk_fma_f32 v[16:17], v[100:101], v[70:71], v[16:17]
    v_pk_fma_f32 v[32:33], v[102:103], v[78:79], v[32:33]
    v_pk_fma_f32 v[48:49], v[104:105], v[86:87], v[48:49]
    v_pk_fma_f32 v[64:65], v[106:107], v[94:95], v[64:65]
    v_pk_fma_f32 v[18:19], v[100:101], v[72:73], v[18:19]
    v_pk_fma_f32 v[34:35], v[102:103], v[80:81], v[34:35]
    v_pk_fma_f32 v[50:51], v[104:105], v[88:89], v[50:51]
    v_pk_fma_f32 v[66:67], v[106:107], v[96:97], v[66:67]
    s_waitcnt vmcnt(9)
    v_lshlrev_b32 v100, 16, v144
    v_and_b32 v101, 0xffff0000, v144
    v_lshlrev_b32 v102, 16, v145
    v_and_b32 v103, 0xffff0000, v145
    v_lshlrev_b32 v104, 16, v146
    v_and_b32 v105, 0xffff0000, v146
    v_lshlrev_b32 v106, 16, v147
    v_and_b32 v107, 0xffff0000, v147
    v_pk_fma_f32 v[16:17], v[100:101], v[68:69], v[16:17]
    v_pk_fma_f32 v[32:33], v[102:103], v[76:77], v[32:33]
    v_pk_fma_f32 v[48:49], v[104:105], v[84:85], v[48:49]
    v_pk_fma_f32 v[64:65], v[106:107], v[92:93], v[64:65]
    v_pk_fma_f32 v[18:19], v[100:101], v[70:71], v[18:19]
    v_pk_fma_f32 v[34:35], v[102:103], v[78:79], v[34:35]
    v_pk_fma_f32 v[50:51], v[104:105], v[86:87], v[50:51]
    v_pk_fma_f32 v[66:67], v[106:107], v[94:95], v[66:67]
    s_waitcnt vmcnt(8)
    v_lshlrev_b32 v100, 16, v148
    v_and_b32 v101, 0xffff0000, v148
    v_lshlrev_b32 v102, 16, v149
    v_and_b32 v103, 0xffff0000, v149
    v_lshlrev_b32 v104, 16, v150
    v_and_b32 v105, 0xffff0000, v150
    v_lshlrev_b32 v106, 16, v151
    v_and_b32 v107, 0xffff0000, v151
    v_pk_fma_f32 v[18:19], v[100:101], v[68:69], v[18:19]
    v_pk_fma_f32 v[34:35], v[102:103], v[76:77], v[34:35]
    v_pk_fma_f32 v[50:51], v[104:105], v[84:85], v[50:51]
    v_pk_fma_f32 v[66:67], v[106:107], v[92:93], v[66:67]
    s_waitcnt vmcnt(7)
    v_lshlrev_b32 v100, 16, v152
    v_and_b32 v101, 0xffff0000, v152
    v_lshlrev_b32 v102, 16, v153
    v_and_b32 v103, 0xffff0000, v153
    v_lshlrev_b32 v104, 16, v154
    v_and_b32 v105, 0xffff0000, v154
    v_lshlrev_b32 v106, 16, v155
    v_and_b32 v107, 0xffff0000, v155
    v_pk_mul_f32 v[4:5], v[4:5], v[100:101]
    v_pk_mul_f32 v[20:21], v[20:21], v[102:103]
    v_pk_mul_f32 v[36:37], v[36:37], v[104:105]
    v_pk_mul_f32 v[52:53], v[52:53], v[106:107]
    s_waitcnt vmcnt(6)
    v_lshlrev_b32 v100, 16, v156
    v_and_b32 v101, 0xffff0000, v156
    v_lshlrev_b32 v102, 16, v157
    v_and_b32 v103, 0xffff0000, v157
    v_lshlrev_b32 v104, 16, v158
    v_and_b32 v105, 0xffff0000, v158
    v_lshlrev_b32 v106, 16, v159
    v_and_b32 v107, 0xffff0000, v159
    v_pk_mul_f32 v[6:7], v[6:7], v[100:101]
    v_pk_mul_f32 v[22:23], v[22:23], v[102:103]
    v_pk_mul_f32 v[38:39], v[38:39], v[104:105]
    v_pk_mul_f32 v[54:55], v[54:55], v[106:107]
    v_cvt_pk_bf16_f32 v111, v6, v4
    v_cvt_pk_bf16_f32 v115, v7, v5
    v_cvt_pk_bf16_f32 v119, v22, v20
    v_cvt_pk_bf16_f32 v123, v23, v21
    v_cvt_pk_bf16_f32 v127, v38, v36
    v_cvt_pk_bf16_f32 v131, v39, v37
    v_cvt_pk_bf16_f32 v135, v54, v52
    v_cvt_pk_bf16_f32 v139, v55, v53
    s_waitcnt vmcnt(5)
    v_lshlrev_b32 v100, 16, v160
    v_and_b32 v101, 0xffff0000, v160
    v_lshlrev_b32 v102, 16, v161
    v_and_b32 v103, 0xffff0000, v161
    v_lshlrev_b32 v104, 16, v162
    v_and_b32 v105, 0xffff0000, v162
    v_lshlrev_b32 v106, 16, v163
    v_and_b32 v107, 0xffff0000, v163
    v_pk_mul_f32 v[8:9], v[8:9], v[100:101]
    v_pk_mul_f32 v[24:25], v[24:25], v[102:103]
    v_pk_mul_f32 v[40:41], v[40:41], v[104:105]
    v_pk_mul_f32 v[56:57], v[56:57], v[106:107]
    s_waitcnt vmcnt(4)
    v_lshlrev_b32 v100, 16, v164
    v_and_b32 v101, 0xffff0000, v164
    v_lshlrev_b32 v102, 16, v165
    v_and_b32 v103, 0xffff0000, v165
    v_lshlrev_b32 v104, 16, v166
    v_and_b32 v105, 0xffff0000, v166
    v_lshlrev_b32 v106, 16, v167
    v_and_b32 v107, 0xffff0000, v167
    v_pk_mul_f32 v[10:11], v[10:11], v[100:101]
    v_pk_mul_f32 v[26:27], v[26:27], v[102:103]
    v_pk_mul_f32 v[42:43], v[42:43], v[104:105]
    v_pk_mul_f32 v[58:59], v[58:59], v[106:107]
    v_cvt_pk_bf16_f32 v110, v10, v8
    v_cvt_pk_bf16_f32 v114, v11, v9
    v_cvt_pk_bf16_f32 v118, v26, v24
    v_cvt_pk_bf16_f32 v122, v27, v25
    v_cvt_pk_bf16_f32 v126, v42, v40
    v_cvt_pk_bf16_f32 v130, v43, v41
    v_cvt_pk_bf16_f32 v134, v58, v56
    v_cvt_pk_bf16_f32 v138, v59, v57
    s_waitcnt vmcnt(3)
    v_lshlrev_b32 v100, 16, v168
    v_and_b32 v101, 0xffff0000, v168
    v_lshlrev_b32 v102, 16, v169
    v_and_b32 v103, 0xffff0000, v169
    v_lshlrev_b32 v104, 16, v170
    v_and_b32 v105, 0xffff0000, v170
    v_lshlrev_b32 v106, 16, v171
    v_and_b32 v107, 0xffff0000, v171
    v_pk_mul_f32 v[12:13], v[12:13], v[100:101]
    v_pk_mul_f32 v[28:29], v[28:29], v[102:103]
    v_pk_mul_f32 v[44:45], v[44:45], v[104:105]
    v_pk_mul_f32 v[60:61], v[60:61], v[106:107]
    s_waitcnt vmcnt(2)
    v_lshlrev_b32 v100, 16, v172
    v_and_b32 v101, 0xffff0000, v172
    v_lshlrev_b32 v102, 16, v173
    v_and_b32 v103, 0xffff0000, v173
    v_lshlrev_b32 v104, 16, v174
    v_and_b32 v105, 0xffff0000, v174
    v_lshlrev_b32 v106, 16, v175
    v_and_b32 v107, 0xffff0000, v175
    v_pk_mul_f32 v[14:15], v[14:15], v[100:101]
    v_pk_mul_f32 v[30:31], v[30:31], v[102:103]
    v_pk_mul_f32 v[46:47], v[46:47], v[104:105]
    v_pk_mul_f32 v[62:63], v[62:63], v[106:107]
    v_cvt_pk_bf16_f32 v109, v14, v12
    v_cvt_pk_bf16_f32 v113, v15, v13
    v_cvt_pk_bf16_f32 v117, v30, v28
    v_cvt_pk_bf16_f32 v121, v31, v29
    v_cvt_pk_bf16_f32 v125, v46, v44
    v_cvt_pk_bf16_f32 v129, v47, v45
    v_cvt_pk_bf16_f32 v133, v62, v60
    v_cvt_pk_bf16_f32 v137, v63, v61
    s_waitcnt vmcnt(1)
    v_lshlrev_b32 v100, 16, v176
    v_and_b32 v101, 0xffff0000, v176
    v_lshlrev_b32 v102, 16, v177
    v_and_b32 v103, 0xffff0000, v177
    v_lshlrev_b32 v104, 16, v178
    v_and_b32 v105, 0xffff0000, v178
    v_lshlrev_b32 v106, 16, v179
    v_and_b32 v107, 0xffff0000, v179
    v_pk_mul_f32 v[16:17], v[16:17], v[100:101]
    v_pk_mul_f32 v[32:33], v[32:33], v[102:103]
    v_pk_mul_f32 v[48:49], v[48:49], v[104:105]
    v_pk_mul_f32 v[64:65], v[64:65], v[106:107]
    s_waitcnt vmcnt(0)
    v_lshlrev_b32 v100, 16, v180
    v_and_b32 v101, 0xffff0000, v180
    v_lshlrev_b32 v102, 16, v181
    v_and_b32 v103, 0xffff0000, v181
    v_lshlrev_b32 v104, 16, v182
    v_and_b32 v105, 0xffff0000, v182
    v_lshlrev_b32 v106, 16, v183
    v_and_b32 v107, 0xffff0000, v183
    v_pk_mul_f32 v[18:19], v[18:19], v[100:101]
    v_pk_mul_f32 v[34:35], v[34:35], v[102:103]
    v_pk_mul_f32 v[50:51], v[50:51], v[104:105]
    v_pk_mul_f32 v[66:67], v[66:67], v[106:107]
    v_cvt_pk_bf16_f32 v108, v18, v16
    ds_write_b128 v247, v[108:111] offset:0
    v_cvt_pk_bf16_f32 v112, v19, v17
    ds_write_b128 v247, v[112:115] offset:128
    v_cvt_pk_bf16_f32 v116, v34, v32
    ds_write_b128 v247, v[116:119] offset:256
    v_cvt_pk_bf16_f32 v120, v35, v33
    ds_write_b128 v247, v[120:123] offset:384
    v_cvt_pk_bf16_f32 v124, v50, v48
    ds_write_b128 v247, v[124:127] offset:512
    v_cvt_pk_bf16_f32 v128, v51, v49
    ds_write_b128 v247, v[128:131] offset:640
    v_cvt_pk_bf16_f32 v132, v66, v64
    ds_write_b128 v247, v[132:135] offset:768
    v_cvt_pk_bf16_f32 v136, v67, v65
    ds_write_b128 v247, v[136:139] offset:896
    ds_read_b128 v[152:155], v248 offset:0
    ds_read_b128 v[156:159], v248 offset:1040
    ds_read_b128 v[160:163], v248 offset:2080
    ds_read_b128 v[164:167], v248 offset:3120
    ds_read_b128 v[168:171], v248 offset:4160
    ds_read_b128 v[172:175], v248 offset:5200
    ds_read_b128 v[176:179], v248 offset:6240
    ds_read_b128 v[180:183], v248 offset:7280
    s_mov_b32 s87, 0
    s_waitcnt lgkmcnt(7)
    buffer_store_dwordx4 v[152:155], v249, s[80:83], s87 offen sc1
    s_mov_b32 s87, 33792
    s_waitcnt lgkmcnt(6)
    buffer_store_dwordx4 v[156:159], v249, s[80:83], s87 offen sc1
    s_mov_b32 s87, 67584
    s_waitcnt lgkmcnt(5)
    buffer_store_dwordx4 v[160:163], v249, s[80:83], s87 offen sc1
    s_mov_b32 s87, 101376
    s_waitcnt lgkmcnt(4)
    buffer_store_dwordx4 v[164:167], v249, s[80:83], s87 offen sc1
    s_mov_b32 s87, 135168
    s_waitcnt lgkmcnt(3)
    buffer_store_dwordx4 v[168:171], v249, s[80:83], s87 offen sc1
    s_mov_b32 s87, 168960
    s_waitcnt lgkmcnt(2)
    buffer_store_dwordx4 v[172:175], v249, s[80:83], s87 offen sc1
    s_mov_b32 s87, 202752
    s_waitcnt lgkmcnt(1)
    buffer_store_dwordx4 v[176:179], v249, s[80:83], s87 offen sc1
    s_mov_b32 s87, 236544
    s_waitcnt lgkmcnt(0)
    buffer_store_dwordx4 v[180:183], v249, s[80:83], s87 offen sc1
L_nopre:
    v_mov_b64 v[4:5], 0
    v_mov_b64 v[6:7], 0
    v_mov_b64 v[8:9], 0
    v_mov_b64 v[10:11], 0
    v_mov_b64 v[12:13], 0
    v_mov_b64 v[14:15], 0
    v_mov_b64 v[16:17], 0
    v_mov_b64 v[18:19], 0
    v_mov_b64 v[20:21], 0
    v_mov_b64 v[22:23], 0
    v_mov_b64 v[24:25], 0
    v_mov_b64 v[26:27], 0
    v_mov_b64 v[28:29], 0
    v_mov_b64 v[30:31], 0
    v_mov_b64 v[32:33], 0
    v_mov_b64 v[34:35], 0
    v_mov_b64 v[36:37], 0
    v_mov_b64 v[38:39], 0
    v_mov_b64 v[40:41], 0
    v_mov_b64 v[42:43], 0
    v_mov_b64 v[44:45], 0
    v_mov_b64 v[46:47], 0
    v_mov_b64 v[48:49], 0
    v_mov_b64 v[50:51], 0
    v_mov_b64 v[52:53], 0
    v_mov_b64 v[54:55], 0
    v_mov_b64 v[56:57], 0
    v_mov_b64 v[58:59], 0
    v_mov_b64 v[60:61], 0
    v_mov_b64 v[62:63], 0
    v_mov_b64 v[64:65], 0
    v_mov_b64 v[66:67], 0
    v_mov_b64 v[68:69], 0
    v_mov_b64 v[70:71], 0
    v_mov_b64 v[72:73], 0
    v_mov_b64 v[74:75], 0
    v_mov_b64 v[76:77], 0
    v_mov_b64 v[78:79], 0
    v_mov_b64 v[80:81], 0
    v_mov_b64 v[82:83], 0
    v_mov_b64 v[84:85], 0
    v_mov_b64 v[86:87], 0
    v_mov_b64 v[88:89], 0
    v_mov_b64 v[90:91], 0
    v_mov_b64 v[92:93], 0
    v_mov_b64 v[94:95], 0
    v_mov_b64 v[96:97], 0
    v_mov_b64 v[98:99], 0
    v_mov_b64 v[100:101], 0
    v_mov_b64 v[102:103], 0
    v_mov_b64 v[104:105], 0
    v_mov_b64 v[106:107], 0
    s_waitcnt lgkmcnt(0)
    s_and_b32 s37, s2, 7
    s_xor_b32 s37, s37, 2
    s_lshl_b32 s37, s37, 5
    s_lshr_b32 s38, s2, 3
    s_add_u32 s37, s37, s38
    s_add_u32 s37, s37, 256
    s_lshl_b32 s37, s37, 8
    s_cmp_eq_u32 s33, 0
    s_cselect_b32 s37, s37, s57
    s_cmp_eq_u32 s32, 0
    s_cbranch_scc0 L_noclear
    s_mov_b64 exec, 1
    buffer_store_dword v4, off, s[52:55], s37 sc1
    s_mov_b64 exec, -1
L_noclear:
    s_mov_b32 s37, 41984
    s_mov_b32 s36, 15
    s_barrier
    ds_read_b128 v[108:111], v196 offset:0
    ds_read_b64_tr_b16 v[124:125], v200 offset:0
    ds_read_b64_tr_b16 v[126:127], v200 offset:512
    ds_read_b128 v[112:115], v196 offset:2048
    ds_read_b64_tr_b16 v[128:129], v201 offset:0
    ds_read_b64_tr_b16 v[130:131], v201 offset:512
    ds_read_b128 v[116:119], v196 offset:4096
    ds_read_b64_tr_b16 v[148:149], v200 offset:8192
    ds_read_b64_tr_b16 v[150:151], v200 offset:8704
    ds_read_b128 v[120:123], v196 offset:6144
    ds_read_b64_tr_b16 v[132:133], v201 offset:8192
    ds_read_b64_tr_b16 v[134:135], v201 offset:8704
    ds_read_b64_tr_b16 v[156:157], v200 offset:16384
    ds_read_b64_tr_b16 v[158:159], v200 offset:16896
    ds_read_b64_tr_b16 v[136:137], v201 offset:16384
    ds_read_b64_tr_b16 v[138:139], v201 offset:16896
    s_branch L_g1_head
L_g1_rare:
    v_readfirstlane_b32 s38, v1
    s_nop 0
    s_cmp_ge_u32 s38, 4
    s_cbranch_scc1 L_sl_done_52
    s_mov_b32 s39, 1048576
L_sl_loop_53:
    ds_read_b32 v1, v228 offset:24
    s_waitcnt lgkmcnt(0)
    v_readfirstlane_b32 s38, v1
    s_nop 0
    s_cmp_ge_u32 s38, 4
    s_cbranch_scc1 L_sl_done_52
    s_sleep 1
    s_sub_u32 s39, s39, 1
    s_cbranch_scc0 L_sl_loop_53
L_sl_done_52:
    s_branch L_g1_nobar
.p2align 6
L_g1_head:
    s_waitcnt lgkmcnt(0)
L_g1_loop:
    v_mfma_f32_16x16x32_bf16 v[4:7], v[124:127], v[108:111], v[4:7]
    ds_read_b128 v[164:167], v197 offset:0
    v_mfma_f32_16x16x32_bf16 v[12:15], v[124:127], v[112:115], v[12:15]
    ds_read_b64_tr_b16 v[180:181], v200 offset:4096
    v_mfma_f32_16x16x32_bf16 v[20:23], v[124:127], v[116:119], v[20:23]
    ds_read_b64_tr_b16 v[182:183], v200 offset:4608
    v_mfma_f32_16x16x32_bf16 v[28:31], v[124:127], v[120:123], v[28:31]
    ds_read_b128 v[168:171], v197 offset:2048
    v_mfma_f32_16x16x32_bf16 v[32:35], v[128:131], v[120:123], v[32:35]
    ds_read_b64_tr_b16 v[184:185], v201 offset:4096
    v_mfma_f32_16x16x32_bf16 v[24:27], v[128:131], v[116:119], v[24:27]
    ds_read_b64_tr_b16 v[186:187], v201 offset:4608
    v_mfma_f32_16x16x32_bf16 v[16:19], v[128:131], v[112:115], v[16:19]
    ds_read_b128 v[172:175], v197 offset:4096
    v_mfma_f32_16x16x32_bf16 v[8:11], v[128:131], v[108:111], v[8:11]
    ds_read_b64_tr_b16 v[152:153], v200 offset:12288
    v_mfma_f32_16x16x32_bf16 v[40:43], v[132:135], v[108:111], v[40:43]
    ds_read_b64_tr_b16 v[154:155], v200 offset:12800
    v_mfma_f32_16x16x32_bf16 v[48:51], v[132:135], v[112:115], v[48:51]
    ds_read_b128 v[176:179], v197 offset:6144
    v_mfma_f32_16x16x32_bf16 v[56:59], v[132:135], v[116:119], v[56:59]
    ds_read_b64_tr_b16 v[188:189], v201 offset:12288
    v_mfma_f32_16x16x32_bf16 v[64:67], v[132:135], v[120:123], v[64:67]
    ds_read_b64_tr_b16 v[190:191], v201 offset:12800
    v_mfma_f32_16x16x32_bf16 v[60:63], v[148:151], v[120:123], v[60:63]
    ds_read2_b32 v[140:141], v198 offset1:2
    v_mfma_f32_16x16x32_bf16 v[52:55], v[148:151], v[116:119], v[52:55]
    ds_read2_b32 v[142:143], v199 offset1:2
    v_mfma_f32_16x16x32_bf16 v[44:47], v[148:151], v[112:115], v[44:47]
    ds_read_b64_tr_b16 v[160:161], v200 offset:20480
    v_mfma_f32_16x16x32_bf16 v[36:39], v[148:151], v[108:111], v[36:39]
    ds_read_b64_tr_b16 v[162:163], v200 offset:20992
    v_mfma_f32_16x16x32_bf16 v[68:71], v[108:111], v[156:159], v[68:71]
    ds_read_b64_tr_b16 v[192:193], v201 offset:20480
    ds_read_b64_tr_b16 v[194:195], v201 offset:20992
    v_mfma_f32_16x16x32_bf16 v[76:79], v[112:115], v[156:159], v[76:79]
    ds_read_b32 v1, v228 offset:24
    s_add_u32 s34, s34, 41984
    v_mfma_f32_16x16x32_bf16 v[84:87], v[116:119], v[156:159], v[84:87]
    s_cmp_eq_u32 s34, 125952
    s_cselect_b32 s35, -83968, s37
    v_mfma_f32_16x16x32_bf16 v[92:95], v[120:123], v[156:159], v[92:95]
    s_cselect_b32 s34, 0, s34
    s_cmp_eq_u32 s36, 1
    v_mfma_f32_16x16x32_bf16 v[96:99], v[120:123], v[136:139], v[96:99]
    v_add_u32 v196, s35, v196
    v_add_u32 v197, s35, v197
    v_mfma_f32_16x16x32_bf16 v[88:91], v[116:119], v[136:139], v[88:91]
    v_add_u32 v198, s35, v198
    v_add_u32 v199, s35, v199
    v_mfma_f32_16x16x32_bf16 v[80:83], v[112:115], v[136:139], v[80:83]
    v_add_u32 v200, s35, v200
    v_add_u32 v201, s35, v201
    v_mfma_f32_16x16x32_bf16 v[72:75], v[108:111], v[136:139], v[72:75]
    s_waitcnt lgkmcnt(0)
    v_smfmac_f32_16x16x64_bf16 v[100:103], v[140:143], v[148:155], v202
    v_smfmac_f32_16x16x64_bf16 v[104:107], v[140:143], v[156:163], v202
    s_cbranch_scc1 L_g1_rare
L_g1_bar:
    s_barrier
L_g1_nobar:
    v_mfma_f32_16x16x32_bf16 v[4:7], v[180:183], v[164:167], v[4:7]
    ds_read_b128 v[108:111], v196 offset:0
    v_mfma_f32_16x16x32_bf16 v[12:15], v[180:183], v[168:171], v[12:15]
    ds_read_b64_tr_b16 v[124:125], v200 offset:0
    v_mfma_f32_16x16x32_bf16 v[20:23], v[180:183], v[172:175], v[20:23]
    ds_read_b64_tr_b16 v[126:127], v200 offset:512
    v_mfma_f32_16x16x32_bf16 v[28:31], v[180:183], v[176:179], v[28:31]
    ds_read_b128 v[112:115], v196 offset:2048
    v_mfma_f32_16x16x32_bf16 v[32:35], v[184:187], v[176:179], v[32:35]
    ds_read_b64_tr_b16 v[128:129], v201 offset:0
    v_mfma_f32_16x16x32_bf16 v[24:27], v[184:187], v[172:175], v[24:27]
    ds_read_b64_tr_b16 v[130:131], v201 offset:512
    v_mfma_f32_16x16x32_bf16 v[16:19], v[184:187], v[168:171], v[16:19]
    ds_read_b128 v[116:119], v196 offset:4096
    v_mfma_f32_16x16x32_bf16 v[8:11], v[184:187], v[164:167], v[8:11]
    ds_read_b64_tr_b16 v[148:149], v200 offset:8192
    v_mfma_f32_16x16x32_bf16 v[40:43], v[188:191], v[164:167], v[40:43]
    ds_read_b64_tr_b16 v[150:151], v200 offset:8704
    v_mfma_f32_16x16x32_bf16 v[48:51], v[188:191], v[168:171], v[48:51]
    ds_read_b128 v[120:123], v196 offset:6144
    v_mfma_f32_16x16x32_bf16 v[56:59], v[188:191], v[172:175], v[56:59]
    ds_read_b64_tr_b16 v[132:133], v201 offset:8192
    v_mfma_f32_16x16x32_bf16 v[64:67], v[188:191], v[176:179], v[64:67]
    ds_read_b64_tr_b16 v[134:135], v201 offset:8704
    v_mfma_f32_16x16x32_bf16 v[60:63], v[152:155], v[176:179], v[60:63]
    ds_read_b64_tr_b16 v[156:157], v200 offset:16384
    v_mfma_f32_16x16x32_bf16 v[52:55], v[152:155], v[172:175], v[52:55]
    ds_read_b64_tr_b16 v[158:159], v200 offset:16896
    v_mfma_f32_16x16x32_bf16 v[44:47], v[152:155], v[168:171], v[44:47]
    ds_read_b64_tr_b16 v[136:137], v201 offset:16384
    v_mfma_f32_16x16x32_bf16 v[36:39], v[152:155], v[164:167], v[36:39]
    ds_read_b64_tr_b16 v[138:139], v201 offset:16896
    v_mfma_f32_16x16x32_bf16 v[68:71], v[164:167], v[160:163], v[68:71]
    s_sub_u32 s36, s36, 1
    v_mfma_f32_16x16x32_bf16 v[76:79], v[168:171], v[160:163], v[76:79]
    s_cmp_lg_u32 s36, 0
    v_mfma_f32_16x16x32_bf16 v[84:87], v[172:175], v[160:163], v[84:87]
    v_mfma_f32_16x16x32_bf16 v[92:95], v[176:179], v[160:163], v[92:95]
    v_mfma_f32_16x16x32_bf16 v[96:99], v[176:179], v[192:195], v[96:99]
    v_mfma_f32_16x16x32_bf16 v[88:91], v[172:175], v[192:195], v[88:91]
    v_mfma_f32_16x16x32_bf16 v[80:83], v[168:171], v[192:195], v[80:83]
    s_waitcnt vmcnt(0) lgkmcnt(0)
    v_mfma_f32_16x16x32_bf16 v[72:75], v[164:167], v[192:195], v[72:75]
    s_cbranch_scc1 L_g1_loop
    v_mfma_f32_16x16x32_bf16 v[4:7], v[124:127], v[108:111], v[4:7]
    ds_read_b128 v[164:167], v197 offset:0
    v_mfma_f32_16x16x32_bf16 v[12:15], v[124:127], v[112:115], v[12:15]
    ds_read_b64_tr_b16 v[180:181], v200 offset:4096
    v_mfma_f32_16x16x32_bf16 v[20:23], v[124:127], v[116:119], v[20:23]
    ds_read_b64_tr_b16 v[182:183], v200 offset:4608
    v_mfma_f32_16x16x32_bf16 v[28:31], v[124:127], v[120:123], v[28:31]
    ds_read_b128 v[168:171], v197 offset:2048
    v_mfma_f32_16x16x32_bf16 v[32:35], v[128:131], v[120:123], v[32:35]
    ds_read_b64_tr_b16 v[184:185], v201 offset:4096
    v_mfma_f32_16x16x32_bf16 v[24:27], v[128:131], v[116:119], v[24:27]
    ds_read_b64_tr_b16 v[186:187], v201 offset:4608
    v_mfma_f32_16x16x32_bf16 v[16:19], v[128:131], v[112:115], v[16:19]
    ds_read_b128 v[172:175], v197 offset:4096
    v_mfma_f32_16x16x32_bf16 v[8:11], v[128:131], v[108:111], v[8:11]
    ds_read_b64_tr_b16 v[152:153], v200 offset:12288
    v_mfma_f32_16x16x32_bf16 v[40:43], v[132:135], v[108:111], v[40:43]
    ds_read_b64_tr_b16 v[154:155], v200 offset:12800
    v_mfma_f32_16x16x32_bf16 v[48:51], v[132:135], v[112:115], v[48:51]
    ds_read_b128 v[176:179], v197 offset:6144
    v_mfma_f32_16x16x32_bf16 v[56:59], v[132:135], v[116:119], v[56:59]
    ds_read_b64_tr_b16 v[188:189], v201 offset:12288
    v_mfma_f32_16x16x32_bf16 v[64:67], v[132:135], v[120:123], v[64:67]
    ds_read_b64_tr_b16 v[190:191], v201 offset:12800
    v_mfma_f32_16x16x32_bf16 v[60:63], v[148:151], v[120:123], v[60:63]
    ds_read2_b32 v[140:141], v198 offset1:2
    v_mfma_f32_16x16x32_bf16 v[52:55], v[148:151], v[116:119], v[52:55]
    ds_read2_b32 v[142:143], v199 offset1:2
    v_mfma_f32_16x16x32_bf16 v[44:47], v[148:151], v[112:115], v[44:47]
    ds_read_b64_tr_b16 v[160:161], v200 offset:20480
    v_mfma_f32_16x16x32_bf16 v[36:39], v[148:151], v[108:111], v[36:39]
    ds_read_b64_tr_b16 v[162:163], v200 offset:20992
    v_mfma_f32_16x16x32_bf16 v[68:71], v[108:111], v[156:159], v[68:71]
    ds_read_b64_tr_b16 v[192:193], v201 offset:20480
    v_mfma_f32_16x16x32_bf16 v[76:79], v[112:115], v[156:159], v[76:79]
    ds_read_b64_tr_b16 v[194:195], v201 offset:20992
    v_mfma_f32_16x16x32_bf16 v[84:87], v[116:119], v[156:159], v[84:87]
    v_mfma_f32_16x16x32_bf16 v[92:95], v[120:123], v[156:159], v[92:95]
    v_mfma_f32_16x16x32_bf16 v[96:99], v[120:123], v[136:139], v[96:99]
    v_mfma_f32_16x16x32_bf16 v[88:91], v[116:119], v[136:139], v[88:91]
    v_mfma_f32_16x16x32_bf16 v[80:83], v[112:115], v[136:139], v[80:83]
    v_mfma_f32_16x16x32_bf16 v[72:75], v[108:111], v[136:139], v[72:75]
    s_waitcnt lgkmcnt(0)
    s_setprio 2
    v_mov_b32 v2, 1
    v_smfmac_f32_16x16x64_bf16 v[100:103], v[140:143], v[148:155], v202
    v_smfmac_f32_16x16x64_bf16 v[104:107], v[140:143], v[156:163], v202
    v_mfma_f32_16x16x32_bf16 v[60:63], v[152:155], v[176:179], v[60:63]
    v_mfma_f32_16x16x32_bf16 v[64:67], v[188:191], v[176:179], v[64:67]
    v_mfma_f32_16x16x32_bf16 v[92:95], v[176:179], v[160:163], v[92:95]
    v_mfma_f32_16x16x32_bf16 v[96:99], v[176:179], v[192:195], v[96:99]
    v_mfma_f32_16x16x32_bf16 v[28:31], v[180:183], v[176:179], v[28:31]
    v_mfma_f32_16x16x32_bf16 v[32:35], v[184:187], v[176:179], v[32:35]
    v_mfma_f32_16x16x32_bf16 v[52:55], v[152:155], v[172:175], v[52:55]
    v_mfma_f32_16x16x32_bf16 v[56:59], v[188:191], v[172:175], v[56:59]
    s_nop 3
    v_permlane32_swap_b32 v100, v104
    v_permlane32_swap_b32 v101, v105
    v_mfma_f32_16x16x32_bf16 v[20:23], v[180:183], v[172:175], v[20:23]
    v_permlane32_swap_b32 v102, v106
    v_permlane32_swap_b32 v103, v107
    v_mfma_f32_16x16x32_bf16 v[24:27], v[184:187], v[172:175], v[24:27]
    v_add_f32 v100, v100, v104
    v_add_f32 v101, v101, v105
    v_mfma_f32_16x16x32_bf16 v[44:47], v[152:155], v[168:171], v[44:47]
    v_add_f32 v102, v102, v106
    v_add_f32 v103, v103, v107
    v_mfma_f32_16x16x32_bf16 v[48:51], v[188:191], v[168:171], v[48:51]
    v_cvt_pk_bf16_f32 v144, v100, v101
    v_cvt_pk_bf16_f32 v145, v102, v103
    v_mfma_f32_16x16x32_bf16 v[12:15], v[180:183], v[168:171], v[12:15]
    ds_write_b64 v219, v[144:145] offset:1024
    ds_write_b16 v203, v144 offset:0
    v_mfma_f32_16x16x32_bf16 v[16:19], v[184:187], v[168:171], v[16:19]
    ds_write_b16_d16_hi v203, v144 offset:8
    ds_write_b16 v203, v145 offset:16
    v_mfma_f32_16x16x32_bf16 v[36:39], v[152:155], v[164:167], v[36:39]
    ds_write_b16_d16_hi v203, v145 offset:24
    v_cvt_pk_bf16_f32 v140, v60, v61
    v_mfma_f32_16x16x32_bf16 v[40:43], v[188:191], v[164:167], v[40:43]
    v_cvt_pk_bf16_f32 v141, v62, v63
    v_cvt_pk_bf16_f32 v142, v64, v65
    v_mfma_f32_16x16x32_bf16 v[4:7], v[180:183], v[164:167], v[4:7]
    v_cvt_pk_bf16_f32 v143, v66, v67
    v_cvt_pk_bf16_f32 v238, v92, v93
    v_mfma_f32_16x16x32_bf16 v[8:11], v[184:187], v[164:167], v[8:11]
    v_cvt_pk_bf16_f32 v239, v94, v95
    v_cvt_pk_bf16_f32 v248, v96, v97
    v_mfma_f32_16x16x32_bf16 v[84:87], v[172:175], v[160:163], v[84:87]
    v_cvt_pk_bf16_f32 v249, v98, v99
    s_cmp_eq_u32 s33, 0
    s_cbranch_scc0 L_at_nopub
    ds_write_b64 v220, v[140:141] offset:2048
    ds_write_b64 v220, v[238:239] offset:3072
    ds_write_b64 v220, v[142:143] offset:2560
    ds_write_b64 v220, v[248:249] offset:3584
L_at_nopub:
    s_mov_b64 exec, 1
    ds_add_u32 v228, v2 offset:20
    s_mov_b64 exec, -1
    v_mfma_f32_16x16x32_bf16 v[88:91], v[172:175], v[192:195], v[88:91]
    v_cvt_pk_bf16_f32 v120, v28, v29
    v_cvt_pk_bf16_f32 v121, v30, v31
    v_mfma_f32_16x16x32_bf16 v[76:79], v[168:171], v[160:163], v[76:79]
    v_cvt_pk_bf16_f32 v122, v32, v33
    v_cvt_pk_bf16_f32 v123, v34, v35
    v_mfma_f32_16x16x32_bf16 v[80:83], v[168:171], v[192:195], v[80:83]
    v_cvt_pk_bf16_f32 v136, v52, v53
    v_cvt_pk_bf16_f32 v137, v54, v55
    v_mfma_f32_16x16x32_bf16 v[68:71], v[164:167], v[160:163], v[68:71]
    v_cvt_pk_bf16_f32 v138, v56, v57
    v_cvt_pk_bf16_f32 v139, v58, v59
    v_mfma_f32_16x16x32_bf16 v[72:75], v[164:167], v[192:195], v[72:75]
    v_cvt_pk_bf16_f32 v116, v20, v21
    v_cvt_pk_bf16_f32 v117, v22, v23
    v_mfma_f32_16x16x32_bf16 v[28:31], v[140:143], v[120:123], v[204:207]
    v_cvt_pk_bf16_f32 v118, v24, v25
    v_cvt_pk_bf16_f32 v119, v26, v27
    v_mfma_f32_16x16x32_bf16 v[32:35], v[136:139], v[120:123], v[208:211]
    v_cvt_pk_bf16_f32 v132, v44, v45
    v_cvt_pk_bf16_f32 v133, v46, v47
    v_mfma_f32_16x16x32_bf16 v[20:23], v[136:139], v[116:119], v[204:207]
    v_cvt_pk_bf16_f32 v134, v48, v49
    v_cvt_pk_bf16_f32 v135, v50, v51
    s_nop 1
    v_mfma_f32_16x16x32_bf16 v[24:27], v[132:135], v[116:119], v[208:211]
    v_cvt_pk_bf16_f32 v112, v12, v13
    v_cvt_pk_bf16_f32 v113, v14, v15
    v_cvt_pk_bf16_f32 v114, v16, v17
    v_cvt_pk_bf16_f32 v115, v18, v19
    s_nop 1
    v_mfma_f32_16x16x32_bf16 v[12:15], v[132:135], v[112:115], v[204:207]
    v_cvt_pk_bf16_f32 v128, v36, v37
    v_cvt_pk_bf16_f32 v129, v38, v39
    v_cvt_pk_bf16_f32 v130, v40, v41
    v_cvt_pk_bf16_f32 v131, v42, v43
    s_nop 1
    v_mfma_f32_16x16x32_bf16 v[16:19], v[128:131], v[112:115], v[208:211]
    v_cvt_pk_bf16_f32 v108, v4, v5
    v_cvt_pk_bf16_f32 v109, v6, v7
    v_cvt_pk_bf16_f32 v110, v8, v9
    v_cvt_pk_bf16_f32 v111, v10, v11
    s_nop 1
    v_mfma_f32_16x16x32_bf16 v[4:7], v[128:131], v[108:111], v[204:207]
    v_cvt_pk_bf16_f32 v236, v84, v85
    v_cvt_pk_bf16_f32 v237, v86, v87
    v_cvt_pk_bf16_f32 v246, v88, v89
    v_cvt_pk_bf16_f32 v247, v90, v91
    v_cvt_pk_bf16_f32 v234, v76, v77
    v_cvt_pk_bf16_f32 v235, v78, v79
    ds_read_b32 v1, v228 offset:20
    v_cvt_pk_bf16_f32 v244, v80, v81
    v_cvt_pk_bf16_f32 v245, v82, v83
    v_cvt_pk_bf16_f32 v232, v68, v69
    v_cvt_pk_bf16_f32 v233, v70, v71
    v_cvt_pk_bf16_f32 v242, v72, v73
    v_cvt_pk_bf16_f32 v243, v74, v75
    s_waitcnt lgkmcnt(0)
    v_readfirstlane_b32 s37, v1
    s_nop 0
    s_cmp_ge_u32 s37, 4
    s_cbranch_scc1 L_sl_done_54
    s_mov_b32 s38, 1048576
L_sl_loop_55:
    ds_read_b32 v1, v228 offset:20
    s_waitcnt lgkmcnt(0)
    v_readfirstlane_b32 s37, v1
    s_nop 0
    s_cmp_ge_u32 s37, 4
    s_cbranch_scc1 L_sl_done_54
    s_sleep 1
    s_sub_u32 s38, s38, 1
    s_cbranch_scc0 L_sl_loop_55
L_sl_done_54:
    ds_read_b64 v[124:125], v221
    ds_read_b64 v[126:127], v222
    ds_read_b64 v[230:231], v221 offset:1024
    ds_read_b64 v[240:241], v222 offset:1024
    v_max_f32 v28, v28, v32
    v_max_f32 v29, v29, v33
    v_max_f32 v30, v30, v34
    v_max_f32 v31, v31, v35
    v_max3_f32 v39, v28, v29, v30
    v_max_f32 v39, v39, v31
    v_max_f32 v20, v20, v24
    v_max_f32 v21, v21, v25
    v_max_f32 v22, v22, v26
    v_max_f32 v23, v23, v27
    v_max3_f32 v38, v20, v21, v22
    v_max_f32 v38, v38, v23
    s_waitcnt lgkmcnt(2)
    v_mfma_f32_16x16x32_bf16 v[8:11], v[124:127], v[108:111], v[212:215]
    s_setprio 2
    s_mov_b32 s37, 0x3e8293ee
    v_max_f32 v12, v12, v16
    v_max_f32 v13, v13, v17
    v_max_f32 v14, v14, v18
    v_max_f32 v15, v15, v19
    v_max3_f32 v37, v12, v13, v14
    v_max_f32 v37, v37, v15
    v_max_f32 v4, v4, v8
    v_max_f32 v5, v5, v9
    v_max_f32 v6, v6, v10
    v_max_f32 v7, v7, v11
    v_max3_f32 v36, v4, v5, v6
    v_max_f32 v36, v36, v7
    v_permlane32_swap_b32 v38, v39
    s_nop 0
    v_permlane32_swap_b32 v36, v37
    v_max_f32 v38, v38, v39
    v_max_f32 v36, v36, v37
    s_nop 1
    v_permlane16_swap_b32 v36, v38
    v_max_f32 v36, v36, v38
    v_mul_f32 v38, s37, v36
    v_mul_f32 v36, s37, v36
    s_nop 1
    v_permlane16_swap_b32 v36, v38
    v_mov_b32 v37, v36
    s_add_u32 m0, s60, 0
    v_mov_b32 v39, v38
    v_permlane32_swap_b32 v36, v37
    s_xor_b32 s63, s62, 0
    v_permlane32_swap_b32 v38, v39
    v_fma_f32 v4, v4, s37, -v36
    buffer_load_dwordx4 v227, s[44:47], s63 offen offset:0 lds
    v_fma_f32 v5, v5, s37, -v36
    v_fma_f32 v6, v6, s37, -v36
    buffer_load_dwordx4 v223, s[44:47], s63 offen offset:1024 lds
    v_fma_f32 v7, v7, s37, -v36
    v_fma_f32 v12, v12, s37, -v37
    s_add_u32 m0, s60, 8192
    v_fma_f32 v13, v13, s37, -v37
    v_fma_f32 v14, v14, s37, -v37
    s_xor_b32 s63, s62, 131072
    v_fma_f32 v15, v15, s37, -v37
    v_fma_f32 v20, v20, s37, -v38
    buffer_load_dwordx4 v227, s[44:47], s63 offen offset:0 lds
    v_fma_f32 v21, v21, s37, -v38
    v_fma_f32 v22, v22, s37, -v38
    buffer_load_dwordx4 v223, s[44:47], s63 offen offset:1024 lds
    v_fma_f32 v23, v23, s37, -v38
    v_fma_f32 v28, v28, s37, -v39
    s_add_u32 m0, s60, 16384
    v_fma_f32 v29, v29, s37, -v39
    v_fma_f32 v30, v30, s37, -v39
    s_xor_b32 s63, s62, 262144
    v_fma_f32 v31, v31, s37, -v39
    v_exp_f32 v28, v28
    buffer_load_dwordx4 v227, s[44:47], s63 offen offset:0 lds
    v_exp_f32 v29, v29
    v_exp_f32 v30, v30
    buffer_load_dwordx4 v223, s[44:47], s63 offen offset:1024 lds
    v_exp_f32 v31, v31
    v_exp_f32 v20, v20
    s_add_u32 m0, s60, 24576
    v_exp_f32 v21, v21
    v_exp_f32 v22, v22
    s_xor_b32 s63, s62, 393216
    v_exp_f32 v23, v23
    v_exp_f32 v12, v12
    buffer_load_dwordx4 v227, s[44:47], s63 offen offset:0 lds
    v_exp_f32 v13, v13
    v_exp_f32 v14, v14
    buffer_load_dwordx4 v223, s[44:47], s63 offen offset:1024 lds
    v_exp_f32 v15, v15
    v_exp_f32 v4, v4
    s_add_u32 m0, s60, 32768
    v_exp_f32 v5, v5
    v_exp_f32 v6, v6
    s_xor_b32 s63, s62, 524288
    v_exp_f32 v7, v7
    v_add_f32 v39, v28, v29
    buffer_load_dwordx4 v227, s[44:47], s63 offen offset:0 lds
    v_add_f32 v32, v30, v31
    v_add_f32 v39, v39, v32
    buffer_load_dwordx4 v223, s[44:47], s63 offen offset:1024 lds
    v_add_f32 v38, v20, v21
    v_add_f32 v24, v22, v23
    s_add_u32 m0, s60, 83968
    v_add_f32 v38, v38, v24
    v_add_f32 v37, v12, v13
    s_xor_b32 s63, s62, 655360
    v_add_f32 v16, v14, v15
    v_add_f32 v37, v37, v16
    buffer_load_dwordx4 v227, s[44:47], s63 offen offset:0 lds
    v_add_f32 v36, v4, v5
    v_add_f32 v8, v6, v7
    buffer_load_dwordx4 v223, s[44:47], s63 offen offset:1024 lds
    v_add_f32 v36, v36, v8
    v_permlane32_swap_b32 v38, v39
    s_add_u32 m0, s60, 92160
    v_permlane32_swap_b32 v36, v37
    v_add_f32 v38, v38, v39
    s_xor_b32 s63, s62, 786432
    v_add_f32 v36, v36, v37
    s_nop 1
    v_permlane16_swap_b32 v36, v38
    buffer_load_dwordx4 v227, s[44:47], s63 offen offset:0 lds
    v_add_f32 v36, v36, v38
    v_rcp_f32 v38, v36
    buffer_load_dwordx4 v223, s[44:47], s63 offen offset:1024 lds
    v_rcp_f32 v36, v36
    s_nop 1
    v_permlane16_swap_b32 v36, v38
    s_add_u32 m0, s60, 100352
    v_mov_b32 v37, v36
    v_mov_b32 v39, v38
    s_xor_b32 s63, s62, 917504
    v_permlane32_swap_b32 v36, v37
    v_permlane32_swap_b32 v38, v39
    buffer_load_dwordx4 v227, s[44:47], s63 offen offset:0 lds
    s_waitcnt lgkmcnt(0)
    v_mul_f32 v4, v4, v36
    buffer_load_dwordx4 v223, s[44:47], s63 offen offset:1024 lds
    v_mul_f32 v5, v5, v36
    v_mul_f32 v6, v6, v36
    s_add_u32 m0, s60, 108544
    v_mul_f32 v7, v7, v36
    v_cvt_pk_bf16_f32 v10, v4, v5
    s_xor_b32 s63, s62, 1048576
    v_cvt_pk_bf16_f32 v11, v6, v7
    v_and_b32 v8, v216, v10
    buffer_load_dwordx4 v227, s[44:47], s63 offen offset:0 lds
    v_and_b32 v9, v217, v11
    v_xor_b32 v10, v8, v10
    buffer_load_dwordx4 v223, s[44:47], s63 offen offset:1024 lds
    v_xor_b32 v11, v9, v11
    s_setprio 2
    s_add_u32 m0, s60, 116736
    v_mfma_f32_16x16x32_bf16 v[68:71], v[230:233], v[8:11], 0
    v_mfma_f32_16x16x32_bf16 v[72:75], v[240:243], v[8:11], 0
    s_xor_b32 s63, s62, 1179648
    s_setprio 2
    v_mul_f32 v12, v12, v37
    buffer_load_dwordx4 v227, s[44:47], s63 offen offset:0 lds
    v_mul_f32 v13, v13, v37
    v_mul_f32 v14, v14, v37
    buffer_load_dwordx4 v223, s[44:47], s63 offen offset:1024 lds
    v_mul_f32 v15, v15, v37
    v_cvt_pk_bf16_f32 v18, v12, v13
    v_cvt_pk_bf16_f32 v19, v14, v15
    v_and_b32 v16, v216, v18
    v_and_b32 v17, v217, v19
    v_xor_b32 v18, v16, v18
    v_xor_b32 v19, v17, v19
    v_cvt_pk_bf16_f32 v108, v68, v69
    v_cvt_pk_bf16_f32 v109, v70, v71
    v_cvt_pk_bf16_f32 v110, v72, v73
    v_cvt_pk_bf16_f32 v111, v74, v75
    s_mov_b32 s37, 0
    buffer_store_dwordx4 v[108:111], v218, s[40:43], s37 offen sc1
    s_setprio 2
    v_mfma_f32_16x16x32_bf16 v[76:79], v[232:235], v[16:19], 0
    v_mfma_f32_16x16x32_bf16 v[80:83], v[242:245], v[16:19], 0
    s_setprio 2
    v_mul_f32 v20, v20, v38
    v_mul_f32 v21, v21, v38
    v_mul_f32 v22, v22, v38
    v_mul_f32 v23, v23, v38
    v_cvt_pk_bf16_f32 v26, v20, v21
    v_cvt_pk_bf16_f32 v27, v22, v23
    v_and_b32 v24, v216, v26
    v_and_b32 v25, v217, v27
    v_xor_b32 v26, v24, v26
    v_xor_b32 v27, v25, v27
    v_cvt_pk_bf16_f32 v112, v76, v77
    v_cvt_pk_bf16_f32 v113, v78, v79
    v_cvt_pk_bf16_f32 v114, v80, v81
    v_cvt_pk_bf16_f32 v115, v82, v83
    s_mov_b32 s37, 32768
    buffer_store_dwordx4 v[112:115], v218, s[40:43], s37 offen sc1
    s_setprio 2
    v_mfma_f32_16x16x32_bf16 v[84:87], v[234:237], v[24:27], 0
    v_mfma_f32_16x16x32_bf16 v[88:91], v[244:247], v[24:27], 0
    s_setprio 2
    v_mul_f32 v28, v28, v39
    v_mul_f32 v29, v29, v39
    v_mul_f32 v30, v30, v39
    v_mul_f32 v31, v31, v39
    v_cvt_pk_bf16_f32 v34, v28, v29
    v_cvt_pk_bf16_f32 v35, v30, v31
    v_and_b32 v32, v216, v34
    v_and_b32 v33, v217, v35
    v_xor_b32 v34, v32, v34
    v_xor_b32 v35, v33, v35
    v_cvt_pk_bf16_f32 v116, v84, v85
    v_cvt_pk_bf16_f32 v117, v86, v87
    v_cvt_pk_bf16_f32 v118, v88, v89
    v_cvt_pk_bf16_f32 v119, v90, v91
    s_mov_b32 s37, 65536
    buffer_store_dwordx4 v[116:119], v218, s[40:43], s37 offen sc1
    s_setprio 2
    v_mfma_f32_16x16x32_bf16 v[92:95], v[236:239], v[32:35], 0
    v_mfma_f32_16x16x32_bf16 v[96:99], v[246:249], v[32:35], 0
    s_setprio 2
    s_nop 5
    v_cvt_pk_bf16_f32 v120, v92, v93
    v_cvt_pk_bf16_f32 v121, v94, v95
    v_cvt_pk_bf16_f32 v122, v96, v97
    v_cvt_pk_bf16_f32 v123, v98, v99
    s_mov_b32 s37, 98304
    buffer_store_dwordx4 v[120:123], v218, s[40:43], s37 offen sc1
    s_setprio 0
    s_lshl_b32 s37, s32, 11
    v_add_u32 v229, s37, v229
    v_xor_b32 v84, 0, v229
    v_xor_b32 v85, 32, v229
    v_xor_b32 v86, 64, v229
    v_xor_b32 v87, 96, v229
    v_add_u32 v88, 83968, v84
    v_add_u32 v89, 83968, v85
    v_add_u32 v90, 83968, v86
    v_add_u32 v91, 83968, v87
    v_add_u32 v92, 125952, v84
    v_add_u32 v93, 125952, v85
    v_add_u32 v94, 125952, v86
    v_add_u32 v95, 125952, v87
    v_xor_b32 v232, 2048, v229
    v_xor_b32 v233, 2080, v229
    v_xor_b32 v234, 2112, v229
    v_xor_b32 v235, 2144, v229
    v_add_u32 v236, 83968, v232
    v_add_u32 v237, 83968, v233
    v_add_u32 v238, 83968, v234
    v_add_u32 v239, 83968, v235
    v_add_u32 v240, 125952, v232
    v_add_u32 v241, 125952, v233
    v_add_u32 v242, 125952, v234
    v_add_u32 v243, 125952, v235
    s_mul_i32 s37, s32, 80896
    s_lshl_b32 s38, s33, 11
    s_add_u32 s37, s37, s38
    s_add_u32 s37, s37, 78848
    v_lshrrev_b32 v1, 5, v0
    v_xor_b32 v1, v1, v0
    v_and_b32 v1, 7, v1
    v_lshl_add_u32 v1, v1, 4, s37
    v_bfe_u32 v2, v0, 4, 1
    v_lshl_add_u32 v1, v2, 3, v1
    v_and_b32 v2, 15, v0
    v_lshl_add_u32 v244, v2, 7, v1
    v_xor_b32 v245, 32, v244
    v_xor_b32 v246, 64, v244
    v_xor_b32 v247, 96, v244
    v_lshrrev_b32 v1, 3, v0
    v_xor_b32 v1, v1, v0
    v_and_b32 v1, 7, v1
    v_and_b32 v2, 56, v0
    v_add_u32 v1, v1, v2
    v_lshl_add_u32 v248, v1, 4, s37
    v_lshl_add_u32 v231, v0, 4, s60
    v_add_u32 v230, 125952, v231
    s_add_u32 s64, s61, 0
    s_and_b32 s64, s64, 7
    s_lshl_b32 s64, s64, 12
    s_add_u32 s65, s61, 1
    s_and_b32 s65, s65, 7
    s_lshl_b32 s65, s65, 12
    s_add_u32 s66, s61, 2
    s_and_b32 s66, s66, 7
    s_lshl_b32 s66, s66, 12
    s_add_u32 s67, s61, 3
    s_and_b32 s67, s67, 7
    s_lshl_b32 s67, s67, 12
    s_add_u32 s68, s61, 4
    s_and_b32 s68, s68, 7
    s_lshl_b32 s68, s68, 12
    s_add_u32 s69, s61, 5
    s_and_b32 s69, s69, 7
    s_lshl_b32 s69, s69, 12
    s_add_u32 s70, s61, 6
    s_and_b32 s70, s70, 7
    s_lshl_b32 s70, s70, 12
    s_add_u32 s71, s61, 7
    s_and_b32 s71, s71, 7
    s_lshl_b32 s71, s71, 12
    s_waitcnt vmcnt(0)
    s_setprio 2
    v_mov_b32 v2, 1
    s_mov_b64 exec, 1
    ds_add_rtn_u32 v1, v228, v2 offset:0
    s_waitcnt lgkmcnt(0)
    v_readfirstlane_b32 s39, v1
    s_nop 0
    s_cmp_eq_u32 s39, 3
    s_cbranch_scc0 L_jo_56a
    s_mov_b64 exec, 0xffff
    v_lshlrev_b32 v1, 8, v0
    buffer_atomic_add v2, v1, s[52:55], s56 offen sc1
L_jo_56a:
    s_mov_b64 exec, -1
    s_setprio 0
    s_xor_b32 s63, s62, 1310720
    buffer_load_dwordx4 v[172:175], v227, s[44:47], s63 offen offset:0
    buffer_load_dwordx4 v[176:179], v223, s[44:47], s63 offen offset:1024
    s_xor_b32 s63, s62, 1441792
    buffer_load_dwordx4 v[180:183], v227, s[44:47], s63 offen offset:0
    buffer_load_dwordx4 v[184:187], v223, s[44:47], s63 offen offset:1024
    s_cmp_eq_u32 s39, 3
    s_cbranch_scc0 L_ps_58
    s_load_dword s37, s[52:53], s57 glc
L_ps_58:
    s_xor_b32 s63, s62, 1572864
    buffer_load_dwordx4 v[188:191], v227, s[44:47], s63 offen offset:0
    buffer_load_dwordx4 v[192:195], v223, s[44:47], s63 offen offset:1024
    s_xor_b32 s63, s62, 1703936
    buffer_load_dwordx4 v[196:199], v227, s[44:47], s63 offen offset:0
    buffer_load_dwordx4 v[200:203], v223, s[44:47], s63 offen offset:1024
    s_xor_b32 s63, s62, 1835008
    buffer_load_dwordx4 v[204:207], v227, s[44:47], s63 offen offset:0
    buffer_load_dwordx4 v[208:211], v223, s[44:47], s63 offen offset:1024
    s_xor_b32 s63, s62, 1966080
    buffer_load_dwordx4 v[212:215], v227, s[44:47], s63 offen offset:0
    buffer_load_dwordx4 v[216:219], v223, s[44:47], s63 offen offset:1024
    s_setprio 0
    s_cmp_eq_u32 s39, 3
    s_cbranch_scc0 L_jo_56
    s_mov_b32 s38, 131072
    s_branch L_sg_chk_61
L_sg_loop_60:
    s_load_dword s37, s[52:53], s57 glc
L_sg_chk_61:
    s_waitcnt lgkmcnt(0)
    s_cmp_ge_u32 s37, 16
    s_cbranch_scc1 L_sg_done_59
    s_sub_u32 s38, s38, 1
    s_cbranch_scc0 L_sg_loop_60
L_sg_done_59:
    v_mov_b32 v1, 16
    s_mov_b64 exec, 1
    ds_add_u32 v228, v1 offset:4
    s_mov_b64 exec, -1
L_jo_56:
    s_waitcnt vmcnt(12)
    s_mov_b64 exec, 1
    ds_add_u32 v228, v2 offset:4
    s_mov_b64 exec, -1
    s_mov_b32 s38, 1048576
L_sl_loop_63:
    ds_read_b32 v1, v228 offset:4
    s_waitcnt lgkmcnt(0)
    v_readfirstlane_b32 s37, v1
    s_nop 0
    s_cmp_ge_u32 s37, 20
    s_cbranch_scc1 L_sl_done_62
    s_sleep 1
    s_sub_u32 s38, s38, 1
    s_cbranch_scc0 L_sl_loop_63
L_sl_done_62:
L_jd_57:
    buffer_load_dwordx4 v[96:99], v224, s[40:43], s64 offen offset:0 sc1
    buffer_load_dwordx4 v[100:103], v225, s[40:43], s64 offen offset:0 sc1
    ds_read_b64_tr_b16 v[36:37], v84 offset:0
    ds_read_b64_tr_b16 v[38:39], v232 offset:0
    buffer_load_dwordx4 v[104:107], v224, s[40:43], s64 offen offset:1024 sc1
    buffer_load_dwordx4 v[108:111], v225, s[40:43], s64 offen offset:1024 sc1
    ds_read_b64_tr_b16 v[40:41], v85 offset:0
    ds_read_b64_tr_b16 v[42:43], v233 offset:0
    buffer_load_dwordx4 v[112:115], v224, s[40:43], s64 offen offset:2048 sc1
    buffer_load_dwordx4 v[116:119], v225, s[40:43], s64 offen offset:2048 sc1
    ds_read_b64_tr_b16 v[44:45], v86 offset:0
    ds_read_b64_tr_b16 v[46:47], v234 offset:0
    buffer_load_dwordx4 v[120:123], v224, s[40:43], s64 offen offset:3072 sc1
    buffer_load_dwordx4 v[124:127], v225, s[40:43], s64 offen offset:3072 sc1
    ds_read_b64_tr_b16 v[48:49], v87 offset:0
    ds_read_b64_tr_b16 v[50:51], v235 offset:0
    buffer_load_dwordx4 v[128:131], v224, s[40:43], s65 offen offset:0 sc1
    buffer_load_dwordx4 v[132:135], v225, s[40:43], s65 offen offset:0 sc1
    ds_read_b64_tr_b16 v[52:53], v84 offset:4096
    ds_read_b64_tr_b16 v[54:55], v232 offset:4096
    buffer_load_dwordx4 v[136:139], v224, s[40:43], s65 offen offset:1024 sc1
    buffer_load_dwordx4 v[140:143], v225, s[40:43], s65 offen offset:1024 sc1
    ds_read_b64_tr_b16 v[56:57], v85 offset:4096
    ds_read_b64_tr_b16 v[58:59], v233 offset:4096
    ds_read_b64_tr_b16 v[60:61], v86 offset:4096
    ds_read_b64_tr_b16 v[62:63], v234 offset:4096
    s_waitcnt lgkmcnt(12)
    ds_read_b64_tr_b16 v[64:65], v87 offset:4096
    ds_read_b64_tr_b16 v[66:67], v235 offset:4096
    ds_read_b32 v1, v228 offset:36
    s_waitcnt vmcnt(10) lgkmcnt(9)
    v_mfma_f32_16x16x32_bf16 v[4:7], v[36:39], v[96:99], 0
    ds_read_b64_tr_b16 v[68:69], v84 offset:8192
    v_mfma_f32_16x16x32_bf16 v[20:23], v[36:39], v[100:103], 0
    ds_read_b64_tr_b16 v[70:71], v232 offset:8192
    v_mfma_f32_16x16x32_bf16 v[8:11], v[40:43], v[96:99], 0
    ds_read_b64_tr_b16 v[36:37], v85 offset:8192
    v_mfma_f32_16x16x32_bf16 v[24:27], v[40:43], v[100:103], 0
    ds_read_b64_tr_b16 v[38:39], v233 offset:8192
    buffer_load_dwordx4 v[144:147], v224, s[40:43], s65 offen offset:2048 sc1
    v_mfma_f32_16x16x32_bf16 v[12:15], v[44:47], v[96:99], 0
    ds_read_b64_tr_b16 v[40:41], v86 offset:8192
    v_mfma_f32_16x16x32_bf16 v[28:31], v[44:47], v[100:103], 0
    ds_read_b64_tr_b16 v[42:43], v234 offset:8192
    v_mfma_f32_16x16x32_bf16 v[16:19], v[48:51], v[96:99], 0
    ds_read_b64_tr_b16 v[44:45], v87 offset:8192
    v_mfma_f32_16x16x32_bf16 v[32:35], v[48:51], v[100:103], 0
    ds_read_b64_tr_b16 v[46:47], v235 offset:8192
    buffer_load_dwordx4 v[148:151], v225, s[40:43], s65 offen offset:2048 sc1
    s_waitcnt lgkmcnt(8)
    v_readfirstlane_b32 s37, v1
    s_nop 0
    s_cmp_ge_u32 s37, 4
    s_cbranch_scc1 L_sl_done_64
    s_mov_b32 s38, 1048576
L_sl_loop_65:
    ds_read_b32 v1, v228 offset:36
    s_waitcnt lgkmcnt(0)
    v_readfirstlane_b32 s37, v1
    s_nop 0
    s_cmp_ge_u32 s37, 4
    s_cbranch_scc1 L_sl_done_64
    s_sleep 1
    s_sub_u32 s38, s38, 1
    s_cbranch_scc0 L_sl_loop_65
L_sl_done_64:
    ds_write_b128 v230, v[172:175] offset:0
    s_waitcnt vmcnt(10)
    v_mfma_f32_16x16x32_bf16 v[4:7], v[52:55], v[104:107], v[4:7]
    ds_read_b64_tr_b16 v[48:49], v84 offset:12288
    v_mfma_f32_16x16x32_bf16 v[20:23], v[52:55], v[108:111], v[20:23]
    ds_read_b64_tr_b16 v[50:51], v232 offset:12288
    v_mfma_f32_16x16x32_bf16 v[8:11], v[56:59], v[104:107], v[8:11]
    ds_read_b64_tr_b16 v[52:53], v85 offset:12288
    v_mfma_f32_16x16x32_bf16 v[24:27], v[56:59], v[108:111], v[24:27]
    ds_read_b64_tr_b16 v[54:55], v233 offset:12288
    buffer_load_dwordx4 v[96:99], v224, s[40:43], s65 offen offset:3072 sc1
    ds_write_b128 v230, v[176:179] offset:1024
    v_mfma_f32_16x16x32_bf16 v[12:15], v[60:63], v[104:107], v[12:15]
    ds_read_b64_tr_b16 v[56:57], v86 offset:12288
    v_mfma_f32_16x16x32_bf16 v[28:31], v[60:63], v[108:111], v[28:31]
    ds_read_b64_tr_b16 v[58:59], v234 offset:12288
    v_mfma_f32_16x16x32_bf16 v[16:19], v[64:67], v[104:107], v[16:19]
    ds_read_b64_tr_b16 v[60:61], v87 offset:12288
    v_mfma_f32_16x16x32_bf16 v[32:35], v[64:67], v[108:111], v[32:35]
    ds_read_b64_tr_b16 v[62:63], v235 offset:12288
    buffer_load_dwordx4 v[100:103], v225, s[40:43], s65 offen offset:3072 sc1
    ds_write_b128 v230, v[180:183] offset:8448
    s_waitcnt vmcnt(10) lgkmcnt(11)
    v_mfma_f32_16x16x32_bf16 v[4:7], v[68:71], v[112:115], v[4:7]
    ds_read_b64_tr_b16 v[64:65], v84 offset:16384
    v_mfma_f32_16x16x32_bf16 v[20:23], v[68:71], v[116:119], v[20:23]
    ds_read_b64_tr_b16 v[66:67], v232 offset:16384
    v_mfma_f32_16x16x32_bf16 v[8:11], v[36:39], v[112:115], v[8:11]
    ds_read_b64_tr_b16 v[68:69], v85 offset:16384
    v_mfma_f32_16x16x32_bf16 v[24:27], v[36:39], v[116:119], v[24:27]
    ds_read_b64_tr_b16 v[70:71], v233 offset:16384
    buffer_load_dwordx4 v[104:107], v224, s[40:43], s66 offen offset:0 sc1
    ds_write_b128 v230, v[184:187] offset:9472
    v_mfma_f32_16x16x32_bf16 v[12:15], v[40:43], v[112:115], v[12:15]
    ds_read_b64_tr_b16 v[36:37], v86 offset:16384
    v_mfma_f32_16x16x32_bf16 v[28:31], v[40:43], v[116:119], v[28:31]
    ds_read_b64_tr_b16 v[38:39], v234 offset:16384
    v_mfma_f32_16x16x32_bf16 v[16:19], v[44:47], v[112:115], v[16:19]
    ds_read_b64_tr_b16 v[40:41], v87 offset:16384
    v_mfma_f32_16x16x32_bf16 v[32:35], v[44:47], v[116:119], v[32:35]
    ds_read_b64_tr_b16 v[42:43], v235 offset:16384
    buffer_load_dwordx4 v[108:111], v225, s[40:43], s66 offen offset:0 sc1
    ds_write_b128 v230, v[188:191] offset:16896
    s_waitcnt vmcnt(10) lgkmcnt(11)
    v_mfma_f32_16x16x32_bf16 v[4:7], v[48:51], v[120:123], v[4:7]
    ds_read_b64_tr_b16 v[44:45], v84 offset:20480
    v_mfma_f32_16x16x32_bf16 v[20:23], v[48:51], v[124:127], v[20:23]
    ds_read_b64_tr_b16 v[46:47], v232 offset:20480
    v_mfma_f32_16x16x32_bf16 v[8:11], v[52:55], v[120:123], v[8:11]
    ds_read_b64_tr_b16 v[48:49], v85 offset:20480
    v_mfma_f32_16x16x32_bf16 v[24:27], v[52:55], v[124:127], v[24:27]
    ds_read_b64_tr_b16 v[50:51], v233 offset:20480
    buffer_load_dwordx4 v[112:115], v224, s[40:43], s66 offen offset:1024 sc1
    ds_write_b128 v230, v[192:195] offset:17920
    v_mfma_f32_16x16x32_bf16 v[12:15], v[56:59], v[120:123], v[12:15]
    ds_read_b64_tr_b16 v[52:53], v86 offset:20480
    v_mfma_f32_16x16x32_bf16 v[28:31], v[56:59], v[124:127], v[28:31]
    ds_read_b64_tr_b16 v[54:55], v234 offset:20480
    v_mfma_f32_16x16x32_bf16 v[16:19], v[60:63], v[120:123], v[16:19]
    ds_read_b64_tr_b16 v[56:57], v87 offset:20480
    v_mfma_f32_16x16x32_bf16 v[32:35], v[60:63], v[124:127], v[32:35]
    ds_read_b64_tr_b16 v[58:59], v235 offset:20480
    buffer_load_dwordx4 v[116:119], v225, s[40:43], s66 offen offset:1024 sc1
    ds_write_b128 v230, v[196:199] offset:25344
    s_waitcnt vmcnt(10) lgkmcnt(11)
    v_mfma_f32_16x16x32_bf16 v[4:7], v[64:67], v[128:131], v[4:7]
    ds_read_b64_tr_b16 v[60:61], v84 offset:24576
    v_mfma_f32_16x16x32_bf16 v[20:23], v[64:67], v[132:135], v[20:23]
    ds_read_b64_tr_b16 v[62:63], v232 offset:24576
    v_mfma_f32_16x16x32_bf16 v[8:11], v[68:71], v[128:131], v[8:11]
    ds_read_b64_tr_b16 v[64:65], v85 offset:24576
    v_mfma_f32_16x16x32_bf16 v[24:27], v[68:71], v[132:135], v[24:27]
    ds_read_b64_tr_b16 v[66:67], v233 offset:24576
    buffer_load_dwordx4 v[120:123], v224, s[40:43], s66 offen offset:2048 sc1
    ds_write_b128 v230, v[200:203] offset:26368
    v_mfma_f32_16x16x32_bf16 v[12:15], v[36:39], v[128:131], v[12:15]
    ds_read_b64_tr_b16 v[68:69], v86 offset:24576
    v_mfma_f32_16x16x32_bf16 v[28:31], v[36:39], v[132:135], v[28:31]
    ds_read_b64_tr_b16 v[70:71], v234 offset:24576
    v_mfma_f32_16x16x32_bf16 v[16:19], v[40:43], v[128:131], v[16:19]
    ds_read_b64_tr_b16 v[36:37], v87 offset:24576
    v_mfma_f32_16x16x32_bf16 v[32:35], v[40:43], v[132:135], v[32:35]
    ds_read_b64_tr_b16 v[38:39], v235 offset:24576
    buffer_load_dwordx4 v[124:127], v225, s[40:43], s66 offen offset:2048 sc1
    ds_write_b128 v231, v[204:207] offset:41984
    s_waitcnt vmcnt(10) lgkmcnt(11)
    v_mfma_f32_16x16x32_bf16 v[4:7], v[44:47], v[136:139], v[4:7]
    ds_read_b64_tr_b16 v[40:41], v84 offset:28672
    v_mfma_f32_16x16x32_bf16 v[20:23], v[44:47], v[140:143], v[20:23]
    ds_read_b64_tr_b16 v[42:43], v232 offset:28672
    v_mfma_f32_16x16x32_bf16 v[8:11], v[48:51], v[136:139], v[8:11]
    ds_read_b64_tr_b16 v[44:45], v85 offset:28672
    v_mfma_f32_16x16x32_bf16 v[24:27], v[48:51], v[140:143], v[24:27]
    ds_read_b64_tr_b16 v[46:47], v233 offset:28672
    buffer_load_dwordx4 v[128:131], v224, s[40:43], s66 offen offset:3072 sc1
    ds_write_b128 v231, v[208:211] offset:43008
    v_mfma_f32_16x16x32_bf16 v[12:15], v[52:55], v[136:139], v[12:15]
    ds_read_b64_tr_b16 v[48:49], v86 offset:28672
    v_mfma_f32_16x16x32_bf16 v[28:31], v[52:55], v[140:143], v[28:31]
    ds_read_b64_tr_b16 v[50:51], v234 offset:28672
    v_mfma_f32_16x16x32_bf16 v[16:19], v[56:59], v[136:139], v[16:19]
    ds_read_b64_tr_b16 v[52:53], v87 offset:28672
    v_mfma_f32_16x16x32_bf16 v[32:35], v[56:59], v[140:143], v[32:35]
    ds_read_b64_tr_b16 v[54:55], v235 offset:28672
    buffer_load_dwordx4 v[132:135], v225, s[40:43], s66 offen offset:3072 sc1
    ds_write_b128 v231, v[212:215] offset:51200
    s_waitcnt vmcnt(10) lgkmcnt(11)
    v_mfma_f32_16x16x32_bf16 v[4:7], v[60:63], v[144:147], v[4:7]
    ds_read_b64_tr_b16 v[56:57], v84 offset:32768
    v_mfma_f32_16x16x32_bf16 v[20:23], v[60:63], v[148:151], v[20:23]
    ds_read_b64_tr_b16 v[58:59], v232 offset:32768
    v_mfma_f32_16x16x32_bf16 v[8:11], v[64:67], v[144:147], v[8:11]
    ds_read_b64_tr_b16 v[60:61], v85 offset:32768
    v_mfma_f32_16x16x32_bf16 v[24:27], v[64:67], v[148:151], v[24:27]
    ds_read_b64_tr_b16 v[62:63], v233 offset:32768
    buffer_load_dwordx4 v[136:139], v224, s[40:43], s67 offen offset:0 sc1
    ds_write_b128 v231, v[216:219] offset:52224
    s_mov_b64 exec, 1
    ds_add_u32 v228, v2 offset:12
    s_mov_b64 exec, -1
    v_mfma_f32_16x16x32_bf16 v[12:15], v[68:71], v[144:147], v[12:15]
    ds_read_b64_tr_b16 v[64:65], v86 offset:32768
    v_mfma_f32_16x16x32_bf16 v[28:31], v[68:71], v[148:151], v[28:31]
    ds_read_b64_tr_b16 v[66:67], v234 offset:32768
    v_mfma_f32_16x16x32_bf16 v[16:19], v[36:39], v[144:147], v[16:19]
    ds_read_b64_tr_b16 v[68:69], v87 offset:32768
    v_mfma_f32_16x16x32_bf16 v[32:35], v[36:39], v[148:151], v[32:35]
    ds_read_b64_tr_b16 v[70:71], v235 offset:32768
    buffer_load_dwordx4 v[140:143], v225, s[40:43], s67 offen offset:0 sc1
    s_waitcnt vmcnt(10) lgkmcnt(11)
    v_mfma_f32_16x16x32_bf16 v[4:7], v[40:43], v[96:99], v[4:7]
    ds_read_b64_tr_b16 v[36:37], v84 offset:36864
    v_mfma_f32_16x16x32_bf16 v[20:23], v[40:43], v[100:103], v[20:23]
    ds_read_b64_tr_b16 v[38:39], v232 offset:36864
    v_mfma_f32_16x16x32_bf16 v[8:11], v[44:47], v[96:99], v[8:11]
    ds_read_b64_tr_b16 v[40:41], v85 offset:36864
    v_mfma_f32_16x16x32_bf16 v[24:27], v[44:47], v[100:103], v[24:27]
    ds_read_b64_tr_b16 v[42:43], v233 offset:36864
    buffer_load_dwordx4 v[144:147], v224, s[40:43], s67 offen offset:1024 sc1
    v_mfma_f32_16x16x32_bf16 v[12:15], v[48:51], v[96:99], v[12:15]
    ds_read_b64_tr_b16 v[44:45], v86 offset:36864
    v_mfma_f32_16x16x32_bf16 v[28:31], v[48:51], v[100:103], v[28:31]
    ds_read_b64_tr_b16 v[46:47], v234 offset:36864
    v_mfma_f32_16x16x32_bf16 v[16:19], v[52:55], v[96:99], v[16:19]
    ds_read_b64_tr_b16 v[48:49], v87 offset:36864
    v_mfma_f32_16x16x32_bf16 v[32:35], v[52:55], v[100:103], v[32:35]
    ds_read_b64_tr_b16 v[50:51], v235 offset:36864
    buffer_load_dwordx4 v[148:151], v225, s[40:43], s67 offen offset:1024 sc1
    s_waitcnt vmcnt(10) lgkmcnt(8)
    v_mfma_f32_16x16x32_bf16 v[4:7], v[56:59], v[104:107], v[4:7]
    ds_read_b64_tr_b16 v[52:53], v88 offset:0
    v_mfma_f32_16x16x32_bf16 v[20:23], v[56:59], v[108:111], v[20:23]
    ds_read_b64_tr_b16 v[54:55], v236 offset:0
    v_mfma_f32_16x16x32_bf16 v[8:11], v[60:63], v[104:107], v[8:11]
    ds_read_b64_tr_b16 v[56:57], v89 offset:0
    v_mfma_f32_16x16x32_bf16 v[24:27], v[60:63], v[108:111], v[24:27]
    ds_read_b64_tr_b16 v[58:59], v237 offset:0
    buffer_load_dwordx4 v[96:99], v224, s[40:43], s67 offen offset:2048 sc1
    v_mfma_f32_16x16x32_bf16 v[12:15], v[64:67], v[104:107], v[12:15]
    ds_read_b64_tr_b16 v[60:61], v90 offset:0
    v_mfma_f32_16x16x32_bf16 v[28:31], v[64:67], v[108:111], v[28:31]
    ds_read_b64_tr_b16 v[62:63], v238 offset:0
    v_mfma_f32_16x16x32_bf16 v[16:19], v[68:71], v[104:107], v[16:19]
    ds_read_b64_tr_b16 v[64:65], v91 offset:0
    v_mfma_f32_16x16x32_bf16 v[32:35], v[68:71], v[108:111], v[32:35]
    ds_read_b64_tr_b16 v[66:67], v239 offset:0
    buffer_load_dwordx4 v[100:103], v225, s[40:43], s67 offen offset:2048 sc1
    s_waitcnt vmcnt(10) lgkmcnt(8)
    v_mfma_f32_16x16x32_bf16 v[4:7], v[36:39], v[112:115], v[4:7]
    ds_read_b64_tr_b16 v[68:69], v88 offset:4096
    v_mfma_f32_16x16x32_bf16 v[20:23], v[36:39], v[116:119], v[20:23]
    ds_read_b64_tr_b16 v[70:71], v236 offset:4096
    v_mfma_f32_16x16x32_bf16 v[8:11], v[40:43], v[112:115], v[8:11]
    ds_read_b64_tr_b16 v[36:37], v89 offset:4096
    v_mfma_f32_16x16x32_bf16 v[24:27], v[40:43], v[116:119], v[24:27]
    ds_read_b64_tr_b16 v[38:39], v237 offset:4096
    buffer_load_dwordx4 v[104:107], v224, s[40:43], s67 offen offset:3072 sc1
    v_mfma_f32_16x16x32_bf16 v[12:15], v[44:47], v[112:115], v[12:15]
    ds_read_b64_tr_b16 v[40:41], v90 offset:4096
    v_mfma_f32_16x16x32_bf16 v[28:31], v[44:47], v[116:119], v[28:31]
    ds_read_b64_tr_b16 v[42:43], v238 offset:4096
    v_mfma_f32_16x16x32_bf16 v[16:19], v[48:51], v[112:115], v[16:19]
    ds_read_b64_tr_b16 v[44:45], v91 offset:4096
    v_mfma_f32_16x16x32_bf16 v[32:35], v[48:51], v[116:119], v[32:35]
    ds_read_b64_tr_b16 v[46:47], v239 offset:4096
    buffer_load_dwordx4 v[108:111], v225, s[40:43], s67 offen offset:3072 sc1
    s_waitcnt vmcnt(10) lgkmcnt(8)
    v_mfma_f32_16x16x32_bf16 v[4:7], v[52:55], v[120:123], v[4:7]
    ds_read_b64_tr_b16 v[48:49], v88 offset:8192
    v_mfma_f32_16x16x32_bf16 v[20:23], v[52:55], v[124:127], v[20:23]
    ds_read_b64_tr_b16 v[50:51], v236 offset:8192
    v_mfma_f32_16x16x32_bf16 v[8:11], v[56:59], v[120:123], v[8:11]
    ds_read_b64_tr_b16 v[52:53], v89 offset:8192
    v_mfma_f32_16x16x32_bf16 v[24:27], v[56:59], v[124:127], v[24:27]
    ds_read_b64_tr_b16 v[54:55], v237 offset:8192
    buffer_load_dwordx4 v[112:115], v224, s[40:43], s68 offen offset:0 sc1
    v_mfma_f32_16x16x32_bf16 v[12:15], v[60:63], v[120:123], v[12:15]
    ds_read_b64_tr_b16 v[56:57], v90 offset:8192
    v_mfma_f32_16x16x32_bf16 v[28:31], v[60:63], v[124:127], v[28:31]
    ds_read_b64_tr_b16 v[58:59], v238 offset:8192
    v_mfma_f32_16x16x32_bf16 v[16:19], v[64:67], v[120:123], v[16:19]
    ds_read_b64_tr_b16 v[60:61], v91 offset:8192
    v_mfma_f32_16x16x32_bf16 v[32:35], v[64:67], v[124:127], v[32:35]
    ds_read_b64_tr_b16 v[62:63], v239 offset:8192
    buffer_load_dwordx4 v[116:119], v225, s[40:43], s68 offen offset:0 sc1
    s_waitcnt vmcnt(10) lgkmcnt(8)
    v_mfma_f32_16x16x32_bf16 v[4:7], v[68:71], v[128:131], v[4:7]
    ds_read_b64_tr_b16 v[64:65], v88 offset:12288
    v_mfma_f32_16x16x32_bf16 v[20:23], v[68:71], v[132:135], v[20:23]
    ds_read_b64_tr_b16 v[66:67], v236 offset:12288
    v_mfma_f32_16x16x32_bf16 v[8:11], v[36:39], v[128:131], v[8:11]
    ds_read_b64_tr_b16 v[68:69], v89 offset:12288
    v_mfma_f32_16x16x32_bf16 v[24:27], v[36:39], v[132:135], v[24:27]
    ds_read_b64_tr_b16 v[70:71], v237 offset:12288
    buffer_load_dwordx4 v[120:123], v224, s[40:43], s68 offen offset:1024 sc1
    v_mfma_f32_16x16x32_bf16 v[12:15], v[40:43], v[128:131], v[12:15]
    ds_read_b64_tr_b16 v[36:37], v90 offset:12288
    v_mfma_f32_16x16x32_bf16 v[28:31], v[40:43], v[132:135], v[28:31]
    ds_read_b64_tr_b16 v[38:39], v238 offset:12288
    v_mfma_f32_16x16x32_bf16 v[16:19], v[44:47], v[128:131], v[16:19]
    ds_read_b64_tr_b16 v[40:41], v91 offset:12288
    v_mfma_f32_16x16x32_bf16 v[32:35], v[44:47], v[132:135], v[32:35]
    ds_read_b64_tr_b16 v[42:43], v239 offset:12288
    buffer_load_dwordx4 v[124:127], v225, s[40:43], s68 offen offset:1024 sc1
    s_waitcnt vmcnt(10) lgkmcnt(8)
    v_mfma_f32_16x16x32_bf16 v[4:7], v[48:51], v[136:139], v[4:7]
    ds_read_b64_tr_b16 v[44:45], v88 offset:16384
    v_mfma_f32_16x16x32_bf16 v[20:23], v[48:51], v[140:143], v[20:23]
    ds_read_b64_tr_b16 v[46:47], v236 offset:16384
    v_mfma_f32_16x16x32_bf16 v[8:11], v[52:55], v[136:139], v[8:11]
    ds_read_b64_tr_b16 v[48:49], v89 offset:16384
    v_mfma_f32_16x16x32_bf16 v[24:27], v[52:55], v[140:143], v[24:27]
    ds_read_b64_tr_b16 v[50:51], v237 offset:16384
    buffer_load_dwordx4 v[128:131], v224, s[40:43], s68 offen offset:2048 sc1
    v_mfma_f32_16x16x32_bf16 v[12:15], v[56:59], v[136:139], v[12:15]
    ds_read_b64_tr_b16 v[52:53], v90 offset:16384
    v_mfma_f32_16x16x32_bf16 v[28:31], v[56:59], v[140:143], v[28:31]
    ds_read_b64_tr_b16 v[54:55], v238 offset:16384
    v_mfma_f32_16x16x32_bf16 v[16:19], v[60:63], v[136:139], v[16:19]
    ds_read_b64_tr_b16 v[56:57], v91 offset:16384
    v_mfma_f32_16x16x32_bf16 v[32:35], v[60:63], v[140:143], v[32:35]
    ds_read_b64_tr_b16 v[58:59], v239 offset:16384
    buffer_load_dwordx4 v[132:135], v225, s[40:43], s68 offen offset:2048 sc1
    s_waitcnt vmcnt(10) lgkmcnt(8)
    v_mfma_f32_16x16x32_bf16 v[4:7], v[64:67], v[144:147], v[4:7]
    ds_read_b64_tr_b16 v[60:61], v88 offset:20480
    v_mfma_f32_16x16x32_bf16 v[20:23], v[64:67], v[148:151], v[20:23]
    ds_read_b64_tr_b16 v[62:63], v236 offset:20480
    v_mfma_f32_16x16x32_bf16 v[8:11], v[68:71], v[144:147], v[8:11]
    ds_read_b64_tr_b16 v[64:65], v89 offset:20480
    v_mfma_f32_16x16x32_bf16 v[24:27], v[68:71], v[148:151], v[24:27]
    ds_read_b64_tr_b16 v[66:67], v237 offset:20480
    buffer_load_dwordx4 v[136:139], v224, s[40:43], s68 offen offset:3072 sc1
    v_mfma_f32_16x16x32_bf16 v[12:15], v[36:39], v[144:147], v[12:15]
    ds_read_b64_tr_b16 v[68:69], v90 offset:20480
    v_mfma_f32_16x16x32_bf16 v[28:31], v[36:39], v[148:151], v[28:31]
    ds_read_b64_tr_b16 v[70:71], v238 offset:20480
    v_mfma_f32_16x16x32_bf16 v[16:19], v[40:43], v[144:147], v[16:19]
    ds_read_b64_tr_b16 v[36:37], v91 offset:20480
    v_mfma_f32_16x16x32_bf16 v[32:35], v[40:43], v[148:151], v[32:35]
    ds_read_b64_tr_b16 v[38:39], v239 offset:20480
    buffer_load_dwordx4 v[140:143], v225, s[40:43], s68 offen offset:3072 sc1
    s_waitcnt vmcnt(10) lgkmcnt(8)
    v_mfma_f32_16x16x32_bf16 v[4:7], v[44:47], v[96:99], v[4:7]
    ds_read_b64_tr_b16 v[40:41], v88 offset:24576
    v_mfma_f32_16x16x32_bf16 v[20:23], v[44:47], v[100:103], v[20:23]
    ds_read_b64_tr_b16 v[42:43], v236 offset:24576
    v_mfma_f32_16x16x32_bf16 v[8:11], v[48:51], v[96:99], v[8:11]
    ds_read_b64_tr_b16 v[44:45], v89 offset:24576
    v_mfma_f32_16x16x32_bf16 v[24:27], v[48:51], v[100:103], v[24:27]
    ds_read_b64_tr_b16 v[46:47], v237 offset:24576
    buffer_load_dwordx4 v[144:147], v224, s[40:43], s69 offen offset:0 sc1
    v_mfma_f32_16x16x32_bf16 v[12:15], v[52:55], v[96:99], v[12:15]
    ds_read_b64_tr_b16 v[48:49], v90 offset:24576
    v_mfma_f32_16x16x32_bf16 v[28:31], v[52:55], v[100:103], v[28:31]
    ds_read_b64_tr_b16 v[50:51], v238 offset:24576
    v_mfma_f32_16x16x32_bf16 v[16:19], v[56:59], v[96:99], v[16:19]
    ds_read_b64_tr_b16 v[52:53], v91 offset:24576
    v_mfma_f32_16x16x32_bf16 v[32:35], v[56:59], v[100:103], v[32:35]
    ds_read_b64_tr_b16 v[54:55], v239 offset:24576
    buffer_load_dwordx4 v[148:151], v225, s[40:43], s69 offen offset:0 sc1
    s_waitcnt vmcnt(10) lgkmcnt(8)
    v_mfma_f32_16x16x32_bf16 v[4:7], v[60:63], v[104:107], v[4:7]
    ds_read_b64_tr_b16 v[56:57], v88 offset:28672
    v_mfma_f32_16x16x32_bf16 v[20:23], v[60:63], v[108:111], v[20:23]
    ds_read_b64_tr_b16 v[58:59], v236 offset:28672
    v_mfma_f32_16x16x32_bf16 v[8:11], v[64:67], v[104:107], v[8:11]
    ds_read_b64_tr_b16 v[60:61], v89 offset:28672
    v_mfma_f32_16x16x32_bf16 v[24:27], v[64:67], v[108:111], v[24:27]
    ds_read_b64_tr_b16 v[62:63], v237 offset:28672
    buffer_load_dwordx4 v[96:99], v224, s[40:43], s69 offen offset:1024 sc1
    v_mfma_f32_16x16x32_bf16 v[12:15], v[68:71], v[104:107], v[12:15]
    ds_read_b64_tr_b16 v[64:65], v90 offset:28672
    v_mfma_f32_16x16x32_bf16 v[28:31], v[68:71], v[108:111], v[28:31]
    ds_read_b64_tr_b16 v[66:67], v238 offset:28672
    v_mfma_f32_16x16x32_bf16 v[16:19], v[36:39], v[104:107], v[16:19]
    ds_read_b64_tr_b16 v[68:69], v91 offset:28672
    v_mfma_f32_16x16x32_bf16 v[32:35], v[36:39], v[108:111], v[32:35]
    ds_read_b64_tr_b16 v[70:71], v239 offset:28672
    buffer_load_dwordx4 v[100:103], v225, s[40:43], s69 offen offset:1024 sc1
    s_waitcnt vmcnt(10) lgkmcnt(8)
    v_mfma_f32_16x16x32_bf16 v[4:7], v[40:43], v[112:115], v[4:7]
    ds_read_b64_tr_b16 v[36:37], v88 offset:32768
    v_mfma_f32_16x16x32_bf16 v[20:23], v[40:43], v[116:119], v[20:23]
    ds_read_b64_tr_b16 v[38:39], v236 offset:32768
    v_mfma_f32_16x16x32_bf16 v[8:11], v[44:47], v[112:115], v[8:11]
    ds_read_b64_tr_b16 v[40:41], v89 offset:32768
    v_mfma_f32_16x16x32_bf16 v[24:27], v[44:47], v[116:119], v[24:27]
    ds_read_b64_tr_b16 v[42:43], v237 offset:32768
    buffer_load_dwordx4 v[104:107], v224, s[40:43], s69 offen offset:2048 sc1
    v_mfma_f32_16x16x32_bf16 v[12:15], v[48:51], v[112:115], v[12:15]
    ds_read_b64_tr_b16 v[44:45], v90 offset:32768
    v_mfma_f32_16x16x32_bf16 v[28:31], v[48:51], v[116:119], v[28:31]
    ds_read_b64_tr_b16 v[46:47], v238 offset:32768
    v_mfma_f32_16x16x32_bf16 v[16:19], v[52:55], v[112:115], v[16:19]
    ds_read_b64_tr_b16 v[48:49], v91 offset:32768
    v_mfma_f32_16x16x32_bf16 v[32:35], v[52:55], v[116:119], v[32:35]
    ds_read_b64_tr_b16 v[50:51], v239 offset:32768
    buffer_load_dwordx4 v[108:111], v225, s[40:43], s69 offen offset:2048 sc1
    ds_read_b32 v1, v228 offset:12
    s_waitcnt vmcnt(10) lgkmcnt(9)
    v_mfma_f32_16x16x32_bf16 v[4:7], v[56:59], v[120:123], v[4:7]
    ds_read_b64_tr_b16 v[52:53], v88 offset:36864
    v_mfma_f32_16x16x32_bf16 v[20:23], v[56:59], v[124:127], v[20:23]
    ds_read_b64_tr_b16 v[54:55], v236 offset:36864
    v_mfma_f32_16x16x32_bf16 v[8:11], v[60:63], v[120:123], v[8:11]
    ds_read_b64_tr_b16 v[56:57], v89 offset:36864
    v_mfma_f32_16x16x32_bf16 v[24:27], v[60:63], v[124:127], v[24:27]
    ds_read_b64_tr_b16 v[58:59], v237 offset:36864
    buffer_load_dwordx4 v[112:115], v224, s[40:43], s69 offen offset:3072 sc1
    v_mfma_f32_16x16x32_bf16 v[12:15], v[64:67], v[120:123], v[12:15]
    ds_read_b64_tr_b16 v[60:61], v90 offset:36864
    v_mfma_f32_16x16x32_bf16 v[28:31], v[64:67], v[124:127], v[28:31]
    ds_read_b64_tr_b16 v[62:63], v238 offset:36864
    v_mfma_f32_16x16x32_bf16 v[16:19], v[68:71], v[120:123], v[16:19]
    ds_read_b64_tr_b16 v[64:65], v91 offset:36864
    v_mfma_f32_16x16x32_bf16 v[32:35], v[68:71], v[124:127], v[32:35]
    ds_read_b64_tr_b16 v[66:67], v239 offset:36864
    buffer_load_dwordx4 v[116:119], v225, s[40:43], s69 offen offset:3072 sc1
    s_waitcnt lgkmcnt(8)
    v_readfirstlane_b32 s37, v1
    s_nop 0
    s_cmp_ge_u32 s37, 4
    s_cbranch_scc1 L_sl_done_66
    s_mov_b32 s38, 1048576
L_sl_loop_67:
    ds_read_b32 v1, v228 offset:12
    s_waitcnt lgkmcnt(0)
    v_readfirstlane_b32 s37, v1
    s_nop 0
    s_cmp_ge_u32 s37, 4
    s_cbranch_scc1 L_sl_done_66
    s_sleep 1
    s_sub_u32 s38, s38, 1
    s_cbranch_scc0 L_sl_loop_67
L_sl_done_66:
    s_waitcnt vmcnt(10)
    v_mfma_f32_16x16x32_bf16 v[4:7], v[36:39], v[128:131], v[4:7]
    ds_read_b64_tr_b16 v[68:69], v92 offset:0
    v_mfma_f32_16x16x32_bf16 v[20:23], v[36:39], v[132:135], v[20:23]
    ds_read_b64_tr_b16 v[70:71], v240 offset:0
    v_mfma_f32_16x16x32_bf16 v[8:11], v[40:43], v[128:131], v[8:11]
    ds_read_b64_tr_b16 v[36:37], v93 offset:0
    v_mfma_f32_16x16x32_bf16 v[24:27], v[40:43], v[132:135], v[24:27]
    ds_read_b64_tr_b16 v[38:39], v241 offset:0
    buffer_load_dwordx4 v[120:123], v224, s[40:43], s70 offen offset:0 sc1
    v_mfma_f32_16x16x32_bf16 v[12:15], v[44:47], v[128:131], v[12:15]
    ds_read_b64_tr_b16 v[40:41], v94 offset:0
    v_mfma_f32_16x16x32_bf16 v[28:31], v[44:47], v[132:135], v[28:31]
    ds_read_b64_tr_b16 v[42:43], v242 offset:0
    v_mfma_f32_16x16x32_bf16 v[16:19], v[48:51], v[128:131], v[16:19]
    ds_read_b64_tr_b16 v[44:45], v95 offset:0
    v_mfma_f32_16x16x32_bf16 v[32:35], v[48:51], v[132:135], v[32:35]
    ds_read_b64_tr_b16 v[46:47], v243 offset:0
    buffer_load_dwordx4 v[124:127], v225, s[40:43], s70 offen offset:0 sc1
    s_waitcnt vmcnt(10) lgkmcnt(8)
    v_mfma_f32_16x16x32_bf16 v[4:7], v[52:55], v[136:139], v[4:7]
    ds_read_b64_tr_b16 v[48:49], v92 offset:4096
    v_mfma_f32_16x16x32_bf16 v[20:23], v[52:55], v[140:143], v[20:23]
    ds_read_b64_tr_b16 v[50:51], v240 offset:4096
    v_mfma_f32_16x16x32_bf16 v[8:11], v[56:59], v[136:139], v[8:11]
    ds_read_b64_tr_b16 v[52:53], v93 offset:4096
    v_mfma_f32_16x16x32_bf16 v[24:27], v[56:59], v[140:143], v[24:27]
    ds_read_b64_tr_b16 v[54:55], v241 offset:4096
    buffer_load_dwordx4 v[128:131], v224, s[40:43], s70 offen offset:1024 sc1
    v_mfma_f32_16x16x32_bf16 v[12:15], v[60:63], v[136:139], v[12:15]
    ds_read_b64_tr_b16 v[56:57], v94 offset:4096
    v_mfma_f32_16x16x32_bf16 v[28:31], v[60:63], v[140:143], v[28:31]
    ds_read_b64_tr_b16 v[58:59], v242 offset:4096
    v_mfma_f32_16x16x32_bf16 v[16:19], v[64:67], v[136:139], v[16:19]
    ds_read_b64_tr_b16 v[60:61], v95 offset:4096
    v_mfma_f32_16x16x32_bf16 v[32:35], v[64:67], v[140:143], v[32:35]
    ds_read_b64_tr_b16 v[62:63], v243 offset:4096
    buffer_load_dwordx4 v[132:135], v225, s[40:43], s70 offen offset:1024 sc1
    s_waitcnt vmcnt(10) lgkmcnt(8)
    v_mfma_f32_16x16x32_bf16 v[4:7], v[68:71], v[144:147], v[4:7]
    ds_read_b64_tr_b16 v[64:65], v92 offset:8448
    v_mfma_f32_16x16x32_bf16 v[20:23], v[68:71], v[148:151], v[20:23]
    ds_read_b64_tr_b16 v[66:67], v240 offset:8448
    v_mfma_f32_16x16x32_bf16 v[8:11], v[36:39], v[144:147], v[8:11]
    ds_read_b64_tr_b16 v[68:69], v93 offset:8448
    v_mfma_f32_16x16x32_bf16 v[24:27], v[36:39], v[148:151], v[24:27]
    ds_read_b64_tr_b16 v[70:71], v241 offset:8448
    buffer_load_dwordx4 v[136:139], v224, s[40:43], s70 offen offset:2048 sc1
    v_mfma_f32_16x16x32_bf16 v[12:15], v[40:43], v[144:147], v[12:15]
    ds_read_b64_tr_b16 v[36:37], v94 offset:8448
    v_mfma_f32_16x16x32_bf16 v[28:31], v[40:43], v[148:151], v[28:31]
    ds_read_b64_tr_b16 v[38:39], v242 offset:8448
    v_mfma_f32_16x16x32_bf16 v[16:19], v[44:47], v[144:147], v[16:19]
    ds_read_b64_tr_b16 v[40:41], v95 offset:8448
    v_mfma_f32_16x16x32_bf16 v[32:35], v[44:47], v[148:151], v[32:35]
    ds_read_b64_tr_b16 v[42:43], v243 offset:8448
    buffer_load_dwordx4 v[140:143], v225, s[40:43], s70 offen offset:2048 sc1
    s_waitcnt vmcnt(10) lgkmcnt(8)
    v_mfma_f32_16x16x32_bf16 v[4:7], v[48:51], v[96:99], v[4:7]
    ds_read_b64_tr_b16 v[44:45], v92 offset:12544
    v_mfma_f32_16x16x32_bf16 v[20:23], v[48:51], v[100:103], v[20:23]
    ds_read_b64_tr_b16 v[46:47], v240 offset:12544
    v_mfma_f32_16x16x32_bf16 v[8:11], v[52:55], v[96:99], v[8:11]
    ds_read_b64_tr_b16 v[48:49], v93 offset:12544
    v_mfma_f32_16x16x32_bf16 v[24:27], v[52:55], v[100:103], v[24:27]
    ds_read_b64_tr_b16 v[50:51], v241 offset:12544
    buffer_load_dwordx4 v[144:147], v224, s[40:43], s70 offen offset:3072 sc1
    v_mfma_f32_16x16x32_bf16 v[12:15], v[56:59], v[96:99], v[12:15]
    ds_read_b64_tr_b16 v[52:53], v94 offset:12544
    v_mfma_f32_16x16x32_bf16 v[28:31], v[56:59], v[100:103], v[28:31]
    ds_read_b64_tr_b16 v[54:55], v242 offset:12544
    v_mfma_f32_16x16x32_bf16 v[16:19], v[60:63], v[96:99], v[16:19]
    ds_read_b64_tr_b16 v[56:57], v95 offset:12544
    v_mfma_f32_16x16x32_bf16 v[32:35], v[60:63], v[100:103], v[32:35]
    ds_read_b64_tr_b16 v[58:59], v243 offset:12544
    buffer_load_dwordx4 v[148:151], v225, s[40:43], s70 offen offset:3072 sc1
    s_waitcnt vmcnt(10) lgkmcnt(8)
    v_mfma_f32_16x16x32_bf16 v[4:7], v[64:67], v[104:107], v[4:7]
    ds_read_b64_tr_b16 v[60:61], v92 offset:16896
    v_mfma_f32_16x16x32_bf16 v[20:23], v[64:67], v[108:111], v[20:23]
    ds_read_b64_tr_b16 v[62:63], v240 offset:16896
    v_mfma_f32_16x16x32_bf16 v[8:11], v[68:71], v[104:107], v[8:11]
    ds_read_b64_tr_b16 v[64:65], v93 offset:16896
    v_mfma_f32_16x16x32_bf16 v[24:27], v[68:71], v[108:111], v[24:27]
    ds_read_b64_tr_b16 v[66:67], v241 offset:16896
    buffer_load_dwordx4 v[96:99], v224, s[40:43], s71 offen offset:0 sc1
    v_mfma_f32_16x16x32_bf16 v[12:15], v[36:39], v[104:107], v[12:15]
    ds_read_b64_tr_b16 v[68:69], v94 offset:16896
    v_mfma_f32_16x16x32_bf16 v[28:31], v[36:39], v[108:111], v[28:31]
    ds_read_b64_tr_b16 v[70:71], v242 offset:16896
    v_mfma_f32_16x16x32_bf16 v[16:19], v[40:43], v[104:107], v[16:19]
    ds_read_b64_tr_b16 v[36:37], v95 offset:16896
    v_mfma_f32_16x16x32_bf16 v[32:35], v[40:43], v[108:111], v[32:35]
    ds_read_b64_tr_b16 v[38:39], v243 offset:16896
    buffer_load_dwordx4 v[100:103], v225, s[40:43], s71 offen offset:0 sc1
    s_waitcnt vmcnt(10) lgkmcnt(8)
    v_mfma_f32_16x16x32_bf16 v[4:7], v[44:47], v[112:115], v[4:7]
    ds_read_b64_tr_b16 v[40:41], v92 offset:20992
    v_mfma_f32_16x16x32_bf16 v[20:23], v[44:47], v[116:119], v[20:23]
    ds_read_b64_tr_b16 v[42:43], v240 offset:20992
    v_mfma_f32_16x16x32_bf16 v[8:11], v[48:51], v[112:115], v[8:11]
    ds_read_b64_tr_b16 v[44:45], v93 offset:20992
    v_mfma_f32_16x16x32_bf16 v[24:27], v[48:51], v[116:119], v[24:27]
    ds_read_b64_tr_b16 v[46:47], v241 offset:20992
    buffer_load_dwordx4 v[104:107], v224, s[40:43], s71 offen offset:1024 sc1
    v_mfma_f32_16x16x32_bf16 v[12:15], v[52:55], v[112:115], v[12:15]
    ds_read_b64_tr_b16 v[48:49], v94 offset:20992
    v_mfma_f32_16x16x32_bf16 v[28:31], v[52:55], v[116:119], v[28:31]
    ds_read_b64_tr_b16 v[50:51], v242 offset:20992
    v_mfma_f32_16x16x32_bf16 v[16:19], v[56:59], v[112:115], v[16:19]
    ds_read_b64_tr_b16 v[52:53], v95 offset:20992
    v_mfma_f32_16x16x32_bf16 v[32:35], v[56:59], v[116:119], v[32:35]
    ds_read_b64_tr_b16 v[54:55], v243 offset:20992
    buffer_load_dwordx4 v[108:111], v225, s[40:43], s71 offen offset:1024 sc1
    s_waitcnt vmcnt(10) lgkmcnt(8)
    v_mfma_f32_16x16x32_bf16 v[4:7], v[60:63], v[120:123], v[4:7]
    ds_read_b64_tr_b16 v[56:57], v92 offset:25344
    v_mfma_f32_16x16x32_bf16 v[20:23], v[60:63], v[124:127], v[20:23]
    ds_read_b64_tr_b16 v[58:59], v240 offset:25344
    v_mfma_f32_16x16x32_bf16 v[8:11], v[64:67], v[120:123], v[8:11]
    ds_read_b64_tr_b16 v[60:61], v93 offset:25344
    v_mfma_f32_16x16x32_bf16 v[24:27], v[64:67], v[124:127], v[24:27]
    ds_read_b64_tr_b16 v[62:63], v241 offset:25344
    buffer_load_dwordx4 v[112:115], v224, s[40:43], s71 offen offset:2048 sc1
    v_mfma_f32_16x16x32_bf16 v[12:15], v[68:71], v[120:123], v[12:15]
    ds_read_b64_tr_b16 v[64:65], v94 offset:25344
    v_mfma_f32_16x16x32_bf16 v[28:31], v[68:71], v[124:127], v[28:31]
    ds_read_b64_tr_b16 v[66:67], v242 offset:25344
    v_mfma_f32_16x16x32_bf16 v[16:19], v[36:39], v[120:123], v[16:19]
    ds_read_b64_tr_b16 v[68:69], v95 offset:25344
    v_mfma_f32_16x16x32_bf16 v[32:35], v[36:39], v[124:127], v[32:35]
    ds_read_b64_tr_b16 v[70:71], v243 offset:25344
    buffer_load_dwordx4 v[116:119], v225, s[40:43], s71 offen offset:2048 sc1
    s_waitcnt vmcnt(10) lgkmcnt(8)
    v_mfma_f32_16x16x32_bf16 v[4:7], v[40:43], v[128:131], v[4:7]
    ds_read_b64_tr_b16 v[36:37], v92 offset:29440
    v_mfma_f32_16x16x32_bf16 v[20:23], v[40:43], v[132:135], v[20:23]
    ds_read_b64_tr_b16 v[38:39], v240 offset:29440
    v_mfma_f32_16x16x32_bf16 v[8:11], v[44:47], v[128:131], v[8:11]
    ds_read_b64_tr_b16 v[40:41], v93 offset:29440
    v_mfma_f32_16x16x32_bf16 v[24:27], v[44:47], v[132:135], v[24:27]
    ds_read_b64_tr_b16 v[42:43], v241 offset:29440
    buffer_load_dwordx4 v[120:123], v224, s[40:43], s71 offen offset:3072 sc1
    v_mfma_f32_16x16x32_bf16 v[12:15], v[48:51], v[128:131], v[12:15]
    ds_read_b64_tr_b16 v[44:45], v94 offset:29440
    v_mfma_f32_16x16x32_bf16 v[28:31], v[48:51], v[132:135], v[28:31]
    ds_read_b64_tr_b16 v[46:47], v242 offset:29440
    v_mfma_f32_16x16x32_bf16 v[16:19], v[52:55], v[128:131], v[16:19]
    ds_read_b64_tr_b16 v[48:49], v95 offset:29440
    v_mfma_f32_16x16x32_bf16 v[32:35], v[52:55], v[132:135], v[32:35]
    ds_read_b64_tr_b16 v[50:51], v243 offset:29440
    buffer_load_dwordx4 v[124:127], v225, s[40:43], s71 offen offset:3072 sc1
    s_waitcnt vmcnt(10) lgkmcnt(8)
    v_mfma_f32_16x16x32_bf16 v[4:7], v[56:59], v[136:139], v[4:7]
    ds_read_b64_tr_b16 v[52:53], v84 offset:41984
    v_mfma_f32_16x16x32_bf16 v[20:23], v[56:59], v[140:143], v[20:23]
    ds_read_b64_tr_b16 v[54:55], v232 offset:41984
    v_mfma_f32_16x16x32_bf16 v[8:11], v[60:63], v[136:139], v[8:11]
    ds_read_b64_tr_b16 v[56:57], v85 offset:41984
    v_mfma_f32_16x16x32_bf16 v[24:27], v[60:63], v[140:143], v[24:27]
    ds_read_b64_tr_b16 v[58:59], v233 offset:41984
    v_mfma_f32_16x16x32_bf16 v[12:15], v[64:67], v[136:139], v[12:15]
    ds_read_b64_tr_b16 v[60:61], v86 offset:41984
    v_mfma_f32_16x16x32_bf16 v[28:31], v[64:67], v[140:143], v[28:31]
    ds_read_b64_tr_b16 v[62:63], v234 offset:41984
    v_mfma_f32_16x16x32_bf16 v[16:19], v[68:71], v[136:139], v[16:19]
    ds_read_b64_tr_b16 v[64:65], v87 offset:41984
    v_mfma_f32_16x16x32_bf16 v[32:35], v[68:71], v[140:143], v[32:35]
    ds_read_b64_tr_b16 v[66:67], v235 offset:41984
    s_waitcnt vmcnt(8) lgkmcnt(8)
    v_mfma_f32_16x16x32_bf16 v[4:7], v[36:39], v[144:147], v[4:7]
    ds_read_b64_tr_b16 v[68:69], v84 offset:46080
    v_mfma_f32_16x16x32_bf16 v[20:23], v[36:39], v[148:151], v[20:23]
    ds_read_b64_tr_b16 v[70:71], v232 offset:46080
    v_mfma_f32_16x16x32_bf16 v[8:11], v[40:43], v[144:147], v[8:11]
    ds_read_b64_tr_b16 v[36:37], v85 offset:46080
    v_mfma_f32_16x16x32_bf16 v[24:27], v[40:43], v[148:151], v[24:27]
    ds_read_b64_tr_b16 v[38:39], v233 offset:46080
    v_mfma_f32_16x16x32_bf16 v[12:15], v[44:47], v[144:147], v[12:15]
    ds_read_b64_tr_b16 v[40:41], v86 offset:46080
    v_mfma_f32_16x16x32_bf16 v[28:31], v[44:47], v[148:151], v[28:31]
    ds_read_b64_tr_b16 v[42:43], v234 offset:46080
    v_mfma_f32_16x16x32_bf16 v[16:19], v[48:51], v[144:147], v[16:19]
    ds_read_b64_tr_b16 v[44:45], v87 offset:46080
    v_mfma_f32_16x16x32_bf16 v[32:35], v[48:51], v[148:151], v[32:35]
    ds_read_b64_tr_b16 v[46:47], v235 offset:46080
    s_waitcnt vmcnt(6) lgkmcnt(8)
    v_mfma_f32_16x16x32_bf16 v[4:7], v[52:55], v[96:99], v[4:7]
    ds_read_b64_tr_b16 v[48:49], v84 offset:51200
    v_mfma_f32_16x16x32_bf16 v[20:23], v[52:55], v[100:103], v[20:23]
    ds_read_b64_tr_b16 v[50:51], v232 offset:51200
    v_mfma_f32_16x16x32_bf16 v[8:11], v[56:59], v[96:99], v[8:11]
    ds_read_b64_tr_b16 v[52:53], v85 offset:51200
    v_mfma_f32_16x16x32_bf16 v[24:27], v[56:59], v[100:103], v[24:27]
    ds_read_b64_tr_b16 v[54:55], v233 offset:51200
    v_mfma_f32_16x16x32_bf16 v[12:15], v[60:63], v[96:99], v[12:15]
    ds_read_b64_tr_b16 v[56:57], v86 offset:51200
    v_mfma_f32_16x16x32_bf16 v[28:31], v[60:63], v[100:103], v[28:31]
    ds_read_b64_tr_b16 v[58:59], v234 offset:51200
    v_mfma_f32_16x16x32_bf16 v[16:19], v[64:67], v[96:99], v[16:19]
    ds_read_b64_tr_b16 v[60:61], v87 offset:51200
    v_mfma_f32_16x16x32_bf16 v[32:35], v[64:67], v[100:103], v[32:35]
    ds_read_b64_tr_b16 v[62:63], v235 offset:51200
    s_waitcnt vmcnt(4) lgkmcnt(8)
    v_mfma_f32_16x16x32_bf16 v[4:7], v[68:71], v[104:107], v[4:7]
    ds_read_b64_tr_b16 v[64:65], v84 offset:55296
    v_mfma_f32_16x16x32_bf16 v[20:23], v[68:71], v[108:111], v[20:23]
    ds_read_b64_tr_b16 v[66:67], v232 offset:55296
    v_mfma_f32_16x16x32_bf16 v[8:11], v[36:39], v[104:107], v[8:11]
    ds_read_b64_tr_b16 v[68:69], v85 offset:55296
    v_mfma_f32_16x16x32_bf16 v[24:27], v[36:39], v[108:111], v[24:27]
    ds_read_b64_tr_b16 v[70:71], v233 offset:55296
    v_mfma_f32_16x16x32_bf16 v[12:15], v[40:43], v[104:107], v[12:15]
    ds_read_b64_tr_b16 v[36:37], v86 offset:55296
    v_mfma_f32_16x16x32_bf16 v[28:31], v[40:43], v[108:111], v[28:31]
    ds_read_b64_tr_b16 v[38:39], v234 offset:55296
    v_mfma_f32_16x16x32_bf16 v[16:19], v[44:47], v[104:107], v[16:19]
    ds_read_b64_tr_b16 v[40:41], v87 offset:55296
    v_mfma_f32_16x16x32_bf16 v[32:35], v[44:47], v[108:111], v[32:35]
    ds_read_b64_tr_b16 v[42:43], v235 offset:55296
    s_waitcnt vmcnt(2) lgkmcnt(8)
    v_mfma_f32_16x16x32_bf16 v[4:7], v[48:51], v[112:115], v[4:7]
    v_mfma_f32_16x16x32_bf16 v[8:11], v[52:55], v[112:115], v[8:11]
    v_mfma_f32_16x16x32_bf16 v[12:15], v[56:59], v[112:115], v[12:15]
    v_mfma_f32_16x16x32_bf16 v[16:19], v[60:63], v[112:115], v[16:19]
    s_waitcnt vmcnt(0) lgkmcnt(0)
    v_mfma_f32_16x16x32_bf16 v[4:7], v[64:67], v[120:123], v[4:7]
    s_nop 0
    s_nop 0
    v_mfma_f32_16x16x32_bf16 v[8:11], v[68:71], v[120:123], v[8:11]
    s_nop 0
    s_nop 0
    v_mfma_f32_16x16x32_bf16 v[12:15], v[36:39], v[120:123], v[12:15]
    s_nop 0
    s_nop 0
    v_cvt_pk_bf16_f32 v172, v4, v5
    v_cvt_pk_bf16_f32 v173, v6, v7
    v_mfma_f32_16x16x32_bf16 v[16:19], v[40:43], v[120:123], v[16:19]
    ds_write_b64 v244, v[172:173]
    v_cvt_pk_bf16_f32 v174, v8, v9
    v_mfma_f32_16x16x32_bf16 v[20:23], v[48:51], v[116:119], v[20:23]
    v_cvt_pk_bf16_f32 v175, v10, v11
    ds_write_b64 v245, v[174:175]
    v_mfma_f32_16x16x32_bf16 v[20:23], v[64:67], v[124:127], v[20:23]
    v_cvt_pk_bf16_f32 v176, v12, v13
    v_cvt_pk_bf16_f32 v177, v14, v15
    v_mfma_f32_16x16x32_bf16 v[24:27], v[52:55], v[116:119], v[24:27]
    ds_write_b64 v246, v[176:177]
    v_cvt_pk_bf16_f32 v178, v16, v17
    v_mfma_f32_16x16x32_bf16 v[24:27], v[68:71], v[124:127], v[24:27]
    v_cvt_pk_bf16_f32 v179, v18, v19
    ds_write_b64 v247, v[178:179]
    v_mfma_f32_16x16x32_bf16 v[28:31], v[56:59], v[116:119], v[28:31]
    ds_read_b128 v[188:191], v248 offset:0
    ds_read_b128 v[192:195], v248 offset:1024
    v_mfma_f32_16x16x32_bf16 v[28:31], v[36:39], v[124:127], v[28:31]
    v_cvt_pk_bf16_f32 v180, v20, v21
    v_cvt_pk_bf16_f32 v181, v22, v23
    v_mfma_f32_16x16x32_bf16 v[32:35], v[60:63], v[116:119], v[32:35]
    ds_write_b64 v244, v[180:181]
    v_cvt_pk_bf16_f32 v182, v24, v25
    v_mfma_f32_16x16x32_bf16 v[32:35], v[40:43], v[124:127], v[32:35]
    v_cvt_pk_bf16_f32 v183, v26, v27
    ds_write_b64 v245, v[182:183]
    v_cvt_pk_bf16_f32 v184, v28, v29
    v_cvt_pk_bf16_f32 v185, v30, v31
    s_mov_b32 s37, 0
    s_waitcnt lgkmcnt(3)
    buffer_store_dwordx4 v[188:191], v226, s[48:51], s37 offen nt
    s_mov_b32 s37, 65536
    s_waitcnt lgkmcnt(2)
    buffer_store_dwordx4 v[192:195], v226, s[48:51], s37 offen nt
    ds_write_b64 v246, v[184:185]
    v_cvt_pk_bf16_f32 v186, v32, v33
    v_cvt_pk_bf16_f32 v187, v34, v35
    ds_write_b64 v247, v[186:187]
    ds_read_b128 v[196:199], v248 offset:0
    ds_read_b128 v[200:203], v248 offset:1024
    s_mov_b32 s37, 131072
    s_waitcnt lgkmcnt(1)
    buffer_store_dwordx4 v[196:199], v226, s[48:51], s37 offen nt
    s_mov_b32 s37, 196608
    s_waitcnt lgkmcnt(0)
    buffer_store_dwordx4 v[200:203], v226, s[48:51], s37 offen nt
    s_endpgm
L_end:
    s_endpgm
.section .rodata,"a"
.p2align 6
.amdhsa_kernel concat_heads__ssm_conv_h3__sliding_local_dilated__prompt_kernel
  .amdhsa_next_free_vgpr 256
  .amdhsa_next_free_sgpr 102
  .amdhsa_accum_offset 256
  .amdhsa_group_segment_fixed_size 0
  .amdhsa_kernarg_size 96
  .amdhsa_user_sgpr_count 2
  .amdhsa_user_sgpr_kernarg_segment_ptr 1
  .amdhsa_system_sgpr_workgroup_id_x 1
  .amdhsa_float_denorm_mode_32 3
.end_amdhsa_kernel
```

```asm
; @launch grid=(256,1,1) block=(512,1,1) lds=163840
.amdgcn_target "amdgcn-amd-amdhsa--gfx950"
.text
.globl concat_heads__ssm_conv_h3__sliding_local_dilated__prompt_kernel
.p2align 8
.type concat_heads__ssm_conv_h3__sliding_local_dilated__prompt_kernel,@function
concat_heads__ssm_conv_h3__sliding_local_dilated__prompt_kernel:
L_entry:
    s_getpc_b64 s[32:33]
    s_cmp_ge_u32 s2, 256
    s_cbranch_scc1 L_end
    s_load_dwordx16 s[8:23], s[0:1], 0
    s_load_dwordx8 s[24:31], s[0:1], 64
    v_lshrrev_b32 v1, 6, v0
    s_and_b32 s4, s2, 1
    v_readfirstlane_b32 s3, v1
    v_and_b32 v0, 63, v0
    s_bfe_u32 s5, s2, 0x30003
    s_bfe_u32 s6, s2, 0x20001
    s_lshr_b32 s7, s2, 6
    s_lshl2_add_u32 s6, s6, s7
    s_cmp_ge_u32 s3, 4
    s_cbranch_scc1 L_crole
    s_bfe_u32 s34, s2, 0x20003
    s_lshl2_add_u32 s34, s34, s3
    s_lshl_b32 s34, s34, 7
    v_lshl_add_u32 v1, v0, 11, s34
    v_min_u32 v1, L_end-L_entry-8, v1
    s_mov_b64 exec, 0xffff
    global_load_dword v252, v1, s[32:33]
    s_mov_b64 exec, -1
    s_and_b32 s84, s2, 3
    s_lshl2_add_u32 s84, s84, s3
    s_bfe_u32 s85, s2, 0x50002
    s_lshl_b32 s87, s85, 10
    s_add_u32 s87, s87, s84
    s_lshl_b32 s87, s87, 7
    v_and_b32 v185, 7, v0
    v_lshl_add_u32 v185, v185, 4, s87
    v_lshrrev_b32 v184, 3, v0
    v_lshl_add_u32 v184, v184, 14, v185
    v_subrev_u32 v185, 6144, v184
    v_add_u32 v188, 4096, v184
    v_subrev_u32 v186, 4096, v184
    v_add_u32 v189, 8192, v184
    v_subrev_u32 v187, 2048, v184
    v_add_u32 v190, 12288, v184
    v_lshlrev_b32 v191, 4, v0
    s_lshl_b32 s86, s3, 9
    s_add_u32 m0, s86, 159744
    s_lshl_b32 s87, s84, 9
    s_waitcnt lgkmcnt(0)
    s_bitcmp0_b32 s2, 7
    s_cbranch_scc1 L_nokv
    s_mov_b32 s80, s14
    s_mov_b32 s81, s15
    s_mov_b32 s82, 0x2000
    s_mov_b32 s83, 0x20000
    s_mov_b32 s72, s10
    s_mov_b32 s73, s11
    s_mov_b32 s74, 0x400000
    s_mov_b32 s75, 0x20000
    s_mov_b32 exec_hi, 0
    buffer_load_dwordx4 v191, s[80:83], s87 offen lds
    s_mov_b64 exec, -1
    buffer_load_dwordx4 v[108:111], v185, s[72:75], 0 offen offset:0 nt
    buffer_load_dwordx4 v[112:115], v186, s[72:75], 0 offen offset:0 nt
    buffer_load_dwordx4 v[116:119], v187, s[72:75], 0 offen offset:0 nt
    buffer_load_dwordx4 v[120:123], v184, s[72:75], 0 offen offset:0 nt
    buffer_load_dwordx4 v[124:127], v184, s[72:75], 0 offen offset:2048 nt
    buffer_load_dwordx4 v[128:131], v188, s[72:75], 0 offen offset:0 nt
    buffer_load_dwordx4 v[132:135], v188, s[72:75], 0 offen offset:2048 nt
    buffer_load_dwordx4 v[136:139], v189, s[72:75], 0 offen offset:0 nt
    buffer_load_dwordx4 v[140:143], v189, s[72:75], 0 offen offset:2048 nt
    buffer_load_dwordx4 v[144:147], v190, s[72:75], 0 offen offset:0 nt
    buffer_load_dwordx4 v[148:151], v190, s[72:75], 0 offen offset:2048 nt
    s_mov_b32 s76, s12
    s_mov_b32 s77, s13
    s_mov_b32 s78, 0x400000
    s_mov_b32 s79, 0x20000
    buffer_load_dwordx4 v[152:155], v184, s[76:79], 0 offen offset:0 nt
    buffer_load_dwordx4 v[156:159], v184, s[76:79], 0 offen offset:2048 nt
    buffer_load_dwordx4 v[160:163], v188, s[76:79], 0 offen offset:0 nt
    buffer_load_dwordx4 v[164:167], v188, s[76:79], 0 offen offset:2048 nt
    buffer_load_dwordx4 v[168:171], v189, s[76:79], 0 offen offset:0 nt
    buffer_load_dwordx4 v[172:175], v189, s[76:79], 0 offen offset:2048 nt
    buffer_load_dwordx4 v[176:179], v190, s[76:79], 0 offen offset:0 nt
    buffer_load_dwordx4 v[180:183], v190, s[76:79], 0 offen offset:2048 nt
L_nokv:
    s_branch L_grole
L_crole:
    s_sub_u32 s70, s3, 4
    s_lshl_b32 s43, s70, 12
    s_lshl_b32 s44, s70, 11
    s_add_u32 s44, s44, 17408
    s_lshl_b32 s49, s70, 4
    s_lshl_b64 s[46:47], 0xffff, s49
    v_lshrrev_b32 v13, 3, v0
    v_and_b32 v14, 7, v0
    v_lshrrev_b32 v15, 4, v0
    s_lshl2_add_u32 s50, s5, s70
    s_lshl_b32 s50, s50, 6
    s_add_u32 s50, s50, s4
    s_lshl_b32 s50, s50, 11
    v_lshl_add_u32 v16, v13, 12, s50
    v_xor_b32 v17, v14, v15
    v_lshl_add_u32 v2, v17, 4, v16
    v_xor_b32 v3, 64, v2
    v_add_u32 v3, 31744, v3
    v_add_u32 v4, 63488, v2
    v_add_u32 v5, 63488, v3
    s_lshl_b32 s49, s5, 7
    s_sub_u32 s49, s49, 8
    s_max_i32 s49, s49, 0
    s_lshl1_add_u32 s49, s49, s4
    s_lshl_b32 s49, s49, 11
    v_lshl_add_u32 v16, v13, 12, s49
    v_lshlrev_b32 v17, 1, v15
    v_xor_b32 v18, v14, v13
    v_lshl_add_u32 v6, v18, 4, v16
    s_mul_i32 s49, s70, 768
    s_add_u32 s49, s49, s6
    s_lshl_b32 s49, s49, 7
    v_mul_u32_u24 v16, 6144, v13
    v_and_b32 v17, 2, v17
    v_xor_b32 v17, v14, v17
    v_lshlrev_b32 v17, 4, v17
    v_add3_u32 v7, v17, v16, s49
    v_xor_b32 v8, 64, v7
    v_add_u32 v8, 48128, v8
    v_add_u32 v9, 2048, v7
    v_add_u32 v10, 2048, v8
    v_add_u32 v11, 4096, v7
    v_add_u32 v12, 4096, v8
    s_movk_i32 s40, 0
    s_mov_b32 s41, 0
    s_lshr_b32 s90, s2, 3
    s_and_b32 s91, s3, 3
    s_lshl2_add_u32 s90, s90, s91
    s_and_b32 s91, s2, 6
    s_lshl3_add_u32 s88, s90, s91
    s_lshl1_add_u32 s88, s88, s4
    s_lshl_b32 s88, s88, 11
    s_and_b32 s89, s2, 7
    s_and_b32 s91, s90, 1
    s_lshl1_add_u32 s89, s89, s91
    s_lshr_b32 s90, s90, 1
    s_mul_i32 s90, s90, 48
    s_add_u32 s89, s89, s90
    s_lshl_b32 s89, s89, 7
    v_and_b32 v251, 1, v0
    v_lshlrev_b32 v251, 12, v251
    v_lshrrev_b32 v252, 1, v0
    v_lshl_add_u32 v251, v252, 7, v251
    v_lshrrev_b32 v250, 2, v0
    v_mul_u32_u24 v250, 393216, v250
    v_and_b32 v252, 3, v0
    v_lshl_add_u32 v252, v252, 11, v250
    s_waitcnt lgkmcnt(0)
    s_mov_b32 s32, s20
    s_mov_b32 s33, s21
    s_mov_b32 s34, 0x400000
    s_mov_b32 s35, 0x20000
    s_mov_b32 s36, s22
    s_mov_b32 s37, s23
    s_mov_b32 s38, 0x600000
    s_mov_b32 s39, 0x20000
    s_setprio 0
    s_and_b32 s73, s2, 7
    s_xor_b32 s73, s73, 2
    s_lshr_b32 s74, s2, 7
    s_lshl1_add_u32 s68, s73, s74
    s_bfe_u32 s69, s2, 0x40003
    s_lshl4_add_u32 s71, s68, s69
    s_lshl2_add_u32 s71, s71, s70
    s_mul_i32 s80, s70, 8448
    s_add_u32 s80, s80, 125952
    s_mul_i32 s81, s70, 9216
    s_add_u32 s81, s81, 41984
    s_add_u32 s52, s30, 0xe00000
    s_addc_u32 s53, s31, 0
    s_mov_b32 s54, 0x20000
    s_mov_b32 s55, 0x20000
    s_add_u32 s64, s30, 0x900000
    s_addc_u32 s65, s31, 0
    s_mov_b32 s66, 0x420000
    s_mov_b32 s67, 0x20000
    s_lshl_b32 s84, s71, 12
    s_mul_i32 s85, s71, 4224
    s_add_u32 s85, s85, 4194304
    s_lshr_b32 s72, s71, 1
    s_lshl_b32 s72, s72, 2
    s_load_dword s72, s[18:19], s72
    v_lshlrev_b32 v224, 4, v0
    v_mov_b32 v228, 0
    v_mov_b32 v229, 0
    v_mov_b32 v230, 0
    v_mov_b32 v231, 0
    v_mov_b32 v227, 134352
    v_mov_b32 v244, 1
    s_bfe_u32 s87, s2, 0x20006
    s_mov_b64 exec, 1
    ds_write_b128 v227, v[228:231]
    ds_write_b128 v227, v[228:231] offset:16
    ds_write_b128 v227, v[228:231] offset:32
    s_mov_b64 exec, -1
    s_lshr_b32 s7, s2, 6
    s_mul_i32 s90, s7, 1048576
    s_sub_u32 s88, s88, s90
    s_mul_i32 s90, s7, 98304
    s_sub_u32 s89, s89, s90
    v_lshrrev_b32 v20, 3, v0
    v_mul_u32_u24 v20, 1048064, v20
    v_add_u32 v251, v251, v20
    v_lshrrev_b32 v20, 4, v0
    v_mul_u32_u24 v20, 1474560, v20
    v_sub_u32 v252, v252, v20
    s_bitcmp0_b32 1, s87
    s_cbranch_scc1 L_stg_1
    s_add_u32 s6, s89, 0
    s_mov_b32 exec_lo, 0x70007
    s_mov_b32 exec_hi, 0x70007
    s_bfe_u32 s7, s89, 0x30007
    s_cmp_lg_u32 s7, 1
    s_cbranch_scc1 L_wx3_2
    buffer_load_dword v250, v252, s[36:39], s6 offen offset:256
L_wx3_2:
    buffer_load_dword v250, v252, s[36:39], s6 offen
    s_mov_b32 exec_lo, 0x3030303
    s_mov_b32 exec_hi, 0
    buffer_load_dword v250, v251, s[32:35], s88 offen offset:0
    s_mov_b64 exec, -1
L_stg_1:
    s_bitcmp0_b32 2, s87
    s_cbranch_scc1 L_stg_3
    s_add_u32 s6, s89, 393216
    s_mov_b32 exec_lo, 0x70007
    s_mov_b32 exec_hi, 0x70007
    s_bfe_u32 s7, s89, 0x30007
    s_cmp_lg_u32 s7, 1
    s_cbranch_scc1 L_wx3_4
    buffer_load_dword v250, v252, s[36:39], s6 offen offset:256
L_wx3_4:
    buffer_load_dword v250, v252, s[36:39], s6 offen
    s_mov_b32 exec_lo, 0x3030303
    s_mov_b32 exec_hi, 0
    buffer_load_dword v250, v251, s[32:35], s88 offen offset:128
    s_mov_b64 exec, -1
L_stg_3:
    s_add_u32 m0, s43, 0
    s_nop 0
    buffer_load_dwordx4 v2, s[32:35], s40 offen offset:0 lds
    s_add_u32 m0, s44, 0
    s_nop 0
    buffer_load_dwordx4 v7, s[36:39], s41 offen offset:0 lds
    buffer_load_dwordx4 v8, s[36:39], s41 offen offset:1024 lds
    s_add_u32 m0, s43, 0
    s_nop 0
    buffer_load_dwordx4 v3, s[32:35], s40 offen offset:1024 lds
    s_add_u32 m0, s44, 8192
    s_nop 0
    buffer_load_dwordx4 v9, s[36:39], s41 offen offset:0 lds
    buffer_load_dwordx4 v10, s[36:39], s41 offen offset:1024 lds
    s_add_u32 m0, s43, 0
    s_nop 0
    buffer_load_dwordx4 v4, s[32:35], s40 offen offset:2048 lds
    s_add_u32 m0, s44, 16384
    s_nop 0
    buffer_load_dwordx4 v11, s[36:39], s41 offen offset:0 lds
    buffer_load_dwordx4 v12, s[36:39], s41 offen offset:1024 lds
    s_add_u32 m0, s43, 0
    s_nop 0
    buffer_load_dwordx4 v5, s[32:35], s40 offen offset:3072 lds
    s_mov_b32 m0, 16384
    s_mov_b64 exec, s[46:47]
    buffer_load_dwordx4 v6, s[32:35], s40 offen lds
    s_mov_b64 exec, -1
    s_movk_i32 s40, 128
    s_mov_b32 s41, 393216
    s_add_u32 m0, s43, 41984
    s_nop 0
    buffer_load_dwordx4 v2, s[32:35], s40 offen offset:0 lds
    s_add_u32 m0, s44, 41984
    s_nop 0
    buffer_load_dwordx4 v7, s[36:39], s41 offen offset:0 lds
    buffer_load_dwordx4 v8, s[36:39], s41 offen offset:1024 lds
    s_add_u32 m0, s43, 41984
    s_nop 0
    buffer_load_dwordx4 v3, s[32:35], s40 offen offset:1024 lds
    s_add_u32 m0, s44, 50176
    s_nop 0
    buffer_load_dwordx4 v9, s[36:39], s41 offen offset:0 lds
    buffer_load_dwordx4 v10, s[36:39], s41 offen offset:1024 lds
    s_add_u32 m0, s43, 41984
    s_nop 0
    buffer_load_dwordx4 v4, s[32:35], s40 offen offset:2048 lds
    s_add_u32 m0, s44, 58368
    s_nop 0
    buffer_load_dwordx4 v11, s[36:39], s41 offen offset:0 lds
    buffer_load_dwordx4 v12, s[36:39], s41 offen offset:1024 lds
    s_add_u32 m0, s43, 41984
    s_nop 0
    buffer_load_dwordx4 v5, s[32:35], s40 offen offset:3072 lds
    s_mov_b32 m0, 58368
    s_mov_b64 exec, s[46:47]
    buffer_load_dwordx4 v6, s[32:35], s40 offen lds
    s_mov_b64 exec, -1
    s_movk_i32 s40, 256
    s_mov_b32 s41, 786432
    s_bitcmp0_b32 1, s87
    s_cbranch_scc1 L_stg_5
    s_add_u32 s6, s89, 786432
    s_mov_b32 exec_lo, 0x70007
    s_mov_b32 exec_hi, 0x70007
    s_bfe_u32 s7, s89, 0x30007
    s_cmp_lg_u32 s7, 1
    s_cbranch_scc1 L_wx3_6
    buffer_load_dword v250, v252, s[36:39], s6 offen offset:256
L_wx3_6:
    buffer_load_dword v250, v252, s[36:39], s6 offen
    s_mov_b32 exec_lo, 0x3030303
    s_mov_b32 exec_hi, 0
    buffer_load_dword v250, v251, s[32:35], s88 offen offset:256
    s_mov_b64 exec, -1
L_stg_5:
    s_bitcmp0_b32 2, s87
    s_cbranch_scc1 L_stg_7
    s_add_u32 s6, s89, 1179648
    s_mov_b32 exec_lo, 0x70007
    s_mov_b32 exec_hi, 0x70007
    s_bfe_u32 s7, s89, 0x30007
    s_cmp_lg_u32 s7, 1
    s_cbranch_scc1 L_wx3_8
    buffer_load_dword v250, v252, s[36:39], s6 offen offset:256
L_wx3_8:
    buffer_load_dword v250, v252, s[36:39], s6 offen
    s_mov_b32 exec_lo, 0x3030303
    s_mov_b32 exec_hi, 0
    buffer_load_dword v250, v251, s[32:35], s88 offen offset:384
    s_mov_b64 exec, -1
L_stg_7:
    s_lshr_b32 s74, s69, 2
    s_and_b32 s75, s69, 3
    s_lshl3_add_u32 s74, s74, s70
    s_lshl3_add_u32 s74, s74, s75
    s_lshl_b32 s74, s74, 3
    v_bfe_u32 v234, v0, 3, 1
    v_lshl_add_u32 v225, v234, 8, s74
    v_bfe_u32 v234, v0, 4, 1
    v_lshl_add_u32 v225, v234, 1, v225
    v_lshrrev_b32 v234, 5, v0
    v_lshl_add_u32 v225, v234, 5, v225
    s_lshl_b32 s74, s68, 7
    v_and_b32 v234, 7, v0
    v_lshl_add_u32 v234, v234, 4, s74
    v_lshl_add_u32 v226, v225, 12, v234
    v_lshl_add_u32 v225, v225, 11, v234
    v_and_b32 v234, 1, v0
    v_xor_b32 v234, 1, v234
    v_mul_u32_u24 v232, 4224, v234
    v_mul_u32_u24 v233, 4576, v234
    v_bfe_u32 v234, v0, 1, 3
    v_lshl_add_u32 v232, v234, 3, v232
    v_xor_b32 v234, 7, v234
    v_lshl_add_u32 v233, v234, 6, v233
    v_lshrrev_b32 v234, 4, v0
    v_lshl_add_u32 v232, v234, 4, v232
    v_lshl_add_u32 v233, v234, 4, v233
    v_add3_u32 v232, v232, s80, 8
    v_add_u32 v233, s81, v233
    s_waitcnt lgkmcnt(0)
    s_bitcmp1_b32 s71, 0
    s_cselect_b32 s74, 0, 16
    s_lshl_b32 s72, s72, s74
    s_and_b32 s72, s72, 0xffff0000
    v_and_b32 v235, 1, v0
    v_lshlrev_b32 v235, 4, v235
    v_lshrrev_b32 v235, v235, s72
    v_bfe_u32 v236, v0, 1, 3
    v_lshl_add_u32 v236, v234, 1, v236
    v_cmp_eq_u32 vcc, 7, v236
    v_mov_b32 v241, 0
    v_mov_b32 v243, 0
    v_cndmask_b32 v240, 0, v235, vcc
    v_cmp_eq_u32 vcc, 6, v236
    s_nop 1
    v_cndmask_b32 v242, 0, v235, vcc
    s_waitcnt vmcnt(13)
    s_bitcmp1_b32 3, s87
    s_cbranch_scc1 L_mw_9
    s_waitcnt vmcnt(11)
L_mw_9:
    s_barrier
    s_add_u32 m0, s43, 83968
    s_nop 0
    buffer_load_dwordx4 v2, s[32:35], s40 offen offset:0 lds
    s_add_u32 m0, s44, 83968
    s_nop 0
    buffer_load_dwordx4 v7, s[36:39], s41 offen offset:0 lds
    buffer_load_dwordx4 v8, s[36:39], s41 offen offset:1024 lds
    s_add_u32 m0, s43, 83968
    s_nop 0
    buffer_load_dwordx4 v3, s[32:35], s40 offen offset:1024 lds
    s_add_u32 m0, s44, 92160
    s_nop 0
    buffer_load_dwordx4 v9, s[36:39], s41 offen offset:0 lds
    buffer_load_dwordx4 v10, s[36:39], s41 offen offset:1024 lds
    s_add_u32 m0, s43, 83968
    s_nop 0
    buffer_load_dwordx4 v4, s[32:35], s40 offen offset:2048 lds
    s_add_u32 m0, s44, 100352
    s_nop 0
    buffer_load_dwordx4 v11, s[36:39], s41 offen offset:0 lds
    buffer_load_dwordx4 v12, s[36:39], s41 offen offset:1024 lds
    s_add_u32 m0, s43, 83968
    s_nop 0
    buffer_load_dwordx4 v5, s[32:35], s40 offen offset:3072 lds
    s_mov_b32 m0, 100352
    s_mov_b64 exec, s[46:47]
    buffer_load_dwordx4 v6, s[32:35], s40 offen lds
    s_mov_b64 exec, -1
    s_movk_i32 s40, 384
    s_mov_b32 s41, 1179648
    s_bitcmp0_b32 1, s87
    s_cbranch_scc1 L_stg_10
    s_add_u32 s6, s89, 1572864
    s_mov_b32 exec_lo, 0x770077
    s_mov_b32 exec_hi, 0x770077
    s_bfe_u32 s7, s89, 0x30007
    s_cmp_lg_u32 s7, 1
    s_cbranch_scc1 L_wx3_11
    buffer_load_dword v250, v252, s[36:39], s6 offen offset:256
L_wx3_11:
    buffer_load_dword v250, v252, s[36:39], s6 offen
    s_mov_b32 exec_lo, 0xf0f0f0f
    s_mov_b32 exec_hi, 0
    buffer_load_dword v250, v251, s[32:35], s88 offen offset:512
    s_mov_b64 exec, -1
L_stg_10:
    s_waitcnt vmcnt(15)
    s_bitcmp1_b32 1, s87
    s_cbranch_scc1 L_mw_12
    s_waitcnt vmcnt(13)
    s_bitcmp1_b32 3, s87
    s_cbranch_scc1 L_mw_12
    s_waitcnt vmcnt(11)
L_mw_12:
    s_barrier
    s_add_u32 m0, s43, 0
    s_nop 0
    buffer_load_dwordx4 v2, s[32:35], s40 offen offset:0 lds
    s_add_u32 m0, s44, 0
    s_nop 0
    buffer_load_dwordx4 v7, s[36:39], s41 offen offset:0 lds
    buffer_load_dwordx4 v8, s[36:39], s41 offen offset:1024 lds
    s_add_u32 m0, s43, 0
    s_nop 0
    buffer_load_dwordx4 v3, s[32:35], s40 offen offset:1024 lds
    s_add_u32 m0, s44, 8192
    s_nop 0
    buffer_load_dwordx4 v9, s[36:39], s41 offen offset:0 lds
    buffer_load_dwordx4 v10, s[36:39], s41 offen offset:1024 lds
    s_add_u32 m0, s43, 0
    s_nop 0
    buffer_load_dwordx4 v4, s[32:35], s40 offen offset:2048 lds
    s_add_u32 m0, s44, 16384
    s_nop 0
    buffer_load_dwordx4 v11, s[36:39], s41 offen offset:0 lds
    buffer_load_dwordx4 v12, s[36:39], s41 offen offset:1024 lds
    s_add_u32 m0, s43, 0
    s_nop 0
    buffer_load_dwordx4 v5, s[32:35], s40 offen offset:3072 lds
    s_mov_b32 m0, 16384
    s_mov_b64 exec, s[46:47]
    buffer_load_dwordx4 v6, s[32:35], s40 offen lds
    s_mov_b64 exec, -1
    s_movk_i32 s40, 512
    s_mov_b32 s41, 1572864
    s_bitcmp0_b32 2, s87
    s_cbranch_scc1 L_stg_13
    s_add_u32 s6, s89, 2359296
    s_mov_b32 exec_lo, 0x770077
    s_mov_b32 exec_hi, 0x770077
    s_bfe_u32 s7, s89, 0x30007
    s_cmp_lg_u32 s7, 1
    s_cbranch_scc1 L_wx3_14
    buffer_load_dword v250, v252, s[36:39], s6 offen offset:256
L_wx3_14:
    buffer_load_dword v250, v252, s[36:39], s6 offen
    s_mov_b32 exec_lo, 0xf0f0f0f
    s_mov_b32 exec_hi, 0
    buffer_load_dword v250, v251, s[32:35], s88 offen offset:768
    s_mov_b64 exec, -1
L_stg_13:
    s_waitcnt vmcnt(13)
    s_bitcmp1_b32 3, s87
    s_cbranch_scc1 L_mw_15
    s_waitcnt vmcnt(11)
L_mw_15:
    s_barrier
    s_add_u32 m0, s43, 41984
    s_nop 0
    buffer_load_dwordx4 v2, s[32:35], s40 offen offset:0 lds
    s_add_u32 m0, s44, 41984
    s_nop 0
    buffer_load_dwordx4 v7, s[36:39], s41 offen offset:0 lds
    buffer_load_dwordx4 v8, s[36:39], s41 offen offset:1024 lds
    s_add_u32 m0, s43, 41984
    s_nop 0
    buffer_load_dwordx4 v3, s[32:35], s40 offen offset:1024 lds
    s_add_u32 m0, s44, 50176
    s_nop 0
    buffer_load_dwordx4 v9, s[36:39], s41 offen offset:0 lds
    buffer_load_dwordx4 v10, s[36:39], s41 offen offset:1024 lds
    s_add_u32 m0, s43, 41984
    s_nop 0
    buffer_load_dwordx4 v4, s[32:35], s40 offen offset:2048 lds
    s_add_u32 m0, s44, 58368
    s_nop 0
    buffer_load_dwordx4 v11, s[36:39], s41 offen offset:0 lds
    buffer_load_dwordx4 v12, s[36:39], s41 offen offset:1024 lds
    s_add_u32 m0, s43, 41984
    s_nop 0
    buffer_load_dwordx4 v5, s[32:35], s40 offen offset:3072 lds
    s_mov_b32 m0, 58368
    s_mov_b64 exec, s[46:47]
    buffer_load_dwordx4 v6, s[32:35], s40 offen lds
    s_mov_b64 exec, -1
    s_movk_i32 s40, 640
    s_mov_b32 s41, 1966080
    s_waitcnt vmcnt(13)
    s_bitcmp1_b32 2, s87
    s_cbranch_scc1 L_mw_16
    s_waitcnt vmcnt(11)
L_mw_16:
    s_barrier
    s_add_u32 m0, s43, 83968
    s_nop 0
    buffer_load_dwordx4 v2, s[32:35], s40 offen offset:0 lds
    s_add_u32 m0, s44, 83968
    s_nop 0
    buffer_load_dwordx4 v7, s[36:39], s41 offen offset:0 lds
    buffer_load_dwordx4 v8, s[36:39], s41 offen offset:1024 lds
    s_add_u32 m0, s43, 83968
    s_nop 0
    buffer_load_dwordx4 v3, s[32:35], s40 offen offset:1024 lds
    s_add_u32 m0, s44, 92160
    s_nop 0
    buffer_load_dwordx4 v9, s[36:39], s41 offen offset:0 lds
    buffer_load_dwordx4 v10, s[36:39], s41 offen offset:1024 lds
    s_add_u32 m0, s43, 83968
    s_nop 0
    buffer_load_dwordx4 v4, s[32:35], s40 offen offset:2048 lds
    s_add_u32 m0, s44, 100352
    s_nop 0
    buffer_load_dwordx4 v11, s[36:39], s41 offen offset:0 lds
    buffer_load_dwordx4 v12, s[36:39], s41 offen offset:1024 lds
    s_add_u32 m0, s43, 83968
    s_nop 0
    buffer_load_dwordx4 v5, s[32:35], s40 offen offset:3072 lds
    s_mov_b32 m0, 100352
    s_mov_b64 exec, s[46:47]
    buffer_load_dwordx4 v6, s[32:35], s40 offen lds
    s_mov_b64 exec, -1
    s_movk_i32 s40, 768
    s_mov_b32 s41, 2359296
    s_bitcmp0_b32 1, s87
    s_cbranch_scc1 L_stg_17
    s_add_u32 s6, s89, 3145728
    s_mov_b32 exec_lo, 0x770077
    s_mov_b32 exec_hi, 0x770077
    s_bfe_u32 s7, s89, 0x30007
    s_cmp_lg_u32 s7, 1
    s_cbranch_scc1 L_wx3_18
    buffer_load_dword v250, v252, s[36:39], s6 offen offset:256
L_wx3_18:
    buffer_load_dword v250, v252, s[36:39], s6 offen
    s_mov_b32 exec_lo, 0xf0f0f0f
    s_mov_b32 exec_hi, 0
    buffer_load_dword v250, v251, s[32:35], s88 offen offset:1024
    s_mov_b64 exec, -1
L_stg_17:
    s_waitcnt vmcnt(13)
    s_bitcmp1_b32 1, s87
    s_cbranch_scc1 L_mw_19
    s_waitcnt vmcnt(11)
L_mw_19:
    s_barrier
    s_add_u32 m0, s43, 0
    s_nop 0
    buffer_load_dwordx4 v2, s[32:35], s40 offen offset:0 lds
    s_add_u32 m0, s44, 0
    s_nop 0
    buffer_load_dwordx4 v7, s[36:39], s41 offen offset:0 lds
    buffer_load_dwordx4 v8, s[36:39], s41 offen offset:1024 lds
    s_add_u32 m0, s43, 0
    s_nop 0
    buffer_load_dwordx4 v3, s[32:35], s40 offen offset:1024 lds
    s_add_u32 m0, s44, 8192
    s_nop 0
    buffer_load_dwordx4 v9, s[36:39], s41 offen offset:0 lds
    buffer_load_dwordx4 v10, s[36:39], s41 offen offset:1024 lds
    s_add_u32 m0, s43, 0
    s_nop 0
    buffer_load_dwordx4 v4, s[32:35], s40 offen offset:2048 lds
    s_add_u32 m0, s44, 16384
    s_nop 0
    buffer_load_dwordx4 v11, s[36:39], s41 offen offset:0 lds
    buffer_load_dwordx4 v12, s[36:39], s41 offen offset:1024 lds
    s_add_u32 m0, s43, 0
    s_nop 0
    buffer_load_dwordx4 v5, s[32:35], s40 offen offset:3072 lds
    s_mov_b32 m0, 16384
    s_mov_b64 exec, s[46:47]
    buffer_load_dwordx4 v6, s[32:35], s40 offen lds
    s_mov_b64 exec, -1
    s_movk_i32 s40, 896
    s_mov_b32 s41, 2752512
    s_bfe_u32 s74, s2, 0x20003
    s_lshl2_add_u32 s74, s74, s70
    s_cmp_lg_u32 s74, 0
    s_cbranch_scc1 L_sig_20
    s_mov_b32 s60, s28
    s_mov_b32 s61, s29
    s_mov_b32 s62, 0x100
    s_mov_b32 s63, 0x20000
    s_and_b32 s74, s2, 3
    s_lshl_b32 s74, s74, 6
    s_mov_b64 exec, 1
    buffer_atomic_add v244, off, s[60:63], s74 sc1
    s_mov_b64 exec, -1
L_sig_20:
    s_load_dwordx2 s[90:91], s[16:17], s84 offset:60
    s_load_dwordx2 s[90:91], s[16:17], s84 offset:188
    s_load_dwordx2 s[90:91], s[16:17], s84 offset:316
    s_load_dwordx2 s[90:91], s[16:17], s84 offset:444
    s_waitcnt vmcnt(13)
    s_bitcmp1_b32 1, s87
    s_cbranch_scc1 L_mw_21
    s_waitcnt vmcnt(11)
L_mw_21:
    s_barrier
    s_add_u32 m0, s43, 41984
    s_nop 0
    buffer_load_dwordx4 v2, s[32:35], s40 offen offset:0 lds
    s_add_u32 m0, s44, 41984
    s_nop 0
    buffer_load_dwordx4 v7, s[36:39], s41 offen offset:0 lds
    buffer_load_dwordx4 v8, s[36:39], s41 offen offset:1024 lds
    s_add_u32 m0, s43, 41984
    s_nop 0
    buffer_load_dwordx4 v3, s[32:35], s40 offen offset:1024 lds
    s_add_u32 m0, s44, 50176
    s_nop 0
    buffer_load_dwordx4 v9, s[36:39], s41 offen offset:0 lds
    buffer_load_dwordx4 v10, s[36:39], s41 offen offset:1024 lds
    s_add_u32 m0, s43, 41984
    s_nop 0
    buffer_load_dwordx4 v4, s[32:35], s40 offen offset:2048 lds
    s_add_u32 m0, s44, 58368
    s_nop 0
    buffer_load_dwordx4 v11, s[36:39], s41 offen offset:0 lds
    buffer_load_dwordx4 v12, s[36:39], s41 offen offset:1024 lds
    s_add_u32 m0, s43, 41984
    s_nop 0
    buffer_load_dwordx4 v5, s[32:35], s40 offen offset:3072 lds
    s_mov_b32 m0, 58368
    s_mov_b64 exec, s[46:47]
    buffer_load_dwordx4 v6, s[32:35], s40 offen lds
    s_mov_b64 exec, -1
    s_movk_i32 s40, 1024
    s_mov_b32 s41, 3145728
    s_bitcmp0_b32 2, s87
    s_cbranch_scc1 L_stg_22
    s_add_u32 s6, s89, 3932160
    s_mov_b32 exec_lo, 0x770077
    s_mov_b32 exec_hi, 0x770077
    s_bfe_u32 s7, s89, 0x30007
    s_cmp_lg_u32 s7, 1
    s_cbranch_scc1 L_wx3_23
    buffer_load_dword v250, v252, s[36:39], s6 offen offset:256
L_wx3_23:
    buffer_load_dword v250, v252, s[36:39], s6 offen
    s_mov_b32 exec_lo, 0xf0f0f0f
    s_mov_b32 exec_hi, 0
    buffer_load_dword v250, v251, s[32:35], s88 offen offset:1280
    s_mov_b64 exec, -1
L_stg_22:
    s_bfe_u32 s74, s2, 0x20003
    s_lshl2_add_u32 s74, s74, s70
    s_cmp_lg_u32 s74, 4
    s_cbranch_scc1 L_sig_24
    s_mov_b32 s60, s28
    s_mov_b32 s61, s29
    s_mov_b32 s62, 0x100
    s_mov_b32 s63, 0x20000
    s_and_b32 s74, s2, 3
    s_lshl_b32 s74, s74, 6
    s_mov_b64 exec, 1
    buffer_atomic_add v244, off, s[60:63], s74 sc1
    s_mov_b64 exec, -1
L_sig_24:
    s_load_dwordx2 s[90:91], s[16:17], s84 offset:572
    s_load_dwordx2 s[90:91], s[16:17], s84 offset:700
    s_load_dwordx2 s[90:91], s[16:17], s84 offset:828
    s_load_dwordx2 s[90:91], s[16:17], s84 offset:956
    s_waitcnt vmcnt(13)
    s_bitcmp1_b32 2, s87
    s_cbranch_scc1 L_mw_25
    s_waitcnt vmcnt(11)
L_mw_25:
    s_barrier
    s_add_u32 m0, s43, 83968
    s_nop 0
    buffer_load_dwordx4 v2, s[32:35], s40 offen offset:0 lds
    s_add_u32 m0, s44, 83968
    s_nop 0
    buffer_load_dwordx4 v7, s[36:39], s41 offen offset:0 lds
    buffer_load_dwordx4 v8, s[36:39], s41 offen offset:1024 lds
    s_add_u32 m0, s43, 83968
    s_nop 0
    buffer_load_dwordx4 v3, s[32:35], s40 offen offset:1024 lds
    s_add_u32 m0, s44, 92160
    s_nop 0
    buffer_load_dwordx4 v9, s[36:39], s41 offen offset:0 lds
    buffer_load_dwordx4 v10, s[36:39], s41 offen offset:1024 lds
    s_add_u32 m0, s43, 83968
    s_nop 0
    buffer_load_dwordx4 v4, s[32:35], s40 offen offset:2048 lds
    s_add_u32 m0, s44, 100352
    s_nop 0
    buffer_load_dwordx4 v11, s[36:39], s41 offen offset:0 lds
    buffer_load_dwordx4 v12, s[36:39], s41 offen offset:1024 lds
    s_add_u32 m0, s43, 83968
    s_nop 0
    buffer_load_dwordx4 v5, s[32:35], s40 offen offset:3072 lds
    s_mov_b32 m0, 100352
    s_mov_b64 exec, s[46:47]
    buffer_load_dwordx4 v6, s[32:35], s40 offen lds
    s_mov_b64 exec, -1
    s_movk_i32 s40, 1152
    s_mov_b32 s41, 3538944
    s_bfe_u32 s74, s2, 0x20003
    s_lshl2_add_u32 s74, s74, s70
    s_cmp_lg_u32 s74, 8
    s_cbranch_scc1 L_sig_26
    s_mov_b32 s60, s28
    s_mov_b32 s61, s29
    s_mov_b32 s62, 0x100
    s_mov_b32 s63, 0x20000
    s_and_b32 s74, s2, 3
    s_lshl_b32 s74, s74, 6
    s_mov_b64 exec, 1
    buffer_atomic_add v244, off, s[60:63], s74 sc1
    s_mov_b64 exec, -1
L_sig_26:
    s_load_dwordx2 s[90:91], s[16:17], s84 offset:1084
    s_load_dwordx2 s[90:91], s[16:17], s84 offset:1212
    s_load_dwordx2 s[90:91], s[16:17], s84 offset:1340
    s_load_dwordx2 s[90:91], s[16:17], s84 offset:1468
    s_waitcnt vmcnt(13)
    s_bitcmp1_b32 2, s87
    s_cbranch_scc1 L_mw_27
    s_waitcnt vmcnt(11)
L_mw_27:
    s_barrier
    s_add_u32 m0, s43, 0
    s_nop 0
    buffer_load_dwordx4 v2, s[32:35], s40 offen offset:0 lds
    s_add_u32 m0, s44, 0
    s_nop 0
    buffer_load_dwordx4 v7, s[36:39], s41 offen offset:0 lds
    buffer_load_dwordx4 v8, s[36:39], s41 offen offset:1024 lds
    s_add_u32 m0, s43, 0
    s_nop 0
    buffer_load_dwordx4 v3, s[32:35], s40 offen offset:1024 lds
    s_add_u32 m0, s44, 8192
    s_nop 0
    buffer_load_dwordx4 v9, s[36:39], s41 offen offset:0 lds
    buffer_load_dwordx4 v10, s[36:39], s41 offen offset:1024 lds
    s_add_u32 m0, s43, 0
    s_nop 0
    buffer_load_dwordx4 v4, s[32:35], s40 offen offset:2048 lds
    s_add_u32 m0, s44, 16384
    s_nop 0
    buffer_load_dwordx4 v11, s[36:39], s41 offen offset:0 lds
    buffer_load_dwordx4 v12, s[36:39], s41 offen offset:1024 lds
    s_add_u32 m0, s43, 0
    s_nop 0
    buffer_load_dwordx4 v5, s[32:35], s40 offen offset:3072 lds
    s_mov_b32 m0, 16384
    s_mov_b64 exec, s[46:47]
    buffer_load_dwordx4 v6, s[32:35], s40 offen lds
    s_mov_b64 exec, -1
    s_movk_i32 s40, 1280
    s_mov_b32 s41, 3932160
    s_bitcmp0_b32 1, s87
    s_cbranch_scc1 L_stg_28
    s_add_u32 s6, s89, 4718592
    s_mov_b32 exec_lo, 0x770077
    s_mov_b32 exec_hi, 0x770077
    s_bfe_u32 s7, s89, 0x30007
    s_cmp_lg_u32 s7, 1
    s_cbranch_scc1 L_wx3_29
    buffer_load_dword v250, v252, s[36:39], s6 offen offset:256
L_wx3_29:
    buffer_load_dword v250, v252, s[36:39], s6 offen
    s_mov_b32 exec_lo, 0xf0f0f0f
    s_mov_b32 exec_hi, 0
    buffer_load_dword v250, v251, s[32:35], s88 offen offset:1536
    s_mov_b64 exec, -1
L_stg_28:
    s_bfe_u32 s74, s2, 0x20003
    s_lshl2_add_u32 s74, s74, s70
    s_cmp_lg_u32 s74, 12
    s_cbranch_scc1 L_sig_30
    s_mov_b32 s60, s28
    s_mov_b32 s61, s29
    s_mov_b32 s62, 0x100
    s_mov_b32 s63, 0x20000
    s_and_b32 s74, s2, 3
    s_lshl_b32 s74, s74, 6
    s_mov_b64 exec, 1
    buffer_atomic_add v244, off, s[60:63], s74 sc1
    s_mov_b64 exec, -1
L_sig_30:
    s_load_dwordx2 s[90:91], s[16:17], s84 offset:1596
    s_load_dwordx2 s[90:91], s[16:17], s84 offset:1724
    s_load_dwordx2 s[90:91], s[16:17], s84 offset:1852
    s_load_dwordx2 s[90:91], s[16:17], s84 offset:1980
    s_waitcnt vmcnt(13)
    s_bitcmp1_b32 1, s87
    s_cbranch_scc1 L_mw_31
    s_waitcnt vmcnt(11)
L_mw_31:
    s_barrier
    s_add_u32 m0, s43, 41984
    s_nop 0
    buffer_load_dwordx4 v2, s[32:35], s40 offen offset:0 lds
    s_add_u32 m0, s44, 41984
    s_nop 0
    buffer_load_dwordx4 v7, s[36:39], s41 offen offset:0 lds
    buffer_load_dwordx4 v8, s[36:39], s41 offen offset:1024 lds
    s_add_u32 m0, s43, 41984
    s_nop 0
    buffer_load_dwordx4 v3, s[32:35], s40 offen offset:1024 lds
    s_add_u32 m0, s44, 50176
    s_nop 0
    buffer_load_dwordx4 v9, s[36:39], s41 offen offset:0 lds
    buffer_load_dwordx4 v10, s[36:39], s41 offen offset:1024 lds
    s_add_u32 m0, s43, 41984
    s_nop 0
    buffer_load_dwordx4 v4, s[32:35], s40 offen offset:2048 lds
    s_add_u32 m0, s44, 58368
    s_nop 0
    buffer_load_dwordx4 v11, s[36:39], s41 offen offset:0 lds
    buffer_load_dwordx4 v12, s[36:39], s41 offen offset:1024 lds
    s_add_u32 m0, s43, 41984
    s_nop 0
    buffer_load_dwordx4 v5, s[32:35], s40 offen offset:3072 lds
    s_mov_b32 m0, 58368
    s_mov_b64 exec, s[46:47]
    buffer_load_dwordx4 v6, s[32:35], s40 offen lds
    s_mov_b64 exec, -1
    s_movk_i32 s40, 1408
    s_mov_b32 s41, 4325376
    s_load_dwordx2 s[90:91], s[16:17], s84 offset:2108
    s_load_dwordx2 s[90:91], s[16:17], s84 offset:2236
    s_load_dwordx2 s[90:91], s[16:17], s84 offset:2364
    s_load_dwordx2 s[90:91], s[16:17], s84 offset:2492
    s_waitcnt vmcnt(13)
    s_bitcmp1_b32 1, s87
    s_cbranch_scc1 L_mw_32
    s_waitcnt vmcnt(11)
L_mw_32:
    s_barrier
    s_add_u32 m0, s43, 83968
    s_nop 0
    buffer_load_dwordx4 v2, s[32:35], s40 offen offset:0 lds
    s_add_u32 m0, s44, 83968
    s_nop 0
    buffer_load_dwordx4 v7, s[36:39], s41 offen offset:0 lds
    buffer_load_dwordx4 v8, s[36:39], s41 offen offset:1024 lds
    s_add_u32 m0, s43, 83968
    s_nop 0
    buffer_load_dwordx4 v3, s[32:35], s40 offen offset:1024 lds
    s_add_u32 m0, s44, 92160
    s_nop 0
    buffer_load_dwordx4 v9, s[36:39], s41 offen offset:0 lds
    buffer_load_dwordx4 v10, s[36:39], s41 offen offset:1024 lds
    s_add_u32 m0, s43, 83968
    s_nop 0
    buffer_load_dwordx4 v4, s[32:35], s40 offen offset:2048 lds
    s_add_u32 m0, s44, 100352
    s_nop 0
    buffer_load_dwordx4 v11, s[36:39], s41 offen offset:0 lds
    buffer_load_dwordx4 v12, s[36:39], s41 offen offset:1024 lds
    s_add_u32 m0, s43, 83968
    s_nop 0
    buffer_load_dwordx4 v5, s[32:35], s40 offen offset:3072 lds
    s_mov_b32 m0, 100352
    s_mov_b64 exec, s[46:47]
    buffer_load_dwordx4 v6, s[32:35], s40 offen lds
    s_mov_b64 exec, -1
    s_movk_i32 s40, 1536
    s_mov_b32 s41, 4718592
    s_bitcmp0_b32 2, s87
    s_cbranch_scc1 L_stg_33
    s_add_u32 s6, s89, 5505024
    s_mov_b32 exec_lo, 0x770077
    s_mov_b32 exec_hi, 0x770077
    s_bfe_u32 s7, s89, 0x30007
    s_cmp_lg_u32 s7, 1
    s_cbranch_scc1 L_wx3_34
    buffer_load_dword v250, v252, s[36:39], s6 offen offset:256
L_wx3_34:
    buffer_load_dword v250, v252, s[36:39], s6 offen
    s_mov_b32 exec_lo, 0xf0f0f0f
    s_mov_b32 exec_hi, 0
    buffer_load_dword v250, v251, s[32:35], s88 offen offset:1792
    s_mov_b64 exec, -1
L_stg_33:
    s_load_dwordx2 s[90:91], s[16:17], s84 offset:2620
    s_load_dwordx2 s[90:91], s[16:17], s84 offset:2748
    s_load_dwordx2 s[90:91], s[16:17], s84 offset:2876
    s_load_dwordx2 s[90:91], s[16:17], s84 offset:3004
    s_waitcnt vmcnt(13)
    s_bitcmp1_b32 2, s87
    s_cbranch_scc1 L_mw_35
    s_waitcnt vmcnt(11)
L_mw_35:
    s_barrier
    s_add_u32 m0, s43, 0
    s_nop 0
    buffer_load_dwordx4 v2, s[32:35], s40 offen offset:0 lds
    s_add_u32 m0, s44, 0
    s_nop 0
    buffer_load_dwordx4 v7, s[36:39], s41 offen offset:0 lds
    buffer_load_dwordx4 v8, s[36:39], s41 offen offset:1024 lds
    s_add_u32 m0, s43, 0
    s_nop 0
    buffer_load_dwordx4 v3, s[32:35], s40 offen offset:1024 lds
    s_add_u32 m0, s44, 8192
    s_nop 0
    buffer_load_dwordx4 v9, s[36:39], s41 offen offset:0 lds
    buffer_load_dwordx4 v10, s[36:39], s41 offen offset:1024 lds
    s_add_u32 m0, s43, 0
    s_nop 0
    buffer_load_dwordx4 v4, s[32:35], s40 offen offset:2048 lds
    s_add_u32 m0, s44, 16384
    s_nop 0
    buffer_load_dwordx4 v11, s[36:39], s41 offen offset:0 lds
    buffer_load_dwordx4 v12, s[36:39], s41 offen offset:1024 lds
    s_add_u32 m0, s43, 0
    s_nop 0
    buffer_load_dwordx4 v5, s[32:35], s40 offen offset:3072 lds
    s_mov_b32 m0, 16384
    s_mov_b64 exec, s[46:47]
    buffer_load_dwordx4 v6, s[32:35], s40 offen lds
    s_mov_b64 exec, -1
    s_movk_i32 s40, 1664
    s_mov_b32 s41, 5111808
    s_load_dwordx2 s[90:91], s[16:17], s84 offset:3132
    s_load_dwordx2 s[90:91], s[16:17], s84 offset:3260
    s_load_dwordx2 s[90:91], s[16:17], s84 offset:3388
    s_load_dwordx2 s[90:91], s[16:17], s84 offset:3516
    s_waitcnt vmcnt(13)
    s_bitcmp1_b32 2, s87
    s_cbranch_scc1 L_mw_36
    s_waitcnt vmcnt(11)
L_mw_36:
    s_barrier
    s_add_u32 m0, s43, 41984
    s_nop 0
    buffer_load_dwordx4 v2, s[32:35], s40 offen offset:0 lds
    s_add_u32 m0, s44, 41984
    s_nop 0
    buffer_load_dwordx4 v7, s[36:39], s41 offen offset:0 lds
    buffer_load_dwordx4 v8, s[36:39], s41 offen offset:1024 lds
    s_add_u32 m0, s43, 41984
    s_nop 0
    buffer_load_dwordx4 v3, s[32:35], s40 offen offset:1024 lds
    s_add_u32 m0, s44, 50176
    s_nop 0
    buffer_load_dwordx4 v9, s[36:39], s41 offen offset:0 lds
    buffer_load_dwordx4 v10, s[36:39], s41 offen offset:1024 lds
    s_add_u32 m0, s43, 41984
    s_nop 0
    buffer_load_dwordx4 v4, s[32:35], s40 offen offset:2048 lds
    s_add_u32 m0, s44, 58368
    s_nop 0
    buffer_load_dwordx4 v11, s[36:39], s41 offen offset:0 lds
    buffer_load_dwordx4 v12, s[36:39], s41 offen offset:1024 lds
    s_add_u32 m0, s43, 41984
    s_nop 0
    buffer_load_dwordx4 v5, s[32:35], s40 offen offset:3072 lds
    s_mov_b32 m0, 58368
    s_mov_b64 exec, s[46:47]
    buffer_load_dwordx4 v6, s[32:35], s40 offen lds
    s_mov_b64 exec, -1
    s_movk_i32 s40, 1792
    s_mov_b32 s41, 5505024
    s_load_dwordx2 s[90:91], s[16:17], s84 offset:3644
    s_load_dwordx2 s[90:91], s[16:17], s84 offset:3772
    s_load_dwordx2 s[90:91], s[16:17], s84 offset:3900
    s_load_dwordx2 s[90:91], s[16:17], s84 offset:4028
    s_waitcnt vmcnt(11)
    s_barrier
    s_add_u32 m0, s43, 83968
    s_nop 0
    buffer_load_dwordx4 v2, s[32:35], s40 offen offset:0 lds
    s_add_u32 m0, s44, 83968
    s_nop 0
    buffer_load_dwordx4 v7, s[36:39], s41 offen offset:0 lds
    buffer_load_dwordx4 v8, s[36:39], s41 offen offset:1024 lds
    s_add_u32 m0, s43, 83968
    s_nop 0
    buffer_load_dwordx4 v3, s[32:35], s40 offen offset:1024 lds
    s_add_u32 m0, s44, 92160
    s_nop 0
    buffer_load_dwordx4 v9, s[36:39], s41 offen offset:0 lds
    buffer_load_dwordx4 v10, s[36:39], s41 offen offset:1024 lds
    s_add_u32 m0, s43, 83968
    s_nop 0
    buffer_load_dwordx4 v4, s[32:35], s40 offen offset:2048 lds
    s_add_u32 m0, s44, 100352
    s_nop 0
    buffer_load_dwordx4 v11, s[36:39], s41 offen offset:0 lds
    buffer_load_dwordx4 v12, s[36:39], s41 offen offset:1024 lds
    s_add_u32 m0, s43, 83968
    s_nop 0
    buffer_load_dwordx4 v5, s[32:35], s40 offen offset:3072 lds
    s_mov_b32 m0, 100352
    s_mov_b64 exec, s[46:47]
    buffer_load_dwordx4 v6, s[32:35], s40 offen lds
    s_mov_b64 exec, -1
    s_movk_i32 s40, 1920
    s_mov_b32 s41, 5898240
    s_waitcnt vmcnt(11)
    s_barrier
    s_load_dword s4, s[28:29], 0
    s_load_dword s5, s[28:29], 64
    s_load_dword s6, s[28:29], 128
    s_load_dword s7, s[28:29], 192
    s_add_u32 m0, s43, 0
    s_nop 0
    buffer_load_dwordx4 v2, s[32:35], s40 offen offset:0 lds
    s_add_u32 m0, s44, 0
    s_nop 0
    buffer_load_dwordx4 v7, s[36:39], s41 offen offset:0 lds
    buffer_load_dwordx4 v8, s[36:39], s41 offen offset:1024 lds
    s_add_u32 m0, s43, 0
    s_nop 0
    buffer_load_dwordx4 v3, s[32:35], s40 offen offset:1024 lds
    s_add_u32 m0, s44, 8192
    s_nop 0
    buffer_load_dwordx4 v9, s[36:39], s41 offen offset:0 lds
    buffer_load_dwordx4 v10, s[36:39], s41 offen offset:1024 lds
    s_add_u32 m0, s43, 0
    s_nop 0
    buffer_load_dwordx4 v4, s[32:35], s40 offen offset:2048 lds
    s_add_u32 m0, s44, 16384
    s_nop 0
    buffer_load_dwordx4 v11, s[36:39], s41 offen offset:0 lds
    buffer_load_dwordx4 v12, s[36:39], s41 offen offset:1024 lds
    s_add_u32 m0, s43, 0
    s_nop 0
    buffer_load_dwordx4 v5, s[32:35], s40 offen offset:3072 lds
    s_mov_b32 m0, 16384
    s_mov_b64 exec, s[46:47]
    buffer_load_dwordx4 v6, s[32:35], s40 offen lds
    s_mov_b64 exec, -1
    s_movk_i32 s40, 2048
    s_mov_b32 s41, 6291456
    s_mov_b32 s60, s8
    s_mov_b32 s61, s9
    s_mov_b32 s62, 0x400000
    s_mov_b32 s63, 0x20000
    s_movk_i32 s75, 8192
    buffer_load_dwordx4 v[208:211], v225, s[60:63], 0 offen offset:0 nt
    buffer_load_dwordx4 v[212:215], v225, s[60:63], 0 offen offset:2048 nt
    buffer_load_dwordx4 v[216:219], v225, s[60:63], s75 offen offset:0 nt
    buffer_load_dwordx4 v[220:223], v225, s[60:63], s75 offen offset:2048 nt
    s_cmp_lg_u32 s70, 0
    s_cbranch_scc1 L_pc_done_39
    s_waitcnt lgkmcnt(0)
    s_min_u32 s4, s4, s5
    s_min_u32 s6, s6, s7
    s_min_u32 s4, s4, s6
    s_cmp_ge_u32 s4, 64
    s_cbranch_scc1 L_pc_done_39
    s_mov_b32 s60, s28
    s_mov_b32 s61, s29
    s_mov_b32 s62, 0x100
    s_mov_b32 s63, 0x20000
    v_lshlrev_b32 v20, 6, v0
    s_mov_b32 s74, 131072
    s_mov_b64 exec, 0xf
L_pc_loop_40:
    buffer_load_dword v21, v20, s[60:63], 0 offen sc1
    s_waitcnt vmcnt(0)
    v_cmp_gt_u32 vcc, 64, v21
    s_cbranch_vccz L_pc_done_39
    s_sleep 4
    s_sub_u32 s74, s74, 1
    s_cbranch_scc0 L_pc_loop_40
L_pc_done_39:
    s_mov_b64 exec, -1
    s_waitcnt vmcnt(15)
    s_barrier
    s_waitcnt vmcnt(4)
    s_mov_b64 exec, 1
    ds_add_u32 v227, v244 offset:24
    s_mov_b64 exec, -1
    s_add_u32 s56, s30, s85
    s_addc_u32 s57, s31, 0
    s_movk_i32 s58, 4096
    s_mov_b32 s59, 0x20000
    s_add_u32 m0, s81, 0
    s_nop 0
    buffer_load_dwordx4 v224, s[56:59], 0 offen offset:0 sc1 lds
    buffer_load_dwordx4 v224, s[56:59], 0 offen offset:1024 sc1 lds
    buffer_load_dwordx4 v224, s[56:59], 0 offen offset:2048 sc1 lds
    buffer_load_dwordx4 v224, s[56:59], 0 offen offset:3072 sc1 lds
    s_add_u32 m0, s81, 4572
    s_nop 0
    buffer_load_dwordx4 v224, s[56:59], 0 offen offset:0 sc1 lds
    buffer_load_dwordx4 v224, s[56:59], 0 offen offset:1024 sc1 lds
    buffer_load_dwordx4 v224, s[56:59], 0 offen offset:2048 sc1 lds
    buffer_load_dwordx4 v224, s[56:59], 0 offen offset:3072 sc1 lds
    s_add_u32 s56, s16, s84
    s_addc_u32 s57, s17, 0
    s_movk_i32 s58, 4096
    s_mov_b32 s59, 0x20000
    s_add_u32 m0, s80, 64
    v_mov_b32 v180, 0
    v_mov_b32 v181, 0
    v_mov_b32 v182, 0
    v_mov_b32 v183, 0
    buffer_load_dwordx4 v224, s[56:59], 0 offen offset:0 lds
    buffer_load_dwordx4 v224, s[56:59], 0 offen offset:1024 lds
    buffer_load_dwordx4 v224, s[56:59], 0 offen offset:2048 lds
    buffer_load_dwordx4 v224, s[56:59], 0 offen offset:3072 lds
    s_add_u32 m0, s80, 4304
    s_mov_b64 exec, 0x100
    buffer_load_dwordx4 v[180:183], off, s[56:59], 0
    s_mov_b64 exec, -1
    buffer_load_dwordx4 v224, s[56:59], 14 offen offset:0 lds
    buffer_load_dwordx4 v224, s[56:59], 14 offen offset:1024 lds
    buffer_load_dwordx4 v224, s[56:59], 14 offen offset:2048 lds
    buffer_load_dwordx4 v224, s[56:59], 14 offen offset:3072 lds
    v_lshrrev_b32 v234, 5, v0
    v_mul_u32_u24 v234, 4064, v234
    v_add3_u32 v234, v234, v224, s81
    s_mov_b32 exec_lo, 0xfffffff
    s_mov_b32 exec_hi, 0xfffffff
    ds_write_b128 v234, v[228:231] offset:4096
    s_mov_b64 exec, 1
    ds_write_b32 v234, v228 offset:8668
    s_mov_b64 exec, -1
    s_setprio 3
    s_waitcnt vmcnt(9)
    s_mov_b32 s60, s24
    s_mov_b32 s61, s25
    s_mov_b32 s62, 0x200000
    s_mov_b32 s63, 0x20000
    s_lshr_b32 s74, s2, 3
    s_lshl2_add_u32 s74, s74, s70
    s_bfe_u32 s75, s2, 0x10002
    s_lshl4_add_u32 s74, s74, s75
    s_lshl_b32 s74, s74, 10
    v_lshrrev_b32 v234, 3, v0
    v_and_b32 v235, 7, v0
    v_lshlrev_b32 v235, 7, v235
    v_lshl_add_u32 v234, v234, 11, v235
    buffer_load_dword v250, v234, s[60:63], s74 offen
    s_waitcnt vmcnt(1)
    v_cmp_lt_u32 vcc, 3, v0
    v_mov_b32 v188, 4160
    v_lshlrev_b32 v184, 16, v180
    v_cndmask_b32 v188, 0, v188, vcc
    v_alignbit_b32 v185, v181, v180, 16
    v_alignbit_b32 v186, v182, v181, 16
    v_alignbit_b32 v187, v183, v182, 16
    v_add3_u32 v188, v188, v224, s80
    s_mov_b64 exec, 0x1ff
    ds_write_b128 v188, v[184:187]
    s_mov_b64 exec, -1
    ds_read_b128 v[112:115], v233 offset:3584
    ds_read_b128 v[116:119], v233 offset:3072
    ds_read_b128 v[120:123], v233 offset:2560
    ds_read_b128 v[124:127], v233 offset:2048
    ds_read_b128 v[128:131], v233 offset:1536
    ds_read_b128 v[132:135], v233 offset:1024
    ds_read_b128 v[136:139], v233 offset:512
    ds_read_b128 v[140:143], v233 offset:0
    ds_read_b64 v[48:49], v232 offset:0
    ds_read_b64 v[50:51], v232 offset:8
    ds_read_b64 v[52:53], v232 offset:512
    ds_read_b64 v[54:55], v232 offset:520
    ds_read_b64 v[56:57], v232 offset:1024
    ds_read_b64 v[58:59], v232 offset:1032
    ds_read_b64 v[60:61], v232 offset:1536
    ds_read_b64 v[62:63], v232 offset:1544
    ds_read_b64 v[64:65], v232 offset:2048
    ds_read_b64 v[66:67], v232 offset:2056
    ds_read_b64 v[68:69], v232 offset:2560
    ds_read_b64 v[70:71], v232 offset:2568
    ds_read_b64 v[72:73], v232 offset:3072
    ds_read_b64 v[74:75], v232 offset:3080
    ds_read_b64 v[76:77], v232 offset:3584
    ds_read_b64 v[78:79], v232 offset:3592
    s_setprio 1
    s_mov_b32 s74, 3
    s_waitcnt lgkmcnt(14)
    v_mfma_f32_16x16x32_bf16 v[16:19], v[240:243], v[112:115], 0
    v_mfma_f32_16x16x32_bf16 v[20:23], v[240:243], v[116:119], 0
    v_mfma_f32_16x16x32_bf16 v[24:27], v[240:243], v[120:123], 0
    v_mfma_f32_16x16x32_bf16 v[28:31], v[240:243], v[124:127], 0
    v_mfma_f32_16x16x32_bf16 v[32:35], v[240:243], v[128:131], 0
    v_mfma_f32_16x16x32_bf16 v[36:39], v[240:243], v[132:135], 0
    v_mfma_f32_16x16x32_bf16 v[40:43], v[240:243], v[136:139], 0
    v_mfma_f32_16x16x32_bf16 v[44:47], v[240:243], v[140:143], 0
    s_waitcnt lgkmcnt(0)
L_conv:
    v_mfma_f32_16x16x32_bf16 v[16:19], v[48:51], v[112:115], v[16:19]
    ds_read_b128 v[144:147], v233 offset:3648
    v_mfma_f32_16x16x32_bf16 v[20:23], v[48:51], v[116:119], v[20:23]
    ds_read_b64 v[80:81], v232 offset:64
    v_mfma_f32_16x16x32_bf16 v[20:23], v[52:55], v[112:115], v[20:23]
    ds_read_b64 v[82:83], v232 offset:72
    v_mfma_f32_16x16x32_bf16 v[24:27], v[48:51], v[120:123], v[24:27]
    ds_read_b128 v[148:151], v233 offset:3136
    v_mfma_f32_16x16x32_bf16 v[24:27], v[52:55], v[116:119], v[24:27]
    ds_read_b64 v[84:85], v232 offset:576
    v_mfma_f32_16x16x32_bf16 v[24:27], v[56:59], v[112:115], v[24:27]
    ds_read_b64 v[86:87], v232 offset:584
    v_mfma_f32_16x16x32_bf16 v[28:31], v[48:51], v[124:127], v[28:31]
    ds_read_b128 v[152:155], v233 offset:2624
    v_mfma_f32_16x16x32_bf16 v[28:31], v[52:55], v[120:123], v[28:31]
    ds_read_b64 v[88:89], v232 offset:1088
    v_mfma_f32_16x16x32_bf16 v[28:31], v[56:59], v[116:119], v[28:31]
    ds_read_b64 v[90:91], v232 offset:1096
    v_mfma_f32_16x16x32_bf16 v[28:31], v[60:63], v[112:115], v[28:31]
    ds_read_b128 v[156:159], v233 offset:2112
    v_mfma_f32_16x16x32_bf16 v[32:35], v[48:51], v[128:131], v[32:35]
    ds_read_b64 v[92:93], v232 offset:1600
    v_mfma_f32_16x16x32_bf16 v[32:35], v[52:55], v[124:127], v[32:35]
    ds_read_b64 v[94:95], v232 offset:1608
    v_mfma_f32_16x16x32_bf16 v[32:35], v[56:59], v[120:123], v[32:35]
    ds_read_b128 v[160:163], v233 offset:1600
    v_mfma_f32_16x16x32_bf16 v[32:35], v[60:63], v[116:119], v[32:35]
    ds_read_b64 v[96:97], v232 offset:2112
    v_mfma_f32_16x16x32_bf16 v[32:35], v[64:67], v[112:115], v[32:35]
    ds_read_b64 v[98:99], v232 offset:2120
    v_mfma_f32_16x16x32_bf16 v[36:39], v[48:51], v[132:135], v[36:39]
    ds_read_b128 v[164:167], v233 offset:1088
    v_mfma_f32_16x16x32_bf16 v[36:39], v[52:55], v[128:131], v[36:39]
    ds_read_b64 v[100:101], v232 offset:2624
    v_mfma_f32_16x16x32_bf16 v[36:39], v[56:59], v[124:127], v[36:39]
    ds_read_b64 v[102:103], v232 offset:2632
    v_mfma_f32_16x16x32_bf16 v[36:39], v[60:63], v[120:123], v[36:39]
    ds_read_b128 v[168:171], v233 offset:576
    v_mfma_f32_16x16x32_bf16 v[36:39], v[64:67], v[116:119], v[36:39]
    ds_read_b64 v[104:105], v232 offset:3136
    v_mfma_f32_16x16x32_bf16 v[36:39], v[68:71], v[112:115], v[36:39]
    ds_read_b64 v[106:107], v232 offset:3144
    v_mfma_f32_16x16x32_bf16 v[40:43], v[48:51], v[136:139], v[40:43]
    ds_read_b128 v[172:175], v233 offset:64
    v_mfma_f32_16x16x32_bf16 v[40:43], v[52:55], v[132:135], v[40:43]
    ds_read_b64 v[108:109], v232 offset:3648
    v_mfma_f32_16x16x32_bf16 v[40:43], v[56:59], v[128:131], v[40:43]
    ds_read_b64 v[110:111], v232 offset:3656
    v_mfma_f32_16x16x32_bf16 v[40:43], v[60:63], v[124:127], v[40:43]
    v_mfma_f32_16x16x32_bf16 v[40:43], v[64:67], v[120:123], v[40:43]
    v_mfma_f32_16x16x32_bf16 v[40:43], v[68:71], v[116:119], v[40:43]
    v_mfma_f32_16x16x32_bf16 v[40:43], v[72:75], v[112:115], v[40:43]
    v_mfma_f32_16x16x32_bf16 v[44:47], v[48:51], v[140:143], v[44:47]
    v_mfma_f32_16x16x32_bf16 v[44:47], v[52:55], v[136:139], v[44:47]
    v_mfma_f32_16x16x32_bf16 v[44:47], v[56:59], v[132:135], v[44:47]
    v_mfma_f32_16x16x32_bf16 v[44:47], v[60:63], v[128:131], v[44:47]
    v_mfma_f32_16x16x32_bf16 v[44:47], v[64:67], v[124:127], v[44:47]
    v_mfma_f32_16x16x32_bf16 v[44:47], v[68:71], v[120:123], v[44:47]
    v_mfma_f32_16x16x32_bf16 v[44:47], v[72:75], v[116:119], v[44:47]
    v_mfma_f32_16x16x32_bf16 v[44:47], v[76:79], v[112:115], v[44:47]
    s_waitcnt lgkmcnt(0)
    v_mfma_f32_16x16x32_bf16 v[16:19], v[80:83], v[144:147], v[16:19]
    ds_read_b128 v[112:115], v233 offset:3712
    v_mfma_f32_16x16x32_bf16 v[20:23], v[80:83], v[148:151], v[20:23]
    ds_read_b64 v[48:49], v232 offset:128
    v_mfma_f32_16x16x32_bf16 v[20:23], v[84:87], v[144:147], v[20:23]
    ds_read_b64 v[50:51], v232 offset:136
    v_mfma_f32_16x16x32_bf16 v[24:27], v[80:83], v[152:155], v[24:27]
    ds_read_b128 v[116:119], v233 offset:3200
    v_mfma_f32_16x16x32_bf16 v[24:27], v[84:87], v[148:151], v[24:27]
    ds_read_b64 v[52:53], v232 offset:640
    v_mfma_f32_16x16x32_bf16 v[24:27], v[88:91], v[144:147], v[24:27]
    ds_read_b64 v[54:55], v232 offset:648
    v_mfma_f32_16x16x32_bf16 v[28:31], v[80:83], v[156:159], v[28:31]
    ds_read_b128 v[120:123], v233 offset:2688
    v_mfma_f32_16x16x32_bf16 v[28:31], v[84:87], v[152:155], v[28:31]
    ds_read_b64 v[56:57], v232 offset:1152
    v_mfma_f32_16x16x32_bf16 v[28:31], v[88:91], v[148:151], v[28:31]
    ds_read_b64 v[58:59], v232 offset:1160
    v_mfma_f32_16x16x32_bf16 v[28:31], v[92:95], v[144:147], v[28:31]
    ds_read_b128 v[124:127], v233 offset:2176
    v_mfma_f32_16x16x32_bf16 v[32:35], v[80:83], v[160:163], v[32:35]
    ds_read_b64 v[60:61], v232 offset:1664
    v_mfma_f32_16x16x32_bf16 v[32:35], v[84:87], v[156:159], v[32:35]
    ds_read_b64 v[62:63], v232 offset:1672
    v_mfma_f32_16x16x32_bf16 v[32:35], v[88:91], v[152:155], v[32:35]
    ds_read_b128 v[128:131], v233 offset:1664
    v_mfma_f32_16x16x32_bf16 v[32:35], v[92:95], v[148:151], v[32:35]
    ds_read_b64 v[64:65], v232 offset:2176
    v_mfma_f32_16x16x32_bf16 v[32:35], v[96:99], v[144:147], v[32:35]
    ds_read_b64 v[66:67], v232 offset:2184
    v_mfma_f32_16x16x32_bf16 v[36:39], v[80:83], v[164:167], v[36:39]
    ds_read_b128 v[132:135], v233 offset:1152
    v_mfma_f32_16x16x32_bf16 v[36:39], v[84:87], v[160:163], v[36:39]
    ds_read_b64 v[68:69], v232 offset:2688
    v_mfma_f32_16x16x32_bf16 v[36:39], v[88:91], v[156:159], v[36:39]
    ds_read_b64 v[70:71], v232 offset:2696
    v_mfma_f32_16x16x32_bf16 v[36:39], v[92:95], v[152:155], v[36:39]
    ds_read_b128 v[136:139], v233 offset:640
    v_mfma_f32_16x16x32_bf16 v[36:39], v[96:99], v[148:151], v[36:39]
    ds_read_b64 v[72:73], v232 offset:3200
    v_mfma_f32_16x16x32_bf16 v[36:39], v[100:103], v[144:147], v[36:39]
    ds_read_b64 v[74:75], v232 offset:3208
    v_mfma_f32_16x16x32_bf16 v[40:43], v[80:83], v[168:171], v[40:43]
    ds_read_b128 v[140:143], v233 offset:128
    v_mfma_f32_16x16x32_bf16 v[40:43], v[84:87], v[164:167], v[40:43]
    ds_read_b64 v[76:77], v232 offset:3712
    v_mfma_f32_16x16x32_bf16 v[40:43], v[88:91], v[160:163], v[40:43]
    ds_read_b64 v[78:79], v232 offset:3720
    v_mfma_f32_16x16x32_bf16 v[40:43], v[92:95], v[156:159], v[40:43]
    v_add_u32 v232, 128, v232
    v_mfma_f32_16x16x32_bf16 v[40:43], v[96:99], v[152:155], v[40:43]
    v_add_u32 v233, 128, v233
    v_mfma_f32_16x16x32_bf16 v[40:43], v[100:103], v[148:151], v[40:43]
    s_sub_u32 s74, s74, 1
    v_mfma_f32_16x16x32_bf16 v[40:43], v[104:107], v[144:147], v[40:43]
    s_cmp_lg_u32 s74, 0
    v_mfma_f32_16x16x32_bf16 v[44:47], v[80:83], v[172:175], v[44:47]
    v_mfma_f32_16x16x32_bf16 v[44:47], v[84:87], v[168:171], v[44:47]
    v_mfma_f32_16x16x32_bf16 v[44:47], v[88:91], v[164:167], v[44:47]
    v_mfma_f32_16x16x32_bf16 v[44:47], v[92:95], v[160:163], v[44:47]
    v_mfma_f32_16x16x32_bf16 v[44:47], v[96:99], v[156:159], v[44:47]
    v_mfma_f32_16x16x32_bf16 v[44:47], v[100:103], v[152:155], v[44:47]
    v_mfma_f32_16x16x32_bf16 v[44:47], v[104:107], v[148:151], v[44:47]
    v_mfma_f32_16x16x32_bf16 v[44:47], v[108:111], v[144:147], v[44:47]
    s_waitcnt lgkmcnt(0)
    s_cbranch_scc1 L_conv
    v_mfma_f32_16x16x32_bf16 v[16:19], v[48:51], v[112:115], v[16:19]
    ds_read_b128 v[144:147], v233 offset:3648
    ds_read_b64 v[80:81], v232 offset:64
    v_mfma_f32_16x16x32_bf16 v[20:23], v[48:51], v[116:119], v[20:23]
    ds_read_b64 v[82:83], v232 offset:72
    ds_read_b128 v[148:151], v233 offset:3136
    v_mfma_f32_16x16x32_bf16 v[20:23], v[52:55], v[112:115], v[20:23]
    ds_read_b64 v[84:85], v232 offset:576
    ds_read_b64 v[86:87], v232 offset:584
    v_mfma_f32_16x16x32_bf16 v[24:27], v[48:51], v[120:123], v[24:27]
    ds_read_b128 v[152:155], v233 offset:2624
    ds_read_b64 v[88:89], v232 offset:1088
    v_mfma_f32_16x16x32_bf16 v[24:27], v[52:55], v[116:119], v[24:27]
    ds_read_b64 v[90:91], v232 offset:1096
    ds_read_b128 v[156:159], v233 offset:2112
    v_mfma_f32_16x16x32_bf16 v[24:27], v[56:59], v[112:115], v[24:27]
    ds_read_b64 v[92:93], v232 offset:1600
    ds_read_b64 v[94:95], v232 offset:1608
    v_mfma_f32_16x16x32_bf16 v[28:31], v[48:51], v[124:127], v[28:31]
    ds_read_b128 v[160:163], v233 offset:1600
    ds_read_b64 v[96:97], v232 offset:2112
    v_mfma_f32_16x16x32_bf16 v[28:31], v[52:55], v[120:123], v[28:31]
    ds_read_b64 v[98:99], v232 offset:2120
    ds_read_b128 v[164:167], v233 offset:1088
    v_mfma_f32_16x16x32_bf16 v[28:31], v[56:59], v[116:119], v[28:31]
    ds_read_b64 v[100:101], v232 offset:2624
    ds_read_b64 v[102:103], v232 offset:2632
    v_mfma_f32_16x16x32_bf16 v[28:31], v[60:63], v[112:115], v[28:31]
    ds_read_b128 v[168:171], v233 offset:576
    ds_read_b64 v[104:105], v232 offset:3136
    v_mfma_f32_16x16x32_bf16 v[32:35], v[48:51], v[128:131], v[32:35]
    ds_read_b64 v[106:107], v232 offset:3144
    ds_read_b128 v[172:175], v233 offset:64
    v_mfma_f32_16x16x32_bf16 v[32:35], v[52:55], v[124:127], v[32:35]
    ds_read_b64 v[108:109], v232 offset:3648
    ds_read_b64 v[110:111], v232 offset:3656
    v_mfma_f32_16x16x32_bf16 v[32:35], v[56:59], v[120:123], v[32:35]
    s_mul_i32 s74, s68, 4224
    s_and_b32 s75, s71, 63
    v_mfma_f32_16x16x32_bf16 v[32:35], v[60:63], v[116:119], v[32:35]
    s_lshl2_add_u32 s74, s75, s74
    s_lshl_b32 s74, s74, 6
    v_mfma_f32_16x16x32_bf16 v[32:35], v[64:67], v[112:115], v[32:35]
    v_and_b32 v234, 15, v0
    v_lshl_add_u32 v234, v234, 4, s74
    v_mfma_f32_16x16x32_bf16 v[36:39], v[48:51], v[132:135], v[36:39]
    v_lshrrev_b32 v235, 4, v0
    v_mul_u32_u24 v235, 16896, v235
    v_mfma_f32_16x16x32_bf16 v[36:39], v[52:55], v[128:131], v[36:39]
    v_add_u32 v234, v234, v235
    v_mfma_f32_16x16x32_bf16 v[36:39], v[56:59], v[124:127], v[36:39]
    v_mfma_f32_16x16x32_bf16 v[36:39], v[60:63], v[120:123], v[36:39]
    v_mfma_f32_16x16x32_bf16 v[36:39], v[64:67], v[116:119], v[36:39]
    v_mfma_f32_16x16x32_bf16 v[36:39], v[68:71], v[112:115], v[36:39]
    s_waitcnt lgkmcnt(0)
    s_mov_b64 exec, 1
    ds_add_u32 v227, v244 offset:36
    s_mov_b64 exec, -1
    v_mfma_f32_16x16x32_bf16 v[16:19], v[80:83], v[144:147], v[16:19]
    s_lshl4_add_u32 s73, s68, 256
    s_add_u32 s45, s73, s69
    v_mfma_f32_16x16x32_bf16 v[20:23], v[80:83], v[148:151], v[20:23]
    s_lshl_b32 s73, s73, 8
    s_lshl_b32 s45, s45, 8
    v_mfma_f32_16x16x32_bf16 v[20:23], v[84:87], v[144:147], v[20:23]
    v_mfma_f32_16x16x32_bf16 v[24:27], v[80:83], v[152:155], v[24:27]
    v_mfma_f32_16x16x32_bf16 v[24:27], v[84:87], v[148:151], v[24:27]
    v_mfma_f32_16x16x32_bf16 v[24:27], v[88:91], v[144:147], v[24:27]
    v_mfma_f32_16x16x32_bf16 v[28:31], v[80:83], v[156:159], v[28:31]
    v_cvt_pk_bf16_f32 v176, v16, v17
    v_cvt_pk_bf16_f32 v177, v18, v19
    v_mfma_f32_16x16x32_bf16 v[28:31], v[84:87], v[152:155], v[28:31]
    v_mfma_f32_16x16x32_bf16 v[28:31], v[88:91], v[148:151], v[28:31]
    v_cvt_pk_bf16_f32 v178, v20, v21
    v_cvt_pk_bf16_f32 v179, v22, v23
    v_mfma_f32_16x16x32_bf16 v[28:31], v[92:95], v[144:147], v[28:31]
    s_mov_b32 s76, 0
    buffer_store_dwordx4 v[176:179], v234, s[64:67], s76 offen sc1
    v_mfma_f32_16x16x32_bf16 v[32:35], v[80:83], v[160:163], v[32:35]
    v_cvt_pk_bf16_f32 v180, v24, v25
    v_cvt_pk_bf16_f32 v181, v26, v27
    v_mfma_f32_16x16x32_bf16 v[32:35], v[84:87], v[156:159], v[32:35]
    v_mfma_f32_16x16x32_bf16 v[32:35], v[88:91], v[152:155], v[32:35]
    v_mfma_f32_16x16x32_bf16 v[32:35], v[92:95], v[148:151], v[32:35]
    v_cvt_pk_bf16_f32 v182, v28, v29
    v_cvt_pk_bf16_f32 v183, v30, v31
    v_mfma_f32_16x16x32_bf16 v[32:35], v[96:99], v[144:147], v[32:35]
    s_mov_b32 s76, 67584
    buffer_store_dwordx4 v[180:183], v234, s[64:67], s76 offen sc1
    v_mfma_f32_16x16x32_bf16 v[36:39], v[80:83], v[164:167], v[36:39]
    v_mfma_f32_16x16x32_bf16 v[36:39], v[84:87], v[160:163], v[36:39]
    v_mfma_f32_16x16x32_bf16 v[36:39], v[88:91], v[156:159], v[36:39]
    v_mfma_f32_16x16x32_bf16 v[36:39], v[92:95], v[152:155], v[36:39]
    v_mfma_f32_16x16x32_bf16 v[36:39], v[96:99], v[148:151], v[36:39]
    v_mfma_f32_16x16x32_bf16 v[36:39], v[100:103], v[144:147], v[36:39]
    v_cvt_pk_bf16_f32 v184, v32, v33
    v_cvt_pk_bf16_f32 v185, v34, v35
    v_mfma_f32_16x16x32_bf16 v[40:43], v[48:51], v[136:139], v[40:43]
    v_mfma_f32_16x16x32_bf16 v[40:43], v[52:55], v[132:135], v[40:43]
    v_mfma_f32_16x16x32_bf16 v[40:43], v[56:59], v[128:131], v[40:43]
    v_mfma_f32_16x16x32_bf16 v[40:43], v[60:63], v[124:127], v[40:43]
    v_mfma_f32_16x16x32_bf16 v[40:43], v[64:67], v[120:123], v[40:43]
    v_mfma_f32_16x16x32_bf16 v[40:43], v[68:71], v[116:119], v[40:43]
    v_cvt_pk_bf16_f32 v186, v36, v37
    v_cvt_pk_bf16_f32 v187, v38, v39
    v_mfma_f32_16x16x32_bf16 v[40:43], v[72:75], v[112:115], v[40:43]
    s_mov_b32 s76, 135168
    buffer_store_dwordx4 v[184:187], v234, s[64:67], s76 offen sc1
    v_mfma_f32_16x16x32_bf16 v[44:47], v[48:51], v[140:143], v[44:47]
    v_mfma_f32_16x16x32_bf16 v[44:47], v[52:55], v[136:139], v[44:47]
    v_mfma_f32_16x16x32_bf16 v[44:47], v[56:59], v[132:135], v[44:47]
    v_mfma_f32_16x16x32_bf16 v[44:47], v[60:63], v[128:131], v[44:47]
    v_mfma_f32_16x16x32_bf16 v[44:47], v[64:67], v[124:127], v[44:47]
    v_mfma_f32_16x16x32_bf16 v[44:47], v[68:71], v[120:123], v[44:47]
    v_mfma_f32_16x16x32_bf16 v[44:47], v[72:75], v[116:119], v[44:47]
    v_mfma_f32_16x16x32_bf16 v[44:47], v[76:79], v[112:115], v[44:47]
    v_mfma_f32_16x16x32_bf16 v[40:43], v[80:83], v[168:171], v[40:43]
    v_mfma_f32_16x16x32_bf16 v[40:43], v[84:87], v[164:167], v[40:43]
    v_mfma_f32_16x16x32_bf16 v[40:43], v[88:91], v[160:163], v[40:43]
    v_mfma_f32_16x16x32_bf16 v[40:43], v[92:95], v[156:159], v[40:43]
    v_mfma_f32_16x16x32_bf16 v[40:43], v[96:99], v[152:155], v[40:43]
    v_mfma_f32_16x16x32_bf16 v[40:43], v[100:103], v[148:151], v[40:43]
    v_mfma_f32_16x16x32_bf16 v[40:43], v[104:107], v[144:147], v[40:43]
    v_mfma_f32_16x16x32_bf16 v[44:47], v[80:83], v[172:175], v[44:47]
    v_mfma_f32_16x16x32_bf16 v[44:47], v[84:87], v[168:171], v[44:47]
    v_mfma_f32_16x16x32_bf16 v[44:47], v[88:91], v[164:167], v[44:47]
    v_mfma_f32_16x16x32_bf16 v[44:47], v[92:95], v[160:163], v[44:47]
    v_mfma_f32_16x16x32_bf16 v[44:47], v[96:99], v[156:159], v[44:47]
    v_mfma_f32_16x16x32_bf16 v[44:47], v[100:103], v[152:155], v[44:47]
    v_mfma_f32_16x16x32_bf16 v[44:47], v[104:107], v[148:151], v[44:47]
    v_mfma_f32_16x16x32_bf16 v[44:47], v[108:111], v[144:147], v[44:47]
    v_cvt_pk_bf16_f32 v188, v40, v41
    v_cvt_pk_bf16_f32 v189, v42, v43
    s_nop 5
    v_cvt_pk_bf16_f32 v190, v44, v45
    v_cvt_pk_bf16_f32 v191, v46, v47
    s_mov_b32 s76, 202752
    buffer_store_dwordx4 v[188:191], v234, s[64:67], s76 offen sc1
    s_setprio 1
    s_waitcnt vmcnt(0)
    v_mov_b32 v238, 1
    s_mov_b64 exec, 1
    ds_add_rtn_u32 v237, v227, v238 offset:8
    s_waitcnt lgkmcnt(0)
    v_readfirstlane_b32 s76, v237
    s_nop 0
    s_cmp_eq_u32 s76, 3
    s_cbranch_scc0 L_jo_45a
    s_mov_b64 exec, 0xffff
    v_lshlrev_b32 v237, 8, v0
    buffer_atomic_add v238, v237, s[52:55], s73 offen sc1
L_jo_45a:
    s_mov_b64 exec, -1
    v_lshlrev_b32 v112, 16, v208
    v_and_b32 v113, 0xffff0000, v208
    v_lshlrev_b32 v114, 16, v209
    v_and_b32 v115, 0xffff0000, v209
    v_lshlrev_b32 v116, 16, v210
    v_and_b32 v117, 0xffff0000, v210
    v_lshlrev_b32 v118, 16, v211
    v_and_b32 v119, 0xffff0000, v211
    v_lshlrev_b32 v120, 16, v212
    v_and_b32 v121, 0xffff0000, v212
    v_lshlrev_b32 v122, 16, v213
    v_and_b32 v123, 0xffff0000, v213
    v_lshlrev_b32 v124, 16, v214
    v_and_b32 v125, 0xffff0000, v214
    v_lshlrev_b32 v126, 16, v215
    v_and_b32 v127, 0xffff0000, v215
    v_lshlrev_b32 v128, 16, v216
    v_and_b32 v129, 0xffff0000, v216
    v_lshlrev_b32 v130, 16, v217
    v_and_b32 v131, 0xffff0000, v217
    v_lshlrev_b32 v132, 16, v218
    v_and_b32 v133, 0xffff0000, v218
    v_lshlrev_b32 v134, 16, v219
    v_and_b32 v135, 0xffff0000, v219
    v_lshlrev_b32 v136, 16, v220
    v_and_b32 v137, 0xffff0000, v220
    v_lshlrev_b32 v138, 16, v221
    v_and_b32 v139, 0xffff0000, v221
    v_lshlrev_b32 v140, 16, v222
    v_and_b32 v141, 0xffff0000, v222
    v_lshlrev_b32 v142, 16, v223
    v_and_b32 v143, 0xffff0000, v223
    s_setprio 1
    s_setprio 1
    s_mul_i32 s77, s70, 4416
    s_add_u32 s77, s77, 60416
    v_lshrrev_b32 v234, 5, v0
    v_lshl_add_u32 v234, v234, 1, v0
    v_lshl_add_u32 v234, v234, 4, s77
    v_and_b32 v235, 7, v0
    v_mul_u32_u24 v235, 544, v235
    v_lshrrev_b32 v236, 3, v0
    v_lshl_add_u32 v235, v236, 3, v235
    v_add_u32 v235, s77, v235
    s_mul_i32 s77, s70, 1088
    s_add_u32 s77, s77, 60416
    v_and_b32 v234, 3, v0
    v_lshl_add_u32 v234, v234, 4, s77
    v_lshrrev_b32 v236, 4, v0
    v_lshl_add_u32 v234, v236, 6, v234
    v_bfe_u32 v236, v0, 2, 2
    v_mul_u32_u24 v236, 4416, v236
    v_add_u32 v234, v234, v236
    s_lshr_b32 s77, s71, 2
    s_mul_i32 s77, s77, 16896
    s_lshl_b32 s78, s70, 12
    s_add_u32 s77, s77, s78
    s_mov_b32 s60, s26
    s_mov_b32 s61, s27
    s_mov_b32 s62, 0x800000
    s_mov_b32 s63, 0x20000
    s_cmp_eq_u32 s76, 3
    s_cbranch_scc0 L_jo_45
    s_mov_b32 s75, 131072
L_sg_loop_48:
    s_load_dword s74, s[52:53], s45 glc
L_sg_chk_49:
    s_waitcnt lgkmcnt(0)
    s_cmp_ge_u32 s74, 16
    s_cbranch_scc1 L_sg_done_47
    s_sub_u32 s75, s75, 1
    s_cbranch_scc0 L_sg_loop_48
L_sg_done_47:
    v_mov_b32 v237, 16
    s_mov_b64 exec, 1
    ds_add_u32 v227, v237 offset:16
    s_mov_b64 exec, -1
    s_branch L_jd_46
L_jo_45:
    s_mov_b32 s75, 1048576
L_sl_loop_51:
    ds_read_b32 v237, v227 offset:16
    s_waitcnt lgkmcnt(0)
    v_readfirstlane_b32 s74, v237
    s_nop 0
    s_cmp_ge_u32 s74, 16
    s_cbranch_scc1 L_sl_done_50
    s_sleep 1
    s_sub_u32 s75, s75, 1
    s_cbranch_scc0 L_sl_loop_51
L_sl_done_50:
L_jd_46:
    buffer_load_dwordx4 v[48:51], v224, s[64:67], s77 offen offset:0 sc1
    buffer_load_dwordx4 v[52:55], v224, s[64:67], s77 offen offset:1024 sc1
    buffer_load_dwordx4 v[56:59], v224, s[64:67], s77 offen offset:2048 sc1
    buffer_load_dwordx4 v[60:63], v224, s[64:67], s77 offen offset:3072 sc1
    s_waitcnt vmcnt(3)
    ds_write_b128 v234, v[48:51] offset:0
    s_waitcnt vmcnt(2)
    ds_write_b128 v234, v[52:55] offset:256
    s_waitcnt vmcnt(1)
    ds_write_b128 v234, v[56:59] offset:544
    s_waitcnt vmcnt(0)
    ds_write_b128 v234, v[60:63] offset:800
    s_mov_b64 exec, 1
    ds_add_u32 v227, v244 offset:44
    s_mov_b64 exec, -1
    s_mov_b32 s75, 1048576
L_sl_loop_53:
    ds_read_b32 v237, v227 offset:44
    s_waitcnt lgkmcnt(0)
    v_readfirstlane_b32 s74, v237
    s_nop 0
    s_cmp_ge_u32 s74, 4
    s_cbranch_scc1 L_sl_done_52
    s_sleep 1
    s_sub_u32 s75, s75, 1
    s_cbranch_scc0 L_sl_loop_53
L_sl_done_52:
    ds_read_b64 v[64:65], v235 offset:0
    ds_read_b64 v[66:67], v235 offset:64
    ds_read_b64 v[68:69], v235 offset:128
    ds_read_b64 v[70:71], v235 offset:192
    ds_read_b64 v[72:73], v235 offset:256
    ds_read_b64 v[74:75], v235 offset:320
    ds_read_b64 v[76:77], v235 offset:384
    ds_read_b64 v[78:79], v235 offset:448
    s_waitcnt lgkmcnt(7)
    v_lshlrev_b32 v16, 16, v64
    v_and_b32 v24, 0xffff0000, v64
    v_lshlrev_b32 v32, 16, v65
    v_and_b32 v40, 0xffff0000, v65
    s_waitcnt lgkmcnt(6)
    v_lshlrev_b32 v17, 16, v66
    v_and_b32 v25, 0xffff0000, v66
    v_lshlrev_b32 v33, 16, v67
    v_and_b32 v41, 0xffff0000, v67
    s_waitcnt lgkmcnt(5)
    v_lshlrev_b32 v18, 16, v68
    v_and_b32 v26, 0xffff0000, v68
    v_lshlrev_b32 v34, 16, v69
    v_and_b32 v42, 0xffff0000, v69
    s_waitcnt lgkmcnt(4)
    v_lshlrev_b32 v19, 16, v70
    v_and_b32 v27, 0xffff0000, v70
    v_lshlrev_b32 v35, 16, v71
    v_and_b32 v43, 0xffff0000, v71
    s_waitcnt lgkmcnt(3)
    v_lshlrev_b32 v20, 16, v72
    v_and_b32 v28, 0xffff0000, v72
    v_lshlrev_b32 v36, 16, v73
    v_and_b32 v44, 0xffff0000, v73
    s_waitcnt lgkmcnt(2)
    v_lshlrev_b32 v21, 16, v74
    v_and_b32 v29, 0xffff0000, v74
    v_lshlrev_b32 v37, 16, v75
    v_and_b32 v45, 0xffff0000, v75
    s_waitcnt lgkmcnt(1)
    v_lshlrev_b32 v22, 16, v76
    v_and_b32 v30, 0xffff0000, v76
    v_lshlrev_b32 v38, 16, v77
    v_and_b32 v46, 0xffff0000, v77
    s_waitcnt lgkmcnt(0)
    v_lshlrev_b32 v23, 16, v78
    v_and_b32 v31, 0xffff0000, v78
    v_lshlrev_b32 v39, 16, v79
    v_and_b32 v47, 0xffff0000, v79
    v_mul_f32 v16, v16, v112
    v_mul_f32 v17, v17, v113
    v_mul_f32 v18, v18, v114
    v_mul_f32 v19, v19, v115
    v_mul_f32 v20, v20, v116
    v_mul_f32 v21, v21, v117
    v_mul_f32 v22, v22, v118
    v_mul_f32 v23, v23, v119
    v_cvt_pk_bf16_f32 v48, v16, v17
    v_cvt_pk_bf16_f32 v49, v18, v19
    v_cvt_pk_bf16_f32 v50, v20, v21
    v_cvt_pk_bf16_f32 v51, v22, v23
    s_mov_b32 s74, 0
    buffer_store_dwordx4 v[48:51], v226, s[60:63], s74 offen nt
    v_mul_f32 v24, v24, v120
    v_mul_f32 v25, v25, v121
    v_mul_f32 v26, v26, v122
    v_mul_f32 v27, v27, v123
    v_mul_f32 v28, v28, v124
    v_mul_f32 v29, v29, v125
    v_mul_f32 v30, v30, v126
    v_mul_f32 v31, v31, v127
    v_cvt_pk_bf16_f32 v52, v24, v25
    v_cvt_pk_bf16_f32 v53, v26, v27
    v_cvt_pk_bf16_f32 v54, v28, v29
    v_cvt_pk_bf16_f32 v55, v30, v31
    s_mov_b32 s74, 4096
    buffer_store_dwordx4 v[52:55], v226, s[60:63], s74 offen nt
    v_mul_f32 v32, v32, v128
    v_mul_f32 v33, v33, v129
    v_mul_f32 v34, v34, v130
    v_mul_f32 v35, v35, v131
    v_mul_f32 v36, v36, v132
    v_mul_f32 v37, v37, v133
    v_mul_f32 v38, v38, v134
    v_mul_f32 v39, v39, v135
    v_cvt_pk_bf16_f32 v56, v32, v33
    v_cvt_pk_bf16_f32 v57, v34, v35
    v_cvt_pk_bf16_f32 v58, v36, v37
    v_cvt_pk_bf16_f32 v59, v38, v39
    s_mov_b32 s74, 16384
    buffer_store_dwordx4 v[56:59], v226, s[60:63], s74 offen nt
    v_mul_f32 v40, v40, v136
    v_mul_f32 v41, v41, v137
    v_mul_f32 v42, v42, v138
    v_mul_f32 v43, v43, v139
    v_mul_f32 v44, v44, v140
    v_mul_f32 v45, v45, v141
    v_mul_f32 v46, v46, v142
    v_mul_f32 v47, v47, v143
    v_cvt_pk_bf16_f32 v60, v40, v41
    v_cvt_pk_bf16_f32 v61, v42, v43
    v_cvt_pk_bf16_f32 v62, v44, v45
    v_cvt_pk_bf16_f32 v63, v46, v47
    s_mov_b32 s74, 20480
    buffer_store_dwordx4 v[60:63], v226, s[60:63], s74 offen nt
    s_endpgm
L_grole:
    s_setprio 2
    s_add_u32 s52, s30, 0xe00000
    s_addc_u32 s53, s31, 0
    s_mov_b32 s54, 0x20000
    s_mov_b32 s55, 0x20000
    s_lshr_b32 s32, s3, 1
    s_and_b32 s33, s3, 1
    v_and_b32 v1, 15, v0
    v_lshrrev_b32 v2, 4, v0
    v_lshrrev_b32 v3, 1, v1
    v_xor_b32 v3, v2, v3
    v_lshlrev_b32 v3, 4, v3
    v_lshl_add_u32 v3, v1, 7, v3
    s_lshl_b32 s37, s33, 13
    v_add_u32 v196, s37, v3
    v_xor_b32 v197, 64, v196
    v_and_b32 v198, 7, v1
    v_lshlrev_b32 v3, 1, v2
    v_xor_b32 v3, v3, v198
    v_lshlrev_b32 v3, 4, v3
    v_lshl_add_u32 v3, v198, 7, v3
    v_lshrrev_b32 v202, 3, v1
    v_lshl_add_u32 v3, v202, 2, v3
    v_add_u32 v198, 16384, v3
    v_xor_b32 v199, 16, v198
    v_mul_u32_u24 v202, 0xaaaa, v202
    v_add_u32 v202, 0x4444, v202
    v_bfe_u32 v3, v0, 2, 2
    v_lshl_add_u32 v200, v2, 3, v3
    v_lshlrev_b32 v200, 7, v200
    v_bfe_u32 v3, v0, 3, 2
    v_xor_b32 v3, s3, v3
    v_lshl_add_u32 v200, v3, 5, v200
    v_and_b32 v3, 3, v0
    v_lshl_add_u32 v200, v3, 3, v200
    v_add_u32 v200, 17408, v200
    v_xor_b32 v201, 32, v200
    s_mov_b32 s34, 0
    v_mov_b32 v228, 134352
    v_and_b32 v1, 15, v0
    v_lshrrev_b32 v2, 4, v0
    v_lshlrev_b32 v2, 2, v2
    v_sub_u32 v1, v1, v2
    s_mov_b32 s37, 0xf149f2ca
    v_mov_b32 v3, s37
    s_or_b32 s38, s5, s33
    s_cmp_eq_u32 s38, 0
    s_cselect_b32 s38, s37, 0
    v_subrev_u32 v2, 0, v1
    v_cmp_gt_u32 vcc, 8, v2
    v_cmp_gt_i32 s[64:65], -8, v2
    v_ashrrev_i32 v2, 31, v2
    v_cndmask_b32 v204, v3, 0, vcc
    v_cndmask_b32 v208, v3, 0, s[64:65]
    v_mov_b32 v216, v2
    v_min_f32 v212, s38, v208
    v_subrev_u32 v2, 1, v1
    v_cmp_gt_u32 vcc, 8, v2
    v_cmp_gt_i32 s[64:65], -8, v2
    v_ashrrev_i32 v2, 31, v2
    v_cndmask_b32 v205, v3, 0, vcc
    v_cndmask_b32 v209, v3, 0, s[64:65]
    v_alignbit_b32 v216, v2, v216, 16
    v_min_f32 v213, s38, v209
    v_subrev_u32 v2, 2, v1
    v_cmp_gt_u32 vcc, 8, v2
    v_cmp_gt_i32 s[64:65], -8, v2
    v_ashrrev_i32 v2, 31, v2
    v_cndmask_b32 v206, v3, 0, vcc
    v_cndmask_b32 v210, v3, 0, s[64:65]
    v_mov_b32 v217, v2
    v_min_f32 v214, s38, v210
    v_subrev_u32 v2, 3, v1
    v_cmp_gt_u32 vcc, 8, v2
    v_cmp_gt_i32 s[64:65], -8, v2
    v_ashrrev_i32 v2, 31, v2
    v_cndmask_b32 v207, v3, 0, vcc
    v_cndmask_b32 v211, v3, 0, s[64:65]
    v_alignbit_b32 v217, v2, v217, 16
    v_min_f32 v215, s38, v211
    s_mul_i32 s37, s32, 80896
    s_add_u32 s37, s37, 78848
    v_lshl_add_u32 v220, v0, 3, s37
    s_lshl_b32 s38, s33, 9
    v_add_u32 v219, s38, v220
    s_add_u32 s38, s38, s37
    v_and_b32 v1, 3, v0
    v_lshl_add_u32 v1, v1, 1, s38
    v_bfe_u32 v2, v0, 2, 2
    v_lshl_add_u32 v1, v2, 7, v1
    v_lshrrev_b32 v2, 4, v0
    v_xor_b32 v2, 2, v2
    v_lshl_add_u32 v203, v2, 5, v1
    s_mul_i32 s38, s33, 2560
    v_add_u32 v221, s38, v220
    v_xor_b32 v222, 512, v221
    s_lshl3_add_u32 s37, s4, s5
    s_lshl1_add_u32 s37, s37, s33
    s_lshl_b32 s37, s37, 7
    s_lshl1_add_u32 s38, s6, s32
    s_add_u32 s37, s37, s38
    s_lshl_b32 s37, s37, 10
    v_lshl_add_u32 v218, v0, 4, s37
    s_mov_b32 s40, s30
    s_mov_b32 s41, s31
    s_mov_b32 s42, 0x400000
    s_mov_b32 s43, 0x20000
    s_and_b32 s58, s2, 3
    s_bfe_u32 s37, s2, 0x20003
    s_lshl2_add_u32 s58, s58, s37
    s_bfe_u32 s59, s2, 0x10002
    s_lshr_b32 s37, s2, 5
    s_lshl3_add_u32 s59, s59, s37
    s_mov_b32 s44, s24
    s_mov_b32 s45, s25
    s_mov_b32 s46, 0x200000
    s_mov_b32 s47, 0x20000
    s_mov_b32 s48, s26
    s_mov_b32 s49, s27
    s_mov_b32 s50, 0x800000
    s_mov_b32 s51, 0x20000
    s_lshl3_add_u32 s56, s4, s5
    s_lshl4_add_u32 s56, s56, 0
    s_lshl_b32 s56, s56, 8
    s_lshl4_add_u32 s57, s58, 0
    s_add_u32 s57, s57, s59
    s_lshl_b32 s57, s57, 8
    s_lshl2_add_u32 s37, s58, s3
    s_lshl_b32 s38, s37, 16
    v_lshl_add_u32 v224, v0, 4, s38
    v_add_u32 v225, 0x8000, v224
    s_and_b32 s37, s37, 31
    s_lshl_b32 s37, s37, 6
    s_lshr_b32 s38, s58, 3
    s_add_u32 s37, s37, s38
    s_lshl_b32 s37, s37, 5
    s_add_u32 s37, s37, s59
    s_add_u32 s37, s37, 16
    s_lshl_b32 s37, s37, 7
    v_lshrrev_b32 v1, 3, v0
    v_lshl_add_u32 v1, v1, 13, s37
    v_and_b32 v2, 7, v0
    v_lshl_add_u32 v226, v2, 4, v1
    v_lshrrev_b32 v1, 4, v0
    v_lshlrev_b32 v1, 1, v1
    v_xor_b32 v1, v0, v1
    v_and_b32 v1, 7, v1
    s_lshl_b32 s37, s59, 7
    v_lshl_add_u32 v1, v1, 4, s37
    v_lshrrev_b32 v227, 3, v0
    v_lshl_add_u32 v227, v227, 11, v1
    v_add_u32 v223, 15360, v227
    s_lshl_b32 s60, s3, 11
    s_mul_i32 s61, s59, 0
    s_and_b32 s61, s61, 7
    s_lshl3_add_u32 s62, s61, s3
    s_lshl_b32 s62, s62, 15
    v_lshrrev_b32 v1, 2, v0
    v_lshlrev_b32 v1, 7, v1
    v_bfe_u32 v2, v0, 3, 2
    v_lshl_add_u32 v1, v2, 5, v1
    v_and_b32 v2, 3, v0
    v_lshl_add_u32 v229, v2, 3, v1
    s_bitcmp0_b32 s2, 7
    s_cbranch_scc1 L_nopre
    s_add_u32 s87, s86, 159744
    v_and_b32 v247, 7, v0
    v_lshl_add_u32 v246, v247, 6, s87
    s_mul_i32 s86, s3, 8448
    s_add_u32 s86, s86, 125952
    s_mul_i32 s87, s84, 2112
    s_sub_u32 s87, s87, s85
    s_lshl_b32 s87, s87, 7
    s_add_u32 s87, s87, 3968
    v_lshl_add_u32 v249, v247, 4, s87
    v_lshrrev_b32 v248, 3, v0
    v_mul_u32_u24 v250, 4224, v248
    v_add_u32 v249, v249, v250
    v_mul_u32_u24 v247, 1040, v247
    v_xor_b32 v248, 7, v248
    v_lshl_add_u32 v247, v248, 4, v247
    v_add_u32 v247, s86, v247
    v_add_u32 v248, s86, v191
    s_add_u32 s80, s30, 0x400000
    s_addc_u32 s81, s31, 0
    s_mov_b32 s82, 0x420000
    s_mov_b32 s83, 0x20000
    s_waitcnt vmcnt(19)
    ds_read_b128 v[230:233], v246 offset:0
    ds_read_b128 v[234:237], v246 offset:16
    ds_read_b128 v[238:241], v246 offset:32
    ds_read_b128 v[242:245], v246 offset:48
    s_waitcnt lgkmcnt(3)
    v_lshlrev_b32 v68, 16, v230
    v_and_b32 v70, 0xffff0000, v230
    v_lshlrev_b32 v72, 16, v231
    v_and_b32 v74, 0xffff0000, v231
    v_lshlrev_b32 v69, 16, v232
    v_and_b32 v71, 0xffff0000, v232
    v_lshlrev_b32 v73, 16, v233
    v_and_b32 v75, 0xffff0000, v233
    s_waitcnt lgkmcnt(2)
    v_lshlrev_b32 v76, 16, v234
    v_and_b32 v78, 0xffff0000, v234
    v_lshlrev_b32 v80, 16, v235
    v_and_b32 v82, 0xffff0000, v235
    v_lshlrev_b32 v77, 16, v236
    v_and_b32 v79, 0xffff0000, v236
    v_lshlrev_b32 v81, 16, v237
    v_and_b32 v83, 0xffff0000, v237
    s_waitcnt lgkmcnt(1)
    v_lshlrev_b32 v84, 16, v238
    v_and_b32 v86, 0xffff0000, v238
    v_lshlrev_b32 v88, 16, v239
    v_and_b32 v90, 0xffff0000, v239
    v_lshlrev_b32 v85, 16, v240
    v_and_b32 v87, 0xffff0000, v240
    v_lshlrev_b32 v89, 16, v241
    v_and_b32 v91, 0xffff0000, v241
    s_waitcnt lgkmcnt(0)
    v_lshlrev_b32 v92, 16, v242
    v_and_b32 v94, 0xffff0000, v242
    v_lshlrev_b32 v96, 16, v243
    v_and_b32 v98, 0xffff0000, v243
    v_lshlrev_b32 v93, 16, v244
    v_and_b32 v95, 0xffff0000, v244
    v_lshlrev_b32 v97, 16, v245
    v_and_b32 v99, 0xffff0000, v245
    s_waitcnt vmcnt(18)
    v_lshlrev_b32 v100, 16, v108
    v_and_b32 v101, 0xffff0000, v108
    v_lshlrev_b32 v102, 16, v109
    v_and_b32 v103, 0xffff0000, v109
    v_lshlrev_b32 v104, 16, v110
    v_and_b32 v105, 0xffff0000, v110
    v_lshlrev_b32 v106, 16, v111
    v_and_b32 v107, 0xffff0000, v111
    v_pk_mul_f32 v[4:5], v[100:101], v[74:75]
    v_pk_mul_f32 v[20:21], v[102:103], v[82:83]
    v_pk_mul_f32 v[36:37], v[104:105], v[90:91]
    v_pk_mul_f32 v[52:53], v[106:107], v[98:99]
    s_waitcnt vmcnt(17)
    v_lshlrev_b32 v100, 16, v112
    v_and_b32 v101, 0xffff0000, v112
    v_lshlrev_b32 v102, 16, v113
    v_and_b32 v103, 0xffff0000, v113
    v_lshlrev_b32 v104, 16, v114
    v_and_b32 v105, 0xffff0000, v114
    v_lshlrev_b32 v106, 16, v115
    v_and_b32 v107, 0xffff0000, v115
    v_pk_fma_f32 v[4:5], v[100:101], v[72:73], v[4:5]
    v_pk_fma_f32 v[20:21], v[102:103], v[80:81], v[20:21]
    v_pk_fma_f32 v[36:37], v[104:105], v[88:89], v[36:37]
    v_pk_fma_f32 v[52:53], v[106:107], v[96:97], v[52:53]
    v_pk_mul_f32 v[6:7], v[100:101], v[74:75]
    v_pk_mul_f32 v[22:23], v[102:103], v[82:83]
    v_pk_mul_f32 v[38:39], v[104:105], v[90:91]
    v_pk_mul_f32 v[54:55], v[106:107], v[98:99]
    s_waitcnt vmcnt(16)
    v_lshlrev_b32 v100, 16, v116
    v_and_b32 v101, 0xffff0000, v116
    v_lshlrev_b32 v102, 16, v117
    v_and_b32 v103, 0xffff0000, v117
    v_lshlrev_b32 v104, 16, v118
    v_and_b32 v105, 0xffff0000, v118
    v_lshlrev_b32 v106, 16, v119
    v_and_b32 v107, 0xffff0000, v119
    v_pk_fma_f32 v[4:5], v[100:101], v[70:71], v[4:5]
    v_pk_fma_f32 v[20:21], v[102:103], v[78:79], v[20:21]
    v_pk_fma_f32 v[36:37], v[104:105], v[86:87], v[36:37]
    v_pk_fma_f32 v[52:53], v[106:107], v[94:95], v[52:53]
    v_pk_fma_f32 v[6:7], v[100:101], v[72:73], v[6:7]
    v_pk_fma_f32 v[22:23], v[102:103], v[80:81], v[22:23]
    v_pk_fma_f32 v[38:39], v[104:105], v[88:89], v[38:39]
    v_pk_fma_f32 v[54:55], v[106:107], v[96:97], v[54:55]
    v_pk_mul_f32 v[8:9], v[100:101], v[74:75]
    v_pk_mul_f32 v[24:25], v[102:103], v[82:83]
    v_pk_mul_f32 v[40:41], v[104:105], v[90:91]
    v_pk_mul_f32 v[56:57], v[106:107], v[98:99]
    s_waitcnt vmcnt(15)
    v_lshlrev_b32 v100, 16, v120
    v_and_b32 v101, 0xffff0000, v120
    v_lshlrev_b32 v102, 16, v121
    v_and_b32 v103, 0xffff0000, v121
    v_lshlrev_b32 v104, 16, v122
    v_and_b32 v105, 0xffff0000, v122
    v_lshlrev_b32 v106, 16, v123
    v_and_b32 v107, 0xffff0000, v123
    v_pk_fma_f32 v[4:5], v[100:101], v[68:69], v[4:5]
    v_pk_fma_f32 v[20:21], v[102:103], v[76:77], v[20:21]
    v_pk_fma_f32 v[36:37], v[104:105], v[84:85], v[36:37]
    v_pk_fma_f32 v[52:53], v[106:107], v[92:93], v[52:53]
    v_pk_fma_f32 v[6:7], v[100:101], v[70:71], v[6:7]
    v_pk_fma_f32 v[22:23], v[102:103], v[78:79], v[22:23]
    v_pk_fma_f32 v[38:39], v[104:105], v[86:87], v[38:39]
    v_pk_fma_f32 v[54:55], v[106:107], v[94:95], v[54:55]
    v_pk_fma_f32 v[8:9], v[100:101], v[72:73], v[8:9]
    v_pk_fma_f32 v[24:25], v[102:103], v[80:81], v[24:25]
    v_pk_fma_f32 v[40:41], v[104:105], v[88:89], v[40:41]
    v_pk_fma_f32 v[56:57], v[106:107], v[96:97], v[56:57]
    v_pk_mul_f32 v[10:11], v[100:101], v[74:75]
    v_pk_mul_f32 v[26:27], v[102:103], v[82:83]
    v_pk_mul_f32 v[42:43], v[104:105], v[90:91]
    v_pk_mul_f32 v[58:59], v[106:107], v[98:99]
    s_waitcnt vmcnt(14)
    v_lshlrev_b32 v100, 16, v124
    v_and_b32 v101, 0xffff0000, v124
    v_lshlrev_b32 v102, 16, v125
    v_and_b32 v103, 0xffff0000, v125
    v_lshlrev_b32 v104, 16, v126
    v_and_b32 v105, 0xffff0000, v126
    v_lshlrev_b32 v106, 16, v127
    v_and_b32 v107, 0xffff0000, v127
    v_pk_fma_f32 v[6:7], v[100:101], v[68:69], v[6:7]
    v_pk_fma_f32 v[22:23], v[102:103], v[76:77], v[22:23]
    v_pk_fma_f32 v[38:39], v[104:105], v[84:85], v[38:39]
    v_pk_fma_f32 v[54:55], v[106:107], v[92:93], v[54:55]
    v_pk_fma_f32 v[8:9], v[100:101], v[70:71], v[8:9]
    v_pk_fma_f32 v[24:25], v[102:103], v[78:79], v[24:25]
    v_pk_fma_f32 v[40:41], v[104:105], v[86:87], v[40:41]
    v_pk_fma_f32 v[56:57], v[106:107], v[94:95], v[56:57]
    v_pk_fma_f32 v[10:11], v[100:101], v[72:73], v[10:11]
    v_pk_fma_f32 v[26:27], v[102:103], v[80:81], v[26:27]
    v_pk_fma_f32 v[42:43], v[104:105], v[88:89], v[42:43]
    v_pk_fma_f32 v[58:59], v[106:107], v[96:97], v[58:59]
    v_pk_mul_f32 v[12:13], v[100:101], v[74:75]
    v_pk_mul_f32 v[28:29], v[102:103], v[82:83]
    v_pk_mul_f32 v[44:45], v[104:105], v[90:91]
    v_pk_mul_f32 v[60:61], v[106:107], v[98:99]
    s_waitcnt vmcnt(13)
    v_lshlrev_b32 v100, 16, v128
    v_and_b32 v101, 0xffff0000, v128
    v_lshlrev_b32 v102, 16, v129
    v_and_b32 v103, 0xffff0000, v129
    v_lshlrev_b32 v104, 16, v130
    v_and_b32 v105, 0xffff0000, v130
    v_lshlrev_b32 v106, 16, v131
    v_and_b32 v107, 0xffff0000, v131
    v_pk_fma_f32 v[8:9], v[100:101], v[68:69], v[8:9]
    v_pk_fma_f32 v[24:25], v[102:103], v[76:77], v[24:25]
    v_pk_fma_f32 v[40:41], v[104:105], v[84:85], v[40:41]
    v_pk_fma_f32 v[56:57], v[106:107], v[92:93], v[56:57]
    v_pk_fma_f32 v[10:11], v[100:101], v[70:71], v[10:11]
    v_pk_fma_f32 v[26:27], v[102:103], v[78:79], v[26:27]
    v_pk_fma_f32 v[42:43], v[104:105], v[86:87], v[42:43]
    v_pk_fma_f32 v[58:59], v[106:107], v[94:95], v[58:59]
    v_pk_fma_f32 v[12:13], v[100:101], v[72:73], v[12:13]
    v_pk_fma_f32 v[28:29], v[102:103], v[80:81], v[28:29]
    v_pk_fma_f32 v[44:45], v[104:105], v[88:89], v[44:45]
    v_pk_fma_f32 v[60:61], v[106:107], v[96:97], v[60:61]
    v_pk_mul_f32 v[14:15], v[100:101], v[74:75]
    v_pk_mul_f32 v[30:31], v[102:103], v[82:83]
    v_pk_mul_f32 v[46:47], v[104:105], v[90:91]
    v_pk_mul_f32 v[62:63], v[106:107], v[98:99]
    s_waitcnt vmcnt(12)
    v_lshlrev_b32 v100, 16, v132
    v_and_b32 v101, 0xffff0000, v132
    v_lshlrev_b32 v102, 16, v133
    v_and_b32 v103, 0xffff0000, v133
    v_lshlrev_b32 v104, 16, v134
    v_and_b32 v105, 0xffff0000, v134
    v_lshlrev_b32 v106, 16, v135
    v_and_b32 v107, 0xffff0000, v135
    v_pk_fma_f32 v[10:11], v[100:101], v[68:69], v[10:11]
    v_pk_fma_f32 v[26:27], v[102:103], v[76:77], v[26:27]
    v_pk_fma_f32 v[42:43], v[104:105], v[84:85], v[42:43]
    v_pk_fma_f32 v[58:59], v[106:107], v[92:93], v[58:59]
    v_pk_fma_f32 v[12:13], v[100:101], v[70:71], v[12:13]
    v_pk_fma_f32 v[28:29], v[102:103], v[78:79], v[28:29]
    v_pk_fma_f32 v[44:45], v[104:105], v[86:87], v[44:45]
    v_pk_fma_f32 v[60:61], v[106:107], v[94:95], v[60:61]
    v_pk_fma_f32 v[14:15], v[100:101], v[72:73], v[14:15]
    v_pk_fma_f32 v[30:31], v[102:103], v[80:81], v[30:31]
    v_pk_fma_f32 v[46:47], v[104:105], v[88:89], v[46:47]
    v_pk_fma_f32 v[62:63], v[106:107], v[96:97], v[62:63]
    v_pk_mul_f32 v[16:17], v[100:101], v[74:75]
    v_pk_mul_f32 v[32:33], v[102:103], v[82:83]
    v_pk_mul_f32 v[48:49], v[104:105], v[90:91]
    v_pk_mul_f32 v[64:65], v[106:107], v[98:99]
    s_waitcnt vmcnt(11)
    v_lshlrev_b32 v100, 16, v136
    v_and_b32 v101, 0xffff0000, v136
    v_lshlrev_b32 v102, 16, v137
    v_and_b32 v103, 0xffff0000, v137
    v_lshlrev_b32 v104, 16, v138
    v_and_b32 v105, 0xffff0000, v138
    v_lshlrev_b32 v106, 16, v139
    v_and_b32 v107, 0xffff0000, v139
    v_pk_fma_f32 v[12:13], v[100:101], v[68:69], v[12:13]
    v_pk_fma_f32 v[28:29], v[102:103], v[76:77], v[28:29]
    v_pk_fma_f32 v[44:45], v[104:105], v[84:85], v[44:45]
    v_pk_fma_f32 v[60:61], v[106:107], v[92:93], v[60:61]
    v_pk_fma_f32 v[14:15], v[100:101], v[70:71], v[14:15]
    v_pk_fma_f32 v[30:31], v[102:103], v[78:79], v[30:31]
    v_pk_fma_f32 v[46:47], v[104:105], v[86:87], v[46:47]
    v_pk_fma_f32 v[62:63], v[106:107], v[94:95], v[62:63]
    v_pk_fma_f32 v[16:17], v[100:101], v[72:73], v[16:17]
    v_pk_fma_f32 v[32:33], v[102:103], v[80:81], v[32:33]
    v_pk_fma_f32 v[48:49], v[104:105], v[88:89], v[48:49]
    v_pk_fma_f32 v[64:65], v[106:107], v[96:97], v[64:65]
    v_pk_mul_f32 v[18:19], v[100:101], v[74:75]
    v_pk_mul_f32 v[34:35], v[102:103], v[82:83]
    v_pk_mul_f32 v[50:51], v[104:105], v[90:91]
    v_pk_mul_f32 v[66:67], v[106:107], v[98:99]
    s_waitcnt vmcnt(10)
    v_lshlrev_b32 v100, 16, v140
    v_and_b32 v101, 0xffff0000, v140
    v_lshlrev_b32 v102, 16, v141
    v_and_b32 v103, 0xffff0000, v141
    v_lshlrev_b32 v104, 16, v142
    v_and_b32 v105, 0xffff0000, v142
    v_lshlrev_b32 v106, 16, v143
    v_and_b32 v107, 0xffff0000, v143
    v_pk_fma_f32 v[14:15], v[100:101], v[68:69], v[14:15]
    v_pk_fma_f32 v[30:31], v[102:103], v[76:77], v[30:31]
    v_pk_fma_f32 v[46:47], v[104:105], v[84:85], v[46:47]
    v_pk_fma_f32 v[62:63], v[106:107], v[92:93], v[62:63]
    v_pk_fma_f32 v[16:17], v[100:101], v[70:71], v[16:17]
    v_pk_fma_f32 v[32:33], v[102:103], v[78:79], v[32:33]
    v_pk_fma_f32 v[48:49], v[104:105], v[86:87], v[48:49]
    v_pk_fma_f32 v[64:65], v[106:107], v[94:95], v[64:65]
    v_pk_fma_f32 v[18:19], v[100:101], v[72:73], v[18:19]
    v_pk_fma_f32 v[34:35], v[102:103], v[80:81], v[34:35]
    v_pk_fma_f32 v[50:51], v[104:105], v[88:89], v[50:51]
    v_pk_fma_f32 v[66:67], v[106:107], v[96:97], v[66:67]
    s_waitcnt vmcnt(9)
    v_lshlrev_b32 v100, 16, v144
    v_and_b32 v101, 0xffff0000, v144
    v_lshlrev_b32 v102, 16, v145
    v_and_b32 v103, 0xffff0000, v145
    v_lshlrev_b32 v104, 16, v146
    v_and_b32 v105, 0xffff0000, v146
    v_lshlrev_b32 v106, 16, v147
    v_and_b32 v107, 0xffff0000, v147
    v_pk_fma_f32 v[16:17], v[100:101], v[68:69], v[16:17]
    v_pk_fma_f32 v[32:33], v[102:103], v[76:77], v[32:33]
    v_pk_fma_f32 v[48:49], v[104:105], v[84:85], v[48:49]
    v_pk_fma_f32 v[64:65], v[106:107], v[92:93], v[64:65]
    v_pk_fma_f32 v[18:19], v[100:101], v[70:71], v[18:19]
    v_pk_fma_f32 v[34:35], v[102:103], v[78:79], v[34:35]
    v_pk_fma_f32 v[50:51], v[104:105], v[86:87], v[50:51]
    v_pk_fma_f32 v[66:67], v[106:107], v[94:95], v[66:67]
    s_waitcnt vmcnt(8)
    v_lshlrev_b32 v100, 16, v148
    v_and_b32 v101, 0xffff0000, v148
    v_lshlrev_b32 v102, 16, v149
    v_and_b32 v103, 0xffff0000, v149
    v_lshlrev_b32 v104, 16, v150
    v_and_b32 v105, 0xffff0000, v150
    v_lshlrev_b32 v106, 16, v151
    v_and_b32 v107, 0xffff0000, v151
    v_pk_fma_f32 v[18:19], v[100:101], v[68:69], v[18:19]
    v_pk_fma_f32 v[34:35], v[102:103], v[76:77], v[34:35]
    v_pk_fma_f32 v[50:51], v[104:105], v[84:85], v[50:51]
    v_pk_fma_f32 v[66:67], v[106:107], v[92:93], v[66:67]
    s_waitcnt vmcnt(7)
    v_lshlrev_b32 v100, 16, v152
    v_and_b32 v101, 0xffff0000, v152
    v_lshlrev_b32 v102, 16, v153
    v_and_b32 v103, 0xffff0000, v153
    v_lshlrev_b32 v104, 16, v154
    v_and_b32 v105, 0xffff0000, v154
    v_lshlrev_b32 v106, 16, v155
    v_and_b32 v107, 0xffff0000, v155
    v_pk_mul_f32 v[4:5], v[4:5], v[100:101]
    v_pk_mul_f32 v[20:21], v[20:21], v[102:103]
    v_pk_mul_f32 v[36:37], v[36:37], v[104:105]
    v_pk_mul_f32 v[52:53], v[52:53], v[106:107]
    s_waitcnt vmcnt(6)
    v_lshlrev_b32 v100, 16, v156
    v_and_b32 v101, 0xffff0000, v156
    v_lshlrev_b32 v102, 16, v157
    v_and_b32 v103, 0xffff0000, v157
    v_lshlrev_b32 v104, 16, v158
    v_and_b32 v105, 0xffff0000, v158
    v_lshlrev_b32 v106, 16, v159
    v_and_b32 v107, 0xffff0000, v159
    v_pk_mul_f32 v[6:7], v[6:7], v[100:101]
    v_pk_mul_f32 v[22:23], v[22:23], v[102:103]
    v_pk_mul_f32 v[38:39], v[38:39], v[104:105]
    v_pk_mul_f32 v[54:55], v[54:55], v[106:107]
    v_cvt_pk_bf16_f32 v111, v6, v4
    v_cvt_pk_bf16_f32 v115, v7, v5
    v_cvt_pk_bf16_f32 v119, v22, v20
    v_cvt_pk_bf16_f32 v123, v23, v21
    v_cvt_pk_bf16_f32 v127, v38, v36
    v_cvt_pk_bf16_f32 v131, v39, v37
    v_cvt_pk_bf16_f32 v135, v54, v52
    v_cvt_pk_bf16_f32 v139, v55, v53
    s_waitcnt vmcnt(5)
    v_lshlrev_b32 v100, 16, v160
    v_and_b32 v101, 0xffff0000, v160
    v_lshlrev_b32 v102, 16, v161
    v_and_b32 v103, 0xffff0000, v161
    v_lshlrev_b32 v104, 16, v162
    v_and_b32 v105, 0xffff0000, v162
    v_lshlrev_b32 v106, 16, v163
    v_and_b32 v107, 0xffff0000, v163
    v_pk_mul_f32 v[8:9], v[8:9], v[100:101]
    v_pk_mul_f32 v[24:25], v[24:25], v[102:103]
    v_pk_mul_f32 v[40:41], v[40:41], v[104:105]
    v_pk_mul_f32 v[56:57], v[56:57], v[106:107]
    s_waitcnt vmcnt(4)
    v_lshlrev_b32 v100, 16, v164
    v_and_b32 v101, 0xffff0000, v164
    v_lshlrev_b32 v102, 16, v165
    v_and_b32 v103, 0xffff0000, v165
    v_lshlrev_b32 v104, 16, v166
    v_and_b32 v105, 0xffff0000, v166
    v_lshlrev_b32 v106, 16, v167
    v_and_b32 v107, 0xffff0000, v167
    v_pk_mul_f32 v[10:11], v[10:11], v[100:101]
    v_pk_mul_f32 v[26:27], v[26:27], v[102:103]
    v_pk_mul_f32 v[42:43], v[42:43], v[104:105]
    v_pk_mul_f32 v[58:59], v[58:59], v[106:107]
    v_cvt_pk_bf16_f32 v110, v10, v8
    v_cvt_pk_bf16_f32 v114, v11, v9
    v_cvt_pk_bf16_f32 v118, v26, v24
    v_cvt_pk_bf16_f32 v122, v27, v25
    v_cvt_pk_bf16_f32 v126, v42, v40
    v_cvt_pk_bf16_f32 v130, v43, v41
    v_cvt_pk_bf16_f32 v134, v58, v56
    v_cvt_pk_bf16_f32 v138, v59, v57
    s_waitcnt vmcnt(3)
    v_lshlrev_b32 v100, 16, v168
    v_and_b32 v101, 0xffff0000, v168
    v_lshlrev_b32 v102, 16, v169
    v_and_b32 v103, 0xffff0000, v169
    v_lshlrev_b32 v104, 16, v170
    v_and_b32 v105, 0xffff0000, v170
    v_lshlrev_b32 v106, 16, v171
    v_and_b32 v107, 0xffff0000, v171
    v_pk_mul_f32 v[12:13], v[12:13], v[100:101]
    v_pk_mul_f32 v[28:29], v[28:29], v[102:103]
    v_pk_mul_f32 v[44:45], v[44:45], v[104:105]
    v_pk_mul_f32 v[60:61], v[60:61], v[106:107]
    s_waitcnt vmcnt(2)
    v_lshlrev_b32 v100, 16, v172
    v_and_b32 v101, 0xffff0000, v172
    v_lshlrev_b32 v102, 16, v173
    v_and_b32 v103, 0xffff0000, v173
    v_lshlrev_b32 v104, 16, v174
    v_and_b32 v105, 0xffff0000, v174
    v_lshlrev_b32 v106, 16, v175
    v_and_b32 v107, 0xffff0000, v175
    v_pk_mul_f32 v[14:15], v[14:15], v[100:101]
    v_pk_mul_f32 v[30:31], v[30:31], v[102:103]
    v_pk_mul_f32 v[46:47], v[46:47], v[104:105]
    v_pk_mul_f32 v[62:63], v[62:63], v[106:107]
    v_cvt_pk_bf16_f32 v109, v14, v12
    v_cvt_pk_bf16_f32 v113, v15, v13
    v_cvt_pk_bf16_f32 v117, v30, v28
    v_cvt_pk_bf16_f32 v121, v31, v29
    v_cvt_pk_bf16_f32 v125, v46, v44
    v_cvt_pk_bf16_f32 v129, v47, v45
    v_cvt_pk_bf16_f32 v133, v62, v60
    v_cvt_pk_bf16_f32 v137, v63, v61
    s_waitcnt vmcnt(1)
    v_lshlrev_b32 v100, 16, v176
    v_and_b32 v101, 0xffff0000, v176
    v_lshlrev_b32 v102, 16, v177
    v_and_b32 v103, 0xffff0000, v177
    v_lshlrev_b32 v104, 16, v178
    v_and_b32 v105, 0xffff0000, v178
    v_lshlrev_b32 v106, 16, v179
    v_and_b32 v107, 0xffff0000, v179
    v_pk_mul_f32 v[16:17], v[16:17], v[100:101]
    v_pk_mul_f32 v[32:33], v[32:33], v[102:103]
    v_pk_mul_f32 v[48:49], v[48:49], v[104:105]
    v_pk_mul_f32 v[64:65], v[64:65], v[106:107]
    s_waitcnt vmcnt(0)
    v_lshlrev_b32 v100, 16, v180
    v_and_b32 v101, 0xffff0000, v180
    v_lshlrev_b32 v102, 16, v181
    v_and_b32 v103, 0xffff0000, v181
    v_lshlrev_b32 v104, 16, v182
    v_and_b32 v105, 0xffff0000, v182
    v_lshlrev_b32 v106, 16, v183
    v_and_b32 v107, 0xffff0000, v183
    v_pk_mul_f32 v[18:19], v[18:19], v[100:101]
    v_pk_mul_f32 v[34:35], v[34:35], v[102:103]
    v_pk_mul_f32 v[50:51], v[50:51], v[104:105]
    v_pk_mul_f32 v[66:67], v[66:67], v[106:107]
    v_cvt_pk_bf16_f32 v108, v18, v16
    ds_write_b128 v247, v[108:111] offset:0
    v_cvt_pk_bf16_f32 v112, v19, v17
    ds_write_b128 v247, v[112:115] offset:128
    v_cvt_pk_bf16_f32 v116, v34, v32
    ds_write_b128 v247, v[116:119] offset:256
    v_cvt_pk_bf16_f32 v120, v35, v33
    ds_write_b128 v247, v[120:123] offset:384
    v_cvt_pk_bf16_f32 v124, v50, v48
    ds_write_b128 v247, v[124:127] offset:512
    v_cvt_pk_bf16_f32 v128, v51, v49
    ds_write_b128 v247, v[128:131] offset:640
    v_cvt_pk_bf16_f32 v132, v66, v64
    ds_write_b128 v247, v[132:135] offset:768
    v_cvt_pk_bf16_f32 v136, v67, v65
    ds_write_b128 v247, v[136:139] offset:896
    ds_read_b128 v[152:155], v248 offset:0
    ds_read_b128 v[156:159], v248 offset:1040
    ds_read_b128 v[160:163], v248 offset:2080
    ds_read_b128 v[164:167], v248 offset:3120
    ds_read_b128 v[168:171], v248 offset:4160
    ds_read_b128 v[172:175], v248 offset:5200
    ds_read_b128 v[176:179], v248 offset:6240
    ds_read_b128 v[180:183], v248 offset:7280
    s_mov_b32 s87, 0
    s_waitcnt lgkmcnt(7)
    buffer_store_dwordx4 v[152:155], v249, s[80:83], s87 offen sc1
    s_mov_b32 s87, 33792
    s_waitcnt lgkmcnt(6)
    buffer_store_dwordx4 v[156:159], v249, s[80:83], s87 offen sc1
    s_mov_b32 s87, 67584
    s_waitcnt lgkmcnt(5)
    buffer_store_dwordx4 v[160:163], v249, s[80:83], s87 offen sc1
    s_mov_b32 s87, 101376
    s_waitcnt lgkmcnt(4)
    buffer_store_dwordx4 v[164:167], v249, s[80:83], s87 offen sc1
    s_mov_b32 s87, 135168
    s_waitcnt lgkmcnt(3)
    buffer_store_dwordx4 v[168:171], v249, s[80:83], s87 offen sc1
    s_mov_b32 s87, 168960
    s_waitcnt lgkmcnt(2)
    buffer_store_dwordx4 v[172:175], v249, s[80:83], s87 offen sc1
    s_mov_b32 s87, 202752
    s_waitcnt lgkmcnt(1)
    buffer_store_dwordx4 v[176:179], v249, s[80:83], s87 offen sc1
    s_mov_b32 s87, 236544
    s_waitcnt lgkmcnt(0)
    buffer_store_dwordx4 v[180:183], v249, s[80:83], s87 offen sc1
L_nopre:
    v_mov_b64 v[4:5], 0
    v_mov_b64 v[6:7], 0
    v_mov_b64 v[8:9], 0
    v_mov_b64 v[10:11], 0
    v_mov_b64 v[12:13], 0
    v_mov_b64 v[14:15], 0
    v_mov_b64 v[16:17], 0
    v_mov_b64 v[18:19], 0
    v_mov_b64 v[20:21], 0
    v_mov_b64 v[22:23], 0
    v_mov_b64 v[24:25], 0
    v_mov_b64 v[26:27], 0
    v_mov_b64 v[28:29], 0
    v_mov_b64 v[30:31], 0
    v_mov_b64 v[32:33], 0
    v_mov_b64 v[34:35], 0
    v_mov_b64 v[36:37], 0
    v_mov_b64 v[38:39], 0
    v_mov_b64 v[40:41], 0
    v_mov_b64 v[42:43], 0
    v_mov_b64 v[44:45], 0
    v_mov_b64 v[46:47], 0
    v_mov_b64 v[48:49], 0
    v_mov_b64 v[50:51], 0
    v_mov_b64 v[52:53], 0
    v_mov_b64 v[54:55], 0
    v_mov_b64 v[56:57], 0
    v_mov_b64 v[58:59], 0
    v_mov_b64 v[60:61], 0
    v_mov_b64 v[62:63], 0
    v_mov_b64 v[64:65], 0
    v_mov_b64 v[66:67], 0
    v_mov_b64 v[68:69], 0
    v_mov_b64 v[70:71], 0
    v_mov_b64 v[72:73], 0
    v_mov_b64 v[74:75], 0
    v_mov_b64 v[76:77], 0
    v_mov_b64 v[78:79], 0
    v_mov_b64 v[80:81], 0
    v_mov_b64 v[82:83], 0
    v_mov_b64 v[84:85], 0
    v_mov_b64 v[86:87], 0
    v_mov_b64 v[88:89], 0
    v_mov_b64 v[90:91], 0
    v_mov_b64 v[92:93], 0
    v_mov_b64 v[94:95], 0
    v_mov_b64 v[96:97], 0
    v_mov_b64 v[98:99], 0
    v_mov_b64 v[100:101], 0
    v_mov_b64 v[102:103], 0
    v_mov_b64 v[104:105], 0
    v_mov_b64 v[106:107], 0
    s_waitcnt lgkmcnt(0)
    s_and_b32 s37, s2, 7
    s_xor_b32 s37, s37, 2
    s_lshl_b32 s37, s37, 5
    s_lshr_b32 s38, s2, 3
    s_add_u32 s37, s37, s38
    s_add_u32 s37, s37, 256
    s_lshl_b32 s37, s37, 8
    s_cmp_eq_u32 s33, 0
    s_cselect_b32 s37, s37, s57
    s_cmp_eq_u32 s32, 0
    s_cbranch_scc0 L_noclear
    s_mov_b64 exec, 1
    buffer_store_dword v4, off, s[52:55], s37 sc1
    s_mov_b64 exec, -1
L_noclear:
    s_mov_b32 s37, 41984
    s_mov_b32 s36, 15
    s_barrier
    ds_read_b128 v[108:111], v196 offset:0
    ds_read_b64_tr_b16 v[124:125], v200 offset:0
    ds_read_b64_tr_b16 v[126:127], v200 offset:512
    ds_read_b128 v[112:115], v196 offset:2048
    ds_read_b64_tr_b16 v[128:129], v201 offset:0
    ds_read_b64_tr_b16 v[130:131], v201 offset:512
    ds_read_b128 v[116:119], v196 offset:4096
    ds_read_b64_tr_b16 v[148:149], v200 offset:8192
    ds_read_b64_tr_b16 v[150:151], v200 offset:8704
    ds_read_b128 v[120:123], v196 offset:6144
    ds_read_b64_tr_b16 v[132:133], v201 offset:8192
    ds_read_b64_tr_b16 v[134:135], v201 offset:8704
    ds_read_b64_tr_b16 v[156:157], v200 offset:16384
    ds_read_b64_tr_b16 v[158:159], v200 offset:16896
    ds_read_b64_tr_b16 v[136:137], v201 offset:16384
    ds_read_b64_tr_b16 v[138:139], v201 offset:16896
    s_branch L_g1_head
L_g1_rare:
    v_readfirstlane_b32 s38, v1
    s_nop 0
    s_cmp_ge_u32 s38, 4
    s_cbranch_scc1 L_sl_done_54
    s_mov_b32 s39, 1048576
L_sl_loop_55:
    ds_read_b32 v1, v228 offset:24
    s_waitcnt lgkmcnt(0)
    v_readfirstlane_b32 s38, v1
    s_nop 0
    s_cmp_ge_u32 s38, 4
    s_cbranch_scc1 L_sl_done_54
    s_sleep 1
    s_sub_u32 s39, s39, 1
    s_cbranch_scc0 L_sl_loop_55
L_sl_done_54:
    s_branch L_g1_nobar
.p2align 6
L_g1_head:
    s_waitcnt lgkmcnt(0)
L_g1_loop:
    v_mfma_f32_16x16x32_bf16 v[4:7], v[124:127], v[108:111], v[4:7]
    ds_read_b128 v[164:167], v197 offset:0
    v_mfma_f32_16x16x32_bf16 v[12:15], v[124:127], v[112:115], v[12:15]
    ds_read_b64_tr_b16 v[180:181], v200 offset:4096
    v_mfma_f32_16x16x32_bf16 v[20:23], v[124:127], v[116:119], v[20:23]
    ds_read_b64_tr_b16 v[182:183], v200 offset:4608
    v_mfma_f32_16x16x32_bf16 v[28:31], v[124:127], v[120:123], v[28:31]
    ds_read_b128 v[168:171], v197 offset:2048
    v_mfma_f32_16x16x32_bf16 v[32:35], v[128:131], v[120:123], v[32:35]
    ds_read_b64_tr_b16 v[184:185], v201 offset:4096
    v_mfma_f32_16x16x32_bf16 v[24:27], v[128:131], v[116:119], v[24:27]
    ds_read_b64_tr_b16 v[186:187], v201 offset:4608
    v_mfma_f32_16x16x32_bf16 v[16:19], v[128:131], v[112:115], v[16:19]
    ds_read_b128 v[172:175], v197 offset:4096
    v_mfma_f32_16x16x32_bf16 v[8:11], v[128:131], v[108:111], v[8:11]
    ds_read_b64_tr_b16 v[152:153], v200 offset:12288
    v_mfma_f32_16x16x32_bf16 v[40:43], v[132:135], v[108:111], v[40:43]
    ds_read_b64_tr_b16 v[154:155], v200 offset:12800
    v_mfma_f32_16x16x32_bf16 v[48:51], v[132:135], v[112:115], v[48:51]
    ds_read_b128 v[176:179], v197 offset:6144
    v_mfma_f32_16x16x32_bf16 v[56:59], v[132:135], v[116:119], v[56:59]
    ds_read_b64_tr_b16 v[188:189], v201 offset:12288
    v_mfma_f32_16x16x32_bf16 v[64:67], v[132:135], v[120:123], v[64:67]
    ds_read_b64_tr_b16 v[190:191], v201 offset:12800
    v_mfma_f32_16x16x32_bf16 v[60:63], v[148:151], v[120:123], v[60:63]
    ds_read2_b32 v[140:141], v198 offset1:2
    v_mfma_f32_16x16x32_bf16 v[52:55], v[148:151], v[116:119], v[52:55]
    ds_read2_b32 v[142:143], v199 offset1:2
    v_mfma_f32_16x16x32_bf16 v[44:47], v[148:151], v[112:115], v[44:47]
    ds_read_b64_tr_b16 v[160:161], v200 offset:20480
    v_mfma_f32_16x16x32_bf16 v[36:39], v[148:151], v[108:111], v[36:39]
    ds_read_b64_tr_b16 v[162:163], v200 offset:20992
    v_mfma_f32_16x16x32_bf16 v[68:71], v[108:111], v[156:159], v[68:71]
    ds_read_b64_tr_b16 v[192:193], v201 offset:20480
    ds_read_b64_tr_b16 v[194:195], v201 offset:20992
    v_mfma_f32_16x16x32_bf16 v[76:79], v[112:115], v[156:159], v[76:79]
    ds_read_b32 v1, v228 offset:24
    s_add_u32 s34, s34, 41984
    v_mfma_f32_16x16x32_bf16 v[84:87], v[116:119], v[156:159], v[84:87]
    s_cmp_eq_u32 s34, 125952
    s_cselect_b32 s35, -83968, s37
    v_mfma_f32_16x16x32_bf16 v[92:95], v[120:123], v[156:159], v[92:95]
    s_cselect_b32 s34, 0, s34
    s_cmp_eq_u32 s36, 1
    v_mfma_f32_16x16x32_bf16 v[96:99], v[120:123], v[136:139], v[96:99]
    v_add_u32 v196, s35, v196
    v_add_u32 v197, s35, v197
    v_mfma_f32_16x16x32_bf16 v[88:91], v[116:119], v[136:139], v[88:91]
    v_add_u32 v198, s35, v198
    v_add_u32 v199, s35, v199
    v_mfma_f32_16x16x32_bf16 v[80:83], v[112:115], v[136:139], v[80:83]
    v_add_u32 v200, s35, v200
    v_add_u32 v201, s35, v201
    v_mfma_f32_16x16x32_bf16 v[72:75], v[108:111], v[136:139], v[72:75]
    s_waitcnt lgkmcnt(0)
    v_smfmac_f32_16x16x64_bf16 v[100:103], v[140:143], v[148:155], v202
    v_smfmac_f32_16x16x64_bf16 v[104:107], v[140:143], v[156:163], v202
    s_cbranch_scc1 L_g1_rare
L_g1_bar:
    s_barrier
L_g1_nobar:
    v_mfma_f32_16x16x32_bf16 v[4:7], v[180:183], v[164:167], v[4:7]
    ds_read_b128 v[108:111], v196 offset:0
    v_mfma_f32_16x16x32_bf16 v[12:15], v[180:183], v[168:171], v[12:15]
    ds_read_b64_tr_b16 v[124:125], v200 offset:0
    v_mfma_f32_16x16x32_bf16 v[20:23], v[180:183], v[172:175], v[20:23]
    ds_read_b64_tr_b16 v[126:127], v200 offset:512
    v_mfma_f32_16x16x32_bf16 v[28:31], v[180:183], v[176:179], v[28:31]
    ds_read_b128 v[112:115], v196 offset:2048
    v_mfma_f32_16x16x32_bf16 v[32:35], v[184:187], v[176:179], v[32:35]
    ds_read_b64_tr_b16 v[128:129], v201 offset:0
    v_mfma_f32_16x16x32_bf16 v[24:27], v[184:187], v[172:175], v[24:27]
    ds_read_b64_tr_b16 v[130:131], v201 offset:512
    v_mfma_f32_16x16x32_bf16 v[16:19], v[184:187], v[168:171], v[16:19]
    ds_read_b128 v[116:119], v196 offset:4096
    v_mfma_f32_16x16x32_bf16 v[8:11], v[184:187], v[164:167], v[8:11]
    ds_read_b64_tr_b16 v[148:149], v200 offset:8192
    v_mfma_f32_16x16x32_bf16 v[40:43], v[188:191], v[164:167], v[40:43]
    ds_read_b64_tr_b16 v[150:151], v200 offset:8704
    v_mfma_f32_16x16x32_bf16 v[48:51], v[188:191], v[168:171], v[48:51]
    ds_read_b128 v[120:123], v196 offset:6144
    v_mfma_f32_16x16x32_bf16 v[56:59], v[188:191], v[172:175], v[56:59]
    ds_read_b64_tr_b16 v[132:133], v201 offset:8192
    v_mfma_f32_16x16x32_bf16 v[64:67], v[188:191], v[176:179], v[64:67]
    ds_read_b64_tr_b16 v[134:135], v201 offset:8704
    v_mfma_f32_16x16x32_bf16 v[60:63], v[152:155], v[176:179], v[60:63]
    ds_read_b64_tr_b16 v[156:157], v200 offset:16384
    v_mfma_f32_16x16x32_bf16 v[52:55], v[152:155], v[172:175], v[52:55]
    ds_read_b64_tr_b16 v[158:159], v200 offset:16896
    v_mfma_f32_16x16x32_bf16 v[44:47], v[152:155], v[168:171], v[44:47]
    ds_read_b64_tr_b16 v[136:137], v201 offset:16384
    v_mfma_f32_16x16x32_bf16 v[36:39], v[152:155], v[164:167], v[36:39]
    ds_read_b64_tr_b16 v[138:139], v201 offset:16896
    v_mfma_f32_16x16x32_bf16 v[68:71], v[164:167], v[160:163], v[68:71]
    s_sub_u32 s36, s36, 1
    v_mfma_f32_16x16x32_bf16 v[76:79], v[168:171], v[160:163], v[76:79]
    s_cmp_lg_u32 s36, 0
    v_mfma_f32_16x16x32_bf16 v[84:87], v[172:175], v[160:163], v[84:87]
    v_mfma_f32_16x16x32_bf16 v[92:95], v[176:179], v[160:163], v[92:95]
    v_mfma_f32_16x16x32_bf16 v[96:99], v[176:179], v[192:195], v[96:99]
    v_mfma_f32_16x16x32_bf16 v[88:91], v[172:175], v[192:195], v[88:91]
    v_mfma_f32_16x16x32_bf16 v[80:83], v[168:171], v[192:195], v[80:83]
    s_waitcnt vmcnt(0) lgkmcnt(0)
    v_mfma_f32_16x16x32_bf16 v[72:75], v[164:167], v[192:195], v[72:75]
    s_cbranch_scc1 L_g1_loop
    v_mfma_f32_16x16x32_bf16 v[4:7], v[124:127], v[108:111], v[4:7]
    ds_read_b128 v[164:167], v197 offset:0
    v_mfma_f32_16x16x32_bf16 v[12:15], v[124:127], v[112:115], v[12:15]
    ds_read_b64_tr_b16 v[180:181], v200 offset:4096
    v_mfma_f32_16x16x32_bf16 v[20:23], v[124:127], v[116:119], v[20:23]
    ds_read_b64_tr_b16 v[182:183], v200 offset:4608
    v_mfma_f32_16x16x32_bf16 v[28:31], v[124:127], v[120:123], v[28:31]
    ds_read_b128 v[168:171], v197 offset:2048
    v_mfma_f32_16x16x32_bf16 v[32:35], v[128:131], v[120:123], v[32:35]
    ds_read_b64_tr_b16 v[184:185], v201 offset:4096
    v_mfma_f32_16x16x32_bf16 v[24:27], v[128:131], v[116:119], v[24:27]
    ds_read_b64_tr_b16 v[186:187], v201 offset:4608
    v_mfma_f32_16x16x32_bf16 v[16:19], v[128:131], v[112:115], v[16:19]
    ds_read_b128 v[172:175], v197 offset:4096
    v_mfma_f32_16x16x32_bf16 v[8:11], v[128:131], v[108:111], v[8:11]
    ds_read_b64_tr_b16 v[152:153], v200 offset:12288
    v_mfma_f32_16x16x32_bf16 v[40:43], v[132:135], v[108:111], v[40:43]
    ds_read_b64_tr_b16 v[154:155], v200 offset:12800
    v_mfma_f32_16x16x32_bf16 v[48:51], v[132:135], v[112:115], v[48:51]
    ds_read_b128 v[176:179], v197 offset:6144
    v_mfma_f32_16x16x32_bf16 v[56:59], v[132:135], v[116:119], v[56:59]
    ds_read_b64_tr_b16 v[188:189], v201 offset:12288
    v_mfma_f32_16x16x32_bf16 v[64:67], v[132:135], v[120:123], v[64:67]
    ds_read_b64_tr_b16 v[190:191], v201 offset:12800
    v_mfma_f32_16x16x32_bf16 v[60:63], v[148:151], v[120:123], v[60:63]
    ds_read2_b32 v[140:141], v198 offset1:2
    v_mfma_f32_16x16x32_bf16 v[52:55], v[148:151], v[116:119], v[52:55]
    ds_read2_b32 v[142:143], v199 offset1:2
    v_mfma_f32_16x16x32_bf16 v[44:47], v[148:151], v[112:115], v[44:47]
    ds_read_b64_tr_b16 v[160:161], v200 offset:20480
    v_mfma_f32_16x16x32_bf16 v[36:39], v[148:151], v[108:111], v[36:39]
    ds_read_b64_tr_b16 v[162:163], v200 offset:20992
    v_mfma_f32_16x16x32_bf16 v[68:71], v[108:111], v[156:159], v[68:71]
    ds_read_b64_tr_b16 v[192:193], v201 offset:20480
    v_mfma_f32_16x16x32_bf16 v[76:79], v[112:115], v[156:159], v[76:79]
    ds_read_b64_tr_b16 v[194:195], v201 offset:20992
    v_mfma_f32_16x16x32_bf16 v[84:87], v[116:119], v[156:159], v[84:87]
    v_mfma_f32_16x16x32_bf16 v[92:95], v[120:123], v[156:159], v[92:95]
    v_mfma_f32_16x16x32_bf16 v[96:99], v[120:123], v[136:139], v[96:99]
    v_mfma_f32_16x16x32_bf16 v[88:91], v[116:119], v[136:139], v[88:91]
    v_mfma_f32_16x16x32_bf16 v[80:83], v[112:115], v[136:139], v[80:83]
    v_mfma_f32_16x16x32_bf16 v[72:75], v[108:111], v[136:139], v[72:75]
    s_waitcnt lgkmcnt(0)
    s_setprio 2
    v_mov_b32 v2, 1
    v_smfmac_f32_16x16x64_bf16 v[100:103], v[140:143], v[148:155], v202
    v_smfmac_f32_16x16x64_bf16 v[104:107], v[140:143], v[156:163], v202
    v_mfma_f32_16x16x32_bf16 v[60:63], v[152:155], v[176:179], v[60:63]
    v_mfma_f32_16x16x32_bf16 v[64:67], v[188:191], v[176:179], v[64:67]
    v_mfma_f32_16x16x32_bf16 v[92:95], v[176:179], v[160:163], v[92:95]
    v_mfma_f32_16x16x32_bf16 v[96:99], v[176:179], v[192:195], v[96:99]
    v_mfma_f32_16x16x32_bf16 v[28:31], v[180:183], v[176:179], v[28:31]
    v_mfma_f32_16x16x32_bf16 v[32:35], v[184:187], v[176:179], v[32:35]
    v_mfma_f32_16x16x32_bf16 v[52:55], v[152:155], v[172:175], v[52:55]
    v_mfma_f32_16x16x32_bf16 v[56:59], v[188:191], v[172:175], v[56:59]
    s_nop 3
    v_permlane32_swap_b32 v100, v104
    v_permlane32_swap_b32 v101, v105
    v_mfma_f32_16x16x32_bf16 v[20:23], v[180:183], v[172:175], v[20:23]
    v_permlane32_swap_b32 v102, v106
    v_permlane32_swap_b32 v103, v107
    v_mfma_f32_16x16x32_bf16 v[24:27], v[184:187], v[172:175], v[24:27]
    v_add_f32 v100, v100, v104
    v_add_f32 v101, v101, v105
    v_mfma_f32_16x16x32_bf16 v[44:47], v[152:155], v[168:171], v[44:47]
    v_add_f32 v102, v102, v106
    v_add_f32 v103, v103, v107
    v_mfma_f32_16x16x32_bf16 v[48:51], v[188:191], v[168:171], v[48:51]
    v_cvt_pk_bf16_f32 v144, v100, v101
    v_cvt_pk_bf16_f32 v145, v102, v103
    v_mfma_f32_16x16x32_bf16 v[12:15], v[180:183], v[168:171], v[12:15]
    ds_write_b64 v219, v[144:145] offset:1024
    ds_write_b16 v203, v144 offset:0
    v_mfma_f32_16x16x32_bf16 v[16:19], v[184:187], v[168:171], v[16:19]
    ds_write_b16_d16_hi v203, v144 offset:8
    ds_write_b16 v203, v145 offset:16
    v_mfma_f32_16x16x32_bf16 v[36:39], v[152:155], v[164:167], v[36:39]
    ds_write_b16_d16_hi v203, v145 offset:24
    v_cvt_pk_bf16_f32 v140, v60, v61
    v_mfma_f32_16x16x32_bf16 v[40:43], v[188:191], v[164:167], v[40:43]
    v_cvt_pk_bf16_f32 v141, v62, v63
    v_cvt_pk_bf16_f32 v142, v64, v65
    v_mfma_f32_16x16x32_bf16 v[4:7], v[180:183], v[164:167], v[4:7]
    v_cvt_pk_bf16_f32 v143, v66, v67
    v_cvt_pk_bf16_f32 v238, v92, v93
    v_mfma_f32_16x16x32_bf16 v[8:11], v[184:187], v[164:167], v[8:11]
    v_cvt_pk_bf16_f32 v239, v94, v95
    v_cvt_pk_bf16_f32 v248, v96, v97
    v_mfma_f32_16x16x32_bf16 v[84:87], v[172:175], v[160:163], v[84:87]
    v_cvt_pk_bf16_f32 v249, v98, v99
    s_cmp_eq_u32 s33, 0
    s_cbranch_scc0 L_at_nopub
    ds_write_b64 v220, v[140:141] offset:2048
    ds_write_b64 v220, v[238:239] offset:3072
    ds_write_b64 v220, v[142:143] offset:2560
    ds_write_b64 v220, v[248:249] offset:3584
L_at_nopub:
    s_mov_b64 exec, 1
    ds_add_u32 v228, v2 offset:20
    s_mov_b64 exec, -1
    v_mfma_f32_16x16x32_bf16 v[88:91], v[172:175], v[192:195], v[88:91]
    v_cvt_pk_bf16_f32 v120, v28, v29
    v_cvt_pk_bf16_f32 v121, v30, v31
    v_mfma_f32_16x16x32_bf16 v[76:79], v[168:171], v[160:163], v[76:79]
    v_cvt_pk_bf16_f32 v122, v32, v33
    v_cvt_pk_bf16_f32 v123, v34, v35
    v_mfma_f32_16x16x32_bf16 v[80:83], v[168:171], v[192:195], v[80:83]
    v_cvt_pk_bf16_f32 v136, v52, v53
    v_cvt_pk_bf16_f32 v137, v54, v55
    v_mfma_f32_16x16x32_bf16 v[68:71], v[164:167], v[160:163], v[68:71]
    v_cvt_pk_bf16_f32 v138, v56, v57
    v_cvt_pk_bf16_f32 v139, v58, v59
    v_mfma_f32_16x16x32_bf16 v[72:75], v[164:167], v[192:195], v[72:75]
    v_cvt_pk_bf16_f32 v116, v20, v21
    v_cvt_pk_bf16_f32 v117, v22, v23
    v_mfma_f32_16x16x32_bf16 v[28:31], v[140:143], v[120:123], v[204:207]
    v_cvt_pk_bf16_f32 v118, v24, v25
    v_cvt_pk_bf16_f32 v119, v26, v27
    v_mfma_f32_16x16x32_bf16 v[32:35], v[136:139], v[120:123], v[208:211]
    v_cvt_pk_bf16_f32 v132, v44, v45
    v_cvt_pk_bf16_f32 v133, v46, v47
    v_mfma_f32_16x16x32_bf16 v[20:23], v[136:139], v[116:119], v[204:207]
    v_cvt_pk_bf16_f32 v134, v48, v49
    v_cvt_pk_bf16_f32 v135, v50, v51
    s_nop 1
    v_mfma_f32_16x16x32_bf16 v[24:27], v[132:135], v[116:119], v[208:211]
    v_cvt_pk_bf16_f32 v112, v12, v13
    v_cvt_pk_bf16_f32 v113, v14, v15
    v_cvt_pk_bf16_f32 v114, v16, v17
    v_cvt_pk_bf16_f32 v115, v18, v19
    s_nop 1
    v_mfma_f32_16x16x32_bf16 v[12:15], v[132:135], v[112:115], v[204:207]
    v_cvt_pk_bf16_f32 v128, v36, v37
    v_cvt_pk_bf16_f32 v129, v38, v39
    v_cvt_pk_bf16_f32 v130, v40, v41
    v_cvt_pk_bf16_f32 v131, v42, v43
    s_nop 1
    v_mfma_f32_16x16x32_bf16 v[16:19], v[128:131], v[112:115], v[208:211]
    v_cvt_pk_bf16_f32 v108, v4, v5
    v_cvt_pk_bf16_f32 v109, v6, v7
    v_cvt_pk_bf16_f32 v110, v8, v9
    v_cvt_pk_bf16_f32 v111, v10, v11
    s_nop 1
    v_mfma_f32_16x16x32_bf16 v[4:7], v[128:131], v[108:111], v[204:207]
    v_cvt_pk_bf16_f32 v236, v84, v85
    v_cvt_pk_bf16_f32 v237, v86, v87
    v_cvt_pk_bf16_f32 v246, v88, v89
    v_cvt_pk_bf16_f32 v247, v90, v91
    v_cvt_pk_bf16_f32 v234, v76, v77
    v_cvt_pk_bf16_f32 v235, v78, v79
    ds_read_b32 v1, v228 offset:20
    v_cvt_pk_bf16_f32 v244, v80, v81
    v_cvt_pk_bf16_f32 v245, v82, v83
    v_cvt_pk_bf16_f32 v232, v68, v69
    v_cvt_pk_bf16_f32 v233, v70, v71
    v_cvt_pk_bf16_f32 v242, v72, v73
    v_cvt_pk_bf16_f32 v243, v74, v75
    s_waitcnt lgkmcnt(0)
    v_readfirstlane_b32 s37, v1
    s_nop 0
    s_cmp_ge_u32 s37, 4
    s_cbranch_scc1 L_sl_done_56
    s_mov_b32 s38, 1048576
L_sl_loop_57:
    ds_read_b32 v1, v228 offset:20
    s_waitcnt lgkmcnt(0)
    v_readfirstlane_b32 s37, v1
    s_nop 0
    s_cmp_ge_u32 s37, 4
    s_cbranch_scc1 L_sl_done_56
    s_sleep 1
    s_sub_u32 s38, s38, 1
    s_cbranch_scc0 L_sl_loop_57
L_sl_done_56:
    ds_read_b64 v[124:125], v221
    ds_read_b64 v[126:127], v222
    ds_read_b64 v[230:231], v221 offset:1024
    ds_read_b64 v[240:241], v222 offset:1024
    v_max_f32 v28, v28, v32
    v_max_f32 v29, v29, v33
    v_max_f32 v30, v30, v34
    v_max_f32 v31, v31, v35
    v_max3_f32 v39, v28, v29, v30
    v_max_f32 v39, v39, v31
    v_max_f32 v20, v20, v24
    v_max_f32 v21, v21, v25
    v_max_f32 v22, v22, v26
    v_max_f32 v23, v23, v27
    v_max3_f32 v38, v20, v21, v22
    v_max_f32 v38, v38, v23
    s_waitcnt lgkmcnt(2)
    v_mfma_f32_16x16x32_bf16 v[8:11], v[124:127], v[108:111], v[212:215]
    s_setprio 2
    s_mov_b32 s37, 0x3e8293ee
    v_max_f32 v12, v12, v16
    v_max_f32 v13, v13, v17
    v_max_f32 v14, v14, v18
    v_max_f32 v15, v15, v19
    v_max3_f32 v37, v12, v13, v14
    v_max_f32 v37, v37, v15
    v_max_f32 v4, v4, v8
    v_max_f32 v5, v5, v9
    v_max_f32 v6, v6, v10
    v_max_f32 v7, v7, v11
    v_max3_f32 v36, v4, v5, v6
    v_max_f32 v36, v36, v7
    v_permlane32_swap_b32 v38, v39
    s_nop 0
    v_permlane32_swap_b32 v36, v37
    v_max_f32 v38, v38, v39
    v_max_f32 v36, v36, v37
    s_nop 1
    v_permlane16_swap_b32 v36, v38
    v_max_f32 v36, v36, v38
    v_mul_f32 v38, s37, v36
    v_mul_f32 v36, s37, v36
    s_nop 1
    v_permlane16_swap_b32 v36, v38
    v_mov_b32 v37, v36
    s_add_u32 m0, s60, 0
    v_mov_b32 v39, v38
    v_permlane32_swap_b32 v36, v37
    s_xor_b32 s63, s62, 0
    v_permlane32_swap_b32 v38, v39
    v_fma_f32 v4, v4, s37, -v36
    buffer_load_dwordx4 v227, s[44:47], s63 offen offset:0 lds
    v_fma_f32 v5, v5, s37, -v36
    v_fma_f32 v6, v6, s37, -v36
    buffer_load_dwordx4 v223, s[44:47], s63 offen offset:1024 lds
    v_fma_f32 v7, v7, s37, -v36
    v_fma_f32 v12, v12, s37, -v37
    s_add_u32 m0, s60, 8192
    v_fma_f32 v13, v13, s37, -v37
    v_fma_f32 v14, v14, s37, -v37
    s_xor_b32 s63, s62, 131072
    v_fma_f32 v15, v15, s37, -v37
    v_fma_f32 v20, v20, s37, -v38
    buffer_load_dwordx4 v227, s[44:47], s63 offen offset:0 lds
    v_fma_f32 v21, v21, s37, -v38
    v_fma_f32 v22, v22, s37, -v38
    buffer_load_dwordx4 v223, s[44:47], s63 offen offset:1024 lds
    v_fma_f32 v23, v23, s37, -v38
    v_fma_f32 v28, v28, s37, -v39
    s_add_u32 m0, s60, 16384
    v_fma_f32 v29, v29, s37, -v39
    v_fma_f32 v30, v30, s37, -v39
    s_xor_b32 s63, s62, 262144
    v_fma_f32 v31, v31, s37, -v39
    v_exp_f32 v28, v28
    buffer_load_dwordx4 v227, s[44:47], s63 offen offset:0 lds
    v_exp_f32 v29, v29
    v_exp_f32 v30, v30
    buffer_load_dwordx4 v223, s[44:47], s63 offen offset:1024 lds
    v_exp_f32 v31, v31
    v_exp_f32 v20, v20
    s_add_u32 m0, s60, 24576
    v_exp_f32 v21, v21
    v_exp_f32 v22, v22
    s_xor_b32 s63, s62, 393216
    v_exp_f32 v23, v23
    v_exp_f32 v12, v12
    buffer_load_dwordx4 v227, s[44:47], s63 offen offset:0 lds
    v_exp_f32 v13, v13
    v_exp_f32 v14, v14
    buffer_load_dwordx4 v223, s[44:47], s63 offen offset:1024 lds
    v_exp_f32 v15, v15
    v_exp_f32 v4, v4
    s_add_u32 m0, s60, 32768
    v_exp_f32 v5, v5
    v_exp_f32 v6, v6
    s_xor_b32 s63, s62, 524288
    v_exp_f32 v7, v7
    v_add_f32 v39, v28, v29
    buffer_load_dwordx4 v227, s[44:47], s63 offen offset:0 lds
    v_add_f32 v32, v30, v31
    v_add_f32 v39, v39, v32
    buffer_load_dwordx4 v223, s[44:47], s63 offen offset:1024 lds
    v_add_f32 v38, v20, v21
    v_add_f32 v24, v22, v23
    s_add_u32 m0, s60, 83968
    v_add_f32 v38, v38, v24
    v_add_f32 v37, v12, v13
    s_xor_b32 s63, s62, 655360
    v_add_f32 v16, v14, v15
    v_add_f32 v37, v37, v16
    buffer_load_dwordx4 v227, s[44:47], s63 offen offset:0 lds
    v_add_f32 v36, v4, v5
    v_add_f32 v8, v6, v7
    buffer_load_dwordx4 v223, s[44:47], s63 offen offset:1024 lds
    v_add_f32 v36, v36, v8
    v_permlane32_swap_b32 v38, v39
    s_add_u32 m0, s60, 92160
    v_permlane32_swap_b32 v36, v37
    v_add_f32 v38, v38, v39
    s_xor_b32 s63, s62, 786432
    v_add_f32 v36, v36, v37
    s_nop 1
    v_permlane16_swap_b32 v36, v38
    buffer_load_dwordx4 v227, s[44:47], s63 offen offset:0 lds
    v_add_f32 v36, v36, v38
    v_rcp_f32 v38, v36
    buffer_load_dwordx4 v223, s[44:47], s63 offen offset:1024 lds
    v_rcp_f32 v36, v36
    s_nop 1
    v_permlane16_swap_b32 v36, v38
    s_add_u32 m0, s60, 100352
    v_mov_b32 v37, v36
    v_mov_b32 v39, v38
    s_xor_b32 s63, s62, 917504
    v_permlane32_swap_b32 v36, v37
    v_permlane32_swap_b32 v38, v39
    buffer_load_dwordx4 v227, s[44:47], s63 offen offset:0 lds
    s_waitcnt lgkmcnt(0)
    v_mul_f32 v4, v4, v36
    buffer_load_dwordx4 v223, s[44:47], s63 offen offset:1024 lds
    v_mul_f32 v5, v5, v36
    v_mul_f32 v6, v6, v36
    s_add_u32 m0, s60, 108544
    v_mul_f32 v7, v7, v36
    v_cvt_pk_bf16_f32 v10, v4, v5
    s_xor_b32 s63, s62, 1048576
    v_cvt_pk_bf16_f32 v11, v6, v7
    v_and_b32 v8, v216, v10
    buffer_load_dwordx4 v227, s[44:47], s63 offen offset:0 lds
    v_and_b32 v9, v217, v11
    v_xor_b32 v10, v8, v10
    buffer_load_dwordx4 v223, s[44:47], s63 offen offset:1024 lds
    v_xor_b32 v11, v9, v11
    s_setprio 2
    s_add_u32 m0, s60, 116736
    v_mfma_f32_16x16x32_bf16 v[68:71], v[230:233], v[8:11], 0
    v_mfma_f32_16x16x32_bf16 v[72:75], v[240:243], v[8:11], 0
    s_xor_b32 s63, s62, 1179648
    s_setprio 2
    v_mul_f32 v12, v12, v37
    buffer_load_dwordx4 v227, s[44:47], s63 offen offset:0 lds
    v_mul_f32 v13, v13, v37
    v_mul_f32 v14, v14, v37
    buffer_load_dwordx4 v223, s[44:47], s63 offen offset:1024 lds
    v_mul_f32 v15, v15, v37
    v_cvt_pk_bf16_f32 v18, v12, v13
    v_cvt_pk_bf16_f32 v19, v14, v15
    v_and_b32 v16, v216, v18
    v_and_b32 v17, v217, v19
    v_xor_b32 v18, v16, v18
    v_xor_b32 v19, v17, v19
    v_cvt_pk_bf16_f32 v108, v68, v69
    v_cvt_pk_bf16_f32 v109, v70, v71
    v_cvt_pk_bf16_f32 v110, v72, v73
    v_cvt_pk_bf16_f32 v111, v74, v75
    s_mov_b32 s37, 0
    buffer_store_dwordx4 v[108:111], v218, s[40:43], s37 offen sc1
    s_setprio 2
    v_mfma_f32_16x16x32_bf16 v[76:79], v[232:235], v[16:19], 0
    v_mfma_f32_16x16x32_bf16 v[80:83], v[242:245], v[16:19], 0
    s_setprio 2
    v_mul_f32 v20, v20, v38
    v_mul_f32 v21, v21, v38
    v_mul_f32 v22, v22, v38
    v_mul_f32 v23, v23, v38
    v_cvt_pk_bf16_f32 v26, v20, v21
    v_cvt_pk_bf16_f32 v27, v22, v23
    v_and_b32 v24, v216, v26
    v_and_b32 v25, v217, v27
    v_xor_b32 v26, v24, v26
    v_xor_b32 v27, v25, v27
    v_cvt_pk_bf16_f32 v112, v76, v77
    v_cvt_pk_bf16_f32 v113, v78, v79
    v_cvt_pk_bf16_f32 v114, v80, v81
    v_cvt_pk_bf16_f32 v115, v82, v83
    s_mov_b32 s37, 32768
    buffer_store_dwordx4 v[112:115], v218, s[40:43], s37 offen sc1
    s_setprio 2
    v_mfma_f32_16x16x32_bf16 v[84:87], v[234:237], v[24:27], 0
    v_mfma_f32_16x16x32_bf16 v[88:91], v[244:247], v[24:27], 0
    s_setprio 2
    v_mul_f32 v28, v28, v39
    v_mul_f32 v29, v29, v39
    v_mul_f32 v30, v30, v39
    v_mul_f32 v31, v31, v39
    v_cvt_pk_bf16_f32 v34, v28, v29
    v_cvt_pk_bf16_f32 v35, v30, v31
    v_and_b32 v32, v216, v34
    v_and_b32 v33, v217, v35
    v_xor_b32 v34, v32, v34
    v_xor_b32 v35, v33, v35
    v_cvt_pk_bf16_f32 v116, v84, v85
    v_cvt_pk_bf16_f32 v117, v86, v87
    v_cvt_pk_bf16_f32 v118, v88, v89
    v_cvt_pk_bf16_f32 v119, v90, v91
    s_mov_b32 s37, 65536
    buffer_store_dwordx4 v[116:119], v218, s[40:43], s37 offen sc1
    s_setprio 2
    v_mfma_f32_16x16x32_bf16 v[92:95], v[236:239], v[32:35], 0
    v_mfma_f32_16x16x32_bf16 v[96:99], v[246:249], v[32:35], 0
    s_setprio 2
    s_nop 5
    v_cvt_pk_bf16_f32 v120, v92, v93
    v_cvt_pk_bf16_f32 v121, v94, v95
    v_cvt_pk_bf16_f32 v122, v96, v97
    v_cvt_pk_bf16_f32 v123, v98, v99
    s_mov_b32 s37, 98304
    buffer_store_dwordx4 v[120:123], v218, s[40:43], s37 offen sc1
    s_setprio 0
    s_lshl_b32 s37, s32, 11
    v_add_u32 v229, s37, v229
    v_xor_b32 v84, 0, v229
    v_xor_b32 v85, 32, v229
    v_xor_b32 v86, 64, v229
    v_xor_b32 v87, 96, v229
    v_add_u32 v88, 83968, v84
    v_add_u32 v89, 83968, v85
    v_add_u32 v90, 83968, v86
    v_add_u32 v91, 83968, v87
    v_add_u32 v92, 125952, v84
    v_add_u32 v93, 125952, v85
    v_add_u32 v94, 125952, v86
    v_add_u32 v95, 125952, v87
    v_xor_b32 v232, 2048, v229
    v_xor_b32 v233, 2080, v229
    v_xor_b32 v234, 2112, v229
    v_xor_b32 v235, 2144, v229
    v_add_u32 v236, 83968, v232
    v_add_u32 v237, 83968, v233
    v_add_u32 v238, 83968, v234
    v_add_u32 v239, 83968, v235
    v_add_u32 v240, 125952, v232
    v_add_u32 v241, 125952, v233
    v_add_u32 v242, 125952, v234
    v_add_u32 v243, 125952, v235
    s_mul_i32 s37, s32, 80896
    s_lshl_b32 s38, s33, 11
    s_add_u32 s37, s37, s38
    s_add_u32 s37, s37, 78848
    v_lshrrev_b32 v1, 5, v0
    v_xor_b32 v1, v1, v0
    v_and_b32 v1, 7, v1
    v_lshl_add_u32 v1, v1, 4, s37
    v_bfe_u32 v2, v0, 4, 1
    v_lshl_add_u32 v1, v2, 3, v1
    v_and_b32 v2, 15, v0
    v_lshl_add_u32 v244, v2, 7, v1
    v_xor_b32 v245, 32, v244
    v_xor_b32 v246, 64, v244
    v_xor_b32 v247, 96, v244
    v_lshrrev_b32 v1, 3, v0
    v_xor_b32 v1, v1, v0
    v_and_b32 v1, 7, v1
    v_and_b32 v2, 56, v0
    v_add_u32 v1, v1, v2
    v_lshl_add_u32 v248, v1, 4, s37
    v_lshl_add_u32 v231, v0, 4, s60
    v_add_u32 v230, 125952, v231
    s_add_u32 s64, s61, 0
    s_and_b32 s64, s64, 7
    s_lshl_b32 s64, s64, 12
    s_add_u32 s65, s61, 1
    s_and_b32 s65, s65, 7
    s_lshl_b32 s65, s65, 12
    s_add_u32 s66, s61, 2
    s_and_b32 s66, s66, 7
    s_lshl_b32 s66, s66, 12
    s_add_u32 s67, s61, 3
    s_and_b32 s67, s67, 7
    s_lshl_b32 s67, s67, 12
    s_add_u32 s68, s61, 4
    s_and_b32 s68, s68, 7
    s_lshl_b32 s68, s68, 12
    s_add_u32 s69, s61, 5
    s_and_b32 s69, s69, 7
    s_lshl_b32 s69, s69, 12
    s_add_u32 s70, s61, 6
    s_and_b32 s70, s70, 7
    s_lshl_b32 s70, s70, 12
    s_add_u32 s71, s61, 7
    s_and_b32 s71, s71, 7
    s_lshl_b32 s71, s71, 12
    s_waitcnt vmcnt(0)
    s_setprio 2
    v_mov_b32 v2, 1
    s_mov_b64 exec, 1
    ds_add_rtn_u32 v1, v228, v2 offset:0
    s_waitcnt lgkmcnt(0)
    v_readfirstlane_b32 s39, v1
    s_nop 0
    s_cmp_eq_u32 s39, 3
    s_cbranch_scc0 L_jo_58a
    s_mov_b64 exec, 0xffff
    v_lshlrev_b32 v1, 8, v0
    buffer_atomic_add v2, v1, s[52:55], s56 offen sc1
L_jo_58a:
    s_mov_b64 exec, -1
    s_setprio 0
    s_xor_b32 s63, s62, 1310720
    buffer_load_dwordx4 v[172:175], v227, s[44:47], s63 offen offset:0
    buffer_load_dwordx4 v[176:179], v223, s[44:47], s63 offen offset:1024
    s_xor_b32 s63, s62, 1441792
    buffer_load_dwordx4 v[180:183], v227, s[44:47], s63 offen offset:0
    buffer_load_dwordx4 v[184:187], v223, s[44:47], s63 offen offset:1024
    s_cmp_eq_u32 s39, 3
    s_cbranch_scc0 L_ps_60
    s_load_dword s37, s[52:53], s57 glc
L_ps_60:
    s_xor_b32 s63, s62, 1572864
    buffer_load_dwordx4 v[188:191], v227, s[44:47], s63 offen offset:0
    buffer_load_dwordx4 v[192:195], v223, s[44:47], s63 offen offset:1024
    s_xor_b32 s63, s62, 1703936
    buffer_load_dwordx4 v[196:199], v227, s[44:47], s63 offen offset:0
    buffer_load_dwordx4 v[200:203], v223, s[44:47], s63 offen offset:1024
    s_xor_b32 s63, s62, 1835008
    buffer_load_dwordx4 v[204:207], v227, s[44:47], s63 offen offset:0
    buffer_load_dwordx4 v[208:211], v223, s[44:47], s63 offen offset:1024
    s_xor_b32 s63, s62, 1966080
    buffer_load_dwordx4 v[212:215], v227, s[44:47], s63 offen offset:0
    buffer_load_dwordx4 v[216:219], v223, s[44:47], s63 offen offset:1024
    s_setprio 0
    s_cmp_eq_u32 s39, 3
    s_cbranch_scc0 L_jo_58
    s_mov_b32 s38, 131072
    s_branch L_sg_chk_63
L_sg_loop_62:
    s_load_dword s37, s[52:53], s57 glc
L_sg_chk_63:
    s_waitcnt lgkmcnt(0)
    s_cmp_ge_u32 s37, 16
    s_cbranch_scc1 L_sg_done_61
    s_sub_u32 s38, s38, 1
    s_cbranch_scc0 L_sg_loop_62
L_sg_done_61:
    v_mov_b32 v1, 16
    s_mov_b64 exec, 1
    ds_add_u32 v228, v1 offset:4
    s_mov_b64 exec, -1
L_jo_58:
    s_waitcnt vmcnt(12)
    s_mov_b64 exec, 1
    ds_add_u32 v228, v2 offset:4
    s_mov_b64 exec, -1
    s_mov_b32 s38, 1048576
L_sl_loop_65:
    ds_read_b32 v1, v228 offset:4
    s_waitcnt lgkmcnt(0)
    v_readfirstlane_b32 s37, v1
    s_nop 0
    s_cmp_ge_u32 s37, 20
    s_cbranch_scc1 L_sl_done_64
    s_sleep 1
    s_sub_u32 s38, s38, 1
    s_cbranch_scc0 L_sl_loop_65
L_sl_done_64:
L_jd_59:
    buffer_load_dwordx4 v[96:99], v224, s[40:43], s64 offen offset:0 sc1
    buffer_load_dwordx4 v[100:103], v225, s[40:43], s64 offen offset:0 sc1
    ds_read_b64_tr_b16 v[36:37], v84 offset:0
    ds_read_b64_tr_b16 v[38:39], v232 offset:0
    buffer_load_dwordx4 v[104:107], v224, s[40:43], s64 offen offset:1024 sc1
    buffer_load_dwordx4 v[108:111], v225, s[40:43], s64 offen offset:1024 sc1
    ds_read_b64_tr_b16 v[40:41], v85 offset:0
    ds_read_b64_tr_b16 v[42:43], v233 offset:0
    buffer_load_dwordx4 v[112:115], v224, s[40:43], s64 offen offset:2048 sc1
    buffer_load_dwordx4 v[116:119], v225, s[40:43], s64 offen offset:2048 sc1
    ds_read_b64_tr_b16 v[44:45], v86 offset:0
    ds_read_b64_tr_b16 v[46:47], v234 offset:0
    buffer_load_dwordx4 v[120:123], v224, s[40:43], s64 offen offset:3072 sc1
    buffer_load_dwordx4 v[124:127], v225, s[40:43], s64 offen offset:3072 sc1
    ds_read_b64_tr_b16 v[48:49], v87 offset:0
    ds_read_b64_tr_b16 v[50:51], v235 offset:0
    buffer_load_dwordx4 v[128:131], v224, s[40:43], s65 offen offset:0 sc1
    buffer_load_dwordx4 v[132:135], v225, s[40:43], s65 offen offset:0 sc1
    ds_read_b64_tr_b16 v[52:53], v84 offset:4096
    ds_read_b64_tr_b16 v[54:55], v232 offset:4096
    buffer_load_dwordx4 v[136:139], v224, s[40:43], s65 offen offset:1024 sc1
    buffer_load_dwordx4 v[140:143], v225, s[40:43], s65 offen offset:1024 sc1
    ds_read_b64_tr_b16 v[56:57], v85 offset:4096
    ds_read_b64_tr_b16 v[58:59], v233 offset:4096
    ds_read_b64_tr_b16 v[60:61], v86 offset:4096
    ds_read_b64_tr_b16 v[62:63], v234 offset:4096
    s_waitcnt lgkmcnt(12)
    ds_read_b64_tr_b16 v[64:65], v87 offset:4096
    ds_read_b64_tr_b16 v[66:67], v235 offset:4096
    ds_read_b32 v1, v228 offset:36
    s_waitcnt vmcnt(10) lgkmcnt(9)
    v_mfma_f32_16x16x32_bf16 v[4:7], v[36:39], v[96:99], 0
    ds_read_b64_tr_b16 v[68:69], v84 offset:8192
    v_mfma_f32_16x16x32_bf16 v[20:23], v[36:39], v[100:103], 0
    ds_read_b64_tr_b16 v[70:71], v232 offset:8192
    v_mfma_f32_16x16x32_bf16 v[8:11], v[40:43], v[96:99], 0
    ds_read_b64_tr_b16 v[36:37], v85 offset:8192
    v_mfma_f32_16x16x32_bf16 v[24:27], v[40:43], v[100:103], 0
    ds_read_b64_tr_b16 v[38:39], v233 offset:8192
    buffer_load_dwordx4 v[144:147], v224, s[40:43], s65 offen offset:2048 sc1
    v_mfma_f32_16x16x32_bf16 v[12:15], v[44:47], v[96:99], 0
    ds_read_b64_tr_b16 v[40:41], v86 offset:8192
    v_mfma_f32_16x16x32_bf16 v[28:31], v[44:47], v[100:103], 0
    ds_read_b64_tr_b16 v[42:43], v234 offset:8192
    v_mfma_f32_16x16x32_bf16 v[16:19], v[48:51], v[96:99], 0
    ds_read_b64_tr_b16 v[44:45], v87 offset:8192
    v_mfma_f32_16x16x32_bf16 v[32:35], v[48:51], v[100:103], 0
    ds_read_b64_tr_b16 v[46:47], v235 offset:8192
    buffer_load_dwordx4 v[148:151], v225, s[40:43], s65 offen offset:2048 sc1
    s_waitcnt lgkmcnt(8)
    v_readfirstlane_b32 s37, v1
    s_nop 0
    s_cmp_ge_u32 s37, 4
    s_cbranch_scc1 L_sl_done_66
    s_mov_b32 s38, 1048576
L_sl_loop_67:
    ds_read_b32 v1, v228 offset:36
    s_waitcnt lgkmcnt(0)
    v_readfirstlane_b32 s37, v1
    s_nop 0
    s_cmp_ge_u32 s37, 4
    s_cbranch_scc1 L_sl_done_66
    s_sleep 1
    s_sub_u32 s38, s38, 1
    s_cbranch_scc0 L_sl_loop_67
L_sl_done_66:
    ds_write_b128 v230, v[172:175] offset:0
    s_waitcnt vmcnt(10)
    v_mfma_f32_16x16x32_bf16 v[4:7], v[52:55], v[104:107], v[4:7]
    ds_read_b64_tr_b16 v[48:49], v84 offset:12288
    v_mfma_f32_16x16x32_bf16 v[20:23], v[52:55], v[108:111], v[20:23]
    ds_read_b64_tr_b16 v[50:51], v232 offset:12288
    v_mfma_f32_16x16x32_bf16 v[8:11], v[56:59], v[104:107], v[8:11]
    ds_read_b64_tr_b16 v[52:53], v85 offset:12288
    v_mfma_f32_16x16x32_bf16 v[24:27], v[56:59], v[108:111], v[24:27]
    ds_read_b64_tr_b16 v[54:55], v233 offset:12288
    buffer_load_dwordx4 v[96:99], v224, s[40:43], s65 offen offset:3072 sc1
    ds_write_b128 v230, v[176:179] offset:1024
    v_mfma_f32_16x16x32_bf16 v[12:15], v[60:63], v[104:107], v[12:15]
    ds_read_b64_tr_b16 v[56:57], v86 offset:12288
    v_mfma_f32_16x16x32_bf16 v[28:31], v[60:63], v[108:111], v[28:31]
    ds_read_b64_tr_b16 v[58:59], v234 offset:12288
    v_mfma_f32_16x16x32_bf16 v[16:19], v[64:67], v[104:107], v[16:19]
    ds_read_b64_tr_b16 v[60:61], v87 offset:12288
    v_mfma_f32_16x16x32_bf16 v[32:35], v[64:67], v[108:111], v[32:35]
    ds_read_b64_tr_b16 v[62:63], v235 offset:12288
    buffer_load_dwordx4 v[100:103], v225, s[40:43], s65 offen offset:3072 sc1
    ds_write_b128 v230, v[180:183] offset:8448
    s_waitcnt vmcnt(10) lgkmcnt(11)
    v_mfma_f32_16x16x32_bf16 v[4:7], v[68:71], v[112:115], v[4:7]
    ds_read_b64_tr_b16 v[64:65], v84 offset:16384
    v_mfma_f32_16x16x32_bf16 v[20:23], v[68:71], v[116:119], v[20:23]
    ds_read_b64_tr_b16 v[66:67], v232 offset:16384
    v_mfma_f32_16x16x32_bf16 v[8:11], v[36:39], v[112:115], v[8:11]
    ds_read_b64_tr_b16 v[68:69], v85 offset:16384
    v_mfma_f32_16x16x32_bf16 v[24:27], v[36:39], v[116:119], v[24:27]
    ds_read_b64_tr_b16 v[70:71], v233 offset:16384
    buffer_load_dwordx4 v[104:107], v224, s[40:43], s66 offen offset:0 sc1
    ds_write_b128 v230, v[184:187] offset:9472
    v_mfma_f32_16x16x32_bf16 v[12:15], v[40:43], v[112:115], v[12:15]
    ds_read_b64_tr_b16 v[36:37], v86 offset:16384
    v_mfma_f32_16x16x32_bf16 v[28:31], v[40:43], v[116:119], v[28:31]
    ds_read_b64_tr_b16 v[38:39], v234 offset:16384
    v_mfma_f32_16x16x32_bf16 v[16:19], v[44:47], v[112:115], v[16:19]
    ds_read_b64_tr_b16 v[40:41], v87 offset:16384
    v_mfma_f32_16x16x32_bf16 v[32:35], v[44:47], v[116:119], v[32:35]
    ds_read_b64_tr_b16 v[42:43], v235 offset:16384
    buffer_load_dwordx4 v[108:111], v225, s[40:43], s66 offen offset:0 sc1
    ds_write_b128 v230, v[188:191] offset:16896
    s_waitcnt vmcnt(10) lgkmcnt(11)
    v_mfma_f32_16x16x32_bf16 v[4:7], v[48:51], v[120:123], v[4:7]
    ds_read_b64_tr_b16 v[44:45], v84 offset:20480
    v_mfma_f32_16x16x32_bf16 v[20:23], v[48:51], v[124:127], v[20:23]
    ds_read_b64_tr_b16 v[46:47], v232 offset:20480
    v_mfma_f32_16x16x32_bf16 v[8:11], v[52:55], v[120:123], v[8:11]
    ds_read_b64_tr_b16 v[48:49], v85 offset:20480
    v_mfma_f32_16x16x32_bf16 v[24:27], v[52:55], v[124:127], v[24:27]
    ds_read_b64_tr_b16 v[50:51], v233 offset:20480
    buffer_load_dwordx4 v[112:115], v224, s[40:43], s66 offen offset:1024 sc1
    ds_write_b128 v230, v[192:195] offset:17920
    v_mfma_f32_16x16x32_bf16 v[12:15], v[56:59], v[120:123], v[12:15]
    ds_read_b64_tr_b16 v[52:53], v86 offset:20480
    v_mfma_f32_16x16x32_bf16 v[28:31], v[56:59], v[124:127], v[28:31]
    ds_read_b64_tr_b16 v[54:55], v234 offset:20480
    v_mfma_f32_16x16x32_bf16 v[16:19], v[60:63], v[120:123], v[16:19]
    ds_read_b64_tr_b16 v[56:57], v87 offset:20480
    v_mfma_f32_16x16x32_bf16 v[32:35], v[60:63], v[124:127], v[32:35]
    ds_read_b64_tr_b16 v[58:59], v235 offset:20480
    buffer_load_dwordx4 v[116:119], v225, s[40:43], s66 offen offset:1024 sc1
    ds_write_b128 v230, v[196:199] offset:25344
    s_waitcnt vmcnt(10) lgkmcnt(11)
    v_mfma_f32_16x16x32_bf16 v[4:7], v[64:67], v[128:131], v[4:7]
    ds_read_b64_tr_b16 v[60:61], v84 offset:24576
    v_mfma_f32_16x16x32_bf16 v[20:23], v[64:67], v[132:135], v[20:23]
    ds_read_b64_tr_b16 v[62:63], v232 offset:24576
    v_mfma_f32_16x16x32_bf16 v[8:11], v[68:71], v[128:131], v[8:11]
    ds_read_b64_tr_b16 v[64:65], v85 offset:24576
    v_mfma_f32_16x16x32_bf16 v[24:27], v[68:71], v[132:135], v[24:27]
    ds_read_b64_tr_b16 v[66:67], v233 offset:24576
    buffer_load_dwordx4 v[120:123], v224, s[40:43], s66 offen offset:2048 sc1
    ds_write_b128 v230, v[200:203] offset:26368
    v_mfma_f32_16x16x32_bf16 v[12:15], v[36:39], v[128:131], v[12:15]
    ds_read_b64_tr_b16 v[68:69], v86 offset:24576
    v_mfma_f32_16x16x32_bf16 v[28:31], v[36:39], v[132:135], v[28:31]
    ds_read_b64_tr_b16 v[70:71], v234 offset:24576
    v_mfma_f32_16x16x32_bf16 v[16:19], v[40:43], v[128:131], v[16:19]
    ds_read_b64_tr_b16 v[36:37], v87 offset:24576
    v_mfma_f32_16x16x32_bf16 v[32:35], v[40:43], v[132:135], v[32:35]
    ds_read_b64_tr_b16 v[38:39], v235 offset:24576
    buffer_load_dwordx4 v[124:127], v225, s[40:43], s66 offen offset:2048 sc1
    ds_write_b128 v231, v[204:207] offset:41984
    s_waitcnt vmcnt(10) lgkmcnt(11)
    v_mfma_f32_16x16x32_bf16 v[4:7], v[44:47], v[136:139], v[4:7]
    ds_read_b64_tr_b16 v[40:41], v84 offset:28672
    v_mfma_f32_16x16x32_bf16 v[20:23], v[44:47], v[140:143], v[20:23]
    ds_read_b64_tr_b16 v[42:43], v232 offset:28672
    v_mfma_f32_16x16x32_bf16 v[8:11], v[48:51], v[136:139], v[8:11]
    ds_read_b64_tr_b16 v[44:45], v85 offset:28672
    v_mfma_f32_16x16x32_bf16 v[24:27], v[48:51], v[140:143], v[24:27]
    ds_read_b64_tr_b16 v[46:47], v233 offset:28672
    buffer_load_dwordx4 v[128:131], v224, s[40:43], s66 offen offset:3072 sc1
    ds_write_b128 v231, v[208:211] offset:43008
    v_mfma_f32_16x16x32_bf16 v[12:15], v[52:55], v[136:139], v[12:15]
    ds_read_b64_tr_b16 v[48:49], v86 offset:28672
    v_mfma_f32_16x16x32_bf16 v[28:31], v[52:55], v[140:143], v[28:31]
    ds_read_b64_tr_b16 v[50:51], v234 offset:28672
    v_mfma_f32_16x16x32_bf16 v[16:19], v[56:59], v[136:139], v[16:19]
    ds_read_b64_tr_b16 v[52:53], v87 offset:28672
    v_mfma_f32_16x16x32_bf16 v[32:35], v[56:59], v[140:143], v[32:35]
    ds_read_b64_tr_b16 v[54:55], v235 offset:28672
    buffer_load_dwordx4 v[132:135], v225, s[40:43], s66 offen offset:3072 sc1
    ds_write_b128 v231, v[212:215] offset:51200
    s_waitcnt vmcnt(10) lgkmcnt(11)
    v_mfma_f32_16x16x32_bf16 v[4:7], v[60:63], v[144:147], v[4:7]
    ds_read_b64_tr_b16 v[56:57], v84 offset:32768
    v_mfma_f32_16x16x32_bf16 v[20:23], v[60:63], v[148:151], v[20:23]
    ds_read_b64_tr_b16 v[58:59], v232 offset:32768
    v_mfma_f32_16x16x32_bf16 v[8:11], v[64:67], v[144:147], v[8:11]
    ds_read_b64_tr_b16 v[60:61], v85 offset:32768
    v_mfma_f32_16x16x32_bf16 v[24:27], v[64:67], v[148:151], v[24:27]
    ds_read_b64_tr_b16 v[62:63], v233 offset:32768
    buffer_load_dwordx4 v[136:139], v224, s[40:43], s67 offen offset:0 sc1
    ds_write_b128 v231, v[216:219] offset:52224
    s_mov_b64 exec, 1
    ds_add_u32 v228, v2 offset:12
    s_mov_b64 exec, -1
    v_mfma_f32_16x16x32_bf16 v[12:15], v[68:71], v[144:147], v[12:15]
    ds_read_b64_tr_b16 v[64:65], v86 offset:32768
    v_mfma_f32_16x16x32_bf16 v[28:31], v[68:71], v[148:151], v[28:31]
    ds_read_b64_tr_b16 v[66:67], v234 offset:32768
    v_mfma_f32_16x16x32_bf16 v[16:19], v[36:39], v[144:147], v[16:19]
    ds_read_b64_tr_b16 v[68:69], v87 offset:32768
    v_mfma_f32_16x16x32_bf16 v[32:35], v[36:39], v[148:151], v[32:35]
    ds_read_b64_tr_b16 v[70:71], v235 offset:32768
    buffer_load_dwordx4 v[140:143], v225, s[40:43], s67 offen offset:0 sc1
    s_waitcnt vmcnt(10) lgkmcnt(11)
    v_mfma_f32_16x16x32_bf16 v[4:7], v[40:43], v[96:99], v[4:7]
    ds_read_b64_tr_b16 v[36:37], v84 offset:36864
    v_mfma_f32_16x16x32_bf16 v[20:23], v[40:43], v[100:103], v[20:23]
    ds_read_b64_tr_b16 v[38:39], v232 offset:36864
    v_mfma_f32_16x16x32_bf16 v[8:11], v[44:47], v[96:99], v[8:11]
    ds_read_b64_tr_b16 v[40:41], v85 offset:36864
    v_mfma_f32_16x16x32_bf16 v[24:27], v[44:47], v[100:103], v[24:27]
    ds_read_b64_tr_b16 v[42:43], v233 offset:36864
    buffer_load_dwordx4 v[144:147], v224, s[40:43], s67 offen offset:1024 sc1
    v_mfma_f32_16x16x32_bf16 v[12:15], v[48:51], v[96:99], v[12:15]
    ds_read_b64_tr_b16 v[44:45], v86 offset:36864
    v_mfma_f32_16x16x32_bf16 v[28:31], v[48:51], v[100:103], v[28:31]
    ds_read_b64_tr_b16 v[46:47], v234 offset:36864
    v_mfma_f32_16x16x32_bf16 v[16:19], v[52:55], v[96:99], v[16:19]
    ds_read_b64_tr_b16 v[48:49], v87 offset:36864
    v_mfma_f32_16x16x32_bf16 v[32:35], v[52:55], v[100:103], v[32:35]
    ds_read_b64_tr_b16 v[50:51], v235 offset:36864
    buffer_load_dwordx4 v[148:151], v225, s[40:43], s67 offen offset:1024 sc1
    s_waitcnt vmcnt(10) lgkmcnt(8)
    v_mfma_f32_16x16x32_bf16 v[4:7], v[56:59], v[104:107], v[4:7]
    ds_read_b64_tr_b16 v[52:53], v88 offset:0
    v_mfma_f32_16x16x32_bf16 v[20:23], v[56:59], v[108:111], v[20:23]
    ds_read_b64_tr_b16 v[54:55], v236 offset:0
    v_mfma_f32_16x16x32_bf16 v[8:11], v[60:63], v[104:107], v[8:11]
    ds_read_b64_tr_b16 v[56:57], v89 offset:0
    v_mfma_f32_16x16x32_bf16 v[24:27], v[60:63], v[108:111], v[24:27]
    ds_read_b64_tr_b16 v[58:59], v237 offset:0
    buffer_load_dwordx4 v[96:99], v224, s[40:43], s67 offen offset:2048 sc1
    v_mfma_f32_16x16x32_bf16 v[12:15], v[64:67], v[104:107], v[12:15]
    ds_read_b64_tr_b16 v[60:61], v90 offset:0
    v_mfma_f32_16x16x32_bf16 v[28:31], v[64:67], v[108:111], v[28:31]
    ds_read_b64_tr_b16 v[62:63], v238 offset:0
    v_mfma_f32_16x16x32_bf16 v[16:19], v[68:71], v[104:107], v[16:19]
    ds_read_b64_tr_b16 v[64:65], v91 offset:0
    v_mfma_f32_16x16x32_bf16 v[32:35], v[68:71], v[108:111], v[32:35]
    ds_read_b64_tr_b16 v[66:67], v239 offset:0
    buffer_load_dwordx4 v[100:103], v225, s[40:43], s67 offen offset:2048 sc1
    s_waitcnt vmcnt(10) lgkmcnt(8)
    v_mfma_f32_16x16x32_bf16 v[4:7], v[36:39], v[112:115], v[4:7]
    ds_read_b64_tr_b16 v[68:69], v88 offset:4096
    v_mfma_f32_16x16x32_bf16 v[20:23], v[36:39], v[116:119], v[20:23]
    ds_read_b64_tr_b16 v[70:71], v236 offset:4096
    v_mfma_f32_16x16x32_bf16 v[8:11], v[40:43], v[112:115], v[8:11]
    ds_read_b64_tr_b16 v[36:37], v89 offset:4096
    v_mfma_f32_16x16x32_bf16 v[24:27], v[40:43], v[116:119], v[24:27]
    ds_read_b64_tr_b16 v[38:39], v237 offset:4096
    buffer_load_dwordx4 v[104:107], v224, s[40:43], s67 offen offset:3072 sc1
    v_mfma_f32_16x16x32_bf16 v[12:15], v[44:47], v[112:115], v[12:15]
    ds_read_b64_tr_b16 v[40:41], v90 offset:4096
    v_mfma_f32_16x16x32_bf16 v[28:31], v[44:47], v[116:119], v[28:31]
    ds_read_b64_tr_b16 v[42:43], v238 offset:4096
    v_mfma_f32_16x16x32_bf16 v[16:19], v[48:51], v[112:115], v[16:19]
    ds_read_b64_tr_b16 v[44:45], v91 offset:4096
    v_mfma_f32_16x16x32_bf16 v[32:35], v[48:51], v[116:119], v[32:35]
    ds_read_b64_tr_b16 v[46:47], v239 offset:4096
    buffer_load_dwordx4 v[108:111], v225, s[40:43], s67 offen offset:3072 sc1
    s_waitcnt vmcnt(10) lgkmcnt(8)
    v_mfma_f32_16x16x32_bf16 v[4:7], v[52:55], v[120:123], v[4:7]
    ds_read_b64_tr_b16 v[48:49], v88 offset:8192
    v_mfma_f32_16x16x32_bf16 v[20:23], v[52:55], v[124:127], v[20:23]
    ds_read_b64_tr_b16 v[50:51], v236 offset:8192
    v_mfma_f32_16x16x32_bf16 v[8:11], v[56:59], v[120:123], v[8:11]
    ds_read_b64_tr_b16 v[52:53], v89 offset:8192
    v_mfma_f32_16x16x32_bf16 v[24:27], v[56:59], v[124:127], v[24:27]
    ds_read_b64_tr_b16 v[54:55], v237 offset:8192
    buffer_load_dwordx4 v[112:115], v224, s[40:43], s68 offen offset:0 sc1
    v_mfma_f32_16x16x32_bf16 v[12:15], v[60:63], v[120:123], v[12:15]
    ds_read_b64_tr_b16 v[56:57], v90 offset:8192
    v_mfma_f32_16x16x32_bf16 v[28:31], v[60:63], v[124:127], v[28:31]
    ds_read_b64_tr_b16 v[58:59], v238 offset:8192
    v_mfma_f32_16x16x32_bf16 v[16:19], v[64:67], v[120:123], v[16:19]
    ds_read_b64_tr_b16 v[60:61], v91 offset:8192
    v_mfma_f32_16x16x32_bf16 v[32:35], v[64:67], v[124:127], v[32:35]
    ds_read_b64_tr_b16 v[62:63], v239 offset:8192
    buffer_load_dwordx4 v[116:119], v225, s[40:43], s68 offen offset:0 sc1
    s_waitcnt vmcnt(10) lgkmcnt(8)
    v_mfma_f32_16x16x32_bf16 v[4:7], v[68:71], v[128:131], v[4:7]
    ds_read_b64_tr_b16 v[64:65], v88 offset:12288
    v_mfma_f32_16x16x32_bf16 v[20:23], v[68:71], v[132:135], v[20:23]
    ds_read_b64_tr_b16 v[66:67], v236 offset:12288
    v_mfma_f32_16x16x32_bf16 v[8:11], v[36:39], v[128:131], v[8:11]
    ds_read_b64_tr_b16 v[68:69], v89 offset:12288
    v_mfma_f32_16x16x32_bf16 v[24:27], v[36:39], v[132:135], v[24:27]
    ds_read_b64_tr_b16 v[70:71], v237 offset:12288
    buffer_load_dwordx4 v[120:123], v224, s[40:43], s68 offen offset:1024 sc1
    v_mfma_f32_16x16x32_bf16 v[12:15], v[40:43], v[128:131], v[12:15]
    ds_read_b64_tr_b16 v[36:37], v90 offset:12288
    v_mfma_f32_16x16x32_bf16 v[28:31], v[40:43], v[132:135], v[28:31]
    ds_read_b64_tr_b16 v[38:39], v238 offset:12288
    v_mfma_f32_16x16x32_bf16 v[16:19], v[44:47], v[128:131], v[16:19]
    ds_read_b64_tr_b16 v[40:41], v91 offset:12288
    v_mfma_f32_16x16x32_bf16 v[32:35], v[44:47], v[132:135], v[32:35]
    ds_read_b64_tr_b16 v[42:43], v239 offset:12288
    buffer_load_dwordx4 v[124:127], v225, s[40:43], s68 offen offset:1024 sc1
    s_waitcnt vmcnt(10) lgkmcnt(8)
    v_mfma_f32_16x16x32_bf16 v[4:7], v[48:51], v[136:139], v[4:7]
    ds_read_b64_tr_b16 v[44:45], v88 offset:16384
    v_mfma_f32_16x16x32_bf16 v[20:23], v[48:51], v[140:143], v[20:23]
    ds_read_b64_tr_b16 v[46:47], v236 offset:16384
    v_mfma_f32_16x16x32_bf16 v[8:11], v[52:55], v[136:139], v[8:11]
    ds_read_b64_tr_b16 v[48:49], v89 offset:16384
    v_mfma_f32_16x16x32_bf16 v[24:27], v[52:55], v[140:143], v[24:27]
    ds_read_b64_tr_b16 v[50:51], v237 offset:16384
    buffer_load_dwordx4 v[128:131], v224, s[40:43], s68 offen offset:2048 sc1
    v_mfma_f32_16x16x32_bf16 v[12:15], v[56:59], v[136:139], v[12:15]
    ds_read_b64_tr_b16 v[52:53], v90 offset:16384
    v_mfma_f32_16x16x32_bf16 v[28:31], v[56:59], v[140:143], v[28:31]
    ds_read_b64_tr_b16 v[54:55], v238 offset:16384
    v_mfma_f32_16x16x32_bf16 v[16:19], v[60:63], v[136:139], v[16:19]
    ds_read_b64_tr_b16 v[56:57], v91 offset:16384
    v_mfma_f32_16x16x32_bf16 v[32:35], v[60:63], v[140:143], v[32:35]
    ds_read_b64_tr_b16 v[58:59], v239 offset:16384
    buffer_load_dwordx4 v[132:135], v225, s[40:43], s68 offen offset:2048 sc1
    s_waitcnt vmcnt(10) lgkmcnt(8)
    v_mfma_f32_16x16x32_bf16 v[4:7], v[64:67], v[144:147], v[4:7]
    ds_read_b64_tr_b16 v[60:61], v88 offset:20480
    v_mfma_f32_16x16x32_bf16 v[20:23], v[64:67], v[148:151], v[20:23]
    ds_read_b64_tr_b16 v[62:63], v236 offset:20480
    v_mfma_f32_16x16x32_bf16 v[8:11], v[68:71], v[144:147], v[8:11]
    ds_read_b64_tr_b16 v[64:65], v89 offset:20480
    v_mfma_f32_16x16x32_bf16 v[24:27], v[68:71], v[148:151], v[24:27]
    ds_read_b64_tr_b16 v[66:67], v237 offset:20480
    buffer_load_dwordx4 v[136:139], v224, s[40:43], s68 offen offset:3072 sc1
    v_mfma_f32_16x16x32_bf16 v[12:15], v[36:39], v[144:147], v[12:15]
    ds_read_b64_tr_b16 v[68:69], v90 offset:20480
    v_mfma_f32_16x16x32_bf16 v[28:31], v[36:39], v[148:151], v[28:31]
    ds_read_b64_tr_b16 v[70:71], v238 offset:20480
    v_mfma_f32_16x16x32_bf16 v[16:19], v[40:43], v[144:147], v[16:19]
    ds_read_b64_tr_b16 v[36:37], v91 offset:20480
    v_mfma_f32_16x16x32_bf16 v[32:35], v[40:43], v[148:151], v[32:35]
    ds_read_b64_tr_b16 v[38:39], v239 offset:20480
    buffer_load_dwordx4 v[140:143], v225, s[40:43], s68 offen offset:3072 sc1
    s_waitcnt vmcnt(10) lgkmcnt(8)
    v_mfma_f32_16x16x32_bf16 v[4:7], v[44:47], v[96:99], v[4:7]
    ds_read_b64_tr_b16 v[40:41], v88 offset:24576
    v_mfma_f32_16x16x32_bf16 v[20:23], v[44:47], v[100:103], v[20:23]
    ds_read_b64_tr_b16 v[42:43], v236 offset:24576
    v_mfma_f32_16x16x32_bf16 v[8:11], v[48:51], v[96:99], v[8:11]
    ds_read_b64_tr_b16 v[44:45], v89 offset:24576
    v_mfma_f32_16x16x32_bf16 v[24:27], v[48:51], v[100:103], v[24:27]
    ds_read_b64_tr_b16 v[46:47], v237 offset:24576
    buffer_load_dwordx4 v[144:147], v224, s[40:43], s69 offen offset:0 sc1
    v_mfma_f32_16x16x32_bf16 v[12:15], v[52:55], v[96:99], v[12:15]
    ds_read_b64_tr_b16 v[48:49], v90 offset:24576
    v_mfma_f32_16x16x32_bf16 v[28:31], v[52:55], v[100:103], v[28:31]
    ds_read_b64_tr_b16 v[50:51], v238 offset:24576
    v_mfma_f32_16x16x32_bf16 v[16:19], v[56:59], v[96:99], v[16:19]
    ds_read_b64_tr_b16 v[52:53], v91 offset:24576
    v_mfma_f32_16x16x32_bf16 v[32:35], v[56:59], v[100:103], v[32:35]
    ds_read_b64_tr_b16 v[54:55], v239 offset:24576
    buffer_load_dwordx4 v[148:151], v225, s[40:43], s69 offen offset:0 sc1
    s_waitcnt vmcnt(10) lgkmcnt(8)
    v_mfma_f32_16x16x32_bf16 v[4:7], v[60:63], v[104:107], v[4:7]
    ds_read_b64_tr_b16 v[56:57], v88 offset:28672
    v_mfma_f32_16x16x32_bf16 v[20:23], v[60:63], v[108:111], v[20:23]
    ds_read_b64_tr_b16 v[58:59], v236 offset:28672
    v_mfma_f32_16x16x32_bf16 v[8:11], v[64:67], v[104:107], v[8:11]
    ds_read_b64_tr_b16 v[60:61], v89 offset:28672
    v_mfma_f32_16x16x32_bf16 v[24:27], v[64:67], v[108:111], v[24:27]
    ds_read_b64_tr_b16 v[62:63], v237 offset:28672
    buffer_load_dwordx4 v[96:99], v224, s[40:43], s69 offen offset:1024 sc1
    v_mfma_f32_16x16x32_bf16 v[12:15], v[68:71], v[104:107], v[12:15]
    ds_read_b64_tr_b16 v[64:65], v90 offset:28672
    v_mfma_f32_16x16x32_bf16 v[28:31], v[68:71], v[108:111], v[28:31]
    ds_read_b64_tr_b16 v[66:67], v238 offset:28672
    v_mfma_f32_16x16x32_bf16 v[16:19], v[36:39], v[104:107], v[16:19]
    ds_read_b64_tr_b16 v[68:69], v91 offset:28672
    v_mfma_f32_16x16x32_bf16 v[32:35], v[36:39], v[108:111], v[32:35]
    ds_read_b64_tr_b16 v[70:71], v239 offset:28672
    buffer_load_dwordx4 v[100:103], v225, s[40:43], s69 offen offset:1024 sc1
    s_waitcnt vmcnt(10) lgkmcnt(8)
    v_mfma_f32_16x16x32_bf16 v[4:7], v[40:43], v[112:115], v[4:7]
    ds_read_b64_tr_b16 v[36:37], v88 offset:32768
    v_mfma_f32_16x16x32_bf16 v[20:23], v[40:43], v[116:119], v[20:23]
    ds_read_b64_tr_b16 v[38:39], v236 offset:32768
    v_mfma_f32_16x16x32_bf16 v[8:11], v[44:47], v[112:115], v[8:11]
    ds_read_b64_tr_b16 v[40:41], v89 offset:32768
    v_mfma_f32_16x16x32_bf16 v[24:27], v[44:47], v[116:119], v[24:27]
    ds_read_b64_tr_b16 v[42:43], v237 offset:32768
    buffer_load_dwordx4 v[104:107], v224, s[40:43], s69 offen offset:2048 sc1
    v_mfma_f32_16x16x32_bf16 v[12:15], v[48:51], v[112:115], v[12:15]
    ds_read_b64_tr_b16 v[44:45], v90 offset:32768
    v_mfma_f32_16x16x32_bf16 v[28:31], v[48:51], v[116:119], v[28:31]
    ds_read_b64_tr_b16 v[46:47], v238 offset:32768
    v_mfma_f32_16x16x32_bf16 v[16:19], v[52:55], v[112:115], v[16:19]
    ds_read_b64_tr_b16 v[48:49], v91 offset:32768
    v_mfma_f32_16x16x32_bf16 v[32:35], v[52:55], v[116:119], v[32:35]
    ds_read_b64_tr_b16 v[50:51], v239 offset:32768
    buffer_load_dwordx4 v[108:111], v225, s[40:43], s69 offen offset:2048 sc1
    ds_read_b32 v1, v228 offset:12
    s_waitcnt vmcnt(10) lgkmcnt(9)
    v_mfma_f32_16x16x32_bf16 v[4:7], v[56:59], v[120:123], v[4:7]
    ds_read_b64_tr_b16 v[52:53], v88 offset:36864
    v_mfma_f32_16x16x32_bf16 v[20:23], v[56:59], v[124:127], v[20:23]
    ds_read_b64_tr_b16 v[54:55], v236 offset:36864
    v_mfma_f32_16x16x32_bf16 v[8:11], v[60:63], v[120:123], v[8:11]
    ds_read_b64_tr_b16 v[56:57], v89 offset:36864
    v_mfma_f32_16x16x32_bf16 v[24:27], v[60:63], v[124:127], v[24:27]
    ds_read_b64_tr_b16 v[58:59], v237 offset:36864
    buffer_load_dwordx4 v[112:115], v224, s[40:43], s69 offen offset:3072 sc1
    v_mfma_f32_16x16x32_bf16 v[12:15], v[64:67], v[120:123], v[12:15]
    ds_read_b64_tr_b16 v[60:61], v90 offset:36864
    v_mfma_f32_16x16x32_bf16 v[28:31], v[64:67], v[124:127], v[28:31]
    ds_read_b64_tr_b16 v[62:63], v238 offset:36864
    v_mfma_f32_16x16x32_bf16 v[16:19], v[68:71], v[120:123], v[16:19]
    ds_read_b64_tr_b16 v[64:65], v91 offset:36864
    v_mfma_f32_16x16x32_bf16 v[32:35], v[68:71], v[124:127], v[32:35]
    ds_read_b64_tr_b16 v[66:67], v239 offset:36864
    buffer_load_dwordx4 v[116:119], v225, s[40:43], s69 offen offset:3072 sc1
    s_waitcnt lgkmcnt(8)
    v_readfirstlane_b32 s37, v1
    s_nop 0
    s_cmp_ge_u32 s37, 4
    s_cbranch_scc1 L_sl_done_68
    s_mov_b32 s38, 1048576
L_sl_loop_69:
    ds_read_b32 v1, v228 offset:12
    s_waitcnt lgkmcnt(0)
    v_readfirstlane_b32 s37, v1
    s_nop 0
    s_cmp_ge_u32 s37, 4
    s_cbranch_scc1 L_sl_done_68
    s_sleep 1
    s_sub_u32 s38, s38, 1
    s_cbranch_scc0 L_sl_loop_69
L_sl_done_68:
    s_waitcnt vmcnt(10)
    v_mfma_f32_16x16x32_bf16 v[4:7], v[36:39], v[128:131], v[4:7]
    ds_read_b64_tr_b16 v[68:69], v92 offset:0
    v_mfma_f32_16x16x32_bf16 v[20:23], v[36:39], v[132:135], v[20:23]
    ds_read_b64_tr_b16 v[70:71], v240 offset:0
    v_mfma_f32_16x16x32_bf16 v[8:11], v[40:43], v[128:131], v[8:11]
    ds_read_b64_tr_b16 v[36:37], v93 offset:0
    v_mfma_f32_16x16x32_bf16 v[24:27], v[40:43], v[132:135], v[24:27]
    ds_read_b64_tr_b16 v[38:39], v241 offset:0
    buffer_load_dwordx4 v[120:123], v224, s[40:43], s70 offen offset:0 sc1
    v_mfma_f32_16x16x32_bf16 v[12:15], v[44:47], v[128:131], v[12:15]
    ds_read_b64_tr_b16 v[40:41], v94 offset:0
    v_mfma_f32_16x16x32_bf16 v[28:31], v[44:47], v[132:135], v[28:31]
    ds_read_b64_tr_b16 v[42:43], v242 offset:0
    v_mfma_f32_16x16x32_bf16 v[16:19], v[48:51], v[128:131], v[16:19]
    ds_read_b64_tr_b16 v[44:45], v95 offset:0
    v_mfma_f32_16x16x32_bf16 v[32:35], v[48:51], v[132:135], v[32:35]
    ds_read_b64_tr_b16 v[46:47], v243 offset:0
    buffer_load_dwordx4 v[124:127], v225, s[40:43], s70 offen offset:0 sc1
    s_waitcnt vmcnt(10) lgkmcnt(8)
    v_mfma_f32_16x16x32_bf16 v[4:7], v[52:55], v[136:139], v[4:7]
    ds_read_b64_tr_b16 v[48:49], v92 offset:4096
    v_mfma_f32_16x16x32_bf16 v[20:23], v[52:55], v[140:143], v[20:23]
    ds_read_b64_tr_b16 v[50:51], v240 offset:4096
    v_mfma_f32_16x16x32_bf16 v[8:11], v[56:59], v[136:139], v[8:11]
    ds_read_b64_tr_b16 v[52:53], v93 offset:4096
    v_mfma_f32_16x16x32_bf16 v[24:27], v[56:59], v[140:143], v[24:27]
    ds_read_b64_tr_b16 v[54:55], v241 offset:4096
    buffer_load_dwordx4 v[128:131], v224, s[40:43], s70 offen offset:1024 sc1
    v_mfma_f32_16x16x32_bf16 v[12:15], v[60:63], v[136:139], v[12:15]
    ds_read_b64_tr_b16 v[56:57], v94 offset:4096
    v_mfma_f32_16x16x32_bf16 v[28:31], v[60:63], v[140:143], v[28:31]
    ds_read_b64_tr_b16 v[58:59], v242 offset:4096
    v_mfma_f32_16x16x32_bf16 v[16:19], v[64:67], v[136:139], v[16:19]
    ds_read_b64_tr_b16 v[60:61], v95 offset:4096
    v_mfma_f32_16x16x32_bf16 v[32:35], v[64:67], v[140:143], v[32:35]
    ds_read_b64_tr_b16 v[62:63], v243 offset:4096
    buffer_load_dwordx4 v[132:135], v225, s[40:43], s70 offen offset:1024 sc1
    s_waitcnt vmcnt(10) lgkmcnt(8)
    v_mfma_f32_16x16x32_bf16 v[4:7], v[68:71], v[144:147], v[4:7]
    ds_read_b64_tr_b16 v[64:65], v92 offset:8448
    v_mfma_f32_16x16x32_bf16 v[20:23], v[68:71], v[148:151], v[20:23]
    ds_read_b64_tr_b16 v[66:67], v240 offset:8448
    v_mfma_f32_16x16x32_bf16 v[8:11], v[36:39], v[144:147], v[8:11]
    ds_read_b64_tr_b16 v[68:69], v93 offset:8448
    v_mfma_f32_16x16x32_bf16 v[24:27], v[36:39], v[148:151], v[24:27]
    ds_read_b64_tr_b16 v[70:71], v241 offset:8448
    buffer_load_dwordx4 v[136:139], v224, s[40:43], s70 offen offset:2048 sc1
    v_mfma_f32_16x16x32_bf16 v[12:15], v[40:43], v[144:147], v[12:15]
    ds_read_b64_tr_b16 v[36:37], v94 offset:8448
    v_mfma_f32_16x16x32_bf16 v[28:31], v[40:43], v[148:151], v[28:31]
    ds_read_b64_tr_b16 v[38:39], v242 offset:8448
    v_mfma_f32_16x16x32_bf16 v[16:19], v[44:47], v[144:147], v[16:19]
    ds_read_b64_tr_b16 v[40:41], v95 offset:8448
    v_mfma_f32_16x16x32_bf16 v[32:35], v[44:47], v[148:151], v[32:35]
    ds_read_b64_tr_b16 v[42:43], v243 offset:8448
    buffer_load_dwordx4 v[140:143], v225, s[40:43], s70 offen offset:2048 sc1
    s_waitcnt vmcnt(10) lgkmcnt(8)
    v_mfma_f32_16x16x32_bf16 v[4:7], v[48:51], v[96:99], v[4:7]
    ds_read_b64_tr_b16 v[44:45], v92 offset:12544
    v_mfma_f32_16x16x32_bf16 v[20:23], v[48:51], v[100:103], v[20:23]
    ds_read_b64_tr_b16 v[46:47], v240 offset:12544
    v_mfma_f32_16x16x32_bf16 v[8:11], v[52:55], v[96:99], v[8:11]
    ds_read_b64_tr_b16 v[48:49], v93 offset:12544
    v_mfma_f32_16x16x32_bf16 v[24:27], v[52:55], v[100:103], v[24:27]
    ds_read_b64_tr_b16 v[50:51], v241 offset:12544
    buffer_load_dwordx4 v[144:147], v224, s[40:43], s70 offen offset:3072 sc1
    v_mfma_f32_16x16x32_bf16 v[12:15], v[56:59], v[96:99], v[12:15]
    ds_read_b64_tr_b16 v[52:53], v94 offset:12544
    v_mfma_f32_16x16x32_bf16 v[28:31], v[56:59], v[100:103], v[28:31]
    ds_read_b64_tr_b16 v[54:55], v242 offset:12544
    v_mfma_f32_16x16x32_bf16 v[16:19], v[60:63], v[96:99], v[16:19]
    ds_read_b64_tr_b16 v[56:57], v95 offset:12544
    v_mfma_f32_16x16x32_bf16 v[32:35], v[60:63], v[100:103], v[32:35]
    ds_read_b64_tr_b16 v[58:59], v243 offset:12544
    buffer_load_dwordx4 v[148:151], v225, s[40:43], s70 offen offset:3072 sc1
    s_waitcnt vmcnt(10) lgkmcnt(8)
    v_mfma_f32_16x16x32_bf16 v[4:7], v[64:67], v[104:107], v[4:7]
    ds_read_b64_tr_b16 v[60:61], v92 offset:16896
    v_mfma_f32_16x16x32_bf16 v[20:23], v[64:67], v[108:111], v[20:23]
    ds_read_b64_tr_b16 v[62:63], v240 offset:16896
    v_mfma_f32_16x16x32_bf16 v[8:11], v[68:71], v[104:107], v[8:11]
    ds_read_b64_tr_b16 v[64:65], v93 offset:16896
    v_mfma_f32_16x16x32_bf16 v[24:27], v[68:71], v[108:111], v[24:27]
    ds_read_b64_tr_b16 v[66:67], v241 offset:16896
    buffer_load_dwordx4 v[96:99], v224, s[40:43], s71 offen offset:0 sc1
    v_mfma_f32_16x16x32_bf16 v[12:15], v[36:39], v[104:107], v[12:15]
    ds_read_b64_tr_b16 v[68:69], v94 offset:16896
    v_mfma_f32_16x16x32_bf16 v[28:31], v[36:39], v[108:111], v[28:31]
    ds_read_b64_tr_b16 v[70:71], v242 offset:16896
    v_mfma_f32_16x16x32_bf16 v[16:19], v[40:43], v[104:107], v[16:19]
    ds_read_b64_tr_b16 v[36:37], v95 offset:16896
    v_mfma_f32_16x16x32_bf16 v[32:35], v[40:43], v[108:111], v[32:35]
    ds_read_b64_tr_b16 v[38:39], v243 offset:16896
    buffer_load_dwordx4 v[100:103], v225, s[40:43], s71 offen offset:0 sc1
    s_waitcnt vmcnt(10) lgkmcnt(8)
    v_mfma_f32_16x16x32_bf16 v[4:7], v[44:47], v[112:115], v[4:7]
    ds_read_b64_tr_b16 v[40:41], v92 offset:20992
    v_mfma_f32_16x16x32_bf16 v[20:23], v[44:47], v[116:119], v[20:23]
    ds_read_b64_tr_b16 v[42:43], v240 offset:20992
    v_mfma_f32_16x16x32_bf16 v[8:11], v[48:51], v[112:115], v[8:11]
    ds_read_b64_tr_b16 v[44:45], v93 offset:20992
    v_mfma_f32_16x16x32_bf16 v[24:27], v[48:51], v[116:119], v[24:27]
    ds_read_b64_tr_b16 v[46:47], v241 offset:20992
    buffer_load_dwordx4 v[104:107], v224, s[40:43], s71 offen offset:1024 sc1
    v_mfma_f32_16x16x32_bf16 v[12:15], v[52:55], v[112:115], v[12:15]
    ds_read_b64_tr_b16 v[48:49], v94 offset:20992
    v_mfma_f32_16x16x32_bf16 v[28:31], v[52:55], v[116:119], v[28:31]
    ds_read_b64_tr_b16 v[50:51], v242 offset:20992
    v_mfma_f32_16x16x32_bf16 v[16:19], v[56:59], v[112:115], v[16:19]
    ds_read_b64_tr_b16 v[52:53], v95 offset:20992
    v_mfma_f32_16x16x32_bf16 v[32:35], v[56:59], v[116:119], v[32:35]
    ds_read_b64_tr_b16 v[54:55], v243 offset:20992
    buffer_load_dwordx4 v[108:111], v225, s[40:43], s71 offen offset:1024 sc1
    s_waitcnt vmcnt(10) lgkmcnt(8)
    v_mfma_f32_16x16x32_bf16 v[4:7], v[60:63], v[120:123], v[4:7]
    ds_read_b64_tr_b16 v[56:57], v92 offset:25344
    v_mfma_f32_16x16x32_bf16 v[20:23], v[60:63], v[124:127], v[20:23]
    ds_read_b64_tr_b16 v[58:59], v240 offset:25344
    v_mfma_f32_16x16x32_bf16 v[8:11], v[64:67], v[120:123], v[8:11]
    ds_read_b64_tr_b16 v[60:61], v93 offset:25344
    v_mfma_f32_16x16x32_bf16 v[24:27], v[64:67], v[124:127], v[24:27]
    ds_read_b64_tr_b16 v[62:63], v241 offset:25344
    buffer_load_dwordx4 v[112:115], v224, s[40:43], s71 offen offset:2048 sc1
    v_mfma_f32_16x16x32_bf16 v[12:15], v[68:71], v[120:123], v[12:15]
    ds_read_b64_tr_b16 v[64:65], v94 offset:25344
    v_mfma_f32_16x16x32_bf16 v[28:31], v[68:71], v[124:127], v[28:31]
    ds_read_b64_tr_b16 v[66:67], v242 offset:25344
    v_mfma_f32_16x16x32_bf16 v[16:19], v[36:39], v[120:123], v[16:19]
    ds_read_b64_tr_b16 v[68:69], v95 offset:25344
    v_mfma_f32_16x16x32_bf16 v[32:35], v[36:39], v[124:127], v[32:35]
    ds_read_b64_tr_b16 v[70:71], v243 offset:25344
    buffer_load_dwordx4 v[116:119], v225, s[40:43], s71 offen offset:2048 sc1
    s_waitcnt vmcnt(10) lgkmcnt(8)
    v_mfma_f32_16x16x32_bf16 v[4:7], v[40:43], v[128:131], v[4:7]
    ds_read_b64_tr_b16 v[36:37], v92 offset:29440
    v_mfma_f32_16x16x32_bf16 v[20:23], v[40:43], v[132:135], v[20:23]
    ds_read_b64_tr_b16 v[38:39], v240 offset:29440
    v_mfma_f32_16x16x32_bf16 v[8:11], v[44:47], v[128:131], v[8:11]
    ds_read_b64_tr_b16 v[40:41], v93 offset:29440
    v_mfma_f32_16x16x32_bf16 v[24:27], v[44:47], v[132:135], v[24:27]
    ds_read_b64_tr_b16 v[42:43], v241 offset:29440
    buffer_load_dwordx4 v[120:123], v224, s[40:43], s71 offen offset:3072 sc1
    v_mfma_f32_16x16x32_bf16 v[12:15], v[48:51], v[128:131], v[12:15]
    ds_read_b64_tr_b16 v[44:45], v94 offset:29440
    v_mfma_f32_16x16x32_bf16 v[28:31], v[48:51], v[132:135], v[28:31]
    ds_read_b64_tr_b16 v[46:47], v242 offset:29440
    v_mfma_f32_16x16x32_bf16 v[16:19], v[52:55], v[128:131], v[16:19]
    ds_read_b64_tr_b16 v[48:49], v95 offset:29440
    v_mfma_f32_16x16x32_bf16 v[32:35], v[52:55], v[132:135], v[32:35]
    ds_read_b64_tr_b16 v[50:51], v243 offset:29440
    buffer_load_dwordx4 v[124:127], v225, s[40:43], s71 offen offset:3072 sc1
    s_waitcnt vmcnt(10) lgkmcnt(8)
    v_mfma_f32_16x16x32_bf16 v[4:7], v[56:59], v[136:139], v[4:7]
    ds_read_b64_tr_b16 v[52:53], v84 offset:41984
    v_mfma_f32_16x16x32_bf16 v[20:23], v[56:59], v[140:143], v[20:23]
    ds_read_b64_tr_b16 v[54:55], v232 offset:41984
    v_mfma_f32_16x16x32_bf16 v[8:11], v[60:63], v[136:139], v[8:11]
    ds_read_b64_tr_b16 v[56:57], v85 offset:41984
    v_mfma_f32_16x16x32_bf16 v[24:27], v[60:63], v[140:143], v[24:27]
    ds_read_b64_tr_b16 v[58:59], v233 offset:41984
    v_mfma_f32_16x16x32_bf16 v[12:15], v[64:67], v[136:139], v[12:15]
    ds_read_b64_tr_b16 v[60:61], v86 offset:41984
    v_mfma_f32_16x16x32_bf16 v[28:31], v[64:67], v[140:143], v[28:31]
    ds_read_b64_tr_b16 v[62:63], v234 offset:41984
    v_mfma_f32_16x16x32_bf16 v[16:19], v[68:71], v[136:139], v[16:19]
    ds_read_b64_tr_b16 v[64:65], v87 offset:41984
    v_mfma_f32_16x16x32_bf16 v[32:35], v[68:71], v[140:143], v[32:35]
    ds_read_b64_tr_b16 v[66:67], v235 offset:41984
    s_waitcnt vmcnt(8) lgkmcnt(8)
    v_mfma_f32_16x16x32_bf16 v[4:7], v[36:39], v[144:147], v[4:7]
    ds_read_b64_tr_b16 v[68:69], v84 offset:46080
    v_mfma_f32_16x16x32_bf16 v[20:23], v[36:39], v[148:151], v[20:23]
    ds_read_b64_tr_b16 v[70:71], v232 offset:46080
    v_mfma_f32_16x16x32_bf16 v[8:11], v[40:43], v[144:147], v[8:11]
    ds_read_b64_tr_b16 v[36:37], v85 offset:46080
    v_mfma_f32_16x16x32_bf16 v[24:27], v[40:43], v[148:151], v[24:27]
    ds_read_b64_tr_b16 v[38:39], v233 offset:46080
    v_mfma_f32_16x16x32_bf16 v[12:15], v[44:47], v[144:147], v[12:15]
    ds_read_b64_tr_b16 v[40:41], v86 offset:46080
    v_mfma_f32_16x16x32_bf16 v[28:31], v[44:47], v[148:151], v[28:31]
    ds_read_b64_tr_b16 v[42:43], v234 offset:46080
    v_mfma_f32_16x16x32_bf16 v[16:19], v[48:51], v[144:147], v[16:19]
    ds_read_b64_tr_b16 v[44:45], v87 offset:46080
    v_mfma_f32_16x16x32_bf16 v[32:35], v[48:51], v[148:151], v[32:35]
    ds_read_b64_tr_b16 v[46:47], v235 offset:46080
    s_waitcnt vmcnt(6) lgkmcnt(8)
    v_mfma_f32_16x16x32_bf16 v[4:7], v[52:55], v[96:99], v[4:7]
    ds_read_b64_tr_b16 v[48:49], v84 offset:51200
    v_mfma_f32_16x16x32_bf16 v[20:23], v[52:55], v[100:103], v[20:23]
    ds_read_b64_tr_b16 v[50:51], v232 offset:51200
    v_mfma_f32_16x16x32_bf16 v[8:11], v[56:59], v[96:99], v[8:11]
    ds_read_b64_tr_b16 v[52:53], v85 offset:51200
    v_mfma_f32_16x16x32_bf16 v[24:27], v[56:59], v[100:103], v[24:27]
    ds_read_b64_tr_b16 v[54:55], v233 offset:51200
    v_mfma_f32_16x16x32_bf16 v[12:15], v[60:63], v[96:99], v[12:15]
    ds_read_b64_tr_b16 v[56:57], v86 offset:51200
    v_mfma_f32_16x16x32_bf16 v[28:31], v[60:63], v[100:103], v[28:31]
    ds_read_b64_tr_b16 v[58:59], v234 offset:51200
    v_mfma_f32_16x16x32_bf16 v[16:19], v[64:67], v[96:99], v[16:19]
    ds_read_b64_tr_b16 v[60:61], v87 offset:51200
    v_mfma_f32_16x16x32_bf16 v[32:35], v[64:67], v[100:103], v[32:35]
    ds_read_b64_tr_b16 v[62:63], v235 offset:51200
    s_waitcnt vmcnt(4) lgkmcnt(8)
    v_mfma_f32_16x16x32_bf16 v[4:7], v[68:71], v[104:107], v[4:7]
    ds_read_b64_tr_b16 v[64:65], v84 offset:55296
    v_mfma_f32_16x16x32_bf16 v[20:23], v[68:71], v[108:111], v[20:23]
    ds_read_b64_tr_b16 v[66:67], v232 offset:55296
    v_mfma_f32_16x16x32_bf16 v[8:11], v[36:39], v[104:107], v[8:11]
    ds_read_b64_tr_b16 v[68:69], v85 offset:55296
    v_mfma_f32_16x16x32_bf16 v[24:27], v[36:39], v[108:111], v[24:27]
    ds_read_b64_tr_b16 v[70:71], v233 offset:55296
    v_mfma_f32_16x16x32_bf16 v[12:15], v[40:43], v[104:107], v[12:15]
    ds_read_b64_tr_b16 v[36:37], v86 offset:55296
    v_mfma_f32_16x16x32_bf16 v[28:31], v[40:43], v[108:111], v[28:31]
    ds_read_b64_tr_b16 v[38:39], v234 offset:55296
    v_mfma_f32_16x16x32_bf16 v[16:19], v[44:47], v[104:107], v[16:19]
    ds_read_b64_tr_b16 v[40:41], v87 offset:55296
    v_mfma_f32_16x16x32_bf16 v[32:35], v[44:47], v[108:111], v[32:35]
    ds_read_b64_tr_b16 v[42:43], v235 offset:55296
    s_waitcnt vmcnt(2) lgkmcnt(8)
    v_mfma_f32_16x16x32_bf16 v[4:7], v[48:51], v[112:115], v[4:7]
    v_mfma_f32_16x16x32_bf16 v[8:11], v[52:55], v[112:115], v[8:11]
    v_mfma_f32_16x16x32_bf16 v[12:15], v[56:59], v[112:115], v[12:15]
    v_mfma_f32_16x16x32_bf16 v[16:19], v[60:63], v[112:115], v[16:19]
    s_waitcnt vmcnt(0) lgkmcnt(0)
    v_mfma_f32_16x16x32_bf16 v[4:7], v[64:67], v[120:123], v[4:7]
    s_nop 0
    s_nop 0
    v_mfma_f32_16x16x32_bf16 v[8:11], v[68:71], v[120:123], v[8:11]
    s_nop 0
    s_nop 0
    v_mfma_f32_16x16x32_bf16 v[12:15], v[36:39], v[120:123], v[12:15]
    s_nop 0
    s_nop 0
    v_cvt_pk_bf16_f32 v172, v4, v5
    v_cvt_pk_bf16_f32 v173, v6, v7
    v_mfma_f32_16x16x32_bf16 v[16:19], v[40:43], v[120:123], v[16:19]
    ds_write_b64 v244, v[172:173]
    v_cvt_pk_bf16_f32 v174, v8, v9
    v_mfma_f32_16x16x32_bf16 v[20:23], v[48:51], v[116:119], v[20:23]
    v_cvt_pk_bf16_f32 v175, v10, v11
    ds_write_b64 v245, v[174:175]
    v_mfma_f32_16x16x32_bf16 v[20:23], v[64:67], v[124:127], v[20:23]
    v_cvt_pk_bf16_f32 v176, v12, v13
    v_cvt_pk_bf16_f32 v177, v14, v15
    v_mfma_f32_16x16x32_bf16 v[24:27], v[52:55], v[116:119], v[24:27]
    ds_write_b64 v246, v[176:177]
    v_cvt_pk_bf16_f32 v178, v16, v17
    v_mfma_f32_16x16x32_bf16 v[24:27], v[68:71], v[124:127], v[24:27]
    v_cvt_pk_bf16_f32 v179, v18, v19
    ds_write_b64 v247, v[178:179]
    v_mfma_f32_16x16x32_bf16 v[28:31], v[56:59], v[116:119], v[28:31]
    ds_read_b128 v[188:191], v248 offset:0
    ds_read_b128 v[192:195], v248 offset:1024
    v_mfma_f32_16x16x32_bf16 v[28:31], v[36:39], v[124:127], v[28:31]
    v_cvt_pk_bf16_f32 v180, v20, v21
    v_cvt_pk_bf16_f32 v181, v22, v23
    v_mfma_f32_16x16x32_bf16 v[32:35], v[60:63], v[116:119], v[32:35]
    ds_write_b64 v244, v[180:181]
    v_cvt_pk_bf16_f32 v182, v24, v25
    v_mfma_f32_16x16x32_bf16 v[32:35], v[40:43], v[124:127], v[32:35]
    v_cvt_pk_bf16_f32 v183, v26, v27
    ds_write_b64 v245, v[182:183]
    v_cvt_pk_bf16_f32 v184, v28, v29
    v_cvt_pk_bf16_f32 v185, v30, v31
    s_mov_b32 s37, 0
    s_waitcnt lgkmcnt(3)
    buffer_store_dwordx4 v[188:191], v226, s[48:51], s37 offen nt
    s_mov_b32 s37, 65536
    s_waitcnt lgkmcnt(2)
    buffer_store_dwordx4 v[192:195], v226, s[48:51], s37 offen nt
    ds_write_b64 v246, v[184:185]
    v_cvt_pk_bf16_f32 v186, v32, v33
    v_cvt_pk_bf16_f32 v187, v34, v35
    ds_write_b64 v247, v[186:187]
    ds_read_b128 v[196:199], v248 offset:0
    ds_read_b128 v[200:203], v248 offset:1024
    s_mov_b32 s37, 131072
    s_waitcnt lgkmcnt(1)
    buffer_store_dwordx4 v[196:199], v226, s[48:51], s37 offen nt
    s_mov_b32 s37, 196608
    s_waitcnt lgkmcnt(0)
    buffer_store_dwordx4 v[200:203], v226, s[48:51], s37 offen nt
    s_endpgm
L_end:
    s_endpgm
.section .rodata,"a"
.p2align 6
.amdhsa_kernel concat_heads__ssm_conv_h3__sliding_local_dilated__prompt_kernel
  .amdhsa_next_free_vgpr 256
  .amdhsa_next_free_sgpr 102
  .amdhsa_accum_offset 256
  .amdhsa_group_segment_fixed_size 0
  .amdhsa_kernarg_size 96
  .amdhsa_user_sgpr_count 2
  .amdhsa_user_sgpr_kernarg_segment_ptr 1
  .amdhsa_system_sgpr_workgroup_id_x 1
  .amdhsa_float_denorm_mode_32 3
.end_amdhsa_kernel
```
